```python
import torch

def _softmax(x, axis=-1):
    return torch.softmax(x, dim=axis)
def _gelu(x):
    return torch.nn.functional.gelu(x, approximate="tanh")
def _silu(x):
    return torch.nn.functional.silu(x)
def _sigmoid(x):
    return torch.sigmoid(x)
def _layernorm(x, axis=-1, eps=1e-5):
    m = x.mean(dim=axis, keepdim=True)
    v = x.var(dim=axis, keepdim=True, unbiased=False)
    return (x - m) / torch.sqrt(v + eps)
def _scatter_add(tgt, idx, src, axis=0):
    return tgt.clone().index_add_(axis, idx, src)
def _segment_sum(src, seg, n):
    out = torch.zeros((n,) + src.shape[1:], dtype=src.dtype)
    return out.index_add_(0, seg, src)
def _pad(x, pw):
    flat = tuple(v for pair in reversed(pw) for v in pair)
    return torch.nn.functional.pad(x, flat)

kernel_name = 'gated_mix__ssm_conv_s5__swiglu_ffn__prompt'

def setup_inputs():

    _w = (lambda a: (lambda t: t.to(torch.bfloat16) if t.is_floating_point() else t)(torch.as_tensor(a)))
    def _A_setup():
        B, S, D = 1, 2048, 576
        P = D
        Lambda_re = -0.5 * (lambda _x: torch.exp(torch.as_tensor(_x)))((lambda *s: torch.randn(*s, dtype=torch.bfloat16) * 0.2)(P))
        Lambda_im = (lambda *s: torch.randn(*s, dtype=torch.bfloat16) * 0.4)(P) * 1.0
        B_re = (lambda *s: torch.randn(*s, dtype=torch.bfloat16) * 0.2)(P, D) * (D ** -0.5)
        B_im = (lambda *s: torch.randn(*s, dtype=torch.bfloat16) * 0.2)(P, D) * (D ** -0.5)
        C_re = (lambda *s: torch.randn(*s, dtype=torch.bfloat16) * 0.2)(D, P) * (P ** -0.5)
        C_im = (lambda *s: torch.randn(*s, dtype=torch.bfloat16) * 0.2)(D, P) * (P ** -0.5)
        log_dt = (lambda *s: torch.randn(*s, dtype=torch.bfloat16) * 0.2)(P) * 0.3 - 2.0
        Dskip = (lambda *s: torch.randn(*s, dtype=torch.bfloat16) * 0.05)(D)
        return {
            "x": _w((lambda *s: torch.randn(*s, dtype=torch.bfloat16) * 0.05)(B, S, D)),
            "Lambda_re": _w(Lambda_re),
            "Lambda_im": _w(Lambda_im),
            "B_re": _w(B_re),
            "B_im": _w(B_im),
            "C_re": _w(C_re),
            "C_im": _w(C_im),
            "log_dt": _w(log_dt),
            "Dskip": _w(Dskip),
        }
    _A_in = _A_setup()

    def _B_setup():
        B, S, D, F = 1, 2048, 576, 4608
        return {
            "x": _w((lambda *s: torch.randn(*s, dtype=torch.bfloat16) * 0.05)(B, S, D)),
            "w_gate": _w((lambda *s: torch.randn(*s, dtype=torch.bfloat16) * 0.05)(D, F)),
            "w_up": _w((lambda *s: torch.randn(*s, dtype=torch.bfloat16) * 0.05)(D, F)),
            "w_down": _w((lambda *s: torch.randn(*s, dtype=torch.bfloat16) * 0.05)(F, D)),
        }
    _B_in = _B_setup()

    return {
        "A_x": _A_in["x"],
        "A_Lambda_re": _A_in["Lambda_re"],
        "A_Lambda_im": _A_in["Lambda_im"],
        "A_B_re": _A_in["B_re"],
        "A_B_im": _A_in["B_im"],
        "A_C_re": _A_in["C_re"],
        "A_C_im": _A_in["C_im"],
        "A_log_dt": _A_in["log_dt"],
        "A_Dskip": _A_in["Dskip"],
        "B_x": _B_in["x"],
        "B_w_gate": _B_in["w_gate"],
        "B_w_up": _B_in["w_up"],
        "B_w_down": _B_in["w_down"],
        "gate_w": _w((lambda *s: torch.randn(*s, dtype=torch.bfloat16) * 0.05)(576) * 16.0),
    }

def reference(A_x, A_Lambda_re, A_Lambda_im, A_B_re, A_B_im, A_C_re, A_C_im, A_log_dt, A_Dskip, B_x, B_w_gate, B_w_up, B_w_down, gate_w):
    def _A_ref(x, Lambda_re, Lambda_im, B_re, B_im, C_re, C_im, log_dt, Dskip):
        Bsz, L, H = x.shape
        Lam = Lambda_re + 1j * Lambda_im
        Bmat = B_re + 1j * B_im
        Cmat = C_re + 1j * C_im
        dt = torch.exp(log_dt)
        Lam_bar = torch.exp(dt * Lam)
        B_bar = ((Lam_bar - 1.0) / Lam)[:, None] * Bmat
        Bu = torch.einsum("bld,pd->blp", x + 0j, B_bar)
        h = torch.zeros_like(Bu[:, 0, :])
        hs = []
        for t in range(L):
            h = Lam_bar[None, :] * h + Bu[:, t, :]
            hs.append(h)
        hseq = torch.stack(hs, 1)
        y = 2.0 * torch.einsum("blp,dp->bld", hseq, Cmat).real + x * Dskip[None, None, :]
        return y

    def _B_ref(x, w_gate, w_up, w_down):
        g = _silu(x @ w_gate)
        u = x @ w_up
        return (g * u) @ w_down

    x = A_x
    g = _sigmoid((x * gate_w).sum(-1, keepdims=True))
    a = _A_ref(x, A_Lambda_re, A_Lambda_im, A_B_re, A_B_im, A_C_re, A_C_im, A_log_dt, A_Dskip)
    b = _B_ref(x, B_w_gate, B_w_up, B_w_down)
    return g * a + (1 - g) * b
```

```asm
; @launch grid=(256,1,1) block=(256,1,1) lds=163840
.amdgcn_target "amdgcn-amd-amdhsa--gfx950"
.text
.globl gated_mix__ssm_conv_s5__swiglu_ffn__prompt_kernel
.p2align 12
.type gated_mix__ssm_conv_s5__swiglu_ffn__prompt_kernel,@function
gated_mix__ssm_conv_s5__swiglu_ffn__prompt_kernel:
    s_cmp_ge_u32 s2, 256
    s_cbranch_scc1 L_end
    s_load_dwordx16 s[16:31], s[0:1], 0
    s_load_dwordx16 s[32:47], s[0:1], 64
    s_load_dwordx2 s[48:49], s[0:1], 128
    v_lshrrev_b32 v1, 6, v0
    v_and_b32 v0, 63, v0
    s_and_b32 s51, s2, 7
    v_readfirstlane_b32 s50, v1
    s_lshr_b32 s3, s2, 3
    s_getpc_b64 s[100:101]
L_e0pc:
    v_lshl_add_u32 v2, s3, 2, v1
    v_and_b32 v3, 7, v0
    v_lshl_add_u32 v2, v2, 3, v3
    v_lshlrev_b32 v2, 7, v2
    v_min_u32 v2, L_codeend-L_e0pc-4, v2
    v_mov_b32 v3, s101
    v_add_co_u32 v2, vcc, s100, v2
    s_nop 1
    v_addc_co_u32 v3, vcc, 0, v3, vcc
    global_load_dword v255, v[2:3], off
    s_cmp_ge_u32 s3, 30
    s_cbranch_scc1 L_prep
    s_cmp_ge_u32 s3, 24
    s_cbranch_scc1 L_other
    s_mul_i32 s96, s3, 43
    s_lshr_b32 s100, s96, 7
    s_lshr_b32 s96, s96, 8
    s_mul_i32 s54, s100, 3
    s_sub_u32 s95, s3, s54
    s_mul_i32 s54, s96, 6
    s_sub_u32 s54, s3, s54
    s_lshr_b32 s98, s54, 1
    s_add_u32 s98, s98, s54
    s_lshl1_add_u32 s98, s96, s98
    s_and_b32 s55, s51, 3
    s_add_u32 s98, s98, s55
    s_lshr_b32 s53, s51, 2
    s_add_u32 s98, s98, s53
    s_lshl2_add_u32 s96, s53, s96
    s_and_b32 s100, s100, 1
    s_lshl1_add_u32 s100, s55, s100
    s_mul_i32 s55, s55, 6
    s_add_u32 s54, s54, s55
    s_lshl_b32 s94, s96, 2
    s_add_u32 s94, s94, s50
    s_mul_i32 s99, s94, 73728
    s_lshl_b32 s97, s94, 10
    s_add_u32 s97, s97, s54
    s_mul_i32 s94, s94, 737280
    s_lshl_b32 s55, s54, 11
    s_add_u32 s94, s94, s55
    s_and_b32 s55, s100, 6
    s_lshl2_add_u32 s55, s55, s100
    s_add_u32 s55, s55, s54
    s_lshl_b32 s55, s55, 7
    s_mul_i32 s52, s50, 40960
    s_mul_i32 s53, s98, 57
    s_lshr_b32 s53, s53, 9
    s_mul_i32 s53, s53, 9
    s_sub_u32 s98, s98, s53
    s_mul_i32 s53, s98, 128
    s_add_u32 s76, s99, s53
    s_mul_i32 s53, s98, 589824
    s_add_u32 s85, s55, s53
    v_lshrrev_b32 v10, 3, v0
    v_mul_u32_u24 v11, 1152, v10
    v_and_b32 v12, 7, v0
    v_lshrrev_b32 v13, 4, v0
    v_xor_b32 v12, v12, v13
    v_lshl_add_u32 v2, v12, 4, v11
    v_xor_b32 v12, 4, v12
    v_lshl_add_u32 v13, v12, 4, v11
    v_add_u32 v3, 8192, v13
    v_add_u32 v4, 16384, v2
    v_add_u32 v5, 24576, v13
    v_lshrrev_b32 v10, 3, v0
    s_lshl_b32 s53, s50, 4
    v_add_u32 v10, s53, v10
    v_mul_u32_u24 v10, 9216, v10
    v_bfe_u32 v11, v0, 4, 1
    v_lshlrev_b32 v11, 2, v11
    v_and_b32 v22, 7, v0
    v_xor_b32 v11, v11, v22
    v_lshl_add_u32 v10, v11, 4, v10
    v_add_u32 v12, 4096, v10
    v_xor_b32 v11, 32, v10
    v_add_u32 v13, 76800, v11
    v_add_u32 v14, 2048, v10
    v_add_u32 v15, 74752, v11
    s_waitcnt lgkmcnt(0)
    s_mov_b32 s56, s16
    s_mov_b32 s57, s17
    s_mov_b32 s58, 2359296
    s_mov_b32 s59, 0x20000
    s_sub_u32 s60, s36, 4096
    s_subb_u32 s61, s37, 0
    s_mov_b32 s62, 5312512
    s_mov_b32 s63, 0x20000
    s_sub_u32 s64, s38, 4096
    s_subb_u32 s65, s39, 0
    s_mov_b32 s66, 5312512
    s_mov_b32 s67, 0x20000
    s_mov_b32 s26, s95
    s_mov_b32 s29, s100
    s_add_u32 m0, s52, 0
    s_add_u32 s53, s76, 0
    buffer_load_dwordx4 v2, s[56:59], s53 offen offset:0 lds
    buffer_load_dwordx4 v3, s[56:59], s53 offen offset:1024 lds
    buffer_load_dwordx4 v4, s[56:59], s53 offen offset:2048 lds
    buffer_load_dwordx4 v5, s[56:59], s53 offen offset:3072 lds
    s_add_u32 m0, s52, 4096
    s_add_u32 s53, s76, 36864
    buffer_load_dwordx4 v2, s[56:59], s53 offen offset:0 lds
    buffer_load_dwordx4 v3, s[56:59], s53 offen offset:1024 lds
    buffer_load_dwordx4 v4, s[56:59], s53 offen offset:2048 lds
    buffer_load_dwordx4 v5, s[56:59], s53 offen offset:3072 lds
    s_add_u32 m0, s52, 24576
    s_add_u32 s54, s85, 0
    buffer_load_dwordx4 v12, s[60:63], s54 offen offset:0 lds
    buffer_load_dwordx4 v13, s[60:63], s54 offen offset:1024 lds
    buffer_load_dwordx4 v14, s[64:67], s54 offen offset:2048 lds
    buffer_load_dwordx4 v15, s[64:67], s54 offen offset:3072 lds
    s_add_u32 s98, s98, 1
    s_cmp_eq_u32 s98, 9
    s_cselect_b32 s98, 0, s98
    s_mul_i32 s53, s98, 128
    s_add_u32 s77, s99, s53
    s_mul_i32 s53, s98, 589824
    s_add_u32 s86, s55, s53
    s_add_u32 s98, s98, 1
    s_cmp_eq_u32 s98, 9
    s_cselect_b32 s98, 0, s98
    s_mul_i32 s53, s98, 128
    s_add_u32 s78, s99, s53
    s_mul_i32 s53, s98, 589824
    s_add_u32 s87, s55, s53
    s_add_u32 s98, s98, 1
    s_cmp_eq_u32 s98, 9
    s_cselect_b32 s98, 0, s98
    s_mul_i32 s53, s98, 128
    s_add_u32 s79, s99, s53
    s_mul_i32 s53, s98, 589824
    s_add_u32 s88, s55, s53
    s_add_u32 s98, s98, 1
    s_cmp_eq_u32 s98, 9
    s_cselect_b32 s98, 0, s98
    s_mul_i32 s53, s98, 128
    s_add_u32 s80, s99, s53
    s_mul_i32 s53, s98, 589824
    s_add_u32 s89, s55, s53
    s_add_u32 s98, s98, 1
    s_cmp_eq_u32 s98, 9
    s_cselect_b32 s98, 0, s98
    s_mul_i32 s53, s98, 128
    s_add_u32 s81, s99, s53
    s_mul_i32 s53, s98, 589824
    s_add_u32 s90, s55, s53
    s_add_u32 s98, s98, 1
    s_cmp_eq_u32 s98, 9
    s_cselect_b32 s98, 0, s98
    s_mul_i32 s53, s98, 128
    s_add_u32 s82, s99, s53
    s_mul_i32 s53, s98, 589824
    s_add_u32 s91, s55, s53
    s_add_u32 s98, s98, 1
    s_cmp_eq_u32 s98, 9
    s_cselect_b32 s98, 0, s98
    s_mul_i32 s53, s98, 128
    s_add_u32 s83, s99, s53
    s_mul_i32 s53, s98, 589824
    s_add_u32 s92, s55, s53
    s_add_u32 s98, s98, 1
    s_cmp_eq_u32 s98, 9
    s_cselect_b32 s98, 0, s98
    s_mul_i32 s53, s98, 128
    s_add_u32 s84, s99, s53
    s_mul_i32 s53, s98, 589824
    s_add_u32 s93, s55, s53
    s_mov_b32 s68, s48
    s_mov_b32 s69, s49
    s_mov_b32 s70, 54034432
    s_mov_b32 s71, 0x20000
    s_mov_b32 s95, 0xbfb8aa3b
    v_and_b32 v10, 15, v0
    v_bfe_u32 v11, v0, 1, 3
    v_lshrrev_b32 v1, 4, v0
    v_xor_b32 v11, v11, v1
    v_lshl_add_u32 v6, v10, 7, s52
    v_lshl_add_u32 v6, v11, 4, v6
    v_xor_b32 v7, 64, v6
    v_lshrrev_b32 v10, 5, v0
    v_mul_u32_u24 v10, 40960, v10
    v_bfe_u32 v11, v0, 2, 2
    v_lshl_add_u32 v10, v11, 7, v10
    v_bfe_u32 v11, v0, 4, 1
    v_mul_u32_u24 v11, 1056, v11
    v_add_u32 v10, v10, v11
    v_and_b32 v11, 3, v0
    v_lshl_add_u32 v10, v11, 3, v10
    v_bfe_u32 v11, v0, 3, 1
    v_lshl_add_u32 v40, v11, 6, v10
    v_add_u32 v41, 81920, v40
    v_xor_b32 v42, 32, v40
    v_add_u32 v43, 81920, v42
    v_xor_b32 v44, 64, v40
    v_add_u32 v45, 81920, v44
    v_xor_b32 v46, 96, v40
    v_add_u32 v47, 81920, v46
    v_lshlrev_b32 v22, 4, v0
    s_cmp_lg_u32 s50, 0
    s_cbranch_scc1 L_wskip_g10
    s_call_b64 s[100:101], L_stub0
L_wskip_g10:
    s_cmp_lg_u32 s50, 1
    s_cbranch_scc1 L_wskip_g11
    s_call_b64 s[100:101], L_stub1
L_wskip_g11:
    s_cmp_lg_u32 s50, 2
    s_cbranch_scc1 L_wskip_g12
    s_call_b64 s[100:101], L_stub2
L_wskip_g12:
    s_cmp_lg_u32 s50, 3
    s_cbranch_scc1 L_wskip_g13
    s_call_b64 s[100:101], L_stub3
L_wskip_g13:
    s_add_u32 m0, s52, 8192
    s_add_u32 s53, s77, 0
    buffer_load_dwordx4 v2, s[56:59], s53 offen offset:0 lds
    buffer_load_dwordx4 v3, s[56:59], s53 offen offset:1024 lds
    buffer_load_dwordx4 v4, s[56:59], s53 offen offset:2048 lds
    buffer_load_dwordx4 v5, s[56:59], s53 offen offset:3072 lds
    s_add_u32 m0, s52, 12288
    s_add_u32 s53, s77, 36864
    buffer_load_dwordx4 v2, s[56:59], s53 offen offset:0 lds
    buffer_load_dwordx4 v3, s[56:59], s53 offen offset:1024 lds
    buffer_load_dwordx4 v4, s[56:59], s53 offen offset:2048 lds
    buffer_load_dwordx4 v5, s[56:59], s53 offen offset:3072 lds
    s_add_u32 m0, s52, 28672
    s_add_u32 s54, s86, 0
    buffer_load_dwordx4 v12, s[60:63], s54 offen offset:0 lds
    buffer_load_dwordx4 v13, s[60:63], s54 offen offset:1024 lds
    buffer_load_dwordx4 v14, s[64:67], s54 offen offset:2048 lds
    buffer_load_dwordx4 v15, s[64:67], s54 offen offset:3072 lds
    s_waitcnt vmcnt(16)
    ds_read_b128 a[0:3], v6 offset:0
    ds_read_b128 a[4:7], v6 offset:2048
    ds_read_b128 a[8:11], v6 offset:4096
    ds_read_b128 a[12:15], v6 offset:6144
    ds_read_b128 a[16:19], v7 offset:0
    ds_read_b128 a[20:23], v7 offset:2048
    ds_read_b128 a[24:27], v7 offset:4096
    ds_read_b128 a[28:31], v7 offset:6144
    s_waitcnt vmcnt(12)
    s_barrier
    ds_read_b64_tr_b16 v[64:65], v40 offset:24576
    ds_read_b64_tr_b16 v[66:67], v40 offset:25088
    ds_read_b64_tr_b16 v[68:69], v42 offset:24576
    ds_read_b64_tr_b16 v[70:71], v42 offset:25088
    ds_read_b64_tr_b16 v[72:73], v40 offset:26624
    ds_read_b64_tr_b16 v[74:75], v40 offset:27136
    ds_read_b64_tr_b16 v[76:77], v42 offset:26624
    ds_read_b64_tr_b16 v[78:79], v42 offset:27136
    ds_read_b64_tr_b16 v[80:81], v44 offset:24576
    ds_read_b64_tr_b16 v[82:83], v44 offset:25088
    ds_read_b64_tr_b16 v[84:85], v46 offset:24576
    ds_read_b64_tr_b16 v[86:87], v46 offset:25088
    s_waitcnt lgkmcnt(4)
    s_add_u32 m0, s52, 16384
    s_add_u32 s53, s78, 0
    buffer_load_dwordx4 v2, s[56:59], s53 offen offset:0 lds
    buffer_load_dwordx4 v3, s[56:59], s53 offen offset:1024 lds
    buffer_load_dwordx4 v4, s[56:59], s53 offen offset:2048 lds
    buffer_load_dwordx4 v5, s[56:59], s53 offen offset:3072 lds
    v_mfma_f32_16x16x32_bf16 v[128:131], v[64:67], a[0:3], 0
    s_mov_b32 s72, s40
    s_mov_b32 s73, s41
    s_mov_b32 s74, 5308416
    s_mov_b32 s75, 0x20000
    v_mfma_f32_16x16x32_bf16 v[136:139], v[64:67], a[4:7], 0
    s_lshl_b32 s27, s29, 1
    s_add_u32 s27, s27, s26
    v_mfma_f32_16x16x32_bf16 v[144:147], v[64:67], a[8:11], 0
    s_lshl_b32 s27, s27, 2
    ds_read_b64_tr_b16 v[88:89], v44 offset:26624
    v_mfma_f32_16x16x32_bf16 v[152:155], v[64:67], a[12:15], 0
    s_add_u32 s27, s27, 3
    ds_read_b64_tr_b16 v[90:91], v44 offset:27136
    v_mfma_f32_16x16x32_bf16 v[132:135], v[68:71], a[0:3], 0
    s_add_u32 s28, s29, 64
    ds_read_b64_tr_b16 v[92:93], v46 offset:26624
    v_mfma_f32_16x16x32_bf16 v[140:143], v[68:71], a[4:7], 0
    s_cmp_eq_u32 s26, 2
    s_cselect_b32 s27, s28, s27
    v_mfma_f32_16x16x32_bf16 v[148:151], v[68:71], a[8:11], 0
    s_and_b32 s28, s29, 6
    s_lshl_b32 s28, s28, 2
    v_mfma_f32_16x16x32_bf16 v[156:159], v[68:71], a[12:15], 0
    s_lshl2_add_u32 s28, s29, s28
    ds_read_b64_tr_b16 v[94:95], v46 offset:27136
    s_add_u32 m0, s52, 20480
    s_add_u32 s53, s78, 36864
    buffer_load_dwordx4 v2, s[56:59], s53 offen offset:0 lds
    buffer_load_dwordx4 v3, s[56:59], s53 offen offset:1024 lds
    buffer_load_dwordx4 v4, s[56:59], s53 offen offset:2048 lds
    buffer_load_dwordx4 v5, s[56:59], s53 offen offset:3072 lds
    v_mfma_f32_16x16x32_bf16 v[160:163], v[72:75], a[0:3], 0
    s_add_u32 s28, s28, s26
    s_sub_u32 s33, s27, s28
    v_mfma_f32_16x16x32_bf16 v[168:171], v[72:75], a[4:7], 0
    s_lshl_b32 s33, s33, 7
    s_lshl_b32 s27, s27, 7
    v_mfma_f32_16x16x32_bf16 v[176:179], v[72:75], a[8:11], 0
    s_lshl2_add_u32 s96, s96, s50
    ds_read_b64_tr_b16 v[64:65], v41 offset:24576
    v_mfma_f32_16x16x32_bf16 v[184:187], v[72:75], a[12:15], 0
    s_mul_i32 s96, s96, 165888
    ds_read_b64_tr_b16 v[66:67], v41 offset:25088
    v_mfma_f32_16x16x32_bf16 v[164:167], v[76:79], a[0:3], 0
    s_add_u32 s96, s96, s27
    s_lshl2_add_u32 s26, s3, s50
    v_mfma_f32_16x16x32_bf16 v[172:175], v[76:79], a[4:7], 0
    s_lshr_b32 s27, s26, 5
    s_and_b32 s26, s26, 31
    v_mfma_f32_16x16x32_bf16 v[180:183], v[76:79], a[8:11], 0
    s_and_b32 s28, s51, 3
    ds_read_b64_tr_b16 v[68:69], v43 offset:24576
    v_mfma_f32_16x16x32_bf16 v[188:191], v[76:79], a[12:15], 0
    ds_read_b64_tr_b16 v[70:71], v43 offset:25088
    s_waitcnt lgkmcnt(4)
    s_add_u32 m0, s52, 32768
    s_add_u32 s54, s87, 0
    buffer_load_dwordx4 v12, s[60:63], s54 offen offset:0 lds
    buffer_load_dwordx4 v13, s[60:63], s54 offen offset:1024 lds
    buffer_load_dwordx4 v14, s[64:67], s54 offen offset:2048 lds
    buffer_load_dwordx4 v15, s[64:67], s54 offen offset:3072 lds
    v_mfma_f32_16x16x32_bf16 v[192:195], v[80:83], a[0:3], 0
    s_lshl_b32 s29, s28, 10
    s_add_u32 s29, s29, s26
    v_mfma_f32_16x16x32_bf16 v[200:203], v[80:83], a[4:7], 0
    s_lshl_b32 s42, s27, 6
    s_add_u32 s42, s42, s29
    v_mfma_f32_16x16x32_bf16 v[208:211], v[80:83], a[8:11], 0
    s_mul_i32 s42, s42, 1152
    ds_read_b64_tr_b16 v[72:73], v41 offset:26624
    v_mfma_f32_16x16x32_bf16 v[216:219], v[80:83], a[12:15], 0
    s_lshl_b32 s43, s27, 8
    ds_read_b64_tr_b16 v[74:75], v41 offset:27136
    v_mfma_f32_16x16x32_bf16 v[196:199], v[84:87], a[0:3], 0
    s_add_u32 s43, s43, s29
    s_add_u32 s43, s43, 192
    v_mfma_f32_16x16x32_bf16 v[204:207], v[84:87], a[4:7], 0
    s_lshl_b32 s28, s28, 7
    s_add_u32 s28, s28, s26
    v_mfma_f32_16x16x32_bf16 v[212:215], v[84:87], a[8:11], 0
    s_add_u32 s28, s28, 4096
    ds_read_b64_tr_b16 v[76:77], v43 offset:26624
    v_mfma_f32_16x16x32_bf16 v[220:223], v[84:87], a[12:15], 0
    ds_read_b64_tr_b16 v[78:79], v43 offset:27136
    v_mfma_f32_16x16x32_bf16 v[224:227], v[88:91], a[0:3], 0
    s_cmp_eq_u32 s27, 2
    s_cselect_b32 s43, s28, s43
    v_mfma_f32_16x16x32_bf16 v[232:235], v[88:91], a[4:7], 0
    s_mul_i32 s43, s43, 1152
    ds_read_b64_tr_b16 v[80:81], v45 offset:24576
    v_mfma_f32_16x16x32_bf16 v[240:243], v[88:91], a[8:11], 0
    s_cmp_eq_u32 s27, 2
    s_cselect_b32 s32, 64, 512
    v_mfma_f32_16x16x32_bf16 v[248:251], v[88:91], a[12:15], 0
    s_mul_i32 s32, s32, 1152
    ds_read_b64_tr_b16 v[82:83], v45 offset:25088
    v_mfma_f32_16x16x32_bf16 v[228:231], v[92:95], a[0:3], 0
    s_add_u32 s32, s32, s43
    s_lshr_b32 s26, s51, 2
    v_mfma_f32_16x16x32_bf16 v[236:239], v[92:95], a[4:7], 0
    s_mul_i32 s27, s26, 294912
    s_sub_u32 s28, s42, s27
    v_mfma_f32_16x16x32_bf16 v[244:247], v[92:95], a[8:11], 0
    s_add_u32 s28, s28, 294912
    ds_read_b64_tr_b16 v[84:85], v47 offset:24576
    v_mfma_f32_16x16x32_bf16 v[252:255], v[92:95], a[12:15], 0
    ds_read_b64_tr_b16 v[86:87], v47 offset:25088
    s_waitcnt lgkmcnt(4)
    v_mfma_f32_16x16x32_bf16 v[128:131], v[64:67], a[16:19], v[128:131]
    s_cmp_lg_u32 s50, 0
    s_cbranch_scc1 L_wskip_g1b0
    s_call_b64 s[100:101], L_stub8
L_wskip_g1b0:
    s_cmp_lg_u32 s50, 1
    s_cbranch_scc1 L_wskip_g1b1
    s_call_b64 s[100:101], L_stub9
L_wskip_g1b1:
    s_cmp_lg_u32 s50, 2
    s_cbranch_scc1 L_wskip_g1b2
    s_call_b64 s[100:101], L_stub10
L_wskip_g1b2:
    s_cmp_lg_u32 s50, 3
    s_cbranch_scc1 L_wskip_g1b3
    s_call_b64 s[100:101], L_stub11
L_wskip_g1b3:
    s_waitcnt vmcnt(16)
    s_add_u32 s42, s42, s27
    v_mfma_f32_16x16x32_bf16 v[136:139], v[64:67], a[20:23], v[136:139]
    s_sub_u32 s27, s32, s43
    ds_read_b64_tr_b16 v[88:89], v45 offset:26624
    v_mfma_f32_16x16x32_bf16 v[144:147], v[64:67], a[24:27], v[144:147]
    s_mul_i32 s27, s27, s26
    ds_read_b64_tr_b16 v[90:91], v45 offset:27136
    v_mfma_f32_16x16x32_bf16 v[152:155], v[64:67], a[28:31], v[152:155]
    s_sub_u32 s32, s32, s27
    ds_read_b128 a[32:35], v6 offset:8192
    v_mfma_f32_16x16x32_bf16 v[132:135], v[68:71], a[16:19], v[132:135]
    s_add_u32 s43, s43, s27
    s_and_b32 s26, s51, 3
    v_mfma_f32_16x16x32_bf16 v[140:143], v[68:71], a[20:23], v[140:143]
    s_mul_i32 s26, s26, 26
    ds_read_b64_tr_b16 v[92:93], v47 offset:26624
    v_mfma_f32_16x16x32_bf16 v[148:151], v[68:71], a[24:27], v[148:151]
    s_add_u32 s97, s97, s26
    ds_read_b64_tr_b16 v[94:95], v47 offset:27136
    v_mfma_f32_16x16x32_bf16 v[156:159], v[68:71], a[28:31], v[156:159]
    s_lshl_b32 s97, s97, 2
    ds_read_b128 a[36:39], v6 offset:10240
    v_mfma_f32_16x16x32_bf16 v[160:163], v[72:75], a[16:19], v[160:163]
    s_waitcnt vmcnt(12)
    s_barrier
    v_mfma_f32_16x16x32_bf16 v[168:171], v[72:75], a[20:23], v[168:171]
    s_add_u32 s97, s97, 53837824
    ds_read_b64_tr_b16 v[64:65], v40 offset:28672
    v_mfma_f32_16x16x32_bf16 v[176:179], v[72:75], a[24:27], v[176:179]
    ds_read_b64_tr_b16 v[66:67], v40 offset:29184
    v_mov_b32 v25, 1
    v_mfma_f32_16x16x32_bf16 v[184:187], v[72:75], a[28:31], v[184:187]
    ds_read_b128 a[40:43], v6 offset:12288
    v_min_u32 v24, 1, v0
    v_mfma_f32_16x16x32_bf16 v[164:167], v[76:79], a[16:19], v[164:167]
    v_lshl_add_u32 v24, v24, 30, s97
    v_min_u32 v1, 8, v0
    v_mfma_f32_16x16x32_bf16 v[172:175], v[76:79], a[20:23], v[172:175]
    ds_read_b64_tr_b16 v[68:69], v42 offset:28672
    v_lshlrev_b32 v10, 7, v1
    v_mfma_f32_16x16x32_bf16 v[180:183], v[76:79], a[24:27], v[180:183]
    ds_read_b64_tr_b16 v[70:71], v42 offset:29184
    v_mul_u32_u24 v1, 9216, v1
    v_mfma_f32_16x16x32_bf16 v[188:191], v[76:79], a[28:31], v[188:191]
    ds_read_b128 a[44:47], v6 offset:14336
    s_waitcnt lgkmcnt(7)
    v_mfma_f32_16x16x32_bf16 v[192:195], v[80:83], a[16:19], v[192:195]
    s_lshl2_add_u32 s26, s3, s50
    s_mul_i32 s26, s26, 1408
    v_mfma_f32_16x16x32_bf16 v[200:203], v[80:83], a[20:23], v[200:203]
    ds_read_b64_tr_b16 v[72:73], v40 offset:30720
    v_min_u32 v20, 10, v0
    v_mfma_f32_16x16x32_bf16 v[208:211], v[80:83], a[24:27], v[208:211]
    ds_read_b64_tr_b16 v[74:75], v40 offset:31232
    v_lshl_add_u32 v20, v20, 7, s26
    v_mfma_f32_16x16x32_bf16 v[216:219], v[80:83], a[28:31], v[216:219]
    ds_read_b128 a[48:51], v7 offset:8192
    v_min_u32 v20, L_codeend-gated_mix__ssm_conv_s5__swiglu_ffn__prompt_kernel-4, v20
    v_mfma_f32_16x16x32_bf16 v[196:199], v[84:87], a[16:19], v[196:199]
    s_getpc_b64 s[100:101]
L_g1pc:
    s_sub_u32 s100, s100, L_g1pc-gated_mix__ssm_conv_s5__swiglu_ffn__prompt_kernel
    s_subb_u32 s101, s101, 0
    v_mov_b32 v21, s101
    v_add_co_u32 v20, vcc, s100, v20
    s_nop 1
    v_addc_co_u32 v21, vcc, 0, v21, vcc
    v_mfma_f32_16x16x32_bf16 v[204:207], v[84:87], a[20:23], v[204:207]
    ds_read_b64_tr_b16 v[76:77], v42 offset:30720
    v_mfma_f32_16x16x32_bf16 v[212:215], v[84:87], a[24:27], v[212:215]
    ds_read_b64_tr_b16 v[78:79], v42 offset:31232
    v_mfma_f32_16x16x32_bf16 v[220:223], v[84:87], a[28:31], v[220:223]
    ds_read_b128 a[52:55], v7 offset:10240
    v_mfma_f32_16x16x32_bf16 v[224:227], v[88:91], a[16:19], v[224:227]
    ds_read_b64_tr_b16 v[80:81], v44 offset:28672
    v_mfma_f32_16x16x32_bf16 v[232:235], v[88:91], a[20:23], v[232:235]
    ds_read_b64_tr_b16 v[82:83], v44 offset:29184
    v_mfma_f32_16x16x32_bf16 v[240:243], v[88:91], a[24:27], v[240:243]
    ds_read_b128 a[56:59], v7 offset:12288
    v_mfma_f32_16x16x32_bf16 v[248:251], v[88:91], a[28:31], v[248:251]
    v_mfma_f32_16x16x32_bf16 v[228:231], v[92:95], a[16:19], v[228:231]
    ds_read_b64_tr_b16 v[84:85], v46 offset:28672
    v_mfma_f32_16x16x32_bf16 v[236:239], v[92:95], a[20:23], v[236:239]
    ds_read_b64_tr_b16 v[86:87], v46 offset:29184
    v_mfma_f32_16x16x32_bf16 v[244:247], v[92:95], a[24:27], v[244:247]
    ds_read_b128 a[60:63], v7 offset:14336
    v_mfma_f32_16x16x32_bf16 v[252:255], v[92:95], a[28:31], v[252:255]
    s_waitcnt lgkmcnt(7)
    s_add_u32 m0, s52, 0
    s_add_u32 s53, s79, 0
    buffer_load_dwordx4 v2, s[56:59], s53 offen offset:0 lds
    buffer_load_dwordx4 v3, s[56:59], s53 offen offset:1024 lds
    buffer_load_dwordx4 v4, s[56:59], s53 offen offset:2048 lds
    buffer_load_dwordx4 v5, s[56:59], s53 offen offset:3072 lds
    v_mfma_f32_16x16x32_bf16 v[128:131], v[64:67], a[32:35], v[128:131]
    ds_read_b64_tr_b16 v[88:89], v44 offset:30720
    v_mfma_f32_16x16x32_bf16 v[136:139], v[64:67], a[36:39], v[136:139]
    ds_read_b64_tr_b16 v[90:91], v44 offset:31232
    v_mfma_f32_16x16x32_bf16 v[144:147], v[64:67], a[40:43], v[144:147]
    v_mfma_f32_16x16x32_bf16 v[152:155], v[64:67], a[44:47], v[152:155]
    v_mfma_f32_16x16x32_bf16 v[132:135], v[68:71], a[32:35], v[132:135]
    ds_read_b64_tr_b16 v[92:93], v46 offset:30720
    v_mfma_f32_16x16x32_bf16 v[140:143], v[68:71], a[36:39], v[140:143]
    ds_read_b64_tr_b16 v[94:95], v46 offset:31232
    v_mfma_f32_16x16x32_bf16 v[148:151], v[68:71], a[40:43], v[148:151]
    v_mfma_f32_16x16x32_bf16 v[156:159], v[68:71], a[44:47], v[156:159]
    s_add_u32 m0, s52, 4096
    s_add_u32 s53, s79, 36864
    buffer_load_dwordx4 v2, s[56:59], s53 offen offset:0 lds
    buffer_load_dwordx4 v3, s[56:59], s53 offen offset:1024 lds
    buffer_load_dwordx4 v4, s[56:59], s53 offen offset:2048 lds
    buffer_load_dwordx4 v5, s[56:59], s53 offen offset:3072 lds
    v_mfma_f32_16x16x32_bf16 v[160:163], v[72:75], a[32:35], v[160:163]
    ds_read_b64_tr_b16 v[64:65], v41 offset:28672
    v_mfma_f32_16x16x32_bf16 v[168:171], v[72:75], a[36:39], v[168:171]
    ds_read_b64_tr_b16 v[66:67], v41 offset:29184
    v_mfma_f32_16x16x32_bf16 v[176:179], v[72:75], a[40:43], v[176:179]
    v_mfma_f32_16x16x32_bf16 v[184:187], v[72:75], a[44:47], v[184:187]
    v_mfma_f32_16x16x32_bf16 v[164:167], v[76:79], a[32:35], v[164:167]
    ds_read_b64_tr_b16 v[68:69], v43 offset:28672
    v_mfma_f32_16x16x32_bf16 v[172:175], v[76:79], a[36:39], v[172:175]
    ds_read_b64_tr_b16 v[70:71], v43 offset:29184
    v_mfma_f32_16x16x32_bf16 v[180:183], v[76:79], a[40:43], v[180:183]
    v_mfma_f32_16x16x32_bf16 v[188:191], v[76:79], a[44:47], v[188:191]
    s_waitcnt lgkmcnt(4)
    s_add_u32 m0, s52, 36864
    s_add_u32 s54, s88, 0
    buffer_load_dwordx4 v12, s[60:63], s54 offen offset:0 lds
    buffer_load_dwordx4 v13, s[60:63], s54 offen offset:1024 lds
    buffer_load_dwordx4 v14, s[64:67], s54 offen offset:2048 lds
    buffer_load_dwordx4 v15, s[64:67], s54 offen offset:3072 lds
    v_mfma_f32_16x16x32_bf16 v[192:195], v[80:83], a[32:35], v[192:195]
    ds_read_b64_tr_b16 v[72:73], v41 offset:30720
    v_mfma_f32_16x16x32_bf16 v[200:203], v[80:83], a[36:39], v[200:203]
    ds_read_b64_tr_b16 v[74:75], v41 offset:31232
    v_mfma_f32_16x16x32_bf16 v[208:211], v[80:83], a[40:43], v[208:211]
    v_mfma_f32_16x16x32_bf16 v[216:219], v[80:83], a[44:47], v[216:219]
    v_mfma_f32_16x16x32_bf16 v[196:199], v[84:87], a[32:35], v[196:199]
    ds_read_b64_tr_b16 v[76:77], v43 offset:30720
    v_mfma_f32_16x16x32_bf16 v[204:207], v[84:87], a[36:39], v[204:207]
    ds_read_b64_tr_b16 v[78:79], v43 offset:31232
    v_mfma_f32_16x16x32_bf16 v[212:215], v[84:87], a[40:43], v[212:215]
    v_mfma_f32_16x16x32_bf16 v[220:223], v[84:87], a[44:47], v[220:223]
    v_mfma_f32_16x16x32_bf16 v[224:227], v[88:91], a[32:35], v[224:227]
    ds_read_b64_tr_b16 v[80:81], v45 offset:28672
    v_mfma_f32_16x16x32_bf16 v[232:235], v[88:91], a[36:39], v[232:235]
    ds_read_b64_tr_b16 v[82:83], v45 offset:29184
    v_mfma_f32_16x16x32_bf16 v[240:243], v[88:91], a[40:43], v[240:243]
    v_mfma_f32_16x16x32_bf16 v[248:251], v[88:91], a[44:47], v[248:251]
    v_mfma_f32_16x16x32_bf16 v[228:231], v[92:95], a[32:35], v[228:231]
    ds_read_b64_tr_b16 v[84:85], v47 offset:28672
    v_mfma_f32_16x16x32_bf16 v[236:239], v[92:95], a[36:39], v[236:239]
    ds_read_b64_tr_b16 v[86:87], v47 offset:29184
    v_mfma_f32_16x16x32_bf16 v[244:247], v[92:95], a[40:43], v[244:247]
    v_mfma_f32_16x16x32_bf16 v[252:255], v[92:95], a[44:47], v[252:255]
    s_waitcnt lgkmcnt(4)
    v_mfma_f32_16x16x32_bf16 v[128:131], v[64:67], a[48:51], v[128:131]
    s_waitcnt vmcnt(16)
    ds_read_b64_tr_b16 v[88:89], v45 offset:30720
    v_mfma_f32_16x16x32_bf16 v[136:139], v[64:67], a[52:55], v[136:139]
    ds_read_b64_tr_b16 v[90:91], v45 offset:31232
    v_mfma_f32_16x16x32_bf16 v[144:147], v[64:67], a[56:59], v[144:147]
    ds_read_b128 a[64:67], v6 offset:16384
    v_mfma_f32_16x16x32_bf16 v[152:155], v[64:67], a[60:63], v[152:155]
    v_mfma_f32_16x16x32_bf16 v[132:135], v[68:71], a[48:51], v[132:135]
    ds_read_b64_tr_b16 v[92:93], v47 offset:30720
    v_mfma_f32_16x16x32_bf16 v[140:143], v[68:71], a[52:55], v[140:143]
    ds_read_b64_tr_b16 v[94:95], v47 offset:31232
    v_mfma_f32_16x16x32_bf16 v[148:151], v[68:71], a[56:59], v[148:151]
    ds_read_b128 a[68:71], v6 offset:18432
    v_mfma_f32_16x16x32_bf16 v[156:159], v[68:71], a[60:63], v[156:159]
    v_mfma_f32_16x16x32_bf16 v[160:163], v[72:75], a[48:51], v[160:163]
    s_waitcnt vmcnt(12)
    s_barrier
    v_mfma_f32_16x16x32_bf16 v[168:171], v[72:75], a[52:55], v[168:171]
    ds_read_b64_tr_b16 v[64:65], v40 offset:32768
    v_mfma_f32_16x16x32_bf16 v[176:179], v[72:75], a[56:59], v[176:179]
    ds_read_b64_tr_b16 v[66:67], v40 offset:33280
    v_mfma_f32_16x16x32_bf16 v[184:187], v[72:75], a[60:63], v[184:187]
    ds_read_b128 a[72:75], v6 offset:20480
    v_mfma_f32_16x16x32_bf16 v[164:167], v[76:79], a[48:51], v[164:167]
    ds_read_b64_tr_b16 v[68:69], v42 offset:32768
    v_mfma_f32_16x16x32_bf16 v[172:175], v[76:79], a[52:55], v[172:175]
    ds_read_b64_tr_b16 v[70:71], v42 offset:33280
    v_mfma_f32_16x16x32_bf16 v[180:183], v[76:79], a[56:59], v[180:183]
    ds_read_b128 a[76:79], v6 offset:22528
    v_mfma_f32_16x16x32_bf16 v[188:191], v[76:79], a[60:63], v[188:191]
    s_waitcnt lgkmcnt(7)
    v_mfma_f32_16x16x32_bf16 v[192:195], v[80:83], a[48:51], v[192:195]
    ds_read_b64_tr_b16 v[72:73], v40 offset:34816
    v_mfma_f32_16x16x32_bf16 v[200:203], v[80:83], a[52:55], v[200:203]
    ds_read_b64_tr_b16 v[74:75], v40 offset:35328
    v_mfma_f32_16x16x32_bf16 v[208:211], v[80:83], a[56:59], v[208:211]
    ds_read_b128 a[80:83], v7 offset:16384
    v_mfma_f32_16x16x32_bf16 v[216:219], v[80:83], a[60:63], v[216:219]
    v_mfma_f32_16x16x32_bf16 v[196:199], v[84:87], a[48:51], v[196:199]
    ds_read_b64_tr_b16 v[76:77], v42 offset:34816
    v_mfma_f32_16x16x32_bf16 v[204:207], v[84:87], a[52:55], v[204:207]
    ds_read_b64_tr_b16 v[78:79], v42 offset:35328
    v_mfma_f32_16x16x32_bf16 v[212:215], v[84:87], a[56:59], v[212:215]
    ds_read_b128 a[84:87], v7 offset:18432
    v_mfma_f32_16x16x32_bf16 v[220:223], v[84:87], a[60:63], v[220:223]
    v_mfma_f32_16x16x32_bf16 v[224:227], v[88:91], a[48:51], v[224:227]
    ds_read_b64_tr_b16 v[80:81], v44 offset:32768
    v_mfma_f32_16x16x32_bf16 v[232:235], v[88:91], a[52:55], v[232:235]
    ds_read_b64_tr_b16 v[82:83], v44 offset:33280
    v_mfma_f32_16x16x32_bf16 v[240:243], v[88:91], a[56:59], v[240:243]
    ds_read_b128 a[88:91], v7 offset:20480
    v_mfma_f32_16x16x32_bf16 v[248:251], v[88:91], a[60:63], v[248:251]
    v_mfma_f32_16x16x32_bf16 v[228:231], v[92:95], a[48:51], v[228:231]
    ds_read_b64_tr_b16 v[84:85], v46 offset:32768
    v_mfma_f32_16x16x32_bf16 v[236:239], v[92:95], a[52:55], v[236:239]
    ds_read_b64_tr_b16 v[86:87], v46 offset:33280
    v_mfma_f32_16x16x32_bf16 v[244:247], v[92:95], a[56:59], v[244:247]
    ds_read_b128 a[92:95], v7 offset:22528
    v_mfma_f32_16x16x32_bf16 v[252:255], v[92:95], a[60:63], v[252:255]
    s_waitcnt lgkmcnt(7)
    s_add_u32 m0, s52, 8192
    s_add_u32 s53, s80, 0
    buffer_load_dwordx4 v2, s[56:59], s53 offen offset:0 lds
    buffer_load_dwordx4 v3, s[56:59], s53 offen offset:1024 lds
    buffer_load_dwordx4 v4, s[56:59], s53 offen offset:2048 lds
    buffer_load_dwordx4 v5, s[56:59], s53 offen offset:3072 lds
    v_mfma_f32_16x16x32_bf16 v[128:131], v[64:67], a[64:67], v[128:131]
    s_add_u32 s55, s42, 0
    ds_read_b64_tr_b16 v[88:89], v44 offset:34816
    v_mfma_f32_16x16x32_bf16 v[136:139], v[64:67], a[68:71], v[136:139]
    buffer_load_dword v26, v10, s[72:75], s55 offen
    v_mfma_f32_16x16x32_bf16 v[144:147], v[64:67], a[72:75], v[144:147]
    ds_read_b64_tr_b16 v[90:91], v44 offset:35328
    v_mfma_f32_16x16x32_bf16 v[152:155], v[64:67], a[76:79], v[152:155]
    v_mfma_f32_16x16x32_bf16 v[132:135], v[68:71], a[64:67], v[132:135]
    ds_read_b64_tr_b16 v[92:93], v46 offset:34816
    v_mfma_f32_16x16x32_bf16 v[140:143], v[68:71], a[68:71], v[140:143]
    ds_read_b64_tr_b16 v[94:95], v46 offset:35328
    v_mfma_f32_16x16x32_bf16 v[148:151], v[68:71], a[72:75], v[148:151]
    v_mfma_f32_16x16x32_bf16 v[156:159], v[68:71], a[76:79], v[156:159]
    s_branch L_sskip0
L_stub0:
    s_branch L_stub4
L_sskip0:
    s_add_u32 m0, s52, 12288
    s_add_u32 s53, s80, 36864
    buffer_load_dwordx4 v2, s[56:59], s53 offen offset:0 lds
    buffer_load_dwordx4 v3, s[56:59], s53 offen offset:1024 lds
    buffer_load_dwordx4 v4, s[56:59], s53 offen offset:2048 lds
    buffer_load_dwordx4 v5, s[56:59], s53 offen offset:3072 lds
    v_mfma_f32_16x16x32_bf16 v[160:163], v[72:75], a[64:67], v[160:163]
    ds_read_b64_tr_b16 v[64:65], v41 offset:32768
    v_mfma_f32_16x16x32_bf16 v[168:171], v[72:75], a[68:71], v[168:171]
    ds_read_b64_tr_b16 v[66:67], v41 offset:33280
    v_mfma_f32_16x16x32_bf16 v[176:179], v[72:75], a[72:75], v[176:179]
    v_mfma_f32_16x16x32_bf16 v[184:187], v[72:75], a[76:79], v[184:187]
    v_mfma_f32_16x16x32_bf16 v[164:167], v[76:79], a[64:67], v[164:167]
    ds_read_b64_tr_b16 v[68:69], v43 offset:32768
    v_mfma_f32_16x16x32_bf16 v[172:175], v[76:79], a[68:71], v[172:175]
    ds_read_b64_tr_b16 v[70:71], v43 offset:33280
    v_mfma_f32_16x16x32_bf16 v[180:183], v[76:79], a[72:75], v[180:183]
    v_mfma_f32_16x16x32_bf16 v[188:191], v[76:79], a[76:79], v[188:191]
    s_waitcnt lgkmcnt(4)
    s_add_u32 m0, s52, 24576
    s_add_u32 s54, s89, 0
    buffer_load_dwordx4 v12, s[60:63], s54 offen offset:0 lds
    buffer_load_dwordx4 v13, s[60:63], s54 offen offset:1024 lds
    buffer_load_dwordx4 v14, s[64:67], s54 offen offset:2048 lds
    buffer_load_dwordx4 v15, s[64:67], s54 offen offset:3072 lds
    v_mfma_f32_16x16x32_bf16 v[192:195], v[80:83], a[64:67], v[192:195]
    ds_read_b64_tr_b16 v[72:73], v41 offset:34816
    v_mfma_f32_16x16x32_bf16 v[200:203], v[80:83], a[68:71], v[200:203]
    ds_read_b64_tr_b16 v[74:75], v41 offset:35328
    v_mfma_f32_16x16x32_bf16 v[208:211], v[80:83], a[72:75], v[208:211]
    v_mfma_f32_16x16x32_bf16 v[216:219], v[80:83], a[76:79], v[216:219]
    v_mfma_f32_16x16x32_bf16 v[196:199], v[84:87], a[64:67], v[196:199]
    ds_read_b64_tr_b16 v[76:77], v43 offset:34816
    v_mfma_f32_16x16x32_bf16 v[204:207], v[84:87], a[68:71], v[204:207]
    ds_read_b64_tr_b16 v[78:79], v43 offset:35328
    v_mfma_f32_16x16x32_bf16 v[212:215], v[84:87], a[72:75], v[212:215]
    v_mfma_f32_16x16x32_bf16 v[220:223], v[84:87], a[76:79], v[220:223]
    v_mfma_f32_16x16x32_bf16 v[224:227], v[88:91], a[64:67], v[224:227]
    ds_read_b64_tr_b16 v[80:81], v45 offset:32768
    v_mfma_f32_16x16x32_bf16 v[232:235], v[88:91], a[68:71], v[232:235]
    ds_read_b64_tr_b16 v[82:83], v45 offset:33280
    v_mfma_f32_16x16x32_bf16 v[240:243], v[88:91], a[72:75], v[240:243]
    v_mfma_f32_16x16x32_bf16 v[248:251], v[88:91], a[76:79], v[248:251]
    v_mfma_f32_16x16x32_bf16 v[228:231], v[92:95], a[64:67], v[228:231]
    ds_read_b64_tr_b16 v[84:85], v47 offset:32768
    v_mfma_f32_16x16x32_bf16 v[236:239], v[92:95], a[68:71], v[236:239]
    ds_read_b64_tr_b16 v[86:87], v47 offset:33280
    v_mfma_f32_16x16x32_bf16 v[244:247], v[92:95], a[72:75], v[244:247]
    v_mfma_f32_16x16x32_bf16 v[252:255], v[92:95], a[76:79], v[252:255]
    s_waitcnt lgkmcnt(4)
    v_mfma_f32_16x16x32_bf16 v[128:131], v[64:67], a[80:83], v[128:131]
    s_waitcnt vmcnt(17)
    ds_read_b64_tr_b16 v[88:89], v45 offset:34816
    v_mfma_f32_16x16x32_bf16 v[136:139], v[64:67], a[84:87], v[136:139]
    ds_read_b64_tr_b16 v[90:91], v45 offset:35328
    v_mfma_f32_16x16x32_bf16 v[144:147], v[64:67], a[88:91], v[144:147]
    ds_read_b128 a[96:99], v6 offset:0
    v_mfma_f32_16x16x32_bf16 v[152:155], v[64:67], a[92:95], v[152:155]
    v_mfma_f32_16x16x32_bf16 v[132:135], v[68:71], a[80:83], v[132:135]
    ds_read_b64_tr_b16 v[92:93], v47 offset:34816
    v_mfma_f32_16x16x32_bf16 v[140:143], v[68:71], a[84:87], v[140:143]
    ds_read_b64_tr_b16 v[94:95], v47 offset:35328
    v_mfma_f32_16x16x32_bf16 v[148:151], v[68:71], a[88:91], v[148:151]
    ds_read_b128 a[100:103], v6 offset:2048
    v_mfma_f32_16x16x32_bf16 v[156:159], v[68:71], a[92:95], v[156:159]
    v_mfma_f32_16x16x32_bf16 v[160:163], v[72:75], a[80:83], v[160:163]
    s_waitcnt vmcnt(13)
    s_barrier
    v_mfma_f32_16x16x32_bf16 v[168:171], v[72:75], a[84:87], v[168:171]
    ds_read_b64_tr_b16 v[64:65], v40 offset:36864
    v_mfma_f32_16x16x32_bf16 v[176:179], v[72:75], a[88:91], v[176:179]
    ds_read_b64_tr_b16 v[66:67], v40 offset:37376
    v_mfma_f32_16x16x32_bf16 v[184:187], v[72:75], a[92:95], v[184:187]
    ds_read_b128 a[104:107], v6 offset:4096
    v_mfma_f32_16x16x32_bf16 v[164:167], v[76:79], a[80:83], v[164:167]
    ds_read_b64_tr_b16 v[68:69], v42 offset:36864
    v_mfma_f32_16x16x32_bf16 v[172:175], v[76:79], a[84:87], v[172:175]
    ds_read_b64_tr_b16 v[70:71], v42 offset:37376
    v_mfma_f32_16x16x32_bf16 v[180:183], v[76:79], a[88:91], v[180:183]
    ds_read_b128 a[108:111], v6 offset:6144
    v_mfma_f32_16x16x32_bf16 v[188:191], v[76:79], a[92:95], v[188:191]
    s_waitcnt lgkmcnt(7)
    v_mfma_f32_16x16x32_bf16 v[192:195], v[80:83], a[80:83], v[192:195]
    ds_read_b64_tr_b16 v[72:73], v40 offset:38912
    v_mfma_f32_16x16x32_bf16 v[200:203], v[80:83], a[84:87], v[200:203]
    ds_read_b64_tr_b16 v[74:75], v40 offset:39424
    v_mfma_f32_16x16x32_bf16 v[208:211], v[80:83], a[88:91], v[208:211]
    ds_read_b128 a[112:115], v7 offset:0
    v_mfma_f32_16x16x32_bf16 v[216:219], v[80:83], a[92:95], v[216:219]
    v_mfma_f32_16x16x32_bf16 v[196:199], v[84:87], a[80:83], v[196:199]
    ds_read_b64_tr_b16 v[76:77], v42 offset:38912
    v_mfma_f32_16x16x32_bf16 v[204:207], v[84:87], a[84:87], v[204:207]
    ds_read_b64_tr_b16 v[78:79], v42 offset:39424
    v_mfma_f32_16x16x32_bf16 v[212:215], v[84:87], a[88:91], v[212:215]
    ds_read_b128 a[116:119], v7 offset:2048
    v_mfma_f32_16x16x32_bf16 v[220:223], v[84:87], a[92:95], v[220:223]
    v_mfma_f32_16x16x32_bf16 v[224:227], v[88:91], a[80:83], v[224:227]
    ds_read_b64_tr_b16 v[80:81], v44 offset:36864
    v_mfma_f32_16x16x32_bf16 v[232:235], v[88:91], a[84:87], v[232:235]
    ds_read_b64_tr_b16 v[82:83], v44 offset:37376
    v_mfma_f32_16x16x32_bf16 v[240:243], v[88:91], a[88:91], v[240:243]
    ds_read_b128 a[120:123], v7 offset:4096
    v_mfma_f32_16x16x32_bf16 v[248:251], v[88:91], a[92:95], v[248:251]
    v_mfma_f32_16x16x32_bf16 v[228:231], v[92:95], a[80:83], v[228:231]
    ds_read_b64_tr_b16 v[84:85], v46 offset:36864
    v_mfma_f32_16x16x32_bf16 v[236:239], v[92:95], a[84:87], v[236:239]
    ds_read_b64_tr_b16 v[86:87], v46 offset:37376
    v_mfma_f32_16x16x32_bf16 v[244:247], v[92:95], a[88:91], v[244:247]
    ds_read_b128 a[124:127], v7 offset:6144
    v_mfma_f32_16x16x32_bf16 v[252:255], v[92:95], a[92:95], v[252:255]
    s_waitcnt lgkmcnt(7)
    s_add_u32 m0, s52, 16384
    s_add_u32 s53, s81, 0
    buffer_load_dwordx4 v2, s[56:59], s53 offen offset:0 lds
    buffer_load_dwordx4 v3, s[56:59], s53 offen offset:1024 lds
    buffer_load_dwordx4 v4, s[56:59], s53 offen offset:2048 lds
    buffer_load_dwordx4 v5, s[56:59], s53 offen offset:3072 lds
    v_mfma_f32_16x16x32_bf16 v[128:131], v[64:67], a[96:99], v[128:131]
    ds_read_b64_tr_b16 v[88:89], v44 offset:38912
    v_mfma_f32_16x16x32_bf16 v[136:139], v[64:67], a[100:103], v[136:139]
    ds_read_b64_tr_b16 v[90:91], v44 offset:39424
    v_mfma_f32_16x16x32_bf16 v[144:147], v[64:67], a[104:107], v[144:147]
    v_mfma_f32_16x16x32_bf16 v[152:155], v[64:67], a[108:111], v[152:155]
    v_mfma_f32_16x16x32_bf16 v[132:135], v[68:71], a[96:99], v[132:135]
    ds_read_b64_tr_b16 v[92:93], v46 offset:38912
    v_mfma_f32_16x16x32_bf16 v[140:143], v[68:71], a[100:103], v[140:143]
    ds_read_b64_tr_b16 v[94:95], v46 offset:39424
    v_mfma_f32_16x16x32_bf16 v[148:151], v[68:71], a[104:107], v[148:151]
    v_mfma_f32_16x16x32_bf16 v[156:159], v[68:71], a[108:111], v[156:159]
    s_add_u32 m0, s52, 20480
    s_add_u32 s53, s81, 36864
    buffer_load_dwordx4 v2, s[56:59], s53 offen offset:0 lds
    buffer_load_dwordx4 v3, s[56:59], s53 offen offset:1024 lds
    buffer_load_dwordx4 v4, s[56:59], s53 offen offset:2048 lds
    buffer_load_dwordx4 v5, s[56:59], s53 offen offset:3072 lds
    v_mfma_f32_16x16x32_bf16 v[160:163], v[72:75], a[96:99], v[160:163]
    ds_read_b64_tr_b16 v[64:65], v41 offset:36864
    v_mfma_f32_16x16x32_bf16 v[168:171], v[72:75], a[100:103], v[168:171]
    ds_read_b64_tr_b16 v[66:67], v41 offset:37376
    v_mfma_f32_16x16x32_bf16 v[176:179], v[72:75], a[104:107], v[176:179]
    v_mfma_f32_16x16x32_bf16 v[184:187], v[72:75], a[108:111], v[184:187]
    v_mfma_f32_16x16x32_bf16 v[164:167], v[76:79], a[96:99], v[164:167]
    ds_read_b64_tr_b16 v[68:69], v43 offset:36864
    v_mfma_f32_16x16x32_bf16 v[172:175], v[76:79], a[100:103], v[172:175]
    ds_read_b64_tr_b16 v[70:71], v43 offset:37376
    v_mfma_f32_16x16x32_bf16 v[180:183], v[76:79], a[104:107], v[180:183]
    v_mfma_f32_16x16x32_bf16 v[188:191], v[76:79], a[108:111], v[188:191]
    s_waitcnt lgkmcnt(4)
    s_add_u32 m0, s52, 28672
    s_add_u32 s54, s90, 0
    buffer_load_dwordx4 v12, s[60:63], s54 offen offset:0 lds
    buffer_load_dwordx4 v13, s[60:63], s54 offen offset:1024 lds
    buffer_load_dwordx4 v14, s[64:67], s54 offen offset:2048 lds
    buffer_load_dwordx4 v15, s[64:67], s54 offen offset:3072 lds
    v_mfma_f32_16x16x32_bf16 v[192:195], v[80:83], a[96:99], v[192:195]
    ds_read_b64_tr_b16 v[72:73], v41 offset:38912
    v_mfma_f32_16x16x32_bf16 v[200:203], v[80:83], a[100:103], v[200:203]
    ds_read_b64_tr_b16 v[74:75], v41 offset:39424
    v_mfma_f32_16x16x32_bf16 v[208:211], v[80:83], a[104:107], v[208:211]
    v_mfma_f32_16x16x32_bf16 v[216:219], v[80:83], a[108:111], v[216:219]
    v_mfma_f32_16x16x32_bf16 v[196:199], v[84:87], a[96:99], v[196:199]
    ds_read_b64_tr_b16 v[76:77], v43 offset:38912
    v_mfma_f32_16x16x32_bf16 v[204:207], v[84:87], a[100:103], v[204:207]
    ds_read_b64_tr_b16 v[78:79], v43 offset:39424
    v_mfma_f32_16x16x32_bf16 v[212:215], v[84:87], a[104:107], v[212:215]
    v_mfma_f32_16x16x32_bf16 v[220:223], v[84:87], a[108:111], v[220:223]
    v_mfma_f32_16x16x32_bf16 v[224:227], v[88:91], a[96:99], v[224:227]
    ds_read_b64_tr_b16 v[80:81], v45 offset:36864
    v_mfma_f32_16x16x32_bf16 v[232:235], v[88:91], a[100:103], v[232:235]
    ds_read_b64_tr_b16 v[82:83], v45 offset:37376
    v_mfma_f32_16x16x32_bf16 v[240:243], v[88:91], a[104:107], v[240:243]
    v_mfma_f32_16x16x32_bf16 v[248:251], v[88:91], a[108:111], v[248:251]
    v_mfma_f32_16x16x32_bf16 v[228:231], v[92:95], a[96:99], v[228:231]
    ds_read_b64_tr_b16 v[84:85], v47 offset:36864
    v_mfma_f32_16x16x32_bf16 v[236:239], v[92:95], a[100:103], v[236:239]
    ds_read_b64_tr_b16 v[86:87], v47 offset:37376
    v_mfma_f32_16x16x32_bf16 v[244:247], v[92:95], a[104:107], v[244:247]
    v_mfma_f32_16x16x32_bf16 v[252:255], v[92:95], a[108:111], v[252:255]
    s_waitcnt lgkmcnt(4)
    v_mfma_f32_16x16x32_bf16 v[128:131], v[64:67], a[112:115], v[128:131]
    s_waitcnt vmcnt(16)
    ds_read_b64_tr_b16 v[88:89], v45 offset:38912
    v_mfma_f32_16x16x32_bf16 v[136:139], v[64:67], a[116:119], v[136:139]
    ds_read_b64_tr_b16 v[90:91], v45 offset:39424
    v_mfma_f32_16x16x32_bf16 v[144:147], v[64:67], a[120:123], v[144:147]
    ds_read_b128 a[128:131], v6 offset:8192
    v_mfma_f32_16x16x32_bf16 v[152:155], v[64:67], a[124:127], v[152:155]
    v_mfma_f32_16x16x32_bf16 v[132:135], v[68:71], a[112:115], v[132:135]
    ds_read_b64_tr_b16 v[92:93], v47 offset:38912
    v_mfma_f32_16x16x32_bf16 v[140:143], v[68:71], a[116:119], v[140:143]
    ds_read_b64_tr_b16 v[94:95], v47 offset:39424
    v_mfma_f32_16x16x32_bf16 v[148:151], v[68:71], a[120:123], v[148:151]
    ds_read_b128 a[132:135], v6 offset:10240
    v_mfma_f32_16x16x32_bf16 v[156:159], v[68:71], a[124:127], v[156:159]
    v_mfma_f32_16x16x32_bf16 v[160:163], v[72:75], a[112:115], v[160:163]
    s_waitcnt vmcnt(12)
    s_barrier
    v_mfma_f32_16x16x32_bf16 v[168:171], v[72:75], a[116:119], v[168:171]
    ds_read_b64_tr_b16 v[64:65], v40 offset:24576
    v_mfma_f32_16x16x32_bf16 v[176:179], v[72:75], a[120:123], v[176:179]
    ds_read_b64_tr_b16 v[66:67], v40 offset:25088
    v_mfma_f32_16x16x32_bf16 v[184:187], v[72:75], a[124:127], v[184:187]
    ds_read_b128 a[136:139], v6 offset:12288
    v_mfma_f32_16x16x32_bf16 v[164:167], v[76:79], a[112:115], v[164:167]
    ds_read_b64_tr_b16 v[68:69], v42 offset:24576
    v_mfma_f32_16x16x32_bf16 v[172:175], v[76:79], a[116:119], v[172:175]
    ds_read_b64_tr_b16 v[70:71], v42 offset:25088
    v_mfma_f32_16x16x32_bf16 v[180:183], v[76:79], a[120:123], v[180:183]
    ds_read_b128 a[140:143], v6 offset:14336
    v_mfma_f32_16x16x32_bf16 v[188:191], v[76:79], a[124:127], v[188:191]
    s_waitcnt lgkmcnt(7)
    v_mfma_f32_16x16x32_bf16 v[192:195], v[80:83], a[112:115], v[192:195]
    ds_read_b64_tr_b16 v[72:73], v40 offset:26624
    v_mfma_f32_16x16x32_bf16 v[200:203], v[80:83], a[116:119], v[200:203]
    ds_read_b64_tr_b16 v[74:75], v40 offset:27136
    v_mfma_f32_16x16x32_bf16 v[208:211], v[80:83], a[120:123], v[208:211]
    ds_read_b128 a[144:147], v7 offset:8192
    v_mfma_f32_16x16x32_bf16 v[216:219], v[80:83], a[124:127], v[216:219]
    v_mfma_f32_16x16x32_bf16 v[196:199], v[84:87], a[112:115], v[196:199]
    ds_read_b64_tr_b16 v[76:77], v42 offset:26624
    v_mfma_f32_16x16x32_bf16 v[204:207], v[84:87], a[116:119], v[204:207]
    ds_read_b64_tr_b16 v[78:79], v42 offset:27136
    v_mfma_f32_16x16x32_bf16 v[212:215], v[84:87], a[120:123], v[212:215]
    ds_read_b128 a[148:151], v7 offset:10240
    v_mfma_f32_16x16x32_bf16 v[220:223], v[84:87], a[124:127], v[220:223]
    v_mfma_f32_16x16x32_bf16 v[224:227], v[88:91], a[112:115], v[224:227]
    ds_read_b64_tr_b16 v[80:81], v44 offset:24576
    v_mfma_f32_16x16x32_bf16 v[232:235], v[88:91], a[116:119], v[232:235]
    ds_read_b64_tr_b16 v[82:83], v44 offset:25088
    v_mfma_f32_16x16x32_bf16 v[240:243], v[88:91], a[120:123], v[240:243]
    ds_read_b128 a[152:155], v7 offset:12288
    v_mfma_f32_16x16x32_bf16 v[248:251], v[88:91], a[124:127], v[248:251]
    v_mfma_f32_16x16x32_bf16 v[228:231], v[92:95], a[112:115], v[228:231]
    ds_read_b64_tr_b16 v[84:85], v46 offset:24576
    v_mfma_f32_16x16x32_bf16 v[236:239], v[92:95], a[116:119], v[236:239]
    ds_read_b64_tr_b16 v[86:87], v46 offset:25088
    v_mfma_f32_16x16x32_bf16 v[244:247], v[92:95], a[120:123], v[244:247]
    ds_read_b128 a[156:159], v7 offset:14336
    v_mfma_f32_16x16x32_bf16 v[252:255], v[92:95], a[124:127], v[252:255]
    s_waitcnt lgkmcnt(7)
    v_mfma_f32_16x16x32_bf16 v[128:131], v[64:67], a[128:131], v[128:131]
    s_add_u32 m0, s52, 0
    s_add_u32 s53, s82, 0
    v_mfma_f32_16x16x32_bf16 v[136:139], v[64:67], a[132:135], v[136:139]
    buffer_load_dwordx4 v2, s[56:59], s53 offen offset:0 lds
    v_mfma_f32_16x16x32_bf16 v[144:147], v[64:67], a[136:139], v[144:147]
    ds_read_b64_tr_b16 v[88:89], v44 offset:26624
    v_mfma_f32_16x16x32_bf16 v[152:155], v[64:67], a[140:143], v[152:155]
    ds_read_b64_tr_b16 v[90:91], v44 offset:27136
    v_mfma_f32_16x16x32_bf16 v[132:135], v[68:71], a[128:131], v[132:135]
    buffer_load_dwordx4 v3, s[56:59], s53 offen offset:1024 lds
    v_mfma_f32_16x16x32_bf16 v[140:143], v[68:71], a[132:135], v[140:143]
    ds_read_b64_tr_b16 v[92:93], v46 offset:26624
    v_mfma_f32_16x16x32_bf16 v[148:151], v[68:71], a[136:139], v[148:151]
    ds_read_b64_tr_b16 v[94:95], v46 offset:27136
    v_mfma_f32_16x16x32_bf16 v[156:159], v[68:71], a[140:143], v[156:159]
    v_mfma_f32_16x16x32_bf16 v[160:163], v[72:75], a[128:131], v[160:163]
    buffer_load_dwordx4 v4, s[56:59], s53 offen offset:2048 lds
    v_mfma_f32_16x16x32_bf16 v[168:171], v[72:75], a[132:135], v[168:171]
    ds_read_b64_tr_b16 v[64:65], v41 offset:24576
    v_mfma_f32_16x16x32_bf16 v[176:179], v[72:75], a[136:139], v[176:179]
    ds_read_b64_tr_b16 v[66:67], v41 offset:25088
    v_mfma_f32_16x16x32_bf16 v[184:187], v[72:75], a[140:143], v[184:187]
    v_mfma_f32_16x16x32_bf16 v[164:167], v[76:79], a[128:131], v[164:167]
    buffer_load_dwordx4 v5, s[56:59], s53 offen offset:3072 lds
    v_mfma_f32_16x16x32_bf16 v[172:175], v[76:79], a[132:135], v[172:175]
    ds_read_b64_tr_b16 v[68:69], v43 offset:24576
    v_mfma_f32_16x16x32_bf16 v[180:183], v[76:79], a[136:139], v[180:183]
    ds_read_b64_tr_b16 v[70:71], v43 offset:25088
    v_mfma_f32_16x16x32_bf16 v[188:191], v[76:79], a[140:143], v[188:191]
    s_waitcnt lgkmcnt(4)
    v_mfma_f32_16x16x32_bf16 v[192:195], v[80:83], a[128:131], v[192:195]
    s_add_u32 m0, s52, 4096
    s_add_u32 s53, s82, 36864
    v_mfma_f32_16x16x32_bf16 v[200:203], v[80:83], a[132:135], v[200:203]
    buffer_load_dwordx4 v2, s[56:59], s53 offen offset:0 lds
    v_mfma_f32_16x16x32_bf16 v[208:211], v[80:83], a[136:139], v[208:211]
    ds_read_b64_tr_b16 v[72:73], v41 offset:26624
    v_mfma_f32_16x16x32_bf16 v[216:219], v[80:83], a[140:143], v[216:219]
    ds_read_b64_tr_b16 v[74:75], v41 offset:27136
    v_mfma_f32_16x16x32_bf16 v[196:199], v[84:87], a[128:131], v[196:199]
    buffer_load_dwordx4 v3, s[56:59], s53 offen offset:1024 lds
    v_mfma_f32_16x16x32_bf16 v[204:207], v[84:87], a[132:135], v[204:207]
    ds_read_b64_tr_b16 v[76:77], v43 offset:26624
    v_mfma_f32_16x16x32_bf16 v[212:215], v[84:87], a[136:139], v[212:215]
    ds_read_b64_tr_b16 v[78:79], v43 offset:27136
    v_mfma_f32_16x16x32_bf16 v[220:223], v[84:87], a[140:143], v[220:223]
    v_mfma_f32_16x16x32_bf16 v[224:227], v[88:91], a[128:131], v[224:227]
    buffer_load_dwordx4 v4, s[56:59], s53 offen offset:2048 lds
    v_mfma_f32_16x16x32_bf16 v[232:235], v[88:91], a[132:135], v[232:235]
    ds_read_b64_tr_b16 v[80:81], v45 offset:24576
    v_mfma_f32_16x16x32_bf16 v[240:243], v[88:91], a[136:139], v[240:243]
    ds_read_b64_tr_b16 v[82:83], v45 offset:25088
    v_mfma_f32_16x16x32_bf16 v[248:251], v[88:91], a[140:143], v[248:251]
    v_mfma_f32_16x16x32_bf16 v[228:231], v[92:95], a[128:131], v[228:231]
    buffer_load_dwordx4 v5, s[56:59], s53 offen offset:3072 lds
    v_mfma_f32_16x16x32_bf16 v[236:239], v[92:95], a[132:135], v[236:239]
    ds_read_b64_tr_b16 v[84:85], v47 offset:24576
    v_mfma_f32_16x16x32_bf16 v[244:247], v[92:95], a[136:139], v[244:247]
    ds_read_b64_tr_b16 v[86:87], v47 offset:25088
    v_mfma_f32_16x16x32_bf16 v[252:255], v[92:95], a[140:143], v[252:255]
    s_waitcnt lgkmcnt(4)
    v_mfma_f32_16x16x32_bf16 v[128:131], v[64:67], a[144:147], v[128:131]
    s_waitcnt vmcnt(12)
    s_add_u32 m0, s52, 32768
    v_mfma_f32_16x16x32_bf16 v[136:139], v[64:67], a[148:151], v[136:139]
    s_add_u32 s54, s91, 0
    ds_read_b64_tr_b16 v[88:89], v45 offset:26624
    v_mfma_f32_16x16x32_bf16 v[144:147], v[64:67], a[152:155], v[144:147]
    buffer_load_dwordx4 v12, s[60:63], s54 offen offset:0 lds
    v_mfma_f32_16x16x32_bf16 v[152:155], v[64:67], a[156:159], v[152:155]
    ds_read_b64_tr_b16 v[90:91], v45 offset:27136
    ds_read_b128 a[160:163], v6 offset:16384
    v_mfma_f32_16x16x32_bf16 v[132:135], v[68:71], a[144:147], v[132:135]
    buffer_load_dwordx4 v13, s[60:63], s54 offen offset:1024 lds
    v_mfma_f32_16x16x32_bf16 v[140:143], v[68:71], a[148:151], v[140:143]
    ds_read_b64_tr_b16 v[92:93], v47 offset:26624
    v_mfma_f32_16x16x32_bf16 v[148:151], v[68:71], a[152:155], v[148:151]
    ds_read_b64_tr_b16 v[94:95], v47 offset:27136
    v_mfma_f32_16x16x32_bf16 v[156:159], v[68:71], a[156:159], v[156:159]
    ds_read_b128 a[164:167], v6 offset:18432
    v_mfma_f32_16x16x32_bf16 v[160:163], v[72:75], a[144:147], v[160:163]
    s_waitcnt vmcnt(10)
    s_barrier
    v_mfma_f32_16x16x32_bf16 v[168:171], v[72:75], a[148:151], v[168:171]
    buffer_load_dwordx4 v14, s[64:67], s54 offen offset:2048 lds
    v_mfma_f32_16x16x32_bf16 v[176:179], v[72:75], a[152:155], v[176:179]
    ds_read_b64_tr_b16 v[64:65], v40 offset:28672
    ds_read_b64_tr_b16 v[66:67], v40 offset:29184
    v_mfma_f32_16x16x32_bf16 v[184:187], v[72:75], a[156:159], v[184:187]
    ds_read_b128 a[168:171], v6 offset:20480
    v_mfma_f32_16x16x32_bf16 v[164:167], v[76:79], a[144:147], v[164:167]
    buffer_load_dwordx4 v15, s[64:67], s54 offen offset:3072 lds
    v_mfma_f32_16x16x32_bf16 v[172:175], v[76:79], a[148:151], v[172:175]
    ds_read_b64_tr_b16 v[68:69], v42 offset:28672
    v_mfma_f32_16x16x32_bf16 v[180:183], v[76:79], a[152:155], v[180:183]
    ds_read_b64_tr_b16 v[70:71], v42 offset:29184
    v_mfma_f32_16x16x32_bf16 v[188:191], v[76:79], a[156:159], v[188:191]
    ds_read_b128 a[172:175], v6 offset:22528
    s_waitcnt lgkmcnt(7)
    v_mfma_f32_16x16x32_bf16 v[192:195], v[80:83], a[144:147], v[192:195]
    ds_read_b64_tr_b16 v[72:73], v40 offset:30720
    v_mfma_f32_16x16x32_bf16 v[200:203], v[80:83], a[148:151], v[200:203]
    ds_read_b64_tr_b16 v[74:75], v40 offset:31232
    v_mfma_f32_16x16x32_bf16 v[208:211], v[80:83], a[152:155], v[208:211]
    ds_read_b128 a[176:179], v7 offset:16384
    v_mfma_f32_16x16x32_bf16 v[216:219], v[80:83], a[156:159], v[216:219]
    v_mfma_f32_16x16x32_bf16 v[196:199], v[84:87], a[144:147], v[196:199]
    ds_read_b64_tr_b16 v[76:77], v42 offset:30720
    v_mfma_f32_16x16x32_bf16 v[204:207], v[84:87], a[148:151], v[204:207]
    ds_read_b64_tr_b16 v[78:79], v42 offset:31232
    v_mfma_f32_16x16x32_bf16 v[212:215], v[84:87], a[152:155], v[212:215]
    ds_read_b128 a[180:183], v7 offset:18432
    v_mfma_f32_16x16x32_bf16 v[220:223], v[84:87], a[156:159], v[220:223]
    v_mfma_f32_16x16x32_bf16 v[224:227], v[88:91], a[144:147], v[224:227]
    ds_read_b64_tr_b16 v[80:81], v44 offset:28672
    v_mfma_f32_16x16x32_bf16 v[232:235], v[88:91], a[148:151], v[232:235]
    ds_read_b64_tr_b16 v[82:83], v44 offset:29184
    v_mfma_f32_16x16x32_bf16 v[240:243], v[88:91], a[152:155], v[240:243]
    ds_read_b128 a[184:187], v7 offset:20480
    v_mfma_f32_16x16x32_bf16 v[248:251], v[88:91], a[156:159], v[248:251]
    v_mfma_f32_16x16x32_bf16 v[228:231], v[92:95], a[144:147], v[228:231]
    ds_read_b64_tr_b16 v[84:85], v46 offset:28672
    v_mfma_f32_16x16x32_bf16 v[236:239], v[92:95], a[148:151], v[236:239]
    ds_read_b64_tr_b16 v[86:87], v46 offset:29184
    v_mfma_f32_16x16x32_bf16 v[244:247], v[92:95], a[152:155], v[244:247]
    ds_read_b128 a[188:191], v7 offset:22528
    v_mfma_f32_16x16x32_bf16 v[252:255], v[92:95], a[156:159], v[252:255]
    s_waitcnt lgkmcnt(7)
    v_mfma_f32_16x16x32_bf16 v[128:131], v[64:67], a[160:163], v[128:131]
    s_add_u32 m0, s52, 8192
    s_add_u32 s53, s83, 0
    v_mfma_f32_16x16x32_bf16 v[136:139], v[64:67], a[164:167], v[136:139]
    buffer_load_dwordx4 v2, s[56:59], s53 offen offset:0 lds
    v_mfma_f32_16x16x32_bf16 v[144:147], v[64:67], a[168:171], v[144:147]
    s_mul_i32 s16, s3, 43
    ds_read_b64_tr_b16 v[88:89], v44 offset:30720
    v_mfma_f32_16x16x32_bf16 v[152:155], v[64:67], a[172:175], v[152:155]
    s_lshr_b32 s16, s16, 7
    ds_read_b64_tr_b16 v[90:91], v44 offset:31232
    v_mfma_f32_16x16x32_bf16 v[132:135], v[68:71], a[160:163], v[132:135]
    buffer_load_dwordx4 v3, s[56:59], s53 offen offset:1024 lds
    v_mfma_f32_16x16x32_bf16 v[140:143], v[68:71], a[164:167], v[140:143]
    s_mul_i32 s17, s16, 3
    s_sub_u32 s99, s3, s17
    v_mfma_f32_16x16x32_bf16 v[148:151], v[68:71], a[168:171], v[148:151]
    s_lshr_b32 s17, s51, 2
    ds_read_b64_tr_b16 v[92:93], v46 offset:30720
    v_mfma_f32_16x16x32_bf16 v[156:159], v[68:71], a[172:175], v[156:159]
    s_lshl3_add_u32 s98, s17, s16
    ds_read_b64_tr_b16 v[94:95], v46 offset:31232
    v_mfma_f32_16x16x32_bf16 v[160:163], v[72:75], a[160:163], v[160:163]
    buffer_load_dwordx4 v4, s[56:59], s53 offen offset:2048 lds
    v_mfma_f32_16x16x32_bf16 v[168:171], v[72:75], a[164:167], v[168:171]
    s_and_b32 s82, s51, 3
    s_mul_i32 s16, s98, 3
    v_mfma_f32_16x16x32_bf16 v[176:179], v[72:75], a[168:171], v[176:179]
    s_add_u32 s16, s16, s99
    ds_read_b64_tr_b16 v[64:65], v41 offset:28672
    v_mfma_f32_16x16x32_bf16 v[184:187], v[72:75], a[172:175], v[184:187]
    s_lshl_b32 s76, s16, 6
    ds_read_b64_tr_b16 v[66:67], v41 offset:29184
    v_mfma_f32_16x16x32_bf16 v[164:167], v[76:79], a[160:163], v[164:167]
    buffer_load_dwordx4 v5, s[56:59], s53 offen offset:3072 lds
    v_mfma_f32_16x16x32_bf16 v[172:175], v[76:79], a[164:167], v[172:175]
    s_add_u32 s76, s76, s50
    s_mul_i32 s76, s76, 6144
    v_mfma_f32_16x16x32_bf16 v[180:183], v[76:79], a[168:171], v[180:183]
    s_lshl2_add_u32 s26, s16, s50
    ds_read_b64_tr_b16 v[68:69], v43 offset:28672
    v_mfma_f32_16x16x32_bf16 v[188:191], v[76:79], a[172:175], v[188:191]
    ds_read_b64_tr_b16 v[70:71], v43 offset:29184
    s_waitcnt lgkmcnt(4)
    v_mfma_f32_16x16x32_bf16 v[192:195], v[80:83], a[160:163], v[192:195]
    s_add_u32 m0, s52, 12288
    s_add_u32 s53, s83, 36864
    v_mfma_f32_16x16x32_bf16 v[200:203], v[80:83], a[164:167], v[200:203]
    buffer_load_dwordx4 v2, s[56:59], s53 offen offset:0 lds
    v_mfma_f32_16x16x32_bf16 v[208:211], v[80:83], a[168:171], v[208:211]
    s_lshl_b32 s26, s26, 7
    ds_read_b64_tr_b16 v[72:73], v41 offset:30720
    v_mfma_f32_16x16x32_bf16 v[216:219], v[80:83], a[172:175], v[216:219]
    s_add_u32 s26, s26, 53970944
    ds_read_b64_tr_b16 v[74:75], v41 offset:31232
    v_mfma_f32_16x16x32_bf16 v[196:199], v[84:87], a[160:163], v[196:199]
    buffer_load_dwordx4 v3, s[56:59], s53 offen offset:1024 lds
    v_mfma_f32_16x16x32_bf16 v[204:207], v[84:87], a[164:167], v[204:207]
    s_lshl2_add_u32 s16, s16, s82
    s_lshl2_add_u32 s27, s16, s50
    v_mfma_f32_16x16x32_bf16 v[212:215], v[84:87], a[168:171], v[212:215]
    s_xor_b32 s17, s82, 1
    ds_read_b64_tr_b16 v[76:77], v43 offset:30720
    v_mfma_f32_16x16x32_bf16 v[220:223], v[84:87], a[172:175], v[220:223]
    s_mul_i32 s78, s17, 98304
    ds_read_b64_tr_b16 v[78:79], v43 offset:31232
    v_mfma_f32_16x16x32_bf16 v[224:227], v[88:91], a[160:163], v[224:227]
    buffer_load_dwordx4 v4, s[56:59], s53 offen offset:2048 lds
    v_mfma_f32_16x16x32_bf16 v[232:235], v[88:91], a[164:167], v[232:235]
    s_add_u32 s78, s78, s76
    s_add_u32 s78, s78, 30244864
    v_mfma_f32_16x16x32_bf16 v[240:243], v[88:91], a[168:171], v[240:243]
    s_xor_b32 s17, s82, 2
    ds_read_b64_tr_b16 v[80:81], v45 offset:28672
    v_mfma_f32_16x16x32_bf16 v[248:251], v[88:91], a[172:175], v[248:251]
    s_mul_i32 s79, s17, 98304
    ds_read_b64_tr_b16 v[82:83], v45 offset:29184
    v_mfma_f32_16x16x32_bf16 v[228:231], v[92:95], a[160:163], v[228:231]
    buffer_load_dwordx4 v5, s[56:59], s53 offen offset:3072 lds
    v_mfma_f32_16x16x32_bf16 v[236:239], v[92:95], a[164:167], v[236:239]
    s_add_u32 s79, s79, s76
    s_add_u32 s79, s79, 30269440
    v_mfma_f32_16x16x32_bf16 v[244:247], v[92:95], a[168:171], v[244:247]
    s_xor_b32 s17, s82, 3
    ds_read_b64_tr_b16 v[84:85], v47 offset:28672
    v_mfma_f32_16x16x32_bf16 v[252:255], v[92:95], a[172:175], v[252:255]
    ds_read_b64_tr_b16 v[86:87], v47 offset:29184
    s_waitcnt lgkmcnt(4)
    v_mfma_f32_16x16x32_bf16 v[128:131], v[64:67], a[176:179], v[128:131]
    s_waitcnt vmcnt(12)
    s_add_u32 m0, s52, 36864
    v_mfma_f32_16x16x32_bf16 v[136:139], v[64:67], a[180:183], v[136:139]
    s_add_u32 s54, s92, 0
    ds_read_b64_tr_b16 v[88:89], v45 offset:30720
    v_mfma_f32_16x16x32_bf16 v[144:147], v[64:67], a[184:187], v[144:147]
    buffer_load_dwordx4 v12, s[60:63], s54 offen offset:0 lds
    v_mfma_f32_16x16x32_bf16 v[152:155], v[64:67], a[188:191], v[152:155]
    ds_read_b64_tr_b16 v[90:91], v45 offset:31232
    ds_read_b128 a[192:195], v6 offset:0
    v_mfma_f32_16x16x32_bf16 v[132:135], v[68:71], a[176:179], v[132:135]
    buffer_load_dwordx4 v13, s[60:63], s54 offen offset:1024 lds
    v_mfma_f32_16x16x32_bf16 v[140:143], v[68:71], a[180:183], v[140:143]
    s_mul_i32 s80, s17, 98304
    ds_read_b64_tr_b16 v[92:93], v47 offset:30720
    v_mfma_f32_16x16x32_bf16 v[148:151], v[68:71], a[184:187], v[148:151]
    s_add_u32 s80, s80, s76
    ds_read_b64_tr_b16 v[94:95], v47 offset:31232
    v_mfma_f32_16x16x32_bf16 v[156:159], v[68:71], a[188:191], v[156:159]
    s_add_u32 s80, s80, 30294016
    ds_read_b128 a[196:199], v6 offset:2048
    v_mfma_f32_16x16x32_bf16 v[160:163], v[72:75], a[176:179], v[160:163]
    s_waitcnt vmcnt(10)
    s_barrier
    v_mfma_f32_16x16x32_bf16 v[168:171], v[72:75], a[180:183], v[168:171]
    buffer_load_dwordx4 v14, s[64:67], s54 offen offset:2048 lds
    v_mfma_f32_16x16x32_bf16 v[176:179], v[72:75], a[184:187], v[176:179]
    s_xor_b32 s17, s82, 0
    ds_read_b64_tr_b16 v[64:65], v40 offset:32768
    v_mfma_f32_16x16x32_bf16 v[184:187], v[72:75], a[188:191], v[184:187]
    ds_read_b64_tr_b16 v[66:67], v40 offset:33280
    ds_read_b128 a[200:203], v6 offset:4096
    v_mfma_f32_16x16x32_bf16 v[164:167], v[76:79], a[176:179], v[164:167]
    buffer_load_dwordx4 v15, s[64:67], s54 offen offset:3072 lds
    v_mfma_f32_16x16x32_bf16 v[172:175], v[76:79], a[180:183], v[172:175]
    s_mul_i32 s81, s17, 98304
    ds_read_b64_tr_b16 v[68:69], v42 offset:32768
    v_mfma_f32_16x16x32_bf16 v[180:183], v[76:79], a[184:187], v[180:183]
    s_add_u32 s81, s81, s76
    ds_read_b64_tr_b16 v[70:71], v42 offset:33280
    v_mfma_f32_16x16x32_bf16 v[188:191], v[76:79], a[188:191], v[188:191]
    ds_read_b128 a[204:207], v6 offset:6144
    s_waitcnt lgkmcnt(7)
    v_mfma_f32_16x16x32_bf16 v[192:195], v[80:83], a[176:179], v[192:195]
    s_add_u32 s81, s81, 30244864
    s_lshl2_add_u32 s17, s82, s26
    v_mfma_f32_16x16x32_bf16 v[200:203], v[80:83], a[180:183], v[200:203]
    ds_read_b64_tr_b16 v[72:73], v40 offset:34816
    v_min_u32 v29, 1, v0
    v_mfma_f32_16x16x32_bf16 v[208:211], v[80:83], a[184:187], v[208:211]
    ds_read_b64_tr_b16 v[74:75], v40 offset:35328
    v_lshl_add_u32 v29, v29, 30, s17
    v_mfma_f32_16x16x32_bf16 v[216:219], v[80:83], a[188:191], v[216:219]
    s_lshl2_add_u32 s16, s98, s50
    ds_read_b128 a[208:211], v7 offset:0
    v_mfma_f32_16x16x32_bf16 v[196:199], v[84:87], a[176:179], v[196:199]
    s_mul_i32 s76, s16, 368640
    s_mul_i32 s17, s82, 12288
    v_mfma_f32_16x16x32_bf16 v[204:207], v[84:87], a[180:183], v[204:207]
    s_add_u32 s76, s76, s17
    ds_read_b64_tr_b16 v[76:77], v42 offset:34816
    v_mfma_f32_16x16x32_bf16 v[212:215], v[84:87], a[184:187], v[212:215]
    s_lshr_b32 s16, s16, 1
    ds_read_b64_tr_b16 v[78:79], v42 offset:35328
    v_mfma_f32_16x16x32_bf16 v[220:223], v[84:87], a[188:191], v[220:223]
    s_lshl_b32 s16, s16, 12
    ds_read_b128 a[212:215], v7 offset:2048
    v_mfma_f32_16x16x32_bf16 v[224:227], v[88:91], a[176:179], v[224:227]
    s_add_u32 s16, s16, 53837824
    s_lshl_b32 s17, s82, 7
    v_mfma_f32_16x16x32_bf16 v[232:235], v[88:91], a[180:183], v[232:235]
    s_add_u32 s17, s16, s17
    ds_read_b64_tr_b16 v[80:81], v44 offset:32768
    v_mfma_f32_16x16x32_bf16 v[240:243], v[88:91], a[184:187], v[240:243]
    ds_read_b64_tr_b16 v[82:83], v44 offset:33280
    v_min_u32 v30, 5, v0
    v_mfma_f32_16x16x32_bf16 v[248:251], v[88:91], a[188:191], v[248:251]
    ds_read_b128 a[216:219], v7 offset:4096
    v_lshl_add_u32 v30, v30, 2, s17
    v_mfma_f32_16x16x32_bf16 v[228:231], v[92:95], a[176:179], v[228:231]
    ds_read_b64_tr_b16 v[84:85], v46 offset:32768
    v_mfma_f32_16x16x32_bf16 v[236:239], v[92:95], a[180:183], v[236:239]
    ds_read_b64_tr_b16 v[86:87], v46 offset:33280
    v_mfma_f32_16x16x32_bf16 v[244:247], v[92:95], a[184:187], v[244:247]
    ds_read_b128 a[220:223], v7 offset:6144
    v_mfma_f32_16x16x32_bf16 v[252:255], v[92:95], a[188:191], v[252:255]
    s_waitcnt lgkmcnt(7)
    s_branch L_sskip1
L_stub1:
    s_branch L_stub5
L_sskip1:
    v_mfma_f32_16x16x32_bf16 v[128:131], v[64:67], a[192:195], v[128:131]
    v_and_b32 v27, 60, v0
    v_mov_b32 v26, -1
    s_cmp_eq_u32 s50, 0
    s_cselect_b64 exec, -1, 0
    global_load_dword v26, v27, s[46:47] offset:128 sc1
    s_mov_b64 exec, -1
    v_mfma_f32_16x16x32_bf16 v[136:139], v[64:67], a[196:199], v[136:139]
    s_add_u32 m0, s52, 16384
    s_add_u32 s53, s84, 0
    v_mfma_f32_16x16x32_bf16 v[144:147], v[64:67], a[200:203], v[144:147]
    buffer_load_dwordx4 v2, s[56:59], s53 offen offset:0 lds
    v_mfma_f32_16x16x32_bf16 v[152:155], v[64:67], a[204:207], v[152:155]
    ds_read_b64_tr_b16 v[88:89], v44 offset:34816
    ds_read_b64_tr_b16 v[90:91], v44 offset:35328
    v_mfma_f32_16x16x32_bf16 v[132:135], v[68:71], a[192:195], v[132:135]
    buffer_load_dwordx4 v3, s[56:59], s53 offen offset:1024 lds
    v_mfma_f32_16x16x32_bf16 v[140:143], v[68:71], a[196:199], v[140:143]
    ds_read_b64_tr_b16 v[92:93], v46 offset:34816
    v_mfma_f32_16x16x32_bf16 v[148:151], v[68:71], a[200:203], v[148:151]
    ds_read_b64_tr_b16 v[94:95], v46 offset:35328
    v_mfma_f32_16x16x32_bf16 v[156:159], v[68:71], a[204:207], v[156:159]
    v_mfma_f32_16x16x32_bf16 v[160:163], v[72:75], a[192:195], v[160:163]
    buffer_load_dwordx4 v4, s[56:59], s53 offen offset:2048 lds
    v_mfma_f32_16x16x32_bf16 v[168:171], v[72:75], a[196:199], v[168:171]
    ds_read_b64_tr_b16 v[64:65], v41 offset:32768
    v_mfma_f32_16x16x32_bf16 v[176:179], v[72:75], a[200:203], v[176:179]
    ds_read_b64_tr_b16 v[66:67], v41 offset:33280
    v_mfma_f32_16x16x32_bf16 v[184:187], v[72:75], a[204:207], v[184:187]
    v_mfma_f32_16x16x32_bf16 v[164:167], v[76:79], a[192:195], v[164:167]
    buffer_load_dwordx4 v5, s[56:59], s53 offen offset:3072 lds
    v_mfma_f32_16x16x32_bf16 v[172:175], v[76:79], a[196:199], v[172:175]
    ds_read_b64_tr_b16 v[68:69], v43 offset:32768
    v_mfma_f32_16x16x32_bf16 v[180:183], v[76:79], a[200:203], v[180:183]
    ds_read_b64_tr_b16 v[70:71], v43 offset:33280
    v_mfma_f32_16x16x32_bf16 v[188:191], v[76:79], a[204:207], v[188:191]
    s_waitcnt lgkmcnt(4)
    v_mfma_f32_16x16x32_bf16 v[192:195], v[80:83], a[192:195], v[192:195]
    s_add_u32 m0, s52, 20480
    s_add_u32 s53, s84, 36864
    v_mfma_f32_16x16x32_bf16 v[200:203], v[80:83], a[196:199], v[200:203]
    buffer_load_dwordx4 v2, s[56:59], s53 offen offset:0 lds
    v_mfma_f32_16x16x32_bf16 v[208:211], v[80:83], a[200:203], v[208:211]
    ds_read_b64_tr_b16 v[72:73], v41 offset:34816
    v_mfma_f32_16x16x32_bf16 v[216:219], v[80:83], a[204:207], v[216:219]
    ds_read_b64_tr_b16 v[74:75], v41 offset:35328
    v_mfma_f32_16x16x32_bf16 v[196:199], v[84:87], a[192:195], v[196:199]
    buffer_load_dwordx4 v3, s[56:59], s53 offen offset:1024 lds
    v_mfma_f32_16x16x32_bf16 v[204:207], v[84:87], a[196:199], v[204:207]
    ds_read_b64_tr_b16 v[76:77], v43 offset:34816
    v_mfma_f32_16x16x32_bf16 v[212:215], v[84:87], a[200:203], v[212:215]
    ds_read_b64_tr_b16 v[78:79], v43 offset:35328
    v_mfma_f32_16x16x32_bf16 v[220:223], v[84:87], a[204:207], v[220:223]
    v_mfma_f32_16x16x32_bf16 v[224:227], v[88:91], a[192:195], v[224:227]
    buffer_load_dwordx4 v4, s[56:59], s53 offen offset:2048 lds
    v_mfma_f32_16x16x32_bf16 v[232:235], v[88:91], a[196:199], v[232:235]
    ds_read_b64_tr_b16 v[80:81], v45 offset:32768
    v_mfma_f32_16x16x32_bf16 v[240:243], v[88:91], a[200:203], v[240:243]
    ds_read_b64_tr_b16 v[82:83], v45 offset:33280
    v_mfma_f32_16x16x32_bf16 v[248:251], v[88:91], a[204:207], v[248:251]
    v_mfma_f32_16x16x32_bf16 v[228:231], v[92:95], a[192:195], v[228:231]
    buffer_load_dwordx4 v5, s[56:59], s53 offen offset:3072 lds
    v_mfma_f32_16x16x32_bf16 v[236:239], v[92:95], a[196:199], v[236:239]
    ds_read_b64_tr_b16 v[84:85], v47 offset:32768
    v_mfma_f32_16x16x32_bf16 v[244:247], v[92:95], a[200:203], v[244:247]
    ds_read_b64_tr_b16 v[86:87], v47 offset:33280
    v_mfma_f32_16x16x32_bf16 v[252:255], v[92:95], a[204:207], v[252:255]
    s_waitcnt lgkmcnt(4)
    v_mfma_f32_16x16x32_bf16 v[128:131], v[64:67], a[208:211], v[128:131]
    s_waitcnt vmcnt(13)
    s_add_u32 m0, s52, 24576
    v_mfma_f32_16x16x32_bf16 v[136:139], v[64:67], a[212:215], v[136:139]
    s_add_u32 s54, s93, 0
    ds_read_b64_tr_b16 v[88:89], v45 offset:34816
    v_mfma_f32_16x16x32_bf16 v[144:147], v[64:67], a[216:219], v[144:147]
    buffer_load_dwordx4 v12, s[60:63], s54 offen offset:0 lds
    v_mfma_f32_16x16x32_bf16 v[152:155], v[64:67], a[220:223], v[152:155]
    ds_read_b64_tr_b16 v[90:91], v45 offset:35328
    ds_read_b128 a[224:227], v6 offset:8192
    v_mfma_f32_16x16x32_bf16 v[132:135], v[68:71], a[208:211], v[132:135]
    buffer_load_dwordx4 v13, s[60:63], s54 offen offset:1024 lds
    v_mfma_f32_16x16x32_bf16 v[140:143], v[68:71], a[212:215], v[140:143]
    ds_read_b64_tr_b16 v[92:93], v47 offset:34816
    v_mfma_f32_16x16x32_bf16 v[148:151], v[68:71], a[216:219], v[148:151]
    ds_read_b64_tr_b16 v[94:95], v47 offset:35328
    v_mfma_f32_16x16x32_bf16 v[156:159], v[68:71], a[220:223], v[156:159]
    ds_read_b128 a[228:231], v6 offset:10240
    v_mfma_f32_16x16x32_bf16 v[160:163], v[72:75], a[208:211], v[160:163]
    s_waitcnt vmcnt(11)
    s_barrier
    v_mfma_f32_16x16x32_bf16 v[168:171], v[72:75], a[212:215], v[168:171]
    buffer_load_dwordx4 v14, s[64:67], s54 offen offset:2048 lds
    v_mfma_f32_16x16x32_bf16 v[176:179], v[72:75], a[216:219], v[176:179]
    ds_read_b64_tr_b16 v[64:65], v40 offset:36864
    ds_read_b64_tr_b16 v[66:67], v40 offset:37376
    v_mfma_f32_16x16x32_bf16 v[184:187], v[72:75], a[220:223], v[184:187]
    ds_read_b128 a[232:235], v6 offset:12288
    v_mfma_f32_16x16x32_bf16 v[164:167], v[76:79], a[208:211], v[164:167]
    buffer_load_dwordx4 v15, s[64:67], s54 offen offset:3072 lds
    v_mfma_f32_16x16x32_bf16 v[172:175], v[76:79], a[212:215], v[172:175]
    ds_read_b64_tr_b16 v[68:69], v42 offset:36864
    v_mfma_f32_16x16x32_bf16 v[180:183], v[76:79], a[216:219], v[180:183]
    ds_read_b64_tr_b16 v[70:71], v42 offset:37376
    v_mfma_f32_16x16x32_bf16 v[188:191], v[76:79], a[220:223], v[188:191]
    ds_read_b128 a[236:239], v6 offset:14336
    s_waitcnt lgkmcnt(7)
    v_mfma_f32_16x16x32_bf16 v[192:195], v[80:83], a[208:211], v[192:195]
    s_add_u32 m0, s52, 0
    s_add_u32 s54, s85, 1024
    v_mfma_f32_16x16x32_bf16 v[200:203], v[80:83], a[212:215], v[200:203]
    buffer_load_dwordx4 v12, s[60:63], s54 offen offset:0 lds
    v_mfma_f32_16x16x32_bf16 v[208:211], v[80:83], a[216:219], v[208:211]
    ds_read_b64_tr_b16 v[72:73], v40 offset:38912
    ds_read_b64_tr_b16 v[74:75], v40 offset:39424
    v_mfma_f32_16x16x32_bf16 v[216:219], v[80:83], a[220:223], v[216:219]
    ds_read_b128 a[240:243], v7 offset:8192
    v_mfma_f32_16x16x32_bf16 v[196:199], v[84:87], a[208:211], v[196:199]
    buffer_load_dwordx4 v13, s[60:63], s54 offen offset:1024 lds
    v_mfma_f32_16x16x32_bf16 v[204:207], v[84:87], a[212:215], v[204:207]
    ds_read_b64_tr_b16 v[76:77], v42 offset:38912
    v_mfma_f32_16x16x32_bf16 v[212:215], v[84:87], a[216:219], v[212:215]
    ds_read_b64_tr_b16 v[78:79], v42 offset:39424
    v_mfma_f32_16x16x32_bf16 v[220:223], v[84:87], a[220:223], v[220:223]
    ds_read_b128 a[244:247], v7 offset:10240
    v_mfma_f32_16x16x32_bf16 v[224:227], v[88:91], a[208:211], v[224:227]
    buffer_load_dwordx4 v14, s[64:67], s54 offen offset:2048 lds
    v_mfma_f32_16x16x32_bf16 v[232:235], v[88:91], a[212:215], v[232:235]
    ds_read_b64_tr_b16 v[80:81], v44 offset:36864
    v_mfma_f32_16x16x32_bf16 v[240:243], v[88:91], a[216:219], v[240:243]
    ds_read_b64_tr_b16 v[82:83], v44 offset:37376
    v_mfma_f32_16x16x32_bf16 v[248:251], v[88:91], a[220:223], v[248:251]
    ds_read_b128 a[248:251], v7 offset:12288
    v_mfma_f32_16x16x32_bf16 v[228:231], v[92:95], a[208:211], v[228:231]
    buffer_load_dwordx4 v15, s[64:67], s54 offen offset:3072 lds
    v_mfma_f32_16x16x32_bf16 v[236:239], v[92:95], a[212:215], v[236:239]
    ds_read_b64_tr_b16 v[84:85], v46 offset:36864
    v_mfma_f32_16x16x32_bf16 v[244:247], v[92:95], a[216:219], v[244:247]
    ds_read_b64_tr_b16 v[86:87], v46 offset:37376
    v_mfma_f32_16x16x32_bf16 v[252:255], v[92:95], a[220:223], v[252:255]
    ds_read_b128 a[252:255], v7 offset:14336
    s_waitcnt lgkmcnt(7)
    v_mfma_f32_16x16x32_bf16 v[128:131], v[64:67], a[224:227], v[128:131]
    s_add_u32 m0, s52, 4096
    s_add_u32 s54, s86, 1024
    v_mfma_f32_16x16x32_bf16 v[136:139], v[64:67], a[228:231], v[136:139]
    buffer_load_dwordx4 v12, s[60:63], s54 offen offset:0 lds
    v_mfma_f32_16x16x32_bf16 v[144:147], v[64:67], a[232:235], v[144:147]
    ds_read_b64_tr_b16 v[88:89], v44 offset:38912
    v_mfma_f32_16x16x32_bf16 v[152:155], v[64:67], a[236:239], v[152:155]
    ds_read_b64_tr_b16 v[90:91], v44 offset:39424
    v_mfma_f32_16x16x32_bf16 v[132:135], v[68:71], a[224:227], v[132:135]
    buffer_load_dwordx4 v13, s[60:63], s54 offen offset:1024 lds
    v_mfma_f32_16x16x32_bf16 v[140:143], v[68:71], a[228:231], v[140:143]
    ds_read_b64_tr_b16 v[92:93], v46 offset:38912
    v_mfma_f32_16x16x32_bf16 v[148:151], v[68:71], a[232:235], v[148:151]
    ds_read_b64_tr_b16 v[94:95], v46 offset:39424
    v_mfma_f32_16x16x32_bf16 v[156:159], v[68:71], a[236:239], v[156:159]
    v_mfma_f32_16x16x32_bf16 v[160:163], v[72:75], a[224:227], v[160:163]
    buffer_load_dwordx4 v14, s[64:67], s54 offen offset:2048 lds
    v_mfma_f32_16x16x32_bf16 v[168:171], v[72:75], a[228:231], v[168:171]
    ds_read_b64_tr_b16 v[64:65], v41 offset:36864
    v_mfma_f32_16x16x32_bf16 v[176:179], v[72:75], a[232:235], v[176:179]
    ds_read_b64_tr_b16 v[66:67], v41 offset:37376
    v_mfma_f32_16x16x32_bf16 v[184:187], v[72:75], a[236:239], v[184:187]
    v_mfma_f32_16x16x32_bf16 v[164:167], v[76:79], a[224:227], v[164:167]
    buffer_load_dwordx4 v15, s[64:67], s54 offen offset:3072 lds
    v_mfma_f32_16x16x32_bf16 v[172:175], v[76:79], a[228:231], v[172:175]
    ds_read_b64_tr_b16 v[68:69], v43 offset:36864
    v_mfma_f32_16x16x32_bf16 v[180:183], v[76:79], a[232:235], v[180:183]
    ds_read_b64_tr_b16 v[70:71], v43 offset:37376
    v_mfma_f32_16x16x32_bf16 v[188:191], v[76:79], a[236:239], v[188:191]
    s_waitcnt lgkmcnt(4)
    v_mfma_f32_16x16x32_bf16 v[192:195], v[80:83], a[224:227], v[192:195]
    global_load_dword v19, v[20:21], off
    v_mfma_f32_16x16x32_bf16 v[200:203], v[80:83], a[228:231], v[200:203]
    ds_read_b64_tr_b16 v[72:73], v41 offset:38912
    v_mfma_f32_16x16x32_bf16 v[208:211], v[80:83], a[232:235], v[208:211]
    ds_read_b64_tr_b16 v[74:75], v41 offset:39424
    v_mfma_f32_16x16x32_bf16 v[216:219], v[80:83], a[236:239], v[216:219]
    v_mfma_f32_16x16x32_bf16 v[196:199], v[84:87], a[224:227], v[196:199]
    ds_read_b64_tr_b16 v[76:77], v43 offset:38912
    v_mfma_f32_16x16x32_bf16 v[204:207], v[84:87], a[228:231], v[204:207]
    ds_read_b64_tr_b16 v[78:79], v43 offset:39424
    v_mfma_f32_16x16x32_bf16 v[212:215], v[84:87], a[232:235], v[212:215]
    v_mfma_f32_16x16x32_bf16 v[220:223], v[84:87], a[236:239], v[220:223]
    v_mfma_f32_16x16x32_bf16 v[224:227], v[88:91], a[224:227], v[224:227]
    ds_read_b64_tr_b16 v[80:81], v45 offset:36864
    v_mfma_f32_16x16x32_bf16 v[232:235], v[88:91], a[228:231], v[232:235]
    ds_read_b64_tr_b16 v[82:83], v45 offset:37376
    v_mfma_f32_16x16x32_bf16 v[240:243], v[88:91], a[232:235], v[240:243]
    v_mfma_f32_16x16x32_bf16 v[248:251], v[88:91], a[236:239], v[248:251]
    v_mfma_f32_16x16x32_bf16 v[228:231], v[92:95], a[224:227], v[228:231]
    ds_read_b64_tr_b16 v[84:85], v47 offset:36864
    v_mfma_f32_16x16x32_bf16 v[236:239], v[92:95], a[228:231], v[236:239]
    ds_read_b64_tr_b16 v[86:87], v47 offset:37376
    v_mfma_f32_16x16x32_bf16 v[244:247], v[92:95], a[232:235], v[244:247]
    v_mfma_f32_16x16x32_bf16 v[252:255], v[92:95], a[236:239], v[252:255]
    s_waitcnt lgkmcnt(4)
    v_mfma_f32_16x16x32_bf16 v[128:131], v[64:67], a[240:243], v[128:131]
    s_waitcnt vmcnt(13)
    ds_read_b64_tr_b16 v[88:89], v45 offset:38912
    v_mfma_f32_16x16x32_bf16 v[136:139], v[64:67], a[244:247], v[136:139]
    ds_read_b64_tr_b16 v[90:91], v45 offset:39424
    v_mfma_f32_16x16x32_bf16 v[144:147], v[64:67], a[248:251], v[144:147]
    ds_read_b128 v[96:99], v6 offset:16384
    v_mfma_f32_16x16x32_bf16 v[152:155], v[64:67], a[252:255], v[152:155]
    v_mfma_f32_16x16x32_bf16 v[132:135], v[68:71], a[240:243], v[132:135]
    ds_read_b64_tr_b16 v[92:93], v47 offset:38912
    v_mfma_f32_16x16x32_bf16 v[140:143], v[68:71], a[244:247], v[140:143]
    ds_read_b64_tr_b16 v[94:95], v47 offset:39424
    v_mfma_f32_16x16x32_bf16 v[148:151], v[68:71], a[248:251], v[148:151]
    ds_read_b128 v[100:103], v6 offset:18432
    v_mfma_f32_16x16x32_bf16 v[156:159], v[68:71], a[252:255], v[156:159]
    v_mfma_f32_16x16x32_bf16 v[160:163], v[72:75], a[240:243], v[160:163]
    s_waitcnt vmcnt(9)
    s_barrier
    v_mfma_f32_16x16x32_bf16 v[168:171], v[72:75], a[244:247], v[168:171]
    ds_read_b64_tr_b16 v[64:65], v40 offset:24576
    v_mfma_f32_16x16x32_bf16 v[176:179], v[72:75], a[248:251], v[176:179]
    ds_read_b64_tr_b16 v[66:67], v40 offset:25088
    v_mfma_f32_16x16x32_bf16 v[184:187], v[72:75], a[252:255], v[184:187]
    ds_read_b128 v[104:107], v6 offset:20480
    v_mfma_f32_16x16x32_bf16 v[164:167], v[76:79], a[240:243], v[164:167]
    ds_read_b64_tr_b16 v[68:69], v42 offset:24576
    v_mfma_f32_16x16x32_bf16 v[172:175], v[76:79], a[244:247], v[172:175]
    ds_read_b64_tr_b16 v[70:71], v42 offset:25088
    v_mfma_f32_16x16x32_bf16 v[180:183], v[76:79], a[248:251], v[180:183]
    ds_read_b128 v[108:111], v6 offset:22528
    v_mfma_f32_16x16x32_bf16 v[188:191], v[76:79], a[252:255], v[188:191]
    s_waitcnt lgkmcnt(7)
    v_mfma_f32_16x16x32_bf16 v[192:195], v[80:83], a[240:243], v[192:195]
    ds_read_b64_tr_b16 v[72:73], v40 offset:26624
    v_mfma_f32_16x16x32_bf16 v[200:203], v[80:83], a[244:247], v[200:203]
    ds_read_b64_tr_b16 v[74:75], v40 offset:27136
    v_mfma_f32_16x16x32_bf16 v[208:211], v[80:83], a[248:251], v[208:211]
    ds_read_b128 v[112:115], v7 offset:16384
    v_mfma_f32_16x16x32_bf16 v[216:219], v[80:83], a[252:255], v[216:219]
    v_mfma_f32_16x16x32_bf16 v[196:199], v[84:87], a[240:243], v[196:199]
    ds_read_b64_tr_b16 v[76:77], v42 offset:26624
    v_mfma_f32_16x16x32_bf16 v[204:207], v[84:87], a[244:247], v[204:207]
    ds_read_b64_tr_b16 v[78:79], v42 offset:27136
    v_mfma_f32_16x16x32_bf16 v[212:215], v[84:87], a[248:251], v[212:215]
    ds_read_b128 v[116:119], v7 offset:18432
    v_mfma_f32_16x16x32_bf16 v[220:223], v[84:87], a[252:255], v[220:223]
    v_mfma_f32_16x16x32_bf16 v[224:227], v[88:91], a[240:243], v[224:227]
    ds_read_b64_tr_b16 v[80:81], v44 offset:24576
    v_mfma_f32_16x16x32_bf16 v[232:235], v[88:91], a[244:247], v[232:235]
    ds_read_b64_tr_b16 v[82:83], v44 offset:25088
    v_mfma_f32_16x16x32_bf16 v[240:243], v[88:91], a[248:251], v[240:243]
    ds_read_b128 v[120:123], v7 offset:20480
    v_mfma_f32_16x16x32_bf16 v[248:251], v[88:91], a[252:255], v[248:251]
    v_mfma_f32_16x16x32_bf16 v[228:231], v[92:95], a[240:243], v[228:231]
    ds_read_b64_tr_b16 v[84:85], v46 offset:24576
    v_mfma_f32_16x16x32_bf16 v[236:239], v[92:95], a[244:247], v[236:239]
    ds_read_b64_tr_b16 v[86:87], v46 offset:25088
    v_mfma_f32_16x16x32_bf16 v[244:247], v[92:95], a[248:251], v[244:247]
    ds_read_b128 v[124:127], v7 offset:22528
    v_mfma_f32_16x16x32_bf16 v[252:255], v[92:95], a[252:255], v[252:255]
    s_waitcnt lgkmcnt(7)
    v_mfma_f32_16x16x32_bf16 v[128:131], v[64:67], v[96:99], v[128:131]
    v_mov_b32 v2, -1
    v_mov_b32 v3, -1
    v_mfma_f32_16x16x32_bf16 v[136:139], v[64:67], v[100:103], v[136:139]
    v_mov_b32 v4, -1
    v_mov_b32 v5, -1
    v_mfma_f32_16x16x32_bf16 v[144:147], v[64:67], v[104:107], v[144:147]
    ds_read_b64_tr_b16 v[88:89], v44 offset:26624
    v_mfma_f32_16x16x32_bf16 v[152:155], v[64:67], v[108:111], v[152:155]
    ds_read_b64_tr_b16 v[90:91], v44 offset:27136
    v_mfma_f32_16x16x32_bf16 v[132:135], v[68:71], v[96:99], v[132:135]
    ds_read_b64_tr_b16 v[92:93], v46 offset:26624
    v_mfma_f32_16x16x32_bf16 v[140:143], v[68:71], v[100:103], v[140:143]
    ds_read_b64_tr_b16 v[94:95], v46 offset:27136
    v_mfma_f32_16x16x32_bf16 v[148:151], v[68:71], v[104:107], v[148:151]
    v_mfma_f32_16x16x32_bf16 v[156:159], v[68:71], v[108:111], v[156:159]
    v_mfma_f32_16x16x32_bf16 v[160:163], v[72:75], v[96:99], v[160:163]
    ds_read_b64_tr_b16 v[64:65], v41 offset:24576
    v_mfma_f32_16x16x32_bf16 v[168:171], v[72:75], v[100:103], v[168:171]
    ds_read_b64_tr_b16 v[66:67], v41 offset:25088
    v_mfma_f32_16x16x32_bf16 v[176:179], v[72:75], v[104:107], v[176:179]
    v_mfma_f32_16x16x32_bf16 v[184:187], v[72:75], v[108:111], v[184:187]
    v_mfma_f32_16x16x32_bf16 v[164:167], v[76:79], v[96:99], v[164:167]
    ds_read_b64_tr_b16 v[68:69], v43 offset:24576
    v_mfma_f32_16x16x32_bf16 v[172:175], v[76:79], v[100:103], v[172:175]
    ds_read_b64_tr_b16 v[70:71], v43 offset:25088
    v_mfma_f32_16x16x32_bf16 v[180:183], v[76:79], v[104:107], v[180:183]
    v_mfma_f32_16x16x32_bf16 v[188:191], v[76:79], v[108:111], v[188:191]
    s_waitcnt lgkmcnt(4)
    v_mfma_f32_16x16x32_bf16 v[192:195], v[80:83], v[96:99], v[192:195]
    ds_read_b64_tr_b16 v[72:73], v41 offset:26624
    v_mfma_f32_16x16x32_bf16 v[200:203], v[80:83], v[100:103], v[200:203]
    ds_read_b64_tr_b16 v[74:75], v41 offset:27136
    v_mfma_f32_16x16x32_bf16 v[208:211], v[80:83], v[104:107], v[208:211]
    v_mfma_f32_16x16x32_bf16 v[216:219], v[80:83], v[108:111], v[216:219]
    v_mfma_f32_16x16x32_bf16 v[196:199], v[84:87], v[96:99], v[196:199]
    ds_read_b64_tr_b16 v[76:77], v43 offset:26624
    v_mfma_f32_16x16x32_bf16 v[204:207], v[84:87], v[100:103], v[204:207]
    ds_read_b64_tr_b16 v[78:79], v43 offset:27136
    v_mfma_f32_16x16x32_bf16 v[212:215], v[84:87], v[104:107], v[212:215]
    v_mfma_f32_16x16x32_bf16 v[220:223], v[84:87], v[108:111], v[220:223]
    v_mfma_f32_16x16x32_bf16 v[224:227], v[88:91], v[96:99], v[224:227]
    s_add_u32 m0, s52, 8192
    s_add_u32 s54, s87, 1024
    v_mfma_f32_16x16x32_bf16 v[232:235], v[88:91], v[100:103], v[232:235]
    buffer_load_dwordx4 v12, s[60:63], s54 offen offset:0 lds
    v_mfma_f32_16x16x32_bf16 v[240:243], v[88:91], v[104:107], v[240:243]
    ds_read_b64_tr_b16 v[80:81], v45 offset:24576
    v_mfma_f32_16x16x32_bf16 v[248:251], v[88:91], v[108:111], v[248:251]
    ds_read_b64_tr_b16 v[82:83], v45 offset:25088
    v_mfma_f32_16x16x32_bf16 v[228:231], v[92:95], v[96:99], v[228:231]
    buffer_load_dwordx4 v13, s[60:63], s54 offen offset:1024 lds
    v_mfma_f32_16x16x32_bf16 v[236:239], v[92:95], v[100:103], v[236:239]
    ds_read_b64_tr_b16 v[84:85], v47 offset:24576
    v_mfma_f32_16x16x32_bf16 v[244:247], v[92:95], v[104:107], v[244:247]
    ds_read_b64_tr_b16 v[86:87], v47 offset:25088
    v_mfma_f32_16x16x32_bf16 v[252:255], v[92:95], v[108:111], v[252:255]
    s_waitcnt lgkmcnt(4)
    v_mfma_f32_16x16x32_bf16 v[128:131], v[64:67], v[112:115], v[128:131]
    buffer_load_dwordx4 v14, s[64:67], s54 offen offset:2048 lds
    v_mfma_f32_16x16x32_bf16 v[136:139], v[64:67], v[116:119], v[136:139]
    ds_read_b64_tr_b16 v[88:89], v45 offset:26624
    v_mfma_f32_16x16x32_bf16 v[144:147], v[64:67], v[120:123], v[144:147]
    ds_read_b64_tr_b16 v[90:91], v45 offset:27136
    v_mfma_f32_16x16x32_bf16 v[152:155], v[64:67], v[124:127], v[152:155]
    v_mfma_f32_16x16x32_bf16 v[132:135], v[68:71], v[112:115], v[132:135]
    buffer_load_dwordx4 v15, s[64:67], s54 offen offset:3072 lds
    v_mfma_f32_16x16x32_bf16 v[140:143], v[68:71], v[116:119], v[140:143]
    ds_read_b64_tr_b16 v[92:93], v47 offset:26624
    v_mfma_f32_16x16x32_bf16 v[148:151], v[68:71], v[120:123], v[148:151]
    ds_read_b64_tr_b16 v[94:95], v47 offset:27136
    v_mfma_f32_16x16x32_bf16 v[156:159], v[68:71], v[124:127], v[156:159]
    v_mfma_f32_16x16x32_bf16 v[160:163], v[72:75], v[112:115], v[160:163]
    s_add_u32 m0, s52, 12288
    s_add_u32 s54, s88, 1024
    v_mfma_f32_16x16x32_bf16 v[168:171], v[72:75], v[116:119], v[168:171]
    buffer_load_dwordx4 v12, s[60:63], s54 offen offset:0 lds
    v_mfma_f32_16x16x32_bf16 v[176:179], v[72:75], v[120:123], v[176:179]
    v_mfma_f32_16x16x32_bf16 v[184:187], v[72:75], v[124:127], v[184:187]
    v_mfma_f32_16x16x32_bf16 v[164:167], v[76:79], v[112:115], v[164:167]
    buffer_load_dwordx4 v13, s[60:63], s54 offen offset:1024 lds
    v_mfma_f32_16x16x32_bf16 v[172:175], v[76:79], v[116:119], v[172:175]
    v_mfma_f32_16x16x32_bf16 v[180:183], v[76:79], v[120:123], v[180:183]
    v_mfma_f32_16x16x32_bf16 v[188:191], v[76:79], v[124:127], v[188:191]
    s_waitcnt lgkmcnt(0)
    v_mfma_f32_16x16x32_bf16 v[192:195], v[80:83], v[112:115], v[192:195]
    buffer_load_dwordx4 v14, s[64:67], s54 offen offset:2048 lds
    v_mfma_f32_16x16x32_bf16 v[200:203], v[80:83], v[116:119], v[200:203]
    v_mfma_f32_16x16x32_bf16 v[208:211], v[80:83], v[120:123], v[208:211]
    v_mfma_f32_16x16x32_bf16 v[216:219], v[80:83], v[124:127], v[216:219]
    v_mfma_f32_16x16x32_bf16 v[196:199], v[84:87], v[112:115], v[196:199]
    buffer_load_dwordx4 v15, s[64:67], s54 offen offset:3072 lds
    v_mfma_f32_16x16x32_bf16 v[204:207], v[84:87], v[116:119], v[204:207]
    v_mfma_f32_16x16x32_bf16 v[212:215], v[84:87], v[120:123], v[212:215]
    v_mfma_f32_16x16x32_bf16 v[220:223], v[84:87], v[124:127], v[220:223]
    v_mfma_f32_16x16x32_bf16 v[224:227], v[88:91], v[112:115], v[224:227]
    v_mfma_f32_16x16x32_bf16 v[232:235], v[88:91], v[116:119], v[232:235]
    v_mfma_f32_16x16x32_bf16 v[240:243], v[88:91], v[120:123], v[240:243]
    v_mfma_f32_16x16x32_bf16 v[248:251], v[88:91], v[124:127], v[248:251]
    v_mfma_f32_16x16x32_bf16 v[228:231], v[92:95], v[112:115], v[228:231]
    v_mfma_f32_16x16x32_bf16 v[236:239], v[92:95], v[116:119], v[236:239]
    v_mfma_f32_16x16x32_bf16 v[244:247], v[92:95], v[120:123], v[244:247]
    v_mfma_f32_16x16x32_bf16 v[252:255], v[92:95], v[124:127], v[252:255]
    v_pk_mul_f32 v[160:161], v[128:129], v[160:161]
    v_pk_mul_f32 v[128:129], v[128:129], s[94:95] op_sel:[0,1] op_sel_hi:[1,1]
    v_pk_mul_f32 v[162:163], v[130:131], v[162:163]
    v_pk_mul_f32 v[130:131], v[130:131], s[94:95] op_sel:[0,1] op_sel_hi:[1,1]
    v_pk_mul_f32 v[164:165], v[132:133], v[164:165]
    v_pk_mul_f32 v[132:133], v[132:133], s[94:95] op_sel:[0,1] op_sel_hi:[1,1]
    v_pk_mul_f32 v[166:167], v[134:135], v[166:167]
    v_pk_mul_f32 v[134:135], v[134:135], s[94:95] op_sel:[0,1] op_sel_hi:[1,1]
    v_exp_f32 v128, v128
    v_exp_f32 v129, v129
    v_exp_f32 v130, v130
    v_exp_f32 v131, v131
    v_exp_f32 v132, v132
    v_exp_f32 v133, v133
    v_exp_f32 v134, v134
    v_exp_f32 v135, v135
    v_pk_add_f32 v[128:129], v[128:129], 1.0 op_sel_hi:[1,0]
    v_pk_add_f32 v[130:131], v[130:131], 1.0 op_sel_hi:[1,0]
    v_pk_add_f32 v[132:133], v[132:133], 1.0 op_sel_hi:[1,0]
    v_pk_add_f32 v[134:135], v[134:135], 1.0 op_sel_hi:[1,0]
    v_rcp_f32 v128, v128
    v_rcp_f32 v129, v129
    v_rcp_f32 v130, v130
    v_rcp_f32 v131, v131
    v_rcp_f32 v132, v132
    v_rcp_f32 v133, v133
    v_rcp_f32 v134, v134
    v_rcp_f32 v135, v135
    v_pk_mul_f32 v[160:161], v[160:161], v[128:129]
    v_pk_mul_f32 v[162:163], v[162:163], v[130:131]
    v_pk_mul_f32 v[164:165], v[164:165], v[132:133]
    v_pk_mul_f32 v[166:167], v[166:167], v[134:135]
    v_cvt_pk_bf16_f32 v48, v160, v161
    v_cvt_pk_bf16_f32 v49, v162, v163
    v_cvt_pk_bf16_f32 v50, v164, v165
    s_add_u32 s16, s94, 0
    v_cvt_pk_bf16_f32 v51, v166, v167
    buffer_store_dwordx4 v[48:51], v22, s[68:71], s16 offen sc1
    v_pk_mul_f32 v[168:169], v[136:137], v[168:169]
    v_pk_mul_f32 v[136:137], v[136:137], s[94:95] op_sel:[0,1] op_sel_hi:[1,1]
    v_pk_mul_f32 v[170:171], v[138:139], v[170:171]
    v_pk_mul_f32 v[138:139], v[138:139], s[94:95] op_sel:[0,1] op_sel_hi:[1,1]
    v_pk_mul_f32 v[172:173], v[140:141], v[172:173]
    v_pk_mul_f32 v[140:141], v[140:141], s[94:95] op_sel:[0,1] op_sel_hi:[1,1]
    v_pk_mul_f32 v[174:175], v[142:143], v[174:175]
    v_pk_mul_f32 v[142:143], v[142:143], s[94:95] op_sel:[0,1] op_sel_hi:[1,1]
    v_exp_f32 v136, v136
    v_exp_f32 v137, v137
    v_exp_f32 v138, v138
    v_exp_f32 v139, v139
    v_exp_f32 v140, v140
    v_exp_f32 v141, v141
    v_exp_f32 v142, v142
    v_exp_f32 v143, v143
    v_pk_add_f32 v[136:137], v[136:137], 1.0 op_sel_hi:[1,0]
    v_pk_add_f32 v[138:139], v[138:139], 1.0 op_sel_hi:[1,0]
    v_pk_add_f32 v[140:141], v[140:141], 1.0 op_sel_hi:[1,0]
    v_pk_add_f32 v[142:143], v[142:143], 1.0 op_sel_hi:[1,0]
    v_rcp_f32 v136, v136
    v_rcp_f32 v137, v137
    v_rcp_f32 v138, v138
    v_rcp_f32 v139, v139
    v_rcp_f32 v140, v140
    v_rcp_f32 v141, v141
    v_rcp_f32 v142, v142
    v_rcp_f32 v143, v143
    v_pk_mul_f32 v[168:169], v[168:169], v[136:137]
    v_pk_mul_f32 v[170:171], v[170:171], v[138:139]
    v_pk_mul_f32 v[172:173], v[172:173], v[140:141]
    v_pk_mul_f32 v[174:175], v[174:175], v[142:143]
    v_cvt_pk_bf16_f32 v52, v168, v169
    v_cvt_pk_bf16_f32 v53, v170, v171
    v_cvt_pk_bf16_f32 v54, v172, v173
    s_add_u32 s16, s94, 1024
    v_cvt_pk_bf16_f32 v55, v174, v175
    buffer_store_dwordx4 v[52:55], v22, s[68:71], s16 offen sc1
    v_pk_mul_f32 v[176:177], v[144:145], v[176:177]
    v_pk_mul_f32 v[144:145], v[144:145], s[94:95] op_sel:[0,1] op_sel_hi:[1,1]
    v_pk_mul_f32 v[178:179], v[146:147], v[178:179]
    v_pk_mul_f32 v[146:147], v[146:147], s[94:95] op_sel:[0,1] op_sel_hi:[1,1]
    v_pk_mul_f32 v[180:181], v[148:149], v[180:181]
    v_pk_mul_f32 v[148:149], v[148:149], s[94:95] op_sel:[0,1] op_sel_hi:[1,1]
    v_pk_mul_f32 v[182:183], v[150:151], v[182:183]
    v_pk_mul_f32 v[150:151], v[150:151], s[94:95] op_sel:[0,1] op_sel_hi:[1,1]
    v_exp_f32 v144, v144
    v_exp_f32 v145, v145
    v_exp_f32 v146, v146
    v_exp_f32 v147, v147
    v_exp_f32 v148, v148
    v_exp_f32 v149, v149
    v_exp_f32 v150, v150
    v_exp_f32 v151, v151
    v_pk_add_f32 v[144:145], v[144:145], 1.0 op_sel_hi:[1,0]
    v_pk_add_f32 v[146:147], v[146:147], 1.0 op_sel_hi:[1,0]
    v_pk_add_f32 v[148:149], v[148:149], 1.0 op_sel_hi:[1,0]
    v_pk_add_f32 v[150:151], v[150:151], 1.0 op_sel_hi:[1,0]
    v_rcp_f32 v144, v144
    v_rcp_f32 v145, v145
    v_rcp_f32 v146, v146
    v_rcp_f32 v147, v147
    v_rcp_f32 v148, v148
    v_rcp_f32 v149, v149
    v_rcp_f32 v150, v150
    v_rcp_f32 v151, v151
    v_pk_mul_f32 v[176:177], v[176:177], v[144:145]
    v_pk_mul_f32 v[178:179], v[178:179], v[146:147]
    v_pk_mul_f32 v[180:181], v[180:181], v[148:149]
    v_pk_mul_f32 v[182:183], v[182:183], v[150:151]
    v_cvt_pk_bf16_f32 v56, v176, v177
    v_cvt_pk_bf16_f32 v57, v178, v179
    v_cvt_pk_bf16_f32 v58, v180, v181
    s_add_u32 s16, s94, 368640
    v_cvt_pk_bf16_f32 v59, v182, v183
    buffer_store_dwordx4 v[56:59], v22, s[68:71], s16 offen sc1
    v_cmp_gt_u32 vcc, 1, v26
    s_cbranch_vccnz L_poll1
L_fok1:
    s_waitcnt vmcnt(12)
    s_barrier
    ds_read_b64_tr_b16 v[64:65], v40 offset:0
    v_pk_mul_f32 v[184:185], v[152:153], v[184:185]
    v_pk_mul_f32 v[152:153], v[152:153], s[94:95] op_sel:[0,1] op_sel_hi:[1,1]
    ds_read_b64_tr_b16 v[66:67], v40 offset:512
    v_pk_mul_f32 v[186:187], v[154:155], v[186:187]
    v_pk_mul_f32 v[154:155], v[154:155], s[94:95] op_sel:[0,1] op_sel_hi:[1,1]
    ds_read_b64_tr_b16 v[68:69], v42 offset:0
    v_pk_mul_f32 v[188:189], v[156:157], v[188:189]
    v_pk_mul_f32 v[156:157], v[156:157], s[94:95] op_sel:[0,1] op_sel_hi:[1,1]
    ds_read_b64_tr_b16 v[70:71], v42 offset:512
    v_pk_mul_f32 v[190:191], v[158:159], v[190:191]
    v_pk_mul_f32 v[158:159], v[158:159], s[94:95] op_sel:[0,1] op_sel_hi:[1,1]
    ds_read_b64_tr_b16 v[72:73], v40 offset:2048
    v_exp_f32 v152, v152
    v_exp_f32 v153, v153
    ds_read_b64_tr_b16 v[74:75], v40 offset:2560
    v_exp_f32 v154, v154
    v_exp_f32 v155, v155
    ds_read_b64_tr_b16 v[76:77], v42 offset:2048
    v_exp_f32 v156, v156
    v_exp_f32 v157, v157
    ds_read_b64_tr_b16 v[78:79], v42 offset:2560
    v_exp_f32 v158, v158
    v_exp_f32 v159, v159
    ds_read_b64_tr_b16 v[80:81], v41 offset:0
    v_pk_add_f32 v[152:153], v[152:153], 1.0 op_sel_hi:[1,0]
    v_pk_add_f32 v[154:155], v[154:155], 1.0 op_sel_hi:[1,0]
    ds_read_b64_tr_b16 v[82:83], v41 offset:512
    v_pk_add_f32 v[156:157], v[156:157], 1.0 op_sel_hi:[1,0]
    v_pk_add_f32 v[158:159], v[158:159], 1.0 op_sel_hi:[1,0]
    ds_read_b64_tr_b16 v[84:85], v43 offset:0
    v_rcp_f32 v152, v152
    v_rcp_f32 v153, v153
    ds_read_b64_tr_b16 v[86:87], v43 offset:512
    v_rcp_f32 v154, v154
    v_rcp_f32 v155, v155
    v_rcp_f32 v156, v156
    v_rcp_f32 v157, v157
    v_rcp_f32 v158, v158
    v_rcp_f32 v159, v159
    v_pk_mul_f32 v[184:185], v[184:185], v[152:153]
    v_pk_mul_f32 v[186:187], v[186:187], v[154:155]
    v_pk_mul_f32 v[188:189], v[188:189], v[156:157]
    v_pk_mul_f32 v[190:191], v[190:191], v[158:159]
    v_cvt_pk_bf16_f32 v60, v184, v185
    v_cvt_pk_bf16_f32 v61, v186, v187
    v_cvt_pk_bf16_f32 v62, v188, v189
    s_add_u32 s16, s94, 369664
    v_cvt_pk_bf16_f32 v63, v190, v191
    buffer_store_dwordx4 v[60:63], v22, s[68:71], s16 offen sc1
    s_waitcnt lgkmcnt(4)
    v_mfma_f32_16x16x32_bf16 v[128:131], v[64:67], a[0:3], 0
    s_add_u32 m0, s52, 28672
    s_add_u32 s54, s89, 1024
    v_mfma_f32_16x16x32_bf16 v[136:139], v[64:67], a[4:7], 0
    buffer_load_dwordx4 v12, s[60:63], s54 offen offset:0 lds
    v_mfma_f32_16x16x32_bf16 v[144:147], v[64:67], a[8:11], 0
    ds_read_b64_tr_b16 v[88:89], v41 offset:2048
    v_mfma_f32_16x16x32_bf16 v[152:155], v[64:67], a[12:15], 0
    ds_read_b64_tr_b16 v[90:91], v41 offset:2560
    v_mfma_f32_16x16x32_bf16 v[132:135], v[68:71], a[0:3], 0
    buffer_load_dwordx4 v13, s[60:63], s54 offen offset:1024 lds
    v_mfma_f32_16x16x32_bf16 v[140:143], v[68:71], a[4:7], 0
    ds_read_b64_tr_b16 v[92:93], v43 offset:2048
    v_mfma_f32_16x16x32_bf16 v[148:151], v[68:71], a[8:11], 0
    ds_read_b64_tr_b16 v[94:95], v43 offset:2560
    v_mfma_f32_16x16x32_bf16 v[156:159], v[68:71], a[12:15], 0
    v_mfma_f32_16x16x32_bf16 v[160:163], v[72:75], a[0:3], 0
    buffer_load_dwordx4 v14, s[64:67], s54 offen offset:2048 lds
    v_mfma_f32_16x16x32_bf16 v[168:171], v[72:75], a[4:7], 0
    ds_read_b64_tr_b16 v[64:65], v40 offset:4096
    v_mul_f32 v32, s95, v192
    v_mfma_f32_16x16x32_bf16 v[176:179], v[72:75], a[8:11], 0
    v_exp_f32 v32, v32
    v_mfma_f32_16x16x32_bf16 v[184:187], v[72:75], a[12:15], 0
    ds_read_b64_tr_b16 v[66:67], v40 offset:4608
    v_mul_f32 v33, s95, v193
    v_mfma_f32_16x16x32_bf16 v[164:167], v[76:79], a[0:3], 0
    buffer_load_dwordx4 v15, s[64:67], s54 offen offset:3072 lds
    v_mfma_f32_16x16x32_bf16 v[172:175], v[76:79], a[4:7], 0
    v_exp_f32 v33, v33
    v_mfma_f32_16x16x32_bf16 v[180:183], v[76:79], a[8:11], 0
    ds_read_b64_tr_b16 v[68:69], v42 offset:4096
    s_branch L_sskip2
L_stub2:
    s_branch L_stub6
L_sskip2:
    v_add_f32 v32, 1.0, v32
    v_mfma_f32_16x16x32_bf16 v[188:191], v[76:79], a[12:15], 0
    ds_read_b64_tr_b16 v[70:71], v42 offset:4608
    s_waitcnt lgkmcnt(4)
    v_mfma_f32_16x16x32_bf16 v[128:131], v[80:83], a[16:19], v[128:131]
    s_add_u32 m0, s52, 16384
    s_add_u32 s54, s90, 1024
    v_mfma_f32_16x16x32_bf16 v[136:139], v[80:83], a[20:23], v[136:139]
    buffer_load_dwordx4 v12, s[60:63], s54 offen offset:0 lds
    v_mfma_f32_16x16x32_bf16 v[144:147], v[80:83], a[24:27], v[144:147]
    ds_read_b64_tr_b16 v[72:73], v40 offset:6144
    v_add_f32 v33, 1.0, v33
    v_mfma_f32_16x16x32_bf16 v[152:155], v[80:83], a[28:31], v[152:155]
    ds_read_b64_tr_b16 v[74:75], v40 offset:6656
    v_mul_f32 v34, v192, v224
    v_mfma_f32_16x16x32_bf16 v[132:135], v[84:87], a[16:19], v[132:135]
    buffer_load_dwordx4 v13, s[60:63], s54 offen offset:1024 lds
    v_mfma_f32_16x16x32_bf16 v[140:143], v[84:87], a[20:23], v[140:143]
    v_rcp_f32 v32, v32
    v_mfma_f32_16x16x32_bf16 v[148:151], v[84:87], a[24:27], v[148:151]
    ds_read_b64_tr_b16 v[76:77], v42 offset:6144
    v_mul_f32 v35, v193, v225
    v_mfma_f32_16x16x32_bf16 v[156:159], v[84:87], a[28:31], v[156:159]
    ds_read_b64_tr_b16 v[78:79], v42 offset:6656
    v_mul_f32 v34, v34, v32
    v_mfma_f32_16x16x32_bf16 v[160:163], v[88:91], a[16:19], v[160:163]
    buffer_load_dwordx4 v14, s[64:67], s54 offen offset:2048 lds
    v_mfma_f32_16x16x32_bf16 v[168:171], v[88:91], a[20:23], v[168:171]
    v_rcp_f32 v33, v33
    v_mfma_f32_16x16x32_bf16 v[176:179], v[88:91], a[24:27], v[176:179]
    ds_read_b64_tr_b16 v[80:81], v41 offset:4096
    v_mul_f32 v35, v35, v33
    v_mfma_f32_16x16x32_bf16 v[184:187], v[88:91], a[28:31], v[184:187]
    ds_read_b64_tr_b16 v[82:83], v41 offset:4608
    v_cvt_pk_bf16_f32 v48, v34, v35
    v_mfma_f32_16x16x32_bf16 v[164:167], v[92:95], a[16:19], v[164:167]
    buffer_load_dwordx4 v15, s[64:67], s54 offen offset:3072 lds
    v_mfma_f32_16x16x32_bf16 v[172:175], v[92:95], a[20:23], v[172:175]
    ds_read_b64_tr_b16 v[84:85], v43 offset:4096
    v_mul_f32 v36, s95, v194
    v_mfma_f32_16x16x32_bf16 v[180:183], v[92:95], a[24:27], v[180:183]
    v_exp_f32 v36, v36
    v_mfma_f32_16x16x32_bf16 v[188:191], v[92:95], a[28:31], v[188:191]
    ds_read_b64_tr_b16 v[86:87], v43 offset:4608
    s_waitcnt lgkmcnt(4)
    v_mfma_f32_16x16x32_bf16 v[128:131], v[64:67], a[32:35], v[128:131]
    s_add_u32 m0, s52, 20480
    s_add_u32 s54, s91, 1024
    v_mfma_f32_16x16x32_bf16 v[136:139], v[64:67], a[36:39], v[136:139]
    buffer_load_dwordx4 v12, s[60:63], s54 offen offset:0 lds
    v_mfma_f32_16x16x32_bf16 v[144:147], v[64:67], a[40:43], v[144:147]
    ds_read_b64_tr_b16 v[88:89], v41 offset:6144
    v_mul_f32 v37, s95, v195
    v_mfma_f32_16x16x32_bf16 v[152:155], v[64:67], a[44:47], v[152:155]
    ds_read_b64_tr_b16 v[90:91], v41 offset:6656
    v_add_f32 v36, 1.0, v36
    v_mfma_f32_16x16x32_bf16 v[132:135], v[68:71], a[32:35], v[132:135]
    buffer_load_dwordx4 v13, s[60:63], s54 offen offset:1024 lds
    v_mfma_f32_16x16x32_bf16 v[140:143], v[68:71], a[36:39], v[140:143]
    v_exp_f32 v37, v37
    v_mfma_f32_16x16x32_bf16 v[148:151], v[68:71], a[40:43], v[148:151]
    ds_read_b64_tr_b16 v[92:93], v43 offset:6144
    v_add_f32 v37, 1.0, v37
    v_mfma_f32_16x16x32_bf16 v[156:159], v[68:71], a[44:47], v[156:159]
    ds_read_b64_tr_b16 v[94:95], v43 offset:6656
    v_mul_f32 v38, v194, v226
    v_mfma_f32_16x16x32_bf16 v[160:163], v[72:75], a[32:35], v[160:163]
    s_waitcnt vmcnt(14)
    s_barrier
    v_mfma_f32_16x16x32_bf16 v[168:171], v[72:75], a[36:39], v[168:171]
    buffer_load_dwordx4 v14, s[64:67], s54 offen offset:2048 lds
    v_mfma_f32_16x16x32_bf16 v[176:179], v[72:75], a[40:43], v[176:179]
    ds_read_b64_tr_b16 v[64:65], v40 offset:8192
    v_mul_f32 v39, v195, v227
    v_mfma_f32_16x16x32_bf16 v[184:187], v[72:75], a[44:47], v[184:187]
    ds_read_b64_tr_b16 v[66:67], v40 offset:8704
    v_mul_f32 v32, s95, v196
    v_mfma_f32_16x16x32_bf16 v[164:167], v[76:79], a[32:35], v[164:167]
    buffer_load_dwordx4 v15, s[64:67], s54 offen offset:3072 lds
    v_mfma_f32_16x16x32_bf16 v[172:175], v[76:79], a[36:39], v[172:175]
    v_rcp_f32 v36, v36
    v_mfma_f32_16x16x32_bf16 v[180:183], v[76:79], a[40:43], v[180:183]
    ds_read_b64_tr_b16 v[68:69], v42 offset:8192
    v_mul_f32 v38, v38, v36
    v_mfma_f32_16x16x32_bf16 v[188:191], v[76:79], a[44:47], v[188:191]
    ds_read_b64_tr_b16 v[70:71], v42 offset:8704
    s_waitcnt lgkmcnt(4)
    v_mfma_f32_16x16x32_bf16 v[128:131], v[80:83], a[48:51], v[128:131]
    s_add_u32 m0, s52, 32768
    s_add_u32 s54, s92, 1024
    v_mfma_f32_16x16x32_bf16 v[136:139], v[80:83], a[52:55], v[136:139]
    buffer_load_dwordx4 v12, s[60:63], s54 offen offset:0 lds
    v_mfma_f32_16x16x32_bf16 v[144:147], v[80:83], a[56:59], v[144:147]
    ds_read_b64_tr_b16 v[72:73], v40 offset:10240
    v_mul_f32 v33, s95, v197
    v_mfma_f32_16x16x32_bf16 v[152:155], v[80:83], a[60:63], v[152:155]
    ds_read_b64_tr_b16 v[74:75], v40 offset:10752
    v_mul_f32 v34, v196, v228
    v_mfma_f32_16x16x32_bf16 v[132:135], v[84:87], a[48:51], v[132:135]
    buffer_load_dwordx4 v13, s[60:63], s54 offen offset:1024 lds
    v_mfma_f32_16x16x32_bf16 v[140:143], v[84:87], a[52:55], v[140:143]
    v_rcp_f32 v37, v37
    v_mfma_f32_16x16x32_bf16 v[148:151], v[84:87], a[56:59], v[148:151]
    ds_read_b64_tr_b16 v[76:77], v42 offset:10240
    v_mul_f32 v39, v39, v37
    v_mfma_f32_16x16x32_bf16 v[156:159], v[84:87], a[60:63], v[156:159]
    ds_read_b64_tr_b16 v[78:79], v42 offset:10752
    v_cvt_pk_bf16_f32 v49, v38, v39
    v_mfma_f32_16x16x32_bf16 v[160:163], v[88:91], a[48:51], v[160:163]
    s_waitcnt vmcnt(14)
    buffer_store_dword v25, v24, s[68:71], 0 offen offset:0 sc1
    v_mfma_f32_16x16x32_bf16 v[168:171], v[88:91], a[52:55], v[168:171]
    buffer_load_dwordx4 v14, s[64:67], s54 offen offset:2048 lds
    v_mfma_f32_16x16x32_bf16 v[176:179], v[88:91], a[56:59], v[176:179]
    ds_read_b64_tr_b16 v[80:81], v41 offset:8192
    v_mul_f32 v35, v197, v229
    v_mfma_f32_16x16x32_bf16 v[184:187], v[88:91], a[60:63], v[184:187]
    ds_read_b64_tr_b16 v[82:83], v41 offset:8704
    v_mul_f32 v36, s95, v198
    v_mfma_f32_16x16x32_bf16 v[164:167], v[92:95], a[48:51], v[164:167]
    buffer_load_dwordx4 v15, s[64:67], s54 offen offset:3072 lds
    v_mfma_f32_16x16x32_bf16 v[172:175], v[92:95], a[52:55], v[172:175]
    v_exp_f32 v32, v32
    v_mfma_f32_16x16x32_bf16 v[180:183], v[92:95], a[56:59], v[180:183]
    ds_read_b64_tr_b16 v[84:85], v43 offset:8192
    v_add_f32 v32, 1.0, v32
    v_mfma_f32_16x16x32_bf16 v[188:191], v[92:95], a[60:63], v[188:191]
    ds_read_b64_tr_b16 v[86:87], v43 offset:8704
    s_waitcnt lgkmcnt(4)
    v_mfma_f32_16x16x32_bf16 v[128:131], v[64:67], a[64:67], v[128:131]
    s_add_u32 m0, s52, 36864
    s_add_u32 s54, s93, 1024
    v_mfma_f32_16x16x32_bf16 v[136:139], v[64:67], a[68:71], v[136:139]
    buffer_load_dwordx4 v12, s[60:63], s54 offen offset:0 lds
    v_mfma_f32_16x16x32_bf16 v[144:147], v[64:67], a[72:75], v[144:147]
    ds_read_b64_tr_b16 v[88:89], v41 offset:10240
    v_mov_b32 v27, v10
    v_mfma_f32_16x16x32_bf16 v[152:155], v[64:67], a[76:79], v[152:155]
    ds_read_b64_tr_b16 v[90:91], v41 offset:10752
    v_mul_f32 v37, s95, v199
    v_mfma_f32_16x16x32_bf16 v[132:135], v[68:71], a[64:67], v[132:135]
    buffer_load_dwordx4 v13, s[60:63], s54 offen offset:1024 lds
    v_mfma_f32_16x16x32_bf16 v[140:143], v[68:71], a[68:71], v[140:143]
    v_exp_f32 v33, v33
    v_mfma_f32_16x16x32_bf16 v[148:151], v[68:71], a[72:75], v[148:151]
    ds_read_b64_tr_b16 v[92:93], v43 offset:10240
    v_add_f32 v33, 1.0, v33
    v_mfma_f32_16x16x32_bf16 v[156:159], v[68:71], a[76:79], v[156:159]
    ds_read_b64_tr_b16 v[94:95], v43 offset:10752
    v_mul_f32 v38, v198, v230
    v_mfma_f32_16x16x32_bf16 v[160:163], v[72:75], a[64:67], v[160:163]
    buffer_load_dwordx4 v14, s[64:67], s54 offen offset:2048 lds
    v_mfma_f32_16x16x32_bf16 v[168:171], v[72:75], a[68:71], v[168:171]
    v_rcp_f32 v32, v32
    v_mfma_f32_16x16x32_bf16 v[176:179], v[72:75], a[72:75], v[176:179]
    ds_read_b64_tr_b16 v[64:65], v40 offset:12288
    v_mul_f32 v34, v34, v32
    v_mfma_f32_16x16x32_bf16 v[184:187], v[72:75], a[76:79], v[184:187]
    ds_read_b64_tr_b16 v[66:67], v40 offset:12800
    v_mul_f32 v39, v199, v231
    v_mfma_f32_16x16x32_bf16 v[164:167], v[76:79], a[64:67], v[164:167]
    buffer_load_dwordx4 v15, s[64:67], s54 offen offset:3072 lds
    v_mfma_f32_16x16x32_bf16 v[172:175], v[76:79], a[68:71], v[172:175]
    v_rcp_f32 v33, v33
    v_mfma_f32_16x16x32_bf16 v[180:183], v[76:79], a[72:75], v[180:183]
    ds_read_b64_tr_b16 v[68:69], v42 offset:12288
    v_mul_f32 v35, v35, v33
    v_mfma_f32_16x16x32_bf16 v[188:191], v[76:79], a[76:79], v[188:191]
    ds_read_b64_tr_b16 v[70:71], v42 offset:12800
    s_waitcnt lgkmcnt(4)
    v_mfma_f32_16x16x32_bf16 v[128:131], v[80:83], a[80:83], v[128:131]
    v_exp_f32 v36, v36
    v_mfma_f32_16x16x32_bf16 v[136:139], v[80:83], a[84:87], v[136:139]
    v_exp_f32 v37, v37
    v_mfma_f32_16x16x32_bf16 v[144:147], v[80:83], a[88:91], v[144:147]
    ds_read_b64_tr_b16 v[72:73], v40 offset:14336
    v_cvt_pk_bf16_f32 v50, v34, v35
    v_mfma_f32_16x16x32_bf16 v[152:155], v[80:83], a[92:95], v[152:155]
    ds_read_b64_tr_b16 v[74:75], v40 offset:14848
    v_add_f32 v36, 1.0, v36
    v_mfma_f32_16x16x32_bf16 v[132:135], v[84:87], a[80:83], v[132:135]
    v_rcp_f32 v36, v36
    v_mfma_f32_16x16x32_bf16 v[140:143], v[84:87], a[84:87], v[140:143]
    ds_read_b64_tr_b16 v[76:77], v42 offset:14336
    v_add_f32 v37, 1.0, v37
    v_mfma_f32_16x16x32_bf16 v[148:151], v[84:87], a[88:91], v[148:151]
    v_rcp_f32 v37, v37
    v_mfma_f32_16x16x32_bf16 v[156:159], v[84:87], a[92:95], v[156:159]
    ds_read_b64_tr_b16 v[78:79], v42 offset:14848
    v_mul_f32 v38, v38, v36
    v_mfma_f32_16x16x32_bf16 v[160:163], v[88:91], a[80:83], v[160:163]
    ds_read_b64_tr_b16 v[80:81], v41 offset:12288
    v_mul_f32 v39, v39, v37
    v_mfma_f32_16x16x32_bf16 v[168:171], v[88:91], a[84:87], v[168:171]
    s_add_u32 s16, s94, 49152
    ds_read_b64_tr_b16 v[82:83], v41 offset:12800
    v_mfma_f32_16x16x32_bf16 v[176:179], v[88:91], a[88:91], v[176:179]
    v_cvt_pk_bf16_f32 v51, v38, v39
    v_mul_f32 v32, s95, v200
    v_mfma_f32_16x16x32_bf16 v[184:187], v[88:91], a[92:95], v[184:187]
    buffer_store_dwordx4 v[48:51], v22, s[68:71], s16 offen sc1
    v_mul_f32 v33, s95, v201
    v_mfma_f32_16x16x32_bf16 v[164:167], v[92:95], a[80:83], v[164:167]
    v_exp_f32 v32, v32
    v_mfma_f32_16x16x32_bf16 v[172:175], v[92:95], a[84:87], v[172:175]
    v_exp_f32 v33, v33
    v_mfma_f32_16x16x32_bf16 v[180:183], v[92:95], a[88:91], v[180:183]
    ds_read_b64_tr_b16 v[84:85], v43 offset:12288
    v_add_f32 v32, 1.0, v32
    v_mfma_f32_16x16x32_bf16 v[188:191], v[92:95], a[92:95], v[188:191]
    ds_read_b64_tr_b16 v[86:87], v43 offset:12800
    s_waitcnt lgkmcnt(4)
    v_mfma_f32_16x16x32_bf16 v[128:131], v[64:67], a[96:99], v[128:131]
    s_add_u32 s55, s96, 4096
    ds_read_b64_tr_b16 v[88:89], v41 offset:14336
    v_mfma_f32_16x16x32_bf16 v[136:139], v[64:67], a[100:103], v[136:139]
    buffer_load_dword v26, v1, s[60:63], s55 offen
    v_mfma_f32_16x16x32_bf16 v[144:147], v[64:67], a[104:107], v[144:147]
    v_rcp_f32 v32, v32
    v_mfma_f32_16x16x32_bf16 v[152:155], v[64:67], a[108:111], v[152:155]
    ds_read_b64_tr_b16 v[90:91], v41 offset:14848
    v_add_f32 v33, 1.0, v33
    v_mfma_f32_16x16x32_bf16 v[132:135], v[68:71], a[96:99], v[132:135]
    v_rcp_f32 v33, v33
    v_mfma_f32_16x16x32_bf16 v[140:143], v[68:71], a[100:103], v[140:143]
    ds_read_b64_tr_b16 v[92:93], v43 offset:14336
    v_mul_f32 v34, v200, v232
    v_mfma_f32_16x16x32_bf16 v[148:151], v[68:71], a[104:107], v[148:151]
    ds_read_b64_tr_b16 v[94:95], v43 offset:14848
    v_mul_f32 v35, v201, v233
    v_mfma_f32_16x16x32_bf16 v[156:159], v[68:71], a[108:111], v[156:159]
    v_mul_f32 v34, v34, v32
    v_mul_f32 v35, v35, v33
    v_mfma_f32_16x16x32_bf16 v[160:163], v[72:75], a[96:99], v[160:163]
    s_waitcnt vmcnt(15)
    s_barrier
    v_mfma_f32_16x16x32_bf16 v[168:171], v[72:75], a[100:103], v[168:171]
    ds_read_b64_tr_b16 v[64:65], v40 offset:28672
    v_cvt_pk_bf16_f32 v52, v34, v35
    v_mfma_f32_16x16x32_bf16 v[176:179], v[72:75], a[104:107], v[176:179]
    ds_read_b64_tr_b16 v[66:67], v40 offset:29184
    v_mul_f32 v36, s95, v202
    v_mfma_f32_16x16x32_bf16 v[184:187], v[72:75], a[108:111], v[184:187]
    v_exp_f32 v36, v36
    v_mfma_f32_16x16x32_bf16 v[164:167], v[76:79], a[96:99], v[164:167]
    ds_read_b64_tr_b16 v[68:69], v42 offset:28672
    v_mul_f32 v37, s95, v203
    v_mfma_f32_16x16x32_bf16 v[172:175], v[76:79], a[100:103], v[172:175]
    v_exp_f32 v37, v37
    v_mfma_f32_16x16x32_bf16 v[180:183], v[76:79], a[104:107], v[180:183]
    ds_read_b64_tr_b16 v[70:71], v42 offset:29184
    v_add_f32 v36, 1.0, v36
    v_mfma_f32_16x16x32_bf16 v[188:191], v[76:79], a[108:111], v[188:191]
    v_add_f32 v37, 1.0, v37
    s_waitcnt lgkmcnt(4)
    v_mfma_f32_16x16x32_bf16 v[128:131], v[80:83], a[112:115], v[128:131]
    v_rcp_f32 v36, v36
    v_mfma_f32_16x16x32_bf16 v[136:139], v[80:83], a[116:119], v[136:139]
    v_rcp_f32 v37, v37
    v_mfma_f32_16x16x32_bf16 v[144:147], v[80:83], a[120:123], v[144:147]
    ds_read_b64_tr_b16 v[72:73], v40 offset:30720
    v_mul_f32 v38, v202, v234
    v_mfma_f32_16x16x32_bf16 v[152:155], v[80:83], a[124:127], v[152:155]
    ds_read_b64_tr_b16 v[74:75], v40 offset:31232
    v_mul_f32 v39, v203, v235
    v_mfma_f32_16x16x32_bf16 v[132:135], v[84:87], a[112:115], v[132:135]
    ds_read_b64_tr_b16 v[76:77], v42 offset:30720
    v_mul_f32 v38, v38, v36
    v_mfma_f32_16x16x32_bf16 v[140:143], v[84:87], a[116:119], v[140:143]
    ds_read_b64_tr_b16 v[78:79], v42 offset:31232
    v_mul_f32 v39, v39, v37
    v_mfma_f32_16x16x32_bf16 v[148:151], v[84:87], a[120:123], v[148:151]
    v_cvt_pk_bf16_f32 v53, v38, v39
    v_mul_f32 v32, s95, v204
    v_mfma_f32_16x16x32_bf16 v[156:159], v[84:87], a[124:127], v[156:159]
    v_exp_f32 v32, v32
    v_mfma_f32_16x16x32_bf16 v[160:163], v[88:91], a[112:115], v[160:163]
    ds_read_b64_tr_b16 v[80:81], v41 offset:28672
    v_mul_f32 v33, s95, v205
    v_mfma_f32_16x16x32_bf16 v[168:171], v[88:91], a[116:119], v[168:171]
    v_exp_f32 v33, v33
    v_mfma_f32_16x16x32_bf16 v[176:179], v[88:91], a[120:123], v[176:179]
    ds_read_b64_tr_b16 v[82:83], v41 offset:29184
    v_add_f32 v32, 1.0, v32
    v_mfma_f32_16x16x32_bf16 v[184:187], v[88:91], a[124:127], v[184:187]
    v_rcp_f32 v32, v32
    v_mfma_f32_16x16x32_bf16 v[164:167], v[92:95], a[112:115], v[164:167]
    ds_read_b64_tr_b16 v[84:85], v43 offset:28672
    v_add_f32 v33, 1.0, v33
    v_mfma_f32_16x16x32_bf16 v[172:175], v[92:95], a[116:119], v[172:175]
    v_rcp_f32 v33, v33
    v_mfma_f32_16x16x32_bf16 v[180:183], v[92:95], a[120:123], v[180:183]
    ds_read_b64_tr_b16 v[86:87], v43 offset:29184
    v_mul_f32 v34, v204, v236
    v_mfma_f32_16x16x32_bf16 v[188:191], v[92:95], a[124:127], v[188:191]
    v_mul_f32 v35, v205, v237
    s_waitcnt lgkmcnt(4)
    v_mfma_f32_16x16x32_bf16 v[128:131], v[64:67], a[128:131], v[128:131]
    s_add_u32 s55, s96, 4096
    ds_read_b64_tr_b16 v[88:89], v41 offset:30720
    v_mfma_f32_16x16x32_bf16 v[136:139], v[64:67], a[132:135], v[136:139]
    buffer_load_dword v26, v1, s[64:67], s55 offen
    v_mfma_f32_16x16x32_bf16 v[144:147], v[64:67], a[136:139], v[144:147]
    ds_read_b64_tr_b16 v[90:91], v41 offset:31232
    v_mul_f32 v34, v34, v32
    v_mfma_f32_16x16x32_bf16 v[152:155], v[64:67], a[140:143], v[152:155]
    v_mul_f32 v35, v35, v33
    v_cvt_pk_bf16_f32 v54, v34, v35
    v_mfma_f32_16x16x32_bf16 v[132:135], v[68:71], a[128:131], v[132:135]
    ds_read_b64_tr_b16 v[92:93], v43 offset:30720
    v_mul_f32 v36, s95, v206
    v_mfma_f32_16x16x32_bf16 v[140:143], v[68:71], a[132:135], v[140:143]
    v_exp_f32 v36, v36
    v_mfma_f32_16x16x32_bf16 v[148:151], v[68:71], a[136:139], v[148:151]
    ds_read_b64_tr_b16 v[94:95], v43 offset:31232
    v_mul_f32 v37, s95, v207
    v_mfma_f32_16x16x32_bf16 v[156:159], v[68:71], a[140:143], v[156:159]
    v_exp_f32 v37, v37
    v_mfma_f32_16x16x32_bf16 v[160:163], v[72:75], a[128:131], v[160:163]
    s_waitcnt vmcnt(3)
    s_barrier
    v_mfma_f32_16x16x32_bf16 v[168:171], v[72:75], a[132:135], v[168:171]
    ds_read_b64_tr_b16 v[64:65], v40 offset:16384
    v_add_f32 v36, 1.0, v36
    v_mfma_f32_16x16x32_bf16 v[176:179], v[72:75], a[136:139], v[176:179]
    v_rcp_f32 v36, v36
    v_mfma_f32_16x16x32_bf16 v[184:187], v[72:75], a[140:143], v[184:187]
    ds_read_b64_tr_b16 v[66:67], v40 offset:16896
    v_add_f32 v37, 1.0, v37
    v_mfma_f32_16x16x32_bf16 v[164:167], v[76:79], a[128:131], v[164:167]
    v_rcp_f32 v37, v37
    v_mfma_f32_16x16x32_bf16 v[172:175], v[76:79], a[132:135], v[172:175]
    ds_read_b64_tr_b16 v[68:69], v42 offset:16384
    v_mul_f32 v38, v206, v238
    v_mfma_f32_16x16x32_bf16 v[180:183], v[76:79], a[136:139], v[180:183]
    ds_read_b64_tr_b16 v[70:71], v42 offset:16896
    v_mul_f32 v39, v207, v239
    v_mfma_f32_16x16x32_bf16 v[188:191], v[76:79], a[140:143], v[188:191]
    v_mul_f32 v38, v38, v36
    s_waitcnt lgkmcnt(4)
    v_mfma_f32_16x16x32_bf16 v[128:131], v[80:83], a[144:147], v[128:131]
    global_load_dword v19, v[20:21], off
    v_mfma_f32_16x16x32_bf16 v[136:139], v[80:83], a[148:151], v[136:139]
    ds_read_b64_tr_b16 v[72:73], v40 offset:18432
    v_mul_f32 v39, v39, v37
    v_mfma_f32_16x16x32_bf16 v[144:147], v[80:83], a[152:155], v[144:147]
    s_add_u32 s16, s94, 50176
    ds_read_b64_tr_b16 v[74:75], v40 offset:18944
    v_mfma_f32_16x16x32_bf16 v[152:155], v[80:83], a[156:159], v[152:155]
    v_cvt_pk_bf16_f32 v55, v38, v39
    v_mul_f32 v32, s95, v208
    v_mfma_f32_16x16x32_bf16 v[132:135], v[84:87], a[144:147], v[132:135]
    buffer_store_dwordx4 v[52:55], v22, s[68:71], s16 offen sc1
    ds_read_b64_tr_b16 v[76:77], v42 offset:18432
    v_mfma_f32_16x16x32_bf16 v[140:143], v[84:87], a[148:151], v[140:143]
    v_exp_f32 v32, v32
    v_mfma_f32_16x16x32_bf16 v[148:151], v[84:87], a[152:155], v[148:151]
    ds_read_b64_tr_b16 v[78:79], v42 offset:18944
    v_mul_f32 v33, s95, v209
    v_mfma_f32_16x16x32_bf16 v[156:159], v[84:87], a[156:159], v[156:159]
    v_exp_f32 v33, v33
    v_mfma_f32_16x16x32_bf16 v[160:163], v[88:91], a[144:147], v[160:163]
    ds_read_b64_tr_b16 v[80:81], v41 offset:16384
    v_add_f32 v32, 1.0, v32
    v_mfma_f32_16x16x32_bf16 v[168:171], v[88:91], a[148:151], v[168:171]
    v_rcp_f32 v32, v32
    v_mfma_f32_16x16x32_bf16 v[176:179], v[88:91], a[152:155], v[176:179]
    ds_read_b64_tr_b16 v[82:83], v41 offset:16896
    v_add_f32 v33, 1.0, v33
    v_mfma_f32_16x16x32_bf16 v[184:187], v[88:91], a[156:159], v[184:187]
    v_rcp_f32 v33, v33
    v_mfma_f32_16x16x32_bf16 v[164:167], v[92:95], a[144:147], v[164:167]
    ds_read_b64_tr_b16 v[84:85], v43 offset:16384
    v_mul_f32 v34, v208, v240
    v_mfma_f32_16x16x32_bf16 v[172:175], v[92:95], a[148:151], v[172:175]
    ds_read_b64_tr_b16 v[86:87], v43 offset:16896
    v_mul_f32 v35, v209, v241
    v_mfma_f32_16x16x32_bf16 v[180:183], v[92:95], a[152:155], v[180:183]
    v_mul_f32 v34, v34, v32
    v_mul_f32 v35, v35, v33
    v_mfma_f32_16x16x32_bf16 v[188:191], v[92:95], a[156:159], v[188:191]
    v_cvt_pk_bf16_f32 v56, v34, v35
    s_waitcnt lgkmcnt(4)
    v_mfma_f32_16x16x32_bf16 v[128:131], v[64:67], a[160:163], v[128:131]
    s_add_u32 s55, s96, 87040
    ds_read_b64_tr_b16 v[88:89], v41 offset:18432
    v_mfma_f32_16x16x32_bf16 v[136:139], v[64:67], a[164:167], v[136:139]
    buffer_load_dword v26, v1, s[60:63], s55 offen
    v_mfma_f32_16x16x32_bf16 v[144:147], v[64:67], a[168:171], v[144:147]
    ds_read_b64_tr_b16 v[90:91], v41 offset:18944
    v_mul_f32 v36, s95, v210
    v_mfma_f32_16x16x32_bf16 v[152:155], v[64:67], a[172:175], v[152:155]
    v_exp_f32 v36, v36
    v_mfma_f32_16x16x32_bf16 v[132:135], v[68:71], a[160:163], v[132:135]
    ds_read_b64_tr_b16 v[92:93], v43 offset:18432
    v_mul_f32 v37, s95, v211
    v_mfma_f32_16x16x32_bf16 v[140:143], v[68:71], a[164:167], v[140:143]
    v_exp_f32 v37, v37
    v_mfma_f32_16x16x32_bf16 v[148:151], v[68:71], a[168:171], v[148:151]
    ds_read_b64_tr_b16 v[94:95], v43 offset:18944
    v_add_f32 v36, 1.0, v36
    v_mfma_f32_16x16x32_bf16 v[156:159], v[68:71], a[172:175], v[156:159]
    v_rcp_f32 v36, v36
    v_mfma_f32_16x16x32_bf16 v[160:163], v[72:75], a[160:163], v[160:163]
    ds_read_b64_tr_b16 v[64:65], v40 offset:20480
    v_add_f32 v37, 1.0, v37
    v_mfma_f32_16x16x32_bf16 v[168:171], v[72:75], a[164:167], v[168:171]
    v_rcp_f32 v37, v37
    v_mfma_f32_16x16x32_bf16 v[176:179], v[72:75], a[168:171], v[176:179]
    ds_read_b64_tr_b16 v[66:67], v40 offset:20992
    v_mul_f32 v38, v210, v242
    v_mfma_f32_16x16x32_bf16 v[184:187], v[72:75], a[172:175], v[184:187]
    v_mul_f32 v39, v211, v243
    v_mul_f32 v38, v38, v36
    v_mfma_f32_16x16x32_bf16 v[164:167], v[76:79], a[160:163], v[164:167]
    ds_read_b64_tr_b16 v[68:69], v42 offset:20480
    v_mul_f32 v39, v39, v37
    v_mfma_f32_16x16x32_bf16 v[172:175], v[76:79], a[164:167], v[172:175]
    ds_read_b64_tr_b16 v[70:71], v42 offset:20992
    v_cvt_pk_bf16_f32 v57, v38, v39
    v_mfma_f32_16x16x32_bf16 v[180:183], v[76:79], a[168:171], v[180:183]
    v_mul_f32 v32, s95, v212
    v_mul_f32 v33, s95, v213
    v_mfma_f32_16x16x32_bf16 v[188:191], v[76:79], a[172:175], v[188:191]
    v_mul_f32 v34, v212, v244
    s_waitcnt lgkmcnt(4)
    v_mfma_f32_16x16x32_bf16 v[128:131], v[80:83], a[176:179], v[128:131]
    s_add_u32 s55, s96, 87040
    ds_read_b64_tr_b16 v[72:73], v40 offset:22528
    v_mfma_f32_16x16x32_bf16 v[136:139], v[80:83], a[180:183], v[136:139]
    buffer_load_dword v26, v1, s[64:67], s55 offen
    v_mfma_f32_16x16x32_bf16 v[144:147], v[80:83], a[184:187], v[144:147]
    v_exp_f32 v32, v32
    v_mfma_f32_16x16x32_bf16 v[152:155], v[80:83], a[188:191], v[152:155]
    ds_read_b64_tr_b16 v[74:75], v40 offset:23040
    v_add_f32 v32, 1.0, v32
    v_mfma_f32_16x16x32_bf16 v[132:135], v[84:87], a[176:179], v[132:135]
    v_exp_f32 v33, v33
    v_mfma_f32_16x16x32_bf16 v[140:143], v[84:87], a[180:183], v[140:143]
    v_rcp_f32 v32, v32
    v_mfma_f32_16x16x32_bf16 v[148:151], v[84:87], a[184:187], v[148:151]
    ds_read_b64_tr_b16 v[76:77], v42 offset:22528
    v_add_f32 v33, 1.0, v33
    v_mfma_f32_16x16x32_bf16 v[156:159], v[84:87], a[188:191], v[156:159]
    ds_read_b64_tr_b16 v[78:79], v42 offset:23040
    v_mul_f32 v35, v213, v245
    v_mfma_f32_16x16x32_bf16 v[160:163], v[88:91], a[176:179], v[160:163]
    v_rcp_f32 v33, v33
    v_mfma_f32_16x16x32_bf16 v[168:171], v[88:91], a[180:183], v[168:171]
    ds_read_b64_tr_b16 v[80:81], v41 offset:20480
    v_mul_f32 v34, v34, v32
    v_mfma_f32_16x16x32_bf16 v[176:179], v[88:91], a[184:187], v[176:179]
    ds_read_b64_tr_b16 v[82:83], v41 offset:20992
    v_mul_f32 v35, v35, v33
    v_mfma_f32_16x16x32_bf16 v[184:187], v[88:91], a[188:191], v[184:187]
    v_cvt_pk_bf16_f32 v58, v34, v35
    v_mul_f32 v36, s95, v214
    v_mfma_f32_16x16x32_bf16 v[164:167], v[92:95], a[176:179], v[164:167]
    v_exp_f32 v36, v36
    v_mfma_f32_16x16x32_bf16 v[172:175], v[92:95], a[180:183], v[172:175]
    ds_read_b64_tr_b16 v[84:85], v43 offset:20480
    v_mul_f32 v37, s95, v215
    v_mfma_f32_16x16x32_bf16 v[180:183], v[92:95], a[184:187], v[180:183]
    v_exp_f32 v37, v37
    v_mfma_f32_16x16x32_bf16 v[188:191], v[92:95], a[188:191], v[188:191]
    ds_read_b64_tr_b16 v[86:87], v43 offset:20992
    s_waitcnt lgkmcnt(4)
    v_mfma_f32_16x16x32_bf16 v[128:131], v[64:67], a[192:195], v[128:131]
    s_add_u32 s55, s42, 36864
    v_and_b32 v6, 15, v0
    v_mfma_f32_16x16x32_bf16 v[136:139], v[64:67], a[196:199], v[136:139]
    buffer_load_dword v26, v27, s[72:75], s55 offen
    v_mfma_f32_16x16x32_bf16 v[144:147], v[64:67], a[200:203], v[144:147]
    ds_read_b64_tr_b16 v[88:89], v41 offset:22528
    v_lshlrev_b32 v6, 7, v6
    v_mfma_f32_16x16x32_bf16 v[152:155], v[64:67], a[204:207], v[152:155]
    s_lshl_b32 s17, s99, 12
    ds_read_b64_tr_b16 v[90:91], v41 offset:23040
    v_mfma_f32_16x16x32_bf16 v[132:135], v[68:71], a[192:195], v[132:135]
    s_add_u32 s17, s17, s76
    ds_read_b64_tr_b16 v[92:93], v43 offset:22528
    v_mfma_f32_16x16x32_bf16 v[140:143], v[68:71], a[196:199], v[140:143]
    ds_read_b64_tr_b16 v[94:95], v43 offset:23040
    v_add_f32 v36, 1.0, v36
    v_mfma_f32_16x16x32_bf16 v[148:151], v[68:71], a[200:203], v[148:151]
    v_rcp_f32 v36, v36
    v_mfma_f32_16x16x32_bf16 v[156:159], v[68:71], a[204:207], v[156:159]
    v_add_f32 v37, 1.0, v37
    v_mul_f32 v38, v214, v246
    v_mfma_f32_16x16x32_bf16 v[160:163], v[72:75], a[192:195], v[160:163]
    v_rcp_f32 v37, v37
    v_mfma_f32_16x16x32_bf16 v[168:171], v[72:75], a[196:199], v[168:171]
    ds_read_b64_tr_b16 v[64:65], v40 offset:32768
    v_mul_f32 v39, v215, v247
    v_mfma_f32_16x16x32_bf16 v[176:179], v[72:75], a[200:203], v[176:179]
    ds_read_b64_tr_b16 v[66:67], v40 offset:33280
    v_mul_f32 v38, v38, v36
    v_mfma_f32_16x16x32_bf16 v[184:187], v[72:75], a[204:207], v[184:187]
    v_mul_f32 v39, v39, v37
    s_add_u32 s16, s94, 417792
    v_mfma_f32_16x16x32_bf16 v[164:167], v[76:79], a[192:195], v[164:167]
    ds_read_b64_tr_b16 v[68:69], v42 offset:32768
    v_cvt_pk_bf16_f32 v59, v38, v39
    v_mfma_f32_16x16x32_bf16 v[172:175], v[76:79], a[196:199], v[172:175]
    buffer_store_dwordx4 v[56:59], v22, s[68:71], s16 offen sc1
    ds_read_b64_tr_b16 v[70:71], v42 offset:33280
    v_mfma_f32_16x16x32_bf16 v[180:183], v[76:79], a[200:203], v[180:183]
    v_mul_f32 v32, s95, v216
    v_mul_f32 v33, s95, v217
    v_mfma_f32_16x16x32_bf16 v[188:191], v[76:79], a[204:207], v[188:191]
    v_mul_f32 v34, v216, v248
    s_waitcnt lgkmcnt(4)
    v_mfma_f32_16x16x32_bf16 v[128:131], v[80:83], a[208:211], v[128:131]
    s_add_u32 s55, s42, 589824
    ds_read_b64_tr_b16 v[72:73], v40 offset:34816
    v_mfma_f32_16x16x32_bf16 v[136:139], v[80:83], a[212:215], v[136:139]
    buffer_load_dword v26, v27, s[72:75], s55 offen
    v_mfma_f32_16x16x32_bf16 v[144:147], v[80:83], a[216:219], v[144:147]
    v_exp_f32 v32, v32
    v_mfma_f32_16x16x32_bf16 v[152:155], v[80:83], a[220:223], v[152:155]
    ds_read_b64_tr_b16 v[74:75], v40 offset:35328
    v_add_f32 v32, 1.0, v32
    v_mfma_f32_16x16x32_bf16 v[132:135], v[84:87], a[208:211], v[132:135]
    v_exp_f32 v33, v33
    v_mfma_f32_16x16x32_bf16 v[140:143], v[84:87], a[212:215], v[140:143]
    v_rcp_f32 v32, v32
    v_mfma_f32_16x16x32_bf16 v[148:151], v[84:87], a[216:219], v[148:151]
    ds_read_b64_tr_b16 v[76:77], v42 offset:34816
    v_add_f32 v33, 1.0, v33
    v_mfma_f32_16x16x32_bf16 v[156:159], v[84:87], a[220:223], v[156:159]
    ds_read_b64_tr_b16 v[78:79], v42 offset:35328
    v_mul_f32 v35, v217, v249
    v_mfma_f32_16x16x32_bf16 v[160:163], v[88:91], a[208:211], v[160:163]
    v_rcp_f32 v33, v33
    v_mfma_f32_16x16x32_bf16 v[168:171], v[88:91], a[212:215], v[168:171]
    ds_read_b64_tr_b16 v[80:81], v41 offset:32768
    v_mul_f32 v34, v34, v32
    v_mfma_f32_16x16x32_bf16 v[176:179], v[88:91], a[216:219], v[176:179]
    ds_read_b64_tr_b16 v[82:83], v41 offset:33280
    v_mul_f32 v35, v35, v33
    v_mfma_f32_16x16x32_bf16 v[184:187], v[88:91], a[220:223], v[184:187]
    v_cvt_pk_bf16_f32 v60, v34, v35
    v_mul_f32 v36, s95, v218
    v_mfma_f32_16x16x32_bf16 v[164:167], v[92:95], a[208:211], v[164:167]
    v_exp_f32 v36, v36
    v_mfma_f32_16x16x32_bf16 v[172:175], v[92:95], a[212:215], v[172:175]
    ds_read_b64_tr_b16 v[84:85], v43 offset:32768
    v_mul_f32 v37, s95, v219
    v_mfma_f32_16x16x32_bf16 v[180:183], v[92:95], a[216:219], v[180:183]
    v_exp_f32 v37, v37
    v_mfma_f32_16x16x32_bf16 v[188:191], v[92:95], a[220:223], v[188:191]
    ds_read_b64_tr_b16 v[86:87], v43 offset:33280
    s_waitcnt lgkmcnt(4)
    v_mfma_f32_16x16x32_bf16 v[128:131], v[64:67], a[224:227], v[128:131]
    s_add_u32 s55, s42, 626688
    ds_read_b64_tr_b16 v[88:89], v41 offset:34816
    v_mfma_f32_16x16x32_bf16 v[136:139], v[64:67], a[228:231], v[136:139]
    buffer_load_dword v26, v27, s[72:75], s55 offen
    v_mfma_f32_16x16x32_bf16 v[144:147], v[64:67], a[232:235], v[144:147]
    ds_read_b64_tr_b16 v[90:91], v41 offset:35328
    v_add_f32 v36, 1.0, v36
    v_mfma_f32_16x16x32_bf16 v[152:155], v[64:67], a[236:239], v[152:155]
    v_rcp_f32 v36, v36
    v_mfma_f32_16x16x32_bf16 v[132:135], v[68:71], a[224:227], v[132:135]
    ds_read_b64_tr_b16 v[92:93], v43 offset:34816
    v_add_f32 v37, 1.0, v37
    v_mfma_f32_16x16x32_bf16 v[140:143], v[68:71], a[228:231], v[140:143]
    v_rcp_f32 v37, v37
    v_mfma_f32_16x16x32_bf16 v[148:151], v[68:71], a[232:235], v[148:151]
    ds_read_b64_tr_b16 v[94:95], v43 offset:35328
    v_mul_f32 v38, v218, v250
    v_mfma_f32_16x16x32_bf16 v[156:159], v[68:71], a[236:239], v[156:159]
    v_mul_f32 v39, v219, v251
    v_mul_f32 v38, v38, v36
    v_mfma_f32_16x16x32_bf16 v[160:163], v[72:75], a[224:227], v[160:163]
    ds_read_b64_tr_b16 v[64:65], v40 offset:36864
    v_mul_f32 v39, v39, v37
    v_mfma_f32_16x16x32_bf16 v[168:171], v[72:75], a[228:231], v[168:171]
    ds_read_b64_tr_b16 v[66:67], v40 offset:37376
    v_cvt_pk_bf16_f32 v61, v38, v39
    v_mfma_f32_16x16x32_bf16 v[176:179], v[72:75], a[232:235], v[176:179]
    v_mul_f32 v32, s95, v220
    v_mul_f32 v33, s95, v221
    v_mfma_f32_16x16x32_bf16 v[184:187], v[72:75], a[236:239], v[184:187]
    v_exp_f32 v32, v32
    v_mfma_f32_16x16x32_bf16 v[164:167], v[76:79], a[224:227], v[164:167]
    v_exp_f32 v33, v33
    v_mfma_f32_16x16x32_bf16 v[172:175], v[76:79], a[228:231], v[172:175]
    ds_read_b64_tr_b16 v[68:69], v42 offset:36864
    v_add_f32 v32, 1.0, v32
    v_mfma_f32_16x16x32_bf16 v[180:183], v[76:79], a[232:235], v[180:183]
    v_rcp_f32 v32, v32
    v_mfma_f32_16x16x32_bf16 v[188:191], v[76:79], a[236:239], v[188:191]
    ds_read_b64_tr_b16 v[70:71], v42 offset:37376
    s_waitcnt lgkmcnt(4)
    v_mfma_f32_16x16x32_bf16 v[128:131], v[80:83], a[240:243], v[128:131]
    s_add_u32 s55, s43, 0
    ds_read_b64_tr_b16 v[72:73], v40 offset:38912
    v_mfma_f32_16x16x32_bf16 v[136:139], v[80:83], a[244:247], v[136:139]
    buffer_load_dword v26, v27, s[72:75], s55 offen
    v_mfma_f32_16x16x32_bf16 v[144:147], v[80:83], a[248:251], v[144:147]
    ds_read_b64_tr_b16 v[74:75], v40 offset:39424
    v_add_f32 v33, 1.0, v33
    v_mfma_f32_16x16x32_bf16 v[152:155], v[80:83], a[252:255], v[152:155]
    v_rcp_f32 v33, v33
    v_mfma_f32_16x16x32_bf16 v[132:135], v[84:87], a[240:243], v[132:135]
    ds_read_b64_tr_b16 v[76:77], v42 offset:38912
    v_mul_f32 v34, v220, v252
    v_mfma_f32_16x16x32_bf16 v[140:143], v[84:87], a[244:247], v[140:143]
    ds_read_b64_tr_b16 v[78:79], v42 offset:39424
    v_mul_f32 v35, v221, v253
    v_mfma_f32_16x16x32_bf16 v[148:151], v[84:87], a[248:251], v[148:151]
    s_branch L_sskip3
L_stub3:
    s_branch L_stub7
L_sskip3:
    v_mul_f32 v34, v34, v32
    v_mul_f32 v35, v35, v33
    v_mfma_f32_16x16x32_bf16 v[156:159], v[84:87], a[252:255], v[156:159]
    v_cvt_pk_bf16_f32 v62, v34, v35
    v_mul_f32 v36, s95, v222
    v_mfma_f32_16x16x32_bf16 v[160:163], v[88:91], a[240:243], v[160:163]
    v_exp_f32 v36, v36
    v_mfma_f32_16x16x32_bf16 v[168:171], v[88:91], a[244:247], v[168:171]
    ds_read_b64_tr_b16 v[80:81], v41 offset:36864
    v_mul_f32 v37, s95, v223
    v_mfma_f32_16x16x32_bf16 v[176:179], v[88:91], a[248:251], v[176:179]
    v_exp_f32 v37, v37
    v_mfma_f32_16x16x32_bf16 v[184:187], v[88:91], a[252:255], v[184:187]
    ds_read_b64_tr_b16 v[82:83], v41 offset:37376
    v_add_f32 v36, 1.0, v36
    v_mfma_f32_16x16x32_bf16 v[164:167], v[92:95], a[240:243], v[164:167]
    v_rcp_f32 v36, v36
    v_mfma_f32_16x16x32_bf16 v[172:175], v[92:95], a[244:247], v[172:175]
    ds_read_b64_tr_b16 v[84:85], v43 offset:36864
    v_add_f32 v37, 1.0, v37
    v_mfma_f32_16x16x32_bf16 v[180:183], v[92:95], a[248:251], v[180:183]
    v_rcp_f32 v37, v37
    v_mfma_f32_16x16x32_bf16 v[188:191], v[92:95], a[252:255], v[188:191]
    ds_read_b64_tr_b16 v[86:87], v43 offset:37376
    s_waitcnt lgkmcnt(4)
    v_mfma_f32_16x16x32_bf16 v[128:131], v[64:67], v[96:99], v[128:131]
    s_add_u32 s55, s43, 36864
    ds_read_b64_tr_b16 v[88:89], v41 offset:38912
    v_mfma_f32_16x16x32_bf16 v[136:139], v[64:67], v[100:103], v[136:139]
    buffer_load_dword v26, v27, s[72:75], s55 offen
    v_mfma_f32_16x16x32_bf16 v[144:147], v[64:67], v[104:107], v[144:147]
    ds_read_b64_tr_b16 v[90:91], v41 offset:39424
    v_mul_f32 v38, v222, v254
    v_mfma_f32_16x16x32_bf16 v[152:155], v[64:67], v[108:111], v[152:155]
    v_mul_f32 v39, v223, v255
    v_mul_f32 v38, v38, v36
    v_mfma_f32_16x16x32_bf16 v[132:135], v[68:71], v[96:99], v[132:135]
    ds_read_b64_tr_b16 v[92:93], v43 offset:38912
    v_mul_f32 v39, v39, v37
    v_mfma_f32_16x16x32_bf16 v[140:143], v[68:71], v[100:103], v[140:143]
    s_add_u32 s16, s94, 418816
    ds_read_b64_tr_b16 v[94:95], v43 offset:39424
    v_mfma_f32_16x16x32_bf16 v[148:151], v[68:71], v[104:107], v[148:151]
    v_cvt_pk_bf16_f32 v63, v38, v39
    v_mfma_f32_16x16x32_bf16 v[156:159], v[68:71], v[108:111], v[156:159]
    buffer_store_dwordx4 v[60:63], v22, s[68:71], s16 offen sc1
    v_mfma_f32_16x16x32_bf16 v[160:163], v[72:75], v[96:99], v[160:163]
    ds_read_b64_tr_b16 v[64:65], v44 offset:0
    v_mfma_f32_16x16x32_bf16 v[168:171], v[72:75], v[100:103], v[168:171]
    ds_read_b64_tr_b16 v[66:67], v44 offset:512
    v_mfma_f32_16x16x32_bf16 v[176:179], v[72:75], v[104:107], v[176:179]
    v_mfma_f32_16x16x32_bf16 v[184:187], v[72:75], v[108:111], v[184:187]
    v_mfma_f32_16x16x32_bf16 v[164:167], v[76:79], v[96:99], v[164:167]
    ds_read_b64_tr_b16 v[68:69], v46 offset:0
    v_mfma_f32_16x16x32_bf16 v[172:175], v[76:79], v[100:103], v[172:175]
    ds_read_b64_tr_b16 v[70:71], v46 offset:512
    v_mfma_f32_16x16x32_bf16 v[180:183], v[76:79], v[104:107], v[180:183]
    v_mfma_f32_16x16x32_bf16 v[188:191], v[76:79], v[108:111], v[188:191]
    s_waitcnt lgkmcnt(4)
    v_mfma_f32_16x16x32_bf16 v[128:131], v[80:83], v[112:115], v[128:131]
    ds_read_b64_tr_b16 v[72:73], v44 offset:2048
    v_mfma_f32_16x16x32_bf16 v[136:139], v[80:83], v[116:119], v[136:139]
    ds_read_b64_tr_b16 v[74:75], v44 offset:2560
    v_mfma_f32_16x16x32_bf16 v[144:147], v[80:83], v[120:123], v[144:147]
    v_mfma_f32_16x16x32_bf16 v[152:155], v[80:83], v[124:127], v[152:155]
    v_mfma_f32_16x16x32_bf16 v[132:135], v[84:87], v[112:115], v[132:135]
    ds_read_b64_tr_b16 v[76:77], v46 offset:2048
    v_mfma_f32_16x16x32_bf16 v[140:143], v[84:87], v[116:119], v[140:143]
    ds_read_b64_tr_b16 v[78:79], v46 offset:2560
    v_mfma_f32_16x16x32_bf16 v[148:151], v[84:87], v[120:123], v[148:151]
    v_mfma_f32_16x16x32_bf16 v[156:159], v[84:87], v[124:127], v[156:159]
    v_mfma_f32_16x16x32_bf16 v[160:163], v[88:91], v[112:115], v[160:163]
    ds_read_b64_tr_b16 v[80:81], v45 offset:0
    v_mfma_f32_16x16x32_bf16 v[168:171], v[88:91], v[116:119], v[168:171]
    ds_read_b64_tr_b16 v[82:83], v45 offset:512
    v_mfma_f32_16x16x32_bf16 v[176:179], v[88:91], v[120:123], v[176:179]
    v_mfma_f32_16x16x32_bf16 v[184:187], v[88:91], v[124:127], v[184:187]
    v_mfma_f32_16x16x32_bf16 v[164:167], v[92:95], v[112:115], v[164:167]
    ds_read_b64_tr_b16 v[84:85], v47 offset:0
    v_mfma_f32_16x16x32_bf16 v[172:175], v[92:95], v[116:119], v[172:175]
    ds_read_b64_tr_b16 v[86:87], v47 offset:512
    v_mfma_f32_16x16x32_bf16 v[180:183], v[92:95], v[120:123], v[180:183]
    v_mfma_f32_16x16x32_bf16 v[188:191], v[92:95], v[124:127], v[188:191]
    s_waitcnt lgkmcnt(4)
    v_mfma_f32_16x16x32_bf16 v[192:195], v[64:67], a[0:3], 0
    ds_read_b64_tr_b16 v[88:89], v45 offset:2048
    v_mfma_f32_16x16x32_bf16 v[200:203], v[64:67], a[4:7], 0
    ds_read_b64_tr_b16 v[90:91], v45 offset:2560
    v_mfma_f32_16x16x32_bf16 v[208:211], v[64:67], a[8:11], 0
    v_mfma_f32_16x16x32_bf16 v[216:219], v[64:67], a[12:15], 0
    v_mfma_f32_16x16x32_bf16 v[196:199], v[68:71], a[0:3], 0
    ds_read_b64_tr_b16 v[92:93], v47 offset:2048
    v_mfma_f32_16x16x32_bf16 v[204:207], v[68:71], a[4:7], 0
    ds_read_b64_tr_b16 v[94:95], v47 offset:2560
    v_mfma_f32_16x16x32_bf16 v[212:215], v[68:71], a[8:11], 0
    v_mfma_f32_16x16x32_bf16 v[220:223], v[68:71], a[12:15], 0
    v_mfma_f32_16x16x32_bf16 v[224:227], v[72:75], a[0:3], 0
    ds_read_b64_tr_b16 v[64:65], v44 offset:4096
    v_mul_f32 v32, s95, v128
    v_mfma_f32_16x16x32_bf16 v[232:235], v[72:75], a[4:7], 0
    v_exp_f32 v32, v32
    v_mfma_f32_16x16x32_bf16 v[240:243], v[72:75], a[8:11], 0
    ds_read_b64_tr_b16 v[66:67], v44 offset:4608
    v_mul_f32 v33, s95, v129
    v_mfma_f32_16x16x32_bf16 v[248:251], v[72:75], a[12:15], 0
    v_exp_f32 v33, v33
    v_mfma_f32_16x16x32_bf16 v[228:231], v[76:79], a[0:3], 0
    ds_read_b64_tr_b16 v[68:69], v46 offset:4096
    v_add_f32 v32, 1.0, v32
    v_mfma_f32_16x16x32_bf16 v[236:239], v[76:79], a[4:7], 0
    v_rcp_f32 v32, v32
    v_mfma_f32_16x16x32_bf16 v[244:247], v[76:79], a[8:11], 0
    ds_read_b64_tr_b16 v[70:71], v46 offset:4608
    v_add_f32 v33, 1.0, v33
    v_mfma_f32_16x16x32_bf16 v[252:255], v[76:79], a[12:15], 0
    v_mul_f32 v34, v128, v160
    s_waitcnt lgkmcnt(4)
    v_mfma_f32_16x16x32_bf16 v[192:195], v[80:83], a[16:19], v[192:195]
    v_rcp_f32 v33, v33
    v_mfma_f32_16x16x32_bf16 v[200:203], v[80:83], a[20:23], v[200:203]
    ds_read_b64_tr_b16 v[72:73], v44 offset:6144
    v_mul_f32 v35, v129, v161
    v_mfma_f32_16x16x32_bf16 v[208:211], v[80:83], a[24:27], v[208:211]
    ds_read_b64_tr_b16 v[74:75], v44 offset:6656
    v_mul_f32 v34, v34, v32
    v_mfma_f32_16x16x32_bf16 v[216:219], v[80:83], a[28:31], v[216:219]
    v_mul_f32 v35, v35, v33
    v_cvt_pk_bf16_f32 v48, v34, v35
    v_mfma_f32_16x16x32_bf16 v[196:199], v[84:87], a[16:19], v[196:199]
    ds_read_b64_tr_b16 v[76:77], v46 offset:6144
    v_mul_f32 v36, s95, v130
    v_mfma_f32_16x16x32_bf16 v[204:207], v[84:87], a[20:23], v[204:207]
    v_exp_f32 v36, v36
    v_mfma_f32_16x16x32_bf16 v[212:215], v[84:87], a[24:27], v[212:215]
    ds_read_b64_tr_b16 v[78:79], v46 offset:6656
    v_mul_f32 v37, s95, v131
    v_mfma_f32_16x16x32_bf16 v[220:223], v[84:87], a[28:31], v[220:223]
    v_exp_f32 v37, v37
    v_mfma_f32_16x16x32_bf16 v[224:227], v[88:91], a[16:19], v[224:227]
    ds_read_b64_tr_b16 v[80:81], v45 offset:4096
    v_add_f32 v36, 1.0, v36
    v_mfma_f32_16x16x32_bf16 v[232:235], v[88:91], a[20:23], v[232:235]
    v_rcp_f32 v36, v36
    v_mfma_f32_16x16x32_bf16 v[240:243], v[88:91], a[24:27], v[240:243]
    ds_read_b64_tr_b16 v[82:83], v45 offset:4608
    v_add_f32 v37, 1.0, v37
    v_mfma_f32_16x16x32_bf16 v[248:251], v[88:91], a[28:31], v[248:251]
    v_rcp_f32 v37, v37
    v_mfma_f32_16x16x32_bf16 v[228:231], v[92:95], a[16:19], v[228:231]
    ds_read_b64_tr_b16 v[84:85], v47 offset:4096
    v_mul_f32 v38, v130, v162
    v_mfma_f32_16x16x32_bf16 v[236:239], v[92:95], a[20:23], v[236:239]
    ds_read_b64_tr_b16 v[86:87], v47 offset:4608
    v_mul_f32 v39, v131, v163
    v_mfma_f32_16x16x32_bf16 v[244:247], v[92:95], a[24:27], v[244:247]
    v_mul_f32 v38, v38, v36
    v_mul_f32 v39, v39, v37
    v_mfma_f32_16x16x32_bf16 v[252:255], v[92:95], a[28:31], v[252:255]
    v_cvt_pk_bf16_f32 v49, v38, v39
    s_waitcnt lgkmcnt(4)
    v_mfma_f32_16x16x32_bf16 v[192:195], v[64:67], a[32:35], v[192:195]
    ds_read_b64_tr_b16 v[88:89], v45 offset:6144
    v_mul_f32 v32, s95, v132
    v_mfma_f32_16x16x32_bf16 v[200:203], v[64:67], a[36:39], v[200:203]
    v_exp_f32 v32, v32
    v_mfma_f32_16x16x32_bf16 v[208:211], v[64:67], a[40:43], v[208:211]
    ds_read_b64_tr_b16 v[90:91], v45 offset:6656
    v_mul_f32 v33, s95, v133
    v_mfma_f32_16x16x32_bf16 v[216:219], v[64:67], a[44:47], v[216:219]
    v_exp_f32 v33, v33
    v_mfma_f32_16x16x32_bf16 v[196:199], v[68:71], a[32:35], v[196:199]
    ds_read_b64_tr_b16 v[92:93], v47 offset:6144
    v_add_f32 v32, 1.0, v32
    v_mfma_f32_16x16x32_bf16 v[204:207], v[68:71], a[36:39], v[204:207]
    v_rcp_f32 v32, v32
    v_mfma_f32_16x16x32_bf16 v[212:215], v[68:71], a[40:43], v[212:215]
    ds_read_b64_tr_b16 v[94:95], v47 offset:6656
    v_add_f32 v33, 1.0, v33
    v_mfma_f32_16x16x32_bf16 v[220:223], v[68:71], a[44:47], v[220:223]
    v_rcp_f32 v33, v33
    v_mfma_f32_16x16x32_bf16 v[224:227], v[72:75], a[32:35], v[224:227]
    ds_read_b64_tr_b16 v[64:65], v44 offset:8192
    v_mul_f32 v34, v132, v164
    v_mfma_f32_16x16x32_bf16 v[232:235], v[72:75], a[36:39], v[232:235]
    ds_read_b64_tr_b16 v[66:67], v44 offset:8704
    v_mul_f32 v35, v133, v165
    v_mfma_f32_16x16x32_bf16 v[240:243], v[72:75], a[40:43], v[240:243]
    v_mul_f32 v34, v34, v32
    v_mul_f32 v35, v35, v33
    v_mfma_f32_16x16x32_bf16 v[248:251], v[72:75], a[44:47], v[248:251]
    v_cvt_pk_bf16_f32 v50, v34, v35
    v_mul_f32 v36, s95, v134
    v_mfma_f32_16x16x32_bf16 v[228:231], v[76:79], a[32:35], v[228:231]
    v_exp_f32 v36, v36
    v_mfma_f32_16x16x32_bf16 v[236:239], v[76:79], a[36:39], v[236:239]
    ds_read_b64_tr_b16 v[68:69], v46 offset:8192
    v_mul_f32 v37, s95, v135
    v_mfma_f32_16x16x32_bf16 v[244:247], v[76:79], a[40:43], v[244:247]
    v_exp_f32 v37, v37
    v_mfma_f32_16x16x32_bf16 v[252:255], v[76:79], a[44:47], v[252:255]
    ds_read_b64_tr_b16 v[70:71], v46 offset:8704
    s_waitcnt lgkmcnt(4)
    v_mfma_f32_16x16x32_bf16 v[192:195], v[80:83], a[48:51], v[192:195]
    ds_read_b64_tr_b16 v[72:73], v44 offset:10240
    v_add_f32 v36, 1.0, v36
    v_mfma_f32_16x16x32_bf16 v[200:203], v[80:83], a[52:55], v[200:203]
    v_rcp_f32 v36, v36
    v_mfma_f32_16x16x32_bf16 v[208:211], v[80:83], a[56:59], v[208:211]
    ds_read_b64_tr_b16 v[74:75], v44 offset:10752
    v_add_f32 v37, 1.0, v37
    v_mfma_f32_16x16x32_bf16 v[216:219], v[80:83], a[60:63], v[216:219]
    v_rcp_f32 v37, v37
    v_mfma_f32_16x16x32_bf16 v[196:199], v[84:87], a[48:51], v[196:199]
    ds_read_b64_tr_b16 v[76:77], v46 offset:10240
    v_mul_f32 v38, v134, v166
    v_mfma_f32_16x16x32_bf16 v[204:207], v[84:87], a[52:55], v[204:207]
    ds_read_b64_tr_b16 v[78:79], v46 offset:10752
    v_mul_f32 v39, v135, v167
    v_mfma_f32_16x16x32_bf16 v[212:215], v[84:87], a[56:59], v[212:215]
    v_mul_f32 v38, v38, v36
    v_mul_f32 v39, v39, v37
    v_mfma_f32_16x16x32_bf16 v[220:223], v[84:87], a[60:63], v[220:223]
    s_add_u32 s16, s94, 98304
    v_cvt_pk_bf16_f32 v51, v38, v39
    v_mfma_f32_16x16x32_bf16 v[224:227], v[88:91], a[48:51], v[224:227]
    buffer_store_dwordx4 v[48:51], v22, s[68:71], s16 offen sc1
    ds_read_b64_tr_b16 v[80:81], v45 offset:8192
    v_mfma_f32_16x16x32_bf16 v[232:235], v[88:91], a[52:55], v[232:235]
    ds_read_b64_tr_b16 v[82:83], v45 offset:8704
    v_mul_f32 v32, s95, v136
    v_mfma_f32_16x16x32_bf16 v[240:243], v[88:91], a[56:59], v[240:243]
    v_exp_f32 v32, v32
    v_mfma_f32_16x16x32_bf16 v[248:251], v[88:91], a[60:63], v[248:251]
    v_mul_f32 v33, s95, v137
    v_add_f32 v32, 1.0, v32
    v_mfma_f32_16x16x32_bf16 v[228:231], v[92:95], a[48:51], v[228:231]
    v_exp_f32 v33, v33
    v_mfma_f32_16x16x32_bf16 v[236:239], v[92:95], a[52:55], v[236:239]
    v_rcp_f32 v32, v32
    v_mfma_f32_16x16x32_bf16 v[244:247], v[92:95], a[56:59], v[244:247]
    ds_read_b64_tr_b16 v[84:85], v47 offset:8192
    v_add_f32 v33, 1.0, v33
    v_mfma_f32_16x16x32_bf16 v[252:255], v[92:95], a[60:63], v[252:255]
    ds_read_b64_tr_b16 v[86:87], v47 offset:8704
    s_waitcnt lgkmcnt(4)
    v_mfma_f32_16x16x32_bf16 v[192:195], v[64:67], a[64:67], v[192:195]
    s_add_u32 s55, s28, 36864
    ds_read_b64_tr_b16 v[88:89], v45 offset:10240
    v_mfma_f32_16x16x32_bf16 v[200:203], v[64:67], a[68:71], v[200:203]
    buffer_load_dword v26, v27, s[72:75], s55 offen
    v_mfma_f32_16x16x32_bf16 v[208:211], v[64:67], a[72:75], v[208:211]
    v_rcp_f32 v33, v33
    v_mfma_f32_16x16x32_bf16 v[216:219], v[64:67], a[76:79], v[216:219]
    ds_read_b64_tr_b16 v[90:91], v45 offset:10752
    v_mul_f32 v34, v136, v168
    v_mfma_f32_16x16x32_bf16 v[196:199], v[68:71], a[64:67], v[196:199]
    ds_read_b64_tr_b16 v[92:93], v47 offset:10240
    v_mul_f32 v35, v137, v169
    v_mfma_f32_16x16x32_bf16 v[204:207], v[68:71], a[68:71], v[204:207]
    ds_read_b64_tr_b16 v[94:95], v47 offset:10752
    v_mul_f32 v34, v34, v32
    v_mfma_f32_16x16x32_bf16 v[212:215], v[68:71], a[72:75], v[212:215]
    v_mul_f32 v35, v35, v33
    v_cvt_pk_bf16_f32 v52, v34, v35
    v_mfma_f32_16x16x32_bf16 v[220:223], v[68:71], a[76:79], v[220:223]
    v_mul_f32 v36, s95, v138
    v_mul_f32 v37, s95, v139
    v_mfma_f32_16x16x32_bf16 v[224:227], v[72:75], a[64:67], v[224:227]
    v_exp_f32 v36, v36
    v_mfma_f32_16x16x32_bf16 v[232:235], v[72:75], a[68:71], v[232:235]
    v_exp_f32 v37, v37
    v_mfma_f32_16x16x32_bf16 v[240:243], v[72:75], a[72:75], v[240:243]
    ds_read_b64_tr_b16 v[64:65], v44 offset:12288
    v_add_f32 v36, 1.0, v36
    v_mfma_f32_16x16x32_bf16 v[248:251], v[72:75], a[76:79], v[248:251]
    ds_read_b64_tr_b16 v[66:67], v44 offset:12800
    v_add_f32 v37, 1.0, v37
    v_mfma_f32_16x16x32_bf16 v[228:231], v[76:79], a[64:67], v[228:231]
    v_rcp_f32 v36, v36
    v_mfma_f32_16x16x32_bf16 v[236:239], v[76:79], a[68:71], v[236:239]
    v_rcp_f32 v37, v37
    v_mfma_f32_16x16x32_bf16 v[244:247], v[76:79], a[72:75], v[244:247]
    ds_read_b64_tr_b16 v[68:69], v46 offset:12288
    v_mul_f32 v38, v138, v170
    v_mfma_f32_16x16x32_bf16 v[252:255], v[76:79], a[76:79], v[252:255]
    ds_read_b64_tr_b16 v[70:71], v46 offset:12800
    s_waitcnt lgkmcnt(4)
    v_mfma_f32_16x16x32_bf16 v[192:195], v[80:83], a[80:83], v[192:195]
    s_add_u32 s55, s28, 589824
    ds_read_b64_tr_b16 v[72:73], v44 offset:14336
    v_mfma_f32_16x16x32_bf16 v[200:203], v[80:83], a[84:87], v[200:203]
    buffer_load_dword v26, v27, s[72:75], s55 offen
    v_mfma_f32_16x16x32_bf16 v[208:211], v[80:83], a[88:91], v[208:211]
    ds_read_b64_tr_b16 v[74:75], v44 offset:14848
    v_mul_f32 v39, v139, v171
    v_mfma_f32_16x16x32_bf16 v[216:219], v[80:83], a[92:95], v[216:219]
    v_mul_f32 v38, v38, v36
    v_mul_f32 v39, v39, v37
    v_mfma_f32_16x16x32_bf16 v[196:199], v[84:87], a[80:83], v[196:199]
    ds_read_b64_tr_b16 v[76:77], v46 offset:14336
    v_cvt_pk_bf16_f32 v53, v38, v39
    v_mfma_f32_16x16x32_bf16 v[204:207], v[84:87], a[84:87], v[204:207]
    ds_read_b64_tr_b16 v[78:79], v46 offset:14848
    v_mul_f32 v32, s95, v140
    v_mfma_f32_16x16x32_bf16 v[212:215], v[84:87], a[88:91], v[212:215]
    v_exp_f32 v32, v32
    v_mfma_f32_16x16x32_bf16 v[220:223], v[84:87], a[92:95], v[220:223]
    v_mul_f32 v33, s95, v141
    v_add_f32 v32, 1.0, v32
    v_mfma_f32_16x16x32_bf16 v[224:227], v[88:91], a[80:83], v[224:227]
    v_exp_f32 v33, v33
    v_mfma_f32_16x16x32_bf16 v[232:235], v[88:91], a[84:87], v[232:235]
    v_rcp_f32 v32, v32
    v_mfma_f32_16x16x32_bf16 v[240:243], v[88:91], a[88:91], v[240:243]
    ds_read_b64_tr_b16 v[80:81], v45 offset:12288
    v_add_f32 v33, 1.0, v33
    v_mfma_f32_16x16x32_bf16 v[248:251], v[88:91], a[92:95], v[248:251]
    ds_read_b64_tr_b16 v[82:83], v45 offset:12800
    v_mul_f32 v34, v140, v172
    v_mfma_f32_16x16x32_bf16 v[228:231], v[92:95], a[80:83], v[228:231]
    v_rcp_f32 v33, v33
    v_mfma_f32_16x16x32_bf16 v[236:239], v[92:95], a[84:87], v[236:239]
    ds_read_b64_tr_b16 v[84:85], v47 offset:12288
    v_mul_f32 v35, v141, v173
    v_mfma_f32_16x16x32_bf16 v[244:247], v[92:95], a[88:91], v[244:247]
    ds_read_b64_tr_b16 v[86:87], v47 offset:12800
    v_mul_f32 v34, v34, v32
    v_mfma_f32_16x16x32_bf16 v[252:255], v[92:95], a[92:95], v[252:255]
    v_mul_f32 v35, v35, v33
    s_waitcnt lgkmcnt(4)
    v_mfma_f32_16x16x32_bf16 v[192:195], v[64:67], a[96:99], v[192:195]
    s_add_u32 s55, s28, 626688
    ds_read_b64_tr_b16 v[88:89], v45 offset:14336
    v_mfma_f32_16x16x32_bf16 v[200:203], v[64:67], a[100:103], v[200:203]
    buffer_load_dword v26, v27, s[72:75], s55 offen
    v_mfma_f32_16x16x32_bf16 v[208:211], v[64:67], a[104:107], v[208:211]
    ds_read_b64_tr_b16 v[90:91], v45 offset:14848
    v_cvt_pk_bf16_f32 v54, v34, v35
    v_mfma_f32_16x16x32_bf16 v[216:219], v[64:67], a[108:111], v[216:219]
    v_mul_f32 v36, s95, v142
    v_mul_f32 v37, s95, v143
    v_mfma_f32_16x16x32_bf16 v[196:199], v[68:71], a[96:99], v[196:199]
    v_exp_f32 v36, v36
    v_mfma_f32_16x16x32_bf16 v[204:207], v[68:71], a[100:103], v[204:207]
    v_exp_f32 v37, v37
    v_mfma_f32_16x16x32_bf16 v[212:215], v[68:71], a[104:107], v[212:215]
    ds_read_b64_tr_b16 v[92:93], v47 offset:14336
    v_add_f32 v36, 1.0, v36
    v_mfma_f32_16x16x32_bf16 v[220:223], v[68:71], a[108:111], v[220:223]
    ds_read_b64_tr_b16 v[94:95], v47 offset:14848
    v_add_f32 v37, 1.0, v37
    v_mfma_f32_16x16x32_bf16 v[224:227], v[72:75], a[96:99], v[224:227]
    s_add_u32 s55, s32, 0
    ds_read_b64_tr_b16 v[64:65], v44 offset:28672
    v_mfma_f32_16x16x32_bf16 v[232:235], v[72:75], a[100:103], v[232:235]
    buffer_load_dword v26, v27, s[72:75], s55 offen
    v_mfma_f32_16x16x32_bf16 v[240:243], v[72:75], a[104:107], v[240:243]
    v_rcp_f32 v36, v36
    v_mfma_f32_16x16x32_bf16 v[248:251], v[72:75], a[108:111], v[248:251]
    ds_read_b64_tr_b16 v[66:67], v44 offset:29184
    v_mul_f32 v38, v142, v174
    v_mfma_f32_16x16x32_bf16 v[228:231], v[76:79], a[96:99], v[228:231]
    v_rcp_f32 v37, v37
    v_mfma_f32_16x16x32_bf16 v[236:239], v[76:79], a[100:103], v[236:239]
    ds_read_b64_tr_b16 v[68:69], v46 offset:28672
    v_mul_f32 v39, v143, v175
    v_mfma_f32_16x16x32_bf16 v[244:247], v[76:79], a[104:107], v[244:247]
    ds_read_b64_tr_b16 v[70:71], v46 offset:29184
    v_mul_f32 v38, v38, v36
    v_mfma_f32_16x16x32_bf16 v[252:255], v[76:79], a[108:111], v[252:255]
    v_mul_f32 v39, v39, v37
    s_waitcnt lgkmcnt(4)
    v_mfma_f32_16x16x32_bf16 v[192:195], v[80:83], a[112:115], v[192:195]
    s_add_u32 s16, s94, 99328
    ds_read_b64_tr_b16 v[72:73], v44 offset:30720
    v_mfma_f32_16x16x32_bf16 v[200:203], v[80:83], a[116:119], v[200:203]
    ds_read_b64_tr_b16 v[74:75], v44 offset:31232
    v_cvt_pk_bf16_f32 v55, v38, v39
    v_mfma_f32_16x16x32_bf16 v[208:211], v[80:83], a[120:123], v[208:211]
    buffer_store_dwordx4 v[52:55], v22, s[68:71], s16 offen sc1
    v_mul_f32 v32, s95, v144
    v_mfma_f32_16x16x32_bf16 v[216:219], v[80:83], a[124:127], v[216:219]
    v_exp_f32 v32, v32
    v_mfma_f32_16x16x32_bf16 v[196:199], v[84:87], a[112:115], v[196:199]
    s_add_u32 s55, s32, 36864
    ds_read_b64_tr_b16 v[76:77], v46 offset:30720
    v_mfma_f32_16x16x32_bf16 v[204:207], v[84:87], a[116:119], v[204:207]
    buffer_load_dword v26, v27, s[72:75], s55 offen
    v_mfma_f32_16x16x32_bf16 v[212:215], v[84:87], a[120:123], v[212:215]
    ds_read_b64_tr_b16 v[78:79], v46 offset:31232
    v_mul_f32 v33, s95, v145
    v_mfma_f32_16x16x32_bf16 v[220:223], v[84:87], a[124:127], v[220:223]
    v_exp_f32 v33, v33
    v_mfma_f32_16x16x32_bf16 v[224:227], v[88:91], a[112:115], v[224:227]
    ds_read_b64_tr_b16 v[80:81], v45 offset:28672
    v_add_f32 v32, 1.0, v32
    v_mfma_f32_16x16x32_bf16 v[232:235], v[88:91], a[116:119], v[232:235]
    v_rcp_f32 v32, v32
    v_mfma_f32_16x16x32_bf16 v[240:243], v[88:91], a[120:123], v[240:243]
    ds_read_b64_tr_b16 v[82:83], v45 offset:29184
    v_add_f32 v33, 1.0, v33
    v_mfma_f32_16x16x32_bf16 v[248:251], v[88:91], a[124:127], v[248:251]
    v_rcp_f32 v33, v33
    v_mfma_f32_16x16x32_bf16 v[228:231], v[92:95], a[112:115], v[228:231]
    ds_read_b64_tr_b16 v[84:85], v47 offset:28672
    v_mul_f32 v34, v144, v176
    v_mfma_f32_16x16x32_bf16 v[236:239], v[92:95], a[116:119], v[236:239]
    ds_read_b64_tr_b16 v[86:87], v47 offset:29184
    v_mul_f32 v35, v145, v177
    v_mfma_f32_16x16x32_bf16 v[244:247], v[92:95], a[120:123], v[244:247]
    v_mul_f32 v34, v34, v32
    v_mul_f32 v35, v35, v33
    v_mfma_f32_16x16x32_bf16 v[252:255], v[92:95], a[124:127], v[252:255]
    v_cvt_pk_bf16_f32 v56, v34, v35
    s_waitcnt lgkmcnt(4)
    v_mfma_f32_16x16x32_bf16 v[192:195], v[64:67], a[128:131], v[192:195]
    global_load_dword v19, v[20:21], off
    v_mfma_f32_16x16x32_bf16 v[200:203], v[64:67], a[132:135], v[200:203]
    ds_read_b64_tr_b16 v[88:89], v45 offset:30720
    v_mul_f32 v36, s95, v146
    v_mfma_f32_16x16x32_bf16 v[208:211], v[64:67], a[136:139], v[208:211]
    v_exp_f32 v36, v36
    v_mfma_f32_16x16x32_bf16 v[216:219], v[64:67], a[140:143], v[216:219]
    ds_read_b64_tr_b16 v[90:91], v45 offset:31232
    v_mul_f32 v37, s95, v147
    v_mfma_f32_16x16x32_bf16 v[196:199], v[68:71], a[128:131], v[196:199]
    v_exp_f32 v37, v37
    v_mfma_f32_16x16x32_bf16 v[204:207], v[68:71], a[132:135], v[204:207]
    ds_read_b64_tr_b16 v[92:93], v47 offset:30720
    v_add_f32 v36, 1.0, v36
    v_mfma_f32_16x16x32_bf16 v[212:215], v[68:71], a[136:139], v[212:215]
    v_rcp_f32 v36, v36
    v_mfma_f32_16x16x32_bf16 v[220:223], v[68:71], a[140:143], v[220:223]
    ds_read_b64_tr_b16 v[94:95], v47 offset:31232
    v_add_f32 v37, 1.0, v37
    v_mfma_f32_16x16x32_bf16 v[224:227], v[72:75], a[128:131], v[224:227]
    v_rcp_f32 v37, v37
    v_mfma_f32_16x16x32_bf16 v[232:235], v[72:75], a[132:135], v[232:235]
    ds_read_b64_tr_b16 v[64:65], v44 offset:16384
    v_mul_f32 v38, v146, v178
    v_mfma_f32_16x16x32_bf16 v[240:243], v[72:75], a[136:139], v[240:243]
    ds_read_b64_tr_b16 v[66:67], v44 offset:16896
    v_mul_f32 v39, v147, v179
    v_mfma_f32_16x16x32_bf16 v[248:251], v[72:75], a[140:143], v[248:251]
    v_mul_f32 v38, v38, v36
    v_mul_f32 v39, v39, v37
    v_mfma_f32_16x16x32_bf16 v[228:231], v[76:79], a[128:131], v[228:231]
    ds_read_b64_tr_b16 v[68:69], v46 offset:16384
    v_cvt_pk_bf16_f32 v57, v38, v39
    v_mfma_f32_16x16x32_bf16 v[236:239], v[76:79], a[132:135], v[236:239]
    ds_read_b64_tr_b16 v[70:71], v46 offset:16896
    v_mul_f32 v32, s95, v148
    v_mfma_f32_16x16x32_bf16 v[244:247], v[76:79], a[136:139], v[244:247]
    v_exp_f32 v32, v32
    v_mfma_f32_16x16x32_bf16 v[252:255], v[76:79], a[140:143], v[252:255]
    v_mul_f32 v33, s95, v149
    s_waitcnt lgkmcnt(4)
    v_mfma_f32_16x16x32_bf16 v[192:195], v[80:83], a[144:147], v[192:195]
    v_exp_f32 v33, v33
    v_mfma_f32_16x16x32_bf16 v[200:203], v[80:83], a[148:151], v[200:203]
    ds_read_b64_tr_b16 v[72:73], v44 offset:18432
    v_add_f32 v32, 1.0, v32
    v_mfma_f32_16x16x32_bf16 v[208:211], v[80:83], a[152:155], v[208:211]
    v_rcp_f32 v32, v32
    v_mfma_f32_16x16x32_bf16 v[216:219], v[80:83], a[156:159], v[216:219]
    ds_read_b64_tr_b16 v[74:75], v44 offset:18944
    v_add_f32 v33, 1.0, v33
    v_mfma_f32_16x16x32_bf16 v[196:199], v[84:87], a[144:147], v[196:199]
    v_rcp_f32 v33, v33
    v_mfma_f32_16x16x32_bf16 v[204:207], v[84:87], a[148:151], v[204:207]
    ds_read_b64_tr_b16 v[76:77], v46 offset:18432
    v_mul_f32 v34, v148, v180
    v_mfma_f32_16x16x32_bf16 v[212:215], v[84:87], a[152:155], v[212:215]
    ds_read_b64_tr_b16 v[78:79], v46 offset:18944
    v_mul_f32 v35, v149, v181
    v_mfma_f32_16x16x32_bf16 v[220:223], v[84:87], a[156:159], v[220:223]
    v_mul_f32 v34, v34, v32
    v_mul_f32 v35, v35, v33
    v_mfma_f32_16x16x32_bf16 v[224:227], v[88:91], a[144:147], v[224:227]
    ds_read_b64_tr_b16 v[80:81], v45 offset:16384
    v_cvt_pk_bf16_f32 v58, v34, v35
    v_mfma_f32_16x16x32_bf16 v[232:235], v[88:91], a[148:151], v[232:235]
    ds_read_b64_tr_b16 v[82:83], v45 offset:16896
    v_mul_f32 v36, s95, v150
    v_mfma_f32_16x16x32_bf16 v[240:243], v[88:91], a[152:155], v[240:243]
    v_exp_f32 v36, v36
    v_mfma_f32_16x16x32_bf16 v[248:251], v[88:91], a[156:159], v[248:251]
    v_mul_f32 v37, s95, v151
    v_add_f32 v36, 1.0, v36
    v_mfma_f32_16x16x32_bf16 v[228:231], v[92:95], a[144:147], v[228:231]
    v_exp_f32 v37, v37
    v_mfma_f32_16x16x32_bf16 v[236:239], v[92:95], a[148:151], v[236:239]
    v_rcp_f32 v36, v36
    v_mfma_f32_16x16x32_bf16 v[244:247], v[92:95], a[152:155], v[244:247]
    ds_read_b64_tr_b16 v[84:85], v47 offset:16384
    v_add_f32 v37, 1.0, v37
    v_mfma_f32_16x16x32_bf16 v[252:255], v[92:95], a[156:159], v[252:255]
    ds_read_b64_tr_b16 v[86:87], v47 offset:16896
    s_waitcnt lgkmcnt(4)
    v_mfma_f32_16x16x32_bf16 v[192:195], v[64:67], a[160:163], v[192:195]
    v_rcp_f32 v37, v37
    v_mfma_f32_16x16x32_bf16 v[200:203], v[64:67], a[164:167], v[200:203]
    ds_read_b64_tr_b16 v[88:89], v45 offset:18432
    v_mul_f32 v38, v150, v182
    v_mfma_f32_16x16x32_bf16 v[208:211], v[64:67], a[168:171], v[208:211]
    ds_read_b64_tr_b16 v[90:91], v45 offset:18944
    v_mul_f32 v39, v151, v183
    v_mfma_f32_16x16x32_bf16 v[216:219], v[64:67], a[172:175], v[216:219]
    v_mul_f32 v38, v38, v36
    v_mul_f32 v39, v39, v37
    v_mfma_f32_16x16x32_bf16 v[196:199], v[68:71], a[160:163], v[196:199]
    s_add_u32 s16, s94, 466944
    ds_read_b64_tr_b16 v[92:93], v47 offset:18432
    v_mfma_f32_16x16x32_bf16 v[204:207], v[68:71], a[164:167], v[204:207]
    ds_read_b64_tr_b16 v[94:95], v47 offset:18944
    v_cvt_pk_bf16_f32 v59, v38, v39
    v_mfma_f32_16x16x32_bf16 v[212:215], v[68:71], a[168:171], v[212:215]
    buffer_store_dwordx4 v[56:59], v22, s[68:71], s16 offen sc1
    v_mul_f32 v32, s95, v152
    v_mfma_f32_16x16x32_bf16 v[220:223], v[68:71], a[172:175], v[220:223]
    v_exp_f32 v32, v32
    v_mfma_f32_16x16x32_bf16 v[224:227], v[72:75], a[160:163], v[224:227]
    s_barrier
    s_add_u32 m0, s52, 0
    v_mfma_f32_16x16x32_bf16 v[232:235], v[72:75], a[164:167], v[232:235]
    s_add_u32 s54, s85, s33
    ds_read_b64_tr_b16 v[64:65], v44 offset:20480
    v_mfma_f32_16x16x32_bf16 v[240:243], v[72:75], a[168:171], v[240:243]
    buffer_load_dwordx4 v12, s[60:63], s54 offen offset:0 lds
    v_mfma_f32_16x16x32_bf16 v[248:251], v[72:75], a[172:175], v[248:251]
    ds_read_b64_tr_b16 v[66:67], v44 offset:20992
    v_mul_f32 v33, s95, v153
    v_mfma_f32_16x16x32_bf16 v[228:231], v[76:79], a[160:163], v[228:231]
    buffer_load_dwordx4 v13, s[60:63], s54 offen offset:1024 lds
    v_mfma_f32_16x16x32_bf16 v[236:239], v[76:79], a[164:167], v[236:239]
    v_exp_f32 v33, v33
    v_mfma_f32_16x16x32_bf16 v[244:247], v[76:79], a[168:171], v[244:247]
    ds_read_b64_tr_b16 v[68:69], v46 offset:20480
    v_add_f32 v32, 1.0, v32
    v_mfma_f32_16x16x32_bf16 v[252:255], v[76:79], a[172:175], v[252:255]
    ds_read_b64_tr_b16 v[70:71], v46 offset:20992
    s_waitcnt lgkmcnt(4)
    v_mfma_f32_16x16x32_bf16 v[192:195], v[80:83], a[176:179], v[192:195]
    buffer_load_dwordx4 v14, s[64:67], s54 offen offset:2048 lds
    v_mfma_f32_16x16x32_bf16 v[200:203], v[80:83], a[180:183], v[200:203]
    v_rcp_f32 v32, v32
    v_mfma_f32_16x16x32_bf16 v[208:211], v[80:83], a[184:187], v[208:211]
    ds_read_b64_tr_b16 v[72:73], v44 offset:22528
    v_add_f32 v33, 1.0, v33
    v_mfma_f32_16x16x32_bf16 v[216:219], v[80:83], a[188:191], v[216:219]
    ds_read_b64_tr_b16 v[74:75], v44 offset:23040
    v_mul_f32 v34, v152, v184
    v_mfma_f32_16x16x32_bf16 v[196:199], v[84:87], a[176:179], v[196:199]
    buffer_load_dwordx4 v15, s[64:67], s54 offen offset:3072 lds
    v_mfma_f32_16x16x32_bf16 v[204:207], v[84:87], a[180:183], v[204:207]
    v_rcp_f32 v33, v33
    v_mfma_f32_16x16x32_bf16 v[212:215], v[84:87], a[184:187], v[212:215]
    ds_read_b64_tr_b16 v[76:77], v46 offset:22528
    v_mul_f32 v35, v153, v185
    v_mfma_f32_16x16x32_bf16 v[220:223], v[84:87], a[188:191], v[220:223]
    ds_read_b64_tr_b16 v[78:79], v46 offset:23040
    v_mul_f32 v34, v34, v32
    v_mfma_f32_16x16x32_bf16 v[224:227], v[88:91], a[176:179], v[224:227]
    s_add_u32 m0, s52, 4096
    s_add_u32 s54, s86, s33
    v_mfma_f32_16x16x32_bf16 v[232:235], v[88:91], a[180:183], v[232:235]
    buffer_load_dwordx4 v12, s[60:63], s54 offen offset:0 lds
    v_mfma_f32_16x16x32_bf16 v[240:243], v[88:91], a[184:187], v[240:243]
    ds_read_b64_tr_b16 v[80:81], v45 offset:20480
    v_mul_f32 v35, v35, v33
    v_mfma_f32_16x16x32_bf16 v[248:251], v[88:91], a[188:191], v[248:251]
    ds_read_b64_tr_b16 v[82:83], v45 offset:20992
    v_cvt_pk_bf16_f32 v60, v34, v35
    v_mfma_f32_16x16x32_bf16 v[228:231], v[92:95], a[176:179], v[228:231]
    buffer_load_dwordx4 v13, s[60:63], s54 offen offset:1024 lds
    v_mfma_f32_16x16x32_bf16 v[236:239], v[92:95], a[180:183], v[236:239]
    ds_read_b64_tr_b16 v[84:85], v47 offset:20480
    v_mul_f32 v36, s95, v154
    v_mfma_f32_16x16x32_bf16 v[244:247], v[92:95], a[184:187], v[244:247]
    v_exp_f32 v36, v36
    v_mfma_f32_16x16x32_bf16 v[252:255], v[92:95], a[188:191], v[252:255]
    ds_read_b64_tr_b16 v[86:87], v47 offset:20992
    s_waitcnt lgkmcnt(4)
    v_mfma_f32_16x16x32_bf16 v[192:195], v[64:67], a[192:195], v[192:195]
    s_waitcnt vmcnt(15)
    buffer_store_dword v25, v24, s[68:71], 0 offen offset:512 sc1
    v_mfma_f32_16x16x32_bf16 v[200:203], v[64:67], a[196:199], v[200:203]
    buffer_load_dwordx4 v14, s[64:67], s54 offen offset:2048 lds
    v_mfma_f32_16x16x32_bf16 v[208:211], v[64:67], a[200:203], v[208:211]
    ds_read_b64_tr_b16 v[88:89], v45 offset:22528
    v_mul_f32 v37, s95, v155
    v_mfma_f32_16x16x32_bf16 v[216:219], v[64:67], a[204:207], v[216:219]
    ds_read_b64_tr_b16 v[90:91], v45 offset:23040
    v_add_f32 v36, 1.0, v36
    v_mfma_f32_16x16x32_bf16 v[196:199], v[68:71], a[192:195], v[196:199]
    buffer_load_dwordx4 v15, s[64:67], s54 offen offset:3072 lds
    v_mfma_f32_16x16x32_bf16 v[204:207], v[68:71], a[196:199], v[204:207]
    v_exp_f32 v37, v37
    v_mfma_f32_16x16x32_bf16 v[212:215], v[68:71], a[200:203], v[212:215]
    ds_read_b64_tr_b16 v[92:93], v47 offset:22528
    v_add_f32 v37, 1.0, v37
    v_mfma_f32_16x16x32_bf16 v[220:223], v[68:71], a[204:207], v[220:223]
    ds_read_b64_tr_b16 v[94:95], v47 offset:23040
    v_mul_f32 v38, v154, v186
    v_mfma_f32_16x16x32_bf16 v[224:227], v[72:75], a[192:195], v[224:227]
    v_rcp_f32 v36, v36
    v_mfma_f32_16x16x32_bf16 v[232:235], v[72:75], a[196:199], v[232:235]
    v_rcp_f32 v37, v37
    v_mfma_f32_16x16x32_bf16 v[240:243], v[72:75], a[200:203], v[240:243]
    ds_read_b64_tr_b16 v[64:65], v44 offset:32768
    v_mul_f32 v39, v155, v187
    s_branch L_sskip4
L_stub4:
    s_setpc_b64 s[100:101]
L_sskip4:
    v_mfma_f32_16x16x32_bf16 v[248:251], v[72:75], a[204:207], v[248:251]
    ds_read_b64_tr_b16 v[66:67], v44 offset:33280
    v_mul_f32 v38, v38, v36
    v_mfma_f32_16x16x32_bf16 v[228:231], v[76:79], a[192:195], v[228:231]
    ds_read_b64_tr_b16 v[68:69], v46 offset:32768
    v_mul_f32 v39, v39, v37
    v_mfma_f32_16x16x32_bf16 v[236:239], v[76:79], a[196:199], v[236:239]
    ds_read_b64_tr_b16 v[70:71], v46 offset:33280
    v_cvt_pk_bf16_f32 v61, v38, v39
    v_mfma_f32_16x16x32_bf16 v[244:247], v[76:79], a[200:203], v[244:247]
    v_mul_f32 v32, s95, v156
    v_mul_f32 v33, s95, v157
    v_mfma_f32_16x16x32_bf16 v[252:255], v[76:79], a[204:207], v[252:255]
    v_mul_f32 v34, v156, v188
    s_waitcnt lgkmcnt(4)
    v_mfma_f32_16x16x32_bf16 v[192:195], v[80:83], a[208:211], v[192:195]
    v_exp_f32 v32, v32
    v_mfma_f32_16x16x32_bf16 v[200:203], v[80:83], a[212:215], v[200:203]
    v_exp_f32 v33, v33
    v_mfma_f32_16x16x32_bf16 v[208:211], v[80:83], a[216:219], v[208:211]
    ds_read_b64_tr_b16 v[72:73], v44 offset:34816
    v_add_f32 v32, 1.0, v32
    v_mfma_f32_16x16x32_bf16 v[216:219], v[80:83], a[220:223], v[216:219]
    ds_read_b64_tr_b16 v[74:75], v44 offset:35328
    v_add_f32 v33, 1.0, v33
    v_mfma_f32_16x16x32_bf16 v[196:199], v[84:87], a[208:211], v[196:199]
    v_rcp_f32 v32, v32
    v_mfma_f32_16x16x32_bf16 v[204:207], v[84:87], a[212:215], v[204:207]
    v_rcp_f32 v33, v33
    v_mfma_f32_16x16x32_bf16 v[212:215], v[84:87], a[216:219], v[212:215]
    ds_read_b64_tr_b16 v[76:77], v46 offset:34816
    v_mul_f32 v35, v157, v189
    v_mfma_f32_16x16x32_bf16 v[220:223], v[84:87], a[220:223], v[220:223]
    ds_read_b64_tr_b16 v[78:79], v46 offset:35328
    v_mul_f32 v34, v34, v32
    v_mfma_f32_16x16x32_bf16 v[224:227], v[88:91], a[208:211], v[224:227]
    ds_read_b64_tr_b16 v[80:81], v45 offset:32768
    v_mul_f32 v35, v35, v33
    v_mfma_f32_16x16x32_bf16 v[232:235], v[88:91], a[212:215], v[232:235]
    ds_read_b64_tr_b16 v[82:83], v45 offset:33280
    v_cvt_pk_bf16_f32 v62, v34, v35
    v_mfma_f32_16x16x32_bf16 v[240:243], v[88:91], a[216:219], v[240:243]
    v_mul_f32 v36, s95, v158
    v_mul_f32 v37, s95, v159
    v_mfma_f32_16x16x32_bf16 v[248:251], v[88:91], a[220:223], v[248:251]
    v_exp_f32 v36, v36
    v_mfma_f32_16x16x32_bf16 v[228:231], v[92:95], a[208:211], v[228:231]
    v_exp_f32 v37, v37
    v_mfma_f32_16x16x32_bf16 v[236:239], v[92:95], a[212:215], v[236:239]
    ds_read_b64_tr_b16 v[84:85], v47 offset:32768
    v_add_f32 v36, 1.0, v36
    v_mfma_f32_16x16x32_bf16 v[244:247], v[92:95], a[216:219], v[244:247]
    v_rcp_f32 v36, v36
    v_mfma_f32_16x16x32_bf16 v[252:255], v[92:95], a[220:223], v[252:255]
    ds_read_b64_tr_b16 v[86:87], v47 offset:33280
    s_waitcnt lgkmcnt(4)
    v_mfma_f32_16x16x32_bf16 v[192:195], v[64:67], a[224:227], v[192:195]
    s_add_u32 m0, s52, 8192
    s_add_u32 s54, s87, s33
    v_mfma_f32_16x16x32_bf16 v[200:203], v[64:67], a[228:231], v[200:203]
    buffer_load_dwordx4 v12, s[60:63], s54 offen offset:0 lds
    v_mfma_f32_16x16x32_bf16 v[208:211], v[64:67], a[232:235], v[208:211]
    ds_read_b64_tr_b16 v[88:89], v45 offset:34816
    v_add_f32 v37, 1.0, v37
    v_mfma_f32_16x16x32_bf16 v[216:219], v[64:67], a[236:239], v[216:219]
    ds_read_b64_tr_b16 v[90:91], v45 offset:35328
    v_mul_f32 v38, v158, v190
    v_mfma_f32_16x16x32_bf16 v[196:199], v[68:71], a[224:227], v[196:199]
    buffer_load_dwordx4 v13, s[60:63], s54 offen offset:1024 lds
    v_mfma_f32_16x16x32_bf16 v[204:207], v[68:71], a[228:231], v[204:207]
    v_rcp_f32 v37, v37
    v_mfma_f32_16x16x32_bf16 v[212:215], v[68:71], a[232:235], v[212:215]
    ds_read_b64_tr_b16 v[92:93], v47 offset:34816
    v_mul_f32 v39, v159, v191
    v_mfma_f32_16x16x32_bf16 v[220:223], v[68:71], a[236:239], v[220:223]
    ds_read_b64_tr_b16 v[94:95], v47 offset:35328
    v_mul_f32 v38, v38, v36
    v_mfma_f32_16x16x32_bf16 v[224:227], v[72:75], a[224:227], v[224:227]
    buffer_load_dwordx4 v14, s[64:67], s54 offen offset:2048 lds
    v_mfma_f32_16x16x32_bf16 v[232:235], v[72:75], a[228:231], v[232:235]
    ds_read_b64_tr_b16 v[64:65], v44 offset:36864
    v_mul_f32 v39, v39, v37
    v_mfma_f32_16x16x32_bf16 v[240:243], v[72:75], a[232:235], v[240:243]
    s_add_u32 s16, s94, 467968
    ds_read_b64_tr_b16 v[66:67], v44 offset:37376
    v_mfma_f32_16x16x32_bf16 v[248:251], v[72:75], a[236:239], v[248:251]
    v_cvt_pk_bf16_f32 v63, v38, v39
    v_mfma_f32_16x16x32_bf16 v[228:231], v[76:79], a[224:227], v[228:231]
    buffer_load_dwordx4 v15, s[64:67], s54 offen offset:3072 lds
    v_mfma_f32_16x16x32_bf16 v[236:239], v[76:79], a[228:231], v[236:239]
    buffer_store_dwordx4 v[60:63], v22, s[68:71], s16 offen sc1
    ds_read_b64_tr_b16 v[68:69], v46 offset:36864
    v_mfma_f32_16x16x32_bf16 v[244:247], v[76:79], a[232:235], v[244:247]
    ds_read_b64_tr_b16 v[70:71], v46 offset:37376
    v_mfma_f32_16x16x32_bf16 v[252:255], v[76:79], a[236:239], v[252:255]
    s_waitcnt lgkmcnt(4)
    v_mfma_f32_16x16x32_bf16 v[192:195], v[80:83], a[240:243], v[192:195]
    s_add_u32 m0, s52, 12288
    s_add_u32 s54, s88, s33
    v_mfma_f32_16x16x32_bf16 v[200:203], v[80:83], a[244:247], v[200:203]
    buffer_load_dwordx4 v12, s[60:63], s54 offen offset:0 lds
    v_mfma_f32_16x16x32_bf16 v[208:211], v[80:83], a[248:251], v[208:211]
    ds_read_b64_tr_b16 v[72:73], v44 offset:38912
    v_mfma_f32_16x16x32_bf16 v[216:219], v[80:83], a[252:255], v[216:219]
    ds_read_b64_tr_b16 v[74:75], v44 offset:39424
    v_mfma_f32_16x16x32_bf16 v[196:199], v[84:87], a[240:243], v[196:199]
    buffer_load_dwordx4 v13, s[60:63], s54 offen offset:1024 lds
    v_mfma_f32_16x16x32_bf16 v[204:207], v[84:87], a[244:247], v[204:207]
    ds_read_b64_tr_b16 v[76:77], v46 offset:38912
    v_mfma_f32_16x16x32_bf16 v[212:215], v[84:87], a[248:251], v[212:215]
    ds_read_b64_tr_b16 v[78:79], v46 offset:39424
    v_mfma_f32_16x16x32_bf16 v[220:223], v[84:87], a[252:255], v[220:223]
    v_mfma_f32_16x16x32_bf16 v[224:227], v[88:91], a[240:243], v[224:227]
    buffer_load_dwordx4 v14, s[64:67], s54 offen offset:2048 lds
    v_mfma_f32_16x16x32_bf16 v[232:235], v[88:91], a[244:247], v[232:235]
    ds_read_b64_tr_b16 v[80:81], v45 offset:36864
    v_mfma_f32_16x16x32_bf16 v[240:243], v[88:91], a[248:251], v[240:243]
    ds_read_b64_tr_b16 v[82:83], v45 offset:37376
    v_mfma_f32_16x16x32_bf16 v[248:251], v[88:91], a[252:255], v[248:251]
    v_mfma_f32_16x16x32_bf16 v[228:231], v[92:95], a[240:243], v[228:231]
    buffer_load_dwordx4 v15, s[64:67], s54 offen offset:3072 lds
    v_mfma_f32_16x16x32_bf16 v[236:239], v[92:95], a[244:247], v[236:239]
    ds_read_b64_tr_b16 v[84:85], v47 offset:36864
    v_mfma_f32_16x16x32_bf16 v[244:247], v[92:95], a[248:251], v[244:247]
    ds_read_b64_tr_b16 v[86:87], v47 offset:37376
    v_mfma_f32_16x16x32_bf16 v[252:255], v[92:95], a[252:255], v[252:255]
    s_waitcnt lgkmcnt(4)
    v_mfma_f32_16x16x32_bf16 v[192:195], v[64:67], v[96:99], v[192:195]
    ds_read_b64_tr_b16 v[88:89], v45 offset:38912
    v_mfma_f32_16x16x32_bf16 v[200:203], v[64:67], v[100:103], v[200:203]
    ds_read_b64_tr_b16 v[90:91], v45 offset:39424
    v_mfma_f32_16x16x32_bf16 v[208:211], v[64:67], v[104:107], v[208:211]
    v_mfma_f32_16x16x32_bf16 v[216:219], v[64:67], v[108:111], v[216:219]
    v_mfma_f32_16x16x32_bf16 v[196:199], v[68:71], v[96:99], v[196:199]
    ds_read_b64_tr_b16 v[92:93], v47 offset:38912
    v_mfma_f32_16x16x32_bf16 v[204:207], v[68:71], v[100:103], v[204:207]
    ds_read_b64_tr_b16 v[94:95], v47 offset:39424
    v_mfma_f32_16x16x32_bf16 v[212:215], v[68:71], v[104:107], v[212:215]
    v_mfma_f32_16x16x32_bf16 v[220:223], v[68:71], v[108:111], v[220:223]
    v_mfma_f32_16x16x32_bf16 v[224:227], v[72:75], v[96:99], v[224:227]
    s_waitcnt vmcnt(9)
    s_barrier
    v_mfma_f32_16x16x32_bf16 v[232:235], v[72:75], v[100:103], v[232:235]
    s_add_u32 m0, s52, 28672
    s_add_u32 s54, s89, s33
    v_mfma_f32_16x16x32_bf16 v[240:243], v[72:75], v[104:107], v[240:243]
    buffer_load_dwordx4 v12, s[60:63], s54 offen offset:0 lds
    v_mfma_f32_16x16x32_bf16 v[248:251], v[72:75], v[108:111], v[248:251]
    ds_read_b64_tr_b16 v[64:65], v40 offset:0
    ds_read_b64_tr_b16 v[66:67], v40 offset:512
    v_mfma_f32_16x16x32_bf16 v[228:231], v[76:79], v[96:99], v[228:231]
    buffer_load_dwordx4 v13, s[60:63], s54 offen offset:1024 lds
    v_mfma_f32_16x16x32_bf16 v[236:239], v[76:79], v[100:103], v[236:239]
    ds_read_b64_tr_b16 v[68:69], v42 offset:0
    v_mfma_f32_16x16x32_bf16 v[244:247], v[76:79], v[104:107], v[244:247]
    ds_read_b64_tr_b16 v[70:71], v42 offset:512
    v_mfma_f32_16x16x32_bf16 v[252:255], v[76:79], v[108:111], v[252:255]
    s_waitcnt lgkmcnt(4)
    v_mfma_f32_16x16x32_bf16 v[192:195], v[80:83], v[112:115], v[192:195]
    buffer_load_dwordx4 v14, s[64:67], s54 offen offset:2048 lds
    v_mfma_f32_16x16x32_bf16 v[200:203], v[80:83], v[116:119], v[200:203]
    ds_read_b64_tr_b16 v[72:73], v40 offset:2048
    v_mfma_f32_16x16x32_bf16 v[208:211], v[80:83], v[120:123], v[208:211]
    ds_read_b64_tr_b16 v[74:75], v40 offset:2560
    v_mfma_f32_16x16x32_bf16 v[216:219], v[80:83], v[124:127], v[216:219]
    v_mfma_f32_16x16x32_bf16 v[196:199], v[84:87], v[112:115], v[196:199]
    buffer_load_dwordx4 v15, s[64:67], s54 offen offset:3072 lds
    v_mfma_f32_16x16x32_bf16 v[204:207], v[84:87], v[116:119], v[204:207]
    ds_read_b64_tr_b16 v[76:77], v42 offset:2048
    v_mfma_f32_16x16x32_bf16 v[212:215], v[84:87], v[120:123], v[212:215]
    ds_read_b64_tr_b16 v[78:79], v42 offset:2560
    v_mfma_f32_16x16x32_bf16 v[220:223], v[84:87], v[124:127], v[220:223]
    v_mfma_f32_16x16x32_bf16 v[224:227], v[88:91], v[112:115], v[224:227]
    s_add_u32 m0, s52, 16384
    s_add_u32 s54, s90, s33
    v_mfma_f32_16x16x32_bf16 v[232:235], v[88:91], v[116:119], v[232:235]
    buffer_load_dwordx4 v12, s[60:63], s54 offen offset:0 lds
    v_mfma_f32_16x16x32_bf16 v[240:243], v[88:91], v[120:123], v[240:243]
    ds_read_b64_tr_b16 v[80:81], v41 offset:0
    v_mfma_f32_16x16x32_bf16 v[248:251], v[88:91], v[124:127], v[248:251]
    ds_read_b64_tr_b16 v[82:83], v41 offset:512
    v_mfma_f32_16x16x32_bf16 v[228:231], v[92:95], v[112:115], v[228:231]
    buffer_load_dwordx4 v13, s[60:63], s54 offen offset:1024 lds
    v_mfma_f32_16x16x32_bf16 v[236:239], v[92:95], v[116:119], v[236:239]
    ds_read_b64_tr_b16 v[84:85], v43 offset:0
    v_mfma_f32_16x16x32_bf16 v[244:247], v[92:95], v[120:123], v[244:247]
    ds_read_b64_tr_b16 v[86:87], v43 offset:512
    v_mfma_f32_16x16x32_bf16 v[252:255], v[92:95], v[124:127], v[252:255]
    s_waitcnt lgkmcnt(4)
    v_mfma_f32_16x16x32_bf16 v[128:131], v[64:67], a[0:3], 0
    buffer_load_dwordx4 v14, s[64:67], s54 offen offset:2048 lds
    v_mfma_f32_16x16x32_bf16 v[136:139], v[64:67], a[4:7], 0
    ds_read_b64_tr_b16 v[88:89], v41 offset:2048
    v_mfma_f32_16x16x32_bf16 v[144:147], v[64:67], a[8:11], 0
    ds_read_b64_tr_b16 v[90:91], v41 offset:2560
    v_mfma_f32_16x16x32_bf16 v[152:155], v[64:67], a[12:15], 0
    v_mfma_f32_16x16x32_bf16 v[132:135], v[68:71], a[0:3], 0
    buffer_load_dwordx4 v15, s[64:67], s54 offen offset:3072 lds
    v_mfma_f32_16x16x32_bf16 v[140:143], v[68:71], a[4:7], 0
    ds_read_b64_tr_b16 v[92:93], v43 offset:2048
    v_mfma_f32_16x16x32_bf16 v[148:151], v[68:71], a[8:11], 0
    ds_read_b64_tr_b16 v[94:95], v43 offset:2560
    v_mfma_f32_16x16x32_bf16 v[156:159], v[68:71], a[12:15], 0
    v_mfma_f32_16x16x32_bf16 v[160:163], v[72:75], a[0:3], 0
    s_add_u32 m0, s52, 20480
    s_add_u32 s54, s91, s33
    v_mfma_f32_16x16x32_bf16 v[168:171], v[72:75], a[4:7], 0
    buffer_load_dwordx4 v12, s[60:63], s54 offen offset:0 lds
    v_mfma_f32_16x16x32_bf16 v[176:179], v[72:75], a[8:11], 0
    ds_read_b64_tr_b16 v[64:65], v40 offset:4096
    v_mul_f32 v32, s95, v192
    v_mfma_f32_16x16x32_bf16 v[184:187], v[72:75], a[12:15], 0
    ds_read_b64_tr_b16 v[66:67], v40 offset:4608
    v_mul_f32 v33, s95, v193
    v_mfma_f32_16x16x32_bf16 v[164:167], v[76:79], a[0:3], 0
    buffer_load_dwordx4 v13, s[60:63], s54 offen offset:1024 lds
    v_mfma_f32_16x16x32_bf16 v[172:175], v[76:79], a[4:7], 0
    v_exp_f32 v32, v32
    v_mfma_f32_16x16x32_bf16 v[180:183], v[76:79], a[8:11], 0
    ds_read_b64_tr_b16 v[68:69], v42 offset:4096
    v_add_f32 v32, 1.0, v32
    v_mfma_f32_16x16x32_bf16 v[188:191], v[76:79], a[12:15], 0
    ds_read_b64_tr_b16 v[70:71], v42 offset:4608
    s_waitcnt lgkmcnt(4)
    v_mfma_f32_16x16x32_bf16 v[128:131], v[80:83], a[16:19], v[128:131]
    buffer_load_dwordx4 v14, s[64:67], s54 offen offset:2048 lds
    v_mfma_f32_16x16x32_bf16 v[136:139], v[80:83], a[20:23], v[136:139]
    v_exp_f32 v33, v33
    v_mfma_f32_16x16x32_bf16 v[144:147], v[80:83], a[24:27], v[144:147]
    ds_read_b64_tr_b16 v[72:73], v40 offset:6144
    v_add_f32 v33, 1.0, v33
    v_mfma_f32_16x16x32_bf16 v[152:155], v[80:83], a[28:31], v[152:155]
    ds_read_b64_tr_b16 v[74:75], v40 offset:6656
    v_mul_f32 v34, v192, v224
    v_mfma_f32_16x16x32_bf16 v[132:135], v[84:87], a[16:19], v[132:135]
    buffer_load_dwordx4 v15, s[64:67], s54 offen offset:3072 lds
    v_mfma_f32_16x16x32_bf16 v[140:143], v[84:87], a[20:23], v[140:143]
    v_rcp_f32 v32, v32
    v_mfma_f32_16x16x32_bf16 v[148:151], v[84:87], a[24:27], v[148:151]
    ds_read_b64_tr_b16 v[76:77], v42 offset:6144
    v_mul_f32 v35, v193, v225
    v_mfma_f32_16x16x32_bf16 v[156:159], v[84:87], a[28:31], v[156:159]
    ds_read_b64_tr_b16 v[78:79], v42 offset:6656
    v_mul_f32 v34, v34, v32
    v_mfma_f32_16x16x32_bf16 v[160:163], v[88:91], a[16:19], v[160:163]
    s_add_u32 m0, s52, 32768
    s_add_u32 s54, s92, s33
    v_mfma_f32_16x16x32_bf16 v[168:171], v[88:91], a[20:23], v[168:171]
    buffer_load_dwordx4 v12, s[60:63], s54 offen offset:0 lds
    v_mfma_f32_16x16x32_bf16 v[176:179], v[88:91], a[24:27], v[176:179]
    ds_read_b64_tr_b16 v[80:81], v41 offset:4096
    v_mul_f32 v36, s95, v194
    v_mfma_f32_16x16x32_bf16 v[184:187], v[88:91], a[28:31], v[184:187]
    ds_read_b64_tr_b16 v[82:83], v41 offset:4608
    v_mul_f32 v37, s95, v195
    v_mfma_f32_16x16x32_bf16 v[164:167], v[92:95], a[16:19], v[164:167]
    s_waitcnt vmcnt(17)
    buffer_store_dword v25, v24, s[68:71], 0 offen offset:1024 sc1
    v_mfma_f32_16x16x32_bf16 v[172:175], v[92:95], a[20:23], v[172:175]
    buffer_load_dwordx4 v13, s[60:63], s54 offen offset:1024 lds
    v_mfma_f32_16x16x32_bf16 v[180:183], v[92:95], a[24:27], v[180:183]
    ds_read_b64_tr_b16 v[84:85], v43 offset:4096
    v_mul_f32 v38, v194, v226
    v_mfma_f32_16x16x32_bf16 v[188:191], v[92:95], a[28:31], v[188:191]
    ds_read_b64_tr_b16 v[86:87], v43 offset:4608
    s_waitcnt lgkmcnt(4)
    v_mfma_f32_16x16x32_bf16 v[128:131], v[64:67], a[32:35], v[128:131]
    buffer_load_dwordx4 v14, s[64:67], s54 offen offset:2048 lds
    v_mfma_f32_16x16x32_bf16 v[136:139], v[64:67], a[36:39], v[136:139]
    v_rcp_f32 v33, v33
    v_mfma_f32_16x16x32_bf16 v[144:147], v[64:67], a[40:43], v[144:147]
    ds_read_b64_tr_b16 v[88:89], v41 offset:6144
    v_mul_f32 v35, v35, v33
    v_mfma_f32_16x16x32_bf16 v[152:155], v[64:67], a[44:47], v[152:155]
    ds_read_b64_tr_b16 v[90:91], v41 offset:6656
    v_cvt_pk_bf16_f32 v48, v34, v35
    v_mfma_f32_16x16x32_bf16 v[132:135], v[68:71], a[32:35], v[132:135]
    buffer_load_dwordx4 v15, s[64:67], s54 offen offset:3072 lds
    v_mfma_f32_16x16x32_bf16 v[140:143], v[68:71], a[36:39], v[140:143]
    v_exp_f32 v36, v36
    v_mfma_f32_16x16x32_bf16 v[148:151], v[68:71], a[40:43], v[148:151]
    ds_read_b64_tr_b16 v[92:93], v43 offset:6144
    v_add_f32 v36, 1.0, v36
    v_mfma_f32_16x16x32_bf16 v[156:159], v[68:71], a[44:47], v[156:159]
    ds_read_b64_tr_b16 v[94:95], v43 offset:6656
    v_mul_f32 v39, v195, v227
    v_mfma_f32_16x16x32_bf16 v[160:163], v[72:75], a[32:35], v[160:163]
    s_waitcnt vmcnt(17)
    s_barrier
    v_mfma_f32_16x16x32_bf16 v[168:171], v[72:75], a[36:39], v[168:171]
    s_add_u32 m0, s52, 36864
    s_add_u32 s54, s93, s33
    v_mfma_f32_16x16x32_bf16 v[176:179], v[72:75], a[40:43], v[176:179]
    buffer_load_dwordx4 v12, s[60:63], s54 offen offset:0 lds
    v_mfma_f32_16x16x32_bf16 v[184:187], v[72:75], a[44:47], v[184:187]
    ds_read_b64_tr_b16 v[64:65], v40 offset:8192
    ds_read_b64_tr_b16 v[66:67], v40 offset:8704
    v_mfma_f32_16x16x32_bf16 v[164:167], v[76:79], a[32:35], v[164:167]
    buffer_load_dwordx4 v13, s[60:63], s54 offen offset:1024 lds
    v_mfma_f32_16x16x32_bf16 v[172:175], v[76:79], a[36:39], v[172:175]
    v_exp_f32 v37, v37
    v_mfma_f32_16x16x32_bf16 v[180:183], v[76:79], a[40:43], v[180:183]
    ds_read_b64_tr_b16 v[68:69], v42 offset:8192
    v_add_f32 v37, 1.0, v37
    v_mfma_f32_16x16x32_bf16 v[188:191], v[76:79], a[44:47], v[188:191]
    ds_read_b64_tr_b16 v[70:71], v42 offset:8704
    s_waitcnt lgkmcnt(4)
    v_mfma_f32_16x16x32_bf16 v[128:131], v[80:83], a[48:51], v[128:131]
    buffer_load_dwordx4 v14, s[64:67], s54 offen offset:2048 lds
    v_mfma_f32_16x16x32_bf16 v[136:139], v[80:83], a[52:55], v[136:139]
    v_rcp_f32 v36, v36
    v_mfma_f32_16x16x32_bf16 v[144:147], v[80:83], a[56:59], v[144:147]
    ds_read_b64_tr_b16 v[72:73], v40 offset:10240
    v_mul_f32 v38, v38, v36
    v_mfma_f32_16x16x32_bf16 v[152:155], v[80:83], a[60:63], v[152:155]
    ds_read_b64_tr_b16 v[74:75], v40 offset:10752
    v_mul_f32 v32, s95, v196
    v_mfma_f32_16x16x32_bf16 v[132:135], v[84:87], a[48:51], v[132:135]
    buffer_load_dwordx4 v15, s[64:67], s54 offen offset:3072 lds
    v_mfma_f32_16x16x32_bf16 v[140:143], v[84:87], a[52:55], v[140:143]
    v_rcp_f32 v37, v37
    v_mfma_f32_16x16x32_bf16 v[148:151], v[84:87], a[56:59], v[148:151]
    ds_read_b64_tr_b16 v[76:77], v42 offset:10240
    v_mul_f32 v39, v39, v37
    v_mfma_f32_16x16x32_bf16 v[156:159], v[84:87], a[60:63], v[156:159]
    ds_read_b64_tr_b16 v[78:79], v42 offset:10752
    v_cvt_pk_bf16_f32 v49, v38, v39
    v_mfma_f32_16x16x32_bf16 v[160:163], v[88:91], a[48:51], v[160:163]
    v_exp_f32 v32, v32
    v_mfma_f32_16x16x32_bf16 v[168:171], v[88:91], a[52:55], v[168:171]
    ds_read_b64_tr_b16 v[80:81], v41 offset:8192
    v_mul_f32 v33, s95, v197
    v_mfma_f32_16x16x32_bf16 v[176:179], v[88:91], a[56:59], v[176:179]
    v_exp_f32 v33, v33
    v_mfma_f32_16x16x32_bf16 v[184:187], v[88:91], a[60:63], v[184:187]
    ds_read_b64_tr_b16 v[82:83], v41 offset:8704
    v_add_f32 v32, 1.0, v32
    v_mfma_f32_16x16x32_bf16 v[164:167], v[92:95], a[48:51], v[164:167]
    v_rcp_f32 v32, v32
    v_mfma_f32_16x16x32_bf16 v[172:175], v[92:95], a[52:55], v[172:175]
    ds_read_b64_tr_b16 v[84:85], v43 offset:8192
    v_add_f32 v33, 1.0, v33
    v_mfma_f32_16x16x32_bf16 v[180:183], v[92:95], a[56:59], v[180:183]
    v_rcp_f32 v33, v33
    v_mfma_f32_16x16x32_bf16 v[188:191], v[92:95], a[60:63], v[188:191]
    ds_read_b64_tr_b16 v[86:87], v43 offset:8704
    s_waitcnt lgkmcnt(4)
    v_mfma_f32_16x16x32_bf16 v[128:131], v[64:67], a[64:67], v[128:131]
    global_load_dword v19, v[20:21], off
    v_mfma_f32_16x16x32_bf16 v[136:139], v[64:67], a[68:71], v[136:139]
    ds_read_b64_tr_b16 v[88:89], v41 offset:10240
    v_mul_f32 v34, v196, v228
    v_mfma_f32_16x16x32_bf16 v[144:147], v[64:67], a[72:75], v[144:147]
    ds_read_b64_tr_b16 v[90:91], v41 offset:10752
    v_mul_f32 v35, v197, v229
    v_mfma_f32_16x16x32_bf16 v[152:155], v[64:67], a[76:79], v[152:155]
    v_mul_f32 v34, v34, v32
    v_mul_f32 v35, v35, v33
    v_mfma_f32_16x16x32_bf16 v[132:135], v[68:71], a[64:67], v[132:135]
    ds_read_b64_tr_b16 v[92:93], v43 offset:10240
    v_cvt_pk_bf16_f32 v50, v34, v35
    v_mfma_f32_16x16x32_bf16 v[140:143], v[68:71], a[68:71], v[140:143]
    ds_read_b64_tr_b16 v[94:95], v43 offset:10752
    v_mul_f32 v36, s95, v198
    v_mfma_f32_16x16x32_bf16 v[148:151], v[68:71], a[72:75], v[148:151]
    v_exp_f32 v36, v36
    v_mfma_f32_16x16x32_bf16 v[156:159], v[68:71], a[76:79], v[156:159]
    v_mul_f32 v37, s95, v199
    v_add_f32 v36, 1.0, v36
    v_mfma_f32_16x16x32_bf16 v[160:163], v[72:75], a[64:67], v[160:163]
    v_exp_f32 v37, v37
    v_mfma_f32_16x16x32_bf16 v[168:171], v[72:75], a[68:71], v[168:171]
    v_rcp_f32 v36, v36
    v_mfma_f32_16x16x32_bf16 v[176:179], v[72:75], a[72:75], v[176:179]
    ds_read_b64_tr_b16 v[64:65], v40 offset:12288
    v_add_f32 v37, 1.0, v37
    v_mfma_f32_16x16x32_bf16 v[184:187], v[72:75], a[76:79], v[184:187]
    ds_read_b64_tr_b16 v[66:67], v40 offset:12800
    v_mul_f32 v38, v198, v230
    v_mfma_f32_16x16x32_bf16 v[164:167], v[76:79], a[64:67], v[164:167]
    v_rcp_f32 v37, v37
    v_mfma_f32_16x16x32_bf16 v[172:175], v[76:79], a[68:71], v[172:175]
    ds_read_b64_tr_b16 v[68:69], v42 offset:12288
    v_mul_f32 v39, v199, v231
    v_mfma_f32_16x16x32_bf16 v[180:183], v[76:79], a[72:75], v[180:183]
    ds_read_b64_tr_b16 v[70:71], v42 offset:12800
    v_mul_f32 v38, v38, v36
    v_mfma_f32_16x16x32_bf16 v[188:191], v[76:79], a[76:79], v[188:191]
    v_mul_f32 v39, v39, v37
    s_waitcnt lgkmcnt(4)
    v_mfma_f32_16x16x32_bf16 v[128:131], v[80:83], a[80:83], v[128:131]
    s_add_u32 s16, s94, 147456
    ds_read_b64_tr_b16 v[72:73], v40 offset:14336
    v_mfma_f32_16x16x32_bf16 v[136:139], v[80:83], a[84:87], v[136:139]
    ds_read_b64_tr_b16 v[74:75], v40 offset:14848
    v_cvt_pk_bf16_f32 v51, v38, v39
    v_mfma_f32_16x16x32_bf16 v[144:147], v[80:83], a[88:91], v[144:147]
    buffer_store_dwordx4 v[48:51], v22, s[68:71], s16 offen sc1
    v_mul_f32 v32, s95, v200
    v_mfma_f32_16x16x32_bf16 v[152:155], v[80:83], a[92:95], v[152:155]
    v_exp_f32 v32, v32
    v_mfma_f32_16x16x32_bf16 v[132:135], v[84:87], a[80:83], v[132:135]
    ds_read_b64_tr_b16 v[76:77], v42 offset:14336
    v_mul_f32 v33, s95, v201
    v_mfma_f32_16x16x32_bf16 v[140:143], v[84:87], a[84:87], v[140:143]
    v_exp_f32 v33, v33
    v_mfma_f32_16x16x32_bf16 v[148:151], v[84:87], a[88:91], v[148:151]
    ds_read_b64_tr_b16 v[78:79], v42 offset:14848
    v_add_f32 v32, 1.0, v32
    v_mfma_f32_16x16x32_bf16 v[156:159], v[84:87], a[92:95], v[156:159]
    v_rcp_f32 v32, v32
    v_mfma_f32_16x16x32_bf16 v[160:163], v[88:91], a[80:83], v[160:163]
    ds_read_b64_tr_b16 v[80:81], v41 offset:12288
    v_add_f32 v33, 1.0, v33
    v_mfma_f32_16x16x32_bf16 v[168:171], v[88:91], a[84:87], v[168:171]
    v_rcp_f32 v33, v33
    v_mfma_f32_16x16x32_bf16 v[176:179], v[88:91], a[88:91], v[176:179]
    ds_read_b64_tr_b16 v[82:83], v41 offset:12800
    v_mul_f32 v34, v200, v232
    v_mfma_f32_16x16x32_bf16 v[184:187], v[88:91], a[92:95], v[184:187]
    v_mul_f32 v35, v201, v233
    v_mul_f32 v34, v34, v32
    v_mfma_f32_16x16x32_bf16 v[164:167], v[92:95], a[80:83], v[164:167]
    ds_read_b64_tr_b16 v[84:85], v43 offset:12288
    v_mul_f32 v35, v35, v33
    v_mfma_f32_16x16x32_bf16 v[172:175], v[92:95], a[84:87], v[172:175]
    ds_read_b64_tr_b16 v[86:87], v43 offset:12800
    v_cvt_pk_bf16_f32 v52, v34, v35
    v_mfma_f32_16x16x32_bf16 v[180:183], v[92:95], a[88:91], v[180:183]
    v_mul_f32 v36, s95, v202
    v_mul_f32 v37, s95, v203
    v_mfma_f32_16x16x32_bf16 v[188:191], v[92:95], a[92:95], v[188:191]
    v_mul_f32 v38, v202, v234
    s_waitcnt lgkmcnt(4)
    v_mfma_f32_16x16x32_bf16 v[128:131], v[64:67], a[96:99], v[128:131]
    v_exp_f32 v36, v36
    v_mfma_f32_16x16x32_bf16 v[136:139], v[64:67], a[100:103], v[136:139]
    v_exp_f32 v37, v37
    v_mfma_f32_16x16x32_bf16 v[144:147], v[64:67], a[104:107], v[144:147]
    ds_read_b64_tr_b16 v[88:89], v41 offset:14336
    v_add_f32 v36, 1.0, v36
    v_mfma_f32_16x16x32_bf16 v[152:155], v[64:67], a[108:111], v[152:155]
    ds_read_b64_tr_b16 v[90:91], v41 offset:14848
    v_add_f32 v37, 1.0, v37
    v_mfma_f32_16x16x32_bf16 v[132:135], v[68:71], a[96:99], v[132:135]
    v_rcp_f32 v36, v36
    v_mfma_f32_16x16x32_bf16 v[140:143], v[68:71], a[100:103], v[140:143]
    v_rcp_f32 v37, v37
    v_mfma_f32_16x16x32_bf16 v[148:151], v[68:71], a[104:107], v[148:151]
    ds_read_b64_tr_b16 v[92:93], v43 offset:14336
    v_mul_f32 v39, v203, v235
    v_mfma_f32_16x16x32_bf16 v[156:159], v[68:71], a[108:111], v[156:159]
    ds_read_b64_tr_b16 v[94:95], v43 offset:14848
    v_mul_f32 v38, v38, v36
    v_mfma_f32_16x16x32_bf16 v[160:163], v[72:75], a[96:99], v[160:163]
    s_waitcnt vmcnt(15)
    s_barrier
    v_mfma_f32_16x16x32_bf16 v[168:171], v[72:75], a[100:103], v[168:171]
    ds_read_b64_tr_b16 v[64:65], v40 offset:28672
    v_mul_f32 v39, v39, v37
    v_mfma_f32_16x16x32_bf16 v[176:179], v[72:75], a[104:107], v[176:179]
    ds_read_b64_tr_b16 v[66:67], v40 offset:29184
    v_cvt_pk_bf16_f32 v53, v38, v39
    v_mfma_f32_16x16x32_bf16 v[184:187], v[72:75], a[108:111], v[184:187]
    v_mul_f32 v32, s95, v204
    v_mul_f32 v33, s95, v205
    v_mfma_f32_16x16x32_bf16 v[164:167], v[76:79], a[96:99], v[164:167]
    v_exp_f32 v32, v32
    v_mfma_f32_16x16x32_bf16 v[172:175], v[76:79], a[100:103], v[172:175]
    v_exp_f32 v33, v33
    v_mfma_f32_16x16x32_bf16 v[180:183], v[76:79], a[104:107], v[180:183]
    ds_read_b64_tr_b16 v[68:69], v42 offset:28672
    v_add_f32 v32, 1.0, v32
    v_mfma_f32_16x16x32_bf16 v[188:191], v[76:79], a[108:111], v[188:191]
    ds_read_b64_tr_b16 v[70:71], v42 offset:29184
    s_waitcnt lgkmcnt(4)
    v_mfma_f32_16x16x32_bf16 v[128:131], v[80:83], a[112:115], v[128:131]
    v_rcp_f32 v32, v32
    v_mfma_f32_16x16x32_bf16 v[136:139], v[80:83], a[116:119], v[136:139]
    ds_read_b64_tr_b16 v[72:73], v40 offset:30720
    v_add_f32 v33, 1.0, v33
    v_mfma_f32_16x16x32_bf16 v[144:147], v[80:83], a[120:123], v[144:147]
    v_rcp_f32 v33, v33
    v_mfma_f32_16x16x32_bf16 v[152:155], v[80:83], a[124:127], v[152:155]
    ds_read_b64_tr_b16 v[74:75], v40 offset:31232
    v_mul_f32 v34, v204, v236
    v_mfma_f32_16x16x32_bf16 v[132:135], v[84:87], a[112:115], v[132:135]
    ds_read_b64_tr_b16 v[76:77], v42 offset:30720
    v_mul_f32 v35, v205, v237
    v_mfma_f32_16x16x32_bf16 v[140:143], v[84:87], a[116:119], v[140:143]
    ds_read_b64_tr_b16 v[78:79], v42 offset:31232
    v_mul_f32 v34, v34, v32
    v_mfma_f32_16x16x32_bf16 v[148:151], v[84:87], a[120:123], v[148:151]
    v_mul_f32 v35, v35, v33
    v_cvt_pk_bf16_f32 v54, v34, v35
    v_mfma_f32_16x16x32_bf16 v[156:159], v[84:87], a[124:127], v[156:159]
    v_mul_f32 v36, s95, v206
    v_mul_f32 v37, s95, v207
    v_mfma_f32_16x16x32_bf16 v[160:163], v[88:91], a[112:115], v[160:163]
    v_exp_f32 v36, v36
    v_mfma_f32_16x16x32_bf16 v[168:171], v[88:91], a[116:119], v[168:171]
    v_exp_f32 v37, v37
    v_mfma_f32_16x16x32_bf16 v[176:179], v[88:91], a[120:123], v[176:179]
    ds_read_b64_tr_b16 v[80:81], v41 offset:28672
    v_add_f32 v36, 1.0, v36
    v_mfma_f32_16x16x32_bf16 v[184:187], v[88:91], a[124:127], v[184:187]
    ds_read_b64_tr_b16 v[82:83], v41 offset:29184
    v_add_f32 v37, 1.0, v37
    v_mfma_f32_16x16x32_bf16 v[164:167], v[92:95], a[112:115], v[164:167]
    v_rcp_f32 v36, v36
    v_mfma_f32_16x16x32_bf16 v[172:175], v[92:95], a[116:119], v[172:175]
    v_rcp_f32 v37, v37
    v_mfma_f32_16x16x32_bf16 v[180:183], v[92:95], a[120:123], v[180:183]
    ds_read_b64_tr_b16 v[84:85], v43 offset:28672
    v_mul_f32 v38, v206, v238
    v_mfma_f32_16x16x32_bf16 v[188:191], v[92:95], a[124:127], v[188:191]
    ds_read_b64_tr_b16 v[86:87], v43 offset:29184
    s_waitcnt lgkmcnt(4)
    v_mfma_f32_16x16x32_bf16 v[128:131], v[64:67], a[128:131], v[128:131]
    ds_read_b64_tr_b16 v[88:89], v41 offset:30720
    v_mul_f32 v39, v207, v239
    v_mfma_f32_16x16x32_bf16 v[136:139], v[64:67], a[132:135], v[136:139]
    ds_read_b64_tr_b16 v[90:91], v41 offset:31232
    v_mul_f32 v38, v38, v36
    v_mfma_f32_16x16x32_bf16 v[144:147], v[64:67], a[136:139], v[144:147]
    v_mul_f32 v39, v39, v37
    s_add_u32 s16, s94, 148480
    v_mfma_f32_16x16x32_bf16 v[152:155], v[64:67], a[140:143], v[152:155]
    v_cvt_pk_bf16_f32 v55, v38, v39
    v_mul_f32 v32, s95, v208
    v_mfma_f32_16x16x32_bf16 v[132:135], v[68:71], a[128:131], v[132:135]
    buffer_store_dwordx4 v[52:55], v22, s[68:71], s16 offen sc1
    ds_read_b64_tr_b16 v[92:93], v43 offset:30720
    v_mfma_f32_16x16x32_bf16 v[140:143], v[68:71], a[132:135], v[140:143]
    v_exp_f32 v32, v32
    v_mfma_f32_16x16x32_bf16 v[148:151], v[68:71], a[136:139], v[148:151]
    ds_read_b64_tr_b16 v[94:95], v43 offset:31232
    v_mul_f32 v33, s95, v209
    v_mfma_f32_16x16x32_bf16 v[156:159], v[68:71], a[140:143], v[156:159]
    v_exp_f32 v33, v33
    v_mfma_f32_16x16x32_bf16 v[160:163], v[72:75], a[128:131], v[160:163]
    ds_read_b64_tr_b16 v[64:65], v40 offset:16384
    v_add_f32 v32, 1.0, v32
    v_mfma_f32_16x16x32_bf16 v[168:171], v[72:75], a[132:135], v[168:171]
    v_rcp_f32 v32, v32
    v_mfma_f32_16x16x32_bf16 v[176:179], v[72:75], a[136:139], v[176:179]
    ds_read_b64_tr_b16 v[66:67], v40 offset:16896
    v_add_f32 v33, 1.0, v33
    v_mfma_f32_16x16x32_bf16 v[184:187], v[72:75], a[140:143], v[184:187]
    v_rcp_f32 v33, v33
    v_mfma_f32_16x16x32_bf16 v[164:167], v[76:79], a[128:131], v[164:167]
    ds_read_b64_tr_b16 v[68:69], v42 offset:16384
    v_mul_f32 v34, v208, v240
    v_mfma_f32_16x16x32_bf16 v[172:175], v[76:79], a[132:135], v[172:175]
    ds_read_b64_tr_b16 v[70:71], v42 offset:16896
    v_mul_f32 v35, v209, v241
    v_mfma_f32_16x16x32_bf16 v[180:183], v[76:79], a[136:139], v[180:183]
    v_mul_f32 v34, v34, v32
    v_mul_f32 v35, v35, v33
    v_mfma_f32_16x16x32_bf16 v[188:191], v[76:79], a[140:143], v[188:191]
    v_cvt_pk_bf16_f32 v56, v34, v35
    s_waitcnt lgkmcnt(4)
    v_mfma_f32_16x16x32_bf16 v[128:131], v[80:83], a[144:147], v[128:131]
    ds_read_b64_tr_b16 v[72:73], v40 offset:18432
    v_mul_f32 v36, s95, v210
    v_mfma_f32_16x16x32_bf16 v[136:139], v[80:83], a[148:151], v[136:139]
    v_exp_f32 v36, v36
    v_mfma_f32_16x16x32_bf16 v[144:147], v[80:83], a[152:155], v[144:147]
    ds_read_b64_tr_b16 v[74:75], v40 offset:18944
    v_mul_f32 v37, s95, v211
    v_mfma_f32_16x16x32_bf16 v[152:155], v[80:83], a[156:159], v[152:155]
    v_exp_f32 v37, v37
    v_mfma_f32_16x16x32_bf16 v[132:135], v[84:87], a[144:147], v[132:135]
    ds_read_b64_tr_b16 v[76:77], v42 offset:18432
    v_add_f32 v36, 1.0, v36
    v_mfma_f32_16x16x32_bf16 v[140:143], v[84:87], a[148:151], v[140:143]
    v_rcp_f32 v36, v36
    v_mfma_f32_16x16x32_bf16 v[148:151], v[84:87], a[152:155], v[148:151]
    ds_read_b64_tr_b16 v[78:79], v42 offset:18944
    v_add_f32 v37, 1.0, v37
    v_mfma_f32_16x16x32_bf16 v[156:159], v[84:87], a[156:159], v[156:159]
    v_rcp_f32 v37, v37
    v_mfma_f32_16x16x32_bf16 v[160:163], v[88:91], a[144:147], v[160:163]
    ds_read_b64_tr_b16 v[80:81], v41 offset:16384
    v_mul_f32 v38, v210, v242
    v_mfma_f32_16x16x32_bf16 v[168:171], v[88:91], a[148:151], v[168:171]
    ds_read_b64_tr_b16 v[82:83], v41 offset:16896
    v_mul_f32 v39, v211, v243
    v_mfma_f32_16x16x32_bf16 v[176:179], v[88:91], a[152:155], v[176:179]
    v_mul_f32 v38, v38, v36
    v_mul_f32 v39, v39, v37
    v_mfma_f32_16x16x32_bf16 v[184:187], v[88:91], a[156:159], v[184:187]
    v_cvt_pk_bf16_f32 v57, v38, v39
    v_mul_f32 v32, s95, v212
    v_mfma_f32_16x16x32_bf16 v[164:167], v[92:95], a[144:147], v[164:167]
    v_exp_f32 v32, v32
    v_mfma_f32_16x16x32_bf16 v[172:175], v[92:95], a[148:151], v[172:175]
    ds_read_b64_tr_b16 v[84:85], v43 offset:16384
    v_mul_f32 v33, s95, v213
    v_mfma_f32_16x16x32_bf16 v[180:183], v[92:95], a[152:155], v[180:183]
    s_branch L_sskip5
L_stub5:
    s_setpc_b64 s[100:101]
L_sskip5:
    v_exp_f32 v33, v33
    v_mfma_f32_16x16x32_bf16 v[188:191], v[92:95], a[156:159], v[188:191]
    ds_read_b64_tr_b16 v[86:87], v43 offset:16896
    s_waitcnt lgkmcnt(4)
    v_mfma_f32_16x16x32_bf16 v[128:131], v[64:67], a[160:163], v[128:131]
    global_load_dword v31, v30, s[48:49] offset:512 sc1
    ds_read_b64_tr_b16 v[88:89], v41 offset:18432
    v_mfma_f32_16x16x32_bf16 v[136:139], v[64:67], a[164:167], v[136:139]
    buffer_store_dwordx4 v[2:5], v22, s[68:71], s78 offen offset:0 sc1
    ds_read_b64_tr_b16 v[90:91], v41 offset:18944
    v_mfma_f32_16x16x32_bf16 v[144:147], v[64:67], a[168:171], v[144:147]
    v_add_f32 v32, 1.0, v32
    v_add_f32 v33, 1.0, v33
    v_mfma_f32_16x16x32_bf16 v[152:155], v[64:67], a[172:175], v[152:155]
    v_rcp_f32 v32, v32
    v_mfma_f32_16x16x32_bf16 v[132:135], v[68:71], a[160:163], v[132:135]
    v_rcp_f32 v33, v33
    v_mfma_f32_16x16x32_bf16 v[140:143], v[68:71], a[164:167], v[140:143]
    ds_read_b64_tr_b16 v[92:93], v43 offset:18432
    v_mul_f32 v34, v212, v244
    v_mfma_f32_16x16x32_bf16 v[148:151], v[68:71], a[168:171], v[148:151]
    ds_read_b64_tr_b16 v[94:95], v43 offset:18944
    v_mul_f32 v35, v213, v245
    v_mfma_f32_16x16x32_bf16 v[156:159], v[68:71], a[172:175], v[156:159]
    v_mul_f32 v34, v34, v32
    v_mul_f32 v35, v35, v33
    v_mfma_f32_16x16x32_bf16 v[160:163], v[72:75], a[160:163], v[160:163]
    s_waitcnt vmcnt(5)
    s_barrier
    v_mfma_f32_16x16x32_bf16 v[168:171], v[72:75], a[164:167], v[168:171]
    ds_read_b64_tr_b16 v[64:65], v40 offset:20480
    v_cvt_pk_bf16_f32 v58, v34, v35
    v_mfma_f32_16x16x32_bf16 v[176:179], v[72:75], a[168:171], v[176:179]
    ds_read_b64_tr_b16 v[66:67], v40 offset:20992
    v_mul_f32 v36, s95, v214
    v_mfma_f32_16x16x32_bf16 v[184:187], v[72:75], a[172:175], v[184:187]
    v_exp_f32 v36, v36
    v_mfma_f32_16x16x32_bf16 v[164:167], v[76:79], a[160:163], v[164:167]
    ds_read_b64_tr_b16 v[68:69], v42 offset:20480
    v_mul_f32 v37, s95, v215
    v_mfma_f32_16x16x32_bf16 v[172:175], v[76:79], a[164:167], v[172:175]
    v_exp_f32 v37, v37
    v_mfma_f32_16x16x32_bf16 v[180:183], v[76:79], a[168:171], v[180:183]
    ds_read_b64_tr_b16 v[70:71], v42 offset:20992
    v_add_f32 v36, 1.0, v36
    v_mfma_f32_16x16x32_bf16 v[188:191], v[76:79], a[172:175], v[188:191]
    v_add_f32 v37, 1.0, v37
    s_waitcnt lgkmcnt(4)
    v_mfma_f32_16x16x32_bf16 v[128:131], v[80:83], a[176:179], v[128:131]
    buffer_store_dwordx4 v[2:5], v22, s[68:71], s78 offen offset:1024 sc1
    ds_read_b64_tr_b16 v[72:73], v40 offset:22528
    v_mfma_f32_16x16x32_bf16 v[136:139], v[80:83], a[180:183], v[136:139]
    v_rcp_f32 v36, v36
    v_mfma_f32_16x16x32_bf16 v[144:147], v[80:83], a[184:187], v[144:147]
    v_rcp_f32 v37, v37
    v_mfma_f32_16x16x32_bf16 v[152:155], v[80:83], a[188:191], v[152:155]
    ds_read_b64_tr_b16 v[74:75], v40 offset:23040
    v_mul_f32 v38, v214, v246
    v_mfma_f32_16x16x32_bf16 v[132:135], v[84:87], a[176:179], v[132:135]
    ds_read_b64_tr_b16 v[76:77], v42 offset:22528
    v_mul_f32 v39, v215, v247
    v_mfma_f32_16x16x32_bf16 v[140:143], v[84:87], a[180:183], v[140:143]
    ds_read_b64_tr_b16 v[78:79], v42 offset:23040
    v_mul_f32 v38, v38, v36
    v_mfma_f32_16x16x32_bf16 v[148:151], v[84:87], a[184:187], v[148:151]
    v_mul_f32 v39, v39, v37
    s_add_u32 s16, s94, 516096
    v_mfma_f32_16x16x32_bf16 v[156:159], v[84:87], a[188:191], v[156:159]
    v_cvt_pk_bf16_f32 v59, v38, v39
    v_mul_f32 v32, s95, v216
    v_mfma_f32_16x16x32_bf16 v[160:163], v[88:91], a[176:179], v[160:163]
    buffer_store_dwordx4 v[56:59], v22, s[68:71], s16 offen sc1
    ds_read_b64_tr_b16 v[80:81], v41 offset:20480
    v_mfma_f32_16x16x32_bf16 v[168:171], v[88:91], a[180:183], v[168:171]
    v_exp_f32 v32, v32
    v_mfma_f32_16x16x32_bf16 v[176:179], v[88:91], a[184:187], v[176:179]
    ds_read_b64_tr_b16 v[82:83], v41 offset:20992
    v_mul_f32 v33, s95, v217
    v_mfma_f32_16x16x32_bf16 v[184:187], v[88:91], a[188:191], v[184:187]
    v_exp_f32 v33, v33
    v_mfma_f32_16x16x32_bf16 v[164:167], v[92:95], a[176:179], v[164:167]
    ds_read_b64_tr_b16 v[84:85], v43 offset:20480
    v_add_f32 v32, 1.0, v32
    v_mfma_f32_16x16x32_bf16 v[172:175], v[92:95], a[180:183], v[172:175]
    v_rcp_f32 v32, v32
    v_mfma_f32_16x16x32_bf16 v[180:183], v[92:95], a[184:187], v[180:183]
    ds_read_b64_tr_b16 v[86:87], v43 offset:20992
    v_add_f32 v33, 1.0, v33
    v_mfma_f32_16x16x32_bf16 v[188:191], v[92:95], a[188:191], v[188:191]
    v_mul_f32 v34, v216, v248
    s_waitcnt lgkmcnt(4)
    v_mfma_f32_16x16x32_bf16 v[128:131], v[64:67], a[192:195], v[128:131]
    buffer_store_dwordx4 v[2:5], v22, s[68:71], s78 offen offset:2048 sc1
    ds_read_b64_tr_b16 v[88:89], v41 offset:22528
    v_mfma_f32_16x16x32_bf16 v[136:139], v[64:67], a[196:199], v[136:139]
    v_rcp_f32 v33, v33
    v_mfma_f32_16x16x32_bf16 v[144:147], v[64:67], a[200:203], v[144:147]
    ds_read_b64_tr_b16 v[90:91], v41 offset:23040
    v_mul_f32 v35, v217, v249
    v_mfma_f32_16x16x32_bf16 v[152:155], v[64:67], a[204:207], v[152:155]
    v_mul_f32 v34, v34, v32
    v_mul_f32 v35, v35, v33
    v_mfma_f32_16x16x32_bf16 v[132:135], v[68:71], a[192:195], v[132:135]
    ds_read_b64_tr_b16 v[92:93], v43 offset:22528
    v_cvt_pk_bf16_f32 v60, v34, v35
    v_mfma_f32_16x16x32_bf16 v[140:143], v[68:71], a[196:199], v[140:143]
    ds_read_b64_tr_b16 v[94:95], v43 offset:23040
    v_mul_f32 v36, s95, v218
    v_mfma_f32_16x16x32_bf16 v[148:151], v[68:71], a[200:203], v[148:151]
    v_exp_f32 v36, v36
    v_mfma_f32_16x16x32_bf16 v[156:159], v[68:71], a[204:207], v[156:159]
    v_mul_f32 v37, s95, v219
    v_add_f32 v36, 1.0, v36
    v_mfma_f32_16x16x32_bf16 v[160:163], v[72:75], a[192:195], v[160:163]
    buffer_store_dwordx4 v[2:5], v22, s[68:71], s79 offen offset:0 sc1
    ds_read_b64_tr_b16 v[64:65], v40 offset:32768
    v_mfma_f32_16x16x32_bf16 v[168:171], v[72:75], a[196:199], v[168:171]
    v_exp_f32 v37, v37
    v_mfma_f32_16x16x32_bf16 v[176:179], v[72:75], a[200:203], v[176:179]
    v_rcp_f32 v36, v36
    v_mfma_f32_16x16x32_bf16 v[184:187], v[72:75], a[204:207], v[184:187]
    ds_read_b64_tr_b16 v[66:67], v40 offset:33280
    v_add_f32 v37, 1.0, v37
    v_mfma_f32_16x16x32_bf16 v[164:167], v[76:79], a[192:195], v[164:167]
    v_rcp_f32 v37, v37
    v_mfma_f32_16x16x32_bf16 v[172:175], v[76:79], a[196:199], v[172:175]
    ds_read_b64_tr_b16 v[68:69], v42 offset:32768
    v_mul_f32 v38, v218, v250
    v_mfma_f32_16x16x32_bf16 v[180:183], v[76:79], a[200:203], v[180:183]
    ds_read_b64_tr_b16 v[70:71], v42 offset:33280
    v_mul_f32 v39, v219, v251
    v_mfma_f32_16x16x32_bf16 v[188:191], v[76:79], a[204:207], v[188:191]
    v_mul_f32 v38, v38, v36
    s_waitcnt lgkmcnt(4)
    v_mfma_f32_16x16x32_bf16 v[128:131], v[80:83], a[208:211], v[128:131]
    ds_read_b64_tr_b16 v[72:73], v40 offset:34816
    v_mul_f32 v39, v39, v37
    v_mfma_f32_16x16x32_bf16 v[136:139], v[80:83], a[212:215], v[136:139]
    ds_read_b64_tr_b16 v[74:75], v40 offset:35328
    v_cvt_pk_bf16_f32 v61, v38, v39
    v_mfma_f32_16x16x32_bf16 v[144:147], v[80:83], a[216:219], v[144:147]
    v_mul_f32 v32, s95, v220
    v_mul_f32 v33, s95, v221
    v_mfma_f32_16x16x32_bf16 v[152:155], v[80:83], a[220:223], v[152:155]
    v_exp_f32 v32, v32
    v_mfma_f32_16x16x32_bf16 v[132:135], v[84:87], a[208:211], v[132:135]
    buffer_store_dwordx4 v[2:5], v22, s[68:71], s80 offen offset:0 sc1
    ds_read_b64_tr_b16 v[76:77], v42 offset:34816
    v_mfma_f32_16x16x32_bf16 v[140:143], v[84:87], a[212:215], v[140:143]
    v_exp_f32 v33, v33
    v_mfma_f32_16x16x32_bf16 v[148:151], v[84:87], a[216:219], v[148:151]
    ds_read_b64_tr_b16 v[78:79], v42 offset:35328
    v_add_f32 v32, 1.0, v32
    v_mfma_f32_16x16x32_bf16 v[156:159], v[84:87], a[220:223], v[156:159]
    v_rcp_f32 v32, v32
    v_mfma_f32_16x16x32_bf16 v[160:163], v[88:91], a[208:211], v[160:163]
    ds_read_b64_tr_b16 v[80:81], v41 offset:32768
    v_add_f32 v33, 1.0, v33
    v_mfma_f32_16x16x32_bf16 v[168:171], v[88:91], a[212:215], v[168:171]
    v_rcp_f32 v33, v33
    v_mfma_f32_16x16x32_bf16 v[176:179], v[88:91], a[216:219], v[176:179]
    ds_read_b64_tr_b16 v[82:83], v41 offset:33280
    v_mul_f32 v34, v220, v252
    v_mfma_f32_16x16x32_bf16 v[184:187], v[88:91], a[220:223], v[184:187]
    v_mul_f32 v35, v221, v253
    v_mul_f32 v34, v34, v32
    v_mfma_f32_16x16x32_bf16 v[164:167], v[92:95], a[208:211], v[164:167]
    ds_read_b64_tr_b16 v[84:85], v43 offset:32768
    v_mul_f32 v35, v35, v33
    v_mfma_f32_16x16x32_bf16 v[172:175], v[92:95], a[212:215], v[172:175]
    ds_read_b64_tr_b16 v[86:87], v43 offset:33280
    v_cvt_pk_bf16_f32 v62, v34, v35
    v_mfma_f32_16x16x32_bf16 v[180:183], v[92:95], a[216:219], v[180:183]
    v_mul_f32 v36, s95, v222
    v_mul_f32 v37, s95, v223
    v_mfma_f32_16x16x32_bf16 v[188:191], v[92:95], a[220:223], v[188:191]
    v_mul_f32 v38, v222, v254
    s_waitcnt lgkmcnt(4)
    v_mfma_f32_16x16x32_bf16 v[128:131], v[64:67], a[224:227], v[128:131]
    s_waitcnt vmcnt(6)
    v_cmp_gt_u32 vcc, 1, v31
    s_cbranch_vccnz L_poll2
L_fok2:
    v_mfma_f32_16x16x32_bf16 v[136:139], v[64:67], a[228:231], v[136:139]
    v_exp_f32 v36, v36
    v_mfma_f32_16x16x32_bf16 v[144:147], v[64:67], a[232:235], v[144:147]
    ds_read_b64_tr_b16 v[88:89], v41 offset:34816
    v_add_f32 v36, 1.0, v36
    v_mfma_f32_16x16x32_bf16 v[152:155], v[64:67], a[236:239], v[152:155]
    ds_read_b64_tr_b16 v[90:91], v41 offset:35328
    v_mul_f32 v39, v223, v255
    v_mfma_f32_16x16x32_bf16 v[132:135], v[68:71], a[224:227], v[132:135]
    v_exp_f32 v37, v37
    v_mfma_f32_16x16x32_bf16 v[140:143], v[68:71], a[228:231], v[140:143]
    v_rcp_f32 v36, v36
    v_mfma_f32_16x16x32_bf16 v[148:151], v[68:71], a[232:235], v[148:151]
    ds_read_b64_tr_b16 v[92:93], v43 offset:34816
    v_add_f32 v37, 1.0, v37
    v_mfma_f32_16x16x32_bf16 v[156:159], v[68:71], a[236:239], v[156:159]
    ds_read_b64_tr_b16 v[94:95], v43 offset:35328
    v_mul_f32 v38, v38, v36
    v_mfma_f32_16x16x32_bf16 v[160:163], v[72:75], a[224:227], v[160:163]
    v_rcp_f32 v37, v37
    v_mfma_f32_16x16x32_bf16 v[168:171], v[72:75], a[228:231], v[168:171]
    v_mul_f32 v39, v39, v37
    s_mul_i32 s53, s99, 384
    v_mfma_f32_16x16x32_bf16 v[176:179], v[72:75], a[232:235], v[176:179]
    s_add_u32 s16, s94, 517120
    ds_read_b64_tr_b16 v[64:65], v40 offset:36864
    v_mfma_f32_16x16x32_bf16 v[184:187], v[72:75], a[236:239], v[184:187]
    ds_read_b64_tr_b16 v[66:67], v40 offset:37376
    v_cvt_pk_bf16_f32 v63, v38, v39
    v_mfma_f32_16x16x32_bf16 v[164:167], v[76:79], a[224:227], v[164:167]
    buffer_store_dwordx4 v[60:63], v22, s[68:71], s16 offen sc1
    s_and_b32 s54, s82, 2
    v_mfma_f32_16x16x32_bf16 v[172:175], v[76:79], a[228:231], v[172:175]
    s_lshl_b32 s54, s54, 7
    s_add_u32 s87, s53, s54
    v_mfma_f32_16x16x32_bf16 v[180:183], v[76:79], a[232:235], v[180:183]
    s_sub_u32 s85, s53, s54
    ds_read_b64_tr_b16 v[68:69], v42 offset:36864
    v_mfma_f32_16x16x32_bf16 v[188:191], v[76:79], a[236:239], v[188:191]
    ds_read_b64_tr_b16 v[70:71], v42 offset:37376
    s_waitcnt lgkmcnt(4)
    v_mfma_f32_16x16x32_bf16 v[128:131], v[80:83], a[240:243], v[128:131]
    s_add_u32 s85, s85, 256
    s_add_u32 s86, s53, 128
    v_mfma_f32_16x16x32_bf16 v[136:139], v[80:83], a[244:247], v[136:139]
    s_mul_i32 s53, s82, 147456
    s_add_u32 s88, s85, s53
    v_mfma_f32_16x16x32_bf16 v[144:147], v[80:83], a[248:251], v[144:147]
    s_add_u32 s89, s86, s53
    ds_read_b64_tr_b16 v[72:73], v40 offset:38912
    v_mfma_f32_16x16x32_bf16 v[152:155], v[80:83], a[252:255], v[152:155]
    s_add_u32 s90, s87, s53
    ds_read_b64_tr_b16 v[74:75], v40 offset:39424
    v_mfma_f32_16x16x32_bf16 v[132:135], v[84:87], a[240:243], v[132:135]
    s_lshl_b32 s53, s53, 3
    s_add_u32 s85, s85, s53
    v_mfma_f32_16x16x32_bf16 v[140:143], v[84:87], a[244:247], v[140:143]
    s_add_u32 s86, s86, s53
    s_add_u32 s87, s87, s53
    v_mfma_f32_16x16x32_bf16 v[148:151], v[84:87], a[248:251], v[148:151]
    ds_read_b64_tr_b16 v[76:77], v42 offset:38912
    v_lshrrev_b32 v3, 3, v0
    v_mfma_f32_16x16x32_bf16 v[156:159], v[84:87], a[252:255], v[156:159]
    s_lshl_b32 s53, s50, 3
    ds_read_b64_tr_b16 v[78:79], v42 offset:39424
    v_mfma_f32_16x16x32_bf16 v[160:163], v[88:91], a[240:243], v[160:163]
    v_add_u32 v3, s53, v3
    v_mul_u32_u24 v3, 1152, v3
    v_mfma_f32_16x16x32_bf16 v[168:171], v[88:91], a[244:247], v[168:171]
    v_bfe_u32 v4, v0, 4, 1
    v_lshlrev_b32 v4, 2, v4
    v_mfma_f32_16x16x32_bf16 v[176:179], v[88:91], a[248:251], v[176:179]
    ds_read_b64_tr_b16 v[80:81], v41 offset:36864
    v_and_b32 v28, 7, v0
    v_mfma_f32_16x16x32_bf16 v[184:187], v[88:91], a[252:255], v[184:187]
    ds_read_b64_tr_b16 v[82:83], v41 offset:37376
    v_xor_b32 v4, v4, v28
    v_mfma_f32_16x16x32_bf16 v[164:167], v[92:95], a[240:243], v[164:167]
    v_lshl_add_u32 v28, v4, 4, v3
    v_and_b32 v4, 32, v0
    v_mfma_f32_16x16x32_bf16 v[172:175], v[92:95], a[244:247], v[172:175]
    v_xor_b32 v28, v28, v4
    v_lshrrev_b32 v3, 5, v0
    v_mfma_f32_16x16x32_bf16 v[180:183], v[92:95], a[248:251], v[180:183]
    ds_read_b64_tr_b16 v[84:85], v43 offset:36864
    v_mul_u32_u24 v3, 40960, v3
    v_mfma_f32_16x16x32_bf16 v[188:191], v[92:95], a[252:255], v[188:191]
    ds_read_b64_tr_b16 v[86:87], v43 offset:37376
    s_waitcnt lgkmcnt(4)
    v_mfma_f32_16x16x32_bf16 v[128:131], v[64:67], v[96:99], v[128:131]
    global_load_dword v31, v30, s[48:49] offset:1024 sc1
    v_bfe_u32 v4, v0, 2, 3
    v_mfma_f32_16x16x32_bf16 v[136:139], v[64:67], v[100:103], v[136:139]
    global_load_dword v19, v[20:21], off
    v_mfma_f32_16x16x32_bf16 v[144:147], v[64:67], v[104:107], v[144:147]
    ds_read_b64_tr_b16 v[88:89], v41 offset:38912
    v_lshl_add_u32 v3, v4, 7, v3
    v_mfma_f32_16x16x32_bf16 v[152:155], v[64:67], v[108:111], v[152:155]
    ds_read_b64_tr_b16 v[90:91], v41 offset:39424
    v_bfe_u32 v4, v0, 4, 1
    v_mfma_f32_16x16x32_bf16 v[132:135], v[68:71], v[96:99], v[132:135]
    v_lshl_add_u32 v3, v4, 5, v3
    v_and_b32 v4, 3, v0
    v_mfma_f32_16x16x32_bf16 v[140:143], v[68:71], v[100:103], v[140:143]
    v_lshl_add_u32 v3, v4, 3, v3
    v_bfe_u32 v4, v0, 3, 1
    v_mfma_f32_16x16x32_bf16 v[148:151], v[68:71], v[104:107], v[148:151]
    ds_read_b64_tr_b16 v[92:93], v43 offset:38912
    v_lshl_add_u32 v2, v4, 6, v3
    v_mfma_f32_16x16x32_bf16 v[156:159], v[68:71], v[108:111], v[156:159]
    ds_read_b64_tr_b16 v[94:95], v43 offset:39424
    v_add_u32 v7, 72704, v28
    v_mfma_f32_16x16x32_bf16 v[160:163], v[72:75], v[96:99], v[160:163]
    v_add_u32 v8, 145408, v28
    v_add_u32 v9, 293888, v28
    v_mfma_f32_16x16x32_bf16 v[168:171], v[72:75], v[100:103], v[168:171]
    s_lshr_b32 s54, s54, 3
    s_and_b32 s53, s82, 1
    v_mfma_f32_16x16x32_bf16 v[176:179], v[72:75], v[104:107], v[176:179]
    s_lshl_b32 s53, s53, 6
    ds_read_b64_tr_b16 v[64:65], v44 offset:0
    v_mfma_f32_16x16x32_bf16 v[184:187], v[72:75], v[108:111], v[184:187]
    s_add_u32 s54, s54, s53
    ds_read_b64_tr_b16 v[66:67], v44 offset:512
    v_mfma_f32_16x16x32_bf16 v[164:167], v[76:79], v[96:99], v[164:167]
    v_xor_b32 v2, s54, v2
    v_add_u32 v3, 81920, v2
    v_mfma_f32_16x16x32_bf16 v[172:175], v[76:79], v[100:103], v[172:175]
    v_xor_b32 v4, 32, v2
    v_add_u32 v5, 81920, v4
    v_mfma_f32_16x16x32_bf16 v[180:183], v[76:79], v[104:107], v[180:183]
    ds_read_b64_tr_b16 v[68:69], v46 offset:0
    v_xor_b32 v12, 64, v2
    v_mfma_f32_16x16x32_bf16 v[188:191], v[76:79], v[108:111], v[188:191]
    ds_read_b64_tr_b16 v[70:71], v46 offset:512
    s_waitcnt lgkmcnt(4)
    v_mfma_f32_16x16x32_bf16 v[128:131], v[80:83], v[112:115], v[128:131]
    v_add_u32 v13, 81920, v12
    v_xor_b32 v14, 96, v2
    v_mfma_f32_16x16x32_bf16 v[136:139], v[80:83], v[116:119], v[136:139]
    ds_read_b64_tr_b16 v[72:73], v44 offset:2048
    v_add_u32 v15, 81920, v14
    v_mfma_f32_16x16x32_bf16 v[144:147], v[80:83], v[120:123], v[144:147]
    ds_read_b64_tr_b16 v[74:75], v44 offset:2560
    v_mfma_f32_16x16x32_bf16 v[152:155], v[80:83], v[124:127], v[152:155]
    v_mfma_f32_16x16x32_bf16 v[132:135], v[84:87], v[112:115], v[132:135]
    ds_read_b64_tr_b16 v[76:77], v46 offset:2048
    v_mfma_f32_16x16x32_bf16 v[140:143], v[84:87], v[116:119], v[140:143]
    ds_read_b64_tr_b16 v[78:79], v46 offset:2560
    v_mfma_f32_16x16x32_bf16 v[148:151], v[84:87], v[120:123], v[148:151]
    v_mfma_f32_16x16x32_bf16 v[156:159], v[84:87], v[124:127], v[156:159]
    v_mfma_f32_16x16x32_bf16 v[160:163], v[88:91], v[112:115], v[160:163]
    ds_read_b64_tr_b16 v[80:81], v45 offset:0
    v_mfma_f32_16x16x32_bf16 v[168:171], v[88:91], v[116:119], v[168:171]
    ds_read_b64_tr_b16 v[82:83], v45 offset:512
    v_mfma_f32_16x16x32_bf16 v[176:179], v[88:91], v[120:123], v[176:179]
    v_mfma_f32_16x16x32_bf16 v[184:187], v[88:91], v[124:127], v[184:187]
    v_mfma_f32_16x16x32_bf16 v[164:167], v[92:95], v[112:115], v[164:167]
    ds_read_b64_tr_b16 v[84:85], v47 offset:0
    v_mfma_f32_16x16x32_bf16 v[172:175], v[92:95], v[116:119], v[172:175]
    ds_read_b64_tr_b16 v[86:87], v47 offset:512
    v_mfma_f32_16x16x32_bf16 v[180:183], v[92:95], v[120:123], v[180:183]
    v_mfma_f32_16x16x32_bf16 v[188:191], v[92:95], v[124:127], v[188:191]
    s_waitcnt lgkmcnt(4)
    v_mfma_f32_16x16x32_bf16 v[192:195], v[64:67], a[0:3], 0
    s_add_u32 m0, s52, 24576
    s_add_u32 s93, s85, 36864
    v_mfma_f32_16x16x32_bf16 v[200:203], v[64:67], a[4:7], 0
    buffer_load_dwordx4 v28, s[72:75], s93 offen offset:0 lds
    v_mfma_f32_16x16x32_bf16 v[208:211], v[64:67], a[8:11], 0
    ds_read_b64_tr_b16 v[88:89], v45 offset:2048
    v_mfma_f32_16x16x32_bf16 v[216:219], v[64:67], a[12:15], 0
    ds_read_b64_tr_b16 v[90:91], v45 offset:2560
    v_mfma_f32_16x16x32_bf16 v[196:199], v[68:71], a[0:3], 0
    buffer_load_dwordx4 v7, s[72:75], s93 offen offset:1024 lds
    v_mfma_f32_16x16x32_bf16 v[204:207], v[68:71], a[4:7], 0
    ds_read_b64_tr_b16 v[92:93], v47 offset:2048
    v_mfma_f32_16x16x32_bf16 v[212:215], v[68:71], a[8:11], 0
    ds_read_b64_tr_b16 v[94:95], v47 offset:2560
    v_mfma_f32_16x16x32_bf16 v[220:223], v[68:71], a[12:15], 0
    v_mfma_f32_16x16x32_bf16 v[224:227], v[72:75], a[0:3], 0
    buffer_load_dwordx4 v8, s[72:75], s93 offen offset:2048 lds
    v_mfma_f32_16x16x32_bf16 v[232:235], v[72:75], a[4:7], 0
    ds_read_b64_tr_b16 v[64:65], v44 offset:4096
    v_mul_f32 v32, s95, v128
    v_mfma_f32_16x16x32_bf16 v[240:243], v[72:75], a[8:11], 0
    v_exp_f32 v32, v32
    v_mfma_f32_16x16x32_bf16 v[248:251], v[72:75], a[12:15], 0
    ds_read_b64_tr_b16 v[66:67], v44 offset:4608
    v_mul_f32 v33, s95, v129
    v_mfma_f32_16x16x32_bf16 v[228:231], v[76:79], a[0:3], 0
    v_exp_f32 v33, v33
    v_mfma_f32_16x16x32_bf16 v[236:239], v[76:79], a[4:7], 0
    ds_read_b64_tr_b16 v[68:69], v46 offset:4096
    v_add_f32 v32, 1.0, v32
    v_mfma_f32_16x16x32_bf16 v[244:247], v[76:79], a[8:11], 0
    v_rcp_f32 v32, v32
    v_mfma_f32_16x16x32_bf16 v[252:255], v[76:79], a[12:15], 0
    ds_read_b64_tr_b16 v[70:71], v46 offset:4608
    s_waitcnt lgkmcnt(4)
    v_mfma_f32_16x16x32_bf16 v[192:195], v[80:83], a[16:19], v[192:195]
    s_add_u32 s83, s76, 49152
    ds_read_b64_tr_b16 v[72:73], v44 offset:6144
    v_mfma_f32_16x16x32_bf16 v[200:203], v[80:83], a[20:23], v[200:203]
    buffer_load_dwordx4 a[0:3], v22, s[68:71], s83 offen offset:0 sc1
    v_mfma_f32_16x16x32_bf16 v[208:211], v[80:83], a[24:27], v[208:211]
    ds_read_b64_tr_b16 v[74:75], v44 offset:6656
    v_add_f32 v33, 1.0, v33
    v_mfma_f32_16x16x32_bf16 v[216:219], v[80:83], a[28:31], v[216:219]
    v_rcp_f32 v33, v33
    v_mfma_f32_16x16x32_bf16 v[196:199], v[84:87], a[16:19], v[196:199]
    buffer_load_dwordx4 a[4:7], v22, s[68:71], s83 offen offset:1024 sc1
    v_mfma_f32_16x16x32_bf16 v[204:207], v[84:87], a[20:23], v[204:207]
    ds_read_b64_tr_b16 v[76:77], v46 offset:6144
    v_mul_f32 v34, v128, v160
    v_mfma_f32_16x16x32_bf16 v[212:215], v[84:87], a[24:27], v[212:215]
    ds_read_b64_tr_b16 v[78:79], v46 offset:6656
    v_mul_f32 v35, v129, v161
    v_mfma_f32_16x16x32_bf16 v[220:223], v[84:87], a[28:31], v[220:223]
    v_mul_f32 v34, v34, v32
    v_mul_f32 v35, v35, v33
    v_mfma_f32_16x16x32_bf16 v[224:227], v[88:91], a[16:19], v[224:227]
    buffer_load_dwordx4 a[8:11], v22, s[68:71], s83 offen offset:2048 sc1
    v_mfma_f32_16x16x32_bf16 v[232:235], v[88:91], a[20:23], v[232:235]
    ds_read_b64_tr_b16 v[80:81], v45 offset:4096
    v_cvt_pk_bf16_f32 v48, v34, v35
    v_mfma_f32_16x16x32_bf16 v[240:243], v[88:91], a[24:27], v[240:243]
    ds_read_b64_tr_b16 v[82:83], v45 offset:4608
    v_mul_f32 v36, s95, v130
    v_mfma_f32_16x16x32_bf16 v[248:251], v[88:91], a[28:31], v[248:251]
    v_exp_f32 v36, v36
    v_mfma_f32_16x16x32_bf16 v[228:231], v[92:95], a[16:19], v[228:231]
    s_waitcnt vmcnt(8)
    buffer_store_dword v25, v24, s[68:71], 0 offen offset:1536 sc1
    v_mfma_f32_16x16x32_bf16 v[236:239], v[92:95], a[20:23], v[236:239]
    buffer_load_dwordx4 a[12:15], v22, s[68:71], s83 offen offset:3072 sc1
    v_mfma_f32_16x16x32_bf16 v[244:247], v[92:95], a[24:27], v[244:247]
    ds_read_b64_tr_b16 v[84:85], v47 offset:4096
    v_mul_f32 v37, s95, v131
    v_mfma_f32_16x16x32_bf16 v[252:255], v[92:95], a[28:31], v[252:255]
    ds_read_b64_tr_b16 v[86:87], v47 offset:4608
    s_waitcnt lgkmcnt(4)
    v_mfma_f32_16x16x32_bf16 v[192:195], v[64:67], a[32:35], v[192:195]
    s_waitcnt vmcnt(9)
    v_cmp_gt_u32 vcc, 1, v31
    s_cbranch_vccnz L_poll3
L_fok3:
    v_mfma_f32_16x16x32_bf16 v[200:203], v[64:67], a[36:39], v[200:203]
    s_add_u32 s83, s76, 53248
    ds_read_b64_tr_b16 v[88:89], v45 offset:6144
    v_mfma_f32_16x16x32_bf16 v[208:211], v[64:67], a[40:43], v[208:211]
    buffer_load_dwordx4 a[16:19], v22, s[68:71], s83 offen offset:0 sc1
    v_mfma_f32_16x16x32_bf16 v[216:219], v[64:67], a[44:47], v[216:219]
    ds_read_b64_tr_b16 v[90:91], v45 offset:6656
    v_add_f32 v36, 1.0, v36
    v_mfma_f32_16x16x32_bf16 v[196:199], v[68:71], a[32:35], v[196:199]
    buffer_load_dwordx4 a[20:23], v22, s[68:71], s83 offen offset:1024 sc1
    v_mfma_f32_16x16x32_bf16 v[204:207], v[68:71], a[36:39], v[204:207]
    v_exp_f32 v37, v37
    v_mfma_f32_16x16x32_bf16 v[212:215], v[68:71], a[40:43], v[212:215]
    ds_read_b64_tr_b16 v[92:93], v47 offset:6144
    v_add_f32 v37, 1.0, v37
    v_mfma_f32_16x16x32_bf16 v[220:223], v[68:71], a[44:47], v[220:223]
    ds_read_b64_tr_b16 v[94:95], v47 offset:6656
    v_mul_f32 v38, v130, v162
    v_mfma_f32_16x16x32_bf16 v[224:227], v[72:75], a[32:35], v[224:227]
    buffer_load_dwordx4 a[24:27], v22, s[68:71], s83 offen offset:2048 sc1
    v_mfma_f32_16x16x32_bf16 v[232:235], v[72:75], a[36:39], v[232:235]
    v_rcp_f32 v36, v36
    v_mfma_f32_16x16x32_bf16 v[240:243], v[72:75], a[40:43], v[240:243]
    ds_read_b64_tr_b16 v[64:65], v44 offset:8192
    v_mul_f32 v39, v131, v163
    v_mfma_f32_16x16x32_bf16 v[248:251], v[72:75], a[44:47], v[248:251]
    ds_read_b64_tr_b16 v[66:67], v44 offset:8704
    v_mul_f32 v38, v38, v36
    v_mfma_f32_16x16x32_bf16 v[228:231], v[76:79], a[32:35], v[228:231]
    v_rcp_f32 v37, v37
    v_mfma_f32_16x16x32_bf16 v[236:239], v[76:79], a[36:39], v[236:239]
    ds_read_b64_tr_b16 v[68:69], v46 offset:8192
    v_mul_f32 v39, v39, v37
    v_mfma_f32_16x16x32_bf16 v[244:247], v[76:79], a[40:43], v[244:247]
    ds_read_b64_tr_b16 v[70:71], v46 offset:8704
    v_cvt_pk_bf16_f32 v49, v38, v39
    v_mfma_f32_16x16x32_bf16 v[252:255], v[76:79], a[44:47], v[252:255]
    v_mul_f32 v32, s95, v132
    s_waitcnt lgkmcnt(4)
    v_mfma_f32_16x16x32_bf16 v[192:195], v[80:83], a[48:51], v[192:195]
    buffer_load_dwordx4 a[28:31], v22, s[68:71], s83 offen offset:3072 sc1
    v_mfma_f32_16x16x32_bf16 v[200:203], v[80:83], a[52:55], v[200:203]
    v_exp_f32 v32, v32
    v_mfma_f32_16x16x32_bf16 v[208:211], v[80:83], a[56:59], v[208:211]
    ds_read_b64_tr_b16 v[72:73], v44 offset:10240
    v_mul_f32 v33, s95, v133
    v_mfma_f32_16x16x32_bf16 v[216:219], v[80:83], a[60:63], v[216:219]
    ds_read_b64_tr_b16 v[74:75], v44 offset:10752
    v_add_f32 v32, 1.0, v32
    v_mfma_f32_16x16x32_bf16 v[196:199], v[84:87], a[48:51], v[196:199]
    s_add_u32 s83, s76, 57344
    ds_read_b64_tr_b16 v[76:77], v46 offset:10240
    v_mfma_f32_16x16x32_bf16 v[204:207], v[84:87], a[52:55], v[204:207]
    buffer_load_dwordx4 a[32:35], v22, s[68:71], s83 offen offset:0 sc1
    v_mfma_f32_16x16x32_bf16 v[212:215], v[84:87], a[56:59], v[212:215]
    v_exp_f32 v33, v33
    v_mfma_f32_16x16x32_bf16 v[220:223], v[84:87], a[60:63], v[220:223]
    ds_read_b64_tr_b16 v[78:79], v46 offset:10752
    v_add_f32 v33, 1.0, v33
    v_mfma_f32_16x16x32_bf16 v[224:227], v[88:91], a[48:51], v[224:227]
    buffer_load_dwordx4 a[36:39], v22, s[68:71], s83 offen offset:1024 sc1
    v_mfma_f32_16x16x32_bf16 v[232:235], v[88:91], a[52:55], v[232:235]
    v_rcp_f32 v32, v32
    v_mfma_f32_16x16x32_bf16 v[240:243], v[88:91], a[56:59], v[240:243]
    ds_read_b64_tr_b16 v[80:81], v45 offset:8192
    v_mul_f32 v34, v132, v164
    v_mfma_f32_16x16x32_bf16 v[248:251], v[88:91], a[60:63], v[248:251]
    ds_read_b64_tr_b16 v[82:83], v45 offset:8704
    v_mul_f32 v35, v133, v165
    v_mfma_f32_16x16x32_bf16 v[228:231], v[92:95], a[48:51], v[228:231]
    buffer_load_dwordx4 a[40:43], v22, s[68:71], s83 offen offset:2048 sc1
    v_mfma_f32_16x16x32_bf16 v[236:239], v[92:95], a[52:55], v[236:239]
    v_rcp_f32 v33, v33
    v_mfma_f32_16x16x32_bf16 v[244:247], v[92:95], a[56:59], v[244:247]
    ds_read_b64_tr_b16 v[84:85], v47 offset:8192
    v_mul_f32 v34, v34, v32
    v_mfma_f32_16x16x32_bf16 v[252:255], v[92:95], a[60:63], v[252:255]
    ds_read_b64_tr_b16 v[86:87], v47 offset:8704
    s_waitcnt lgkmcnt(4)
    v_mfma_f32_16x16x32_bf16 v[192:195], v[64:67], a[64:67], v[192:195]
    ds_read_b64_tr_b16 v[88:89], v45 offset:10240
    v_mul_f32 v35, v35, v33
    v_cvt_pk_bf16_f32 v50, v34, v35
    v_mfma_f32_16x16x32_bf16 v[200:203], v[64:67], a[68:71], v[200:203]
    ds_read_b64_tr_b16 v[90:91], v45 offset:10752
    v_mul_f32 v36, s95, v134
    v_mfma_f32_16x16x32_bf16 v[208:211], v[64:67], a[72:75], v[208:211]
    v_exp_f32 v36, v36
    v_mfma_f32_16x16x32_bf16 v[216:219], v[64:67], a[76:79], v[216:219]
    v_mul_f32 v37, s95, v135
    v_add_f32 v36, 1.0, v36
    v_mfma_f32_16x16x32_bf16 v[196:199], v[68:71], a[64:67], v[196:199]
    buffer_load_dwordx4 a[44:47], v22, s[68:71], s83 offen offset:3072 sc1
    v_mfma_f32_16x16x32_bf16 v[204:207], v[68:71], a[68:71], v[204:207]
    v_exp_f32 v37, v37
    v_mfma_f32_16x16x32_bf16 v[212:215], v[68:71], a[72:75], v[212:215]
    ds_read_b64_tr_b16 v[92:93], v47 offset:10240
    v_add_f32 v37, 1.0, v37
    v_mfma_f32_16x16x32_bf16 v[220:223], v[68:71], a[76:79], v[220:223]
    ds_read_b64_tr_b16 v[94:95], v47 offset:10752
    v_mul_f32 v38, v134, v166
    v_mfma_f32_16x16x32_bf16 v[224:227], v[72:75], a[64:67], v[224:227]
    s_barrier
    s_add_u32 m0, s52, 0
    v_mfma_f32_16x16x32_bf16 v[232:235], v[72:75], a[68:71], v[232:235]
    s_add_u32 s93, s86, 36864
    ds_read_b64_tr_b16 v[64:65], v44 offset:12288
    v_mfma_f32_16x16x32_bf16 v[240:243], v[72:75], a[72:75], v[240:243]
    buffer_load_dwordx4 v28, s[72:75], s93 offen offset:0 lds
    v_mfma_f32_16x16x32_bf16 v[248:251], v[72:75], a[76:79], v[248:251]
    ds_read_b64_tr_b16 v[66:67], v44 offset:12800
    v_mul_f32 v39, v135, v167
    v_mfma_f32_16x16x32_bf16 v[228:231], v[76:79], a[64:67], v[228:231]
    buffer_load_dwordx4 v7, s[72:75], s93 offen offset:1024 lds
    v_mfma_f32_16x16x32_bf16 v[236:239], v[76:79], a[68:71], v[236:239]
    v_rcp_f32 v36, v36
    v_mfma_f32_16x16x32_bf16 v[244:247], v[76:79], a[72:75], v[244:247]
    ds_read_b64_tr_b16 v[68:69], v46 offset:12288
    v_mul_f32 v38, v38, v36
    s_add_u32 s16, s94, 196608
    v_mfma_f32_16x16x32_bf16 v[252:255], v[76:79], a[76:79], v[252:255]
    ds_read_b64_tr_b16 v[70:71], v46 offset:12800
    s_waitcnt lgkmcnt(4)
    v_mfma_f32_16x16x32_bf16 v[192:195], v[80:83], a[80:83], v[192:195]
    buffer_load_dwordx4 v8, s[72:75], s93 offen offset:2048 lds
    v_mfma_f32_16x16x32_bf16 v[200:203], v[80:83], a[84:87], v[200:203]
    v_rcp_f32 v37, v37
    v_mfma_f32_16x16x32_bf16 v[208:211], v[80:83], a[88:91], v[208:211]
    ds_read_b64_tr_b16 v[72:73], v44 offset:14336
    v_mul_f32 v39, v39, v37
    v_cvt_pk_bf16_f32 v51, v38, v39
    v_mfma_f32_16x16x32_bf16 v[216:219], v[80:83], a[92:95], v[216:219]
    buffer_store_dwordx4 v[48:51], v22, s[68:71], s16 offen sc1
    ds_read_b64_tr_b16 v[74:75], v44 offset:14848
    v_mfma_f32_16x16x32_bf16 v[196:199], v[84:87], a[80:83], v[196:199]
    ds_read_b64_tr_b16 v[76:77], v46 offset:14336
    v_mul_f32 v32, s95, v136
    v_mul_f32 v33, s95, v137
    v_mfma_f32_16x16x32_bf16 v[204:207], v[84:87], a[84:87], v[204:207]
    v_exp_f32 v32, v32
    v_mfma_f32_16x16x32_bf16 v[212:215], v[84:87], a[88:91], v[212:215]
    v_exp_f32 v33, v33
    v_mfma_f32_16x16x32_bf16 v[220:223], v[84:87], a[92:95], v[220:223]
    ds_read_b64_tr_b16 v[78:79], v46 offset:14848
    v_add_f32 v32, 1.0, v32
    v_mfma_f32_16x16x32_bf16 v[224:227], v[88:91], a[80:83], v[224:227]
    s_add_u32 m0, s52, 3072
    s_add_u32 s93, s85, 331776
    v_mfma_f32_16x16x32_bf16 v[232:235], v[88:91], a[84:87], v[232:235]
    buffer_load_dwordx4 v28, s[72:75], s93 offen offset:0 lds
    v_mfma_f32_16x16x32_bf16 v[240:243], v[88:91], a[88:91], v[240:243]
    ds_read_b64_tr_b16 v[80:81], v45 offset:12288
    v_add_f32 v33, 1.0, v33
    v_mfma_f32_16x16x32_bf16 v[248:251], v[88:91], a[92:95], v[248:251]
    ds_read_b64_tr_b16 v[82:83], v45 offset:12800
    v_mul_f32 v34, v136, v168
    v_mfma_f32_16x16x32_bf16 v[228:231], v[92:95], a[80:83], v[228:231]
    buffer_load_dwordx4 v7, s[72:75], s93 offen offset:1024 lds
    v_mfma_f32_16x16x32_bf16 v[236:239], v[92:95], a[84:87], v[236:239]
    v_rcp_f32 v32, v32
    v_mfma_f32_16x16x32_bf16 v[244:247], v[92:95], a[88:91], v[244:247]
    ds_read_b64_tr_b16 v[84:85], v47 offset:12288
    v_mul_f32 v35, v137, v169
    v_mul_f32 v34, v34, v32
    v_mfma_f32_16x16x32_bf16 v[252:255], v[92:95], a[92:95], v[252:255]
    ds_read_b64_tr_b16 v[86:87], v47 offset:12800
    s_waitcnt lgkmcnt(4)
    v_mfma_f32_16x16x32_bf16 v[192:195], v[64:67], a[96:99], v[192:195]
    buffer_load_dwordx4 v8, s[72:75], s93 offen offset:2048 lds
    v_mfma_f32_16x16x32_bf16 v[200:203], v[64:67], a[100:103], v[200:203]
    v_rcp_f32 v33, v33
    v_mfma_f32_16x16x32_bf16 v[208:211], v[64:67], a[104:107], v[208:211]
    ds_read_b64_tr_b16 v[88:89], v45 offset:14336
    v_mul_f32 v35, v35, v33
    v_cvt_pk_bf16_f32 v52, v34, v35
    s_branch L_sskip6
L_stub6:
    s_setpc_b64 s[100:101]
L_sskip6:
    v_mfma_f32_16x16x32_bf16 v[216:219], v[64:67], a[108:111], v[216:219]
    ds_read_b64_tr_b16 v[90:91], v45 offset:14848
    v_mul_f32 v36, s95, v138
    v_mfma_f32_16x16x32_bf16 v[196:199], v[68:71], a[96:99], v[196:199]
    s_add_u32 s83, s76, 98304
    ds_read_b64_tr_b16 v[92:93], v47 offset:14336
    v_mul_f32 v37, s95, v139
    v_mfma_f32_16x16x32_bf16 v[204:207], v[68:71], a[100:103], v[204:207]
    buffer_load_dwordx4 a[48:51], v22, s[68:71], s83 offen offset:0 sc1
    v_mfma_f32_16x16x32_bf16 v[212:215], v[68:71], a[104:107], v[212:215]
    v_exp_f32 v36, v36
    v_mfma_f32_16x16x32_bf16 v[220:223], v[68:71], a[108:111], v[220:223]
    ds_read_b64_tr_b16 v[94:95], v47 offset:14848
    v_add_f32 v36, 1.0, v36
    v_mfma_f32_16x16x32_bf16 v[224:227], v[72:75], a[96:99], v[224:227]
    v_exp_f32 v37, v37
    v_mfma_f32_16x16x32_bf16 v[232:235], v[72:75], a[100:103], v[232:235]
    v_rcp_f32 v36, v36
    v_mfma_f32_16x16x32_bf16 v[240:243], v[72:75], a[104:107], v[240:243]
    ds_read_b64_tr_b16 v[64:65], v44 offset:28672
    v_add_f32 v37, 1.0, v37
    v_mul_f32 v38, v138, v170
    v_mfma_f32_16x16x32_bf16 v[248:251], v[72:75], a[108:111], v[248:251]
    ds_read_b64_tr_b16 v[66:67], v44 offset:29184
    v_mul_f32 v39, v139, v171
    v_mfma_f32_16x16x32_bf16 v[228:231], v[76:79], a[96:99], v[228:231]
    buffer_load_dwordx4 a[52:55], v22, s[68:71], s83 offen offset:1024 sc1
    v_mfma_f32_16x16x32_bf16 v[236:239], v[76:79], a[100:103], v[236:239]
    v_rcp_f32 v37, v37
    v_mfma_f32_16x16x32_bf16 v[244:247], v[76:79], a[104:107], v[244:247]
    ds_read_b64_tr_b16 v[68:69], v46 offset:28672
    v_mul_f32 v38, v38, v36
    v_mfma_f32_16x16x32_bf16 v[252:255], v[76:79], a[108:111], v[252:255]
    ds_read_b64_tr_b16 v[70:71], v46 offset:29184
    s_waitcnt lgkmcnt(4)
    v_mfma_f32_16x16x32_bf16 v[192:195], v[80:83], a[112:115], v[192:195]
    buffer_load_dwordx4 a[56:59], v22, s[68:71], s83 offen offset:2048 sc1
    v_mfma_f32_16x16x32_bf16 v[200:203], v[80:83], a[116:119], v[200:203]
    ds_read_b64_tr_b16 v[72:73], v44 offset:30720
    v_mul_f32 v39, v39, v37
    v_cvt_pk_bf16_f32 v53, v38, v39
    v_mfma_f32_16x16x32_bf16 v[208:211], v[80:83], a[120:123], v[208:211]
    ds_read_b64_tr_b16 v[74:75], v44 offset:31232
    v_mul_f32 v32, s95, v140
    v_mfma_f32_16x16x32_bf16 v[216:219], v[80:83], a[124:127], v[216:219]
    v_exp_f32 v32, v32
    v_mfma_f32_16x16x32_bf16 v[196:199], v[84:87], a[112:115], v[196:199]
    buffer_load_dwordx4 a[60:63], v22, s[68:71], s83 offen offset:3072 sc1
    v_mfma_f32_16x16x32_bf16 v[204:207], v[84:87], a[116:119], v[204:207]
    ds_read_b64_tr_b16 v[76:77], v46 offset:30720
    v_mul_f32 v33, s95, v141
    v_add_f32 v32, 1.0, v32
    v_mfma_f32_16x16x32_bf16 v[212:215], v[84:87], a[120:123], v[212:215]
    v_exp_f32 v33, v33
    v_mfma_f32_16x16x32_bf16 v[220:223], v[84:87], a[124:127], v[220:223]
    ds_read_b64_tr_b16 v[78:79], v46 offset:31232
    v_add_f32 v33, 1.0, v33
    v_mfma_f32_16x16x32_bf16 v[224:227], v[88:91], a[112:115], v[224:227]
    s_add_u32 s83, s76, 102400
    ds_read_b64_tr_b16 v[80:81], v45 offset:28672
    v_mfma_f32_16x16x32_bf16 v[232:235], v[88:91], a[116:119], v[232:235]
    buffer_load_dwordx4 a[64:67], v22, s[68:71], s83 offen offset:0 sc1
    v_mfma_f32_16x16x32_bf16 v[240:243], v[88:91], a[120:123], v[240:243]
    v_rcp_f32 v32, v32
    v_mfma_f32_16x16x32_bf16 v[248:251], v[88:91], a[124:127], v[248:251]
    ds_read_b64_tr_b16 v[82:83], v45 offset:29184
    v_mul_f32 v34, v140, v172
    v_mfma_f32_16x16x32_bf16 v[228:231], v[92:95], a[112:115], v[228:231]
    v_rcp_f32 v33, v33
    v_mfma_f32_16x16x32_bf16 v[236:239], v[92:95], a[116:119], v[236:239]
    ds_read_b64_tr_b16 v[84:85], v47 offset:28672
    v_mul_f32 v35, v141, v173
    v_mul_f32 v34, v34, v32
    v_mfma_f32_16x16x32_bf16 v[244:247], v[92:95], a[120:123], v[244:247]
    ds_read_b64_tr_b16 v[86:87], v47 offset:29184
    v_mul_f32 v35, v35, v33
    v_mfma_f32_16x16x32_bf16 v[252:255], v[92:95], a[124:127], v[252:255]
    v_cvt_pk_bf16_f32 v54, v34, v35
    s_waitcnt lgkmcnt(4)
    v_mfma_f32_16x16x32_bf16 v[192:195], v[64:67], a[128:131], v[192:195]
    buffer_load_dwordx4 a[68:71], v22, s[68:71], s83 offen offset:1024 sc1
    v_mfma_f32_16x16x32_bf16 v[200:203], v[64:67], a[132:135], v[200:203]
    ds_read_b64_tr_b16 v[88:89], v45 offset:30720
    v_mul_f32 v36, s95, v142
    v_mfma_f32_16x16x32_bf16 v[208:211], v[64:67], a[136:139], v[208:211]
    v_exp_f32 v36, v36
    v_mfma_f32_16x16x32_bf16 v[216:219], v[64:67], a[140:143], v[216:219]
    ds_read_b64_tr_b16 v[90:91], v45 offset:31232
    v_mul_f32 v37, s95, v143
    v_mfma_f32_16x16x32_bf16 v[196:199], v[68:71], a[128:131], v[196:199]
    buffer_load_dwordx4 a[72:75], v22, s[68:71], s83 offen offset:2048 sc1
    v_mfma_f32_16x16x32_bf16 v[204:207], v[68:71], a[132:135], v[204:207]
    v_exp_f32 v37, v37
    v_mfma_f32_16x16x32_bf16 v[212:215], v[68:71], a[136:139], v[212:215]
    ds_read_b64_tr_b16 v[92:93], v47 offset:30720
    v_add_f32 v36, 1.0, v36
    v_add_f32 v37, 1.0, v37
    v_mfma_f32_16x16x32_bf16 v[220:223], v[68:71], a[140:143], v[220:223]
    ds_read_b64_tr_b16 v[94:95], v47 offset:31232
    v_mul_f32 v38, v142, v174
    v_mfma_f32_16x16x32_bf16 v[224:227], v[72:75], a[128:131], v[224:227]
    s_barrier
    s_add_u32 m0, s52, 6144
    v_mfma_f32_16x16x32_bf16 v[232:235], v[72:75], a[132:135], v[232:235]
    s_add_u32 s93, s86, 331776
    ds_read_b64_tr_b16 v[64:65], v44 offset:16384
    v_mfma_f32_16x16x32_bf16 v[240:243], v[72:75], a[136:139], v[240:243]
    buffer_load_dwordx4 v28, s[72:75], s93 offen offset:0 lds
    v_mfma_f32_16x16x32_bf16 v[248:251], v[72:75], a[140:143], v[248:251]
    ds_read_b64_tr_b16 v[66:67], v44 offset:16896
    v_mul_f32 v39, v143, v175
    v_mfma_f32_16x16x32_bf16 v[228:231], v[76:79], a[128:131], v[228:231]
    v_rcp_f32 v36, v36
    v_mfma_f32_16x16x32_bf16 v[236:239], v[76:79], a[132:135], v[236:239]
    v_rcp_f32 v37, v37
    v_mfma_f32_16x16x32_bf16 v[244:247], v[76:79], a[136:139], v[244:247]
    ds_read_b64_tr_b16 v[68:69], v46 offset:16384
    v_mul_f32 v38, v38, v36
    v_mul_f32 v39, v39, v37
    v_mfma_f32_16x16x32_bf16 v[252:255], v[76:79], a[140:143], v[252:255]
    ds_read_b64_tr_b16 v[70:71], v46 offset:16896
    s_waitcnt lgkmcnt(4)
    v_mfma_f32_16x16x32_bf16 v[192:195], v[80:83], a[144:147], v[192:195]
    buffer_load_dwordx4 v7, s[72:75], s93 offen offset:1024 lds
    v_mfma_f32_16x16x32_bf16 v[200:203], v[80:83], a[148:151], v[200:203]
    s_add_u32 s16, s94, 197632
    ds_read_b64_tr_b16 v[72:73], v44 offset:18432
    v_cvt_pk_bf16_f32 v55, v38, v39
    v_mfma_f32_16x16x32_bf16 v[208:211], v[80:83], a[152:155], v[208:211]
    buffer_store_dwordx4 v[52:55], v22, s[68:71], s16 offen sc1
    ds_read_b64_tr_b16 v[74:75], v44 offset:18944
    v_mfma_f32_16x16x32_bf16 v[216:219], v[80:83], a[156:159], v[216:219]
    v_mul_f32 v32, s95, v144
    v_mul_f32 v33, s95, v145
    v_mfma_f32_16x16x32_bf16 v[196:199], v[84:87], a[144:147], v[196:199]
    buffer_load_dwordx4 v8, s[72:75], s93 offen offset:2048 lds
    v_mfma_f32_16x16x32_bf16 v[204:207], v[84:87], a[148:151], v[204:207]
    v_exp_f32 v32, v32
    v_mfma_f32_16x16x32_bf16 v[212:215], v[84:87], a[152:155], v[212:215]
    ds_read_b64_tr_b16 v[76:77], v46 offset:18432
    v_add_f32 v32, 1.0, v32
    v_mul_f32 v34, v144, v176
    v_mfma_f32_16x16x32_bf16 v[220:223], v[84:87], a[156:159], v[220:223]
    ds_read_b64_tr_b16 v[78:79], v46 offset:18944
    v_mul_f32 v35, v145, v177
    v_mfma_f32_16x16x32_bf16 v[224:227], v[88:91], a[144:147], v[224:227]
    s_add_u32 m0, s52, 9216
    s_add_u32 s93, s85, 589824
    v_mfma_f32_16x16x32_bf16 v[232:235], v[88:91], a[148:151], v[232:235]
    buffer_load_dwordx4 v28, s[72:75], s93 offen offset:0 lds
    v_mfma_f32_16x16x32_bf16 v[240:243], v[88:91], a[152:155], v[240:243]
    ds_read_b64_tr_b16 v[80:81], v45 offset:16384
    v_mul_f32 v36, s95, v146
    v_mfma_f32_16x16x32_bf16 v[248:251], v[88:91], a[156:159], v[248:251]
    ds_read_b64_tr_b16 v[82:83], v45 offset:16896
    v_mul_f32 v37, s95, v147
    v_mfma_f32_16x16x32_bf16 v[228:231], v[92:95], a[144:147], v[228:231]
    buffer_load_dwordx4 v7, s[72:75], s93 offen offset:1024 lds
    v_mfma_f32_16x16x32_bf16 v[236:239], v[92:95], a[148:151], v[236:239]
    v_exp_f32 v33, v33
    v_mfma_f32_16x16x32_bf16 v[244:247], v[92:95], a[152:155], v[244:247]
    ds_read_b64_tr_b16 v[84:85], v47 offset:16384
    v_add_f32 v33, 1.0, v33
    v_mul_f32 v38, v146, v178
    v_mfma_f32_16x16x32_bf16 v[252:255], v[92:95], a[156:159], v[252:255]
    ds_read_b64_tr_b16 v[86:87], v47 offset:16896
    s_waitcnt lgkmcnt(4)
    v_mfma_f32_16x16x32_bf16 v[192:195], v[64:67], a[160:163], v[192:195]
    buffer_load_dwordx4 v8, s[72:75], s93 offen offset:2048 lds
    v_mfma_f32_16x16x32_bf16 v[200:203], v[64:67], a[164:167], v[200:203]
    v_rcp_f32 v32, v32
    v_mfma_f32_16x16x32_bf16 v[208:211], v[64:67], a[168:171], v[208:211]
    ds_read_b64_tr_b16 v[88:89], v45 offset:18432
    v_mul_f32 v34, v34, v32
    v_mul_f32 v39, v147, v179
    v_mfma_f32_16x16x32_bf16 v[216:219], v[64:67], a[172:175], v[216:219]
    ds_read_b64_tr_b16 v[90:91], v45 offset:18944
    v_mfma_f32_16x16x32_bf16 v[196:199], v[68:71], a[160:163], v[196:199]
    v_rcp_f32 v33, v33
    v_mfma_f32_16x16x32_bf16 v[204:207], v[68:71], a[164:167], v[204:207]
    v_exp_f32 v36, v36
    v_mfma_f32_16x16x32_bf16 v[212:215], v[68:71], a[168:171], v[212:215]
    ds_read_b64_tr_b16 v[92:93], v47 offset:18432
    v_mul_f32 v35, v35, v33
    v_cvt_pk_bf16_f32 v56, v34, v35
    v_mfma_f32_16x16x32_bf16 v[220:223], v[68:71], a[172:175], v[220:223]
    ds_read_b64_tr_b16 v[94:95], v47 offset:18944
    v_add_f32 v36, 1.0, v36
    v_mfma_f32_16x16x32_bf16 v[224:227], v[72:75], a[160:163], v[224:227]
    s_add_u32 m0, s52, 12288
    s_add_u32 s93, s86, 589824
    ds_read_b64_tr_b16 v[64:65], v44 offset:20480
    v_mfma_f32_16x16x32_bf16 v[232:235], v[72:75], a[164:167], v[232:235]
    buffer_load_dwordx4 v28, s[72:75], s93 offen offset:0 lds
    v_mfma_f32_16x16x32_bf16 v[240:243], v[72:75], a[168:171], v[240:243]
    v_exp_f32 v37, v37
    v_mfma_f32_16x16x32_bf16 v[248:251], v[72:75], a[172:175], v[248:251]
    ds_read_b64_tr_b16 v[66:67], v44 offset:20992
    v_add_f32 v37, 1.0, v37
    v_mfma_f32_16x16x32_bf16 v[228:231], v[76:79], a[160:163], v[228:231]
    buffer_load_dwordx4 v7, s[72:75], s93 offen offset:1024 lds
    v_mfma_f32_16x16x32_bf16 v[236:239], v[76:79], a[164:167], v[236:239]
    v_rcp_f32 v36, v36
    v_mfma_f32_16x16x32_bf16 v[244:247], v[76:79], a[168:171], v[244:247]
    ds_read_b64_tr_b16 v[68:69], v46 offset:20480
    v_mul_f32 v38, v38, v36
    v_mul_f32 v32, s95, v148
    v_mfma_f32_16x16x32_bf16 v[252:255], v[76:79], a[172:175], v[252:255]
    ds_read_b64_tr_b16 v[70:71], v46 offset:20992
    s_waitcnt lgkmcnt(4)
    v_mfma_f32_16x16x32_bf16 v[192:195], v[80:83], a[176:179], v[192:195]
    buffer_load_dwordx4 v8, s[72:75], s93 offen offset:2048 lds
    v_mfma_f32_16x16x32_bf16 v[200:203], v[80:83], a[180:183], v[200:203]
    v_rcp_f32 v37, v37
    v_mfma_f32_16x16x32_bf16 v[208:211], v[80:83], a[184:187], v[208:211]
    ds_read_b64_tr_b16 v[72:73], v44 offset:22528
    v_mul_f32 v39, v39, v37
    v_cvt_pk_bf16_f32 v57, v38, v39
    v_mfma_f32_16x16x32_bf16 v[216:219], v[80:83], a[188:191], v[216:219]
    ds_read_b64_tr_b16 v[74:75], v44 offset:23040
    v_mul_f32 v33, s95, v149
    v_mfma_f32_16x16x32_bf16 v[196:199], v[84:87], a[176:179], v[196:199]
    buffer_load_dwordx4 a[76:79], v22, s[68:71], s83 offen offset:3072 sc1
    v_mfma_f32_16x16x32_bf16 v[204:207], v[84:87], a[180:183], v[204:207]
    v_exp_f32 v32, v32
    v_mfma_f32_16x16x32_bf16 v[212:215], v[84:87], a[184:187], v[212:215]
    ds_read_b64_tr_b16 v[76:77], v46 offset:22528
    v_add_f32 v32, 1.0, v32
    v_mul_f32 v34, v148, v180
    v_mfma_f32_16x16x32_bf16 v[220:223], v[84:87], a[188:191], v[220:223]
    ds_read_b64_tr_b16 v[78:79], v46 offset:23040
    v_mul_f32 v35, v149, v181
    v_mfma_f32_16x16x32_bf16 v[224:227], v[88:91], a[176:179], v[224:227]
    s_add_u32 s83, s76, 106496
    ds_read_b64_tr_b16 v[80:81], v45 offset:20480
    v_mul_f32 v36, s95, v150
    v_mfma_f32_16x16x32_bf16 v[232:235], v[88:91], a[180:183], v[232:235]
    buffer_load_dwordx4 a[80:83], v22, s[68:71], s83 offen offset:0 sc1
    v_mfma_f32_16x16x32_bf16 v[240:243], v[88:91], a[184:187], v[240:243]
    v_exp_f32 v33, v33
    v_mfma_f32_16x16x32_bf16 v[248:251], v[88:91], a[188:191], v[248:251]
    ds_read_b64_tr_b16 v[82:83], v45 offset:20992
    v_add_f32 v33, 1.0, v33
    v_mfma_f32_16x16x32_bf16 v[228:231], v[92:95], a[176:179], v[228:231]
    v_rcp_f32 v32, v32
    v_mfma_f32_16x16x32_bf16 v[236:239], v[92:95], a[180:183], v[236:239]
    v_rcp_f32 v33, v33
    v_mfma_f32_16x16x32_bf16 v[244:247], v[92:95], a[184:187], v[244:247]
    ds_read_b64_tr_b16 v[84:85], v47 offset:20480
    v_mul_f32 v34, v34, v32
    v_mul_f32 v35, v35, v33
    v_mfma_f32_16x16x32_bf16 v[252:255], v[92:95], a[188:191], v[252:255]
    ds_read_b64_tr_b16 v[86:87], v47 offset:20992
    s_waitcnt lgkmcnt(4)
    v_mfma_f32_16x16x32_bf16 v[192:195], v[64:67], a[192:195], v[192:195]
    global_load_dword v31, v30, s[48:49] offset:1536 sc1
    ds_read_b64_tr_b16 v[88:89], v45 offset:22528
    v_cvt_pk_bf16_f32 v58, v34, v35
    v_mfma_f32_16x16x32_bf16 v[200:203], v[64:67], a[196:199], v[200:203]
    buffer_load_dwordx4 a[84:87], v22, s[68:71], s83 offen offset:1024 sc1
    v_mfma_f32_16x16x32_bf16 v[208:211], v[64:67], a[200:203], v[208:211]
    v_exp_f32 v36, v36
    v_mfma_f32_16x16x32_bf16 v[216:219], v[64:67], a[204:207], v[216:219]
    ds_read_b64_tr_b16 v[90:91], v45 offset:23040
    v_mul_f32 v37, s95, v151
    v_mfma_f32_16x16x32_bf16 v[196:199], v[68:71], a[192:195], v[196:199]
    buffer_load_dwordx4 a[88:91], v22, s[68:71], s83 offen offset:2048 sc1
    v_mfma_f32_16x16x32_bf16 v[204:207], v[68:71], a[196:199], v[204:207]
    v_exp_f32 v37, v37
    v_mfma_f32_16x16x32_bf16 v[212:215], v[68:71], a[200:203], v[212:215]
    ds_read_b64_tr_b16 v[92:93], v47 offset:22528
    v_add_f32 v36, 1.0, v36
    v_add_f32 v37, 1.0, v37
    v_mfma_f32_16x16x32_bf16 v[220:223], v[68:71], a[204:207], v[220:223]
    ds_read_b64_tr_b16 v[94:95], v47 offset:23040
    v_mul_f32 v38, v150, v182
    v_mfma_f32_16x16x32_bf16 v[224:227], v[72:75], a[192:195], v[224:227]
    s_barrier
    s_add_u32 m0, s52, 27648
    s_add_u32 s93, s85, 884736
    v_mfma_f32_16x16x32_bf16 v[232:235], v[72:75], a[196:199], v[232:235]
    buffer_load_dwordx4 v28, s[72:75], s93 offen offset:0 lds
    v_mfma_f32_16x16x32_bf16 v[240:243], v[72:75], a[200:203], v[240:243]
    ds_read_b64_tr_b16 v[64:65], v44 offset:32768
    v_mul_f32 v39, v151, v183
    v_mfma_f32_16x16x32_bf16 v[248:251], v[72:75], a[204:207], v[248:251]
    s_add_u32 s16, s94, 565248
    ds_read_b64_tr_b16 v[66:67], v44 offset:33280
    v_mfma_f32_16x16x32_bf16 v[228:231], v[76:79], a[192:195], v[228:231]
    v_rcp_f32 v36, v36
    v_mfma_f32_16x16x32_bf16 v[236:239], v[76:79], a[196:199], v[236:239]
    v_rcp_f32 v37, v37
    v_mfma_f32_16x16x32_bf16 v[244:247], v[76:79], a[200:203], v[244:247]
    ds_read_b64_tr_b16 v[68:69], v46 offset:32768
    v_mul_f32 v38, v38, v36
    v_mul_f32 v39, v39, v37
    v_mfma_f32_16x16x32_bf16 v[252:255], v[76:79], a[204:207], v[252:255]
    ds_read_b64_tr_b16 v[70:71], v46 offset:33280
    s_waitcnt lgkmcnt(4)
    v_mfma_f32_16x16x32_bf16 v[192:195], v[80:83], a[208:211], v[192:195]
    buffer_load_dwordx4 v7, s[72:75], s93 offen offset:1024 lds
    v_mfma_f32_16x16x32_bf16 v[200:203], v[80:83], a[212:215], v[200:203]
    ds_read_b64_tr_b16 v[72:73], v44 offset:34816
    v_cvt_pk_bf16_f32 v59, v38, v39
    v_mul_f32 v32, s95, v152
    v_mfma_f32_16x16x32_bf16 v[208:211], v[80:83], a[216:219], v[208:211]
    buffer_store_dwordx4 v[56:59], v22, s[68:71], s16 offen sc1
    ds_read_b64_tr_b16 v[74:75], v44 offset:35328
    v_mfma_f32_16x16x32_bf16 v[216:219], v[80:83], a[220:223], v[216:219]
    v_exp_f32 v32, v32
    v_mfma_f32_16x16x32_bf16 v[196:199], v[84:87], a[208:211], v[196:199]
    buffer_load_dwordx4 v8, s[72:75], s93 offen offset:2048 lds
    v_mfma_f32_16x16x32_bf16 v[204:207], v[84:87], a[212:215], v[204:207]
    ds_read_b64_tr_b16 v[76:77], v46 offset:34816
    v_mul_f32 v33, s95, v153
    v_add_f32 v32, 1.0, v32
    v_mfma_f32_16x16x32_bf16 v[212:215], v[84:87], a[216:219], v[212:215]
    v_exp_f32 v33, v33
    v_mfma_f32_16x16x32_bf16 v[220:223], v[84:87], a[220:223], v[220:223]
    ds_read_b64_tr_b16 v[78:79], v46 offset:35328
    v_add_f32 v33, 1.0, v33
    v_mfma_f32_16x16x32_bf16 v[224:227], v[88:91], a[208:211], v[224:227]
    buffer_load_dwordx4 a[92:95], v22, s[68:71], s83 offen offset:3072 sc1
    v_mfma_f32_16x16x32_bf16 v[232:235], v[88:91], a[212:215], v[232:235]
    v_rcp_f32 v32, v32
    v_mfma_f32_16x16x32_bf16 v[240:243], v[88:91], a[216:219], v[240:243]
    ds_read_b64_tr_b16 v[80:81], v45 offset:32768
    v_mul_f32 v34, v152, v184
    v_mfma_f32_16x16x32_bf16 v[248:251], v[88:91], a[220:223], v[248:251]
    ds_read_b64_tr_b16 v[82:83], v45 offset:33280
    v_mul_f32 v35, v153, v185
    v_mfma_f32_16x16x32_bf16 v[228:231], v[92:95], a[208:211], v[228:231]
    s_add_u32 m0, s52, 15360
    s_add_u32 s93, s86, 884736
    ds_read_b64_tr_b16 v[84:85], v47 offset:32768
    v_mfma_f32_16x16x32_bf16 v[236:239], v[92:95], a[212:215], v[236:239]
    buffer_load_dwordx4 v28, s[72:75], s93 offen offset:0 lds
    v_mfma_f32_16x16x32_bf16 v[244:247], v[92:95], a[216:219], v[244:247]
    v_rcp_f32 v33, v33
    v_mfma_f32_16x16x32_bf16 v[252:255], v[92:95], a[220:223], v[252:255]
    ds_read_b64_tr_b16 v[86:87], v47 offset:33280
    s_waitcnt lgkmcnt(4)
    v_mfma_f32_16x16x32_bf16 v[192:195], v[64:67], a[224:227], v[192:195]
    buffer_load_dwordx4 v7, s[72:75], s93 offen offset:1024 lds
    v_mfma_f32_16x16x32_bf16 v[200:203], v[64:67], a[228:231], v[200:203]
    ds_read_b64_tr_b16 v[88:89], v45 offset:34816
    v_mul_f32 v34, v34, v32
    v_mul_f32 v35, v35, v33
    v_mfma_f32_16x16x32_bf16 v[208:211], v[64:67], a[232:235], v[208:211]
    ds_read_b64_tr_b16 v[90:91], v45 offset:35328
    v_cvt_pk_bf16_f32 v60, v34, v35
    v_mfma_f32_16x16x32_bf16 v[216:219], v[64:67], a[236:239], v[216:219]
    v_mul_f32 v36, s95, v154
    v_mul_f32 v37, s95, v155
    v_mfma_f32_16x16x32_bf16 v[196:199], v[68:71], a[224:227], v[196:199]
    v_exp_f32 v36, v36
    v_mfma_f32_16x16x32_bf16 v[204:207], v[68:71], a[228:231], v[204:207]
    v_exp_f32 v37, v37
    v_mfma_f32_16x16x32_bf16 v[212:215], v[68:71], a[232:235], v[212:215]
    ds_read_b64_tr_b16 v[92:93], v47 offset:34816
    v_add_f32 v36, 1.0, v36
    v_add_f32 v37, 1.0, v37
    v_mfma_f32_16x16x32_bf16 v[220:223], v[68:71], a[236:239], v[220:223]
    ds_read_b64_tr_b16 v[94:95], v47 offset:35328
    v_mul_f32 v38, v154, v186
    v_mfma_f32_16x16x32_bf16 v[224:227], v[72:75], a[224:227], v[224:227]
    buffer_load_dwordx4 v8, s[72:75], s93 offen offset:2048 lds
    v_mfma_f32_16x16x32_bf16 v[232:235], v[72:75], a[228:231], v[232:235]
    v_rcp_f32 v36, v36
    v_mfma_f32_16x16x32_bf16 v[240:243], v[72:75], a[232:235], v[240:243]
    ds_read_b64_tr_b16 v[64:65], v44 offset:36864
    v_mul_f32 v39, v155, v187
    v_mfma_f32_16x16x32_bf16 v[248:251], v[72:75], a[236:239], v[248:251]
    ds_read_b64_tr_b16 v[66:67], v44 offset:37376
    v_mul_f32 v38, v38, v36
    v_mfma_f32_16x16x32_bf16 v[228:231], v[76:79], a[224:227], v[228:231]
    v_rcp_f32 v37, v37
    v_mfma_f32_16x16x32_bf16 v[236:239], v[76:79], a[228:231], v[236:239]
    ds_read_b64_tr_b16 v[68:69], v46 offset:36864
    v_mul_f32 v39, v39, v37
    v_cvt_pk_bf16_f32 v61, v38, v39
    v_mfma_f32_16x16x32_bf16 v[244:247], v[76:79], a[232:235], v[244:247]
    ds_read_b64_tr_b16 v[70:71], v46 offset:37376
    v_mul_f32 v32, s95, v156
    v_mfma_f32_16x16x32_bf16 v[252:255], v[76:79], a[236:239], v[252:255]
    v_mul_f32 v33, s95, v157
    s_waitcnt lgkmcnt(4)
    v_mfma_f32_16x16x32_bf16 v[192:195], v[80:83], a[240:243], v[192:195]
    v_exp_f32 v32, v32
    v_mfma_f32_16x16x32_bf16 v[200:203], v[80:83], a[244:247], v[200:203]
    v_exp_f32 v33, v33
    v_mfma_f32_16x16x32_bf16 v[208:211], v[80:83], a[248:251], v[208:211]
    ds_read_b64_tr_b16 v[72:73], v44 offset:38912
    v_add_f32 v32, 1.0, v32
    v_mfma_f32_16x16x32_bf16 v[216:219], v[80:83], a[252:255], v[216:219]
    ds_read_b64_tr_b16 v[74:75], v44 offset:39424
    v_add_f32 v33, 1.0, v33
    v_mfma_f32_16x16x32_bf16 v[196:199], v[84:87], a[240:243], v[196:199]
    v_rcp_f32 v32, v32
    v_mfma_f32_16x16x32_bf16 v[204:207], v[84:87], a[244:247], v[204:207]
    v_rcp_f32 v33, v33
    v_mfma_f32_16x16x32_bf16 v[212:215], v[84:87], a[248:251], v[212:215]
    ds_read_b64_tr_b16 v[76:77], v46 offset:38912
    v_mul_f32 v34, v156, v188
    v_mfma_f32_16x16x32_bf16 v[220:223], v[84:87], a[252:255], v[220:223]
    ds_read_b64_tr_b16 v[78:79], v46 offset:39424
    v_mul_f32 v35, v157, v189
    v_mfma_f32_16x16x32_bf16 v[224:227], v[88:91], a[240:243], v[224:227]
    ds_read_b64_tr_b16 v[80:81], v45 offset:36864
    v_mul_f32 v34, v34, v32
    v_mfma_f32_16x16x32_bf16 v[232:235], v[88:91], a[244:247], v[232:235]
    ds_read_b64_tr_b16 v[82:83], v45 offset:37376
    v_mul_f32 v35, v35, v33
    v_mfma_f32_16x16x32_bf16 v[240:243], v[88:91], a[248:251], v[240:243]
    v_cvt_pk_bf16_f32 v62, v34, v35
    v_mul_f32 v36, s95, v158
    v_mfma_f32_16x16x32_bf16 v[248:251], v[88:91], a[252:255], v[248:251]
    v_exp_f32 v36, v36
    v_mfma_f32_16x16x32_bf16 v[228:231], v[92:95], a[240:243], v[228:231]
    ds_read_b64_tr_b16 v[84:85], v47 offset:36864
    v_mul_f32 v37, s95, v159
    v_mfma_f32_16x16x32_bf16 v[236:239], v[92:95], a[244:247], v[236:239]
    v_exp_f32 v37, v37
    v_mfma_f32_16x16x32_bf16 v[244:247], v[92:95], a[248:251], v[244:247]
    ds_read_b64_tr_b16 v[86:87], v47 offset:37376
    v_add_f32 v36, 1.0, v36
    v_mfma_f32_16x16x32_bf16 v[252:255], v[92:95], a[252:255], v[252:255]
    v_add_f32 v37, 1.0, v37
    s_waitcnt lgkmcnt(4)
    v_mfma_f32_16x16x32_bf16 v[192:195], v[64:67], v[96:99], v[192:195]
    s_branch L_sskip7
.p2align 12
L_stub7:
    s_setpc_b64 s[100:101]
L_sskip7:
    s_waitcnt vmcnt(10)
    v_cmp_gt_u32 vcc, 1, v31
    s_cbranch_vccnz L_poll4
L_fok4:
    v_mfma_f32_16x16x32_bf16 v[200:203], v[64:67], v[100:103], v[200:203]
    s_add_u32 s83, s76, 147456
    ds_read_b64_tr_b16 v[88:89], v45 offset:38912
    v_mfma_f32_16x16x32_bf16 v[208:211], v[64:67], v[104:107], v[208:211]
    buffer_load_dwordx4 a[96:99], v22, s[68:71], s83 offen offset:0 sc1
    v_mfma_f32_16x16x32_bf16 v[216:219], v[64:67], v[108:111], v[216:219]
    ds_read_b64_tr_b16 v[90:91], v45 offset:39424
    v_mul_f32 v38, v158, v190
    v_mfma_f32_16x16x32_bf16 v[196:199], v[68:71], v[96:99], v[196:199]
    buffer_load_dwordx4 a[100:103], v22, s[68:71], s83 offen offset:1024 sc1
    v_mfma_f32_16x16x32_bf16 v[204:207], v[68:71], v[100:103], v[204:207]
    v_rcp_f32 v36, v36
    v_mfma_f32_16x16x32_bf16 v[212:215], v[68:71], v[104:107], v[212:215]
    ds_read_b64_tr_b16 v[92:93], v47 offset:38912
    v_mul_f32 v39, v159, v191
    v_mfma_f32_16x16x32_bf16 v[220:223], v[68:71], v[108:111], v[220:223]
    ds_read_b64_tr_b16 v[94:95], v47 offset:39424
    v_mul_f32 v38, v38, v36
    v_mfma_f32_16x16x32_bf16 v[224:227], v[72:75], v[96:99], v[224:227]
    buffer_load_dwordx4 a[104:107], v22, s[68:71], s83 offen offset:2048 sc1
    v_mfma_f32_16x16x32_bf16 v[232:235], v[72:75], v[100:103], v[232:235]
    v_rcp_f32 v37, v37
    v_mfma_f32_16x16x32_bf16 v[240:243], v[72:75], v[104:107], v[240:243]
    v_mul_f32 v39, v39, v37
    s_add_u32 s16, s94, 566272
    v_mfma_f32_16x16x32_bf16 v[248:251], v[72:75], v[108:111], v[248:251]
    v_cvt_pk_bf16_f32 v63, v38, v39
    v_mfma_f32_16x16x32_bf16 v[228:231], v[76:79], v[96:99], v[228:231]
    buffer_load_dwordx4 a[108:111], v22, s[68:71], s83 offen offset:3072 sc1
    v_mfma_f32_16x16x32_bf16 v[236:239], v[76:79], v[100:103], v[236:239]
    buffer_store_dwordx4 v[60:63], v22, s[68:71], s16 offen sc1
    v_mfma_f32_16x16x32_bf16 v[244:247], v[76:79], v[104:107], v[244:247]
    v_mfma_f32_16x16x32_bf16 v[252:255], v[76:79], v[108:111], v[252:255]
    s_waitcnt lgkmcnt(0)
    v_mfma_f32_16x16x32_bf16 v[192:195], v[80:83], v[112:115], v[192:195]
    s_add_u32 s83, s76, 151552
    v_mfma_f32_16x16x32_bf16 v[200:203], v[80:83], v[116:119], v[200:203]
    buffer_load_dwordx4 a[112:115], v22, s[68:71], s83 offen offset:0 sc1
    v_mfma_f32_16x16x32_bf16 v[208:211], v[80:83], v[120:123], v[208:211]
    v_mfma_f32_16x16x32_bf16 v[216:219], v[80:83], v[124:127], v[216:219]
    v_mfma_f32_16x16x32_bf16 v[196:199], v[84:87], v[112:115], v[196:199]
    buffer_load_dwordx4 a[116:119], v22, s[68:71], s83 offen offset:1024 sc1
    v_mfma_f32_16x16x32_bf16 v[204:207], v[84:87], v[116:119], v[204:207]
    v_mfma_f32_16x16x32_bf16 v[212:215], v[84:87], v[120:123], v[212:215]
    v_mfma_f32_16x16x32_bf16 v[220:223], v[84:87], v[124:127], v[220:223]
    v_mfma_f32_16x16x32_bf16 v[224:227], v[88:91], v[112:115], v[224:227]
    buffer_load_dwordx4 a[120:123], v22, s[68:71], s83 offen offset:2048 sc1
    v_mfma_f32_16x16x32_bf16 v[232:235], v[88:91], v[116:119], v[232:235]
    v_mfma_f32_16x16x32_bf16 v[240:243], v[88:91], v[120:123], v[240:243]
    v_mfma_f32_16x16x32_bf16 v[248:251], v[88:91], v[124:127], v[248:251]
    v_mfma_f32_16x16x32_bf16 v[228:231], v[92:95], v[112:115], v[228:231]
    v_mfma_f32_16x16x32_bf16 v[236:239], v[92:95], v[116:119], v[236:239]
    v_mfma_f32_16x16x32_bf16 v[244:247], v[92:95], v[120:123], v[244:247]
    v_mfma_f32_16x16x32_bf16 v[252:255], v[92:95], v[124:127], v[252:255]
    s_barrier
    s_nop 7
    v_pk_mul_f32 v[224:225], v[192:193], v[224:225]
    v_pk_mul_f32 v[192:193], v[192:193], s[94:95] op_sel:[0,1] op_sel_hi:[1,1]
    v_pk_mul_f32 v[226:227], v[194:195], v[226:227]
    v_pk_mul_f32 v[194:195], v[194:195], s[94:95] op_sel:[0,1] op_sel_hi:[1,1]
    v_pk_mul_f32 v[228:229], v[196:197], v[228:229]
    v_pk_mul_f32 v[196:197], v[196:197], s[94:95] op_sel:[0,1] op_sel_hi:[1,1]
    v_pk_mul_f32 v[230:231], v[198:199], v[230:231]
    v_pk_mul_f32 v[198:199], v[198:199], s[94:95] op_sel:[0,1] op_sel_hi:[1,1]
    s_add_u32 m0, s52, 18432
    s_add_u32 s93, s85, 626688
    buffer_load_dwordx4 v28, s[72:75], s93 offen offset:0 lds
    v_exp_f32 v192, v192
    v_exp_f32 v193, v193
    v_exp_f32 v194, v194
    buffer_load_dwordx4 v7, s[72:75], s93 offen offset:1024 lds
    v_exp_f32 v195, v195
    v_exp_f32 v196, v196
    buffer_load_dwordx4 v8, s[72:75], s93 offen offset:2048 lds
    v_exp_f32 v197, v197
    v_exp_f32 v198, v198
    v_exp_f32 v199, v199
    v_pk_add_f32 v[192:193], v[192:193], 1.0 op_sel_hi:[1,0]
    v_pk_add_f32 v[194:195], v[194:195], 1.0 op_sel_hi:[1,0]
    v_pk_add_f32 v[196:197], v[196:197], 1.0 op_sel_hi:[1,0]
    v_pk_add_f32 v[198:199], v[198:199], 1.0 op_sel_hi:[1,0]
    v_rcp_f32 v192, v192
    v_rcp_f32 v193, v193
    buffer_load_dwordx4 a[124:127], v22, s[68:71], s83 offen offset:3072 sc1
    v_rcp_f32 v194, v194
    v_rcp_f32 v195, v195
    v_rcp_f32 v196, v196
    v_rcp_f32 v197, v197
    v_rcp_f32 v198, v198
    v_rcp_f32 v199, v199
    v_pk_mul_f32 v[224:225], v[224:225], v[192:193]
    v_pk_mul_f32 v[226:227], v[226:227], v[194:195]
    v_pk_mul_f32 v[228:229], v[228:229], v[196:197]
    v_pk_mul_f32 v[230:231], v[230:231], v[198:199]
    v_cvt_pk_bf16_f32 v48, v224, v225
    v_cvt_pk_bf16_f32 v49, v226, v227
    v_cvt_pk_bf16_f32 v50, v228, v229
    s_add_u32 s16, s94, 245760
    s_add_u32 m0, s52, 21504
    s_add_u32 s93, s85, 921600
    buffer_load_dwordx4 v28, s[72:75], s93 offen offset:0 lds
    v_cvt_pk_bf16_f32 v51, v230, v231
    buffer_store_dwordx4 v[48:51], v22, s[68:71], s16 offen sc1
    v_pk_mul_f32 v[232:233], v[200:201], v[232:233]
    v_pk_mul_f32 v[200:201], v[200:201], s[94:95] op_sel:[0,1] op_sel_hi:[1,1]
    v_pk_mul_f32 v[234:235], v[202:203], v[234:235]
    v_pk_mul_f32 v[202:203], v[202:203], s[94:95] op_sel:[0,1] op_sel_hi:[1,1]
    v_pk_mul_f32 v[236:237], v[204:205], v[236:237]
    v_pk_mul_f32 v[204:205], v[204:205], s[94:95] op_sel:[0,1] op_sel_hi:[1,1]
    v_pk_mul_f32 v[238:239], v[206:207], v[238:239]
    v_pk_mul_f32 v[206:207], v[206:207], s[94:95] op_sel:[0,1] op_sel_hi:[1,1]
    v_exp_f32 v200, v200
    v_exp_f32 v201, v201
    v_exp_f32 v202, v202
    v_exp_f32 v203, v203
    v_exp_f32 v204, v204
    v_exp_f32 v205, v205
    v_exp_f32 v206, v206
    v_exp_f32 v207, v207
    v_pk_add_f32 v[200:201], v[200:201], 1.0 op_sel_hi:[1,0]
    v_pk_add_f32 v[202:203], v[202:203], 1.0 op_sel_hi:[1,0]
    v_pk_add_f32 v[204:205], v[204:205], 1.0 op_sel_hi:[1,0]
    v_pk_add_f32 v[206:207], v[206:207], 1.0 op_sel_hi:[1,0]
    v_rcp_f32 v200, v200
    v_rcp_f32 v201, v201
    v_rcp_f32 v202, v202
    v_rcp_f32 v203, v203
    v_rcp_f32 v204, v204
    v_rcp_f32 v205, v205
    buffer_load_dwordx4 v7, s[72:75], s93 offen offset:1024 lds
    v_rcp_f32 v206, v206
    v_rcp_f32 v207, v207
    v_pk_mul_f32 v[232:233], v[232:233], v[200:201]
    v_pk_mul_f32 v[234:235], v[234:235], v[202:203]
    v_pk_mul_f32 v[236:237], v[236:237], v[204:205]
    v_pk_mul_f32 v[238:239], v[238:239], v[206:207]
    v_cvt_pk_bf16_f32 v52, v232, v233
    v_cvt_pk_bf16_f32 v53, v234, v235
    v_cvt_pk_bf16_f32 v54, v236, v237
    s_add_u32 s16, s94, 246784
    v_cvt_pk_bf16_f32 v55, v238, v239
    buffer_load_dwordx4 v8, s[72:75], s93 offen offset:2048 lds
    buffer_store_dwordx4 v[52:55], v22, s[68:71], s16 offen sc1
    v_pk_mul_f32 v[240:241], v[208:209], v[240:241]
    v_pk_mul_f32 v[208:209], v[208:209], s[94:95] op_sel:[0,1] op_sel_hi:[1,1]
    v_pk_mul_f32 v[242:243], v[210:211], v[242:243]
    v_pk_mul_f32 v[210:211], v[210:211], s[94:95] op_sel:[0,1] op_sel_hi:[1,1]
    v_pk_mul_f32 v[244:245], v[212:213], v[244:245]
    v_pk_mul_f32 v[212:213], v[212:213], s[94:95] op_sel:[0,1] op_sel_hi:[1,1]
    v_pk_mul_f32 v[246:247], v[214:215], v[246:247]
    v_pk_mul_f32 v[214:215], v[214:215], s[94:95] op_sel:[0,1] op_sel_hi:[1,1]
    v_exp_f32 v208, v208
    v_exp_f32 v209, v209
    v_exp_f32 v210, v210
    v_exp_f32 v211, v211
    v_exp_f32 v212, v212
    v_exp_f32 v213, v213
    v_exp_f32 v214, v214
    v_exp_f32 v215, v215
    s_waitcnt vmcnt(12)
    buffer_store_dword v25, v24, s[68:71], 0 offen offset:2048 sc1
    v_pk_add_f32 v[208:209], v[208:209], 1.0 op_sel_hi:[1,0]
    v_pk_add_f32 v[210:211], v[210:211], 1.0 op_sel_hi:[1,0]
    v_pk_add_f32 v[212:213], v[212:213], 1.0 op_sel_hi:[1,0]
    v_pk_add_f32 v[214:215], v[214:215], 1.0 op_sel_hi:[1,0]
    v_rcp_f32 v208, v208
    v_rcp_f32 v209, v209
    v_rcp_f32 v210, v210
    v_rcp_f32 v211, v211
    v_rcp_f32 v212, v212
    v_rcp_f32 v213, v213
    s_add_u32 s83, s76, 155648
    buffer_load_dwordx4 a[128:131], v22, s[68:71], s83 offen offset:0 sc1
    v_rcp_f32 v214, v214
    v_rcp_f32 v215, v215
    v_pk_mul_f32 v[240:241], v[240:241], v[208:209]
    v_pk_mul_f32 v[242:243], v[242:243], v[210:211]
    s_waitcnt vmcnt(8)
    s_barrier
    v_pk_mul_f32 v[244:245], v[244:245], v[212:213]
    ds_read_b64_tr_b16 v[160:161], v2 offset:24576
    v_pk_mul_f32 v[246:247], v[246:247], v[214:215]
    v_cvt_pk_bf16_f32 v56, v240, v241
    ds_read_b64_tr_b16 v[162:163], v3 offset:24576
    v_cvt_pk_bf16_f32 v57, v242, v243
    v_cvt_pk_bf16_f32 v58, v244, v245
    buffer_load_dwordx4 a[132:135], v22, s[68:71], s83 offen offset:1024 sc1
    ds_read_b64_tr_b16 v[164:165], v12 offset:24576
    s_add_u32 s16, s94, 614400
    v_cvt_pk_bf16_f32 v59, v246, v247
    ds_read_b64_tr_b16 v[166:167], v13 offset:24576
    buffer_store_dwordx4 v[56:59], v22, s[68:71], s16 offen sc1
    v_pk_mul_f32 v[248:249], v[216:217], v[248:249]
    ds_read_b64_tr_b16 v[168:169], v4 offset:24576
    v_pk_mul_f32 v[216:217], v[216:217], s[94:95] op_sel:[0,1] op_sel_hi:[1,1]
    v_pk_mul_f32 v[250:251], v[218:219], v[250:251]
    ds_read_b64_tr_b16 v[170:171], v5 offset:24576
    v_pk_mul_f32 v[218:219], v[218:219], s[94:95] op_sel:[0,1] op_sel_hi:[1,1]
    v_pk_mul_f32 v[252:253], v[220:221], v[252:253]
    ds_read_b64_tr_b16 v[172:173], v14 offset:24576
    v_pk_mul_f32 v[220:221], v[220:221], s[94:95] op_sel:[0,1] op_sel_hi:[1,1]
    v_pk_mul_f32 v[254:255], v[222:223], v[254:255]
    ds_read_b64_tr_b16 v[174:175], v15 offset:24576
    v_pk_mul_f32 v[222:223], v[222:223], s[94:95] op_sel:[0,1] op_sel_hi:[1,1]
    v_exp_f32 v216, v216
    ds_read_b64_tr_b16 v[176:177], v2 offset:25600
    v_exp_f32 v217, v217
    v_exp_f32 v218, v218
    ds_read_b64_tr_b16 v[178:179], v3 offset:25600
    v_exp_f32 v219, v219
    v_exp_f32 v220, v220
    ds_read_b64_tr_b16 v[180:181], v12 offset:25600
    v_exp_f32 v221, v221
    v_exp_f32 v222, v222
    ds_read_b64_tr_b16 v[182:183], v13 offset:25600
    v_exp_f32 v223, v223
    v_pk_add_f32 v[216:217], v[216:217], 1.0 op_sel_hi:[1,0]
    ds_read_b64_tr_b16 v[184:185], v4 offset:25600
    v_pk_add_f32 v[218:219], v[218:219], 1.0 op_sel_hi:[1,0]
    v_pk_add_f32 v[220:221], v[220:221], 1.0 op_sel_hi:[1,0]
    ds_read_b64_tr_b16 v[186:187], v5 offset:25600
    v_pk_add_f32 v[222:223], v[222:223], 1.0 op_sel_hi:[1,0]
    v_rcp_f32 v216, v216
    ds_read_b64_tr_b16 v[188:189], v14 offset:25600
    v_rcp_f32 v217, v217
    v_rcp_f32 v218, v218
    buffer_load_dwordx4 a[136:139], v22, s[68:71], s83 offen offset:2048 sc1
    ds_read_b64_tr_b16 v[190:191], v15 offset:25600
    v_rcp_f32 v219, v219
    v_rcp_f32 v220, v220
    ds_read_b64_tr_b16 v[32:33], v2 offset:26624
    v_rcp_f32 v221, v221
    v_rcp_f32 v222, v222
    ds_read_b64_tr_b16 v[34:35], v3 offset:26624
    v_rcp_f32 v223, v223
    v_pk_mul_f32 v[248:249], v[248:249], v[216:217]
    ds_read_b64_tr_b16 v[36:37], v12 offset:26624
    v_pk_mul_f32 v[250:251], v[250:251], v[218:219]
    v_pk_mul_f32 v[252:253], v[252:253], v[220:221]
    ds_read_b64_tr_b16 v[38:39], v13 offset:26624
    v_pk_mul_f32 v[254:255], v[254:255], v[222:223]
    v_cvt_pk_bf16_f32 v60, v248, v249
    buffer_load_dwordx4 a[140:143], v22, s[68:71], s83 offen offset:3072 sc1
    v_cvt_pk_bf16_f32 v61, v250, v251
    v_cvt_pk_bf16_f32 v62, v252, v253
    s_add_u32 s16, s94, 615424
    v_cvt_pk_bf16_f32 v63, v254, v255
    buffer_store_dwordx4 v[60:63], v22, s[68:71], s16 offen sc1
    s_waitcnt lgkmcnt(12)
    v_mfma_f32_16x16x32_bf16 v[80:83], v[160:163], a[0:3], 0
    ds_read_b64_tr_b16 v[40:41], v4 offset:26624
    v_mfma_f32_16x16x32_bf16 v[84:87], v[160:163], a[4:7], 0
    ds_read_b64_tr_b16 v[42:43], v5 offset:26624
    v_mfma_f32_16x16x32_bf16 v[96:99], v[164:167], a[0:3], 0
    ds_read_b64_tr_b16 v[44:45], v14 offset:26624
    v_mfma_f32_16x16x32_bf16 v[100:103], v[164:167], a[4:7], 0
    ds_read_b64_tr_b16 v[46:47], v15 offset:26624
    v_mfma_f32_16x16x32_bf16 v[88:91], v[168:171], a[0:3], 0
    ds_read_b64_tr_b16 v[160:161], v12 offset:0
    v_mfma_f32_16x16x32_bf16 v[92:95], v[168:171], a[4:7], 0
    ds_read_b64_tr_b16 v[162:163], v13 offset:0
    v_mfma_f32_16x16x32_bf16 v[104:107], v[172:175], a[0:3], 0
    ds_read_b64_tr_b16 v[164:165], v2 offset:0
    v_mfma_f32_16x16x32_bf16 v[108:111], v[172:175], a[4:7], 0
    ds_read_b64_tr_b16 v[166:167], v3 offset:0
    s_waitcnt lgkmcnt(12)
    v_mfma_f32_16x16x32_bf16 v[80:83], v[176:179], a[8:11], v[80:83]
    ds_read_b64_tr_b16 v[168:169], v14 offset:0
    v_mfma_f32_16x16x32_bf16 v[84:87], v[176:179], a[12:15], v[84:87]
    ds_read_b64_tr_b16 v[170:171], v15 offset:0
    v_mfma_f32_16x16x32_bf16 v[96:99], v[180:183], a[8:11], v[96:99]
    ds_read_b64_tr_b16 v[172:173], v4 offset:0
    v_mfma_f32_16x16x32_bf16 v[100:103], v[180:183], a[12:15], v[100:103]
    ds_read_b64_tr_b16 v[174:175], v5 offset:0
    v_mfma_f32_16x16x32_bf16 v[88:91], v[184:187], a[8:11], v[88:91]
    s_add_u32 m0, s52, 30720
    ds_read_b64_tr_b16 v[176:177], v12 offset:1024
    v_mfma_f32_16x16x32_bf16 v[92:95], v[184:187], a[12:15], v[92:95]
    s_add_u32 s93, s85, 221184
    ds_read_b64_tr_b16 v[178:179], v13 offset:1024
    v_mfma_f32_16x16x32_bf16 v[104:107], v[188:191], a[8:11], v[104:107]
    ds_read_b64_tr_b16 v[180:181], v2 offset:1024
    v_mfma_f32_16x16x32_bf16 v[108:111], v[188:191], a[12:15], v[108:111]
    ds_read_b64_tr_b16 v[182:183], v3 offset:1024
    s_waitcnt lgkmcnt(12)
    v_mfma_f32_16x16x32_bf16 v[80:83], v[32:35], a[16:19], v[80:83]
    buffer_load_dwordx4 v28, s[72:75], s93 offen offset:0 lds
    v_mfma_f32_16x16x32_bf16 v[84:87], v[32:35], a[20:23], v[84:87]
    ds_read_b64_tr_b16 v[184:185], v14 offset:1024
    ds_read_b64_tr_b16 v[186:187], v15 offset:1024
    v_mfma_f32_16x16x32_bf16 v[96:99], v[36:39], a[16:19], v[96:99]
    ds_read_b64_tr_b16 v[188:189], v4 offset:1024
    v_mfma_f32_16x16x32_bf16 v[100:103], v[36:39], a[20:23], v[100:103]
    ds_read_b64_tr_b16 v[190:191], v5 offset:1024
    v_mfma_f32_16x16x32_bf16 v[88:91], v[40:43], a[16:19], v[88:91]
    buffer_load_dwordx4 v9, s[72:75], s93 offen offset:1024 lds
    v_mfma_f32_16x16x32_bf16 v[92:95], v[40:43], a[20:23], v[92:95]
    s_add_u32 s93, s88, 4716544
    ds_read_b64_tr_b16 v[32:33], v12 offset:2048
    v_mfma_f32_16x16x32_bf16 v[104:107], v[44:47], a[16:19], v[104:107]
    ds_read_b64_tr_b16 v[34:35], v13 offset:2048
    ds_read_b64_tr_b16 v[36:37], v2 offset:2048
    v_mfma_f32_16x16x32_bf16 v[108:111], v[44:47], a[20:23], v[108:111]
    ds_read_b64_tr_b16 v[38:39], v3 offset:2048
    s_waitcnt lgkmcnt(12)
    v_mfma_f32_16x16x32_bf16 v[64:67], v[160:163], a[0:3], 0
    buffer_load_dwordx4 v28, s[72:75], s93 offen offset:2048 lds
    v_mfma_f32_16x16x32_bf16 v[68:71], v[160:163], a[4:7], 0
    s_add_u32 m0, s52, 33792
    s_add_u32 s93, s85, 811008
    v_mfma_f32_16x16x32_bf16 v[128:131], v[164:167], a[0:3], 0
    ds_read_b64_tr_b16 v[40:41], v14 offset:2048
    ds_read_b64_tr_b16 v[42:43], v15 offset:2048
    v_mfma_f32_16x16x32_bf16 v[132:135], v[164:167], a[4:7], 0
    ds_read_b64_tr_b16 v[44:45], v4 offset:2048
    ds_read_b64_tr_b16 v[46:47], v5 offset:2048
    v_mfma_f32_16x16x32_bf16 v[72:75], v[168:171], a[0:3], 0
    buffer_load_dwordx4 v28, s[72:75], s93 offen offset:0 lds
    v_mfma_f32_16x16x32_bf16 v[76:79], v[168:171], a[4:7], 0
    ds_read_b64_tr_b16 v[160:161], v2 offset:3072
    ds_read_b64_tr_b16 v[162:163], v3 offset:3072
    v_mfma_f32_16x16x32_bf16 v[136:139], v[172:175], a[0:3], 0
    ds_read_b64_tr_b16 v[164:165], v12 offset:3072
    v_mfma_f32_16x16x32_bf16 v[140:143], v[172:175], a[4:7], 0
    ds_read_b64_tr_b16 v[166:167], v13 offset:3072
    s_waitcnt lgkmcnt(12)
    v_mfma_f32_16x16x32_bf16 v[64:67], v[176:179], a[8:11], v[64:67]
    buffer_load_dwordx4 v9, s[72:75], s93 offen offset:1024 lds
    v_mfma_f32_16x16x32_bf16 v[68:71], v[176:179], a[12:15], v[68:71]
    s_add_u32 s93, s88, 4790272
    ds_read_b64_tr_b16 v[168:169], v4 offset:3072
    v_mfma_f32_16x16x32_bf16 v[128:131], v[180:183], a[8:11], v[128:131]
    ds_read_b64_tr_b16 v[170:171], v5 offset:3072
    ds_read_b64_tr_b16 v[172:173], v14 offset:3072
    v_mfma_f32_16x16x32_bf16 v[132:135], v[180:183], a[12:15], v[132:135]
    ds_read_b64_tr_b16 v[174:175], v15 offset:3072
    v_mfma_f32_16x16x32_bf16 v[72:75], v[184:187], a[8:11], v[72:75]
    buffer_load_dwordx4 v28, s[72:75], s93 offen offset:2048 lds
    v_mfma_f32_16x16x32_bf16 v[76:79], v[184:187], a[12:15], v[76:79]
    s_add_u32 m0, s52, 36864
    ds_read_b64_tr_b16 v[176:177], v2 offset:4096
    v_mfma_f32_16x16x32_bf16 v[136:139], v[188:191], a[8:11], v[136:139]
    ds_read_b64_tr_b16 v[178:179], v3 offset:4096
    ds_read_b64_tr_b16 v[180:181], v12 offset:4096
    v_mfma_f32_16x16x32_bf16 v[140:143], v[188:191], a[12:15], v[140:143]
    ds_read_b64_tr_b16 v[182:183], v13 offset:4096
    s_waitcnt lgkmcnt(12)
    v_mfma_f32_16x16x32_bf16 v[64:67], v[32:35], a[16:19], v[64:67]
    s_add_u32 s93, s85, 258048
    ds_read_b64_tr_b16 v[184:185], v4 offset:4096
    v_mfma_f32_16x16x32_bf16 v[68:71], v[32:35], a[20:23], v[68:71]
    buffer_load_dwordx4 v28, s[72:75], s93 offen offset:0 lds
    v_mfma_f32_16x16x32_bf16 v[128:131], v[36:39], a[16:19], v[128:131]
    ds_read_b64_tr_b16 v[186:187], v5 offset:4096
    ds_read_b64_tr_b16 v[188:189], v14 offset:4096
    v_mfma_f32_16x16x32_bf16 v[132:135], v[36:39], a[20:23], v[132:135]
    ds_read_b64_tr_b16 v[190:191], v15 offset:4096
    v_mfma_f32_16x16x32_bf16 v[72:75], v[40:43], a[16:19], v[72:75]
    buffer_load_dwordx4 v9, s[72:75], s93 offen offset:1024 lds
    v_mfma_f32_16x16x32_bf16 v[76:79], v[40:43], a[20:23], v[76:79]
    s_add_u32 s93, s88, 4753408
    ds_read_b64_tr_b16 v[32:33], v2 offset:5120
    v_mfma_f32_16x16x32_bf16 v[136:139], v[44:47], a[16:19], v[136:139]
    ds_read_b64_tr_b16 v[34:35], v3 offset:5120
    ds_read_b64_tr_b16 v[36:37], v12 offset:5120
    v_mfma_f32_16x16x32_bf16 v[140:143], v[44:47], a[20:23], v[140:143]
    ds_read_b64_tr_b16 v[38:39], v13 offset:5120
    s_waitcnt lgkmcnt(12)
    v_mfma_f32_16x16x32_bf16 v[80:83], v[160:163], a[24:27], v[80:83]
    buffer_load_dwordx4 v28, s[72:75], s93 offen offset:2048 lds
    v_mfma_f32_16x16x32_bf16 v[84:87], v[160:163], a[28:31], v[84:87]
    ds_read_b64_tr_b16 v[40:41], v4 offset:5120
    ds_read_b64_tr_b16 v[42:43], v5 offset:5120
    v_mfma_f32_16x16x32_bf16 v[96:99], v[164:167], a[24:27], v[96:99]
    ds_read_b64_tr_b16 v[44:45], v14 offset:5120
    v_mfma_f32_16x16x32_bf16 v[100:103], v[164:167], a[28:31], v[100:103]
    ds_read_b64_tr_b16 v[46:47], v15 offset:5120
    v_mfma_f32_16x16x32_bf16 v[88:91], v[168:171], a[24:27], v[88:91]
    s_waitcnt vmcnt(9)
    buffer_store_dword v25, v24, s[68:71], 0 offen offset:2560 sc1
    s_barrier
    v_mfma_f32_16x16x32_bf16 v[92:95], v[168:171], a[28:31], v[92:95]
    s_add_u32 m0, s52, 24576
    ds_read_b64_tr_b16 v[160:161], v12 offset:6144
    v_mfma_f32_16x16x32_bf16 v[104:107], v[172:175], a[24:27], v[104:107]
    ds_read_b64_tr_b16 v[162:163], v13 offset:6144
    ds_read_b64_tr_b16 v[164:165], v2 offset:6144
    v_mfma_f32_16x16x32_bf16 v[108:111], v[172:175], a[28:31], v[108:111]
    ds_read_b64_tr_b16 v[166:167], v3 offset:6144
    s_waitcnt lgkmcnt(12)
    v_mfma_f32_16x16x32_bf16 v[80:83], v[176:179], a[32:35], v[80:83]
    s_add_u32 s93, s85, 847872
    ds_read_b64_tr_b16 v[168:169], v14 offset:6144
    v_mfma_f32_16x16x32_bf16 v[84:87], v[176:179], a[36:39], v[84:87]
    buffer_load_dwordx4 v28, s[72:75], s93 offen offset:0 lds
    v_mfma_f32_16x16x32_bf16 v[96:99], v[180:183], a[32:35], v[96:99]
    ds_read_b64_tr_b16 v[170:171], v15 offset:6144
    v_min_u32 v27, 5, v0
    v_mfma_f32_16x16x32_bf16 v[100:103], v[180:183], a[36:39], v[100:103]
    ds_read_b64_tr_b16 v[172:173], v4 offset:6144
    ds_read_b64_tr_b16 v[174:175], v5 offset:6144
    v_mfma_f32_16x16x32_bf16 v[88:91], v[184:187], a[32:35], v[88:91]
    buffer_load_dwordx4 v9, s[72:75], s93 offen offset:1024 lds
    v_mfma_f32_16x16x32_bf16 v[92:95], v[184:187], a[36:39], v[92:95]
    s_add_u32 s93, s88, 4827136
    ds_read_b64_tr_b16 v[176:177], v12 offset:7168
    v_mfma_f32_16x16x32_bf16 v[104:107], v[188:191], a[32:35], v[104:107]
    ds_read_b64_tr_b16 v[178:179], v13 offset:7168
    ds_read_b64_tr_b16 v[180:181], v2 offset:7168
    v_mfma_f32_16x16x32_bf16 v[108:111], v[188:191], a[36:39], v[108:111]
    ds_read_b64_tr_b16 v[182:183], v3 offset:7168
    s_waitcnt lgkmcnt(12)
    v_mfma_f32_16x16x32_bf16 v[80:83], v[32:35], a[40:43], v[80:83]
    buffer_load_dwordx4 v28, s[72:75], s93 offen offset:2048 lds
    v_mfma_f32_16x16x32_bf16 v[84:87], v[32:35], a[44:47], v[84:87]
    s_add_u32 m0, s52, 0
    s_add_u32 s93, s86, 626688
    v_mfma_f32_16x16x32_bf16 v[96:99], v[36:39], a[40:43], v[96:99]
    ds_read_b64_tr_b16 v[184:185], v14 offset:7168
    ds_read_b64_tr_b16 v[186:187], v15 offset:7168
    v_mfma_f32_16x16x32_bf16 v[100:103], v[36:39], a[44:47], v[100:103]
    ds_read_b64_tr_b16 v[188:189], v4 offset:7168
    ds_read_b64_tr_b16 v[190:191], v5 offset:7168
    v_mfma_f32_16x16x32_bf16 v[88:91], v[40:43], a[40:43], v[88:91]
    buffer_load_dwordx4 v28, s[72:75], s93 offen offset:0 lds
    v_mfma_f32_16x16x32_bf16 v[92:95], v[40:43], a[44:47], v[92:95]
    ds_read_b64_tr_b16 v[32:33], v12 offset:8192
    v_lshl_add_u32 v27, v27, 2, s26
    v_mfma_f32_16x16x32_bf16 v[104:107], v[44:47], a[40:43], v[104:107]
    ds_read_b64_tr_b16 v[34:35], v13 offset:8192
    ds_read_b64_tr_b16 v[36:37], v2 offset:8192
    v_mfma_f32_16x16x32_bf16 v[108:111], v[44:47], a[44:47], v[108:111]
    ds_read_b64_tr_b16 v[38:39], v3 offset:8192
    s_waitcnt lgkmcnt(12)
    v_mfma_f32_16x16x32_bf16 v[64:67], v[160:163], a[24:27], v[64:67]
    buffer_load_dwordx4 v7, s[72:75], s93 offen offset:1024 lds
    v_mfma_f32_16x16x32_bf16 v[68:71], v[160:163], a[28:31], v[68:71]
    v_mov_b32 v252, -1
    v_mov_b32 v253, -1
    v_mfma_f32_16x16x32_bf16 v[128:131], v[164:167], a[24:27], v[128:131]
    ds_read_b64_tr_b16 v[40:41], v14 offset:8192
    ds_read_b64_tr_b16 v[42:43], v15 offset:8192
    v_mfma_f32_16x16x32_bf16 v[132:135], v[164:167], a[28:31], v[132:135]
    ds_read_b64_tr_b16 v[44:45], v4 offset:8192
    ds_read_b64_tr_b16 v[46:47], v5 offset:8192
    v_mfma_f32_16x16x32_bf16 v[72:75], v[168:171], a[24:27], v[72:75]
    buffer_load_dwordx4 v8, s[72:75], s93 offen offset:2048 lds
    v_mfma_f32_16x16x32_bf16 v[76:79], v[168:171], a[28:31], v[76:79]
    ds_read_b64_tr_b16 v[160:161], v2 offset:9216
    v_mov_b32 v254, -1
    v_mfma_f32_16x16x32_bf16 v[136:139], v[172:175], a[24:27], v[136:139]
    ds_read_b64_tr_b16 v[162:163], v3 offset:9216
    ds_read_b64_tr_b16 v[164:165], v12 offset:9216
    v_mfma_f32_16x16x32_bf16 v[140:143], v[172:175], a[28:31], v[140:143]
    ds_read_b64_tr_b16 v[166:167], v13 offset:9216
    s_waitcnt lgkmcnt(12)
    v_mfma_f32_16x16x32_bf16 v[64:67], v[176:179], a[32:35], v[64:67]
    ds_read_b64_tr_b16 v[168:169], v4 offset:9216
    v_mov_b32 v255, -1
    v_mfma_f32_16x16x32_bf16 v[68:71], v[176:179], a[36:39], v[68:71]
    buffer_store_dwordx4 v[252:255], v22, s[68:71], s79 offen offset:1024 sc1
    ds_read_b64_tr_b16 v[170:171], v5 offset:9216
    v_mfma_f32_16x16x32_bf16 v[128:131], v[180:183], a[32:35], v[128:131]
    s_mul_i32 s77, s27, 6144
    ds_read_b64_tr_b16 v[172:173], v14 offset:9216
    v_mfma_f32_16x16x32_bf16 v[132:135], v[180:183], a[36:39], v[132:135]
    s_add_u32 s77, s77, 49119232
    ds_read_b64_tr_b16 v[174:175], v15 offset:9216
    v_mfma_f32_16x16x32_bf16 v[72:75], v[184:187], a[32:35], v[72:75]
    s_add_u32 s60, s81, 0
    ds_read_b64_tr_b16 v[176:177], v2 offset:10240
    v_mfma_f32_16x16x32_bf16 v[76:79], v[184:187], a[36:39], v[76:79]
    s_add_u32 s61, s81, 24576
    ds_read_b64_tr_b16 v[178:179], v3 offset:10240
    v_mfma_f32_16x16x32_bf16 v[136:139], v[188:191], a[32:35], v[136:139]
    s_add_u32 s62, s81, 49152
    ds_read_b64_tr_b16 v[180:181], v12 offset:10240
    v_mfma_f32_16x16x32_bf16 v[140:143], v[188:191], a[36:39], v[140:143]
    ds_read_b64_tr_b16 v[182:183], v13 offset:10240
    s_waitcnt lgkmcnt(12)
    v_mfma_f32_16x16x32_bf16 v[64:67], v[32:35], a[40:43], v[64:67]
    s_add_u32 s63, s81, 73728
    ds_read_b64_tr_b16 v[184:185], v4 offset:10240
    v_mfma_f32_16x16x32_bf16 v[68:71], v[32:35], a[44:47], v[68:71]
    ds_read_b64_tr_b16 v[186:187], v5 offset:10240
    v_and_b32 v17, 15, v0
    v_mfma_f32_16x16x32_bf16 v[128:131], v[36:39], a[40:43], v[128:131]
    ds_read_b64_tr_b16 v[188:189], v14 offset:10240
    v_mul_u32_u24 v16, 2304, v17
    v_mfma_f32_16x16x32_bf16 v[132:135], v[36:39], a[44:47], v[132:135]
    ds_read_b64_tr_b16 v[190:191], v15 offset:10240
    v_lshrrev_b32 v1, 4, v0
    v_mfma_f32_16x16x32_bf16 v[72:75], v[40:43], a[40:43], v[72:75]
    ds_read_b64_tr_b16 v[32:33], v2 offset:11264
    v_lshl_add_u32 v16, v1, 4, v16
    v_mfma_f32_16x16x32_bf16 v[76:79], v[40:43], a[44:47], v[76:79]
    ds_read_b64_tr_b16 v[34:35], v3 offset:11264
    v_add_u32 v19, 36864, v16
    v_mfma_f32_16x16x32_bf16 v[136:139], v[44:47], a[40:43], v[136:139]
    ds_read_b64_tr_b16 v[36:37], v12 offset:11264
    v_lshlrev_b32 v1, 2, v1
    v_mfma_f32_16x16x32_bf16 v[140:143], v[44:47], a[44:47], v[140:143]
    ds_read_b64_tr_b16 v[38:39], v13 offset:11264
    s_waitcnt lgkmcnt(12)
    v_mfma_f32_16x16x32_bf16 v[80:83], v[160:163], a[48:51], v[80:83]
    buffer_store_dwordx4 v[252:255], v22, s[68:71], s79 offen offset:2048 sc1
    ds_read_b64_tr_b16 v[40:41], v4 offset:11264
    v_mfma_f32_16x16x32_bf16 v[84:87], v[160:163], a[52:55], v[84:87]
    ds_read_b64_tr_b16 v[42:43], v5 offset:11264
    v_sub_u32 v1, v17, v1
    v_mfma_f32_16x16x32_bf16 v[96:99], v[164:167], a[48:51], v[96:99]
    ds_read_b64_tr_b16 v[44:45], v14 offset:11264
    v_lshlrev_b32 v17, 2, v17
    v_mfma_f32_16x16x32_bf16 v[100:103], v[164:167], a[52:55], v[100:103]
    ds_read_b64_tr_b16 v[46:47], v15 offset:11264
    v_and_b32 v56, 1, v0
    v_mfma_f32_16x16x32_bf16 v[88:91], v[168:171], a[48:51], v[88:91]
    ds_read_b64_tr_b16 v[160:161], v12 offset:12288
    v_lshlrev_b32 v56, 4, v56
    v_mfma_f32_16x16x32_bf16 v[92:95], v[168:171], a[52:55], v[92:95]
    ds_read_b64_tr_b16 v[162:163], v13 offset:12288
    v_mov_b32 v57, 0x3f80
    v_mfma_f32_16x16x32_bf16 v[104:107], v[172:175], a[48:51], v[104:107]
    ds_read_b64_tr_b16 v[164:165], v2 offset:12288
    v_lshlrev_b32 v57, v56, v57
    v_mfma_f32_16x16x32_bf16 v[108:111], v[172:175], a[52:55], v[108:111]
    ds_read_b64_tr_b16 v[166:167], v3 offset:12288
    s_waitcnt lgkmcnt(12)
    v_mfma_f32_16x16x32_bf16 v[80:83], v[176:179], a[56:59], v[80:83]
    global_load_dword v31, v30, s[48:49] offset:2048 sc1
    ds_read_b64_tr_b16 v[168:169], v14 offset:12288
    v_mfma_f32_16x16x32_bf16 v[84:87], v[176:179], a[60:63], v[84:87]
    ds_read_b64_tr_b16 v[170:171], v15 offset:12288
    v_lshrrev_b32 v1, 1, v1
    v_mfma_f32_16x16x32_bf16 v[96:99], v[180:183], a[56:59], v[96:99]
    v_cmp_eq_u32 s[28:29], 0, v1
    v_mov_b32 v56, 0
    v_mfma_f32_16x16x32_bf16 v[100:103], v[180:183], a[60:63], v[100:103]
    ds_read_b64_tr_b16 v[172:173], v4 offset:12288
    ds_read_b64_tr_b16 v[174:175], v5 offset:12288
    v_mfma_f32_16x16x32_bf16 v[88:91], v[184:187], a[56:59], v[88:91]
    ds_read_b64_tr_b16 v[176:177], v12 offset:13312
    v_mov_b32 v60, 0
    v_mfma_f32_16x16x32_bf16 v[92:95], v[184:187], a[60:63], v[92:95]
    ds_read_b64_tr_b16 v[178:179], v13 offset:13312
    v_cndmask_b32 v58, 0, v57, s[28:29]
    v_mfma_f32_16x16x32_bf16 v[104:107], v[188:191], a[56:59], v[104:107]
    ds_read_b64_tr_b16 v[180:181], v2 offset:13312
    v_mfma_f32_16x16x32_bf16 v[108:111], v[188:191], a[60:63], v[108:111]
    ds_read_b64_tr_b16 v[182:183], v3 offset:13312
    s_waitcnt lgkmcnt(12)
    v_mfma_f32_16x16x32_bf16 v[80:83], v[32:35], a[64:67], v[80:83]
    buffer_store_dwordx4 v[252:255], v22, s[68:71], s80 offen offset:1024 sc1
    ds_read_b64_tr_b16 v[184:185], v14 offset:13312
    v_mfma_f32_16x16x32_bf16 v[84:87], v[32:35], a[68:71], v[84:87]
    v_cmp_eq_u32 s[28:29], 1, v1
    v_mov_b32 v61, 0
    v_mfma_f32_16x16x32_bf16 v[96:99], v[36:39], a[64:67], v[96:99]
    s_and_b32 s54, s82, 1
    ds_read_b64_tr_b16 v[186:187], v15 offset:13312
    v_mfma_f32_16x16x32_bf16 v[100:103], v[36:39], a[68:71], v[100:103]
    ds_read_b64_tr_b16 v[188:189], v4 offset:13312
    ds_read_b64_tr_b16 v[190:191], v5 offset:13312
    v_mfma_f32_16x16x32_bf16 v[88:91], v[40:43], a[64:67], v[88:91]
    ds_read_b64_tr_b16 v[32:33], v12 offset:14336
    v_cndmask_b32 v59, 0, v57, s[28:29]
    v_mfma_f32_16x16x32_bf16 v[92:95], v[40:43], a[68:71], v[92:95]
    s_branch L_sskip8
L_stub8:
    s_setpc_b64 s[100:101]
L_sskip8:
    ds_read_b64_tr_b16 v[34:35], v13 offset:14336
    v_mov_b32 v57, 0
    v_mfma_f32_16x16x32_bf16 v[104:107], v[44:47], a[64:67], v[104:107]
    s_lshl_b32 s53, s98, 2
    ds_read_b64_tr_b16 v[36:37], v2 offset:14336
    v_mfma_f32_16x16x32_bf16 v[108:111], v[44:47], a[68:71], v[108:111]
    ds_read_b64_tr_b16 v[38:39], v3 offset:14336
    s_waitcnt lgkmcnt(12)
    v_mfma_f32_16x16x32_bf16 v[64:67], v[160:163], a[48:51], v[64:67]
    s_add_u32 s53, s53, s50
    ds_read_b64_tr_b16 v[40:41], v14 offset:14336
    v_mfma_f32_16x16x32_bf16 v[68:71], v[160:163], a[52:55], v[68:71]
    s_lshl_b32 s96, s53, 7
    ds_read_b64_tr_b16 v[42:43], v15 offset:14336
    v_mfma_f32_16x16x32_bf16 v[128:131], v[164:167], a[48:51], v[128:131]
    s_add_u32 s96, s96, 30236672
    ds_read_b64_tr_b16 v[44:45], v4 offset:14336
    v_mfma_f32_16x16x32_bf16 v[132:135], v[164:167], a[52:55], v[132:135]
    s_mul_i32 s94, s53, 73728
    ds_read_b64_tr_b16 v[46:47], v5 offset:14336
    v_mfma_f32_16x16x32_bf16 v[72:75], v[168:171], a[48:51], v[72:75]
    s_waitcnt vmcnt(4)
    s_barrier
    v_mfma_f32_16x16x32_bf16 v[76:79], v[168:171], a[52:55], v[76:79]
    s_add_u32 m0, s52, 3072
    ds_read_b64_tr_b16 v[160:161], v2 offset:27648
    v_mfma_f32_16x16x32_bf16 v[136:139], v[172:175], a[48:51], v[136:139]
    ds_read_b64_tr_b16 v[162:163], v3 offset:27648
    ds_read_b64_tr_b16 v[164:165], v12 offset:27648
    v_mfma_f32_16x16x32_bf16 v[140:143], v[172:175], a[52:55], v[140:143]
    ds_read_b64_tr_b16 v[166:167], v13 offset:27648
    s_waitcnt lgkmcnt(12)
    v_mfma_f32_16x16x32_bf16 v[64:67], v[176:179], a[56:59], v[64:67]
    s_add_u32 s93, s86, 921600
    ds_read_b64_tr_b16 v[168:169], v4 offset:27648
    v_mfma_f32_16x16x32_bf16 v[68:71], v[176:179], a[60:63], v[68:71]
    buffer_load_dwordx4 v28, s[72:75], s93 offen offset:0 lds
    v_mfma_f32_16x16x32_bf16 v[128:131], v[180:183], a[56:59], v[128:131]
    buffer_store_dwordx4 v[252:255], v22, s[68:71], s80 offen offset:2048 sc1
    ds_read_b64_tr_b16 v[170:171], v5 offset:27648
    v_mfma_f32_16x16x32_bf16 v[132:135], v[180:183], a[60:63], v[132:135]
    ds_read_b64_tr_b16 v[172:173], v14 offset:27648
    ds_read_b64_tr_b16 v[174:175], v15 offset:27648
    v_mfma_f32_16x16x32_bf16 v[72:75], v[184:187], a[56:59], v[72:75]
    buffer_load_dwordx4 v7, s[72:75], s93 offen offset:1024 lds
    v_mfma_f32_16x16x32_bf16 v[76:79], v[184:187], a[60:63], v[76:79]
    s_mul_i32 s53, s99, 768
    ds_read_b64_tr_b16 v[176:177], v2 offset:28672
    v_mfma_f32_16x16x32_bf16 v[136:139], v[188:191], a[56:59], v[136:139]
    ds_read_b64_tr_b16 v[178:179], v3 offset:28672
    ds_read_b64_tr_b16 v[180:181], v12 offset:28672
    v_mfma_f32_16x16x32_bf16 v[140:143], v[188:191], a[60:63], v[140:143]
    ds_read_b64_tr_b16 v[182:183], v13 offset:28672
    s_waitcnt lgkmcnt(12)
    v_mfma_f32_16x16x32_bf16 v[64:67], v[32:35], a[64:67], v[64:67]
    buffer_load_dwordx4 v8, s[72:75], s93 offen offset:2048 lds
    v_mfma_f32_16x16x32_bf16 v[68:71], v[32:35], a[68:71], v[68:71]
    s_add_u32 s94, s94, s53
    s_lshr_b32 s53, s82, 1
    v_mfma_f32_16x16x32_bf16 v[128:131], v[36:39], a[64:67], v[128:131]
    ds_read_b64_tr_b16 v[184:185], v4 offset:28672
    ds_read_b64_tr_b16 v[186:187], v5 offset:28672
    v_mfma_f32_16x16x32_bf16 v[132:135], v[36:39], a[68:71], v[132:135]
    ds_read_b64_tr_b16 v[188:189], v14 offset:28672
    ds_read_b64_tr_b16 v[190:191], v15 offset:28672
    v_mfma_f32_16x16x32_bf16 v[72:75], v[40:43], a[64:67], v[72:75]
    s_add_u32 m0, s52, 6144
    ds_read_b64_tr_b16 v[32:33], v2 offset:29696
    v_mfma_f32_16x16x32_bf16 v[76:79], v[40:43], a[68:71], v[76:79]
    s_add_u32 s93, s86, 221184
    ds_read_b64_tr_b16 v[34:35], v3 offset:29696
    v_mfma_f32_16x16x32_bf16 v[136:139], v[44:47], a[64:67], v[136:139]
    s_lshl1_add_u32 s54, s54, s53
    ds_read_b64_tr_b16 v[36:37], v12 offset:29696
    v_mfma_f32_16x16x32_bf16 v[140:143], v[44:47], a[68:71], v[140:143]
    ds_read_b64_tr_b16 v[38:39], v13 offset:29696
    s_waitcnt lgkmcnt(12)
    v_mfma_f32_16x16x32_bf16 v[80:83], v[160:163], a[72:75], v[80:83]
    buffer_load_dwordx4 v28, s[72:75], s93 offen offset:0 lds
    v_mfma_f32_16x16x32_bf16 v[84:87], v[160:163], a[76:79], v[84:87]
    s_lshl_b32 s54, s54, 6
    s_add_u32 s94, s94, s54
    v_mfma_f32_16x16x32_bf16 v[96:99], v[164:167], a[72:75], v[96:99]
    ds_read_b64_tr_b16 v[40:41], v4 offset:29696
    ds_read_b64_tr_b16 v[42:43], v5 offset:29696
    v_mfma_f32_16x16x32_bf16 v[100:103], v[164:167], a[76:79], v[100:103]
    ds_read_b64_tr_b16 v[44:45], v14 offset:29696
    ds_read_b64_tr_b16 v[46:47], v15 offset:29696
    v_mfma_f32_16x16x32_bf16 v[88:91], v[168:171], a[72:75], v[88:91]
    buffer_load_dwordx4 v9, s[72:75], s93 offen offset:1024 lds
    v_mfma_f32_16x16x32_bf16 v[92:95], v[168:171], a[76:79], v[92:95]
    s_add_u32 s93, s89, 4716544
    ds_read_b64_tr_b16 v[160:161], v12 offset:15360
    v_mfma_f32_16x16x32_bf16 v[104:107], v[172:175], a[72:75], v[104:107]
    ds_read_b64_tr_b16 v[162:163], v13 offset:15360
    ds_read_b64_tr_b16 v[164:165], v2 offset:15360
    v_mfma_f32_16x16x32_bf16 v[108:111], v[172:175], a[76:79], v[108:111]
    ds_read_b64_tr_b16 v[166:167], v3 offset:15360
    s_waitcnt lgkmcnt(12)
    v_mfma_f32_16x16x32_bf16 v[80:83], v[176:179], a[80:83], v[80:83]
    s_waitcnt vmcnt(7)
    v_cmp_gt_u32 vcc, 1, v31
    s_cbranch_vccnz L_poll5
L_fok5:
    global_load_dword v31, v30, s[48:49] offset:2560 sc1
    v_mfma_f32_16x16x32_bf16 v[84:87], v[176:179], a[84:87], v[84:87]
    buffer_load_dwordx4 v28, s[72:75], s93 offen offset:2048 lds
    v_mfma_f32_16x16x32_bf16 v[96:99], v[180:183], a[80:83], v[96:99]
    ds_read_b64_tr_b16 v[168:169], v14 offset:15360
    ds_read_b64_tr_b16 v[170:171], v15 offset:15360
    v_mfma_f32_16x16x32_bf16 v[100:103], v[180:183], a[84:87], v[100:103]
    ds_read_b64_tr_b16 v[172:173], v4 offset:15360
    ds_read_b64_tr_b16 v[174:175], v5 offset:15360
    v_mfma_f32_16x16x32_bf16 v[88:91], v[184:187], a[80:83], v[88:91]
    s_add_u32 s83, s76, 196608
    ds_read_b64_tr_b16 v[176:177], v12 offset:16384
    v_mfma_f32_16x16x32_bf16 v[92:95], v[184:187], a[84:87], v[92:95]
    buffer_load_dwordx4 a[144:147], v22, s[68:71], s83 offen offset:0 sc1
    v_mfma_f32_16x16x32_bf16 v[104:107], v[188:191], a[80:83], v[104:107]
    ds_read_b64_tr_b16 v[178:179], v13 offset:16384
    ds_read_b64_tr_b16 v[180:181], v2 offset:16384
    v_mfma_f32_16x16x32_bf16 v[108:111], v[188:191], a[84:87], v[108:111]
    ds_read_b64_tr_b16 v[182:183], v3 offset:16384
    s_waitcnt lgkmcnt(12)
    v_mfma_f32_16x16x32_bf16 v[80:83], v[32:35], a[88:91], v[80:83]
    buffer_load_dwordx4 a[148:151], v22, s[68:71], s83 offen offset:1024 sc1
    v_mfma_f32_16x16x32_bf16 v[84:87], v[32:35], a[92:95], v[84:87]
    s_add_u32 s95, s94, 256
    s_lshl_b32 s53, s53, 9
    v_mfma_f32_16x16x32_bf16 v[96:99], v[36:39], a[88:91], v[96:99]
    ds_read_b64_tr_b16 v[184:185], v14 offset:16384
    ds_read_b64_tr_b16 v[186:187], v15 offset:16384
    v_mfma_f32_16x16x32_bf16 v[100:103], v[36:39], a[92:95], v[100:103]
    ds_read_b64_tr_b16 v[188:189], v4 offset:16384
    ds_read_b64_tr_b16 v[190:191], v5 offset:16384
    v_mfma_f32_16x16x32_bf16 v[88:91], v[40:43], a[88:91], v[88:91]
    buffer_load_dwordx4 a[152:155], v22, s[68:71], s83 offen offset:2048 sc1
    v_mfma_f32_16x16x32_bf16 v[92:95], v[40:43], a[92:95], v[92:95]
    s_add_u32 s94, s94, s53
    ds_read_b64_tr_b16 v[32:33], v12 offset:17408
    v_mfma_f32_16x16x32_bf16 v[104:107], v[44:47], a[88:91], v[104:107]
    ds_read_b64_tr_b16 v[34:35], v13 offset:17408
    ds_read_b64_tr_b16 v[36:37], v2 offset:17408
    v_mfma_f32_16x16x32_bf16 v[108:111], v[44:47], a[92:95], v[108:111]
    ds_read_b64_tr_b16 v[38:39], v3 offset:17408
    s_waitcnt lgkmcnt(12)
    v_mfma_f32_16x16x32_bf16 v[64:67], v[160:163], a[72:75], v[64:67]
    buffer_load_dwordx4 a[156:159], v22, s[68:71], s83 offen offset:3072 sc1
    v_mfma_f32_16x16x32_bf16 v[68:71], v[160:163], a[76:79], v[68:71]
    s_xor_b32 s97, s94, 64
    s_andn2_b32 s97, s94, 64
    v_mfma_f32_16x16x32_bf16 v[128:131], v[164:167], a[72:75], v[128:131]
    ds_read_b64_tr_b16 v[40:41], v14 offset:17408
    ds_read_b64_tr_b16 v[42:43], v15 offset:17408
    v_mfma_f32_16x16x32_bf16 v[132:135], v[164:167], a[76:79], v[132:135]
    ds_read_b64_tr_b16 v[44:45], v4 offset:17408
    ds_read_b64_tr_b16 v[46:47], v5 offset:17408
    v_mfma_f32_16x16x32_bf16 v[72:75], v[168:171], a[72:75], v[72:75]
    s_add_u32 s83, s76, 200704
    ds_read_b64_tr_b16 v[160:161], v2 offset:18432
    v_mfma_f32_16x16x32_bf16 v[76:79], v[168:171], a[76:79], v[76:79]
    buffer_load_dwordx4 a[160:163], v22, s[68:71], s83 offen offset:0 sc1
    v_mfma_f32_16x16x32_bf16 v[136:139], v[172:175], a[72:75], v[136:139]
    ds_read_b64_tr_b16 v[162:163], v3 offset:18432
    ds_read_b64_tr_b16 v[164:165], v12 offset:18432
    v_mfma_f32_16x16x32_bf16 v[140:143], v[172:175], a[76:79], v[140:143]
    ds_read_b64_tr_b16 v[166:167], v13 offset:18432
    s_waitcnt lgkmcnt(12)
    v_mfma_f32_16x16x32_bf16 v[64:67], v[176:179], a[80:83], v[64:67]
    buffer_load_dwordx4 a[164:167], v22, s[68:71], s83 offen offset:1024 sc1
    v_mfma_f32_16x16x32_bf16 v[68:71], v[176:179], a[84:87], v[68:71]
    s_and_b32 s53, s94, 64
    v_and_b32 v1, 1, v0
    v_mfma_f32_16x16x32_bf16 v[128:131], v[180:183], a[80:83], v[128:131]
    ds_read_b64_tr_b16 v[168:169], v4 offset:18432
    ds_read_b64_tr_b16 v[170:171], v5 offset:18432
    v_mfma_f32_16x16x32_bf16 v[132:135], v[180:183], a[84:87], v[132:135]
    ds_read_b64_tr_b16 v[172:173], v14 offset:18432
    ds_read_b64_tr_b16 v[174:175], v15 offset:18432
    v_mfma_f32_16x16x32_bf16 v[72:75], v[184:187], a[80:83], v[72:75]
    ds_read_b64_tr_b16 v[176:177], v2 offset:19456
    v_mul_u32_u24 v62, 2240, v1
    v_mfma_f32_16x16x32_bf16 v[76:79], v[184:187], a[84:87], v[76:79]
    ds_read_b64_tr_b16 v[178:179], v3 offset:19456
    v_sub_u32 v62, v16, v62
    v_mfma_f32_16x16x32_bf16 v[136:139], v[188:191], a[80:83], v[136:139]
    ds_read_b64_tr_b16 v[180:181], v12 offset:19456
    v_xor_b32 v62, s53, v62
    v_mfma_f32_16x16x32_bf16 v[140:143], v[188:191], a[84:87], v[140:143]
    ds_read_b64_tr_b16 v[182:183], v13 offset:19456
    s_waitcnt lgkmcnt(12)
    v_mfma_f32_16x16x32_bf16 v[64:67], v[32:35], a[88:91], v[64:67]
    buffer_load_dwordx4 a[168:171], v22, s[68:71], s83 offen offset:2048 sc1
    v_mfma_f32_16x16x32_bf16 v[68:71], v[32:35], a[92:95], v[68:71]
    v_add_u32 v63, 36864, v62
    s_mov_b32 s28, 0x55555555
    v_mfma_f32_16x16x32_bf16 v[128:131], v[36:39], a[88:91], v[128:131]
    ds_read_b64_tr_b16 v[184:185], v4 offset:19456
    ds_read_b64_tr_b16 v[186:187], v5 offset:19456
    v_mfma_f32_16x16x32_bf16 v[132:135], v[36:39], a[92:95], v[132:135]
    ds_read_b64_tr_b16 v[188:189], v14 offset:19456
    ds_read_b64_tr_b16 v[190:191], v15 offset:19456
    v_mfma_f32_16x16x32_bf16 v[72:75], v[40:43], a[88:91], v[72:75]
    buffer_load_dwordx4 a[172:175], v22, s[68:71], s83 offen offset:3072 sc1
    v_mfma_f32_16x16x32_bf16 v[76:79], v[40:43], a[92:95], v[76:79]
    s_mov_b32 s29, 0x55555555
    ds_read_b64_tr_b16 v[32:33], v2 offset:20480
    v_mfma_f32_16x16x32_bf16 v[136:139], v[44:47], a[88:91], v[136:139]
    ds_read_b64_tr_b16 v[34:35], v3 offset:20480
    ds_read_b64_tr_b16 v[36:37], v12 offset:20480
    v_mfma_f32_16x16x32_bf16 v[140:143], v[44:47], a[92:95], v[140:143]
    ds_read_b64_tr_b16 v[38:39], v13 offset:20480
    s_waitcnt lgkmcnt(12)
    v_mfma_f32_16x16x32_bf16 v[80:83], v[160:163], a[96:99], v[80:83]
    s_waitcnt vmcnt(14)
    buffer_store_dword v25, v29, s[68:71], 0 offen sc1
    v_mfma_f32_16x16x32_bf16 v[84:87], v[160:163], a[100:103], v[84:87]
    s_add_u32 s83, s76, 204800
    s_mov_b32 s64, s44
    v_mfma_f32_16x16x32_bf16 v[96:99], v[164:167], a[96:99], v[96:99]
    ds_read_b64_tr_b16 v[40:41], v4 offset:20480
    ds_read_b64_tr_b16 v[42:43], v5 offset:20480
    v_mfma_f32_16x16x32_bf16 v[100:103], v[164:167], a[100:103], v[100:103]
    ds_read_b64_tr_b16 v[44:45], v14 offset:20480
    ds_read_b64_tr_b16 v[46:47], v15 offset:20480
    v_mfma_f32_16x16x32_bf16 v[88:91], v[168:171], a[96:99], v[88:91]
    buffer_load_dwordx4 a[176:179], v22, s[68:71], s83 offen offset:0 sc1
    s_waitcnt vmcnt(10)
    s_barrier
    v_mfma_f32_16x16x32_bf16 v[92:95], v[168:171], a[100:103], v[92:95]
    s_mov_b32 s65, s45
    ds_read_b64_tr_b16 v[160:161], v2 offset:21504
    v_mfma_f32_16x16x32_bf16 v[104:107], v[172:175], a[96:99], v[104:107]
    ds_read_b64_tr_b16 v[162:163], v3 offset:21504
    ds_read_b64_tr_b16 v[164:165], v12 offset:21504
    v_mfma_f32_16x16x32_bf16 v[108:111], v[172:175], a[100:103], v[108:111]
    ds_read_b64_tr_b16 v[166:167], v13 offset:21504
    s_waitcnt lgkmcnt(12)
    v_mfma_f32_16x16x32_bf16 v[80:83], v[176:179], a[104:107], v[80:83]
    v_cmp_gt_u32 vcc, 1, v31
    s_cbranch_vccnz L_poll6
L_fok6:
    v_mfma_f32_16x16x32_bf16 v[84:87], v[176:179], a[108:111], v[84:87]
    buffer_load_dwordx4 a[180:183], v22, s[68:71], s83 offen offset:1024 sc1
    v_mfma_f32_16x16x32_bf16 v[96:99], v[180:183], a[104:107], v[96:99]
    ds_read_b64_tr_b16 v[168:169], v4 offset:21504
    ds_read_b64_tr_b16 v[170:171], v5 offset:21504
    v_mfma_f32_16x16x32_bf16 v[100:103], v[180:183], a[108:111], v[100:103]
    ds_read_b64_tr_b16 v[172:173], v14 offset:21504
    ds_read_b64_tr_b16 v[174:175], v15 offset:21504
    v_mfma_f32_16x16x32_bf16 v[88:91], v[184:187], a[104:107], v[88:91]
    buffer_load_dwordx4 a[184:187], v22, s[68:71], s83 offen offset:2048 sc1
    v_mfma_f32_16x16x32_bf16 v[92:95], v[184:187], a[108:111], v[92:95]
    s_mov_b32 s66, 4718592
    ds_read_b64_tr_b16 v[176:177], v2 offset:22528
    v_mfma_f32_16x16x32_bf16 v[104:107], v[188:191], a[104:107], v[104:107]
    ds_read_b64_tr_b16 v[178:179], v3 offset:22528
    ds_read_b64_tr_b16 v[180:181], v12 offset:22528
    v_mfma_f32_16x16x32_bf16 v[108:111], v[188:191], a[108:111], v[108:111]
    ds_read_b64_tr_b16 v[182:183], v13 offset:22528
    s_waitcnt lgkmcnt(12)
    v_mfma_f32_16x16x32_bf16 v[80:83], v[32:35], a[112:115], v[80:83]
    buffer_load_dwordx4 a[188:191], v22, s[68:71], s83 offen offset:3072 sc1
    v_mfma_f32_16x16x32_bf16 v[84:87], v[32:35], a[116:119], v[84:87]
    s_mov_b32 s67, 0x20000
    ds_read_b64_tr_b16 v[184:185], v4 offset:22528
    v_mfma_f32_16x16x32_bf16 v[96:99], v[36:39], a[112:115], v[96:99]
    ds_read_b64_tr_b16 v[186:187], v5 offset:22528
    ds_read_b64_tr_b16 v[188:189], v14 offset:22528
    v_mfma_f32_16x16x32_bf16 v[100:103], v[36:39], a[116:119], v[100:103]
    ds_read_b64_tr_b16 v[190:191], v15 offset:22528
    v_mfma_f32_16x16x32_bf16 v[88:91], v[40:43], a[112:115], v[88:91]
    s_add_u32 s83, s76, 245760
    ds_read_b64_tr_b16 v[32:33], v2 offset:23552
    v_mfma_f32_16x16x32_bf16 v[92:95], v[40:43], a[116:119], v[92:95]
    buffer_load_dwordx4 a[192:195], v22, s[68:71], s83 offen offset:0 sc1
    v_mfma_f32_16x16x32_bf16 v[104:107], v[44:47], a[112:115], v[104:107]
    ds_read_b64_tr_b16 v[34:35], v3 offset:23552
    ds_read_b64_tr_b16 v[36:37], v12 offset:23552
    v_mfma_f32_16x16x32_bf16 v[108:111], v[44:47], a[116:119], v[108:111]
    ds_read_b64_tr_b16 v[38:39], v13 offset:23552
    s_waitcnt lgkmcnt(12)
    v_mfma_f32_16x16x32_bf16 v[80:83], v[160:163], a[120:123], v[80:83]
    ds_read_b64_tr_b16 v[40:41], v4 offset:23552
    v_mfma_f32_16x16x32_bf16 v[84:87], v[160:163], a[124:127], v[84:87]
    ds_read_b64_tr_b16 v[42:43], v5 offset:23552
    v_mfma_f32_16x16x32_bf16 v[96:99], v[164:167], a[120:123], v[96:99]
    ds_read_b64_tr_b16 v[44:45], v14 offset:23552
    v_mfma_f32_16x16x32_bf16 v[100:103], v[164:167], a[124:127], v[100:103]
    ds_read_b64_tr_b16 v[46:47], v15 offset:23552
    v_mfma_f32_16x16x32_bf16 v[88:91], v[168:171], a[120:123], v[88:91]
    buffer_load_dwordx4 a[196:199], v22, s[68:71], s83 offen offset:1024 sc1
    v_mfma_f32_16x16x32_bf16 v[92:95], v[168:171], a[124:127], v[92:95]
    ds_read_b64_tr_b16 v[160:161], v2 offset:30720
    ds_read_b64_tr_b16 v[162:163], v3 offset:30720
    v_mfma_f32_16x16x32_bf16 v[104:107], v[172:175], a[120:123], v[104:107]
    ds_read_b64_tr_b16 v[164:165], v12 offset:30720
    v_mfma_f32_16x16x32_bf16 v[108:111], v[172:175], a[124:127], v[108:111]
    ds_read_b64_tr_b16 v[166:167], v13 offset:30720
    s_waitcnt lgkmcnt(12)
    v_mfma_f32_16x16x32_bf16 v[80:83], v[176:179], a[128:131], v[80:83]
    buffer_load_dwordx4 a[200:203], v22, s[68:71], s83 offen offset:2048 sc1
    v_mfma_f32_16x16x32_bf16 v[84:87], v[176:179], a[132:135], v[84:87]
    ds_read_b64_tr_b16 v[168:169], v4 offset:30720
    ds_read_b64_tr_b16 v[170:171], v5 offset:30720
    v_mfma_f32_16x16x32_bf16 v[96:99], v[180:183], a[128:131], v[96:99]
    ds_read_b64_tr_b16 v[172:173], v14 offset:30720
    v_mfma_f32_16x16x32_bf16 v[100:103], v[180:183], a[132:135], v[100:103]
    ds_read_b64_tr_b16 v[174:175], v15 offset:30720
    v_mfma_f32_16x16x32_bf16 v[88:91], v[184:187], a[128:131], v[88:91]
    buffer_load_dwordx4 a[204:207], v22, s[68:71], s83 offen offset:3072 sc1
    v_mfma_f32_16x16x32_bf16 v[92:95], v[184:187], a[132:135], v[92:95]
    ds_read_b64_tr_b16 v[176:177], v2 offset:31744
    ds_read_b64_tr_b16 v[178:179], v3 offset:31744
    v_mfma_f32_16x16x32_bf16 v[104:107], v[188:191], a[128:131], v[104:107]
    ds_read_b64_tr_b16 v[180:181], v12 offset:31744
    v_mfma_f32_16x16x32_bf16 v[108:111], v[188:191], a[132:135], v[108:111]
    ds_read_b64_tr_b16 v[182:183], v13 offset:31744
    s_waitcnt lgkmcnt(12)
    v_mfma_f32_16x16x32_bf16 v[80:83], v[32:35], a[136:139], v[80:83]
    ds_read_b64_tr_b16 v[184:185], v4 offset:31744
    v_mfma_f32_16x16x32_bf16 v[84:87], v[32:35], a[140:143], v[84:87]
    ds_read_b64_tr_b16 v[186:187], v5 offset:31744
    v_mfma_f32_16x16x32_bf16 v[96:99], v[36:39], a[136:139], v[96:99]
    ds_read_b64_tr_b16 v[188:189], v14 offset:31744
    v_mfma_f32_16x16x32_bf16 v[100:103], v[36:39], a[140:143], v[100:103]
    ds_read_b64_tr_b16 v[190:191], v15 offset:31744
    v_mfma_f32_16x16x32_bf16 v[88:91], v[40:43], a[136:139], v[88:91]
    s_add_u32 s83, s76, 249856
    ds_read_b64_tr_b16 v[32:33], v2 offset:32768
    v_mfma_f32_16x16x32_bf16 v[92:95], v[40:43], a[140:143], v[92:95]
    buffer_load_dwordx4 a[208:211], v22, s[68:71], s83 offen offset:0 sc1
    v_mfma_f32_16x16x32_bf16 v[104:107], v[44:47], a[136:139], v[104:107]
    ds_read_b64_tr_b16 v[34:35], v3 offset:32768
    ds_read_b64_tr_b16 v[36:37], v12 offset:32768
    v_mfma_f32_16x16x32_bf16 v[108:111], v[44:47], a[140:143], v[108:111]
    ds_read_b64_tr_b16 v[38:39], v13 offset:32768
    s_waitcnt vmcnt(16) lgkmcnt(12)
    v_mfma_f32_16x16x32_bf16 v[80:83], v[160:163], a[144:147], v[80:83]
    buffer_load_dwordx4 a[212:215], v22, s[68:71], s83 offen offset:1024 sc1
    v_mfma_f32_16x16x32_bf16 v[84:87], v[160:163], a[148:151], v[84:87]
    ds_read_b64_tr_b16 v[40:41], v4 offset:32768
    ds_read_b64_tr_b16 v[42:43], v5 offset:32768
    v_mfma_f32_16x16x32_bf16 v[96:99], v[164:167], a[144:147], v[96:99]
    ds_read_b64_tr_b16 v[44:45], v14 offset:32768
    v_mfma_f32_16x16x32_bf16 v[100:103], v[164:167], a[148:151], v[100:103]
    ds_read_b64_tr_b16 v[46:47], v15 offset:32768
    v_mfma_f32_16x16x32_bf16 v[88:91], v[168:171], a[144:147], v[88:91]
    buffer_load_dwordx4 a[216:219], v22, s[68:71], s83 offen offset:2048 sc1
    v_mfma_f32_16x16x32_bf16 v[92:95], v[168:171], a[148:151], v[92:95]
    ds_read_b64_tr_b16 v[160:161], v2 offset:33792
    ds_read_b64_tr_b16 v[162:163], v3 offset:33792
    v_mfma_f32_16x16x32_bf16 v[104:107], v[172:175], a[144:147], v[104:107]
    ds_read_b64_tr_b16 v[164:165], v12 offset:33792
    v_mfma_f32_16x16x32_bf16 v[108:111], v[172:175], a[148:151], v[108:111]
    ds_read_b64_tr_b16 v[166:167], v13 offset:33792
    s_waitcnt vmcnt(16) lgkmcnt(12)
    v_mfma_f32_16x16x32_bf16 v[80:83], v[176:179], a[152:155], v[80:83]
    buffer_load_dwordx4 a[220:223], v22, s[68:71], s83 offen offset:3072 sc1
    v_mfma_f32_16x16x32_bf16 v[84:87], v[176:179], a[156:159], v[84:87]
    ds_read_b64_tr_b16 v[168:169], v4 offset:33792
    ds_read_b64_tr_b16 v[170:171], v5 offset:33792
    v_mfma_f32_16x16x32_bf16 v[96:99], v[180:183], a[152:155], v[96:99]
    ds_read_b64_tr_b16 v[172:173], v14 offset:33792
    v_mfma_f32_16x16x32_bf16 v[100:103], v[180:183], a[156:159], v[100:103]
    ds_read_b64_tr_b16 v[174:175], v15 offset:33792
    v_mfma_f32_16x16x32_bf16 v[88:91], v[184:187], a[152:155], v[88:91]
    s_add_u32 s83, s76, 253952
    ds_read_b64_tr_b16 v[176:177], v2 offset:34816
    v_mfma_f32_16x16x32_bf16 v[92:95], v[184:187], a[156:159], v[92:95]
    buffer_load_dwordx4 a[224:227], v22, s[68:71], s83 offen offset:0 sc1
    v_mfma_f32_16x16x32_bf16 v[104:107], v[188:191], a[152:155], v[104:107]
    ds_read_b64_tr_b16 v[178:179], v3 offset:34816
    ds_read_b64_tr_b16 v[180:181], v12 offset:34816
    v_mfma_f32_16x16x32_bf16 v[108:111], v[188:191], a[156:159], v[108:111]
    ds_read_b64_tr_b16 v[182:183], v13 offset:34816
    s_waitcnt vmcnt(16) lgkmcnt(12)
    v_mfma_f32_16x16x32_bf16 v[80:83], v[32:35], a[160:163], v[80:83]
    buffer_load_dwordx4 a[228:231], v22, s[68:71], s83 offen offset:1024 sc1
    v_mfma_f32_16x16x32_bf16 v[84:87], v[32:35], a[164:167], v[84:87]
    ds_read_b64_tr_b16 v[184:185], v4 offset:34816
    ds_read_b64_tr_b16 v[186:187], v5 offset:34816
    v_mfma_f32_16x16x32_bf16 v[96:99], v[36:39], a[160:163], v[96:99]
    ds_read_b64_tr_b16 v[188:189], v14 offset:34816
    v_mfma_f32_16x16x32_bf16 v[100:103], v[36:39], a[164:167], v[100:103]
    ds_read_b64_tr_b16 v[190:191], v15 offset:34816
    v_mfma_f32_16x16x32_bf16 v[88:91], v[40:43], a[160:163], v[88:91]
    buffer_load_dwordx4 a[232:235], v22, s[68:71], s83 offen offset:2048 sc1
    v_mfma_f32_16x16x32_bf16 v[92:95], v[40:43], a[164:167], v[92:95]
    ds_read_b64_tr_b16 v[32:33], v2 offset:35840
    ds_read_b64_tr_b16 v[34:35], v3 offset:35840
    v_mfma_f32_16x16x32_bf16 v[104:107], v[44:47], a[160:163], v[104:107]
    ds_read_b64_tr_b16 v[36:37], v12 offset:35840
    v_mfma_f32_16x16x32_bf16 v[108:111], v[44:47], a[164:167], v[108:111]
    ds_read_b64_tr_b16 v[38:39], v13 offset:35840
    s_waitcnt vmcnt(16) lgkmcnt(12)
    v_mfma_f32_16x16x32_bf16 v[80:83], v[160:163], a[168:171], v[80:83]
    buffer_load_dwordx4 a[236:239], v22, s[68:71], s83 offen offset:3072 sc1
    v_mfma_f32_16x16x32_bf16 v[84:87], v[160:163], a[172:175], v[84:87]
    ds_read_b64_tr_b16 v[40:41], v4 offset:35840
    ds_read_b64_tr_b16 v[42:43], v5 offset:35840
    v_mfma_f32_16x16x32_bf16 v[96:99], v[164:167], a[168:171], v[96:99]
    ds_read_b64_tr_b16 v[44:45], v14 offset:35840
    v_mfma_f32_16x16x32_bf16 v[100:103], v[164:167], a[172:175], v[100:103]
    ds_read_b64_tr_b16 v[46:47], v15 offset:35840
    v_mfma_f32_16x16x32_bf16 v[88:91], v[168:171], a[168:171], v[88:91]
    s_barrier
    ds_read_b64_tr_b16 v[160:161], v2 offset:36864
    v_mfma_f32_16x16x32_bf16 v[92:95], v[168:171], a[172:175], v[92:95]
    ds_read_b64_tr_b16 v[162:163], v3 offset:36864
    v_mfma_f32_16x16x32_bf16 v[104:107], v[172:175], a[168:171], v[104:107]
    ds_read_b64_tr_b16 v[164:165], v12 offset:36864
    v_mfma_f32_16x16x32_bf16 v[108:111], v[172:175], a[172:175], v[108:111]
    ds_read_b64_tr_b16 v[166:167], v13 offset:36864
    s_waitcnt vmcnt(14) lgkmcnt(12)
    v_mfma_f32_16x16x32_bf16 v[80:83], v[176:179], a[176:179], v[80:83]
    ds_read_b64_tr_b16 v[168:169], v4 offset:36864
    v_mfma_f32_16x16x32_bf16 v[84:87], v[176:179], a[180:183], v[84:87]
    ds_read_b64_tr_b16 v[170:171], v5 offset:36864
    v_mfma_f32_16x16x32_bf16 v[96:99], v[180:183], a[176:179], v[96:99]
    ds_read_b64_tr_b16 v[172:173], v14 offset:36864
    v_mfma_f32_16x16x32_bf16 v[100:103], v[180:183], a[180:183], v[100:103]
    ds_read_b64_tr_b16 v[174:175], v15 offset:36864
    v_mfma_f32_16x16x32_bf16 v[88:91], v[184:187], a[176:179], v[88:91]
    ds_read_b64_tr_b16 v[176:177], v2 offset:37888
    v_mfma_f32_16x16x32_bf16 v[92:95], v[184:187], a[180:183], v[92:95]
    ds_read_b64_tr_b16 v[178:179], v3 offset:37888
    v_mfma_f32_16x16x32_bf16 v[104:107], v[188:191], a[176:179], v[104:107]
    ds_read_b64_tr_b16 v[180:181], v12 offset:37888
    v_mfma_f32_16x16x32_bf16 v[108:111], v[188:191], a[180:183], v[108:111]
    ds_read_b64_tr_b16 v[182:183], v13 offset:37888
    s_waitcnt vmcnt(12) lgkmcnt(12)
    v_mfma_f32_16x16x32_bf16 v[80:83], v[32:35], a[184:187], v[80:83]
    s_add_u32 m0, s52, 9216
    ds_read_b64_tr_b16 v[184:185], v4 offset:37888
    v_mfma_f32_16x16x32_bf16 v[84:87], v[32:35], a[188:191], v[84:87]
    s_add_u32 s93, s86, 811008
    ds_read_b64_tr_b16 v[186:187], v5 offset:37888
    v_mfma_f32_16x16x32_bf16 v[96:99], v[36:39], a[184:187], v[96:99]
    buffer_load_dwordx4 v28, s[72:75], s93 offen offset:0 lds
    v_mfma_f32_16x16x32_bf16 v[100:103], v[36:39], a[188:191], v[100:103]
    ds_read_b64_tr_b16 v[188:189], v14 offset:37888
    ds_read_b64_tr_b16 v[190:191], v15 offset:37888
    v_mfma_f32_16x16x32_bf16 v[88:91], v[40:43], a[184:187], v[88:91]
    buffer_load_dwordx4 v9, s[72:75], s93 offen offset:1024 lds
    v_mfma_f32_16x16x32_bf16 v[92:95], v[40:43], a[188:191], v[92:95]
    ds_read_b64_tr_b16 v[32:33], v2 offset:38912
    ds_read_b64_tr_b16 v[34:35], v3 offset:38912
    v_mfma_f32_16x16x32_bf16 v[104:107], v[44:47], a[184:187], v[104:107]
    ds_read_b64_tr_b16 v[36:37], v12 offset:38912
    v_mfma_f32_16x16x32_bf16 v[108:111], v[44:47], a[188:191], v[108:111]
    ds_read_b64_tr_b16 v[38:39], v13 offset:38912
    s_waitcnt vmcnt(12) lgkmcnt(12)
    v_mfma_f32_16x16x32_bf16 v[80:83], v[160:163], a[192:195], v[80:83]
    s_add_u32 s93, s89, 4790272
    ds_read_b64_tr_b16 v[40:41], v4 offset:38912
    v_mfma_f32_16x16x32_bf16 v[84:87], v[160:163], a[196:199], v[84:87]
    buffer_load_dwordx4 v28, s[72:75], s93 offen offset:2048 lds
    v_mfma_f32_16x16x32_bf16 v[96:99], v[164:167], a[192:195], v[96:99]
    ds_read_b64_tr_b16 v[42:43], v5 offset:38912
    ds_read_b64_tr_b16 v[44:45], v14 offset:38912
    v_mfma_f32_16x16x32_bf16 v[100:103], v[164:167], a[196:199], v[100:103]
    ds_read_b64_tr_b16 v[46:47], v15 offset:38912
    v_mfma_f32_16x16x32_bf16 v[88:91], v[168:171], a[192:195], v[88:91]
    s_add_u32 m0, s52, 12288
    ds_read_b64_tr_b16 v[160:161], v2 offset:24576
    v_mfma_f32_16x16x32_bf16 v[92:95], v[168:171], a[196:199], v[92:95]
    s_add_u32 s93, s86, 258048
    ds_read_b64_tr_b16 v[162:163], v3 offset:24576
    v_mfma_f32_16x16x32_bf16 v[104:107], v[172:175], a[192:195], v[104:107]
    ds_read_b64_tr_b16 v[164:165], v12 offset:24576
    v_mfma_f32_16x16x32_bf16 v[108:111], v[172:175], a[196:199], v[108:111]
    ds_read_b64_tr_b16 v[166:167], v13 offset:24576
    s_waitcnt vmcnt(11) lgkmcnt(12)
    v_mfma_f32_16x16x32_bf16 v[80:83], v[176:179], a[200:203], v[80:83]
    buffer_load_dwordx4 v28, s[72:75], s93 offen offset:0 lds
    v_mfma_f32_16x16x32_bf16 v[84:87], v[176:179], a[204:207], v[84:87]
    ds_read_b64_tr_b16 v[168:169], v4 offset:24576
    ds_read_b64_tr_b16 v[170:171], v5 offset:24576
    v_mfma_f32_16x16x32_bf16 v[96:99], v[180:183], a[200:203], v[96:99]
    ds_read_b64_tr_b16 v[172:173], v14 offset:24576
    v_mfma_f32_16x16x32_bf16 v[100:103], v[180:183], a[204:207], v[100:103]
    ds_read_b64_tr_b16 v[174:175], v15 offset:24576
    v_mfma_f32_16x16x32_bf16 v[88:91], v[184:187], a[200:203], v[88:91]
    buffer_load_dwordx4 v9, s[72:75], s93 offen offset:1024 lds
    v_mfma_f32_16x16x32_bf16 v[92:95], v[184:187], a[204:207], v[92:95]
    s_add_u32 s93, s89, 4753408
    ds_read_b64_tr_b16 v[176:177], v2 offset:25600
    v_mfma_f32_16x16x32_bf16 v[104:107], v[188:191], a[200:203], v[104:107]
    ds_read_b64_tr_b16 v[178:179], v3 offset:25600
    ds_read_b64_tr_b16 v[180:181], v12 offset:25600
    v_mfma_f32_16x16x32_bf16 v[108:111], v[188:191], a[204:207], v[108:111]
    ds_read_b64_tr_b16 v[182:183], v13 offset:25600
    s_waitcnt vmcnt(11) lgkmcnt(12)
    v_mfma_f32_16x16x32_bf16 v[80:83], v[32:35], a[208:211], v[80:83]
    buffer_load_dwordx4 v28, s[72:75], s93 offen offset:2048 lds
    v_mfma_f32_16x16x32_bf16 v[84:87], v[32:35], a[212:215], v[84:87]
    s_add_u32 m0, s52, 27648
    s_add_u32 s93, s86, 847872
    v_mfma_f32_16x16x32_bf16 v[96:99], v[36:39], a[208:211], v[96:99]
    ds_read_b64_tr_b16 v[184:185], v4 offset:25600
    ds_read_b64_tr_b16 v[186:187], v5 offset:25600
    v_mfma_f32_16x16x32_bf16 v[100:103], v[36:39], a[212:215], v[100:103]
    ds_read_b64_tr_b16 v[188:189], v14 offset:25600
    ds_read_b64_tr_b16 v[190:191], v15 offset:25600
    v_mfma_f32_16x16x32_bf16 v[88:91], v[40:43], a[208:211], v[88:91]
    buffer_load_dwordx4 v28, s[72:75], s93 offen offset:0 lds
    v_mfma_f32_16x16x32_bf16 v[92:95], v[40:43], a[212:215], v[92:95]
    ds_read_b64_tr_b16 v[32:33], v2 offset:26624
    ds_read_b64_tr_b16 v[34:35], v3 offset:26624
    v_mfma_f32_16x16x32_bf16 v[104:107], v[44:47], a[208:211], v[104:107]
    ds_read_b64_tr_b16 v[36:37], v12 offset:26624
    v_mfma_f32_16x16x32_bf16 v[108:111], v[44:47], a[212:215], v[108:111]
    ds_read_b64_tr_b16 v[38:39], v13 offset:26624
    s_waitcnt vmcnt(11) lgkmcnt(12)
    v_mfma_f32_16x16x32_bf16 v[80:83], v[160:163], a[216:219], v[80:83]
    buffer_load_dwordx4 v9, s[72:75], s93 offen offset:1024 lds
    v_mfma_f32_16x16x32_bf16 v[84:87], v[160:163], a[220:223], v[84:87]
    ds_read_b64_tr_b16 v[40:41], v4 offset:26624
    ds_read_b64_tr_b16 v[42:43], v5 offset:26624
    v_mfma_f32_16x16x32_bf16 v[96:99], v[164:167], a[216:219], v[96:99]
    ds_read_b64_tr_b16 v[44:45], v14 offset:26624
    v_mfma_f32_16x16x32_bf16 v[100:103], v[164:167], a[220:223], v[100:103]
    ds_read_b64_tr_b16 v[46:47], v15 offset:26624
    v_mfma_f32_16x16x32_bf16 v[88:91], v[168:171], a[216:219], v[88:91]
    s_add_u32 s93, s89, 4827136
    ds_read_b64_tr_b16 v[160:161], v12 offset:0
    v_mfma_f32_16x16x32_bf16 v[92:95], v[168:171], a[220:223], v[92:95]
    buffer_load_dwordx4 v28, s[72:75], s93 offen offset:2048 lds
    v_mfma_f32_16x16x32_bf16 v[104:107], v[172:175], a[216:219], v[104:107]
    ds_read_b64_tr_b16 v[162:163], v13 offset:0
    ds_read_b64_tr_b16 v[164:165], v2 offset:0
    v_mfma_f32_16x16x32_bf16 v[108:111], v[172:175], a[220:223], v[108:111]
    ds_read_b64_tr_b16 v[166:167], v3 offset:0
    s_waitcnt vmcnt(11) lgkmcnt(12)
    v_mfma_f32_16x16x32_bf16 v[80:83], v[176:179], a[224:227], v[80:83]
    s_add_u32 m0, s52, 15360
    ds_read_b64_tr_b16 v[168:169], v14 offset:0
    v_mfma_f32_16x16x32_bf16 v[84:87], v[176:179], a[228:231], v[84:87]
    s_add_u32 s93, s87, 36864
    ds_read_b64_tr_b16 v[170:171], v15 offset:0
    s_branch L_sskip9
L_stub9:
    s_setpc_b64 s[100:101]
L_sskip9:
    v_mfma_f32_16x16x32_bf16 v[96:99], v[180:183], a[224:227], v[96:99]
    buffer_load_dwordx4 v28, s[72:75], s93 offen offset:0 lds
    v_mfma_f32_16x16x32_bf16 v[100:103], v[180:183], a[228:231], v[100:103]
    ds_read_b64_tr_b16 v[172:173], v4 offset:0
    ds_read_b64_tr_b16 v[174:175], v5 offset:0
    v_mfma_f32_16x16x32_bf16 v[88:91], v[184:187], a[224:227], v[88:91]
    buffer_load_dwordx4 v7, s[72:75], s93 offen offset:1024 lds
    v_mfma_f32_16x16x32_bf16 v[92:95], v[184:187], a[228:231], v[92:95]
    ds_read_b64_tr_b16 v[176:177], v12 offset:1024
    ds_read_b64_tr_b16 v[178:179], v13 offset:1024
    v_mfma_f32_16x16x32_bf16 v[104:107], v[188:191], a[224:227], v[104:107]
    ds_read_b64_tr_b16 v[180:181], v2 offset:1024
    v_mfma_f32_16x16x32_bf16 v[108:111], v[188:191], a[228:231], v[108:111]
    ds_read_b64_tr_b16 v[182:183], v3 offset:1024
    s_waitcnt vmcnt(11) lgkmcnt(12)
    v_mfma_f32_16x16x32_bf16 v[80:83], v[32:35], a[232:235], v[80:83]
    buffer_load_dwordx4 v8, s[72:75], s93 offen offset:2048 lds
    v_mfma_f32_16x16x32_bf16 v[84:87], v[32:35], a[236:239], v[84:87]
    ds_read_b64_tr_b16 v[184:185], v14 offset:1024
    ds_read_b64_tr_b16 v[186:187], v15 offset:1024
    v_mfma_f32_16x16x32_bf16 v[96:99], v[36:39], a[232:235], v[96:99]
    ds_read_b64_tr_b16 v[188:189], v4 offset:1024
    v_mfma_f32_16x16x32_bf16 v[100:103], v[36:39], a[236:239], v[100:103]
    ds_read_b64_tr_b16 v[190:191], v5 offset:1024
    v_mfma_f32_16x16x32_bf16 v[88:91], v[40:43], a[232:235], v[88:91]
    s_add_u32 m0, s52, 18432
    ds_read_b64_tr_b16 v[32:33], v12 offset:2048
    v_mfma_f32_16x16x32_bf16 v[92:95], v[40:43], a[236:239], v[92:95]
    s_add_u32 s93, s87, 331776
    ds_read_b64_tr_b16 v[34:35], v13 offset:2048
    v_mfma_f32_16x16x32_bf16 v[104:107], v[44:47], a[232:235], v[104:107]
    ds_read_b64_tr_b16 v[36:37], v2 offset:2048
    v_mfma_f32_16x16x32_bf16 v[108:111], v[44:47], a[236:239], v[108:111]
    ds_read_b64_tr_b16 v[38:39], v3 offset:2048
    s_waitcnt lgkmcnt(12)
    v_mfma_f32_16x16x32_bf16 v[64:67], v[160:163], a[96:99], v[64:67]
    buffer_load_dwordx4 v28, s[72:75], s93 offen offset:0 lds
    v_mfma_f32_16x16x32_bf16 v[68:71], v[160:163], a[100:103], v[68:71]
    ds_read_b64_tr_b16 v[40:41], v14 offset:2048
    ds_read_b64_tr_b16 v[42:43], v15 offset:2048
    v_mfma_f32_16x16x32_bf16 v[128:131], v[164:167], a[96:99], v[128:131]
    ds_read_b64_tr_b16 v[44:45], v4 offset:2048
    v_mfma_f32_16x16x32_bf16 v[132:135], v[164:167], a[100:103], v[132:135]
    ds_read_b64_tr_b16 v[46:47], v5 offset:2048
    v_mfma_f32_16x16x32_bf16 v[72:75], v[168:171], a[96:99], v[72:75]
    buffer_load_dwordx4 v7, s[72:75], s93 offen offset:1024 lds
    s_waitcnt vmcnt(8)
    s_barrier
    v_mfma_f32_16x16x32_bf16 v[76:79], v[168:171], a[100:103], v[76:79]
    ds_read_b64_tr_b16 v[160:161], v12 offset:3072
    v_cvt_pk_bf16_f32 v80, v80, v81
    v_mfma_f32_16x16x32_bf16 v[136:139], v[172:175], a[96:99], v[136:139]
    ds_read_b64_tr_b16 v[162:163], v13 offset:3072
    ds_read_b64_tr_b16 v[164:165], v2 offset:3072
    v_mfma_f32_16x16x32_bf16 v[140:143], v[172:175], a[100:103], v[140:143]
    ds_read_b64_tr_b16 v[166:167], v3 offset:3072
    s_waitcnt lgkmcnt(12)
    v_mfma_f32_16x16x32_bf16 v[64:67], v[176:179], a[104:107], v[64:67]
    buffer_load_dwordx4 v8, s[72:75], s93 offen offset:2048 lds
    v_mfma_f32_16x16x32_bf16 v[68:71], v[176:179], a[108:111], v[68:71]
    s_add_u32 m0, s52, 21504
    s_add_u32 s93, s87, 589824
    v_mfma_f32_16x16x32_bf16 v[128:131], v[180:183], a[104:107], v[128:131]
    ds_read_b64_tr_b16 v[168:169], v14 offset:3072
    ds_read_b64_tr_b16 v[170:171], v15 offset:3072
    v_mfma_f32_16x16x32_bf16 v[132:135], v[180:183], a[108:111], v[132:135]
    ds_read_b64_tr_b16 v[172:173], v4 offset:3072
    ds_read_b64_tr_b16 v[174:175], v5 offset:3072
    v_mfma_f32_16x16x32_bf16 v[72:75], v[184:187], a[104:107], v[72:75]
    buffer_load_dwordx4 v28, s[72:75], s93 offen offset:0 lds
    v_mfma_f32_16x16x32_bf16 v[76:79], v[184:187], a[108:111], v[76:79]
    ds_read_b64_tr_b16 v[176:177], v12 offset:4096
    v_cvt_pk_bf16_f32 v81, v82, v83
    v_mfma_f32_16x16x32_bf16 v[136:139], v[188:191], a[104:107], v[136:139]
    ds_read_b64_tr_b16 v[178:179], v13 offset:4096
    ds_read_b64_tr_b16 v[180:181], v2 offset:4096
    v_mfma_f32_16x16x32_bf16 v[140:143], v[188:191], a[108:111], v[140:143]
    ds_read_b64_tr_b16 v[182:183], v3 offset:4096
    s_waitcnt lgkmcnt(12)
    v_mfma_f32_16x16x32_bf16 v[64:67], v[32:35], a[112:115], v[64:67]
    buffer_load_dwordx4 v7, s[72:75], s93 offen offset:1024 lds
    v_mfma_f32_16x16x32_bf16 v[68:71], v[32:35], a[116:119], v[68:71]
    v_cvt_pk_bf16_f32 v82, v84, v85
    v_cvt_pk_bf16_f32 v83, v86, v87
    v_mfma_f32_16x16x32_bf16 v[128:131], v[36:39], a[112:115], v[128:131]
    ds_read_b64_tr_b16 v[184:185], v14 offset:4096
    ds_read_b64_tr_b16 v[186:187], v15 offset:4096
    v_mfma_f32_16x16x32_bf16 v[132:135], v[36:39], a[116:119], v[132:135]
    ds_read_b64_tr_b16 v[188:189], v4 offset:4096
    ds_read_b64_tr_b16 v[190:191], v5 offset:4096
    v_mfma_f32_16x16x32_bf16 v[72:75], v[40:43], a[112:115], v[72:75]
    buffer_load_dwordx4 v8, s[72:75], s93 offen offset:2048 lds
    v_mfma_f32_16x16x32_bf16 v[76:79], v[40:43], a[116:119], v[76:79]
    s_add_u32 m0, s52, 30720
    ds_read_b64_tr_b16 v[32:33], v12 offset:5120
    v_mfma_f32_16x16x32_bf16 v[136:139], v[44:47], a[112:115], v[136:139]
    ds_read_b64_tr_b16 v[34:35], v13 offset:5120
    ds_read_b64_tr_b16 v[36:37], v2 offset:5120
    v_mfma_f32_16x16x32_bf16 v[140:143], v[44:47], a[116:119], v[140:143]
    ds_read_b64_tr_b16 v[38:39], v3 offset:5120
    s_waitcnt lgkmcnt(12)
    v_mfma_f32_16x16x32_bf16 v[64:67], v[160:163], a[120:123], v[64:67]
    s_add_u32 s93, s87, 884736
    ds_read_b64_tr_b16 v[40:41], v14 offset:5120
    v_mfma_f32_16x16x32_bf16 v[68:71], v[160:163], a[124:127], v[68:71]
    buffer_load_dwordx4 v28, s[72:75], s93 offen offset:0 lds
    v_mfma_f32_16x16x32_bf16 v[128:131], v[164:167], a[120:123], v[128:131]
    buffer_store_dwordx4 v[80:83], v22, s[68:71], s79 offen offset:2048 sc1
    ds_read_b64_tr_b16 v[42:43], v15 offset:5120
    v_mfma_f32_16x16x32_bf16 v[132:135], v[164:167], a[124:127], v[132:135]
    ds_read_b64_tr_b16 v[44:45], v4 offset:5120
    ds_read_b64_tr_b16 v[46:47], v5 offset:5120
    v_mfma_f32_16x16x32_bf16 v[72:75], v[168:171], a[120:123], v[72:75]
    buffer_load_dwordx4 v7, s[72:75], s93 offen offset:1024 lds
    v_mfma_f32_16x16x32_bf16 v[76:79], v[168:171], a[124:127], v[76:79]
    ds_read_b64_tr_b16 v[160:161], v12 offset:6144
    v_cvt_pk_bf16_f32 v88, v88, v89
    v_mfma_f32_16x16x32_bf16 v[136:139], v[172:175], a[120:123], v[136:139]
    ds_read_b64_tr_b16 v[162:163], v13 offset:6144
    ds_read_b64_tr_b16 v[164:165], v2 offset:6144
    v_mfma_f32_16x16x32_bf16 v[140:143], v[172:175], a[124:127], v[140:143]
    ds_read_b64_tr_b16 v[166:167], v3 offset:6144
    s_waitcnt lgkmcnt(12)
    v_mfma_f32_16x16x32_bf16 v[64:67], v[176:179], a[128:131], v[64:67]
    ds_read_b64_tr_b16 v[168:169], v14 offset:6144
    v_cvt_pk_bf16_f32 v89, v90, v91
    v_mfma_f32_16x16x32_bf16 v[68:71], v[176:179], a[132:135], v[68:71]
    ds_read_b64_tr_b16 v[170:171], v15 offset:6144
    v_cvt_pk_bf16_f32 v90, v92, v93
    v_mfma_f32_16x16x32_bf16 v[128:131], v[180:183], a[128:131], v[128:131]
    ds_read_b64_tr_b16 v[172:173], v4 offset:6144
    v_cvt_pk_bf16_f32 v91, v94, v95
    v_mfma_f32_16x16x32_bf16 v[132:135], v[180:183], a[132:135], v[132:135]
    buffer_store_dwordx4 v[88:91], v22, s[68:71], s79 offen offset:1024 sc1
    ds_read_b64_tr_b16 v[174:175], v5 offset:6144
    v_mfma_f32_16x16x32_bf16 v[72:75], v[184:187], a[128:131], v[72:75]
    ds_read_b64_tr_b16 v[176:177], v12 offset:7168
    v_cvt_pk_bf16_f32 v96, v96, v97
    v_mfma_f32_16x16x32_bf16 v[76:79], v[184:187], a[132:135], v[76:79]
    ds_read_b64_tr_b16 v[178:179], v13 offset:7168
    v_cvt_pk_bf16_f32 v97, v98, v99
    v_mfma_f32_16x16x32_bf16 v[136:139], v[188:191], a[128:131], v[136:139]
    ds_read_b64_tr_b16 v[180:181], v2 offset:7168
    v_cvt_pk_bf16_f32 v98, v100, v101
    v_mfma_f32_16x16x32_bf16 v[140:143], v[188:191], a[132:135], v[140:143]
    ds_read_b64_tr_b16 v[182:183], v3 offset:7168
    s_waitcnt lgkmcnt(12)
    v_mfma_f32_16x16x32_bf16 v[64:67], v[32:35], a[136:139], v[64:67]
    ds_read_b64_tr_b16 v[184:185], v14 offset:7168
    v_cvt_pk_bf16_f32 v99, v102, v103
    v_mfma_f32_16x16x32_bf16 v[68:71], v[32:35], a[140:143], v[68:71]
    buffer_store_dwordx4 v[96:99], v22, s[68:71], s80 offen offset:2048 sc1
    ds_read_b64_tr_b16 v[186:187], v15 offset:7168
    v_mfma_f32_16x16x32_bf16 v[128:131], v[36:39], a[136:139], v[128:131]
    ds_read_b64_tr_b16 v[188:189], v4 offset:7168
    v_cvt_pk_bf16_f32 v104, v104, v105
    v_mfma_f32_16x16x32_bf16 v[132:135], v[36:39], a[140:143], v[132:135]
    ds_read_b64_tr_b16 v[190:191], v5 offset:7168
    v_cvt_pk_bf16_f32 v105, v106, v107
    v_mfma_f32_16x16x32_bf16 v[72:75], v[40:43], a[136:139], v[72:75]
    ds_read_b64_tr_b16 v[32:33], v12 offset:8192
    v_cvt_pk_bf16_f32 v106, v108, v109
    v_mfma_f32_16x16x32_bf16 v[76:79], v[40:43], a[140:143], v[76:79]
    ds_read_b64_tr_b16 v[34:35], v13 offset:8192
    v_cvt_pk_bf16_f32 v107, v110, v111
    v_mfma_f32_16x16x32_bf16 v[136:139], v[44:47], a[136:139], v[136:139]
    buffer_store_dwordx4 v[104:107], v22, s[68:71], s80 offen offset:1024 sc1
    ds_read_b64_tr_b16 v[36:37], v2 offset:8192
    v_mfma_f32_16x16x32_bf16 v[140:143], v[44:47], a[140:143], v[140:143]
    ds_read_b64_tr_b16 v[38:39], v3 offset:8192
    s_waitcnt lgkmcnt(12)
    v_mfma_f32_16x16x32_bf16 v[64:67], v[160:163], a[144:147], v[64:67]
    ds_read_b64_tr_b16 v[40:41], v14 offset:8192
    v_mfma_f32_16x16x32_bf16 v[68:71], v[160:163], a[148:151], v[68:71]
    ds_read_b64_tr_b16 v[42:43], v15 offset:8192
    v_mfma_f32_16x16x32_bf16 v[128:131], v[164:167], a[144:147], v[128:131]
    ds_read_b64_tr_b16 v[44:45], v4 offset:8192
    v_mfma_f32_16x16x32_bf16 v[132:135], v[164:167], a[148:151], v[132:135]
    ds_read_b64_tr_b16 v[46:47], v5 offset:8192
    v_mfma_f32_16x16x32_bf16 v[72:75], v[168:171], a[144:147], v[72:75]
    ds_read_b64_tr_b16 v[160:161], v12 offset:9216
    v_mfma_f32_16x16x32_bf16 v[76:79], v[168:171], a[148:151], v[76:79]
    ds_read_b64_tr_b16 v[162:163], v13 offset:9216
    v_mfma_f32_16x16x32_bf16 v[136:139], v[172:175], a[144:147], v[136:139]
    ds_read_b64_tr_b16 v[164:165], v2 offset:9216
    v_mfma_f32_16x16x32_bf16 v[140:143], v[172:175], a[148:151], v[140:143]
    ds_read_b64_tr_b16 v[166:167], v3 offset:9216
    s_waitcnt lgkmcnt(12)
    v_mfma_f32_16x16x32_bf16 v[64:67], v[176:179], a[152:155], v[64:67]
    ds_read_b64_tr_b16 v[168:169], v14 offset:9216
    v_mfma_f32_16x16x32_bf16 v[68:71], v[176:179], a[156:159], v[68:71]
    ds_read_b64_tr_b16 v[170:171], v15 offset:9216
    v_mfma_f32_16x16x32_bf16 v[128:131], v[180:183], a[152:155], v[128:131]
    ds_read_b64_tr_b16 v[172:173], v4 offset:9216
    v_mfma_f32_16x16x32_bf16 v[132:135], v[180:183], a[156:159], v[132:135]
    ds_read_b64_tr_b16 v[174:175], v5 offset:9216
    v_mfma_f32_16x16x32_bf16 v[72:75], v[184:187], a[152:155], v[72:75]
    buffer_load_dwordx4 v8, s[72:75], s93 offen offset:2048 lds
    v_mfma_f32_16x16x32_bf16 v[76:79], v[184:187], a[156:159], v[76:79]
    ds_read_b64_tr_b16 v[176:177], v12 offset:10240
    ds_read_b64_tr_b16 v[178:179], v13 offset:10240
    v_mfma_f32_16x16x32_bf16 v[136:139], v[188:191], a[152:155], v[136:139]
    ds_read_b64_tr_b16 v[180:181], v2 offset:10240
    v_mfma_f32_16x16x32_bf16 v[140:143], v[188:191], a[156:159], v[140:143]
    ds_read_b64_tr_b16 v[182:183], v3 offset:10240
    s_waitcnt lgkmcnt(12)
    v_mfma_f32_16x16x32_bf16 v[64:67], v[32:35], a[160:163], v[64:67]
    s_add_u32 m0, s52, 33792
    ds_read_b64_tr_b16 v[184:185], v14 offset:10240
    v_mfma_f32_16x16x32_bf16 v[68:71], v[32:35], a[164:167], v[68:71]
    s_add_u32 s93, s87, 626688
    ds_read_b64_tr_b16 v[186:187], v15 offset:10240
    v_mfma_f32_16x16x32_bf16 v[128:131], v[36:39], a[160:163], v[128:131]
    buffer_load_dwordx4 v28, s[72:75], s93 offen offset:0 lds
    v_mfma_f32_16x16x32_bf16 v[132:135], v[36:39], a[164:167], v[132:135]
    ds_read_b64_tr_b16 v[188:189], v4 offset:10240
    ds_read_b64_tr_b16 v[190:191], v5 offset:10240
    v_mfma_f32_16x16x32_bf16 v[72:75], v[40:43], a[160:163], v[72:75]
    buffer_load_dwordx4 v7, s[72:75], s93 offen offset:1024 lds
    v_mfma_f32_16x16x32_bf16 v[76:79], v[40:43], a[164:167], v[76:79]
    ds_read_b64_tr_b16 v[32:33], v12 offset:11264
    ds_read_b64_tr_b16 v[34:35], v13 offset:11264
    v_mfma_f32_16x16x32_bf16 v[136:139], v[44:47], a[160:163], v[136:139]
    ds_read_b64_tr_b16 v[36:37], v2 offset:11264
    v_mfma_f32_16x16x32_bf16 v[140:143], v[44:47], a[164:167], v[140:143]
    ds_read_b64_tr_b16 v[38:39], v3 offset:11264
    s_waitcnt lgkmcnt(12)
    v_mfma_f32_16x16x32_bf16 v[64:67], v[160:163], a[168:171], v[64:67]
    buffer_load_dwordx4 v8, s[72:75], s93 offen offset:2048 lds
    v_mfma_f32_16x16x32_bf16 v[68:71], v[160:163], a[172:175], v[68:71]
    ds_read_b64_tr_b16 v[40:41], v14 offset:11264
    ds_read_b64_tr_b16 v[42:43], v15 offset:11264
    v_mfma_f32_16x16x32_bf16 v[128:131], v[164:167], a[168:171], v[128:131]
    ds_read_b64_tr_b16 v[44:45], v4 offset:11264
    v_mfma_f32_16x16x32_bf16 v[132:135], v[164:167], a[172:175], v[132:135]
    ds_read_b64_tr_b16 v[46:47], v5 offset:11264
    v_mfma_f32_16x16x32_bf16 v[72:75], v[168:171], a[168:171], v[72:75]
    s_waitcnt vmcnt(10)
    s_barrier
    v_mfma_f32_16x16x32_bf16 v[76:79], v[168:171], a[172:175], v[76:79]
    s_add_u32 m0, s52, 36864
    ds_read_b64_tr_b16 v[160:161], v12 offset:12288
    v_mfma_f32_16x16x32_bf16 v[136:139], v[172:175], a[168:171], v[136:139]
    ds_read_b64_tr_b16 v[162:163], v13 offset:12288
    ds_read_b64_tr_b16 v[164:165], v2 offset:12288
    v_mfma_f32_16x16x32_bf16 v[140:143], v[172:175], a[172:175], v[140:143]
    ds_read_b64_tr_b16 v[166:167], v3 offset:12288
    s_waitcnt lgkmcnt(12)
    v_mfma_f32_16x16x32_bf16 v[64:67], v[176:179], a[176:179], v[64:67]
    s_add_u32 s93, s87, 921600
    ds_read_b64_tr_b16 v[168:169], v14 offset:12288
    v_mfma_f32_16x16x32_bf16 v[68:71], v[176:179], a[180:183], v[68:71]
    buffer_load_dwordx4 v28, s[72:75], s93 offen offset:0 lds
    v_mfma_f32_16x16x32_bf16 v[128:131], v[180:183], a[176:179], v[128:131]
    ds_read_b64_tr_b16 v[170:171], v15 offset:12288
    ds_read_b64_tr_b16 v[172:173], v4 offset:12288
    v_mfma_f32_16x16x32_bf16 v[132:135], v[180:183], a[180:183], v[132:135]
    ds_read_b64_tr_b16 v[174:175], v5 offset:12288
    v_mfma_f32_16x16x32_bf16 v[72:75], v[184:187], a[176:179], v[72:75]
    buffer_load_dwordx4 v7, s[72:75], s93 offen offset:1024 lds
    v_mfma_f32_16x16x32_bf16 v[76:79], v[184:187], a[180:183], v[76:79]
    ds_read_b64_tr_b16 v[176:177], v12 offset:13312
    ds_read_b64_tr_b16 v[178:179], v13 offset:13312
    v_mfma_f32_16x16x32_bf16 v[136:139], v[188:191], a[176:179], v[136:139]
    ds_read_b64_tr_b16 v[180:181], v2 offset:13312
    v_mfma_f32_16x16x32_bf16 v[140:143], v[188:191], a[180:183], v[140:143]
    ds_read_b64_tr_b16 v[182:183], v3 offset:13312
    s_waitcnt lgkmcnt(12)
    v_mfma_f32_16x16x32_bf16 v[64:67], v[32:35], a[184:187], v[64:67]
    buffer_load_dwordx4 v8, s[72:75], s93 offen offset:2048 lds
    v_mfma_f32_16x16x32_bf16 v[68:71], v[32:35], a[188:191], v[68:71]
    ds_read_b64_tr_b16 v[184:185], v14 offset:13312
    ds_read_b64_tr_b16 v[186:187], v15 offset:13312
    v_mfma_f32_16x16x32_bf16 v[128:131], v[36:39], a[184:187], v[128:131]
    ds_read_b64_tr_b16 v[188:189], v4 offset:13312
    v_mfma_f32_16x16x32_bf16 v[132:135], v[36:39], a[188:191], v[132:135]
    ds_read_b64_tr_b16 v[190:191], v5 offset:13312
    v_mfma_f32_16x16x32_bf16 v[72:75], v[40:43], a[184:187], v[72:75]
    s_add_u32 m0, s52, 24576
    ds_read_b64_tr_b16 v[32:33], v12 offset:14336
    v_mfma_f32_16x16x32_bf16 v[76:79], v[40:43], a[188:191], v[76:79]
    s_add_u32 s93, s87, 221184
    ds_read_b64_tr_b16 v[34:35], v13 offset:14336
    v_mfma_f32_16x16x32_bf16 v[136:139], v[44:47], a[184:187], v[136:139]
    ds_read_b64_tr_b16 v[36:37], v2 offset:14336
    v_mfma_f32_16x16x32_bf16 v[140:143], v[44:47], a[188:191], v[140:143]
    ds_read_b64_tr_b16 v[38:39], v3 offset:14336
    s_waitcnt lgkmcnt(12)
    v_mfma_f32_16x16x32_bf16 v[64:67], v[160:163], a[192:195], v[64:67]
    buffer_load_dwordx4 v28, s[72:75], s93 offen offset:0 lds
    v_mfma_f32_16x16x32_bf16 v[68:71], v[160:163], a[196:199], v[68:71]
    ds_read_b64_tr_b16 v[40:41], v14 offset:14336
    ds_read_b64_tr_b16 v[42:43], v15 offset:14336
    v_mfma_f32_16x16x32_bf16 v[128:131], v[164:167], a[192:195], v[128:131]
    ds_read_b64_tr_b16 v[44:45], v4 offset:14336
    v_mfma_f32_16x16x32_bf16 v[132:135], v[164:167], a[196:199], v[132:135]
    ds_read_b64_tr_b16 v[46:47], v5 offset:14336
    v_mfma_f32_16x16x32_bf16 v[72:75], v[168:171], a[192:195], v[72:75]
    buffer_load_dwordx4 v9, s[72:75], s93 offen offset:1024 lds
    v_mfma_f32_16x16x32_bf16 v[76:79], v[168:171], a[196:199], v[76:79]
    s_add_u32 s93, s90, 4716544
    ds_read_b64_tr_b16 v[160:161], v12 offset:27648
    v_mfma_f32_16x16x32_bf16 v[136:139], v[172:175], a[192:195], v[136:139]
    ds_read_b64_tr_b16 v[162:163], v13 offset:27648
    ds_read_b64_tr_b16 v[164:165], v2 offset:27648
    v_mfma_f32_16x16x32_bf16 v[140:143], v[172:175], a[196:199], v[140:143]
    ds_read_b64_tr_b16 v[166:167], v3 offset:27648
    s_waitcnt lgkmcnt(12)
    v_mfma_f32_16x16x32_bf16 v[64:67], v[176:179], a[200:203], v[64:67]
    buffer_load_dwordx4 v28, s[72:75], s93 offen offset:2048 lds
    v_mfma_f32_16x16x32_bf16 v[68:71], v[176:179], a[204:207], v[68:71]
    s_add_u32 m0, s52, 0
    s_add_u32 s93, s87, 811008
    v_mfma_f32_16x16x32_bf16 v[128:131], v[180:183], a[200:203], v[128:131]
    ds_read_b64_tr_b16 v[168:169], v14 offset:27648
    ds_read_b64_tr_b16 v[170:171], v15 offset:27648
    v_mfma_f32_16x16x32_bf16 v[132:135], v[180:183], a[204:207], v[132:135]
    ds_read_b64_tr_b16 v[172:173], v4 offset:27648
    ds_read_b64_tr_b16 v[174:175], v5 offset:27648
    v_mfma_f32_16x16x32_bf16 v[72:75], v[184:187], a[200:203], v[72:75]
    buffer_load_dwordx4 v28, s[72:75], s93 offen offset:0 lds
    v_mfma_f32_16x16x32_bf16 v[76:79], v[184:187], a[204:207], v[76:79]
    ds_read_b64_tr_b16 v[176:177], v12 offset:28672
    ds_read_b64_tr_b16 v[178:179], v13 offset:28672
    v_mfma_f32_16x16x32_bf16 v[136:139], v[188:191], a[200:203], v[136:139]
    ds_read_b64_tr_b16 v[180:181], v2 offset:28672
    v_mfma_f32_16x16x32_bf16 v[140:143], v[188:191], a[204:207], v[140:143]
    ds_read_b64_tr_b16 v[182:183], v3 offset:28672
    s_waitcnt lgkmcnt(12)
    v_mfma_f32_16x16x32_bf16 v[64:67], v[32:35], a[208:211], v[64:67]
    buffer_load_dwordx4 v9, s[72:75], s93 offen offset:1024 lds
    v_mfma_f32_16x16x32_bf16 v[68:71], v[32:35], a[212:215], v[68:71]
    s_add_u32 s93, s90, 4790272
    ds_read_b64_tr_b16 v[184:185], v14 offset:28672
    v_mfma_f32_16x16x32_bf16 v[128:131], v[36:39], a[208:211], v[128:131]
    ds_read_b64_tr_b16 v[186:187], v15 offset:28672
    ds_read_b64_tr_b16 v[188:189], v4 offset:28672
    v_mfma_f32_16x16x32_bf16 v[132:135], v[36:39], a[212:215], v[132:135]
    ds_read_b64_tr_b16 v[190:191], v5 offset:28672
    v_mfma_f32_16x16x32_bf16 v[72:75], v[40:43], a[208:211], v[72:75]
    buffer_load_dwordx4 v28, s[72:75], s93 offen offset:2048 lds
    v_mfma_f32_16x16x32_bf16 v[76:79], v[40:43], a[212:215], v[76:79]
    s_add_u32 m0, s52, 3072
    ds_read_b64_tr_b16 v[32:33], v12 offset:29696
    v_mfma_f32_16x16x32_bf16 v[136:139], v[44:47], a[208:211], v[136:139]
    ds_read_b64_tr_b16 v[34:35], v13 offset:29696
    ds_read_b64_tr_b16 v[36:37], v2 offset:29696
    v_mfma_f32_16x16x32_bf16 v[140:143], v[44:47], a[212:215], v[140:143]
    ds_read_b64_tr_b16 v[38:39], v3 offset:29696
    s_waitcnt lgkmcnt(12)
    v_mfma_f32_16x16x32_bf16 v[64:67], v[160:163], a[216:219], v[64:67]
    s_add_u32 s93, s87, 258048
    ds_read_b64_tr_b16 v[40:41], v14 offset:29696
    v_mfma_f32_16x16x32_bf16 v[68:71], v[160:163], a[220:223], v[68:71]
    buffer_load_dwordx4 v28, s[72:75], s93 offen offset:0 lds
    v_mfma_f32_16x16x32_bf16 v[128:131], v[164:167], a[216:219], v[128:131]
    ds_read_b64_tr_b16 v[42:43], v15 offset:29696
    ds_read_b64_tr_b16 v[44:45], v4 offset:29696
    v_mfma_f32_16x16x32_bf16 v[132:135], v[164:167], a[220:223], v[132:135]
    ds_read_b64_tr_b16 v[46:47], v5 offset:29696
    v_mfma_f32_16x16x32_bf16 v[72:75], v[168:171], a[216:219], v[72:75]
    buffer_load_dwordx4 v9, s[72:75], s93 offen offset:1024 lds
    v_mfma_f32_16x16x32_bf16 v[76:79], v[168:171], a[220:223], v[76:79]
    s_add_u32 s93, s90, 4753408
    ds_read_b64_tr_b16 v[160:161], v12 offset:15360
    v_mfma_f32_16x16x32_bf16 v[136:139], v[172:175], a[216:219], v[136:139]
    ds_read_b64_tr_b16 v[162:163], v13 offset:15360
    ds_read_b64_tr_b16 v[164:165], v14 offset:15360
    v_mfma_f32_16x16x32_bf16 v[140:143], v[172:175], a[220:223], v[140:143]
    ds_read_b64_tr_b16 v[166:167], v15 offset:15360
    s_waitcnt lgkmcnt(12)
    v_mfma_f32_16x16x32_bf16 v[64:67], v[176:179], a[224:227], v[64:67]
    buffer_load_dwordx4 v28, s[72:75], s93 offen offset:2048 lds
    v_mfma_f32_16x16x32_bf16 v[68:71], v[176:179], a[228:231], v[68:71]
    s_add_u32 m0, s52, 6144
    s_add_u32 s93, s87, 847872
    v_mfma_f32_16x16x32_bf16 v[128:131], v[180:183], a[224:227], v[128:131]
    ds_read_b64_tr_b16 v[168:169], v12 offset:16384
    ds_read_b64_tr_b16 v[170:171], v13 offset:16384
    v_mfma_f32_16x16x32_bf16 v[132:135], v[180:183], a[228:231], v[132:135]
    ds_read_b64_tr_b16 v[172:173], v14 offset:16384
    ds_read_b64_tr_b16 v[174:175], v15 offset:16384
    v_mfma_f32_16x16x32_bf16 v[72:75], v[184:187], a[224:227], v[72:75]
    buffer_load_dwordx4 v28, s[72:75], s93 offen offset:0 lds
    v_mfma_f32_16x16x32_bf16 v[76:79], v[184:187], a[228:231], v[76:79]
    ds_read_b64_tr_b16 v[176:177], v12 offset:17408
    ds_read_b64_tr_b16 v[178:179], v13 offset:17408
    v_mfma_f32_16x16x32_bf16 v[136:139], v[188:191], a[224:227], v[136:139]
    ds_read_b64_tr_b16 v[180:181], v14 offset:17408
    v_mfma_f32_16x16x32_bf16 v[140:143], v[188:191], a[228:231], v[140:143]
    ds_read_b64_tr_b16 v[182:183], v15 offset:17408
    s_waitcnt lgkmcnt(12)
    v_mfma_f32_16x16x32_bf16 v[64:67], v[32:35], a[232:235], v[64:67]
    buffer_load_dwordx4 v9, s[72:75], s93 offen offset:1024 lds
    v_mfma_f32_16x16x32_bf16 v[68:71], v[32:35], a[236:239], v[68:71]
    s_add_u32 s93, s90, 4827136
    ds_read_b64_tr_b16 v[184:185], v12 offset:18432
    v_mfma_f32_16x16x32_bf16 v[128:131], v[36:39], a[232:235], v[128:131]
    ds_read_b64_tr_b16 v[186:187], v13 offset:18432
    ds_read_b64_tr_b16 v[188:189], v14 offset:18432
    v_mfma_f32_16x16x32_bf16 v[132:135], v[36:39], a[236:239], v[132:135]
    ds_read_b64_tr_b16 v[190:191], v15 offset:18432
    v_mfma_f32_16x16x32_bf16 v[72:75], v[40:43], a[232:235], v[72:75]
    buffer_load_dwordx4 v28, s[72:75], s93 offen offset:2048 lds
    v_mfma_f32_16x16x32_bf16 v[76:79], v[40:43], a[236:239], v[76:79]
    ds_read_b64_tr_b16 v[32:33], v12 offset:19456
    ds_read_b64_tr_b16 v[34:35], v13 offset:19456
    v_mfma_f32_16x16x32_bf16 v[136:139], v[44:47], a[232:235], v[136:139]
    ds_read_b64_tr_b16 v[36:37], v14 offset:19456
    v_mfma_f32_16x16x32_bf16 v[140:143], v[44:47], a[236:239], v[140:143]
    ds_read_b64_tr_b16 v[38:39], v15 offset:19456
    s_waitcnt lgkmcnt(12)
    v_mfma_f32_16x16x32_bf16 v[112:115], v[160:163], a[0:3], 0
    ds_read_b64_tr_b16 v[40:41], v12 offset:20480
    v_mfma_f32_16x16x32_bf16 v[116:119], v[160:163], a[4:7], 0
    ds_read_b64_tr_b16 v[42:43], v13 offset:20480
    v_mfma_f32_16x16x32_bf16 v[120:123], v[164:167], a[0:3], 0
    ds_read_b64_tr_b16 v[44:45], v14 offset:20480
    v_mfma_f32_16x16x32_bf16 v[124:127], v[164:167], a[4:7], 0
    ds_read_b64_tr_b16 v[46:47], v15 offset:20480
    v_mfma_f32_16x16x32_bf16 v[112:115], v[168:171], a[8:11], v[112:115]
    global_load_dword v6, v27, s[48:49] sc1
    ds_read_b64_tr_b16 v[160:161], v12 offset:21504
    v_mfma_f32_16x16x32_bf16 v[116:119], v[168:171], a[12:15], v[116:119]
    ds_read_b64_tr_b16 v[162:163], v13 offset:21504
    v_cvt_pk_bf16_f32 v64, v64, v65
    v_mfma_f32_16x16x32_bf16 v[120:123], v[172:175], a[8:11], v[120:123]
    ds_read_b64_tr_b16 v[164:165], v14 offset:21504
    v_cvt_pk_bf16_f32 v65, v66, v67
    v_mfma_f32_16x16x32_bf16 v[124:127], v[172:175], a[12:15], v[124:127]
    ds_read_b64_tr_b16 v[166:167], v15 offset:21504
    s_waitcnt lgkmcnt(12)
    v_mfma_f32_16x16x32_bf16 v[112:115], v[176:179], a[16:19], v[112:115]
    ds_read_b64_tr_b16 v[168:169], v12 offset:22528
    v_cvt_pk_bf16_f32 v66, v68, v69
    v_mfma_f32_16x16x32_bf16 v[116:119], v[176:179], a[20:23], v[116:119]
    ds_read_b64_tr_b16 v[170:171], v13 offset:22528
    v_cvt_pk_bf16_f32 v67, v70, v71
    v_mfma_f32_16x16x32_bf16 v[120:123], v[180:183], a[16:19], v[120:123]
    buffer_store_dwordx4 v[64:67], v22, s[68:71], s78 offen offset:0 sc1
    ds_read_b64_tr_b16 v[172:173], v14 offset:22528
    v_mfma_f32_16x16x32_bf16 v[124:127], v[180:183], a[20:23], v[124:127]
    ds_read_b64_tr_b16 v[174:175], v15 offset:22528
    v_cvt_pk_bf16_f32 v72, v72, v73
    v_mfma_f32_16x16x32_bf16 v[112:115], v[184:187], a[24:27], v[112:115]
    ds_read_b64_tr_b16 v[176:177], v12 offset:23552
    v_cvt_pk_bf16_f32 v73, v74, v75
    v_mfma_f32_16x16x32_bf16 v[116:119], v[184:187], a[28:31], v[116:119]
    ds_read_b64_tr_b16 v[178:179], v13 offset:23552
    v_cvt_pk_bf16_f32 v74, v76, v77
    v_mfma_f32_16x16x32_bf16 v[120:123], v[188:191], a[24:27], v[120:123]
    ds_read_b64_tr_b16 v[180:181], v14 offset:23552
    v_cvt_pk_bf16_f32 v75, v78, v79
    v_mfma_f32_16x16x32_bf16 v[124:127], v[188:191], a[28:31], v[124:127]
    ds_read_b64_tr_b16 v[182:183], v15 offset:23552
    s_waitcnt lgkmcnt(12)
    v_mfma_f32_16x16x32_bf16 v[112:115], v[32:35], a[32:35], v[112:115]
    s_waitcnt vmcnt(8)
    s_barrier
    v_mfma_f32_16x16x32_bf16 v[116:119], v[32:35], a[36:39], v[116:119]
    buffer_store_dwordx4 v[72:75], v22, s[68:71], s80 offen offset:0 sc1
    ds_read_b64_tr_b16 v[184:185], v12 offset:30720
    v_mfma_f32_16x16x32_bf16 v[120:123], v[36:39], a[32:35], v[120:123]
    ds_read_b64_tr_b16 v[186:187], v13 offset:30720
    ds_read_b64_tr_b16 v[188:189], v14 offset:30720
    v_mfma_f32_16x16x32_bf16 v[124:127], v[36:39], a[36:39], v[124:127]
    ds_read_b64_tr_b16 v[190:191], v15 offset:30720
    v_mfma_f32_16x16x32_bf16 v[112:115], v[40:43], a[40:43], v[112:115]
    ds_read_b64_tr_b16 v[32:33], v12 offset:31744
    v_cvt_pk_bf16_f32 v136, v136, v137
    v_mfma_f32_16x16x32_bf16 v[116:119], v[40:43], a[44:47], v[116:119]
    ds_read_b64_tr_b16 v[34:35], v13 offset:31744
    v_cvt_pk_bf16_f32 v137, v138, v139
    v_mfma_f32_16x16x32_bf16 v[120:123], v[44:47], a[40:43], v[120:123]
    ds_read_b64_tr_b16 v[36:37], v14 offset:31744
    v_cvt_pk_bf16_f32 v138, v140, v141
    v_mfma_f32_16x16x32_bf16 v[124:127], v[44:47], a[44:47], v[124:127]
    ds_read_b64_tr_b16 v[38:39], v15 offset:31744
    s_waitcnt lgkmcnt(12)
    v_mfma_f32_16x16x32_bf16 v[112:115], v[160:163], a[48:51], v[112:115]
    ds_read_b64_tr_b16 v[40:41], v12 offset:32768
    v_cvt_pk_bf16_f32 v139, v142, v143
    v_mfma_f32_16x16x32_bf16 v[116:119], v[160:163], a[52:55], v[116:119]
    buffer_store_dwordx4 v[136:139], v22, s[68:71], s79 offen offset:0 sc1
    ds_read_b64_tr_b16 v[42:43], v13 offset:32768
    v_mfma_f32_16x16x32_bf16 v[120:123], v[164:167], a[48:51], v[120:123]
    ds_read_b64_tr_b16 v[44:45], v14 offset:32768
    v_mfma_f32_16x16x32_bf16 v[124:127], v[164:167], a[52:55], v[124:127]
    ds_read_b64_tr_b16 v[46:47], v15 offset:32768
    v_mfma_f32_16x16x32_bf16 v[112:115], v[168:171], a[56:59], v[112:115]
    ds_read_b64_tr_b16 v[160:161], v12 offset:33792
    v_mfma_f32_16x16x32_bf16 v[116:119], v[168:171], a[60:63], v[116:119]
    ds_read_b64_tr_b16 v[162:163], v13 offset:33792
    v_mfma_f32_16x16x32_bf16 v[120:123], v[172:175], a[56:59], v[120:123]
    ds_read_b64_tr_b16 v[164:165], v14 offset:33792
    v_mfma_f32_16x16x32_bf16 v[124:127], v[172:175], a[60:63], v[124:127]
    ds_read_b64_tr_b16 v[166:167], v15 offset:33792
    s_waitcnt lgkmcnt(12)
    v_mfma_f32_16x16x32_bf16 v[112:115], v[176:179], a[64:67], v[112:115]
    ds_read_b64_tr_b16 v[168:169], v12 offset:34816
    v_mfma_f32_16x16x32_bf16 v[116:119], v[176:179], a[68:71], v[116:119]
    ds_read_b64_tr_b16 v[170:171], v13 offset:34816
    v_mfma_f32_16x16x32_bf16 v[120:123], v[180:183], a[64:67], v[120:123]
    ds_read_b64_tr_b16 v[172:173], v14 offset:34816
    v_mfma_f32_16x16x32_bf16 v[124:127], v[180:183], a[68:71], v[124:127]
    ds_read_b64_tr_b16 v[174:175], v15 offset:34816
    v_mfma_f32_16x16x32_bf16 v[112:115], v[184:187], a[72:75], v[112:115]
    ds_read_b64_tr_b16 v[176:177], v12 offset:35840
    v_mfma_f32_16x16x32_bf16 v[116:119], v[184:187], a[76:79], v[116:119]
    ds_read_b64_tr_b16 v[178:179], v13 offset:35840
    v_mfma_f32_16x16x32_bf16 v[120:123], v[188:191], a[72:75], v[120:123]
    ds_read_b64_tr_b16 v[180:181], v14 offset:35840
    v_mfma_f32_16x16x32_bf16 v[124:127], v[188:191], a[76:79], v[124:127]
    ds_read_b64_tr_b16 v[182:183], v15 offset:35840
    s_waitcnt lgkmcnt(12)
    v_mfma_f32_16x16x32_bf16 v[112:115], v[32:35], a[80:83], v[112:115]
    ds_read_b64_tr_b16 v[184:185], v12 offset:36864
    v_mfma_f32_16x16x32_bf16 v[116:119], v[32:35], a[84:87], v[116:119]
    ds_read_b64_tr_b16 v[186:187], v13 offset:36864
    v_mfma_f32_16x16x32_bf16 v[120:123], v[36:39], a[80:83], v[120:123]
    ds_read_b64_tr_b16 v[188:189], v14 offset:36864
    v_mfma_f32_16x16x32_bf16 v[124:127], v[36:39], a[84:87], v[124:127]
    ds_read_b64_tr_b16 v[190:191], v15 offset:36864
    v_mfma_f32_16x16x32_bf16 v[112:115], v[40:43], a[88:91], v[112:115]
    ds_read_b64_tr_b16 v[32:33], v12 offset:37888
    v_mfma_f32_16x16x32_bf16 v[116:119], v[40:43], a[92:95], v[116:119]
    ds_read_b64_tr_b16 v[34:35], v13 offset:37888
    s_branch L_sskip10
L_stub10:
    s_setpc_b64 s[100:101]
L_sskip10:
    v_mfma_f32_16x16x32_bf16 v[120:123], v[44:47], a[88:91], v[120:123]
    ds_read_b64_tr_b16 v[36:37], v14 offset:37888
    v_mfma_f32_16x16x32_bf16 v[124:127], v[44:47], a[92:95], v[124:127]
    ds_read_b64_tr_b16 v[38:39], v15 offset:37888
    s_waitcnt lgkmcnt(12)
    v_mfma_f32_16x16x32_bf16 v[112:115], v[160:163], a[96:99], v[112:115]
    ds_read_b64_tr_b16 v[40:41], v12 offset:38912
    v_mfma_f32_16x16x32_bf16 v[116:119], v[160:163], a[100:103], v[116:119]
    ds_read_b64_tr_b16 v[42:43], v13 offset:38912
    v_mfma_f32_16x16x32_bf16 v[120:123], v[164:167], a[96:99], v[120:123]
    ds_read_b64_tr_b16 v[44:45], v14 offset:38912
    v_mfma_f32_16x16x32_bf16 v[124:127], v[164:167], a[100:103], v[124:127]
    ds_read_b64_tr_b16 v[46:47], v15 offset:38912
    v_mfma_f32_16x16x32_bf16 v[112:115], v[168:171], a[104:107], v[112:115]
    s_waitcnt vmcnt(3)
    v_cmp_gt_u32 vcc, 1, v6
    s_cbranch_vccnz L_poll7
L_fok7:
    v_mfma_f32_16x16x32_bf16 v[116:119], v[168:171], a[108:111], v[116:119]
    ds_read_b64_tr_b16 v[160:161], v12 offset:24576
    ds_read_b64_tr_b16 v[162:163], v13 offset:24576
    v_mfma_f32_16x16x32_bf16 v[120:123], v[172:175], a[104:107], v[120:123]
    ds_read_b64_tr_b16 v[164:165], v14 offset:24576
    v_mfma_f32_16x16x32_bf16 v[124:127], v[172:175], a[108:111], v[124:127]
    ds_read_b64_tr_b16 v[166:167], v15 offset:24576
    s_waitcnt lgkmcnt(12)
    v_mfma_f32_16x16x32_bf16 v[112:115], v[176:179], a[112:115], v[112:115]
    buffer_load_dword v10, v17, s[68:71], s96 offen offset:0 sc1
    v_mfma_f32_16x16x32_bf16 v[116:119], v[176:179], a[116:119], v[116:119]
    ds_read_b64_tr_b16 v[168:169], v12 offset:25600
    ds_read_b64_tr_b16 v[170:171], v13 offset:25600
    v_mfma_f32_16x16x32_bf16 v[120:123], v[180:183], a[112:115], v[120:123]
    ds_read_b64_tr_b16 v[172:173], v14 offset:25600
    v_mfma_f32_16x16x32_bf16 v[124:127], v[180:183], a[116:119], v[124:127]
    ds_read_b64_tr_b16 v[174:175], v15 offset:25600
    v_mfma_f32_16x16x32_bf16 v[112:115], v[184:187], a[120:123], v[112:115]
    buffer_load_dword v11, v17, s[68:71], s96 offen offset:64 sc1
    v_mfma_f32_16x16x32_bf16 v[116:119], v[184:187], a[124:127], v[116:119]
    ds_read_b64_tr_b16 v[176:177], v12 offset:26624
    ds_read_b64_tr_b16 v[178:179], v13 offset:26624
    v_mfma_f32_16x16x32_bf16 v[120:123], v[188:191], a[120:123], v[120:123]
    ds_read_b64_tr_b16 v[180:181], v14 offset:26624
    v_mfma_f32_16x16x32_bf16 v[124:127], v[188:191], a[124:127], v[124:127]
    ds_read_b64_tr_b16 v[182:183], v15 offset:26624
    s_waitcnt lgkmcnt(12)
    v_mfma_f32_16x16x32_bf16 v[112:115], v[32:35], a[128:131], v[112:115]
    buffer_load_dwordx4 v[208:211], v22, s[68:71], s61 offen offset:1024 sc1
    v_mfma_f32_16x16x32_bf16 v[116:119], v[32:35], a[132:135], v[116:119]
    ds_read_b64_tr_b16 v[184:185], v12 offset:0
    ds_read_b64_tr_b16 v[186:187], v13 offset:0
    v_mfma_f32_16x16x32_bf16 v[120:123], v[36:39], a[128:131], v[120:123]
    ds_read_b64_tr_b16 v[188:189], v14 offset:0
    v_mfma_f32_16x16x32_bf16 v[124:127], v[36:39], a[132:135], v[124:127]
    ds_read_b64_tr_b16 v[190:191], v15 offset:0
    v_mfma_f32_16x16x32_bf16 v[112:115], v[40:43], a[136:139], v[112:115]
    buffer_load_dwordx4 v[212:215], v22, s[68:71], s61 offen offset:2048 sc1
    v_mfma_f32_16x16x32_bf16 v[116:119], v[40:43], a[140:143], v[116:119]
    ds_read_b64_tr_b16 v[32:33], v12 offset:1024
    ds_read_b64_tr_b16 v[34:35], v13 offset:1024
    v_mfma_f32_16x16x32_bf16 v[120:123], v[44:47], a[136:139], v[120:123]
    ds_read_b64_tr_b16 v[36:37], v14 offset:1024
    v_mfma_f32_16x16x32_bf16 v[124:127], v[44:47], a[140:143], v[124:127]
    ds_read_b64_tr_b16 v[38:39], v15 offset:1024
    s_waitcnt lgkmcnt(12)
    v_mfma_f32_16x16x32_bf16 v[112:115], v[160:163], a[144:147], v[112:115]
    buffer_load_dwordx4 v[220:223], v22, s[68:71], s62 offen offset:1024 sc1
    v_mfma_f32_16x16x32_bf16 v[116:119], v[160:163], a[148:151], v[116:119]
    ds_read_b64_tr_b16 v[40:41], v12 offset:2048
    ds_read_b64_tr_b16 v[42:43], v13 offset:2048
    v_mfma_f32_16x16x32_bf16 v[120:123], v[164:167], a[144:147], v[120:123]
    ds_read_b64_tr_b16 v[44:45], v14 offset:2048
    v_mfma_f32_16x16x32_bf16 v[124:127], v[164:167], a[148:151], v[124:127]
    ds_read_b64_tr_b16 v[46:47], v15 offset:2048
    v_mfma_f32_16x16x32_bf16 v[112:115], v[168:171], a[152:155], v[112:115]
    buffer_load_dwordx4 v[224:227], v22, s[68:71], s62 offen offset:2048 sc1
    s_barrier
    v_mfma_f32_16x16x32_bf16 v[116:119], v[168:171], a[156:159], v[116:119]
    ds_read_b64_tr_b16 v[160:161], v12 offset:3072
    ds_read_b64_tr_b16 v[162:163], v13 offset:3072
    v_mfma_f32_16x16x32_bf16 v[120:123], v[172:175], a[152:155], v[120:123]
    ds_read_b64_tr_b16 v[164:165], v14 offset:3072
    v_mfma_f32_16x16x32_bf16 v[124:127], v[172:175], a[156:159], v[124:127]
    ds_read_b64_tr_b16 v[166:167], v15 offset:3072
    s_waitcnt lgkmcnt(12)
    v_mfma_f32_16x16x32_bf16 v[112:115], v[176:179], a[160:163], v[112:115]
    ds_read_b64_tr_b16 v[168:169], v12 offset:4096
    v_mfma_f32_16x16x32_bf16 v[116:119], v[176:179], a[164:167], v[116:119]
    ds_read_b64_tr_b16 v[170:171], v13 offset:4096
    v_mfma_f32_16x16x32_bf16 v[120:123], v[180:183], a[160:163], v[120:123]
    ds_read_b64_tr_b16 v[172:173], v14 offset:4096
    v_mfma_f32_16x16x32_bf16 v[124:127], v[180:183], a[164:167], v[124:127]
    ds_read_b64_tr_b16 v[174:175], v15 offset:4096
    v_mfma_f32_16x16x32_bf16 v[112:115], v[184:187], a[168:171], v[112:115]
    buffer_load_dwordx4 v[240:243], v22, s[68:71], s77 offen offset:0 sc1
    v_mfma_f32_16x16x32_bf16 v[116:119], v[184:187], a[172:175], v[116:119]
    ds_read_b64_tr_b16 v[176:177], v12 offset:5120
    ds_read_b64_tr_b16 v[178:179], v13 offset:5120
    v_mfma_f32_16x16x32_bf16 v[120:123], v[188:191], a[168:171], v[120:123]
    ds_read_b64_tr_b16 v[180:181], v14 offset:5120
    v_mfma_f32_16x16x32_bf16 v[124:127], v[188:191], a[172:175], v[124:127]
    ds_read_b64_tr_b16 v[182:183], v15 offset:5120
    s_waitcnt lgkmcnt(12)
    v_mfma_f32_16x16x32_bf16 v[112:115], v[32:35], a[176:179], v[112:115]
    buffer_load_dwordx4 v[244:247], v22, s[68:71], s77 offen offset:1024 sc1
    v_mfma_f32_16x16x32_bf16 v[116:119], v[32:35], a[180:183], v[116:119]
    ds_read_b64_tr_b16 v[184:185], v12 offset:6144
    ds_read_b64_tr_b16 v[186:187], v13 offset:6144
    v_mfma_f32_16x16x32_bf16 v[120:123], v[36:39], a[176:179], v[120:123]
    ds_read_b64_tr_b16 v[188:189], v14 offset:6144
    v_mfma_f32_16x16x32_bf16 v[124:127], v[36:39], a[180:183], v[124:127]
    ds_read_b64_tr_b16 v[190:191], v15 offset:6144
    v_mfma_f32_16x16x32_bf16 v[112:115], v[40:43], a[184:187], v[112:115]
    buffer_load_dwordx4 v[248:251], v22, s[68:71], s77 offen offset:2048 sc1
    v_mfma_f32_16x16x32_bf16 v[116:119], v[40:43], a[188:191], v[116:119]
    ds_read_b64_tr_b16 v[32:33], v12 offset:7168
    ds_read_b64_tr_b16 v[34:35], v13 offset:7168
    v_mfma_f32_16x16x32_bf16 v[120:123], v[44:47], a[184:187], v[120:123]
    ds_read_b64_tr_b16 v[36:37], v14 offset:7168
    v_mfma_f32_16x16x32_bf16 v[124:127], v[44:47], a[188:191], v[124:127]
    ds_read_b64_tr_b16 v[38:39], v15 offset:7168
    s_waitcnt lgkmcnt(12)
    v_mfma_f32_16x16x32_bf16 v[112:115], v[160:163], a[192:195], v[112:115]
    ds_read_b64_tr_b16 v[40:41], v12 offset:8192
    v_mfma_f32_16x16x32_bf16 v[116:119], v[160:163], a[196:199], v[116:119]
    ds_read_b64_tr_b16 v[42:43], v13 offset:8192
    v_mfma_f32_16x16x32_bf16 v[120:123], v[164:167], a[192:195], v[120:123]
    ds_read_b64_tr_b16 v[44:45], v14 offset:8192
    v_mfma_f32_16x16x32_bf16 v[124:127], v[164:167], a[196:199], v[124:127]
    ds_read_b64_tr_b16 v[46:47], v15 offset:8192
    v_mfma_f32_16x16x32_bf16 v[112:115], v[168:171], a[200:203], v[112:115]
    ds_read_b64_tr_b16 v[160:161], v2 offset:15360
    v_mfma_f32_16x16x32_bf16 v[116:119], v[168:171], a[204:207], v[116:119]
    ds_read_b64_tr_b16 v[162:163], v3 offset:15360
    v_mfma_f32_16x16x32_bf16 v[120:123], v[172:175], a[200:203], v[120:123]
    ds_read_b64_tr_b16 v[164:165], v4 offset:15360
    v_mfma_f32_16x16x32_bf16 v[124:127], v[172:175], a[204:207], v[124:127]
    ds_read_b64_tr_b16 v[166:167], v5 offset:15360
    s_waitcnt lgkmcnt(12)
    v_mfma_f32_16x16x32_bf16 v[112:115], v[176:179], a[208:211], v[112:115]
    ds_read_b64_tr_b16 v[168:169], v2 offset:16384
    v_mfma_f32_16x16x32_bf16 v[116:119], v[176:179], a[212:215], v[116:119]
    ds_read_b64_tr_b16 v[170:171], v3 offset:16384
    v_mfma_f32_16x16x32_bf16 v[120:123], v[180:183], a[208:211], v[120:123]
    ds_read_b64_tr_b16 v[172:173], v4 offset:16384
    v_mfma_f32_16x16x32_bf16 v[124:127], v[180:183], a[212:215], v[124:127]
    ds_read_b64_tr_b16 v[174:175], v5 offset:16384
    v_mfma_f32_16x16x32_bf16 v[112:115], v[184:187], a[216:219], v[112:115]
    ds_read_b64_tr_b16 v[176:177], v2 offset:17408
    v_mfma_f32_16x16x32_bf16 v[116:119], v[184:187], a[220:223], v[116:119]
    ds_read_b64_tr_b16 v[178:179], v3 offset:17408
    v_mfma_f32_16x16x32_bf16 v[120:123], v[188:191], a[216:219], v[120:123]
    ds_read_b64_tr_b16 v[180:181], v4 offset:17408
    v_mfma_f32_16x16x32_bf16 v[124:127], v[188:191], a[220:223], v[124:127]
    ds_read_b64_tr_b16 v[182:183], v5 offset:17408
    s_waitcnt lgkmcnt(12)
    v_mfma_f32_16x16x32_bf16 v[112:115], v[32:35], a[224:227], v[112:115]
    buffer_load_dwordx4 v[204:207], v22, s[68:71], s61 offen offset:0 sc1
    v_mfma_f32_16x16x32_bf16 v[116:119], v[32:35], a[228:231], v[116:119]
    ds_read_b64_tr_b16 v[184:185], v2 offset:18432
    ds_read_b64_tr_b16 v[186:187], v3 offset:18432
    v_mfma_f32_16x16x32_bf16 v[120:123], v[36:39], a[224:227], v[120:123]
    ds_read_b64_tr_b16 v[188:189], v4 offset:18432
    v_mfma_f32_16x16x32_bf16 v[124:127], v[36:39], a[228:231], v[124:127]
    ds_read_b64_tr_b16 v[190:191], v5 offset:18432
    v_mfma_f32_16x16x32_bf16 v[112:115], v[40:43], a[232:235], v[112:115]
    buffer_load_dwordx4 v[216:219], v22, s[68:71], s62 offen offset:0 sc1
    v_mfma_f32_16x16x32_bf16 v[116:119], v[40:43], a[236:239], v[116:119]
    ds_read_b64_tr_b16 v[32:33], v2 offset:19456
    ds_read_b64_tr_b16 v[34:35], v3 offset:19456
    v_mfma_f32_16x16x32_bf16 v[120:123], v[44:47], a[232:235], v[120:123]
    ds_read_b64_tr_b16 v[36:37], v4 offset:19456
    v_mfma_f32_16x16x32_bf16 v[124:127], v[44:47], a[236:239], v[124:127]
    ds_read_b64_tr_b16 v[38:39], v5 offset:19456
    s_waitcnt lgkmcnt(12)
    v_mfma_f32_16x16x32_bf16 v[144:147], v[160:163], a[0:3], 0
    s_waitcnt vmcnt(5)
    v_max3_u32 v18, v208, v212, v224
    v_max_u32 v18, v18, v220
    v_cmp_eq_u32 vcc, -1, v18
    s_cbranch_vccnz L_poll8
L_fok8:
    v_mfma_f32_16x16x32_bf16 v[148:151], v[160:163], a[4:7], 0
    buffer_load_dwordx4 v[192:195], v22, s[68:71], s60 offen offset:0 sc1
    v_mfma_f32_16x16x32_bf16 v[152:155], v[164:167], a[0:3], 0
    ds_read_b64_tr_b16 v[40:41], v2 offset:20480
    ds_read_b64_tr_b16 v[42:43], v3 offset:20480
    ds_read_b64_tr_b16 v[44:45], v4 offset:20480
    v_mfma_f32_16x16x32_bf16 v[156:159], v[164:167], a[4:7], 0
    ds_read_b64_tr_b16 v[46:47], v5 offset:20480
    v_mfma_f32_16x16x32_bf16 v[144:147], v[168:171], a[8:11], v[144:147]
    v_cvt_pk_bf16_f32 v112, v112, v113
    v_cvt_pk_bf16_f32 v113, v114, v115
    v_cvt_pk_bf16_f32 v114, v116, v117
    v_mfma_f32_16x16x32_bf16 v[148:151], v[168:171], a[12:15], v[148:151]
    ds_read_b64_tr_b16 v[160:161], v2 offset:21504
    v_cvt_pk_bf16_f32 v115, v118, v119
    v_mfma_f32_16x16x32_bf16 v[144:147], v[58:61], v[208:211], v[144:147]
    buffer_store_dwordx4 v[112:115], v22, s[68:71], s78 offen offset:1024 sc1
    v_cvt_pk_bf16_f32 v120, v120, v121
    v_cvt_pk_bf16_f32 v121, v122, v123
    v_mfma_f32_16x16x32_bf16 v[148:151], v[56:59], v[208:211], v[148:151]
    ds_read_b64_tr_b16 v[162:163], v3 offset:21504
    v_cvt_pk_bf16_f32 v122, v124, v125
    v_mfma_f32_16x16x32_bf16 v[152:155], v[172:175], a[8:11], v[152:155]
    ds_read_b64_tr_b16 v[164:165], v4 offset:21504
    v_cvt_pk_bf16_f32 v123, v126, v127
    v_mfma_f32_16x16x32_bf16 v[156:159], v[172:175], a[12:15], v[156:159]
    ds_read_b64_tr_b16 v[166:167], v5 offset:21504
    s_waitcnt lgkmcnt(12)
    v_mfma_f32_16x16x32_bf16 v[144:147], v[176:179], a[16:19], v[144:147]
    buffer_store_dwordx4 v[120:123], v22, s[68:71], s78 offen offset:2048 sc1
    ds_read_b64_tr_b16 v[168:169], v2 offset:22528
    v_mfma_f32_16x16x32_bf16 v[148:151], v[176:179], a[20:23], v[148:151]
    ds_read_b64_tr_b16 v[170:171], v3 offset:22528
    v_mfma_f32_16x16x32_bf16 v[152:155], v[58:61], v[212:215], v[152:155]
    ds_read_b64_tr_b16 v[172:173], v4 offset:22528
    v_mfma_f32_16x16x32_bf16 v[156:159], v[56:59], v[212:215], v[156:159]
    ds_read_b64_tr_b16 v[174:175], v5 offset:22528
    v_mfma_f32_16x16x32_bf16 v[152:155], v[180:183], a[16:19], v[152:155]
    v_mfma_f32_16x16x32_bf16 v[156:159], v[180:183], a[20:23], v[156:159]
    v_mfma_f32_16x16x32_bf16 v[144:147], v[184:187], a[24:27], v[144:147]
    ds_read_b64_tr_b16 v[176:177], v2 offset:23552
    v_mfma_f32_16x16x32_bf16 v[148:151], v[184:187], a[28:31], v[148:151]
    ds_read_b64_tr_b16 v[178:179], v3 offset:23552
    v_mfma_f32_16x16x32_bf16 v[144:147], v[58:61], v[220:223], v[144:147]
    ds_read_b64_tr_b16 v[180:181], v4 offset:23552
    v_mfma_f32_16x16x32_bf16 v[148:151], v[56:59], v[220:223], v[148:151]
    ds_read_b64_tr_b16 v[182:183], v5 offset:23552
    v_mfma_f32_16x16x32_bf16 v[152:155], v[188:191], a[24:27], v[152:155]
    v_mfma_f32_16x16x32_bf16 v[156:159], v[188:191], a[28:31], v[156:159]
    s_waitcnt lgkmcnt(12)
    v_mfma_f32_16x16x32_bf16 v[144:147], v[32:35], a[32:35], v[144:147]
    buffer_load_dwordx4 v[228:231], v22, s[68:71], s63 offen offset:0 sc1
    v_mfma_f32_16x16x32_bf16 v[148:151], v[32:35], a[36:39], v[148:151]
    ds_read_b64_tr_b16 v[184:185], v2 offset:30720
    v_mfma_f32_16x16x32_bf16 v[152:155], v[58:61], v[224:227], v[152:155]
    ds_read_b64_tr_b16 v[186:187], v3 offset:30720
    v_mfma_f32_16x16x32_bf16 v[156:159], v[56:59], v[224:227], v[156:159]
    ds_read_b64_tr_b16 v[188:189], v4 offset:30720
    v_mfma_f32_16x16x32_bf16 v[152:155], v[36:39], a[32:35], v[152:155]
    ds_read_b64_tr_b16 v[190:191], v5 offset:30720
    v_mfma_f32_16x16x32_bf16 v[156:159], v[36:39], a[36:39], v[156:159]
    v_mfma_f32_16x16x32_bf16 v[144:147], v[40:43], a[40:43], v[144:147]
    buffer_load_dwordx4 v[232:235], v22, s[68:71], s63 offen offset:1024 sc1
    v_mfma_f32_16x16x32_bf16 v[148:151], v[40:43], a[44:47], v[148:151]
    ds_read_b64_tr_b16 v[32:33], v2 offset:31744
    ds_read_b64_tr_b16 v[34:35], v3 offset:31744
    v_mfma_f32_16x16x32_bf16 v[152:155], v[44:47], a[40:43], v[152:155]
    ds_read_b64_tr_b16 v[36:37], v4 offset:31744
    v_mfma_f32_16x16x32_bf16 v[156:159], v[44:47], a[44:47], v[156:159]
    ds_read_b64_tr_b16 v[38:39], v5 offset:31744
    s_waitcnt lgkmcnt(12)
    v_mfma_f32_16x16x32_bf16 v[144:147], v[160:163], a[48:51], v[144:147]
    s_waitcnt vmcnt(7)
    v_max3_u32 v18, v240, v244, v248
    v_cmp_eq_u32 vcc, -1, v18
    s_cbranch_vccnz L_poll9
L_fok9:
    v_mfma_f32_16x16x32_bf16 v[148:151], v[160:163], a[52:55], v[148:151]
    buffer_load_dwordx4 v[236:239], v22, s[68:71], s63 offen offset:2048 sc1
    v_mfma_f32_16x16x32_bf16 v[152:155], v[164:167], a[48:51], v[152:155]
    ds_read_b64_tr_b16 v[40:41], v2 offset:32768
    ds_read_b64_tr_b16 v[42:43], v3 offset:32768
    v_mfma_f32_16x16x32_bf16 v[156:159], v[164:167], a[52:55], v[156:159]
    ds_read_b64_tr_b16 v[44:45], v4 offset:32768
    ds_read_b64_tr_b16 v[46:47], v5 offset:32768
    v_mfma_f32_16x16x32_bf16 v[144:147], v[168:171], a[56:59], v[144:147]
    ds_read_b64_tr_b16 v[160:161], v2 offset:33792
    v_mfma_f32_16x16x32_bf16 v[148:151], v[168:171], a[60:63], v[148:151]
    ds_read_b64_tr_b16 v[162:163], v3 offset:33792
    v_mfma_f32_16x16x32_bf16 v[128:131], v[58:61], v[240:243], v[128:131]
    ds_read_b64_tr_b16 v[164:165], v4 offset:33792
    v_mfma_f32_16x16x32_bf16 v[132:135], v[56:59], v[240:243], v[132:135]
    ds_read_b64_tr_b16 v[166:167], v5 offset:33792
    v_mfma_f32_16x16x32_bf16 v[152:155], v[172:175], a[56:59], v[152:155]
    v_mfma_f32_16x16x32_bf16 v[156:159], v[172:175], a[60:63], v[156:159]
    s_waitcnt lgkmcnt(12)
    v_mfma_f32_16x16x32_bf16 v[144:147], v[176:179], a[64:67], v[144:147]
    s_branch L_sskip11
.p2align 12
L_stub11:
    s_setpc_b64 s[100:101]
L_sskip11:
    ds_read_b64_tr_b16 v[168:169], v2 offset:34816
    v_mfma_f32_16x16x32_bf16 v[148:151], v[176:179], a[68:71], v[148:151]
    ds_read_b64_tr_b16 v[170:171], v3 offset:34816
    v_mfma_f32_16x16x32_bf16 v[144:147], v[58:61], v[244:247], v[144:147]
    ds_read_b64_tr_b16 v[172:173], v4 offset:34816
    v_mfma_f32_16x16x32_bf16 v[148:151], v[56:59], v[244:247], v[148:151]
    ds_read_b64_tr_b16 v[174:175], v5 offset:34816
    v_mfma_f32_16x16x32_bf16 v[152:155], v[180:183], a[64:67], v[152:155]
    v_mfma_f32_16x16x32_bf16 v[156:159], v[180:183], a[68:71], v[156:159]
    v_mfma_f32_16x16x32_bf16 v[144:147], v[184:187], a[72:75], v[144:147]
    ds_read_b64_tr_b16 v[176:177], v2 offset:35840
    v_mfma_f32_16x16x32_bf16 v[148:151], v[184:187], a[76:79], v[148:151]
    ds_read_b64_tr_b16 v[178:179], v3 offset:35840
    v_mfma_f32_16x16x32_bf16 v[152:155], v[58:61], v[248:251], v[152:155]
    ds_read_b64_tr_b16 v[180:181], v4 offset:35840
    v_mfma_f32_16x16x32_bf16 v[156:159], v[56:59], v[248:251], v[156:159]
    ds_read_b64_tr_b16 v[182:183], v5 offset:35840
    v_mfma_f32_16x16x32_bf16 v[152:155], v[188:191], a[72:75], v[152:155]
    v_mfma_f32_16x16x32_bf16 v[156:159], v[188:191], a[76:79], v[156:159]
    s_waitcnt lgkmcnt(12)
    v_mfma_f32_16x16x32_bf16 v[144:147], v[32:35], a[80:83], v[144:147]
    ds_read_b64_tr_b16 v[184:185], v2 offset:36864
    v_mfma_f32_16x16x32_bf16 v[148:151], v[32:35], a[84:87], v[148:151]
    ds_read_b64_tr_b16 v[186:187], v3 offset:36864
    v_mfma_f32_16x16x32_bf16 v[152:155], v[36:39], a[80:83], v[152:155]
    ds_read_b64_tr_b16 v[188:189], v4 offset:36864
    v_mfma_f32_16x16x32_bf16 v[156:159], v[36:39], a[84:87], v[156:159]
    ds_read_b64_tr_b16 v[190:191], v5 offset:36864
    v_mfma_f32_16x16x32_bf16 v[144:147], v[40:43], a[88:91], v[144:147]
    buffer_load_dwordx4 v[196:199], v22, s[68:71], s60 offen offset:1024 sc1
    v_mfma_f32_16x16x32_bf16 v[148:151], v[40:43], a[92:95], v[148:151]
    ds_read_b64_tr_b16 v[32:33], v2 offset:37888
    ds_read_b64_tr_b16 v[34:35], v3 offset:37888
    v_mfma_f32_16x16x32_bf16 v[152:155], v[44:47], a[88:91], v[152:155]
    ds_read_b64_tr_b16 v[36:37], v4 offset:37888
    v_mfma_f32_16x16x32_bf16 v[156:159], v[44:47], a[92:95], v[156:159]
    ds_read_b64_tr_b16 v[38:39], v5 offset:37888
    s_waitcnt lgkmcnt(12)
    v_mfma_f32_16x16x32_bf16 v[144:147], v[160:163], a[96:99], v[144:147]
    buffer_load_dwordx4 v[200:203], v22, s[68:71], s60 offen offset:2048 sc1
    v_mfma_f32_16x16x32_bf16 v[148:151], v[160:163], a[100:103], v[148:151]
    ds_read_b64_tr_b16 v[40:41], v2 offset:38912
    ds_read_b64_tr_b16 v[42:43], v3 offset:38912
    v_mfma_f32_16x16x32_bf16 v[152:155], v[164:167], a[96:99], v[152:155]
    ds_read_b64_tr_b16 v[44:45], v4 offset:38912
    v_mfma_f32_16x16x32_bf16 v[156:159], v[164:167], a[100:103], v[156:159]
    ds_read_b64_tr_b16 v[46:47], v5 offset:38912
    v_mfma_f32_16x16x32_bf16 v[144:147], v[168:171], a[104:107], v[144:147]
    s_waitcnt vmcnt(7)
    v_max3_u32 v18, v204, v216, v192
    v_cmp_eq_u32 vcc, -1, v18
    s_cbranch_vccnz L_poll10
L_fok10:
    v_mfma_f32_16x16x32_bf16 v[148:151], v[168:171], a[108:111], v[148:151]
    ds_read_b64_tr_b16 v[160:161], v2 offset:24576
    ds_read_b64_tr_b16 v[162:163], v3 offset:24576
    v_mfma_f32_16x16x32_bf16 v[152:155], v[172:175], a[104:107], v[152:155]
    ds_read_b64_tr_b16 v[164:165], v4 offset:24576
    v_mfma_f32_16x16x32_bf16 v[156:159], v[172:175], a[108:111], v[156:159]
    ds_read_b64_tr_b16 v[166:167], v5 offset:24576
    s_waitcnt lgkmcnt(12)
    v_mfma_f32_16x16x32_bf16 v[144:147], v[176:179], a[112:115], v[144:147]
    ds_read_b64_tr_b16 v[168:169], v2 offset:25600
    v_mfma_f32_16x16x32_bf16 v[148:151], v[176:179], a[116:119], v[148:151]
    ds_read_b64_tr_b16 v[170:171], v3 offset:25600
    v_mfma_f32_16x16x32_bf16 v[128:131], v[58:61], v[204:207], v[128:131]
    ds_read_b64_tr_b16 v[172:173], v4 offset:25600
    v_mfma_f32_16x16x32_bf16 v[132:135], v[56:59], v[204:207], v[132:135]
    ds_read_b64_tr_b16 v[174:175], v5 offset:25600
    v_mfma_f32_16x16x32_bf16 v[152:155], v[180:183], a[112:115], v[152:155]
    v_mfma_f32_16x16x32_bf16 v[156:159], v[180:183], a[116:119], v[156:159]
    v_mfma_f32_16x16x32_bf16 v[144:147], v[184:187], a[120:123], v[144:147]
    ds_read_b64_tr_b16 v[176:177], v2 offset:26624
    v_mfma_f32_16x16x32_bf16 v[148:151], v[184:187], a[124:127], v[148:151]
    ds_read_b64_tr_b16 v[178:179], v3 offset:26624
    v_mfma_f32_16x16x32_bf16 v[128:131], v[58:61], v[216:219], v[128:131]
    ds_read_b64_tr_b16 v[180:181], v4 offset:26624
    v_mfma_f32_16x16x32_bf16 v[132:135], v[56:59], v[216:219], v[132:135]
    ds_read_b64_tr_b16 v[182:183], v5 offset:26624
    v_mfma_f32_16x16x32_bf16 v[152:155], v[188:191], a[120:123], v[152:155]
    v_mfma_f32_16x16x32_bf16 v[156:159], v[188:191], a[124:127], v[156:159]
    s_waitcnt lgkmcnt(12)
    v_mfma_f32_16x16x32_bf16 v[144:147], v[32:35], a[128:131], v[144:147]
    ds_read_b64_tr_b16 v[184:185], v2 offset:0
    v_mfma_f32_16x16x32_bf16 v[148:151], v[32:35], a[132:135], v[148:151]
    ds_read_b64_tr_b16 v[186:187], v3 offset:0
    v_mfma_f32_16x16x32_bf16 v[128:131], v[58:61], v[192:195], v[128:131]
    ds_read_b64_tr_b16 v[188:189], v4 offset:0
    v_mfma_f32_16x16x32_bf16 v[132:135], v[56:59], v[192:195], v[132:135]
    ds_read_b64_tr_b16 v[190:191], v5 offset:0
    v_mfma_f32_16x16x32_bf16 v[152:155], v[36:39], a[128:131], v[152:155]
    v_mfma_f32_16x16x32_bf16 v[156:159], v[36:39], a[132:135], v[156:159]
    v_mfma_f32_16x16x32_bf16 v[144:147], v[40:43], a[136:139], v[144:147]
    ds_read_b64_tr_b16 v[32:33], v2 offset:1024
    v_mfma_f32_16x16x32_bf16 v[148:151], v[40:43], a[140:143], v[148:151]
    ds_read_b64_tr_b16 v[34:35], v3 offset:1024
    v_mfma_f32_16x16x32_bf16 v[152:155], v[44:47], a[136:139], v[152:155]
    ds_read_b64_tr_b16 v[36:37], v4 offset:1024
    v_mfma_f32_16x16x32_bf16 v[156:159], v[44:47], a[140:143], v[156:159]
    ds_read_b64_tr_b16 v[38:39], v5 offset:1024
    s_waitcnt lgkmcnt(12)
    v_mfma_f32_16x16x32_bf16 v[144:147], v[160:163], a[144:147], v[144:147]
    ds_read_b64_tr_b16 v[40:41], v2 offset:2048
    v_mfma_f32_16x16x32_bf16 v[148:151], v[160:163], a[148:151], v[148:151]
    ds_read_b64_tr_b16 v[42:43], v3 offset:2048
    v_mfma_f32_16x16x32_bf16 v[152:155], v[164:167], a[144:147], v[152:155]
    ds_read_b64_tr_b16 v[44:45], v4 offset:2048
    v_mfma_f32_16x16x32_bf16 v[156:159], v[164:167], a[148:151], v[156:159]
    ds_read_b64_tr_b16 v[46:47], v5 offset:2048
    v_mfma_f32_16x16x32_bf16 v[144:147], v[168:171], a[152:155], v[144:147]
    s_waitcnt vmcnt(2)
    v_max3_u32 v18, v228, v232, v236
    v_cmp_eq_u32 vcc, -1, v18
    s_cbranch_vccnz L_poll11
L_fok11:
    v_mfma_f32_16x16x32_bf16 v[148:151], v[168:171], a[156:159], v[148:151]
    ds_read_b64_tr_b16 v[160:161], v2 offset:3072
    ds_read_b64_tr_b16 v[162:163], v3 offset:3072
    v_mfma_f32_16x16x32_bf16 v[152:155], v[172:175], a[152:155], v[152:155]
    ds_read_b64_tr_b16 v[164:165], v4 offset:3072
    v_mfma_f32_16x16x32_bf16 v[156:159], v[172:175], a[156:159], v[156:159]
    ds_read_b64_tr_b16 v[166:167], v5 offset:3072
    s_waitcnt lgkmcnt(12)
    v_mfma_f32_16x16x32_bf16 v[144:147], v[176:179], a[160:163], v[144:147]
    ds_read_b64_tr_b16 v[168:169], v2 offset:4096
    v_mfma_f32_16x16x32_bf16 v[148:151], v[176:179], a[164:167], v[148:151]
    ds_read_b64_tr_b16 v[170:171], v3 offset:4096
    v_mfma_f32_16x16x32_bf16 v[80:83], v[58:61], v[228:231], 0
    ds_read_b64_tr_b16 v[172:173], v4 offset:4096
    v_mfma_f32_16x16x32_bf16 v[84:87], v[56:59], v[228:231], 0
    ds_read_b64_tr_b16 v[174:175], v5 offset:4096
    v_mfma_f32_16x16x32_bf16 v[152:155], v[180:183], a[160:163], v[152:155]
    v_mfma_f32_16x16x32_bf16 v[156:159], v[180:183], a[164:167], v[156:159]
    v_mfma_f32_16x16x32_bf16 v[144:147], v[184:187], a[168:171], v[144:147]
    ds_read_b64_tr_b16 v[176:177], v2 offset:5120
    v_mfma_f32_16x16x32_bf16 v[148:151], v[184:187], a[172:175], v[148:151]
    ds_read_b64_tr_b16 v[178:179], v3 offset:5120
    v_mfma_f32_16x16x32_bf16 v[88:91], v[58:61], v[232:235], 0
    ds_read_b64_tr_b16 v[180:181], v4 offset:5120
    v_mfma_f32_16x16x32_bf16 v[92:95], v[56:59], v[232:235], 0
    ds_read_b64_tr_b16 v[182:183], v5 offset:5120
    v_mfma_f32_16x16x32_bf16 v[152:155], v[188:191], a[168:171], v[152:155]
    v_mfma_f32_16x16x32_bf16 v[156:159], v[188:191], a[172:175], v[156:159]
    s_waitcnt lgkmcnt(12)
    v_mfma_f32_16x16x32_bf16 v[144:147], v[32:35], a[176:179], v[144:147]
    ds_read_b64_tr_b16 v[184:185], v2 offset:6144
    v_mfma_f32_16x16x32_bf16 v[148:151], v[32:35], a[180:183], v[148:151]
    ds_read_b64_tr_b16 v[186:187], v3 offset:6144
    v_mfma_f32_16x16x32_bf16 v[96:99], v[58:61], v[236:239], 0
    ds_read_b64_tr_b16 v[188:189], v4 offset:6144
    v_mfma_f32_16x16x32_bf16 v[100:103], v[56:59], v[236:239], 0
    ds_read_b64_tr_b16 v[190:191], v5 offset:6144
    v_mfma_f32_16x16x32_bf16 v[152:155], v[36:39], a[176:179], v[152:155]
    v_mfma_f32_16x16x32_bf16 v[156:159], v[36:39], a[180:183], v[156:159]
    v_mfma_f32_16x16x32_bf16 v[144:147], v[40:43], a[184:187], v[144:147]
    ds_read_b64_tr_b16 v[32:33], v2 offset:7168
    v_mfma_f32_16x16x32_bf16 v[148:151], v[40:43], a[188:191], v[148:151]
    ds_read_b64_tr_b16 v[34:35], v3 offset:7168
    v_mfma_f32_16x16x32_bf16 v[152:155], v[44:47], a[184:187], v[152:155]
    ds_read_b64_tr_b16 v[36:37], v4 offset:7168
    v_mfma_f32_16x16x32_bf16 v[156:159], v[44:47], a[188:191], v[156:159]
    ds_read_b64_tr_b16 v[38:39], v5 offset:7168
    s_waitcnt lgkmcnt(12)
    v_mfma_f32_16x16x32_bf16 v[144:147], v[160:163], a[192:195], v[144:147]
    ds_read_b64_tr_b16 v[40:41], v2 offset:8192
    v_fma_f32 v128, v128, v10, v80
    v_mfma_f32_16x16x32_bf16 v[148:151], v[160:163], a[196:199], v[148:151]
    ds_read_b64_tr_b16 v[42:43], v3 offset:8192
    v_fma_f32 v129, v129, v10, v81
    v_mfma_f32_16x16x32_bf16 v[152:155], v[164:167], a[192:195], v[152:155]
    ds_read_b64_tr_b16 v[44:45], v4 offset:8192
    v_fma_f32 v130, v130, v10, v82
    v_mfma_f32_16x16x32_bf16 v[156:159], v[164:167], a[196:199], v[156:159]
    ds_read_b64_tr_b16 v[46:47], v5 offset:8192
    v_fma_f32 v131, v131, v10, v83
    v_mfma_f32_16x16x32_bf16 v[144:147], v[168:171], a[200:203], v[144:147]
    buffer_store_dwordx4 v[128:131], v16, s[64:67], s95 offen sc0 sc1
    v_fma_f32 v132, v132, v11, v84
    v_mfma_f32_16x16x32_bf16 v[148:151], v[168:171], a[204:207], v[148:151]
    v_fma_f32 v133, v133, v11, v85
    v_fma_f32 v134, v134, v11, v86
    v_mfma_f32_16x16x32_bf16 v[152:155], v[172:175], a[200:203], v[152:155]
    v_fma_f32 v135, v135, v11, v87
    v_mfma_f32_16x16x32_bf16 v[156:159], v[172:175], a[204:207], v[156:159]
    s_waitcnt lgkmcnt(8)
    v_mfma_f32_16x16x32_bf16 v[144:147], v[176:179], a[208:211], v[144:147]
    s_waitcnt vmcnt(1)
    v_max3_u32 v18, v196, v200, v200
    v_cmp_eq_u32 vcc, -1, v18
    s_cbranch_vccnz L_poll12
L_fok12:
    v_mfma_f32_16x16x32_bf16 v[148:151], v[176:179], a[212:215], v[148:151]
    buffer_store_dwordx4 v[132:135], v19, s[64:67], s95 offen sc0 sc1
    v_mfma_f32_16x16x32_bf16 v[152:155], v[180:183], a[208:211], v[152:155]
    v_mfma_f32_16x16x32_bf16 v[156:159], v[180:183], a[212:215], v[156:159]
    v_mfma_f32_16x16x32_bf16 v[144:147], v[184:187], a[216:219], v[144:147]
    v_mfma_f32_16x16x32_bf16 v[148:151], v[184:187], a[220:223], v[148:151]
    v_mfma_f32_16x16x32_bf16 v[144:147], v[58:61], v[196:199], v[144:147]
    v_mfma_f32_16x16x32_bf16 v[148:151], v[56:59], v[196:199], v[148:151]
    v_mfma_f32_16x16x32_bf16 v[152:155], v[188:191], a[216:219], v[152:155]
    v_mfma_f32_16x16x32_bf16 v[156:159], v[188:191], a[220:223], v[156:159]
    s_waitcnt lgkmcnt(0)
    v_mfma_f32_16x16x32_bf16 v[144:147], v[32:35], a[224:227], v[144:147]
    v_mfma_f32_16x16x32_bf16 v[148:151], v[32:35], a[228:231], v[148:151]
    v_mfma_f32_16x16x32_bf16 v[152:155], v[58:61], v[200:203], v[152:155]
    v_mfma_f32_16x16x32_bf16 v[156:159], v[56:59], v[200:203], v[156:159]
    v_mfma_f32_16x16x32_bf16 v[152:155], v[36:39], a[224:227], v[152:155]
    v_mfma_f32_16x16x32_bf16 v[156:159], v[36:39], a[228:231], v[156:159]
    v_mfma_f32_16x16x32_bf16 v[144:147], v[40:43], a[232:235], v[144:147]
    v_mfma_f32_16x16x32_bf16 v[148:151], v[40:43], a[236:239], v[148:151]
    v_mfma_f32_16x16x32_bf16 v[152:155], v[44:47], a[232:235], v[152:155]
    v_mfma_f32_16x16x32_bf16 v[156:159], v[44:47], a[236:239], v[156:159]
    s_nop 7
    v_fma_f32 v144, v144, v10, v88
    v_fma_f32 v145, v145, v10, v89
    v_fma_f32 v146, v146, v10, v90
    v_fma_f32 v147, v147, v10, v91
    v_fma_f32 v152, v152, v10, v96
    v_fma_f32 v153, v153, v10, v97
    v_fma_f32 v154, v154, v10, v98
    v_fma_f32 v155, v155, v10, v99
    s_not_b64 vcc, s[28:29]
    v_cndmask_b32_dpp v68, v144, v152, vcc quad_perm:[1,0,3,2] row_mask:0xf bank_mask:0xf
    v_cndmask_b32_dpp v69, v145, v153, vcc quad_perm:[1,0,3,2] row_mask:0xf bank_mask:0xf
    v_cndmask_b32_dpp v70, v146, v154, vcc quad_perm:[1,0,3,2] row_mask:0xf bank_mask:0xf
    v_cndmask_b32_dpp v71, v147, v155, vcc quad_perm:[1,0,3,2] row_mask:0xf bank_mask:0xf
    buffer_store_dwordx4 v[68:71], v62, s[64:67], s97 offen offset:2304 sc0 sc1
    s_mov_b64 vcc, s[28:29]
    v_cndmask_b32_dpp v64, v152, v144, vcc quad_perm:[1,0,3,2] row_mask:0xf bank_mask:0xf
    v_cndmask_b32_dpp v65, v153, v145, vcc quad_perm:[1,0,3,2] row_mask:0xf bank_mask:0xf
    v_cndmask_b32_dpp v66, v154, v146, vcc quad_perm:[1,0,3,2] row_mask:0xf bank_mask:0xf
    v_cndmask_b32_dpp v67, v155, v147, vcc quad_perm:[1,0,3,2] row_mask:0xf bank_mask:0xf
    buffer_store_dwordx4 v[64:67], v62, s[64:67], s97 offen offset:0 sc0 sc1
    v_fma_f32 v148, v148, v11, v92
    v_fma_f32 v149, v149, v11, v93
    v_fma_f32 v150, v150, v11, v94
    v_fma_f32 v151, v151, v11, v95
    v_fma_f32 v156, v156, v11, v100
    v_fma_f32 v157, v157, v11, v101
    v_fma_f32 v158, v158, v11, v102
    v_fma_f32 v159, v159, v11, v103
    s_not_b64 vcc, s[28:29]
    v_cndmask_b32_dpp v76, v148, v156, vcc quad_perm:[1,0,3,2] row_mask:0xf bank_mask:0xf
    v_cndmask_b32_dpp v77, v149, v157, vcc quad_perm:[1,0,3,2] row_mask:0xf bank_mask:0xf
    v_cndmask_b32_dpp v78, v150, v158, vcc quad_perm:[1,0,3,2] row_mask:0xf bank_mask:0xf
    v_cndmask_b32_dpp v79, v151, v159, vcc quad_perm:[1,0,3,2] row_mask:0xf bank_mask:0xf
    buffer_store_dwordx4 v[76:79], v63, s[64:67], s97 offen offset:2304 sc0 sc1
    s_mov_b64 vcc, s[28:29]
    v_cndmask_b32_dpp v72, v156, v148, vcc quad_perm:[1,0,3,2] row_mask:0xf bank_mask:0xf
    v_cndmask_b32_dpp v73, v157, v149, vcc quad_perm:[1,0,3,2] row_mask:0xf bank_mask:0xf
    v_cndmask_b32_dpp v74, v158, v150, vcc quad_perm:[1,0,3,2] row_mask:0xf bank_mask:0xf
    v_cndmask_b32_dpp v75, v159, v151, vcc quad_perm:[1,0,3,2] row_mask:0xf bank_mask:0xf
    buffer_store_dwordx4 v[72:75], v63, s[64:67], s97 offen offset:0 sc0 sc1
L_end:
    s_endpgm
L_poll12:
    s_mov_b32 s101, 0x40000
L_loop12:
    buffer_load_dwordx4 v[196:199], v22, s[68:71], s60 offen offset:1024 sc1
    buffer_load_dwordx4 v[200:203], v22, s[68:71], s60 offen offset:2048 sc1
    s_waitcnt vmcnt(0)
    v_max3_u32 v18, v196, v200, v200
    v_cmp_eq_u32 vcc, -1, v18
    s_cbranch_vccz L_fok12
    s_sleep 2
    s_sub_u32 s101, s101, 1
    s_cmp_lg_u32 s101, 0
    s_cbranch_scc1 L_loop12
    s_branch L_fok12
L_poll11:
    s_mov_b32 s101, 0x40000
L_loop11:
    buffer_load_dwordx4 v[228:231], v22, s[68:71], s63 offen offset:0 sc1
    buffer_load_dwordx4 v[232:235], v22, s[68:71], s63 offen offset:1024 sc1
    buffer_load_dwordx4 v[236:239], v22, s[68:71], s63 offen offset:2048 sc1
    s_waitcnt vmcnt(0)
    v_max3_u32 v18, v228, v232, v236
    v_cmp_eq_u32 vcc, -1, v18
    s_cbranch_vccz L_fok11
    s_sleep 2
    s_sub_u32 s101, s101, 1
    s_cmp_lg_u32 s101, 0
    s_cbranch_scc1 L_loop11
    s_branch L_fok11
L_poll10:
    s_mov_b32 s101, 0x40000
L_loop10:
    buffer_load_dwordx4 v[204:207], v22, s[68:71], s61 offen offset:0 sc1
    buffer_load_dwordx4 v[216:219], v22, s[68:71], s62 offen offset:0 sc1
    buffer_load_dwordx4 v[192:195], v22, s[68:71], s60 offen offset:0 sc1
    s_waitcnt vmcnt(0)
    v_max3_u32 v18, v204, v216, v192
    v_cmp_eq_u32 vcc, -1, v18
    s_cbranch_vccz L_fok10
    s_sleep 2
    s_sub_u32 s101, s101, 1
    s_cmp_lg_u32 s101, 0
    s_cbranch_scc1 L_loop10
    s_branch L_fok10
L_poll9:
    s_mov_b32 s101, 0x40000
L_loop9:
    buffer_load_dwordx4 v[240:243], v22, s[68:71], s77 offen offset:0 sc1
    buffer_load_dwordx4 v[244:247], v22, s[68:71], s77 offen offset:1024 sc1
    buffer_load_dwordx4 v[248:251], v22, s[68:71], s77 offen offset:2048 sc1
    s_waitcnt vmcnt(0)
    v_max3_u32 v18, v240, v244, v248
    v_cmp_eq_u32 vcc, -1, v18
    s_cbranch_vccz L_fok9
    s_sleep 2
    s_sub_u32 s101, s101, 1
    s_cmp_lg_u32 s101, 0
    s_cbranch_scc1 L_loop9
    s_branch L_fok9
L_poll8:
    s_mov_b32 s101, 0x40000
L_loop8:
    buffer_load_dwordx4 v[208:211], v22, s[68:71], s61 offen offset:1024 sc1
    buffer_load_dwordx4 v[212:215], v22, s[68:71], s61 offen offset:2048 sc1
    buffer_load_dwordx4 v[220:223], v22, s[68:71], s62 offen offset:1024 sc1
    buffer_load_dwordx4 v[224:227], v22, s[68:71], s62 offen offset:2048 sc1
    s_waitcnt vmcnt(0)
    v_max3_u32 v18, v208, v212, v224
    v_max_u32 v18, v18, v220
    v_cmp_eq_u32 vcc, -1, v18
    s_cbranch_vccz L_fok8
    s_sleep 2
    s_sub_u32 s101, s101, 1
    s_cmp_lg_u32 s101, 0
    s_cbranch_scc1 L_loop8
    s_branch L_fok8
L_poll7:
    s_mov_b32 s101, 0x40000
L_loop7:
    global_load_dword v6, v27, s[48:49] sc1
    s_waitcnt vmcnt(0)
    v_cmp_gt_u32 vcc, 1, v6
    s_cbranch_vccz L_fok7
    s_sleep 4
    s_sub_u32 s101, s101, 1
    s_cmp_lg_u32 s101, 0
    s_cbranch_scc1 L_loop7
    s_branch L_fok7
L_poll6:
    s_mov_b32 s101, 0x40000
L_loop6:
    global_load_dword v31, v30, s[48:49] offset:2560 sc1
    s_waitcnt vmcnt(0)
    v_cmp_gt_u32 vcc, 1, v31
    s_cbranch_vccz L_fok6
    s_sleep 4
    s_sub_u32 s101, s101, 1
    s_cmp_lg_u32 s101, 0
    s_cbranch_scc1 L_loop6
    s_branch L_fok6
L_poll5:
    s_mov_b32 s101, 0x40000
L_loop5:
    global_load_dword v31, v30, s[48:49] offset:2048 sc1
    s_waitcnt vmcnt(0)
    v_cmp_gt_u32 vcc, 1, v31
    s_cbranch_vccz L_fok5
    s_sleep 4
    s_sub_u32 s101, s101, 1
    s_cmp_lg_u32 s101, 0
    s_cbranch_scc1 L_loop5
    s_branch L_fok5
L_poll4:
    s_mov_b32 s101, 0x40000
L_loop4:
    global_load_dword v31, v30, s[48:49] offset:1536 sc1
    s_waitcnt vmcnt(0)
    v_cmp_gt_u32 vcc, 1, v31
    s_cbranch_vccz L_fok4
    s_sleep 4
    s_sub_u32 s101, s101, 1
    s_cmp_lg_u32 s101, 0
    s_cbranch_scc1 L_loop4
    s_branch L_fok4
L_poll3:
    s_mov_b32 s101, 0x40000
L_loop3:
    global_load_dword v31, v30, s[48:49] offset:1024 sc1
    s_waitcnt vmcnt(0)
    v_cmp_gt_u32 vcc, 1, v31
    s_cbranch_vccz L_fok3
    s_sleep 4
    s_sub_u32 s101, s101, 1
    s_cmp_lg_u32 s101, 0
    s_cbranch_scc1 L_loop3
    s_branch L_fok3
L_poll2:
    s_mov_b32 s101, 0x40000
L_loop2:
    global_load_dword v31, v30, s[48:49] offset:512 sc1
    s_waitcnt vmcnt(0)
    v_cmp_gt_u32 vcc, 1, v31
    s_cbranch_vccz L_fok2
    s_sleep 4
    s_sub_u32 s101, s101, 1
    s_cmp_lg_u32 s101, 0
    s_cbranch_scc1 L_loop2
    s_branch L_fok2
L_poll1:
    s_mov_b32 s101, 0x40000
L_loop1:
    global_load_dword v26, v27, s[46:47] offset:128 sc1
    s_waitcnt vmcnt(0)
    v_cmp_gt_u32 vcc, 1, v26
    s_cbranch_vccz L_fok1
    s_sleep 4
    s_sub_u32 s101, s101, 1
    s_cmp_lg_u32 s101, 0
    s_cbranch_scc1 L_loop1
    s_branch L_fok1
.p2align 12
L_other:
    s_sub_u32 s98, s3, 24
    s_mov_b32 s99, s51
    s_lshl_b32 s94, s99, 2
    s_add_u32 s94, s94, s50
    s_mul_i32 s96, s94, 73728
    s_mul_i32 s94, s94, 737280
    s_mul_i32 s54, s98, 12288
    s_add_u32 s94, s94, s54
    s_add_u32 s94, s94, 294912
    s_mul_i32 s52, s50, 40960
    s_mul_i32 s97, s98, 110592
    s_lshl_b32 s95, s99, 1
    s_add_u32 s95, s95, s98
    s_add_u32 s95, s95, 1
    s_mul_i32 s53, s95, 57
    s_lshr_b32 s53, s53, 9
    s_mul_i32 s53, s53, 9
    s_sub_u32 s95, s95, s53
    s_mul_i32 s53, s95, 128
    s_add_u32 s76, s96, s53
    s_mul_i32 s53, s95, 128
    s_add_u32 s85, s97, s53
    v_lshrrev_b32 v10, 3, v0
    v_and_b32 v11, 32, v0
    v_and_b32 v12, 1, v10
    v_lshl_add_u32 v11, v12, 4, v11
    v_bfe_u32 v12, v0, 4, 1
    v_add_u32 v11, v11, v12
    v_mul_u32_u24 v11, 1152, v11
    v_and_b32 v12, 7, v0
    v_lshrrev_b32 v13, 4, v0
    v_xor_b32 v12, v12, v13
    v_lshl_add_u32 v2, v12, 4, v11
    v_xor_b32 v12, 4, v12
    v_lshl_add_u32 v13, v12, 4, v11
    v_add_u32 v3, 1280, v13
    v_add_u32 v4, 2560, v2
    v_add_u32 v5, 3840, v13
    v_lshrrev_b32 v45, 3, v0
    s_lshl_b32 s53, s50, 3
    v_add_u32 v45, s53, v45
    v_mul_u32_u24 v45, 1152, v45
    v_and_b32 v46, 7, v0
    v_lshrrev_b32 v47, 4, v0
    v_xor_b32 v46, v46, v47
    s_and_b32 s53, s50, 1
    s_lshl_b32 s53, s53, 2
    v_xor_b32 v46, s53, v46
    v_lshl_add_u32 v45, v46, 4, v45
    v_add_u32 v56, 0, v45
    v_add_u32 v57, 35840, v45
    v_add_u32 v58, 71680, v45
    s_mul_i32 s53, s98, 192
    v_and_b32 v44, 31, v0
    v_lshlrev_b32 v44, 1, v44
    v_add_u32 v44, s53, v44
    s_waitcnt lgkmcnt(0)
    s_mov_b32 s56, s16
    s_mov_b32 s57, s17
    s_mov_b32 s58, 2359296
    s_mov_b32 s59, 0x20000
    s_mov_b32 s60, s22
    s_mov_b32 s61, s23
    s_mov_b32 s62, 663552
    s_mov_b32 s63, 0x20000
    s_mov_b32 s64, s24
    s_mov_b32 s65, s25
    s_mov_b32 s66, 663552
    s_mov_b32 s67, 0x20000
    s_add_u32 m0, s52, 0
    s_add_u32 s53, s76, 0
    buffer_load_dwordx4 v2, s[56:59], s53 offen offset:0 lds
    buffer_load_dwordx4 v3, s[56:59], s53 offen offset:1024 lds
    buffer_load_dwordx4 v4, s[56:59], s53 offen offset:2048 lds
    buffer_load_dwordx4 v5, s[56:59], s53 offen offset:3072 lds
    s_add_u32 m0, s52, 4096
    s_add_u32 s53, s76, 9216
    buffer_load_dwordx4 v2, s[56:59], s53 offen offset:0 lds
    buffer_load_dwordx4 v3, s[56:59], s53 offen offset:1024 lds
    buffer_load_dwordx4 v4, s[56:59], s53 offen offset:2048 lds
    buffer_load_dwordx4 v5, s[56:59], s53 offen offset:3072 lds
    s_add_u32 m0, s52, 16384
    s_nop 0
    buffer_load_dwordx4 v56, s[60:63], s85 offen offset:0 lds
    buffer_load_dwordx4 v57, s[60:63], s85 offen offset:1024 lds
    buffer_load_dwordx4 v58, s[60:63], s85 offen offset:2048 lds
    s_add_u32 m0, s52, 19456
    s_nop 0
    buffer_load_dwordx4 v56, s[64:67], s85 offen offset:0 lds
    buffer_load_dwordx4 v57, s[64:67], s85 offen offset:1024 lds
    buffer_load_dwordx4 v58, s[64:67], s85 offen offset:2048 lds
    s_add_u32 s95, s95, 1
    s_cmp_eq_u32 s95, 9
    s_cselect_b32 s95, 0, s95
    s_mul_i32 s53, s95, 128
    s_add_u32 s77, s96, s53
    s_mul_i32 s53, s95, 128
    s_add_u32 s86, s97, s53
    s_add_u32 s95, s95, 1
    s_cmp_eq_u32 s95, 9
    s_cselect_b32 s95, 0, s95
    s_mul_i32 s53, s95, 128
    s_add_u32 s78, s96, s53
    s_mul_i32 s53, s95, 128
    s_add_u32 s87, s97, s53
    s_add_u32 s95, s95, 1
    s_cmp_eq_u32 s95, 9
    s_cselect_b32 s95, 0, s95
    s_mul_i32 s53, s95, 128
    s_add_u32 s79, s96, s53
    s_mul_i32 s53, s95, 128
    s_add_u32 s88, s97, s53
    s_add_u32 s95, s95, 1
    s_cmp_eq_u32 s95, 9
    s_cselect_b32 s95, 0, s95
    s_mul_i32 s53, s95, 128
    s_add_u32 s80, s96, s53
    s_mul_i32 s53, s95, 128
    s_add_u32 s89, s97, s53
    s_add_u32 s95, s95, 1
    s_cmp_eq_u32 s95, 9
    s_cselect_b32 s95, 0, s95
    s_mul_i32 s53, s95, 128
    s_add_u32 s81, s96, s53
    s_mul_i32 s53, s95, 128
    s_add_u32 s90, s97, s53
    s_add_u32 s95, s95, 1
    s_cmp_eq_u32 s95, 9
    s_cselect_b32 s95, 0, s95
    s_mul_i32 s53, s95, 128
    s_add_u32 s82, s96, s53
    s_mul_i32 s53, s95, 128
    s_add_u32 s91, s97, s53
    s_add_u32 s95, s95, 1
    s_cmp_eq_u32 s95, 9
    s_cselect_b32 s95, 0, s95
    s_mul_i32 s53, s95, 128
    s_add_u32 s83, s96, s53
    s_mul_i32 s53, s95, 128
    s_add_u32 s92, s97, s53
    s_add_u32 s95, s95, 1
    s_cmp_eq_u32 s95, 9
    s_cselect_b32 s95, 0, s95
    s_mul_i32 s53, s95, 128
    s_add_u32 s84, s96, s53
    s_mul_i32 s53, s95, 128
    s_add_u32 s93, s97, s53
    s_mov_b32 s68, s48
    s_mov_b32 s69, s49
    s_mov_b32 s70, 53837824
    s_mov_b32 s71, 0x20000
    s_add_u32 s72, s48, 53995520
    s_addc_u32 s73, s49, 0
    s_mov_b32 s74, 36864
    s_mov_b32 s75, 0x20000
    v_and_b32 v10, 31, v0
    v_bfe_u32 v11, v0, 1, 3
    v_lshrrev_b32 v1, 5, v0
    v_xor_b32 v11, v11, v1
    v_lshlrev_b32 v10, 7, v10
    v_add_u32 v10, s52, v10
    v_xor_b32 v1, 0, v11
    v_lshl_add_u32 v6, v1, 4, v10
    v_xor_b32 v1, 2, v11
    v_lshl_add_u32 v7, v1, 4, v10
    v_xor_b32 v1, 4, v11
    v_lshl_add_u32 v8, v1, 4, v10
    v_xor_b32 v1, 6, v11
    v_lshl_add_u32 v9, v1, 4, v10
    v_lshlrev_b32 v1, 4, v0
    v_bfe_u32 v45, v0, 3, 2
    v_mul_u32_u24 v45, 40960, v45
    v_and_b32 v46, 7, v0
    v_lshl_add_u32 v45, v46, 7, v45
    v_bfe_u32 v46, v0, 1, 3
    v_lshrrev_b32 v47, 5, v0
    v_xor_b32 v46, v46, v47
    v_xor_b32 v47, 0, v46
    v_lshl_add_u32 v59, v47, 4, v45
    v_xor_b32 v47, 2, v46
    v_lshl_add_u32 v60, v47, 4, v45
    v_xor_b32 v47, 4, v46
    v_lshl_add_u32 v61, v47, 4, v45
    v_xor_b32 v47, 6, v46
    v_lshl_add_u32 v62, v47, 4, v45
    s_cmp_lg_u32 s50, 0
    s_cbranch_scc1 L_wskip_ssm0
    s_call_b64 s[100:101], L_stub13
L_wskip_ssm0:
    s_cmp_lg_u32 s50, 1
    s_cbranch_scc1 L_wskip_ssm1
    s_call_b64 s[100:101], L_stub14
L_wskip_ssm1:
    s_cmp_lg_u32 s50, 2
    s_cbranch_scc1 L_wskip_ssm2
    s_call_b64 s[100:101], L_stub15
L_wskip_ssm2:
    s_cmp_lg_u32 s50, 3
    s_cbranch_scc1 L_wskip_ssm3
    s_call_b64 s[100:101], L_stub16
L_wskip_ssm3:
    s_lshr_b32 s53, s98, 1
    s_mul_i32 s53, s53, 384
    v_and_b32 v45, 15, v0
    v_lshl_add_u32 v45, v45, 1, s53
    v_and_or_b32 v45, v0, 32, v45
    s_add_u32 m0, s52, 8192
    s_add_u32 s53, s77, 0
    buffer_load_dwordx4 v2, s[56:59], s53 offen offset:0 lds
    buffer_load_dwordx4 v3, s[56:59], s53 offen offset:1024 lds
    buffer_load_dwordx4 v4, s[56:59], s53 offen offset:2048 lds
    buffer_load_dwordx4 v5, s[56:59], s53 offen offset:3072 lds
    s_mov_b32 s96, 0x3fb8aa3b
    s_mov_b32 s97, 0x3e22f983
    s_bitcmp1_b32 s50, 0
    s_cselect_b64 s[26:27], -1, 0
    s_bitcmp1_b32 s50, 1
    s_cselect_b64 s[28:29], -1, 0
    s_mov_b32 s42, 0
    s_mov_b32 s43, -1
    s_waitcnt vmcnt(10)
    ds_read_b128 a[0:3], v6 offset:0
    ds_read_b128 a[4:7], v6 offset:4096
    ds_read_b128 a[8:11], v7 offset:0
    ds_read_b128 a[12:15], v7 offset:4096
    ds_read_b128 a[16:19], v8 offset:0
    ds_read_b128 a[20:23], v8 offset:4096
    ds_read_b128 a[24:27], v9 offset:0
    ds_read_b128 a[28:31], v9 offset:4096
    s_waitcnt vmcnt(4)
    s_barrier
    ds_read_b128 a[64:67], v59 offset:16384
    ds_read_b128 a[68:71], v59 offset:19456
    ds_read_b128 a[72:75], v59 offset:17408
    ds_read_b128 a[76:79], v59 offset:20480
    ds_read_b128 a[80:83], v59 offset:18432
    ds_read_b128 a[84:87], v59 offset:21504
    s_waitcnt lgkmcnt(6)
    s_waitcnt lgkmcnt(3)
    v_mfma_f32_32x32x16_bf16 v[64:79], a[0:3], a[64:67], 0
    s_add_u32 m0, s52, 12288
    s_add_u32 s53, s77, 9216
    buffer_load_dwordx4 v2, s[56:59], s53 offen offset:0 lds
    ds_read_b128 a[88:91], v60 offset:16384
    v_mfma_f32_32x32x16_bf16 v[80:95], a[4:7], a[64:67], 0
    buffer_load_dwordx4 v3, s[56:59], s53 offen offset:1024 lds
    ds_read_b128 a[92:95], v60 offset:19456
    v_mfma_f32_32x32x16_bf16 v[96:111], a[0:3], a[68:71], 0
    buffer_load_dwordx4 v4, s[56:59], s53 offen offset:2048 lds
    ds_read_b128 a[96:99], v60 offset:17408
    v_mfma_f32_32x32x16_bf16 v[112:127], a[4:7], a[68:71], 0
    buffer_load_dwordx4 v5, s[56:59], s53 offen offset:3072 lds
    ds_read_b128 a[100:103], v60 offset:20480
    v_mfma_f32_32x32x16_bf16 v[128:143], a[0:3], a[72:75], 0
    s_add_u32 m0, s52, 22528
    s_nop 0
    buffer_load_dwordx4 v56, s[60:63], s86 offen offset:0 lds
    ds_read_b128 a[104:107], v60 offset:18432
    v_mfma_f32_32x32x16_bf16 v[144:159], a[4:7], a[72:75], 0
    buffer_load_dwordx4 v57, s[60:63], s86 offen offset:1024 lds
    ds_read_b128 a[108:111], v60 offset:21504
    s_waitcnt lgkmcnt(6)
    v_mfma_f32_32x32x16_bf16 v[160:175], a[0:3], a[76:79], 0
    buffer_load_dwordx4 v58, s[60:63], s86 offen offset:2048 lds
    v_mfma_f32_32x32x16_bf16 v[176:191], a[4:7], a[76:79], 0
    s_add_u32 m0, s52, 25600
    s_nop 0
    buffer_load_dwordx4 v56, s[64:67], s86 offen offset:0 lds
    v_mfma_f32_32x32x16_bf16 v[192:207], a[0:3], a[80:83], 0
    buffer_load_dwordx4 v57, s[64:67], s86 offen offset:1024 lds
    v_mfma_f32_32x32x16_bf16 v[208:223], a[4:7], a[80:83], 0
    buffer_load_dwordx4 v58, s[64:67], s86 offen offset:2048 lds
    v_mfma_f32_32x32x16_bf16 v[224:239], a[0:3], a[84:87], 0
    v_mfma_f32_32x32x16_bf16 v[240:255], a[4:7], a[84:87], 0
    s_waitcnt lgkmcnt(3)
    v_mfma_f32_32x32x16_bf16 v[64:79], a[8:11], a[88:91], v[64:79]
    s_add_u32 m0, s52, 0
    s_add_u32 s53, s78, 0
    buffer_load_dwordx4 v2, s[56:59], s53 offen offset:0 lds
    ds_read_b128 a[64:67], v61 offset:16384
    v_mfma_f32_32x32x16_bf16 v[80:95], a[12:15], a[88:91], v[80:95]
    ds_read_b128 a[68:71], v61 offset:19456
    v_mfma_f32_32x32x16_bf16 v[96:111], a[8:11], a[92:95], v[96:111]
    ds_read_b128 a[72:75], v61 offset:17408
    v_mfma_f32_32x32x16_bf16 v[112:127], a[12:15], a[92:95], v[112:127]
    buffer_load_dwordx4 v3, s[56:59], s53 offen offset:1024 lds
    ds_read_b128 a[76:79], v61 offset:20480
    v_mfma_f32_32x32x16_bf16 v[128:143], a[8:11], a[96:99], v[128:143]
    ds_read_b128 a[80:83], v61 offset:18432
    v_mfma_f32_32x32x16_bf16 v[144:159], a[12:15], a[96:99], v[144:159]
    ds_read_b128 a[84:87], v61 offset:21504
    s_waitcnt lgkmcnt(6)
    v_mfma_f32_32x32x16_bf16 v[160:175], a[8:11], a[100:103], v[160:175]
    buffer_load_dwordx4 v4, s[56:59], s53 offen offset:2048 lds
    v_mfma_f32_32x32x16_bf16 v[176:191], a[12:15], a[100:103], v[176:191]
    v_mfma_f32_32x32x16_bf16 v[192:207], a[8:11], a[104:107], v[192:207]
    v_mfma_f32_32x32x16_bf16 v[208:223], a[12:15], a[104:107], v[208:223]
    buffer_load_dwordx4 v5, s[56:59], s53 offen offset:3072 lds
    v_mfma_f32_32x32x16_bf16 v[224:239], a[8:11], a[108:111], v[224:239]
    v_mfma_f32_32x32x16_bf16 v[240:255], a[12:15], a[108:111], v[240:255]
    s_waitcnt lgkmcnt(3)
    v_mfma_f32_32x32x16_bf16 v[64:79], a[16:19], a[64:67], v[64:79]
    s_cmp_lg_u32 s50, 0
    s_cbranch_scc1 L_wskip_ssmb0
    s_call_b64 s[100:101], L_stub17
L_wskip_ssmb0:
    s_cmp_lg_u32 s50, 1
    s_cbranch_scc1 L_wskip_ssmb1
    s_call_b64 s[100:101], L_stub18
L_wskip_ssmb1:
    s_cmp_lg_u32 s50, 2
    s_cbranch_scc1 L_wskip_ssmb2
    s_call_b64 s[100:101], L_stub19
L_wskip_ssmb2:
    s_cmp_lg_u32 s50, 3
    s_cbranch_scc1 L_wskip_ssmb3
    s_call_b64 s[100:101], L_stub20
L_wskip_ssmb3:
    s_waitcnt vmcnt(10)
    ds_read_b128 a[88:91], v62 offset:16384
    ds_read_b128 a[32:35], v6 offset:8192
    v_mfma_f32_32x32x16_bf16 v[80:95], a[20:23], a[64:67], v[80:95]
    s_add_u32 m0, s52, 4096
    s_add_u32 s53, s78, 9216
    buffer_load_dwordx4 v2, s[56:59], s53 offen offset:0 lds
    ds_read_b128 a[92:95], v62 offset:19456
    ds_read_b128 a[36:39], v6 offset:12288
    v_mfma_f32_32x32x16_bf16 v[96:111], a[16:19], a[68:71], v[96:111]
    ds_read_b128 a[96:99], v62 offset:17408
    ds_read_b128 a[40:43], v7 offset:8192
    v_mfma_f32_32x32x16_bf16 v[112:127], a[20:23], a[68:71], v[112:127]
    buffer_load_dwordx4 v3, s[56:59], s53 offen offset:1024 lds
    ds_read_b128 a[100:103], v62 offset:20480
    ds_read_b128 a[44:47], v7 offset:12288
    v_mfma_f32_32x32x16_bf16 v[128:143], a[16:19], a[72:75], v[128:143]
    ds_read_b128 a[104:107], v62 offset:18432
    ds_read_b128 a[48:51], v8 offset:8192
    v_mfma_f32_32x32x16_bf16 v[144:159], a[20:23], a[72:75], v[144:159]
    ds_read_b128 a[108:111], v62 offset:21504
    ds_read_b128 a[52:55], v8 offset:12288
    s_waitcnt lgkmcnt(12)
    v_mfma_f32_32x32x16_bf16 v[160:175], a[16:19], a[76:79], v[160:175]
    buffer_load_dwordx4 v4, s[56:59], s53 offen offset:2048 lds
    ds_read_b128 a[56:59], v9 offset:8192
    v_mfma_f32_32x32x16_bf16 v[176:191], a[20:23], a[76:79], v[176:191]
    ds_read_b128 a[60:63], v9 offset:12288
    v_mfma_f32_32x32x16_bf16 v[192:207], a[16:19], a[80:83], v[192:207]
    v_mfma_f32_32x32x16_bf16 v[208:223], a[20:23], a[80:83], v[208:223]
    buffer_load_dwordx4 v5, s[56:59], s53 offen offset:3072 lds
    v_mfma_f32_32x32x16_bf16 v[224:239], a[16:19], a[84:87], v[224:239]
    v_mfma_f32_32x32x16_bf16 v[240:255], a[20:23], a[84:87], v[240:255]
    s_waitcnt lgkmcnt(9)
    v_mfma_f32_32x32x16_bf16 v[64:79], a[24:27], a[88:91], v[64:79]
    s_waitcnt vmcnt(8)
    s_barrier
    ds_read_b128 a[64:67], v59 offset:22528
    v_mfma_f32_32x32x16_bf16 v[80:95], a[28:31], a[88:91], v[80:95]
    s_add_u32 m0, s52, 28672
    s_nop 0
    buffer_load_dwordx4 v56, s[60:63], s87 offen offset:0 lds
    ds_read_b128 a[68:71], v59 offset:25600
    v_mfma_f32_32x32x16_bf16 v[96:111], a[24:27], a[92:95], v[96:111]
    ds_read_b128 a[72:75], v59 offset:23552
    v_mfma_f32_32x32x16_bf16 v[112:127], a[28:31], a[92:95], v[112:127]
    buffer_load_dwordx4 v57, s[60:63], s87 offen offset:1024 lds
    ds_read_b128 a[76:79], v59 offset:26624
    v_mfma_f32_32x32x16_bf16 v[128:143], a[24:27], a[96:99], v[128:143]
    ds_read_b128 a[80:83], v59 offset:24576
    v_mfma_f32_32x32x16_bf16 v[144:159], a[28:31], a[96:99], v[144:159]
    ds_read_b128 a[84:87], v59 offset:27648
    s_waitcnt lgkmcnt(9)
    v_mfma_f32_32x32x16_bf16 v[160:175], a[24:27], a[100:103], v[160:175]
    buffer_load_dwordx4 v58, s[60:63], s87 offen offset:2048 lds
    v_mfma_f32_32x32x16_bf16 v[176:191], a[28:31], a[100:103], v[176:191]
    v_mfma_f32_32x32x16_bf16 v[192:207], a[24:27], a[104:107], v[192:207]
    v_mfma_f32_32x32x16_bf16 v[208:223], a[28:31], a[104:107], v[208:223]
    s_add_u32 m0, s52, 31744
    s_nop 0
    buffer_load_dwordx4 v56, s[64:67], s87 offen offset:0 lds
    v_mfma_f32_32x32x16_bf16 v[224:239], a[24:27], a[108:111], v[224:239]
    v_mfma_f32_32x32x16_bf16 v[240:255], a[28:31], a[108:111], v[240:255]
    s_waitcnt lgkmcnt(6)
    s_waitcnt lgkmcnt(3)
    v_mfma_f32_32x32x16_bf16 v[64:79], a[32:35], a[64:67], v[64:79]
    global_load_ushort v14, v44, s[18:19] offset:0
    ds_read_b128 a[88:91], v60 offset:22528
    v_mfma_f32_32x32x16_bf16 v[80:95], a[36:39], a[64:67], v[80:95]
    global_load_ushort v15, v44, s[20:21] offset:0
    ds_read_b128 a[92:95], v60 offset:25600
    v_mfma_f32_32x32x16_bf16 v[96:111], a[32:35], a[68:71], v[96:111]
    global_load_ushort v20, v44, s[30:31] offset:0
    ds_read_b128 a[96:99], v60 offset:23552
    v_mfma_f32_32x32x16_bf16 v[112:127], a[36:39], a[68:71], v[112:127]
    global_load_ushort v16, v44, s[18:19] offset:64
    ds_read_b128 a[100:103], v60 offset:26624
    v_mfma_f32_32x32x16_bf16 v[128:143], a[32:35], a[72:75], v[128:143]
    global_load_ushort v17, v44, s[20:21] offset:64
    ds_read_b128 a[104:107], v60 offset:24576
    v_mfma_f32_32x32x16_bf16 v[144:159], a[36:39], a[72:75], v[144:159]
    global_load_ushort v22, v44, s[30:31] offset:64
    ds_read_b128 a[108:111], v60 offset:27648
    s_waitcnt lgkmcnt(6)
    v_mfma_f32_32x32x16_bf16 v[160:175], a[32:35], a[76:79], v[160:175]
    global_load_ushort v18, v44, s[18:19] offset:128
    v_mfma_f32_32x32x16_bf16 v[176:191], a[36:39], a[76:79], v[176:191]
    global_load_ushort v19, v44, s[20:21] offset:128
    v_mfma_f32_32x32x16_bf16 v[192:207], a[32:35], a[80:83], v[192:207]
    global_load_ushort v24, v44, s[30:31] offset:128
    v_mfma_f32_32x32x16_bf16 v[208:223], a[36:39], a[80:83], v[208:223]
    global_load_ushort a112, v45, s[32:33] offset:0
    v_mfma_f32_32x32x16_bf16 v[224:239], a[32:35], a[84:87], v[224:239]
    global_load_ushort a113, v45, s[32:33] offset:64
    v_mfma_f32_32x32x16_bf16 v[240:255], a[36:39], a[84:87], v[240:255]
    global_load_ushort a114, v45, s[32:33] offset:128
    s_waitcnt lgkmcnt(3)
    v_mfma_f32_32x32x16_bf16 v[64:79], a[40:43], a[88:91], v[64:79]
    global_load_ushort a115, v45, s[32:33] offset:192
    ds_read_b128 a[64:67], v61 offset:22528
    v_mfma_f32_32x32x16_bf16 v[80:95], a[44:47], a[88:91], v[80:95]
    global_load_ushort a116, v45, s[32:33] offset:256
    ds_read_b128 a[68:71], v61 offset:25600
    v_mfma_f32_32x32x16_bf16 v[96:111], a[40:43], a[92:95], v[96:111]
    global_load_ushort a117, v45, s[32:33] offset:320
    ds_read_b128 a[72:75], v61 offset:23552
    v_mfma_f32_32x32x16_bf16 v[112:127], a[44:47], a[92:95], v[112:127]
    buffer_load_dwordx4 v57, s[64:67], s87 offen offset:1024 lds
    ds_read_b128 a[76:79], v61 offset:26624
    v_mfma_f32_32x32x16_bf16 v[128:143], a[40:43], a[96:99], v[128:143]
    buffer_load_dwordx4 v58, s[64:67], s87 offen offset:2048 lds
    ds_read_b128 a[80:83], v61 offset:24576
    v_mfma_f32_32x32x16_bf16 v[144:159], a[44:47], a[96:99], v[144:159]
    ds_read_b128 a[84:87], v61 offset:27648
    s_waitcnt lgkmcnt(6)
    v_mfma_f32_32x32x16_bf16 v[160:175], a[40:43], a[100:103], v[160:175]
    v_mfma_f32_32x32x16_bf16 v[176:191], a[44:47], a[100:103], v[176:191]
    s_add_u32 m0, s52, 8192
    s_add_u32 s53, s79, 0
    buffer_load_dwordx4 v2, s[56:59], s53 offen offset:0 lds
    v_mfma_f32_32x32x16_bf16 v[192:207], a[40:43], a[104:107], v[192:207]
    v_mfma_f32_32x32x16_bf16 v[208:223], a[44:47], a[104:107], v[208:223]
    v_mfma_f32_32x32x16_bf16 v[224:239], a[40:43], a[108:111], v[224:239]
    buffer_load_dwordx4 v3, s[56:59], s53 offen offset:1024 lds
    v_mfma_f32_32x32x16_bf16 v[240:255], a[44:47], a[108:111], v[240:255]
    s_waitcnt lgkmcnt(3)
    v_mfma_f32_32x32x16_bf16 v[64:79], a[48:51], a[64:67], v[64:79]
    s_waitcnt vmcnt(23)
    ds_read_b128 a[88:91], v62 offset:22528
    ds_read_b128 a[0:3], v6 offset:0
    v_mfma_f32_32x32x16_bf16 v[80:95], a[52:55], a[64:67], v[80:95]
    buffer_load_dwordx4 v4, s[56:59], s53 offen offset:2048 lds
    ds_read_b128 a[92:95], v62 offset:25600
    ds_read_b128 a[4:7], v6 offset:4096
    v_mfma_f32_32x32x16_bf16 v[96:111], a[48:51], a[68:71], v[96:111]
    ds_read_b128 a[96:99], v62 offset:23552
    ds_read_b128 a[8:11], v7 offset:0
    v_mfma_f32_32x32x16_bf16 v[112:127], a[52:55], a[68:71], v[112:127]
    ds_read_b128 a[100:103], v62 offset:26624
    ds_read_b128 a[12:15], v7 offset:4096
    v_mfma_f32_32x32x16_bf16 v[128:143], a[48:51], a[72:75], v[128:143]
    buffer_load_dwordx4 v5, s[56:59], s53 offen offset:3072 lds
    ds_read_b128 a[104:107], v62 offset:24576
    ds_read_b128 a[16:19], v8 offset:0
    v_mfma_f32_32x32x16_bf16 v[144:159], a[52:55], a[72:75], v[144:159]
    ds_read_b128 a[108:111], v62 offset:27648
    ds_read_b128 a[20:23], v8 offset:4096
    s_waitcnt lgkmcnt(12)
    v_mfma_f32_32x32x16_bf16 v[160:175], a[48:51], a[76:79], v[160:175]
    ds_read_b128 a[24:27], v9 offset:0
    v_mfma_f32_32x32x16_bf16 v[176:191], a[52:55], a[76:79], v[176:191]
    s_add_u32 m0, s52, 12288
    s_add_u32 s53, s79, 9216
    buffer_load_dwordx4 v2, s[56:59], s53 offen offset:0 lds
    ds_read_b128 a[28:31], v9 offset:4096
    v_mfma_f32_32x32x16_bf16 v[192:207], a[48:51], a[80:83], v[192:207]
    v_mfma_f32_32x32x16_bf16 v[208:223], a[52:55], a[80:83], v[208:223]
    v_mfma_f32_32x32x16_bf16 v[224:239], a[48:51], a[84:87], v[224:239]
    buffer_load_dwordx4 v3, s[56:59], s53 offen offset:1024 lds
    v_mfma_f32_32x32x16_bf16 v[240:255], a[52:55], a[84:87], v[240:255]
    s_waitcnt lgkmcnt(9)
    v_mfma_f32_32x32x16_bf16 v[64:79], a[56:59], a[88:91], v[64:79]
    s_waitcnt vmcnt(6)
    s_barrier
    ds_read_b128 a[64:67], v59 offset:28672
    v_mfma_f32_32x32x16_bf16 v[80:95], a[60:63], a[88:91], v[80:95]
    buffer_load_dwordx4 v4, s[56:59], s53 offen offset:2048 lds
    ds_read_b128 a[68:71], v59 offset:31744
    v_mfma_f32_32x32x16_bf16 v[96:111], a[56:59], a[92:95], v[96:111]
    ds_read_b128 a[72:75], v59 offset:29696
    v_mfma_f32_32x32x16_bf16 v[112:127], a[60:63], a[92:95], v[112:127]
    ds_read_b128 a[76:79], v59 offset:32768
    v_mfma_f32_32x32x16_bf16 v[128:143], a[56:59], a[96:99], v[128:143]
    buffer_load_dwordx4 v5, s[56:59], s53 offen offset:3072 lds
    ds_read_b128 a[80:83], v59 offset:30720
    v_mfma_f32_32x32x16_bf16 v[144:159], a[60:63], a[96:99], v[144:159]
    ds_read_b128 a[84:87], v59 offset:33792
    s_waitcnt lgkmcnt(9)
    v_mfma_f32_32x32x16_bf16 v[160:175], a[56:59], a[100:103], v[160:175]
    v_mfma_f32_32x32x16_bf16 v[176:191], a[60:63], a[100:103], v[176:191]
    s_add_u32 m0, s52, 34816
    s_nop 0
    buffer_load_dwordx4 v56, s[60:63], s88 offen offset:0 lds
    v_mfma_f32_32x32x16_bf16 v[192:207], a[56:59], a[104:107], v[192:207]
    v_mfma_f32_32x32x16_bf16 v[208:223], a[60:63], a[104:107], v[208:223]
    v_mfma_f32_32x32x16_bf16 v[224:239], a[56:59], a[108:111], v[224:239]
    buffer_load_dwordx4 v57, s[60:63], s88 offen offset:1024 lds
    v_mfma_f32_32x32x16_bf16 v[240:255], a[60:63], a[108:111], v[240:255]
    s_waitcnt lgkmcnt(6)
    s_waitcnt lgkmcnt(3)
    v_mfma_f32_32x32x16_bf16 v[64:79], a[0:3], a[64:67], v[64:79]
    ds_read_b128 a[88:91], v60 offset:28672
    s_lshl_b32 s95, s51, 7
    s_add_u32 s95, s95, 53968896
    v_and_b32 v63, 15, v0
    v_lshl_add_u32 v63, v63, 2, s95
    v_mfma_f32_32x32x16_bf16 v[80:95], a[4:7], a[64:67], v[80:95]
    buffer_load_dwordx4 v58, s[60:63], s88 offen offset:2048 lds
    ds_read_b128 a[92:95], v60 offset:31744
    s_and_b32 s44, s98, 1
    s_lshl1_add_u32 s44, s99, s44
    s_lshl2_add_u32 s36, s44, s50
    v_mfma_f32_32x32x16_bf16 v[96:111], a[0:3], a[68:71], v[96:111]
    ds_read_b128 a[96:99], v60 offset:29696
    s_mul_i32 s36, s36, 36864
    s_mul_i32 s44, s44, 3
    s_lshr_b32 s45, s98, 1
    s_mul_i32 s37, s45, 384
    v_mfma_f32_32x32x16_bf16 v[112:127], a[4:7], a[68:71], v[112:127]
    ds_read_b128 a[100:103], v60 offset:32768
    s_add_u32 s36, s36, s37
    s_add_u32 s44, s44, s45
    s_lshl_b32 s44, s44, 6
    s_add_u32 s44, s44, s50
    v_mfma_f32_32x32x16_bf16 v[128:143], a[0:3], a[72:75], v[128:143]
    s_add_u32 m0, s52, 37888
    s_nop 0
    buffer_load_dwordx4 v56, s[64:67], s88 offen offset:0 lds
    ds_read_b128 a[104:107], v60 offset:30720
    s_mul_i32 s44, s44, 6144
    v_mfma_f32_32x32x16_bf16 v[144:159], a[4:7], a[72:75], v[144:159]
    ds_read_b128 a[108:111], v60 offset:33792
    s_add_u32 s44, s44, 30318592
    v_accvgpr_write_b32 a128, -1
    v_accvgpr_write_b32 a129, -1
    s_waitcnt lgkmcnt(6)
    v_mfma_f32_32x32x16_bf16 v[160:175], a[0:3], a[76:79], v[160:175]
    v_accvgpr_write_b32 a130, -1
    v_accvgpr_write_b32 a131, -1
    v_lshlrev_b32 v20, 16, v20
    v_mul_f32 v20, s96, v20
    v_exp_f32 v20, v20
    v_mfma_f32_32x32x16_bf16 v[176:191], a[4:7], a[76:79], v[176:191]
    buffer_load_dwordx4 v57, s[64:67], s88 offen offset:1024 lds
    v_lshlrev_b32 v14, 16, v14
    v_lshlrev_b32 v15, 16, v15
    v_cvt_pk_bf16_f32 v20, v20, v20
    v_lshlrev_b32 v20, 16, v20
    v_mfma_f32_32x32x16_bf16 v[192:207], a[0:3], a[80:83], v[192:207]
    v_mul_f32 v44, v20, v14
    v_mul_f32 v45, v20, v15
    v_mul_f32 v44, s96, v44
    v_mul_f32 v45, s97, v45
    v_exp_f32 v44, v44
    v_mfma_f32_32x32x16_bf16 v[208:223], a[4:7], a[80:83], v[208:223]
    v_rndne_f32 v46, v45
    v_sub_f32 v45, v45, v46
    v_cos_f32 v46, v45
    v_sin_f32 v47, v45
    v_mfma_f32_32x32x16_bf16 v[224:239], a[0:3], a[84:87], v[224:239]
    buffer_load_dwordx4 v58, s[64:67], s88 offen offset:2048 lds
    v_mul_f32 v48, v14, v14
    v_mul_f32 v26, v44, v46
    v_mul_f32 v27, v44, v47
    v_mov_b32 v14, v26
    v_mfma_f32_32x32x16_bf16 v[240:255], a[4:7], a[84:87], v[240:255]
    v_mov_b32 v15, v27
    v_mul_f32 v44, v27, v27
    v_fma_f32 v44, v26, v26, -v44
    v_mul_f32 v45, v26, v27
    s_waitcnt lgkmcnt(3)
    v_mfma_f32_32x32x16_bf16 v[64:79], a[8:11], a[88:91], v[64:79]
    ds_read_b128 a[64:67], v61 offset:28672
    v_fma_f32 v27, v27, v26, v45
    v_mov_b32 v26, v44
    v_mul_f32 v44, v27, v27
    v_fma_f32 v44, v26, v26, -v44
    v_mfma_f32_32x32x16_bf16 v[80:95], a[12:15], a[88:91], v[80:95]
    s_add_u32 m0, s52, 0
    s_add_u32 s53, s80, 0
    buffer_load_dwordx4 v2, s[56:59], s53 offen offset:0 lds
    ds_read_b128 a[68:71], v61 offset:31744
    v_mul_f32 v45, v26, v27
    v_mfma_f32_32x32x16_bf16 v[96:111], a[8:11], a[92:95], v[96:111]
    ds_read_b128 a[72:75], v61 offset:29696
    v_fma_f32 v27, v27, v26, v45
    v_mov_b32 v26, v44
    v_mul_f32 v44, v27, v27
    v_fma_f32 v44, v26, v26, -v44
    v_mfma_f32_32x32x16_bf16 v[112:127], a[12:15], a[92:95], v[112:127]
    ds_read_b128 a[76:79], v61 offset:32768
    v_mul_f32 v45, v26, v27
    v_fma_f32 v27, v27, v26, v45
    v_mov_b32 v26, v44
    v_mul_f32 v44, v27, v27
    v_mfma_f32_32x32x16_bf16 v[128:143], a[8:11], a[96:99], v[128:143]
    buffer_load_dwordx4 v3, s[56:59], s53 offen offset:1024 lds
    ds_read_b128 a[80:83], v61 offset:30720
    v_fma_f32 v44, v26, v26, -v44
    v_mul_f32 v45, v26, v27
    v_fma_f32 v27, v27, v26, v45
    v_mfma_f32_32x32x16_bf16 v[144:159], a[12:15], a[96:99], v[144:159]
    ds_read_b128 a[84:87], v61 offset:33792
    v_mov_b32 v26, v44
    v_mul_f32 v44, v27, v27
    v_fma_f32 v44, v26, v26, -v44
    s_waitcnt lgkmcnt(6)
    v_mfma_f32_32x32x16_bf16 v[160:175], a[8:11], a[100:103], v[160:175]
    v_mul_f32 v45, v26, v27
    v_fma_f32 v33, v27, v26, v45
    v_mov_b32 v32, v44
    v_cndmask_b32 v20, 1.0, v32, s[42:43]
    v_cndmask_b32 v21, 0, v33, s[42:43]
    v_mfma_f32_32x32x16_bf16 v[176:191], a[12:15], a[100:103], v[176:191]
    buffer_load_dwordx4 v4, s[56:59], s53 offen offset:2048 lds
    v_mul_f32 v44, v33, v33
    v_fma_f32 v44, v32, v32, -v44
    v_mul_f32 v45, v32, v33
    v_fma_f32 v39, v33, v32, v45
    v_mfma_f32_32x32x16_bf16 v[192:207], a[8:11], a[104:107], v[192:207]
    v_mov_b32 v38, v44
    v_cndmask_b32 v46, 1.0, v38, s[26:27]
    v_cndmask_b32 v47, 0, v39, s[26:27]
    v_mul_f32 v44, v21, v47
    v_fma_f32 v44, v20, v46, -v44
    v_mfma_f32_32x32x16_bf16 v[208:223], a[12:15], a[104:107], v[208:223]
    v_mul_f32 v45, v20, v47
    v_fma_f32 v21, v21, v46, v45
    v_mov_b32 v20, v44
    v_mul_f32 v44, v39, v39
    s_branch L_sskip13
L_stub13:
    s_setpc_b64 s[100:101]
L_sskip13:
    v_fma_f32 v44, v38, v38, -v44
    v_mfma_f32_32x32x16_bf16 v[224:239], a[8:11], a[108:111], v[224:239]
    buffer_load_dwordx4 v5, s[56:59], s53 offen offset:3072 lds
    v_mul_f32 v45, v38, v39
    v_fma_f32 v39, v39, v38, v45
    v_mov_b32 v38, v44
    v_cndmask_b32 v46, 1.0, v38, s[28:29]
    v_mfma_f32_32x32x16_bf16 v[240:255], a[12:15], a[108:111], v[240:255]
    v_cndmask_b32 v47, 0, v39, s[28:29]
    v_mul_f32 v44, v21, v47
    v_fma_f32 v44, v20, v46, -v44
    v_mul_f32 v45, v20, v47
    s_waitcnt lgkmcnt(3)
    v_mfma_f32_32x32x16_bf16 v[64:79], a[16:19], a[64:67], v[64:79]
    s_waitcnt vmcnt(10)
    ds_read_b128 a[88:91], v62 offset:28672
    ds_read_b128 a[32:35], v6 offset:8192
    v_fma_f32 v21, v21, v46, v45
    v_mov_b32 v20, v44
    v_mfma_f32_32x32x16_bf16 v[80:95], a[20:23], a[64:67], v[80:95]
    s_add_u32 m0, s52, 4096
    s_add_u32 s53, s80, 9216
    buffer_load_dwordx4 v2, s[56:59], s53 offen offset:0 lds
    ds_read_b128 a[92:95], v62 offset:31744
    ds_read_b128 a[36:39], v6 offset:12288
    v_mfma_f32_32x32x16_bf16 v[96:111], a[16:19], a[68:71], v[96:111]
    ds_read_b128 a[96:99], v62 offset:29696
    ds_read_b128 a[40:43], v7 offset:8192
    v_mul_f32 v44, v39, v39
    v_fma_f32 v44, v38, v38, -v44
    v_mul_f32 v45, v38, v39
    v_mfma_f32_32x32x16_bf16 v[112:127], a[20:23], a[68:71], v[112:127]
    ds_read_b128 a[100:103], v62 offset:32768
    ds_read_b128 a[44:47], v7 offset:12288
    v_fma_f32 v39, v39, v38, v45
    v_mov_b32 v38, v44
    v_lshlrev_b32 v22, 16, v22
    v_mfma_f32_32x32x16_bf16 v[128:143], a[16:19], a[72:75], v[128:143]
    buffer_load_dwordx4 v3, s[56:59], s53 offen offset:1024 lds
    ds_read_b128 a[104:107], v62 offset:30720
    ds_read_b128 a[48:51], v8 offset:8192
    v_mul_f32 v22, s96, v22
    v_mfma_f32_32x32x16_bf16 v[144:159], a[20:23], a[72:75], v[144:159]
    ds_read_b128 a[108:111], v62 offset:33792
    ds_read_b128 a[52:55], v8 offset:12288
    v_exp_f32 v22, v22
    v_lshlrev_b32 v16, 16, v16
    s_waitcnt lgkmcnt(12)
    v_mfma_f32_32x32x16_bf16 v[160:175], a[16:19], a[76:79], v[160:175]
    ds_read_b128 a[56:59], v9 offset:8192
    v_lshlrev_b32 v17, 16, v17
    v_cvt_pk_bf16_f32 v22, v22, v22
    v_lshlrev_b32 v22, 16, v22
    v_mul_f32 v44, v22, v16
    v_mfma_f32_32x32x16_bf16 v[176:191], a[20:23], a[76:79], v[176:191]
    buffer_load_dwordx4 v4, s[56:59], s53 offen offset:2048 lds
    ds_read_b128 a[60:63], v9 offset:12288
    v_mul_f32 v45, v22, v17
    v_mul_f32 v44, s96, v44
    v_mul_f32 v45, s97, v45
    v_mfma_f32_32x32x16_bf16 v[192:207], a[16:19], a[80:83], v[192:207]
    v_exp_f32 v44, v44
    v_rndne_f32 v46, v45
    v_sub_f32 v45, v45, v46
    v_cos_f32 v46, v45
    v_mfma_f32_32x32x16_bf16 v[208:223], a[20:23], a[80:83], v[208:223]
    v_sin_f32 v47, v45
    v_mul_f32 v48, v16, v16
    v_mul_f32 v28, v44, v46
    v_mul_f32 v29, v44, v47
    v_mov_b32 v16, v28
    v_mfma_f32_32x32x16_bf16 v[224:239], a[16:19], a[84:87], v[224:239]
    buffer_load_dwordx4 v5, s[56:59], s53 offen offset:3072 lds
    v_mov_b32 v17, v29
    v_mul_f32 v44, v29, v29
    v_fma_f32 v44, v28, v28, -v44
    v_mul_f32 v45, v28, v29
    v_mfma_f32_32x32x16_bf16 v[240:255], a[20:23], a[84:87], v[240:255]
    v_fma_f32 v29, v29, v28, v45
    v_mov_b32 v28, v44
    v_mul_f32 v44, v29, v29
    v_fma_f32 v44, v28, v28, -v44
    s_waitcnt lgkmcnt(9)
    v_mfma_f32_32x32x16_bf16 v[64:79], a[24:27], a[88:91], v[64:79]
    s_waitcnt vmcnt(8)
    s_barrier
    ds_read_b128 a[64:67], v59 offset:34816
    v_mul_f32 v45, v28, v29
    v_fma_f32 v29, v29, v28, v45
    v_mfma_f32_32x32x16_bf16 v[80:95], a[28:31], a[88:91], v[80:95]
    s_add_u32 m0, s52, 16384
    s_nop 0
    buffer_load_dwordx4 v56, s[60:63], s89 offen offset:0 lds
    ds_read_b128 a[68:71], v59 offset:37888
    v_mov_b32 v28, v44
    v_mfma_f32_32x32x16_bf16 v[96:111], a[24:27], a[92:95], v[96:111]
    ds_read_b128 a[72:75], v59 offset:35840
    v_mul_f32 v44, v29, v29
    v_fma_f32 v44, v28, v28, -v44
    v_mul_f32 v45, v28, v29
    v_fma_f32 v29, v29, v28, v45
    v_mfma_f32_32x32x16_bf16 v[112:127], a[28:31], a[92:95], v[112:127]
    ds_read_b128 a[76:79], v59 offset:38912
    v_mov_b32 v28, v44
    v_mul_f32 v44, v29, v29
    v_fma_f32 v44, v28, v28, -v44
    v_mul_f32 v45, v28, v29
    v_mfma_f32_32x32x16_bf16 v[128:143], a[24:27], a[96:99], v[128:143]
    buffer_load_dwordx4 v57, s[60:63], s89 offen offset:1024 lds
    ds_read_b128 a[80:83], v59 offset:36864
    v_fma_f32 v29, v29, v28, v45
    v_mov_b32 v28, v44
    v_mul_f32 v44, v29, v29
    v_mfma_f32_32x32x16_bf16 v[144:159], a[28:31], a[96:99], v[144:159]
    ds_read_b128 a[84:87], v59 offset:39936
    v_fma_f32 v44, v28, v28, -v44
    v_mul_f32 v45, v28, v29
    v_fma_f32 v35, v29, v28, v45
    s_waitcnt lgkmcnt(9)
    v_mfma_f32_32x32x16_bf16 v[160:175], a[24:27], a[100:103], v[160:175]
    v_mov_b32 v34, v44
    v_cndmask_b32 v22, 1.0, v34, s[42:43]
    v_cndmask_b32 v23, 0, v35, s[42:43]
    v_mul_f32 v44, v35, v35
    v_fma_f32 v44, v34, v34, -v44
    v_mfma_f32_32x32x16_bf16 v[176:191], a[28:31], a[100:103], v[176:191]
    buffer_load_dwordx4 v58, s[60:63], s89 offen offset:2048 lds
    v_mul_f32 v45, v34, v35
    v_fma_f32 v41, v35, v34, v45
    v_mov_b32 v40, v44
    v_cndmask_b32 v46, 1.0, v40, s[26:27]
    v_mfma_f32_32x32x16_bf16 v[192:207], a[24:27], a[104:107], v[192:207]
    v_cndmask_b32 v47, 0, v41, s[26:27]
    v_mul_f32 v44, v23, v47
    v_fma_f32 v44, v22, v46, -v44
    v_mul_f32 v45, v22, v47
    v_fma_f32 v23, v23, v46, v45
    v_mfma_f32_32x32x16_bf16 v[208:223], a[28:31], a[104:107], v[208:223]
    v_mov_b32 v22, v44
    v_mul_f32 v44, v41, v41
    v_fma_f32 v44, v40, v40, -v44
    v_mul_f32 v45, v40, v41
    v_fma_f32 v41, v41, v40, v45
    v_mfma_f32_32x32x16_bf16 v[224:239], a[24:27], a[108:111], v[224:239]
    s_add_u32 m0, s52, 19456
    s_nop 0
    buffer_load_dwordx4 v56, s[64:67], s89 offen offset:0 lds
    v_mov_b32 v40, v44
    v_cndmask_b32 v46, 1.0, v40, s[28:29]
    v_mfma_f32_32x32x16_bf16 v[240:255], a[28:31], a[108:111], v[240:255]
    v_cndmask_b32 v47, 0, v41, s[28:29]
    v_mul_f32 v44, v23, v47
    v_fma_f32 v44, v22, v46, -v44
    v_mul_f32 v45, v22, v47
    s_waitcnt lgkmcnt(6)
    s_waitcnt lgkmcnt(3)
    v_mfma_f32_32x32x16_bf16 v[64:79], a[32:35], a[64:67], v[64:79]
    ds_read_b128 a[88:91], v60 offset:34816
    s_add_u32 s45, s44, 0
    v_fma_f32 v23, v23, v46, v45
    v_mov_b32 v22, v44
    v_mul_f32 v44, v41, v41
    v_mfma_f32_32x32x16_bf16 v[80:95], a[36:39], a[64:67], v[80:95]
    buffer_load_dwordx4 v57, s[64:67], s89 offen offset:1024 lds
    ds_read_b128 a[92:95], v60 offset:37888
    v_fma_f32 v44, v40, v40, -v44
    v_mul_f32 v45, v40, v41
    v_fma_f32 v41, v41, v40, v45
    v_mfma_f32_32x32x16_bf16 v[96:111], a[32:35], a[68:71], v[96:111]
    buffer_store_dwordx4 a[128:131], v1, s[68:71], s45 offen offset:0 sc1
    v_mfma_f32_32x32x16_bf16 v[112:127], a[36:39], a[68:71], v[112:127]
    ds_read_b128 a[96:99], v60 offset:35840
    ds_read_b128 a[100:103], v60 offset:38912
    v_mov_b32 v40, v44
    v_lshlrev_b32 v24, 16, v24
    v_mul_f32 v24, s96, v24
    v_mfma_f32_32x32x16_bf16 v[128:143], a[32:35], a[72:75], v[128:143]
    buffer_load_dwordx4 v58, s[64:67], s89 offen offset:2048 lds
    ds_read_b128 a[104:107], v60 offset:36864
    v_exp_f32 v24, v24
    v_lshlrev_b32 v18, 16, v18
    v_mfma_f32_32x32x16_bf16 v[144:159], a[36:39], a[72:75], v[144:159]
    ds_read_b128 a[108:111], v60 offset:39936
    v_lshlrev_b32 v19, 16, v19
    v_cvt_pk_bf16_f32 v24, v24, v24
    v_lshlrev_b32 v24, 16, v24
    s_waitcnt lgkmcnt(6)
    v_mfma_f32_32x32x16_bf16 v[160:175], a[32:35], a[76:79], v[160:175]
    v_mul_f32 v44, v24, v18
    v_mul_f32 v45, v24, v19
    v_mul_f32 v44, s96, v44
    v_mul_f32 v45, s97, v45
    v_exp_f32 v44, v44
    v_mfma_f32_32x32x16_bf16 v[176:191], a[36:39], a[76:79], v[176:191]
    s_add_u32 m0, s52, 8192
    s_add_u32 s53, s81, 0
    buffer_load_dwordx4 v2, s[56:59], s53 offen offset:0 lds
    v_rndne_f32 v46, v45
    v_sub_f32 v45, v45, v46
    v_mfma_f32_32x32x16_bf16 v[192:207], a[32:35], a[80:83], v[192:207]
    v_cos_f32 v46, v45
    v_sin_f32 v47, v45
    v_mul_f32 v48, v18, v18
    v_mul_f32 v30, v44, v46
    v_mfma_f32_32x32x16_bf16 v[208:223], a[36:39], a[80:83], v[208:223]
    v_mul_f32 v31, v44, v47
    v_mov_b32 v18, v30
    v_mov_b32 v19, v31
    v_mul_f32 v44, v31, v31
    v_fma_f32 v44, v30, v30, -v44
    v_mfma_f32_32x32x16_bf16 v[224:239], a[32:35], a[84:87], v[224:239]
    buffer_load_dwordx4 v3, s[56:59], s53 offen offset:1024 lds
    v_mul_f32 v45, v30, v31
    v_fma_f32 v31, v31, v30, v45
    v_mov_b32 v30, v44
    v_mul_f32 v44, v31, v31
    v_mfma_f32_32x32x16_bf16 v[240:255], a[36:39], a[84:87], v[240:255]
    v_fma_f32 v44, v30, v30, -v44
    v_mul_f32 v45, v30, v31
    v_fma_f32 v31, v31, v30, v45
    v_mov_b32 v30, v44
    s_waitcnt lgkmcnt(3)
    v_mfma_f32_32x32x16_bf16 v[64:79], a[40:43], a[88:91], v[64:79]
    ds_read_b128 a[64:67], v61 offset:34816
    v_mul_f32 v44, v31, v31
    v_fma_f32 v44, v30, v30, -v44
    v_mul_f32 v45, v30, v31
    v_fma_f32 v31, v31, v30, v45
    v_mfma_f32_32x32x16_bf16 v[80:95], a[44:47], a[88:91], v[80:95]
    buffer_load_dwordx4 v4, s[56:59], s53 offen offset:2048 lds
    ds_read_b128 a[68:71], v61 offset:37888
    v_mov_b32 v30, v44
    v_mul_f32 v44, v31, v31
    v_fma_f32 v44, v30, v30, -v44
    v_mfma_f32_32x32x16_bf16 v[96:111], a[40:43], a[92:95], v[96:111]
    ds_read_b128 a[72:75], v61 offset:35840
    v_mul_f32 v45, v30, v31
    v_fma_f32 v31, v31, v30, v45
    v_mov_b32 v30, v44
    v_mul_f32 v44, v31, v31
    v_mfma_f32_32x32x16_bf16 v[112:127], a[44:47], a[92:95], v[112:127]
    buffer_store_dwordx4 a[128:131], v1, s[68:71], s45 offen offset:1024 sc1
    v_mfma_f32_32x32x16_bf16 v[128:143], a[40:43], a[96:99], v[128:143]
    buffer_load_dwordx4 v5, s[56:59], s53 offen offset:3072 lds
    ds_read_b128 a[76:79], v61 offset:38912
    ds_read_b128 a[80:83], v61 offset:36864
    v_fma_f32 v44, v30, v30, -v44
    v_mul_f32 v45, v30, v31
    v_mfma_f32_32x32x16_bf16 v[144:159], a[44:47], a[96:99], v[144:159]
    ds_read_b128 a[84:87], v61 offset:39936
    v_fma_f32 v37, v31, v30, v45
    v_mov_b32 v36, v44
    v_cndmask_b32 v24, 1.0, v36, s[42:43]
    s_waitcnt lgkmcnt(6)
    v_mfma_f32_32x32x16_bf16 v[160:175], a[40:43], a[100:103], v[160:175]
    v_cndmask_b32 v25, 0, v37, s[42:43]
    v_mul_f32 v44, v37, v37
    v_fma_f32 v44, v36, v36, -v44
    v_mul_f32 v45, v36, v37
    v_fma_f32 v43, v37, v36, v45
    v_mfma_f32_32x32x16_bf16 v[176:191], a[44:47], a[100:103], v[176:191]
    s_add_u32 m0, s52, 12288
    s_add_u32 s53, s81, 9216
    buffer_load_dwordx4 v2, s[56:59], s53 offen offset:0 lds
    v_mov_b32 v42, v44
    v_cndmask_b32 v46, 1.0, v42, s[26:27]
    v_mfma_f32_32x32x16_bf16 v[192:207], a[40:43], a[104:107], v[192:207]
    v_cndmask_b32 v47, 0, v43, s[26:27]
    v_mul_f32 v44, v25, v47
    v_fma_f32 v44, v24, v46, -v44
    v_mul_f32 v45, v24, v47
    v_fma_f32 v25, v25, v46, v45
    v_mfma_f32_32x32x16_bf16 v[208:223], a[44:47], a[104:107], v[208:223]
    v_mov_b32 v24, v44
    v_mul_f32 v44, v43, v43
    v_fma_f32 v44, v42, v42, -v44
    v_mul_f32 v45, v42, v43
    v_fma_f32 v43, v43, v42, v45
    v_mfma_f32_32x32x16_bf16 v[224:239], a[40:43], a[108:111], v[224:239]
    buffer_load_dwordx4 v3, s[56:59], s53 offen offset:1024 lds
    v_mov_b32 v42, v44
    v_cndmask_b32 v46, 1.0, v42, s[28:29]
    v_cndmask_b32 v47, 0, v43, s[28:29]
    v_mul_f32 v44, v25, v47
    v_mfma_f32_32x32x16_bf16 v[240:255], a[44:47], a[108:111], v[240:255]
    v_fma_f32 v44, v24, v46, -v44
    v_mul_f32 v45, v24, v47
    v_fma_f32 v25, v25, v46, v45
    v_mov_b32 v24, v44
    s_waitcnt lgkmcnt(3)
    v_mfma_f32_32x32x16_bf16 v[64:79], a[48:51], a[64:67], v[64:79]
    s_waitcnt vmcnt(14)
    ds_read_b128 a[88:91], v62 offset:34816
    ds_read_b128 a[0:3], v6 offset:0
    v_mul_f32 v44, v43, v43
    v_fma_f32 v44, v42, v42, -v44
    v_mfma_f32_32x32x16_bf16 v[80:95], a[52:55], a[64:67], v[80:95]
    buffer_load_dwordx4 v4, s[56:59], s53 offen offset:2048 lds
    ds_read_b128 a[92:95], v62 offset:37888
    ds_read_b128 a[4:7], v6 offset:4096
    v_mul_f32 v45, v42, v43
    v_fma_f32 v43, v43, v42, v45
    v_mfma_f32_32x32x16_bf16 v[96:111], a[48:51], a[68:71], v[96:111]
    ds_read_b128 a[96:99], v62 offset:35840
    ds_read_b128 a[8:11], v7 offset:0
    v_mov_b32 v42, v44
    v_and_b32 v10, 15, v0
    v_bfe_u32 v11, v0, 4, 1
    v_mfma_f32_32x32x16_bf16 v[112:127], a[52:55], a[68:71], v[112:127]
    ds_read_b128 a[100:103], v62 offset:38912
    ds_read_b128 a[12:15], v7 offset:4096
    v_lshlrev_b32 v11, 3, v11
    v_sub_u32 v11, v10, v11
    v_lshrrev_b32 v11, 1, v11
    v_mfma_f32_32x32x16_bf16 v[128:143], a[48:51], a[72:75], v[128:143]
    buffer_load_dwordx4 v5, s[56:59], s53 offen offset:3072 lds
    ds_read_b128 a[104:107], v62 offset:36864
    ds_read_b128 a[16:19], v8 offset:0
    v_lshrrev_b32 v10, 5, v0
    v_lshl_add_u32 v11, v10, 3, v11
    v_mfma_f32_32x32x16_bf16 v[144:159], a[52:55], a[72:75], v[144:159]
    ds_read_b128 a[108:111], v62 offset:39936
    ds_read_b128 a[20:23], v8 offset:4096
    v_and_b32 v10, 1, v0
    v_lshlrev_b32 v10, 4, v10
    s_waitcnt lgkmcnt(12)
    v_mfma_f32_32x32x16_bf16 v[160:175], a[48:51], a[76:79], v[160:175]
    buffer_store_dwordx4 a[128:131], v1, s[68:71], s45 offen offset:2048 sc1
    v_mfma_f32_32x32x16_bf16 v[176:191], a[52:55], a[76:79], v[176:191]
    s_add_u32 m0, s52, 22528
    s_nop 0
    buffer_load_dwordx4 v56, s[60:63], s90 offen offset:0 lds
    ds_read_b128 a[24:27], v9 offset:0
    v_accvgpr_read_b32 v44, a112
    v_mfma_f32_32x32x16_bf16 v[192:207], a[48:51], a[80:83], v[192:207]
    ds_read_b128 a[28:31], v9 offset:4096
    v_accvgpr_read_b32 v45, a113
    v_accvgpr_read_b32 v46, a114
    v_accvgpr_read_b32 v47, a115
    v_accvgpr_read_b32 v48, a116
    v_mfma_f32_32x32x16_bf16 v[208:223], a[52:55], a[80:83], v[208:223]
    v_accvgpr_read_b32 v49, a117
    v_cmp_eq_u32 s[26:27], 0, v11
    v_lshlrev_b32 v44, v10, v44
    v_lshlrev_b32 v45, v10, v45
    v_lshlrev_b32 v46, v10, v46
    v_mfma_f32_32x32x16_bf16 v[224:239], a[48:51], a[84:87], v[224:239]
    buffer_load_dwordx4 v57, s[60:63], s90 offen offset:1024 lds
    v_lshlrev_b32 v47, v10, v47
    v_lshlrev_b32 v48, v10, v48
    v_lshlrev_b32 v49, v10, v49
    v_cndmask_b32 v50, 0, v44, s[26:27]
    v_mfma_f32_32x32x16_bf16 v[240:255], a[52:55], a[84:87], v[240:255]
    v_cndmask_b32 v51, 0, v45, s[26:27]
    v_cndmask_b32 v52, 0, v46, s[26:27]
    v_cndmask_b32 v53, 0, v47, s[26:27]
    v_cndmask_b32 v54, 0, v48, s[26:27]
    s_waitcnt lgkmcnt(9)
    v_mfma_f32_32x32x16_bf16 v[64:79], a[56:59], a[88:91], v[64:79]
    s_waitcnt vmcnt(12)
    s_barrier
    ds_read_b128 a[64:67], v59 offset:16384
    v_cndmask_b32 v55, 0, v49, s[26:27]
    v_mfma_f32_32x32x16_bf16 v[80:95], a[60:63], a[88:91], v[80:95]
    buffer_load_dwordx4 v58, s[60:63], s90 offen offset:2048 lds
    ds_read_b128 a[68:71], v59 offset:19456
    v_cmp_eq_u32 s[26:27], 1, v11
    v_accvgpr_write_b32 a160, v50
    v_accvgpr_write_b32 a168, v51
    v_mfma_f32_32x32x16_bf16 v[96:111], a[56:59], a[92:95], v[96:111]
    ds_read_b128 a[72:75], v59 offset:17408
    v_accvgpr_write_b32 a176, v52
    v_accvgpr_write_b32 a184, v53
    v_accvgpr_write_b32 a192, v54
    v_accvgpr_write_b32 a200, v55
    v_mfma_f32_32x32x16_bf16 v[112:127], a[60:63], a[92:95], v[112:127]
    ds_read_b128 a[76:79], v59 offset:20480
    v_cndmask_b32 v50, 0, v44, s[26:27]
    v_cndmask_b32 v51, 0, v45, s[26:27]
    v_cndmask_b32 v52, 0, v46, s[26:27]
    v_cndmask_b32 v53, 0, v47, s[26:27]
    v_mfma_f32_32x32x16_bf16 v[128:143], a[56:59], a[96:99], v[128:143]
    s_add_u32 m0, s52, 25600
    s_nop 0
    buffer_load_dwordx4 v56, s[64:67], s90 offen offset:0 lds
    ds_read_b128 a[80:83], v59 offset:18432
    v_cndmask_b32 v54, 0, v48, s[26:27]
    v_mfma_f32_32x32x16_bf16 v[144:159], a[60:63], a[96:99], v[144:159]
    ds_read_b128 a[84:87], v59 offset:21504
    v_cndmask_b32 v55, 0, v49, s[26:27]
    v_cmp_eq_u32 s[26:27], 2, v11
    v_accvgpr_write_b32 a161, v50
    s_waitcnt lgkmcnt(9)
    v_mfma_f32_32x32x16_bf16 v[160:175], a[56:59], a[100:103], v[160:175]
    v_accvgpr_write_b32 a169, v51
    v_accvgpr_write_b32 a177, v52
    v_accvgpr_write_b32 a185, v53
    v_accvgpr_write_b32 a193, v54
    v_accvgpr_write_b32 a201, v55
    v_mfma_f32_32x32x16_bf16 v[176:191], a[60:63], a[100:103], v[176:191]
    buffer_load_dwordx4 v57, s[64:67], s90 offen offset:1024 lds
    v_cndmask_b32 v50, 0, v44, s[26:27]
    v_cndmask_b32 v51, 0, v45, s[26:27]
    v_cndmask_b32 v52, 0, v46, s[26:27]
    v_cndmask_b32 v53, 0, v47, s[26:27]
    v_mfma_f32_32x32x16_bf16 v[192:207], a[56:59], a[104:107], v[192:207]
    v_cndmask_b32 v54, 0, v48, s[26:27]
    v_cndmask_b32 v55, 0, v49, s[26:27]
    v_cmp_eq_u32 s[26:27], 3, v11
    v_accvgpr_write_b32 a162, v50
    v_accvgpr_write_b32 a170, v51
    v_mfma_f32_32x32x16_bf16 v[208:223], a[60:63], a[104:107], v[208:223]
    v_accvgpr_write_b32 a178, v52
    v_accvgpr_write_b32 a186, v53
    v_accvgpr_write_b32 a194, v54
    v_accvgpr_write_b32 a202, v55
    v_cndmask_b32 v50, 0, v44, s[26:27]
    v_mfma_f32_32x32x16_bf16 v[224:239], a[56:59], a[108:111], v[224:239]
    buffer_load_dwordx4 v58, s[64:67], s90 offen offset:2048 lds
    v_cndmask_b32 v51, 0, v45, s[26:27]
    v_cndmask_b32 v52, 0, v46, s[26:27]
    v_cndmask_b32 v53, 0, v47, s[26:27]
    v_cndmask_b32 v54, 0, v48, s[26:27]
    v_mfma_f32_32x32x16_bf16 v[240:255], a[60:63], a[108:111], v[240:255]
    v_cndmask_b32 v55, 0, v49, s[26:27]
    v_cmp_eq_u32 s[26:27], 8, v11
    v_accvgpr_write_b32 a163, v50
    v_accvgpr_write_b32 a171, v51
    s_waitcnt lgkmcnt(6)
    v_and_b32 v13, 60, v0
    v_mov_b32 v12, -1
    s_cmp_eq_u32 s50, 0
    s_cselect_b64 exec, -1, 0
    global_load_dword v12, v13, s[46:47] offset:128 sc1
    s_mov_b64 exec, -1
    s_waitcnt lgkmcnt(3)
    v_mfma_f32_32x32x16_bf16 v[64:79], a[0:3], a[64:67], v[64:79]
    ds_read_b128 a[88:91], v60 offset:16384
    s_add_u32 s45, s44, 98304
    v_accvgpr_write_b32 a179, v52
    v_accvgpr_write_b32 a187, v53
    v_accvgpr_write_b32 a195, v54
    v_mfma_f32_32x32x16_bf16 v[80:95], a[4:7], a[64:67], v[80:95]
    s_add_u32 m0, s52, 0
    s_add_u32 s53, s82, 0
    buffer_load_dwordx4 v2, s[56:59], s53 offen offset:0 lds
    ds_read_b128 a[92:95], v60 offset:19456
    v_accvgpr_write_b32 a203, v55
    v_mfma_f32_32x32x16_bf16 v[96:111], a[0:3], a[68:71], v[96:111]
    buffer_store_dwordx4 a[128:131], v1, s[68:71], s45 offen offset:0 sc1
    v_mfma_f32_32x32x16_bf16 v[112:127], a[4:7], a[68:71], v[112:127]
    ds_read_b128 a[96:99], v60 offset:17408
    ds_read_b128 a[100:103], v60 offset:20480
    v_cndmask_b32 v50, 0, v44, s[26:27]
    v_cndmask_b32 v51, 0, v45, s[26:27]
    v_cndmask_b32 v52, 0, v46, s[26:27]
    v_mfma_f32_32x32x16_bf16 v[128:143], a[0:3], a[72:75], v[128:143]
    buffer_load_dwordx4 v3, s[56:59], s53 offen offset:1024 lds
    ds_read_b128 a[104:107], v60 offset:18432
    v_cndmask_b32 v53, 0, v47, s[26:27]
    v_cndmask_b32 v54, 0, v48, s[26:27]
    v_cndmask_b32 v55, 0, v49, s[26:27]
    v_mfma_f32_32x32x16_bf16 v[144:159], a[4:7], a[72:75], v[144:159]
    ds_read_b128 a[108:111], v60 offset:21504
    v_cmp_eq_u32 s[26:27], 9, v11
    v_accvgpr_write_b32 a164, v50
    v_accvgpr_write_b32 a172, v51
    s_waitcnt lgkmcnt(6)
    v_mfma_f32_32x32x16_bf16 v[160:175], a[0:3], a[76:79], v[160:175]
    v_accvgpr_write_b32 a180, v52
    v_accvgpr_write_b32 a188, v53
    v_accvgpr_write_b32 a196, v54
    v_accvgpr_write_b32 a204, v55
    v_cndmask_b32 v50, 0, v44, s[26:27]
    v_mfma_f32_32x32x16_bf16 v[176:191], a[4:7], a[76:79], v[176:191]
    buffer_load_dwordx4 v4, s[56:59], s53 offen offset:2048 lds
    v_cndmask_b32 v51, 0, v45, s[26:27]
    v_cndmask_b32 v52, 0, v46, s[26:27]
    v_cndmask_b32 v53, 0, v47, s[26:27]
    v_cndmask_b32 v54, 0, v48, s[26:27]
    v_mfma_f32_32x32x16_bf16 v[192:207], a[0:3], a[80:83], v[192:207]
    v_cndmask_b32 v55, 0, v49, s[26:27]
    v_cmp_eq_u32 s[26:27], 10, v11
    v_accvgpr_write_b32 a165, v50
    v_accvgpr_write_b32 a173, v51
    v_accvgpr_write_b32 a181, v52
    v_mfma_f32_32x32x16_bf16 v[208:223], a[4:7], a[80:83], v[208:223]
    v_accvgpr_write_b32 a189, v53
    v_accvgpr_write_b32 a197, v54
    v_accvgpr_write_b32 a205, v55
    v_cndmask_b32 v50, 0, v44, s[26:27]
    v_cndmask_b32 v51, 0, v45, s[26:27]
    v_mfma_f32_32x32x16_bf16 v[224:239], a[0:3], a[84:87], v[224:239]
    buffer_load_dwordx4 v5, s[56:59], s53 offen offset:3072 lds
    v_cndmask_b32 v52, 0, v46, s[26:27]
    v_cndmask_b32 v53, 0, v47, s[26:27]
    v_cndmask_b32 v54, 0, v48, s[26:27]
    v_cndmask_b32 v55, 0, v49, s[26:27]
    v_mfma_f32_32x32x16_bf16 v[240:255], a[4:7], a[84:87], v[240:255]
    v_cmp_eq_u32 s[26:27], 11, v11
    v_accvgpr_write_b32 a166, v50
    v_accvgpr_write_b32 a174, v51
    v_accvgpr_write_b32 a182, v52
    s_waitcnt lgkmcnt(3)
    v_mfma_f32_32x32x16_bf16 v[64:79], a[8:11], a[88:91], v[64:79]
    ds_read_b128 a[64:67], v61 offset:16384
    v_accvgpr_write_b32 a190, v53
    v_accvgpr_write_b32 a198, v54
    v_accvgpr_write_b32 a206, v55
    v_cndmask_b32 v50, 0, v44, s[26:27]
    v_mfma_f32_32x32x16_bf16 v[80:95], a[12:15], a[88:91], v[80:95]
    s_add_u32 m0, s52, 4096
    s_add_u32 s53, s82, 9216
    buffer_load_dwordx4 v2, s[56:59], s53 offen offset:0 lds
    ds_read_b128 a[68:71], v61 offset:19456
    v_cndmask_b32 v51, 0, v45, s[26:27]
    v_mfma_f32_32x32x16_bf16 v[96:111], a[8:11], a[92:95], v[96:111]
    ds_read_b128 a[72:75], v61 offset:17408
    v_cndmask_b32 v52, 0, v46, s[26:27]
    v_cndmask_b32 v53, 0, v47, s[26:27]
    v_cndmask_b32 v54, 0, v48, s[26:27]
    v_cndmask_b32 v55, 0, v49, s[26:27]
    v_mfma_f32_32x32x16_bf16 v[112:127], a[12:15], a[92:95], v[112:127]
    buffer_store_dwordx4 a[128:131], v1, s[68:71], s45 offen offset:1024 sc1
    v_mfma_f32_32x32x16_bf16 v[128:143], a[8:11], a[96:99], v[128:143]
    buffer_load_dwordx4 v3, s[56:59], s53 offen offset:1024 lds
    ds_read_b128 a[76:79], v61 offset:20480
    ds_read_b128 a[80:83], v61 offset:18432
    v_accvgpr_write_b32 a167, v50
    v_accvgpr_write_b32 a175, v51
    v_mfma_f32_32x32x16_bf16 v[144:159], a[12:15], a[96:99], v[144:159]
    ds_read_b128 a[84:87], v61 offset:21504
    v_accvgpr_write_b32 a183, v52
    v_accvgpr_write_b32 a191, v53
    v_accvgpr_write_b32 a199, v54
    s_waitcnt lgkmcnt(6)
    v_mfma_f32_32x32x16_bf16 v[160:175], a[8:11], a[100:103], v[160:175]
    v_accvgpr_write_b32 a207, v55
    v_lshrrev_b32 v44, 3, v0
    v_mul_u32_u24 v44, 1152, v44
    v_and_b32 v45, 7, v0
    v_lshrrev_b32 v46, 4, v0
    v_mfma_f32_32x32x16_bf16 v[176:191], a[12:15], a[100:103], v[176:191]
    buffer_load_dwordx4 v4, s[56:59], s53 offen offset:2048 lds
    v_xor_b32 v45, v45, v46
    v_lshl_add_u32 v44, v45, 4, v44
    v_xor_b32 v45, 64, v44
    v_and_b32 v47, 15, v0
    v_mfma_f32_32x32x16_bf16 v[192:207], a[8:11], a[104:107], v[192:207]
    v_lshl_add_u32 v47, v47, 7, s52
    v_bfe_u32 v48, v0, 1, 3
    v_xor_b32 v46, v46, v48
    v_lshl_add_u32 v46, v46, 4, v47
    v_xor_b32 v47, 64, v46
    v_mfma_f32_32x32x16_bf16 v[208:223], a[12:15], a[104:107], v[208:223]
    v_mfma_f32_32x32x16_bf16 v[224:239], a[8:11], a[108:111], v[224:239]
    buffer_load_dwordx4 v5, s[56:59], s53 offen offset:3072 lds
    v_mfma_f32_32x32x16_bf16 v[240:255], a[12:15], a[108:111], v[240:255]
    s_waitcnt lgkmcnt(3)
    v_mfma_f32_32x32x16_bf16 v[64:79], a[16:19], a[64:67], v[64:79]
    s_waitcnt vmcnt(18)
    ds_read_b128 a[88:91], v62 offset:16384
    ds_read_b128 a[32:35], v6 offset:8192
    v_mfma_f32_32x32x16_bf16 v[80:95], a[20:23], a[64:67], v[80:95]
    s_add_u32 m0, s52, 28672
    s_nop 0
    buffer_load_dwordx4 v56, s[60:63], s91 offen offset:0 lds
    ds_read_b128 a[92:95], v62 offset:19456
    ds_read_b128 a[36:39], v6 offset:12288
    v_mfma_f32_32x32x16_bf16 v[96:111], a[16:19], a[68:71], v[96:111]
    ds_read_b128 a[96:99], v62 offset:17408
    ds_read_b128 a[40:43], v7 offset:8192
    v_mfma_f32_32x32x16_bf16 v[112:127], a[20:23], a[68:71], v[112:127]
    ds_read_b128 a[100:103], v62 offset:20480
    ds_read_b128 a[44:47], v7 offset:12288
    v_mfma_f32_32x32x16_bf16 v[128:143], a[16:19], a[72:75], v[128:143]
    buffer_load_dwordx4 v57, s[60:63], s91 offen offset:1024 lds
    ds_read_b128 a[104:107], v62 offset:18432
    ds_read_b128 a[48:51], v8 offset:8192
    v_mfma_f32_32x32x16_bf16 v[144:159], a[20:23], a[72:75], v[144:159]
    ds_read_b128 a[108:111], v62 offset:21504
    ds_read_b128 a[52:55], v8 offset:12288
    s_waitcnt lgkmcnt(12)
    v_mfma_f32_32x32x16_bf16 v[160:175], a[16:19], a[76:79], v[160:175]
    buffer_store_dwordx4 a[128:131], v1, s[68:71], s45 offen offset:2048 sc1
    v_mfma_f32_32x32x16_bf16 v[176:191], a[20:23], a[76:79], v[176:191]
    buffer_load_dwordx4 v58, s[60:63], s91 offen offset:2048 lds
    ds_read_b128 a[56:59], v9 offset:8192
    v_mfma_f32_32x32x16_bf16 v[192:207], a[16:19], a[80:83], v[192:207]
    ds_read_b128 a[60:63], v9 offset:12288
    v_mfma_f32_32x32x16_bf16 v[208:223], a[20:23], a[80:83], v[208:223]
    v_mfma_f32_32x32x16_bf16 v[224:239], a[16:19], a[84:87], v[224:239]
    s_add_u32 m0, s52, 31744
    s_nop 0
    buffer_load_dwordx4 v56, s[64:67], s91 offen offset:0 lds
    v_mfma_f32_32x32x16_bf16 v[240:255], a[20:23], a[84:87], v[240:255]
    s_waitcnt lgkmcnt(9)
    s_branch L_sskip14
L_stub14:
    s_setpc_b64 s[100:101]
L_sskip14:
    v_mfma_f32_32x32x16_bf16 v[64:79], a[24:27], a[88:91], v[64:79]
    s_waitcnt vmcnt(16)
    s_barrier
    ds_read_b128 a[64:67], v59 offset:22528
    v_mfma_f32_32x32x16_bf16 v[80:95], a[28:31], a[88:91], v[80:95]
    buffer_load_dwordx4 v57, s[64:67], s91 offen offset:1024 lds
    ds_read_b128 a[68:71], v59 offset:25600
    v_mfma_f32_32x32x16_bf16 v[96:111], a[24:27], a[92:95], v[96:111]
    ds_read_b128 a[72:75], v59 offset:23552
    v_mfma_f32_32x32x16_bf16 v[112:127], a[28:31], a[92:95], v[112:127]
    ds_read_b128 a[76:79], v59 offset:26624
    v_mfma_f32_32x32x16_bf16 v[128:143], a[24:27], a[96:99], v[128:143]
    buffer_load_dwordx4 v58, s[64:67], s91 offen offset:2048 lds
    ds_read_b128 a[80:83], v59 offset:24576
    v_mfma_f32_32x32x16_bf16 v[144:159], a[28:31], a[96:99], v[144:159]
    ds_read_b128 a[84:87], v59 offset:27648
    s_waitcnt lgkmcnt(9)
    v_mfma_f32_32x32x16_bf16 v[160:175], a[24:27], a[100:103], v[160:175]
    v_mfma_f32_32x32x16_bf16 v[176:191], a[28:31], a[100:103], v[176:191]
    v_mfma_f32_32x32x16_bf16 v[192:207], a[24:27], a[104:107], v[192:207]
    v_mfma_f32_32x32x16_bf16 v[208:223], a[28:31], a[104:107], v[208:223]
    v_mfma_f32_32x32x16_bf16 v[224:239], a[24:27], a[108:111], v[224:239]
    v_mfma_f32_32x32x16_bf16 v[240:255], a[28:31], a[108:111], v[240:255]
    s_waitcnt lgkmcnt(6)
    s_waitcnt lgkmcnt(3)
    v_mfma_f32_32x32x16_bf16 v[64:79], a[32:35], a[64:67], v[64:79]
    ds_read_b128 a[88:91], v60 offset:22528
    v_mfma_f32_32x32x16_bf16 v[80:95], a[36:39], a[64:67], v[80:95]
    s_add_u32 m0, s52, 8192
    s_add_u32 s53, s83, 0
    buffer_load_dwordx4 v2, s[56:59], s53 offen offset:0 lds
    ds_read_b128 a[92:95], v60 offset:25600
    v_mfma_f32_32x32x16_bf16 v[96:111], a[32:35], a[68:71], v[96:111]
    ds_read_b128 a[96:99], v60 offset:23552
    v_mfma_f32_32x32x16_bf16 v[112:127], a[36:39], a[68:71], v[112:127]
    ds_read_b128 a[100:103], v60 offset:26624
    v_mfma_f32_32x32x16_bf16 v[128:143], a[32:35], a[72:75], v[128:143]
    buffer_load_dwordx4 v3, s[56:59], s53 offen offset:1024 lds
    ds_read_b128 a[104:107], v60 offset:24576
    v_mfma_f32_32x32x16_bf16 v[144:159], a[36:39], a[72:75], v[144:159]
    ds_read_b128 a[108:111], v60 offset:27648
    s_waitcnt lgkmcnt(6)
    v_mfma_f32_32x32x16_bf16 v[160:175], a[32:35], a[76:79], v[160:175]
    v_mfma_f32_32x32x16_bf16 v[176:191], a[36:39], a[76:79], v[176:191]
    buffer_load_dwordx4 v4, s[56:59], s53 offen offset:2048 lds
    v_mfma_f32_32x32x16_bf16 v[192:207], a[32:35], a[80:83], v[192:207]
    v_mfma_f32_32x32x16_bf16 v[208:223], a[36:39], a[80:83], v[208:223]
    v_mfma_f32_32x32x16_bf16 v[224:239], a[32:35], a[84:87], v[224:239]
    buffer_load_dwordx4 v5, s[56:59], s53 offen offset:3072 lds
    v_mfma_f32_32x32x16_bf16 v[240:255], a[36:39], a[84:87], v[240:255]
    s_waitcnt lgkmcnt(3)
    v_mfma_f32_32x32x16_bf16 v[64:79], a[40:43], a[88:91], v[64:79]
    ds_read_b128 a[64:67], v61 offset:22528
    v_mfma_f32_32x32x16_bf16 v[80:95], a[44:47], a[88:91], v[80:95]
    s_add_u32 m0, s52, 12288
    s_add_u32 s53, s83, 9216
    buffer_load_dwordx4 v2, s[56:59], s53 offen offset:0 lds
    ds_read_b128 a[68:71], v61 offset:25600
    v_mfma_f32_32x32x16_bf16 v[96:111], a[40:43], a[92:95], v[96:111]
    ds_read_b128 a[72:75], v61 offset:23552
    v_mfma_f32_32x32x16_bf16 v[112:127], a[44:47], a[92:95], v[112:127]
    ds_read_b128 a[76:79], v61 offset:26624
    v_mfma_f32_32x32x16_bf16 v[128:143], a[40:43], a[96:99], v[128:143]
    buffer_load_dwordx4 v3, s[56:59], s53 offen offset:1024 lds
    ds_read_b128 a[80:83], v61 offset:24576
    v_mfma_f32_32x32x16_bf16 v[144:159], a[44:47], a[96:99], v[144:159]
    ds_read_b128 a[84:87], v61 offset:27648
    s_waitcnt lgkmcnt(6)
    v_mfma_f32_32x32x16_bf16 v[160:175], a[40:43], a[100:103], v[160:175]
    v_mfma_f32_32x32x16_bf16 v[176:191], a[44:47], a[100:103], v[176:191]
    buffer_load_dwordx4 v4, s[56:59], s53 offen offset:2048 lds
    v_mfma_f32_32x32x16_bf16 v[192:207], a[40:43], a[104:107], v[192:207]
    v_mfma_f32_32x32x16_bf16 v[208:223], a[44:47], a[104:107], v[208:223]
    v_mfma_f32_32x32x16_bf16 v[224:239], a[40:43], a[108:111], v[224:239]
    buffer_load_dwordx4 v5, s[56:59], s53 offen offset:3072 lds
    v_mfma_f32_32x32x16_bf16 v[240:255], a[44:47], a[108:111], v[240:255]
    s_waitcnt lgkmcnt(3)
    v_mfma_f32_32x32x16_bf16 v[64:79], a[48:51], a[64:67], v[64:79]
    s_waitcnt vmcnt(15)
    ds_read_b128 a[88:91], v62 offset:22528
    ds_read_b128 a[0:3], v6 offset:0
    v_mfma_f32_32x32x16_bf16 v[80:95], a[52:55], a[64:67], v[80:95]
    s_add_u32 m0, s52, 34816
    s_nop 0
    buffer_load_dwordx4 v56, s[60:63], s92 offen offset:0 lds
    ds_read_b128 a[92:95], v62 offset:25600
    ds_read_b128 a[4:7], v6 offset:4096
    v_mfma_f32_32x32x16_bf16 v[96:111], a[48:51], a[68:71], v[96:111]
    ds_read_b128 a[96:99], v62 offset:23552
    ds_read_b128 a[8:11], v7 offset:0
    v_mfma_f32_32x32x16_bf16 v[112:127], a[52:55], a[68:71], v[112:127]
    ds_read_b128 a[100:103], v62 offset:26624
    ds_read_b128 a[12:15], v7 offset:4096
    v_mfma_f32_32x32x16_bf16 v[128:143], a[48:51], a[72:75], v[128:143]
    buffer_load_dwordx4 v57, s[60:63], s92 offen offset:1024 lds
    ds_read_b128 a[104:107], v62 offset:24576
    ds_read_b128 a[16:19], v8 offset:0
    v_mfma_f32_32x32x16_bf16 v[144:159], a[52:55], a[72:75], v[144:159]
    ds_read_b128 a[108:111], v62 offset:27648
    ds_read_b128 a[20:23], v8 offset:4096
    s_waitcnt lgkmcnt(12)
    v_mfma_f32_32x32x16_bf16 v[160:175], a[48:51], a[76:79], v[160:175]
    ds_read_b128 a[24:27], v9 offset:0
    v_mfma_f32_32x32x16_bf16 v[176:191], a[52:55], a[76:79], v[176:191]
    buffer_load_dwordx4 v58, s[60:63], s92 offen offset:2048 lds
    ds_read_b128 a[28:31], v9 offset:4096
    v_mfma_f32_32x32x16_bf16 v[192:207], a[48:51], a[80:83], v[192:207]
    v_mfma_f32_32x32x16_bf16 v[208:223], a[52:55], a[80:83], v[208:223]
    v_mfma_f32_32x32x16_bf16 v[224:239], a[48:51], a[84:87], v[224:239]
    s_add_u32 m0, s52, 37888
    s_nop 0
    buffer_load_dwordx4 v56, s[64:67], s92 offen offset:0 lds
    v_mfma_f32_32x32x16_bf16 v[240:255], a[52:55], a[84:87], v[240:255]
    s_waitcnt lgkmcnt(9)
    v_mfma_f32_32x32x16_bf16 v[64:79], a[56:59], a[88:91], v[64:79]
    s_waitcnt vmcnt(12)
    s_barrier
    ds_read_b128 a[64:67], v59 offset:28672
    v_mfma_f32_32x32x16_bf16 v[80:95], a[60:63], a[88:91], v[80:95]
    buffer_load_dwordx4 v57, s[64:67], s92 offen offset:1024 lds
    ds_read_b128 a[68:71], v59 offset:31744
    v_mfma_f32_32x32x16_bf16 v[96:111], a[56:59], a[92:95], v[96:111]
    ds_read_b128 a[72:75], v59 offset:29696
    v_mfma_f32_32x32x16_bf16 v[112:127], a[60:63], a[92:95], v[112:127]
    ds_read_b128 a[76:79], v59 offset:32768
    v_mfma_f32_32x32x16_bf16 v[128:143], a[56:59], a[96:99], v[128:143]
    buffer_load_dwordx4 v58, s[64:67], s92 offen offset:2048 lds
    ds_read_b128 a[80:83], v59 offset:30720
    v_mfma_f32_32x32x16_bf16 v[144:159], a[60:63], a[96:99], v[144:159]
    ds_read_b128 a[84:87], v59 offset:33792
    s_waitcnt lgkmcnt(9)
    v_mfma_f32_32x32x16_bf16 v[160:175], a[56:59], a[100:103], v[160:175]
    v_mfma_f32_32x32x16_bf16 v[176:191], a[60:63], a[100:103], v[176:191]
    v_mfma_f32_32x32x16_bf16 v[192:207], a[56:59], a[104:107], v[192:207]
    v_mfma_f32_32x32x16_bf16 v[208:223], a[60:63], a[104:107], v[208:223]
    v_mfma_f32_32x32x16_bf16 v[224:239], a[56:59], a[108:111], v[224:239]
    v_mfma_f32_32x32x16_bf16 v[240:255], a[60:63], a[108:111], v[240:255]
    s_waitcnt lgkmcnt(6)
    s_waitcnt lgkmcnt(3)
    v_mfma_f32_32x32x16_bf16 v[64:79], a[0:3], a[64:67], v[64:79]
    ds_read_b128 a[88:91], v60 offset:28672
    v_mfma_f32_32x32x16_bf16 v[80:95], a[4:7], a[64:67], v[80:95]
    s_add_u32 m0, s52, 0
    s_add_u32 s53, s84, 0
    buffer_load_dwordx4 v2, s[56:59], s53 offen offset:0 lds
    ds_read_b128 a[92:95], v60 offset:31744
    v_mfma_f32_32x32x16_bf16 v[96:111], a[0:3], a[68:71], v[96:111]
    ds_read_b128 a[96:99], v60 offset:29696
    v_mfma_f32_32x32x16_bf16 v[112:127], a[4:7], a[68:71], v[112:127]
    ds_read_b128 a[100:103], v60 offset:32768
    v_mfma_f32_32x32x16_bf16 v[128:143], a[0:3], a[72:75], v[128:143]
    buffer_load_dwordx4 v3, s[56:59], s53 offen offset:1024 lds
    ds_read_b128 a[104:107], v60 offset:30720
    v_mfma_f32_32x32x16_bf16 v[144:159], a[4:7], a[72:75], v[144:159]
    ds_read_b128 a[108:111], v60 offset:33792
    s_waitcnt lgkmcnt(6)
    v_mfma_f32_32x32x16_bf16 v[160:175], a[0:3], a[76:79], v[160:175]
    v_mfma_f32_32x32x16_bf16 v[176:191], a[4:7], a[76:79], v[176:191]
    buffer_load_dwordx4 v4, s[56:59], s53 offen offset:2048 lds
    v_mfma_f32_32x32x16_bf16 v[192:207], a[0:3], a[80:83], v[192:207]
    v_mfma_f32_32x32x16_bf16 v[208:223], a[4:7], a[80:83], v[208:223]
    v_mfma_f32_32x32x16_bf16 v[224:239], a[0:3], a[84:87], v[224:239]
    buffer_load_dwordx4 v5, s[56:59], s53 offen offset:3072 lds
    v_mfma_f32_32x32x16_bf16 v[240:255], a[4:7], a[84:87], v[240:255]
    s_waitcnt lgkmcnt(3)
    v_mfma_f32_32x32x16_bf16 v[64:79], a[8:11], a[88:91], v[64:79]
    ds_read_b128 a[64:67], v61 offset:28672
    v_mfma_f32_32x32x16_bf16 v[80:95], a[12:15], a[88:91], v[80:95]
    s_add_u32 m0, s52, 4096
    s_add_u32 s53, s84, 9216
    buffer_load_dwordx4 v2, s[56:59], s53 offen offset:0 lds
    ds_read_b128 a[68:71], v61 offset:31744
    v_mfma_f32_32x32x16_bf16 v[96:111], a[8:11], a[92:95], v[96:111]
    ds_read_b128 a[72:75], v61 offset:29696
    v_mfma_f32_32x32x16_bf16 v[112:127], a[12:15], a[92:95], v[112:127]
    ds_read_b128 a[76:79], v61 offset:32768
    v_mfma_f32_32x32x16_bf16 v[128:143], a[8:11], a[96:99], v[128:143]
    buffer_load_dwordx4 v3, s[56:59], s53 offen offset:1024 lds
    ds_read_b128 a[80:83], v61 offset:30720
    v_mfma_f32_32x32x16_bf16 v[144:159], a[12:15], a[96:99], v[144:159]
    ds_read_b128 a[84:87], v61 offset:33792
    s_waitcnt lgkmcnt(6)
    v_mfma_f32_32x32x16_bf16 v[160:175], a[8:11], a[100:103], v[160:175]
    v_mfma_f32_32x32x16_bf16 v[176:191], a[12:15], a[100:103], v[176:191]
    buffer_load_dwordx4 v4, s[56:59], s53 offen offset:2048 lds
    v_mfma_f32_32x32x16_bf16 v[192:207], a[8:11], a[104:107], v[192:207]
    v_mfma_f32_32x32x16_bf16 v[208:223], a[12:15], a[104:107], v[208:223]
    v_mfma_f32_32x32x16_bf16 v[224:239], a[8:11], a[108:111], v[224:239]
    buffer_load_dwordx4 v5, s[56:59], s53 offen offset:3072 lds
    v_mfma_f32_32x32x16_bf16 v[240:255], a[12:15], a[108:111], v[240:255]
    s_waitcnt lgkmcnt(3)
    v_mfma_f32_32x32x16_bf16 v[64:79], a[16:19], a[64:67], v[64:79]
    s_waitcnt vmcnt(14)
    ds_read_b128 a[88:91], v62 offset:28672
    ds_read_b128 a[32:35], v6 offset:8192
    v_mfma_f32_32x32x16_bf16 v[80:95], a[20:23], a[64:67], v[80:95]
    s_add_u32 m0, s52, 16384
    s_nop 0
    buffer_load_dwordx4 v56, s[60:63], s93 offen offset:0 lds
    ds_read_b128 a[92:95], v62 offset:31744
    ds_read_b128 a[36:39], v6 offset:12288
    v_mfma_f32_32x32x16_bf16 v[96:111], a[16:19], a[68:71], v[96:111]
    ds_read_b128 a[96:99], v62 offset:29696
    ds_read_b128 a[40:43], v7 offset:8192
    v_mfma_f32_32x32x16_bf16 v[112:127], a[20:23], a[68:71], v[112:127]
    ds_read_b128 a[100:103], v62 offset:32768
    ds_read_b128 a[44:47], v7 offset:12288
    v_mfma_f32_32x32x16_bf16 v[128:143], a[16:19], a[72:75], v[128:143]
    buffer_load_dwordx4 v57, s[60:63], s93 offen offset:1024 lds
    ds_read_b128 a[104:107], v62 offset:30720
    ds_read_b128 a[48:51], v8 offset:8192
    v_mfma_f32_32x32x16_bf16 v[144:159], a[20:23], a[72:75], v[144:159]
    ds_read_b128 a[108:111], v62 offset:33792
    ds_read_b128 a[52:55], v8 offset:12288
    s_waitcnt lgkmcnt(12)
    v_mfma_f32_32x32x16_bf16 v[160:175], a[16:19], a[76:79], v[160:175]
    ds_read_b128 a[56:59], v9 offset:8192
    v_mfma_f32_32x32x16_bf16 v[176:191], a[20:23], a[76:79], v[176:191]
    buffer_load_dwordx4 v58, s[60:63], s93 offen offset:2048 lds
    ds_read_b128 a[60:63], v9 offset:12288
    v_mfma_f32_32x32x16_bf16 v[192:207], a[16:19], a[80:83], v[192:207]
    v_mfma_f32_32x32x16_bf16 v[208:223], a[20:23], a[80:83], v[208:223]
    v_mfma_f32_32x32x16_bf16 v[224:239], a[16:19], a[84:87], v[224:239]
    s_add_u32 m0, s52, 19456
    s_nop 0
    buffer_load_dwordx4 v56, s[64:67], s93 offen offset:0 lds
    v_mfma_f32_32x32x16_bf16 v[240:255], a[20:23], a[84:87], v[240:255]
    s_waitcnt lgkmcnt(9)
    v_mfma_f32_32x32x16_bf16 v[64:79], a[24:27], a[88:91], v[64:79]
    s_waitcnt vmcnt(12)
    v_cmp_gt_u32 vcc, 1, v12
    s_cbranch_vccnz L_poll13
L_fok13:
    s_barrier
    ds_read_b128 a[64:67], v59 offset:34816
    v_mfma_f32_32x32x16_bf16 v[80:95], a[28:31], a[88:91], v[80:95]
    buffer_load_dwordx4 v57, s[64:67], s93 offen offset:1024 lds
    ds_read_b128 a[68:71], v59 offset:37888
    v_mfma_f32_32x32x16_bf16 v[96:111], a[24:27], a[92:95], v[96:111]
    ds_read_b128 a[72:75], v59 offset:35840
    v_mfma_f32_32x32x16_bf16 v[112:127], a[28:31], a[92:95], v[112:127]
    ds_read_b128 a[76:79], v59 offset:38912
    v_mfma_f32_32x32x16_bf16 v[128:143], a[24:27], a[96:99], v[128:143]
    buffer_load_dwordx4 v58, s[64:67], s93 offen offset:2048 lds
    ds_read_b128 a[80:83], v59 offset:36864
    v_mfma_f32_32x32x16_bf16 v[144:159], a[28:31], a[96:99], v[144:159]
    ds_read_b128 a[84:87], v59 offset:39936
    s_waitcnt lgkmcnt(9)
    v_mfma_f32_32x32x16_bf16 v[160:175], a[24:27], a[100:103], v[160:175]
    v_mfma_f32_32x32x16_bf16 v[176:191], a[28:31], a[100:103], v[176:191]
    v_mfma_f32_32x32x16_bf16 v[192:207], a[24:27], a[104:107], v[192:207]
    v_mfma_f32_32x32x16_bf16 v[208:223], a[28:31], a[104:107], v[208:223]
    v_mfma_f32_32x32x16_bf16 v[224:239], a[24:27], a[108:111], v[224:239]
    v_mfma_f32_32x32x16_bf16 v[240:255], a[28:31], a[108:111], v[240:255]
    s_waitcnt lgkmcnt(6)
    global_load_dword v10, v63, s[48:49] sc1
    s_waitcnt lgkmcnt(3)
    v_mfma_f32_32x32x16_bf16 v[64:79], a[32:35], a[64:67], v[64:79]
    ds_read_b128 a[88:91], v60 offset:34816
    s_mov_b32 s64, s40
    s_mov_b32 s65, s41
    s_mov_b32 s66, 5308416
    s_mov_b32 s67, 0x20000
    v_mfma_f32_32x32x16_bf16 v[80:95], a[36:39], a[64:67], v[80:95]
    s_add_u32 m0, s52, 8192
    s_add_u32 s92, s36, 0
    buffer_load_dwordx4 v44, s[56:59], s92 offen lds
    ds_read_b128 a[92:95], v60 offset:37888
    v_mfma_f32_32x32x16_bf16 v[96:111], a[32:35], a[68:71], v[96:111]
    ds_read_b128 a[96:99], v60 offset:35840
    s_add_u32 s60, s48, 23592960
    s_addc_u32 s61, s49, 0
    s_mov_b32 s62, 6635520
    s_mov_b32 s63, 0x20000
    v_mfma_f32_32x32x16_bf16 v[112:127], a[36:39], a[68:71], v[112:127]
    ds_read_b128 a[100:103], v60 offset:38912
    s_lshr_b32 s79, s98, 1
    s_mul_i32 s84, s79, 384
    v_lshrrev_b32 v3, 3, v0
    s_lshl_b32 s53, s50, 3
    v_mfma_f32_32x32x16_bf16 v[128:143], a[32:35], a[72:75], v[128:143]
    s_add_u32 m0, s52, 9216
    s_add_u32 s92, s36, 9216
    buffer_load_dwordx4 v45, s[56:59], s92 offen lds
    ds_read_b128 a[104:107], v60 offset:36864
    v_add_u32 v3, s53, v3
    v_mfma_f32_32x32x16_bf16 v[144:159], a[36:39], a[72:75], v[144:159]
    ds_read_b128 a[108:111], v60 offset:39936
    v_mul_u32_u24 v3, 1152, v3
    v_bfe_u32 v4, v0, 4, 1
    v_lshlrev_b32 v4, 2, v4
    s_waitcnt lgkmcnt(6)
    v_mfma_f32_32x32x16_bf16 v[160:175], a[32:35], a[76:79], v[160:175]
    s_add_u32 m0, s52, 10240
    s_add_u32 s92, s36, 18432
    buffer_load_dwordx4 v44, s[56:59], s92 offen lds
    v_and_b32 v2, 7, v0
    v_xor_b32 v4, v4, v2
    v_mfma_f32_32x32x16_bf16 v[176:191], a[36:39], a[76:79], v[176:191]
    v_lshl_add_u32 v2, v4, 4, v3
    v_and_b32 v4, 32, v0
    v_xor_b32 v2, v2, v4
    v_lshrrev_b32 v3, 5, v0
    v_mul_u32_u24 v3, 40960, v3
    v_mfma_f32_32x32x16_bf16 v[192:207], a[32:35], a[80:83], v[192:207]
    v_bfe_u32 v4, v0, 2, 3
    v_lshl_add_u32 v3, v4, 7, v3
    v_bfe_u32 v4, v0, 4, 1
    v_lshl_add_u32 v3, v4, 5, v3
    v_and_b32 v4, 3, v0
    v_mfma_f32_32x32x16_bf16 v[208:223], a[36:39], a[80:83], v[208:223]
    s_add_u32 m0, s52, 11264
    s_add_u32 s92, s36, 27648
    buffer_load_dwordx4 v45, s[56:59], s92 offen lds
    v_lshl_add_u32 v3, v4, 3, v3
    v_bfe_u32 v4, v0, 3, 1
    v_mfma_f32_32x32x16_bf16 v[224:239], a[32:35], a[84:87], v[224:239]
    v_lshl_add_u32 v5, v4, 6, v3
    s_mul_i32 s77, s79, 2211840
    s_mul_i32 s53, s50, 3072
    s_add_u32 s77, s77, s53
    s_and_b32 s55, s98, 1
    v_mfma_f32_32x32x16_bf16 v[240:255], a[36:39], a[84:87], v[240:255]
    s_add_u32 m0, s52, 12288
    s_add_u32 s92, s36, 128
    buffer_load_dwordx4 v44, s[56:59], s92 offen lds
    s_lshl_b32 s54, s99, 1
    s_waitcnt lgkmcnt(3)
    v_mfma_f32_32x32x16_bf16 v[64:79], a[40:43], a[88:91], v[64:79]
    ds_read_b128 a[64:67], v61 offset:34816
    s_add_u32 s53, s55, s54
    s_lshl_b32 s78, s53, 2
    s_add_u32 s78, s78, s50
    s_lshr_b32 s81, s78, 1
    v_mfma_f32_32x32x16_bf16 v[80:95], a[44:47], a[88:91], v[80:95]
    s_add_u32 m0, s52, 13312
    s_add_u32 s92, s36, 9344
    buffer_load_dwordx4 v45, s[56:59], s92 offen lds
    ds_read_b128 a[68:71], v61 offset:37888
    s_lshl_b32 s81, s81, 12
    v_mfma_f32_32x32x16_bf16 v[96:111], a[40:43], a[92:95], v[96:111]
    ds_read_b128 a[72:75], v61 offset:35840
    s_add_u32 s81, s81, 53837824
    s_mul_i32 s76, s78, 368640
    s_mul_i32 s80, s53, 3
    s_add_u32 s80, s80, s79
    v_mfma_f32_32x32x16_bf16 v[112:127], a[44:47], a[92:95], v[112:127]
    ds_read_b128 a[76:79], v61 offset:38912
    s_mul_i32 s85, s98, 12288
    s_add_u32 s85, s85, 294912
    s_xor_b32 s86, s98, 1
    s_mul_i32 s86, s86, 12288
    v_mfma_f32_32x32x16_bf16 v[128:143], a[40:43], a[96:99], v[128:143]
    s_add_u32 m0, s52, 14336
    s_add_u32 s92, s36, 18560
    buffer_load_dwordx4 v44, s[56:59], s92 offen lds
    ds_read_b128 a[80:83], v61 offset:36864
    s_add_u32 s86, s86, 294912
    v_mfma_f32_32x32x16_bf16 v[144:159], a[44:47], a[96:99], v[144:159]
    ds_read_b128 a[84:87], v61 offset:39936
    s_add_u32 s87, s85, 24576
    s_sub_u32 s54, s85, 49152
    s_waitcnt lgkmcnt(6)
    v_mfma_f32_32x32x16_bf16 v[160:175], a[40:43], a[100:103], v[160:175]
    s_add_u32 m0, s52, 15360
    s_add_u32 s92, s36, 27776
    buffer_load_dwordx4 v45, s[56:59], s92 offen lds
    s_cmp_ge_u32 s87, 368640
    s_cselect_b32 s87, s54, s87
    v_mfma_f32_32x32x16_bf16 v[176:191], a[44:47], a[100:103], v[176:191]
    s_add_u32 s88, s86, 24576
    s_sub_u32 s54, s86, 49152
    s_cmp_ge_u32 s88, 368640
    s_cselect_b32 s88, s54, s88
    s_add_u32 s89, s87, 24576
    v_mfma_f32_32x32x16_bf16 v[192:207], a[40:43], a[104:107], v[192:207]
    s_sub_u32 s54, s87, 49152
    s_cmp_ge_u32 s89, 368640
    s_cselect_b32 s89, s54, s89
    s_add_u32 s90, s88, 24576
    s_sub_u32 s54, s88, 49152
    v_mfma_f32_32x32x16_bf16 v[208:223], a[44:47], a[104:107], v[208:223]
    s_add_u32 m0, s52, 22528
    s_add_u32 s92, s36, 256
    buffer_load_dwordx4 v44, s[56:59], s92 offen lds
    s_cmp_ge_u32 s90, 368640
    s_cselect_b32 s90, s54, s90
    v_mfma_f32_32x32x16_bf16 v[224:239], a[40:43], a[108:111], v[224:239]
    v_and_b32 v11, 31, v0
    v_and_b32 v58, 16, v0
    v_add_u32 v58, v58, v11
    v_mul_u32_u24 v58, 144, v58
    v_lshrrev_b32 v3, 5, v0
    v_mfma_f32_32x32x16_bf16 v[240:255], a[44:47], a[108:111], v[240:255]
    s_add_u32 m0, s52, 23552
    s_add_u32 s92, s36, 9472
    buffer_load_dwordx4 v45, s[56:59], s92 offen lds
    v_lshl_add_u32 v58, v3, 6, v58
    s_waitcnt lgkmcnt(3)
    v_mfma_f32_32x32x16_bf16 v[64:79], a[48:51], a[64:67], v[64:79]
    s_waitcnt vmcnt(17)
    ds_read_b128 a[88:91], v62 offset:34816
    ds_read_b128 a[0:3], v6 offset:0
    v_add_u32 v58, s52, v58
    v_lshlrev_b32 v11, 3, v11
    v_mfma_f32_32x32x16_bf16 v[80:95], a[52:55], a[64:67], v[80:95]
    s_add_u32 m0, s52, 24576
    s_add_u32 s92, s36, 18688
    buffer_load_dwordx4 v44, s[56:59], s92 offen lds
    ds_read_b128 a[92:95], v62 offset:37888
    ds_read_b128 a[4:7], v6 offset:4096
    v_mfma_f32_32x32x16_bf16 v[96:111], a[48:51], a[68:71], v[96:111]
    ds_read_b128 a[96:99], v62 offset:35840
    ds_read_b128 a[8:11], v7 offset:0
    v_mul_u32_u24 v57, 768, v3
    v_add3_u32 v57, v57, v11, s52
    s_lshl_b32 s54, s50, 1
    v_mfma_f32_32x32x16_bf16 v[112:127], a[52:55], a[68:71], v[112:127]
    ds_read_b128 a[100:103], v62 offset:38912
    ds_read_b128 a[12:15], v7 offset:4096
    v_add_u32 v4, s54, v3
    v_add_u32 v3, 81920, v11
    s_lshl_b32 s96, s98, 3
    v_mfma_f32_32x32x16_bf16 v[128:143], a[48:51], a[72:75], v[128:143]
    s_add_u32 m0, s52, 25600
    s_add_u32 s92, s36, 27904
    buffer_load_dwordx4 v45, s[56:59], s92 offen lds
    ds_read_b128 a[104:107], v62 offset:36864
    ds_read_b128 a[16:19], v8 offset:0
    v_mfma_f32_32x32x16_bf16 v[144:159], a[52:55], a[72:75], v[144:159]
    ds_read_b128 a[108:111], v62 offset:39936
    ds_read_b128 a[20:23], v8 offset:4096
    s_add_u32 s96, s96, s99
    s_mul_i32 s96, s96, 768
    s_waitcnt lgkmcnt(12)
    v_mfma_f32_32x32x16_bf16 v[160:175], a[48:51], a[76:79], v[160:175]
    ds_read_b128 a[24:27], v9 offset:0
    s_lshl_b32 s55, s55, 1
    s_lshr_b32 s54, s50, 1
    s_add_u32 s55, s55, s54
    s_mul_i32 s97, s55, 40960
    v_mfma_f32_32x32x16_bf16 v[176:191], a[52:55], a[76:79], v[176:191]
    ds_read_b128 a[28:31], v9 offset:4096
    s_and_b32 s54, s50, 1
    s_lshl_b32 s54, s54, 6
    s_add_u32 s97, s97, s54
    v_mfma_f32_32x32x16_bf16 v[192:207], a[48:51], a[80:83], v[192:207]
    v_mfma_f32_32x32x16_bf16 v[208:223], a[52:55], a[80:83], v[208:223]
    v_mfma_f32_32x32x16_bf16 v[224:239], a[48:51], a[84:87], v[224:239]
    v_mfma_f32_32x32x16_bf16 v[240:255], a[52:55], a[84:87], v[240:255]
    s_waitcnt lgkmcnt(9)
    v_mfma_f32_32x32x16_bf16 v[64:79], a[56:59], a[88:91], v[64:79]
    s_waitcnt vmcnt(13)
    s_barrier
    ds_read_b128 a[64:67], v59 offset:16384
    v_mfma_f32_32x32x16_bf16 v[80:95], a[60:63], a[88:91], v[80:95]
    ds_read_b128 a[68:71], v59 offset:19456
    v_mfma_f32_32x32x16_bf16 v[96:111], a[56:59], a[92:95], v[96:111]
    ds_read_b128 a[72:75], v59 offset:17408
    v_mfma_f32_32x32x16_bf16 v[112:127], a[60:63], a[92:95], v[112:127]
    ds_read_b128 a[76:79], v59 offset:20480
    v_mfma_f32_32x32x16_bf16 v[128:143], a[56:59], a[96:99], v[128:143]
    ds_read_b128 a[80:83], v59 offset:18432
    v_mfma_f32_32x32x16_bf16 v[144:159], a[60:63], a[96:99], v[144:159]
    ds_read_b128 a[84:87], v59 offset:21504
    s_waitcnt lgkmcnt(9)
    v_mfma_f32_32x32x16_bf16 v[160:175], a[56:59], a[100:103], v[160:175]
    v_mfma_f32_32x32x16_bf16 v[176:191], a[60:63], a[100:103], v[176:191]
    v_mfma_f32_32x32x16_bf16 v[192:207], a[56:59], a[104:107], v[192:207]
    v_mfma_f32_32x32x16_bf16 v[208:223], a[60:63], a[104:107], v[208:223]
    v_mfma_f32_32x32x16_bf16 v[224:239], a[56:59], a[108:111], v[224:239]
    v_mfma_f32_32x32x16_bf16 v[240:255], a[60:63], a[108:111], v[240:255]
    s_waitcnt lgkmcnt(6)
    s_waitcnt vmcnt(12)
    v_cmp_gt_u32 vcc, 2, v10
    s_cbranch_vccnz L_poll14
L_fok14:
    s_waitcnt vmcnt(0)
    s_waitcnt lgkmcnt(3)
    v_mfma_f32_32x32x16_bf16 v[64:79], a[0:3], a[64:67], v[64:79]
    ds_read_b128 a[88:91], v60 offset:16384
    ds_read_b128 a[208:211], v46 offset:8192
    v_mfma_f32_32x32x16_bf16 v[80:95], a[4:7], a[64:67], v[80:95]
    s_add_u32 m0, s52, 0
    s_add_u32 s82, s77, s85
    buffer_load_dwordx4 v1, s[60:63], s82 offen offset:0 sc1 lds
    ds_read_b128 a[92:95], v60 offset:19456
    ds_read_b128 a[212:215], v46 offset:10240
    v_mfma_f32_32x32x16_bf16 v[96:111], a[0:3], a[68:71], v[96:111]
    ds_read_b128 a[96:99], v60 offset:17408
    ds_read_b128 a[216:219], v47 offset:8192
    v_mfma_f32_32x32x16_bf16 v[112:127], a[4:7], a[68:71], v[112:127]
    ds_read_b128 a[100:103], v60 offset:20480
    ds_read_b128 a[220:223], v47 offset:10240
    v_mfma_f32_32x32x16_bf16 v[128:143], a[0:3], a[72:75], v[128:143]
    buffer_load_dwordx4 v1, s[60:63], s82 offen offset:1024 sc1 lds
    ds_read_b128 a[104:107], v60 offset:18432
    ds_read_b128 a[224:227], v46 offset:12288
    v_mfma_f32_32x32x16_bf16 v[144:159], a[4:7], a[72:75], v[144:159]
    ds_read_b128 a[108:111], v60 offset:21504
    ds_read_b128 a[228:231], v46 offset:14336
    s_waitcnt lgkmcnt(12)
    v_mfma_f32_32x32x16_bf16 v[160:175], a[0:3], a[76:79], v[160:175]
    buffer_load_dwordx4 v1, s[60:63], s82 offen offset:2048 sc1 lds
    ds_read_b128 a[232:235], v47 offset:12288
    v_mfma_f32_32x32x16_bf16 v[176:191], a[4:7], a[76:79], v[176:191]
    ds_read_b128 a[236:239], v47 offset:14336
    v_mfma_f32_32x32x16_bf16 v[192:207], a[0:3], a[80:83], v[192:207]
    ds_read_b128 a[240:243], v46 offset:22528
    v_mfma_f32_32x32x16_bf16 v[208:223], a[4:7], a[80:83], v[208:223]
    s_add_u32 m0, s52, 3072
    s_add_u32 s82, s82, 368640
    buffer_load_dwordx4 v1, s[60:63], s82 offen offset:0 sc1 lds
    ds_read_b128 a[244:247], v46 offset:24576
    v_mfma_f32_32x32x16_bf16 v[224:239], a[0:3], a[84:87], v[224:239]
    ds_read_b128 a[248:251], v47 offset:22528
    v_mfma_f32_32x32x16_bf16 v[240:255], a[4:7], a[84:87], v[240:255]
    buffer_load_dwordx4 v1, s[60:63], s82 offen offset:1024 sc1 lds
    ds_read_b128 a[252:255], v47 offset:24576
    s_waitcnt lgkmcnt(13)
    v_mfma_f32_32x32x16_bf16 v[64:79], a[8:11], a[88:91], v[64:79]
    ds_read_b128 a[64:67], v61 offset:16384
    v_min_u32 v7, 5, v0
    v_lshl_add_u32 v7, v7, 2, s81
    v_min_u32 v6, 5, v0
    v_add_u32 v6, 18, v6
    v_mfma_f32_32x32x16_bf16 v[80:95], a[12:15], a[88:91], v[80:95]
    buffer_load_dwordx4 v1, s[60:63], s82 offen offset:2048 sc1 lds
    ds_read_b128 a[68:71], v61 offset:19456
    v_mul_u32_u24 v10, 43, v6
    v_lshrrev_b32 v10, 8, v10
    v_mul_u32_u24 v10, 104, v10
    v_mfma_f32_32x32x16_bf16 v[96:111], a[8:11], a[92:95], v[96:111]
    ds_read_b128 a[72:75], v61 offset:17408
    v_lshl_add_u32 v6, v6, 2, s81
    v_add_u32 v6, v6, v10
    v_lshrrev_b32 v9, 4, v0
    v_lshlrev_b32 v9, 3, v9
    v_mfma_f32_32x32x16_bf16 v[112:127], a[12:15], a[92:95], v[112:127]
    ds_read_b128 a[76:79], v61 offset:20480
    v_bfe_u32 v10, v0, 2, 2
    v_add_u32 v9, v9, v10
    v_mul_u32_u24 v9, 144, v9
    v_and_b32 v10, 3, v0
    v_mfma_f32_32x32x16_bf16 v[128:143], a[8:11], a[96:99], v[128:143]
    ds_read_b128 a[80:83], v61 offset:18432
    v_lshl_add_u32 v9, v10, 3, v9
    v_mfma_f32_32x32x16_bf16 v[144:159], a[12:15], a[96:99], v[144:159]
    ds_read_b128 a[84:87], v61 offset:21504
    s_waitcnt lgkmcnt(13)
    v_mfma_f32_32x32x16_bf16 v[160:175], a[8:11], a[100:103], v[160:175]
    v_mfma_f32_32x32x16_bf16 v[176:191], a[12:15], a[100:103], v[176:191]
    v_mfma_f32_32x32x16_bf16 v[192:207], a[8:11], a[104:107], v[192:207]
    v_mfma_f32_32x32x16_bf16 v[208:223], a[12:15], a[104:107], v[208:223]
    v_mfma_f32_32x32x16_bf16 v[224:239], a[8:11], a[108:111], v[224:239]
    v_mfma_f32_32x32x16_bf16 v[240:255], a[12:15], a[108:111], v[240:255]
    s_waitcnt lgkmcnt(6)
    s_waitcnt lgkmcnt(3)
    v_mfma_f32_32x32x16_bf16 v[64:79], a[16:19], a[64:67], v[64:79]
    ds_read_b128 a[88:91], v62 offset:16384
    v_mfma_f32_32x32x16_bf16 v[80:95], a[20:23], a[64:67], v[80:95]
    s_add_u32 m0, s52, 6144
    s_add_u32 s82, s82, 368640
    buffer_load_dwordx4 v1, s[60:63], s82 offen offset:0 sc1 lds
    ds_read_b128 a[92:95], v62 offset:19456
    v_mfma_f32_32x32x16_bf16 v[96:111], a[16:19], a[68:71], v[96:111]
    ds_read_b128 a[96:99], v62 offset:17408
    v_mfma_f32_32x32x16_bf16 v[112:127], a[20:23], a[68:71], v[112:127]
    ds_read_b128 a[100:103], v62 offset:20480
    v_mfma_f32_32x32x16_bf16 v[128:143], a[16:19], a[72:75], v[128:143]
    buffer_load_dwordx4 v1, s[60:63], s82 offen offset:1024 sc1 lds
    ds_read_b128 a[104:107], v62 offset:18432
    s_branch L_sskip15
L_stub15:
    s_setpc_b64 s[100:101]
L_sskip15:
    v_mfma_f32_32x32x16_bf16 v[144:159], a[20:23], a[72:75], v[144:159]
    ds_read_b128 a[108:111], v62 offset:21504
    s_waitcnt lgkmcnt(6)
    v_mfma_f32_32x32x16_bf16 v[160:175], a[16:19], a[76:79], v[160:175]
    buffer_load_dwordx4 v1, s[60:63], s82 offen offset:2048 sc1 lds
    v_mfma_f32_32x32x16_bf16 v[176:191], a[20:23], a[76:79], v[176:191]
    v_mfma_f32_32x32x16_bf16 v[192:207], a[16:19], a[80:83], v[192:207]
    v_mfma_f32_32x32x16_bf16 v[208:223], a[20:23], a[80:83], v[208:223]
    s_add_u32 m0, s52, 9216
    s_add_u32 s82, s82, 368640
    buffer_load_dwordx4 v1, s[60:63], s82 offen offset:0 sc1 lds
    v_mfma_f32_32x32x16_bf16 v[224:239], a[16:19], a[84:87], v[224:239]
    v_mfma_f32_32x32x16_bf16 v[240:255], a[20:23], a[84:87], v[240:255]
    buffer_load_dwordx4 v1, s[60:63], s82 offen offset:1024 sc1 lds
    s_waitcnt lgkmcnt(3)
    v_mfma_f32_32x32x16_bf16 v[64:79], a[24:27], a[88:91], v[64:79]
    v_mfma_f32_32x32x16_bf16 v[80:95], a[28:31], a[88:91], v[80:95]
    buffer_load_dwordx4 v1, s[60:63], s82 offen offset:2048 sc1 lds
    v_mfma_f32_32x32x16_bf16 v[96:111], a[24:27], a[92:95], v[96:111]
    v_mfma_f32_32x32x16_bf16 v[112:127], a[28:31], a[92:95], v[112:127]
    v_mfma_f32_32x32x16_bf16 v[128:143], a[24:27], a[96:99], v[128:143]
    s_add_u32 m0, s52, 12288
    s_add_u32 s82, s82, 368640
    buffer_load_dwordx4 v1, s[60:63], s82 offen offset:0 sc1 lds
    v_mfma_f32_32x32x16_bf16 v[144:159], a[28:31], a[96:99], v[144:159]
    s_waitcnt lgkmcnt(0)
    v_mfma_f32_32x32x16_bf16 v[160:175], a[24:27], a[100:103], v[160:175]
    buffer_load_dwordx4 v1, s[60:63], s82 offen offset:1024 sc1 lds
    v_mfma_f32_32x32x16_bf16 v[176:191], a[28:31], a[100:103], v[176:191]
    v_mfma_f32_32x32x16_bf16 v[192:207], a[24:27], a[104:107], v[192:207]
    v_mfma_f32_32x32x16_bf16 v[208:223], a[28:31], a[104:107], v[208:223]
    buffer_load_dwordx4 v1, s[60:63], s82 offen offset:2048 sc1 lds
    v_mfma_f32_32x32x16_bf16 v[224:239], a[24:27], a[108:111], v[224:239]
    v_mfma_f32_32x32x16_bf16 v[240:255], a[28:31], a[108:111], v[240:255]
    v_add_u32 v62, s52, v9
    v_add_u32 v9, s97, v9
    s_nop 1
    v_pk_fma_f32 v[48:49], v[14:15], v[64:65], v[66:67] op_sel:[0,0,0] op_sel_hi:[0,1,1]
    v_pk_fma_f32 v[50:51], v[14:15], v[96:97], v[98:99] op_sel:[0,0,0] op_sel_hi:[0,1,1]
    v_pk_fma_f32 v[48:49], v[14:15], v[96:97], v[48:49] op_sel:[1,0,0] op_sel_hi:[1,1,1] neg_lo:[1,0,0] neg_hi:[1,0,0]
    v_pk_fma_f32 v[50:51], v[14:15], v[64:65], v[50:51] op_sel:[1,0,0] op_sel_hi:[1,1,1]
    v_pk_fma_f32 v[44:45], v[14:15], v[48:49], v[68:69] op_sel:[0,0,0] op_sel_hi:[0,1,1]
    v_pk_fma_f32 v[46:47], v[14:15], v[50:51], v[100:101] op_sel:[0,0,0] op_sel_hi:[0,1,1]
    v_pk_fma_f32 v[44:45], v[14:15], v[50:51], v[44:45] op_sel:[1,0,0] op_sel_hi:[1,1,1] neg_lo:[1,0,0] neg_hi:[1,0,0]
    v_pk_fma_f32 v[46:47], v[14:15], v[48:49], v[46:47] op_sel:[1,0,0] op_sel_hi:[1,1,1]
    v_pk_fma_f32 v[48:49], v[14:15], v[44:45], v[70:71] op_sel:[0,0,0] op_sel_hi:[0,1,1]
    v_pk_fma_f32 v[50:51], v[14:15], v[46:47], v[102:103] op_sel:[0,0,0] op_sel_hi:[0,1,1]
    v_pk_fma_f32 v[48:49], v[14:15], v[46:47], v[48:49] op_sel:[1,0,0] op_sel_hi:[1,1,1] neg_lo:[1,0,0] neg_hi:[1,0,0]
    v_pk_fma_f32 v[50:51], v[14:15], v[44:45], v[50:51] op_sel:[1,0,0] op_sel_hi:[1,1,1]
    v_pk_fma_f32 v[44:45], v[14:15], v[48:49], v[72:73] op_sel:[0,0,0] op_sel_hi:[0,1,1]
    v_pk_fma_f32 v[46:47], v[14:15], v[50:51], v[104:105] op_sel:[0,0,0] op_sel_hi:[0,1,1]
    v_pk_fma_f32 v[44:45], v[14:15], v[50:51], v[44:45] op_sel:[1,0,0] op_sel_hi:[1,1,1] neg_lo:[1,0,0] neg_hi:[1,0,0]
    v_pk_fma_f32 v[46:47], v[14:15], v[48:49], v[46:47] op_sel:[1,0,0] op_sel_hi:[1,1,1]
    v_pk_fma_f32 v[48:49], v[14:15], v[44:45], v[74:75] op_sel:[0,0,0] op_sel_hi:[0,1,1]
    v_pk_fma_f32 v[50:51], v[14:15], v[46:47], v[106:107] op_sel:[0,0,0] op_sel_hi:[0,1,1]
    v_pk_fma_f32 v[48:49], v[14:15], v[46:47], v[48:49] op_sel:[1,0,0] op_sel_hi:[1,1,1] neg_lo:[1,0,0] neg_hi:[1,0,0]
    v_pk_fma_f32 v[50:51], v[14:15], v[44:45], v[50:51] op_sel:[1,0,0] op_sel_hi:[1,1,1]
    v_pk_fma_f32 v[44:45], v[14:15], v[48:49], v[76:77] op_sel:[0,0,0] op_sel_hi:[0,1,1]
    v_pk_fma_f32 v[46:47], v[14:15], v[50:51], v[108:109] op_sel:[0,0,0] op_sel_hi:[0,1,1]
    v_pk_fma_f32 v[44:45], v[14:15], v[50:51], v[44:45] op_sel:[1,0,0] op_sel_hi:[1,1,1] neg_lo:[1,0,0] neg_hi:[1,0,0]
    v_pk_fma_f32 v[46:47], v[14:15], v[48:49], v[46:47] op_sel:[1,0,0] op_sel_hi:[1,1,1]
    v_pk_fma_f32 v[48:49], v[14:15], v[44:45], v[78:79] op_sel:[0,0,0] op_sel_hi:[0,1,1]
    v_pk_fma_f32 v[50:51], v[14:15], v[46:47], v[110:111] op_sel:[0,0,0] op_sel_hi:[0,1,1]
    v_pk_fma_f32 v[48:49], v[14:15], v[46:47], v[48:49] op_sel:[1,0,0] op_sel_hi:[1,1,1] neg_lo:[1,0,0] neg_hi:[1,0,0]
    v_pk_fma_f32 v[50:51], v[14:15], v[44:45], v[50:51] op_sel:[1,0,0] op_sel_hi:[1,1,1]
    v_pk_fma_f32 v[44:45], v[14:15], v[48:49], v[80:81] op_sel:[0,0,0] op_sel_hi:[0,1,1]
    v_pk_fma_f32 v[46:47], v[14:15], v[50:51], v[112:113] op_sel:[0,0,0] op_sel_hi:[0,1,1]
    v_pk_fma_f32 v[44:45], v[14:15], v[50:51], v[44:45] op_sel:[1,0,0] op_sel_hi:[1,1,1] neg_lo:[1,0,0] neg_hi:[1,0,0]
    v_pk_fma_f32 v[46:47], v[14:15], v[48:49], v[46:47] op_sel:[1,0,0] op_sel_hi:[1,1,1]
    v_pk_fma_f32 v[48:49], v[14:15], v[44:45], v[82:83] op_sel:[0,0,0] op_sel_hi:[0,1,1]
    v_pk_fma_f32 v[50:51], v[14:15], v[46:47], v[114:115] op_sel:[0,0,0] op_sel_hi:[0,1,1]
    v_pk_fma_f32 v[48:49], v[14:15], v[46:47], v[48:49] op_sel:[1,0,0] op_sel_hi:[1,1,1] neg_lo:[1,0,0] neg_hi:[1,0,0]
    v_pk_fma_f32 v[50:51], v[14:15], v[44:45], v[50:51] op_sel:[1,0,0] op_sel_hi:[1,1,1]
    v_pk_fma_f32 v[44:45], v[14:15], v[48:49], v[84:85] op_sel:[0,0,0] op_sel_hi:[0,1,1]
    v_pk_fma_f32 v[46:47], v[14:15], v[50:51], v[116:117] op_sel:[0,0,0] op_sel_hi:[0,1,1]
    v_pk_fma_f32 v[44:45], v[14:15], v[50:51], v[44:45] op_sel:[1,0,0] op_sel_hi:[1,1,1] neg_lo:[1,0,0] neg_hi:[1,0,0]
    v_pk_fma_f32 v[46:47], v[14:15], v[48:49], v[46:47] op_sel:[1,0,0] op_sel_hi:[1,1,1]
    v_pk_fma_f32 v[48:49], v[14:15], v[44:45], v[86:87] op_sel:[0,0,0] op_sel_hi:[0,1,1]
    v_pk_fma_f32 v[50:51], v[14:15], v[46:47], v[118:119] op_sel:[0,0,0] op_sel_hi:[0,1,1]
    v_pk_fma_f32 v[48:49], v[14:15], v[46:47], v[48:49] op_sel:[1,0,0] op_sel_hi:[1,1,1] neg_lo:[1,0,0] neg_hi:[1,0,0]
    v_pk_fma_f32 v[50:51], v[14:15], v[44:45], v[50:51] op_sel:[1,0,0] op_sel_hi:[1,1,1]
    v_pk_fma_f32 v[44:45], v[14:15], v[48:49], v[88:89] op_sel:[0,0,0] op_sel_hi:[0,1,1]
    v_pk_fma_f32 v[46:47], v[14:15], v[50:51], v[120:121] op_sel:[0,0,0] op_sel_hi:[0,1,1]
    v_pk_fma_f32 v[44:45], v[14:15], v[50:51], v[44:45] op_sel:[1,0,0] op_sel_hi:[1,1,1] neg_lo:[1,0,0] neg_hi:[1,0,0]
    v_pk_fma_f32 v[46:47], v[14:15], v[48:49], v[46:47] op_sel:[1,0,0] op_sel_hi:[1,1,1]
    v_pk_fma_f32 v[48:49], v[14:15], v[44:45], v[90:91] op_sel:[0,0,0] op_sel_hi:[0,1,1]
    v_pk_fma_f32 v[50:51], v[14:15], v[46:47], v[122:123] op_sel:[0,0,0] op_sel_hi:[0,1,1]
    v_pk_fma_f32 v[48:49], v[14:15], v[46:47], v[48:49] op_sel:[1,0,0] op_sel_hi:[1,1,1] neg_lo:[1,0,0] neg_hi:[1,0,0]
    v_pk_fma_f32 v[50:51], v[14:15], v[44:45], v[50:51] op_sel:[1,0,0] op_sel_hi:[1,1,1]
    v_pk_fma_f32 v[44:45], v[14:15], v[48:49], v[92:93] op_sel:[0,0,0] op_sel_hi:[0,1,1]
    v_pk_fma_f32 v[46:47], v[14:15], v[50:51], v[124:125] op_sel:[0,0,0] op_sel_hi:[0,1,1]
    v_pk_fma_f32 v[44:45], v[14:15], v[50:51], v[44:45] op_sel:[1,0,0] op_sel_hi:[1,1,1] neg_lo:[1,0,0] neg_hi:[1,0,0]
    v_pk_fma_f32 v[46:47], v[14:15], v[48:49], v[46:47] op_sel:[1,0,0] op_sel_hi:[1,1,1]
    v_pk_fma_f32 v[48:49], v[14:15], v[44:45], v[94:95] op_sel:[0,0,0] op_sel_hi:[0,1,1]
    v_pk_fma_f32 v[50:51], v[14:15], v[46:47], v[126:127] op_sel:[0,0,0] op_sel_hi:[0,1,1]
    v_pk_fma_f32 v[48:49], v[14:15], v[46:47], v[48:49] op_sel:[1,0,0] op_sel_hi:[1,1,1] neg_lo:[1,0,0] neg_hi:[1,0,0]
    v_pk_fma_f32 v[50:51], v[14:15], v[44:45], v[50:51] op_sel:[1,0,0] op_sel_hi:[1,1,1]
    v_fma_f32 v52, v26, v48, v49
    v_fma_f32 v53, v26, v50, v51
    v_accvgpr_write_b32 a154, v48
    v_fma_f32 v52, -v27, v50, v52
    v_fma_f32 v53, v27, v48, v53
    v_accvgpr_write_b32 a155, v50
    ds_write_b64 v57, v[52:53] offset:29184
    v_pk_fma_f32 v[48:49], v[16:17], v[128:129], v[130:131] op_sel:[0,0,0] op_sel_hi:[0,1,1]
    v_pk_fma_f32 v[50:51], v[16:17], v[160:161], v[162:163] op_sel:[0,0,0] op_sel_hi:[0,1,1]
    v_pk_fma_f32 v[48:49], v[16:17], v[160:161], v[48:49] op_sel:[1,0,0] op_sel_hi:[1,1,1] neg_lo:[1,0,0] neg_hi:[1,0,0]
    v_pk_fma_f32 v[50:51], v[16:17], v[128:129], v[50:51] op_sel:[1,0,0] op_sel_hi:[1,1,1]
    v_pk_fma_f32 v[44:45], v[16:17], v[48:49], v[132:133] op_sel:[0,0,0] op_sel_hi:[0,1,1]
    v_pk_fma_f32 v[46:47], v[16:17], v[50:51], v[164:165] op_sel:[0,0,0] op_sel_hi:[0,1,1]
    v_pk_fma_f32 v[44:45], v[16:17], v[50:51], v[44:45] op_sel:[1,0,0] op_sel_hi:[1,1,1] neg_lo:[1,0,0] neg_hi:[1,0,0]
    v_pk_fma_f32 v[46:47], v[16:17], v[48:49], v[46:47] op_sel:[1,0,0] op_sel_hi:[1,1,1]
    v_pk_fma_f32 v[48:49], v[16:17], v[44:45], v[134:135] op_sel:[0,0,0] op_sel_hi:[0,1,1]
    v_pk_fma_f32 v[50:51], v[16:17], v[46:47], v[166:167] op_sel:[0,0,0] op_sel_hi:[0,1,1]
    v_pk_fma_f32 v[48:49], v[16:17], v[46:47], v[48:49] op_sel:[1,0,0] op_sel_hi:[1,1,1] neg_lo:[1,0,0] neg_hi:[1,0,0]
    v_pk_fma_f32 v[50:51], v[16:17], v[44:45], v[50:51] op_sel:[1,0,0] op_sel_hi:[1,1,1]
    v_pk_fma_f32 v[44:45], v[16:17], v[48:49], v[136:137] op_sel:[0,0,0] op_sel_hi:[0,1,1]
    v_pk_fma_f32 v[46:47], v[16:17], v[50:51], v[168:169] op_sel:[0,0,0] op_sel_hi:[0,1,1]
    v_pk_fma_f32 v[44:45], v[16:17], v[50:51], v[44:45] op_sel:[1,0,0] op_sel_hi:[1,1,1] neg_lo:[1,0,0] neg_hi:[1,0,0]
    v_pk_fma_f32 v[46:47], v[16:17], v[48:49], v[46:47] op_sel:[1,0,0] op_sel_hi:[1,1,1]
    v_pk_fma_f32 v[48:49], v[16:17], v[44:45], v[138:139] op_sel:[0,0,0] op_sel_hi:[0,1,1]
    v_pk_fma_f32 v[50:51], v[16:17], v[46:47], v[170:171] op_sel:[0,0,0] op_sel_hi:[0,1,1]
    v_pk_fma_f32 v[48:49], v[16:17], v[46:47], v[48:49] op_sel:[1,0,0] op_sel_hi:[1,1,1] neg_lo:[1,0,0] neg_hi:[1,0,0]
    v_pk_fma_f32 v[50:51], v[16:17], v[44:45], v[50:51] op_sel:[1,0,0] op_sel_hi:[1,1,1]
    v_pk_fma_f32 v[44:45], v[16:17], v[48:49], v[140:141] op_sel:[0,0,0] op_sel_hi:[0,1,1]
    v_pk_fma_f32 v[46:47], v[16:17], v[50:51], v[172:173] op_sel:[0,0,0] op_sel_hi:[0,1,1]
    v_pk_fma_f32 v[44:45], v[16:17], v[50:51], v[44:45] op_sel:[1,0,0] op_sel_hi:[1,1,1] neg_lo:[1,0,0] neg_hi:[1,0,0]
    v_pk_fma_f32 v[46:47], v[16:17], v[48:49], v[46:47] op_sel:[1,0,0] op_sel_hi:[1,1,1]
    v_pk_fma_f32 v[48:49], v[16:17], v[44:45], v[142:143] op_sel:[0,0,0] op_sel_hi:[0,1,1]
    v_pk_fma_f32 v[50:51], v[16:17], v[46:47], v[174:175] op_sel:[0,0,0] op_sel_hi:[0,1,1]
    v_pk_fma_f32 v[48:49], v[16:17], v[46:47], v[48:49] op_sel:[1,0,0] op_sel_hi:[1,1,1] neg_lo:[1,0,0] neg_hi:[1,0,0]
    v_pk_fma_f32 v[50:51], v[16:17], v[44:45], v[50:51] op_sel:[1,0,0] op_sel_hi:[1,1,1]
    v_pk_fma_f32 v[44:45], v[16:17], v[48:49], v[144:145] op_sel:[0,0,0] op_sel_hi:[0,1,1]
    v_pk_fma_f32 v[46:47], v[16:17], v[50:51], v[176:177] op_sel:[0,0,0] op_sel_hi:[0,1,1]
    v_pk_fma_f32 v[44:45], v[16:17], v[50:51], v[44:45] op_sel:[1,0,0] op_sel_hi:[1,1,1] neg_lo:[1,0,0] neg_hi:[1,0,0]
    v_pk_fma_f32 v[46:47], v[16:17], v[48:49], v[46:47] op_sel:[1,0,0] op_sel_hi:[1,1,1]
    v_pk_fma_f32 v[48:49], v[16:17], v[44:45], v[146:147] op_sel:[0,0,0] op_sel_hi:[0,1,1]
    v_pk_fma_f32 v[50:51], v[16:17], v[46:47], v[178:179] op_sel:[0,0,0] op_sel_hi:[0,1,1]
    v_pk_fma_f32 v[48:49], v[16:17], v[46:47], v[48:49] op_sel:[1,0,0] op_sel_hi:[1,1,1] neg_lo:[1,0,0] neg_hi:[1,0,0]
    v_pk_fma_f32 v[50:51], v[16:17], v[44:45], v[50:51] op_sel:[1,0,0] op_sel_hi:[1,1,1]
    v_pk_fma_f32 v[44:45], v[16:17], v[48:49], v[148:149] op_sel:[0,0,0] op_sel_hi:[0,1,1]
    v_pk_fma_f32 v[46:47], v[16:17], v[50:51], v[180:181] op_sel:[0,0,0] op_sel_hi:[0,1,1]
    v_pk_fma_f32 v[44:45], v[16:17], v[50:51], v[44:45] op_sel:[1,0,0] op_sel_hi:[1,1,1] neg_lo:[1,0,0] neg_hi:[1,0,0]
    v_pk_fma_f32 v[46:47], v[16:17], v[48:49], v[46:47] op_sel:[1,0,0] op_sel_hi:[1,1,1]
    v_pk_fma_f32 v[48:49], v[16:17], v[44:45], v[150:151] op_sel:[0,0,0] op_sel_hi:[0,1,1]
    v_pk_fma_f32 v[50:51], v[16:17], v[46:47], v[182:183] op_sel:[0,0,0] op_sel_hi:[0,1,1]
    v_pk_fma_f32 v[48:49], v[16:17], v[46:47], v[48:49] op_sel:[1,0,0] op_sel_hi:[1,1,1] neg_lo:[1,0,0] neg_hi:[1,0,0]
    v_pk_fma_f32 v[50:51], v[16:17], v[44:45], v[50:51] op_sel:[1,0,0] op_sel_hi:[1,1,1]
    v_pk_fma_f32 v[44:45], v[16:17], v[48:49], v[152:153] op_sel:[0,0,0] op_sel_hi:[0,1,1]
    v_pk_fma_f32 v[46:47], v[16:17], v[50:51], v[184:185] op_sel:[0,0,0] op_sel_hi:[0,1,1]
    v_pk_fma_f32 v[44:45], v[16:17], v[50:51], v[44:45] op_sel:[1,0,0] op_sel_hi:[1,1,1] neg_lo:[1,0,0] neg_hi:[1,0,0]
    v_pk_fma_f32 v[46:47], v[16:17], v[48:49], v[46:47] op_sel:[1,0,0] op_sel_hi:[1,1,1]
    v_pk_fma_f32 v[48:49], v[16:17], v[44:45], v[154:155] op_sel:[0,0,0] op_sel_hi:[0,1,1]
    v_pk_fma_f32 v[50:51], v[16:17], v[46:47], v[186:187] op_sel:[0,0,0] op_sel_hi:[0,1,1]
    v_pk_fma_f32 v[48:49], v[16:17], v[46:47], v[48:49] op_sel:[1,0,0] op_sel_hi:[1,1,1] neg_lo:[1,0,0] neg_hi:[1,0,0]
    v_pk_fma_f32 v[50:51], v[16:17], v[44:45], v[50:51] op_sel:[1,0,0] op_sel_hi:[1,1,1]
    v_pk_fma_f32 v[44:45], v[16:17], v[48:49], v[156:157] op_sel:[0,0,0] op_sel_hi:[0,1,1]
    v_pk_fma_f32 v[46:47], v[16:17], v[50:51], v[188:189] op_sel:[0,0,0] op_sel_hi:[0,1,1]
    v_pk_fma_f32 v[44:45], v[16:17], v[50:51], v[44:45] op_sel:[1,0,0] op_sel_hi:[1,1,1] neg_lo:[1,0,0] neg_hi:[1,0,0]
    v_pk_fma_f32 v[46:47], v[16:17], v[48:49], v[46:47] op_sel:[1,0,0] op_sel_hi:[1,1,1]
    v_pk_fma_f32 v[48:49], v[16:17], v[44:45], v[158:159] op_sel:[0,0,0] op_sel_hi:[0,1,1]
    v_pk_fma_f32 v[50:51], v[16:17], v[46:47], v[190:191] op_sel:[0,0,0] op_sel_hi:[0,1,1]
    v_pk_fma_f32 v[48:49], v[16:17], v[46:47], v[48:49] op_sel:[1,0,0] op_sel_hi:[1,1,1] neg_lo:[1,0,0] neg_hi:[1,0,0]
    v_pk_fma_f32 v[50:51], v[16:17], v[44:45], v[50:51] op_sel:[1,0,0] op_sel_hi:[1,1,1]
    v_fma_f32 v54, v28, v48, v49
    v_fma_f32 v55, v28, v50, v51
    v_accvgpr_write_b32 a156, v48
    v_fma_f32 v54, -v29, v50, v54
    v_fma_f32 v55, v29, v48, v55
    v_accvgpr_write_b32 a157, v50
    ds_write_b64 v57, v[54:55] offset:29440
    v_pk_fma_f32 v[48:49], v[18:19], v[192:193], v[194:195] op_sel:[0,0,0] op_sel_hi:[0,1,1]
    v_pk_fma_f32 v[50:51], v[18:19], v[224:225], v[226:227] op_sel:[0,0,0] op_sel_hi:[0,1,1]
    v_pk_fma_f32 v[48:49], v[18:19], v[224:225], v[48:49] op_sel:[1,0,0] op_sel_hi:[1,1,1] neg_lo:[1,0,0] neg_hi:[1,0,0]
    v_pk_fma_f32 v[50:51], v[18:19], v[192:193], v[50:51] op_sel:[1,0,0] op_sel_hi:[1,1,1]
    v_pk_fma_f32 v[44:45], v[18:19], v[48:49], v[196:197] op_sel:[0,0,0] op_sel_hi:[0,1,1]
    v_pk_fma_f32 v[46:47], v[18:19], v[50:51], v[228:229] op_sel:[0,0,0] op_sel_hi:[0,1,1]
    v_pk_fma_f32 v[44:45], v[18:19], v[50:51], v[44:45] op_sel:[1,0,0] op_sel_hi:[1,1,1] neg_lo:[1,0,0] neg_hi:[1,0,0]
    v_pk_fma_f32 v[46:47], v[18:19], v[48:49], v[46:47] op_sel:[1,0,0] op_sel_hi:[1,1,1]
    v_pk_fma_f32 v[48:49], v[18:19], v[44:45], v[198:199] op_sel:[0,0,0] op_sel_hi:[0,1,1]
    v_pk_fma_f32 v[50:51], v[18:19], v[46:47], v[230:231] op_sel:[0,0,0] op_sel_hi:[0,1,1]
    v_pk_fma_f32 v[48:49], v[18:19], v[46:47], v[48:49] op_sel:[1,0,0] op_sel_hi:[1,1,1] neg_lo:[1,0,0] neg_hi:[1,0,0]
    v_pk_fma_f32 v[50:51], v[18:19], v[44:45], v[50:51] op_sel:[1,0,0] op_sel_hi:[1,1,1]
    v_pk_fma_f32 v[44:45], v[18:19], v[48:49], v[200:201] op_sel:[0,0,0] op_sel_hi:[0,1,1]
    v_pk_fma_f32 v[46:47], v[18:19], v[50:51], v[232:233] op_sel:[0,0,0] op_sel_hi:[0,1,1]
    v_pk_fma_f32 v[44:45], v[18:19], v[50:51], v[44:45] op_sel:[1,0,0] op_sel_hi:[1,1,1] neg_lo:[1,0,0] neg_hi:[1,0,0]
    v_pk_fma_f32 v[46:47], v[18:19], v[48:49], v[46:47] op_sel:[1,0,0] op_sel_hi:[1,1,1]
    v_pk_fma_f32 v[48:49], v[18:19], v[44:45], v[202:203] op_sel:[0,0,0] op_sel_hi:[0,1,1]
    v_pk_fma_f32 v[50:51], v[18:19], v[46:47], v[234:235] op_sel:[0,0,0] op_sel_hi:[0,1,1]
    v_pk_fma_f32 v[48:49], v[18:19], v[46:47], v[48:49] op_sel:[1,0,0] op_sel_hi:[1,1,1] neg_lo:[1,0,0] neg_hi:[1,0,0]
    v_pk_fma_f32 v[50:51], v[18:19], v[44:45], v[50:51] op_sel:[1,0,0] op_sel_hi:[1,1,1]
    v_pk_fma_f32 v[44:45], v[18:19], v[48:49], v[204:205] op_sel:[0,0,0] op_sel_hi:[0,1,1]
    v_pk_fma_f32 v[46:47], v[18:19], v[50:51], v[236:237] op_sel:[0,0,0] op_sel_hi:[0,1,1]
    v_pk_fma_f32 v[44:45], v[18:19], v[50:51], v[44:45] op_sel:[1,0,0] op_sel_hi:[1,1,1] neg_lo:[1,0,0] neg_hi:[1,0,0]
    v_pk_fma_f32 v[46:47], v[18:19], v[48:49], v[46:47] op_sel:[1,0,0] op_sel_hi:[1,1,1]
    v_pk_fma_f32 v[48:49], v[18:19], v[44:45], v[206:207] op_sel:[0,0,0] op_sel_hi:[0,1,1]
    v_pk_fma_f32 v[50:51], v[18:19], v[46:47], v[238:239] op_sel:[0,0,0] op_sel_hi:[0,1,1]
    v_pk_fma_f32 v[48:49], v[18:19], v[46:47], v[48:49] op_sel:[1,0,0] op_sel_hi:[1,1,1] neg_lo:[1,0,0] neg_hi:[1,0,0]
    v_pk_fma_f32 v[50:51], v[18:19], v[44:45], v[50:51] op_sel:[1,0,0] op_sel_hi:[1,1,1]
    v_pk_fma_f32 v[44:45], v[18:19], v[48:49], v[208:209] op_sel:[0,0,0] op_sel_hi:[0,1,1]
    v_pk_fma_f32 v[46:47], v[18:19], v[50:51], v[240:241] op_sel:[0,0,0] op_sel_hi:[0,1,1]
    v_pk_fma_f32 v[44:45], v[18:19], v[50:51], v[44:45] op_sel:[1,0,0] op_sel_hi:[1,1,1] neg_lo:[1,0,0] neg_hi:[1,0,0]
    v_pk_fma_f32 v[46:47], v[18:19], v[48:49], v[46:47] op_sel:[1,0,0] op_sel_hi:[1,1,1]
    v_pk_fma_f32 v[48:49], v[18:19], v[44:45], v[210:211] op_sel:[0,0,0] op_sel_hi:[0,1,1]
    v_pk_fma_f32 v[50:51], v[18:19], v[46:47], v[242:243] op_sel:[0,0,0] op_sel_hi:[0,1,1]
    v_pk_fma_f32 v[48:49], v[18:19], v[46:47], v[48:49] op_sel:[1,0,0] op_sel_hi:[1,1,1] neg_lo:[1,0,0] neg_hi:[1,0,0]
    v_pk_fma_f32 v[50:51], v[18:19], v[44:45], v[50:51] op_sel:[1,0,0] op_sel_hi:[1,1,1]
    v_pk_fma_f32 v[44:45], v[18:19], v[48:49], v[212:213] op_sel:[0,0,0] op_sel_hi:[0,1,1]
    v_pk_fma_f32 v[46:47], v[18:19], v[50:51], v[244:245] op_sel:[0,0,0] op_sel_hi:[0,1,1]
    v_pk_fma_f32 v[44:45], v[18:19], v[50:51], v[44:45] op_sel:[1,0,0] op_sel_hi:[1,1,1] neg_lo:[1,0,0] neg_hi:[1,0,0]
    v_pk_fma_f32 v[46:47], v[18:19], v[48:49], v[46:47] op_sel:[1,0,0] op_sel_hi:[1,1,1]
    v_pk_fma_f32 v[48:49], v[18:19], v[44:45], v[214:215] op_sel:[0,0,0] op_sel_hi:[0,1,1]
    v_pk_fma_f32 v[50:51], v[18:19], v[46:47], v[246:247] op_sel:[0,0,0] op_sel_hi:[0,1,1]
    v_pk_fma_f32 v[48:49], v[18:19], v[46:47], v[48:49] op_sel:[1,0,0] op_sel_hi:[1,1,1] neg_lo:[1,0,0] neg_hi:[1,0,0]
    v_pk_fma_f32 v[50:51], v[18:19], v[44:45], v[50:51] op_sel:[1,0,0] op_sel_hi:[1,1,1]
    v_pk_fma_f32 v[44:45], v[18:19], v[48:49], v[216:217] op_sel:[0,0,0] op_sel_hi:[0,1,1]
    v_pk_fma_f32 v[46:47], v[18:19], v[50:51], v[248:249] op_sel:[0,0,0] op_sel_hi:[0,1,1]
    v_pk_fma_f32 v[44:45], v[18:19], v[50:51], v[44:45] op_sel:[1,0,0] op_sel_hi:[1,1,1] neg_lo:[1,0,0] neg_hi:[1,0,0]
    v_pk_fma_f32 v[46:47], v[18:19], v[48:49], v[46:47] op_sel:[1,0,0] op_sel_hi:[1,1,1]
    v_pk_fma_f32 v[48:49], v[18:19], v[44:45], v[218:219] op_sel:[0,0,0] op_sel_hi:[0,1,1]
    v_pk_fma_f32 v[50:51], v[18:19], v[46:47], v[250:251] op_sel:[0,0,0] op_sel_hi:[0,1,1]
    v_pk_fma_f32 v[48:49], v[18:19], v[46:47], v[48:49] op_sel:[1,0,0] op_sel_hi:[1,1,1] neg_lo:[1,0,0] neg_hi:[1,0,0]
    v_pk_fma_f32 v[50:51], v[18:19], v[44:45], v[50:51] op_sel:[1,0,0] op_sel_hi:[1,1,1]
    v_pk_fma_f32 v[44:45], v[18:19], v[48:49], v[220:221] op_sel:[0,0,0] op_sel_hi:[0,1,1]
    v_pk_fma_f32 v[46:47], v[18:19], v[50:51], v[252:253] op_sel:[0,0,0] op_sel_hi:[0,1,1]
    v_pk_fma_f32 v[44:45], v[18:19], v[50:51], v[44:45] op_sel:[1,0,0] op_sel_hi:[1,1,1] neg_lo:[1,0,0] neg_hi:[1,0,0]
    v_pk_fma_f32 v[46:47], v[18:19], v[48:49], v[46:47] op_sel:[1,0,0] op_sel_hi:[1,1,1]
    v_pk_fma_f32 v[48:49], v[18:19], v[44:45], v[222:223] op_sel:[0,0,0] op_sel_hi:[0,1,1]
    v_pk_fma_f32 v[50:51], v[18:19], v[46:47], v[254:255] op_sel:[0,0,0] op_sel_hi:[0,1,1]
    v_pk_fma_f32 v[48:49], v[18:19], v[46:47], v[48:49] op_sel:[1,0,0] op_sel_hi:[1,1,1] neg_lo:[1,0,0] neg_hi:[1,0,0]
    v_pk_fma_f32 v[50:51], v[18:19], v[44:45], v[50:51] op_sel:[1,0,0] op_sel_hi:[1,1,1]
    v_fma_f32 v52, v30, v48, v49
    v_fma_f32 v53, v30, v50, v51
    v_accvgpr_write_b32 a158, v48
    v_fma_f32 v52, -v31, v50, v52
    v_fma_f32 v53, v31, v48, v53
    v_accvgpr_write_b32 a159, v50
    ds_write_b64 v57, v[52:53] offset:29696
    s_waitcnt lgkmcnt(0)
    s_barrier
    v_add_u32 v59, 40960, v11
    v_add_u32 v60, 40960, v3
    ds_read_b64 a[0:1], v11 offset:29184
    ds_read_b64 a[2:3], v11 offset:29440
    ds_read_b64 a[4:5], v11 offset:29696
    ds_read_b64 a[6:7], v11 offset:29952
    ds_read_b64 a[8:9], v11 offset:30208
    ds_read_b64 a[10:11], v11 offset:30464
    ds_read_b64 a[12:13], v59 offset:29184
    ds_read_b64 a[14:15], v59 offset:29440
    ds_read_b64 a[16:17], v59 offset:29696
    ds_read_b64 a[18:19], v59 offset:29952
    ds_read_b64 a[20:21], v59 offset:30208
    ds_read_b64 a[22:23], v59 offset:30464
    ds_read_b64 a[24:25], v3 offset:29184
    ds_read_b64 a[26:27], v3 offset:29440
    ds_read_b64 a[28:29], v3 offset:29696
    ds_read_b64 a[30:31], v3 offset:29952
    ds_read_b64 a[32:33], v3 offset:30208
    ds_read_b64 a[34:35], v3 offset:30464
    ds_read_b64 a[36:37], v60 offset:29184
    ds_read_b64 a[38:39], v60 offset:29440
    ds_read_b64 a[40:41], v60 offset:29696
    ds_read_b64 a[42:43], v60 offset:29952
    ds_read_b64 a[44:45], v60 offset:30208
    ds_read_b64 a[46:47], v60 offset:30464
    s_waitcnt lgkmcnt(0)
    s_cmp_eq_u32 s50, 3
    s_cbranch_scc1 L_ssm_nopub
    s_cmp_lg_u32 s50, 0
    s_cbranch_scc1 L_ssm_pub1
    v_accvgpr_read_b32 v44, a0
    v_accvgpr_read_b32 v45, a1
    v_accvgpr_read_b32 v52, a6
    v_accvgpr_read_b32 v53, a7
    v_pk_fma_f32 v[52:53], v[32:33], v[44:45], v[52:53] op_sel:[0,0,0] op_sel_hi:[0,1,1]
    v_pk_fma_f32 v[44:45], v[32:33], v[44:45], v[52:53] op_sel:[1,1,0] op_sel_hi:[1,0,1] neg_lo:[1,0,0]
    v_accvgpr_read_b32 v50, a12
    v_accvgpr_read_b32 v51, a13
    v_pk_fma_f32 v[50:51], v[32:33], v[44:45], v[50:51] op_sel:[0,0,0] op_sel_hi:[0,1,1]
    v_pk_fma_f32 v[44:45], v[32:33], v[44:45], v[50:51] op_sel:[1,1,0] op_sel_hi:[1,0,1] neg_lo:[1,0,0]
    v_accvgpr_read_b32 v52, a18
    v_accvgpr_read_b32 v53, a19
    v_pk_fma_f32 v[52:53], v[32:33], v[44:45], v[52:53] op_sel:[0,0,0] op_sel_hi:[0,1,1]
    v_pk_fma_f32 v[44:45], v[32:33], v[44:45], v[52:53] op_sel:[1,1,0] op_sel_hi:[1,0,1] neg_lo:[1,0,0]
    v_accvgpr_read_b32 v50, a24
    v_accvgpr_read_b32 v51, a25
    v_pk_fma_f32 v[50:51], v[32:33], v[44:45], v[50:51] op_sel:[0,0,0] op_sel_hi:[0,1,1]
    v_pk_fma_f32 v[44:45], v[32:33], v[44:45], v[50:51] op_sel:[1,1,0] op_sel_hi:[1,0,1] neg_lo:[1,0,0]
    v_accvgpr_read_b32 v52, a30
    v_accvgpr_read_b32 v53, a31
    v_pk_fma_f32 v[52:53], v[32:33], v[44:45], v[52:53] op_sel:[0,0,0] op_sel_hi:[0,1,1]
    v_pk_fma_f32 v[44:45], v[32:33], v[44:45], v[52:53] op_sel:[1,1,0] op_sel_hi:[1,0,1] neg_lo:[1,0,0]
    v_accvgpr_read_b32 v50, a36
    v_accvgpr_read_b32 v51, a37
    v_pk_fma_f32 v[50:51], v[32:33], v[44:45], v[50:51] op_sel:[0,0,0] op_sel_hi:[0,1,1]
    v_pk_fma_f32 v[44:45], v[32:33], v[44:45], v[50:51] op_sel:[1,1,0] op_sel_hi:[1,0,1] neg_lo:[1,0,0]
    v_accvgpr_read_b32 v52, a42
    v_accvgpr_read_b32 v53, a43
    v_pk_fma_f32 v[52:53], v[32:33], v[44:45], v[52:53] op_sel:[0,0,0] op_sel_hi:[0,1,1]
    v_pk_fma_f32 v[44:45], v[32:33], v[44:45], v[52:53] op_sel:[1,1,0] op_sel_hi:[1,0,1] neg_lo:[1,0,0]
    v_or_b32 v44, 1, v44
    buffer_store_dwordx2 v[44:45], v11, s[72:75], s96 offen offset:0 sc1
    v_mov_b32 v60, v38
    v_mov_b32 v61, v39
    s_branch L_ssm_nopub
L_ssm_pub1:
    s_cmp_lg_u32 s50, 1
    s_cbranch_scc1 L_ssm_pub2
    v_accvgpr_read_b32 v44, a2
    v_accvgpr_read_b32 v45, a3
    v_accvgpr_read_b32 v52, a8
    v_accvgpr_read_b32 v53, a9
    v_pk_fma_f32 v[52:53], v[34:35], v[44:45], v[52:53] op_sel:[0,0,0] op_sel_hi:[0,1,1]
    v_pk_fma_f32 v[44:45], v[34:35], v[44:45], v[52:53] op_sel:[1,1,0] op_sel_hi:[1,0,1] neg_lo:[1,0,0]
    v_accvgpr_read_b32 v50, a14
    v_accvgpr_read_b32 v51, a15
    v_pk_fma_f32 v[50:51], v[34:35], v[44:45], v[50:51] op_sel:[0,0,0] op_sel_hi:[0,1,1]
    v_pk_fma_f32 v[44:45], v[34:35], v[44:45], v[50:51] op_sel:[1,1,0] op_sel_hi:[1,0,1] neg_lo:[1,0,0]
    v_accvgpr_read_b32 v52, a20
    v_accvgpr_read_b32 v53, a21
    v_pk_fma_f32 v[52:53], v[34:35], v[44:45], v[52:53] op_sel:[0,0,0] op_sel_hi:[0,1,1]
    v_pk_fma_f32 v[44:45], v[34:35], v[44:45], v[52:53] op_sel:[1,1,0] op_sel_hi:[1,0,1] neg_lo:[1,0,0]
    v_accvgpr_read_b32 v50, a26
    v_accvgpr_read_b32 v51, a27
    v_pk_fma_f32 v[50:51], v[34:35], v[44:45], v[50:51] op_sel:[0,0,0] op_sel_hi:[0,1,1]
    v_pk_fma_f32 v[44:45], v[34:35], v[44:45], v[50:51] op_sel:[1,1,0] op_sel_hi:[1,0,1] neg_lo:[1,0,0]
    v_accvgpr_read_b32 v52, a32
    v_accvgpr_read_b32 v53, a33
    v_pk_fma_f32 v[52:53], v[34:35], v[44:45], v[52:53] op_sel:[0,0,0] op_sel_hi:[0,1,1]
    v_pk_fma_f32 v[44:45], v[34:35], v[44:45], v[52:53] op_sel:[1,1,0] op_sel_hi:[1,0,1] neg_lo:[1,0,0]
    v_accvgpr_read_b32 v50, a38
    v_accvgpr_read_b32 v51, a39
    v_pk_fma_f32 v[50:51], v[34:35], v[44:45], v[50:51] op_sel:[0,0,0] op_sel_hi:[0,1,1]
    v_pk_fma_f32 v[44:45], v[34:35], v[44:45], v[50:51] op_sel:[1,1,0] op_sel_hi:[1,0,1] neg_lo:[1,0,0]
    v_accvgpr_read_b32 v52, a44
    v_accvgpr_read_b32 v53, a45
    v_pk_fma_f32 v[52:53], v[34:35], v[44:45], v[52:53] op_sel:[0,0,0] op_sel_hi:[0,1,1]
    v_pk_fma_f32 v[44:45], v[34:35], v[44:45], v[52:53] op_sel:[1,1,0] op_sel_hi:[1,0,1] neg_lo:[1,0,0]
    v_or_b32 v44, 1, v44
    buffer_store_dwordx2 v[44:45], v11, s[72:75], s96 offen offset:256 sc1
    v_mov_b32 v60, v40
    v_mov_b32 v61, v41
    s_add_u32 s96, s96, 256
    s_branch L_ssm_nopub
L_ssm_pub2:
    v_accvgpr_read_b32 v44, a4
    v_accvgpr_read_b32 v45, a5
    v_accvgpr_read_b32 v52, a10
    v_accvgpr_read_b32 v53, a11
    v_pk_fma_f32 v[52:53], v[36:37], v[44:45], v[52:53] op_sel:[0,0,0] op_sel_hi:[0,1,1]
    v_pk_fma_f32 v[44:45], v[36:37], v[44:45], v[52:53] op_sel:[1,1,0] op_sel_hi:[1,0,1] neg_lo:[1,0,0]
    v_accvgpr_read_b32 v50, a16
    v_accvgpr_read_b32 v51, a17
    v_pk_fma_f32 v[50:51], v[36:37], v[44:45], v[50:51] op_sel:[0,0,0] op_sel_hi:[0,1,1]
    v_pk_fma_f32 v[44:45], v[36:37], v[44:45], v[50:51] op_sel:[1,1,0] op_sel_hi:[1,0,1] neg_lo:[1,0,0]
    v_accvgpr_read_b32 v52, a22
    v_accvgpr_read_b32 v53, a23
    v_pk_fma_f32 v[52:53], v[36:37], v[44:45], v[52:53] op_sel:[0,0,0] op_sel_hi:[0,1,1]
    v_pk_fma_f32 v[44:45], v[36:37], v[44:45], v[52:53] op_sel:[1,1,0] op_sel_hi:[1,0,1] neg_lo:[1,0,0]
    v_accvgpr_read_b32 v50, a28
    v_accvgpr_read_b32 v51, a29
    v_pk_fma_f32 v[50:51], v[36:37], v[44:45], v[50:51] op_sel:[0,0,0] op_sel_hi:[0,1,1]
    v_pk_fma_f32 v[44:45], v[36:37], v[44:45], v[50:51] op_sel:[1,1,0] op_sel_hi:[1,0,1] neg_lo:[1,0,0]
    v_accvgpr_read_b32 v52, a34
    v_accvgpr_read_b32 v53, a35
    v_pk_fma_f32 v[52:53], v[36:37], v[44:45], v[52:53] op_sel:[0,0,0] op_sel_hi:[0,1,1]
    v_pk_fma_f32 v[44:45], v[36:37], v[44:45], v[52:53] op_sel:[1,1,0] op_sel_hi:[1,0,1] neg_lo:[1,0,0]
    v_accvgpr_read_b32 v50, a40
    v_accvgpr_read_b32 v51, a41
    v_pk_fma_f32 v[50:51], v[36:37], v[44:45], v[50:51] op_sel:[0,0,0] op_sel_hi:[0,1,1]
    v_pk_fma_f32 v[44:45], v[36:37], v[44:45], v[50:51] op_sel:[1,1,0] op_sel_hi:[1,0,1] neg_lo:[1,0,0]
    v_accvgpr_read_b32 v52, a46
    v_accvgpr_read_b32 v53, a47
    v_pk_fma_f32 v[52:53], v[36:37], v[44:45], v[52:53] op_sel:[0,0,0] op_sel_hi:[0,1,1]
    v_pk_fma_f32 v[44:45], v[36:37], v[44:45], v[52:53] op_sel:[1,1,0] op_sel_hi:[1,0,1] neg_lo:[1,0,0]
    v_or_b32 v44, 1, v44
    buffer_store_dwordx2 v[44:45], v11, s[72:75], s96 offen offset:512 sc1
    v_mov_b32 v60, v42
    v_mov_b32 v61, v43
    s_add_u32 s96, s96, 512
L_ssm_nopub:
    global_load_dword v10, v6, s[48:49] sc1
    v_mov_b32 v44, 0
    v_mov_b32 v45, 0
    v_mov_b32 v46, 0
    v_mov_b32 v47, 0
    v_mov_b32 v48, 0
    v_mov_b32 v49, 0
    s_add_u32 m0, s52, 15360
    s_add_u32 s82, s82, 368640
    buffer_load_dwordx4 v1, s[60:63], s82 offen offset:0 sc1 lds
    v_cmp_lt_u32 vcc, 0, v4
    s_mov_b64 exec, vcc
    v_accvgpr_read_b32 v50, a0
    v_accvgpr_read_b32 v51, a1
    v_accvgpr_read_b32 v52, a2
    v_accvgpr_read_b32 v53, a3
    v_accvgpr_read_b32 v54, a4
    v_accvgpr_read_b32 v55, a5
    v_pk_fma_f32 v[50:51], v[32:33], v[44:45], v[50:51] op_sel:[0,0,0] op_sel_hi:[0,1,1]
    v_pk_fma_f32 v[44:45], v[32:33], v[44:45], v[50:51] op_sel:[1,1,0] op_sel_hi:[1,0,1] neg_lo:[1,0,0]
    v_pk_fma_f32 v[52:53], v[34:35], v[46:47], v[52:53] op_sel:[0,0,0] op_sel_hi:[0,1,1]
    v_pk_fma_f32 v[46:47], v[34:35], v[46:47], v[52:53] op_sel:[1,1,0] op_sel_hi:[1,0,1] neg_lo:[1,0,0]
    v_pk_fma_f32 v[54:55], v[36:37], v[48:49], v[54:55] op_sel:[0,0,0] op_sel_hi:[0,1,1]
    v_pk_fma_f32 v[48:49], v[36:37], v[48:49], v[54:55] op_sel:[1,1,0] op_sel_hi:[1,0,1] neg_lo:[1,0,0]
    s_mov_b64 exec, -1
    buffer_load_dwordx4 v1, s[60:63], s82 offen offset:1024 sc1 lds
    v_cmp_lt_u32 vcc, 1, v4
    s_mov_b64 exec, vcc
    v_accvgpr_read_b32 v50, a6
    v_accvgpr_read_b32 v51, a7
    v_accvgpr_read_b32 v52, a8
    v_accvgpr_read_b32 v53, a9
    v_accvgpr_read_b32 v54, a10
    v_accvgpr_read_b32 v55, a11
    v_pk_fma_f32 v[50:51], v[32:33], v[44:45], v[50:51] op_sel:[0,0,0] op_sel_hi:[0,1,1]
    v_pk_fma_f32 v[44:45], v[32:33], v[44:45], v[50:51] op_sel:[1,1,0] op_sel_hi:[1,0,1] neg_lo:[1,0,0]
    v_pk_fma_f32 v[52:53], v[34:35], v[46:47], v[52:53] op_sel:[0,0,0] op_sel_hi:[0,1,1]
    v_pk_fma_f32 v[46:47], v[34:35], v[46:47], v[52:53] op_sel:[1,1,0] op_sel_hi:[1,0,1] neg_lo:[1,0,0]
    v_pk_fma_f32 v[54:55], v[36:37], v[48:49], v[54:55] op_sel:[0,0,0] op_sel_hi:[0,1,1]
    v_pk_fma_f32 v[48:49], v[36:37], v[48:49], v[54:55] op_sel:[1,1,0] op_sel_hi:[1,0,1] neg_lo:[1,0,0]
    s_mov_b64 exec, -1
    buffer_load_dwordx4 v1, s[60:63], s82 offen offset:2048 sc1 lds
    v_cmp_lt_u32 vcc, 2, v4
    s_mov_b64 exec, vcc
    v_accvgpr_read_b32 v50, a12
    v_accvgpr_read_b32 v51, a13
    v_accvgpr_read_b32 v52, a14
    v_accvgpr_read_b32 v53, a15
    v_accvgpr_read_b32 v54, a16
    v_accvgpr_read_b32 v55, a17
    v_pk_fma_f32 v[50:51], v[32:33], v[44:45], v[50:51] op_sel:[0,0,0] op_sel_hi:[0,1,1]
    v_pk_fma_f32 v[44:45], v[32:33], v[44:45], v[50:51] op_sel:[1,1,0] op_sel_hi:[1,0,1] neg_lo:[1,0,0]
    v_pk_fma_f32 v[52:53], v[34:35], v[46:47], v[52:53] op_sel:[0,0,0] op_sel_hi:[0,1,1]
    v_pk_fma_f32 v[46:47], v[34:35], v[46:47], v[52:53] op_sel:[1,1,0] op_sel_hi:[1,0,1] neg_lo:[1,0,0]
    v_pk_fma_f32 v[54:55], v[36:37], v[48:49], v[54:55] op_sel:[0,0,0] op_sel_hi:[0,1,1]
    v_pk_fma_f32 v[48:49], v[36:37], v[48:49], v[54:55] op_sel:[1,1,0] op_sel_hi:[1,0,1] neg_lo:[1,0,0]
    s_mov_b64 exec, -1
    s_cmp_eq_u32 s50, 3
    s_cbranch_scc1 L_lbsa1
    s_cmp_lt_u32 s99, 7
    s_cbranch_scc1 L_lbsa7
    s_sub_u32 s54, s96, 5376
    buffer_load_dwordx2 a[124:125], v11, s[72:75], s54 offen sc1
L_lbsa7:
    s_cmp_lt_u32 s99, 6
    s_cbranch_scc1 L_lbsa6
    s_sub_u32 s54, s96, 4608
    buffer_load_dwordx2 a[122:123], v11, s[72:75], s54 offen sc1
L_lbsa6:
    s_cmp_lt_u32 s99, 5
    s_cbranch_scc1 L_lbsa5
    s_sub_u32 s54, s96, 3840
    buffer_load_dwordx2 a[120:121], v11, s[72:75], s54 offen sc1
L_lbsa5:
    s_cmp_lt_u32 s99, 4
    s_cbranch_scc1 L_lbsa4
    s_sub_u32 s54, s96, 3072
    buffer_load_dwordx2 a[118:119], v11, s[72:75], s54 offen sc1
L_lbsa4:
    s_cmp_lt_u32 s99, 3
    s_cbranch_scc1 L_lbsa3
    s_sub_u32 s54, s96, 2304
    buffer_load_dwordx2 a[116:117], v11, s[72:75], s54 offen sc1
L_lbsa3:
    s_cmp_lt_u32 s99, 2
    s_cbranch_scc1 L_lbsa2
    s_sub_u32 s54, s96, 1536
    buffer_load_dwordx2 a[114:115], v11, s[72:75], s54 offen sc1
L_lbsa2:
    s_cmp_lt_u32 s99, 1
    s_cbranch_scc1 L_lbsa1
    s_sub_u32 s54, s96, 768
    buffer_load_dwordx2 a[112:113], v11, s[72:75], s54 offen sc1
L_lbsa1:
    v_cmp_lt_u32 vcc, 3, v4
    s_mov_b64 exec, vcc
    v_accvgpr_read_b32 v50, a18
    v_accvgpr_read_b32 v51, a19
    v_accvgpr_read_b32 v52, a20
    v_accvgpr_read_b32 v53, a21
    v_accvgpr_read_b32 v54, a22
    v_accvgpr_read_b32 v55, a23
    v_pk_fma_f32 v[50:51], v[32:33], v[44:45], v[50:51] op_sel:[0,0,0] op_sel_hi:[0,1,1]
    v_pk_fma_f32 v[44:45], v[32:33], v[44:45], v[50:51] op_sel:[1,1,0] op_sel_hi:[1,0,1] neg_lo:[1,0,0]
    v_pk_fma_f32 v[52:53], v[34:35], v[46:47], v[52:53] op_sel:[0,0,0] op_sel_hi:[0,1,1]
    v_pk_fma_f32 v[46:47], v[34:35], v[46:47], v[52:53] op_sel:[1,1,0] op_sel_hi:[1,0,1] neg_lo:[1,0,0]
    v_pk_fma_f32 v[54:55], v[36:37], v[48:49], v[54:55] op_sel:[0,0,0] op_sel_hi:[0,1,1]
    v_pk_fma_f32 v[48:49], v[36:37], v[48:49], v[54:55] op_sel:[1,1,0] op_sel_hi:[1,0,1] neg_lo:[1,0,0]
    s_mov_b64 exec, -1
    v_cmp_lt_u32 vcc, 4, v4
    s_mov_b64 exec, vcc
    v_accvgpr_read_b32 v50, a24
    v_accvgpr_read_b32 v51, a25
    v_accvgpr_read_b32 v52, a26
    v_accvgpr_read_b32 v53, a27
    v_accvgpr_read_b32 v54, a28
    v_accvgpr_read_b32 v55, a29
    v_pk_fma_f32 v[50:51], v[32:33], v[44:45], v[50:51] op_sel:[0,0,0] op_sel_hi:[0,1,1]
    v_pk_fma_f32 v[44:45], v[32:33], v[44:45], v[50:51] op_sel:[1,1,0] op_sel_hi:[1,0,1] neg_lo:[1,0,0]
    v_pk_fma_f32 v[52:53], v[34:35], v[46:47], v[52:53] op_sel:[0,0,0] op_sel_hi:[0,1,1]
    v_pk_fma_f32 v[46:47], v[34:35], v[46:47], v[52:53] op_sel:[1,1,0] op_sel_hi:[1,0,1] neg_lo:[1,0,0]
    v_pk_fma_f32 v[54:55], v[36:37], v[48:49], v[54:55] op_sel:[0,0,0] op_sel_hi:[0,1,1]
    v_pk_fma_f32 v[48:49], v[36:37], v[48:49], v[54:55] op_sel:[1,1,0] op_sel_hi:[1,0,1] neg_lo:[1,0,0]
    s_mov_b64 exec, -1
    s_add_u32 s45, s44, 196608
    buffer_store_dwordx4 a[128:131], v1, s[68:71], s45 offen offset:0 sc1
    buffer_store_dwordx4 a[128:131], v1, s[68:71], s45 offen offset:1024 sc1
    buffer_store_dwordx4 a[128:131], v1, s[68:71], s45 offen offset:2048 sc1
    v_cmp_lt_u32 vcc, 5, v4
    s_mov_b64 exec, vcc
    v_accvgpr_read_b32 v50, a30
    v_accvgpr_read_b32 v51, a31
    v_accvgpr_read_b32 v52, a32
    v_accvgpr_read_b32 v53, a33
    v_accvgpr_read_b32 v54, a34
    v_accvgpr_read_b32 v55, a35
    v_pk_fma_f32 v[50:51], v[32:33], v[44:45], v[50:51] op_sel:[0,0,0] op_sel_hi:[0,1,1]
    v_pk_fma_f32 v[44:45], v[32:33], v[44:45], v[50:51] op_sel:[1,1,0] op_sel_hi:[1,0,1] neg_lo:[1,0,0]
    v_pk_fma_f32 v[52:53], v[34:35], v[46:47], v[52:53] op_sel:[0,0,0] op_sel_hi:[0,1,1]
    v_pk_fma_f32 v[46:47], v[34:35], v[46:47], v[52:53] op_sel:[1,1,0] op_sel_hi:[1,0,1] neg_lo:[1,0,0]
    v_pk_fma_f32 v[54:55], v[36:37], v[48:49], v[54:55] op_sel:[0,0,0] op_sel_hi:[0,1,1]
    v_pk_fma_f32 v[48:49], v[36:37], v[48:49], v[54:55] op_sel:[1,1,0] op_sel_hi:[1,0,1] neg_lo:[1,0,0]
    s_mov_b64 exec, -1
    s_add_u32 s45, s44, 294912
    buffer_store_dwordx4 a[128:131], v1, s[68:71], s45 offen offset:0 sc1
    buffer_store_dwordx4 a[128:131], v1, s[68:71], s45 offen offset:1024 sc1
    buffer_store_dwordx4 a[128:131], v1, s[68:71], s45 offen offset:2048 sc1
    v_cmp_lt_u32 vcc, 6, v4
    s_mov_b64 exec, vcc
    v_accvgpr_read_b32 v50, a36
    v_accvgpr_read_b32 v51, a37
    v_accvgpr_read_b32 v52, a38
    v_accvgpr_read_b32 v53, a39
    v_accvgpr_read_b32 v54, a40
    v_accvgpr_read_b32 v55, a41
    v_pk_fma_f32 v[50:51], v[32:33], v[44:45], v[50:51] op_sel:[0,0,0] op_sel_hi:[0,1,1]
    v_pk_fma_f32 v[44:45], v[32:33], v[44:45], v[50:51] op_sel:[1,1,0] op_sel_hi:[1,0,1] neg_lo:[1,0,0]
    v_pk_fma_f32 v[52:53], v[34:35], v[46:47], v[52:53] op_sel:[0,0,0] op_sel_hi:[0,1,1]
    v_pk_fma_f32 v[46:47], v[34:35], v[46:47], v[52:53] op_sel:[1,1,0] op_sel_hi:[1,0,1] neg_lo:[1,0,0]
    v_pk_fma_f32 v[54:55], v[36:37], v[48:49], v[54:55] op_sel:[0,0,0] op_sel_hi:[0,1,1]
    v_pk_fma_f32 v[48:49], v[36:37], v[48:49], v[54:55] op_sel:[1,1,0] op_sel_hi:[1,0,1] neg_lo:[1,0,0]
    s_mov_b64 exec, -1
    s_cmp_eq_u32 s50, 3
    s_cbranch_scc1 L_lb_done
    s_mov_b32 s101, 0x40000
    s_waitcnt vmcnt(6)
L_lb_try:
    v_mov_b32 v50, 0
    v_mov_b32 v51, 0
    v_mov_b32 v56, -1
    s_cmp_lt_u32 s99, 7
    s_cbranch_scc1 L_lbc7
    v_accvgpr_read_b32 v32, a124
    v_accvgpr_read_b32 v33, a125
    v_min_u32 v56, v56, v32
    v_pk_fma_f32 v[32:33], v[60:61], v[50:51], v[32:33] op_sel:[0,0,0] op_sel_hi:[0,1,1]
    v_pk_fma_f32 v[50:51], v[60:61], v[50:51], v[32:33] op_sel:[1,1,0] op_sel_hi:[1,0,1] neg_lo:[1,0,0]
L_lbc7:
    s_cmp_lt_u32 s99, 6
    s_cbranch_scc1 L_lbc6
    v_accvgpr_read_b32 v32, a122
    s_branch L_sskip16
L_stub16:
    s_setpc_b64 s[100:101]
L_sskip16:
    v_accvgpr_read_b32 v33, a123
    v_min_u32 v56, v56, v32
    v_pk_fma_f32 v[32:33], v[60:61], v[50:51], v[32:33] op_sel:[0,0,0] op_sel_hi:[0,1,1]
    v_pk_fma_f32 v[50:51], v[60:61], v[50:51], v[32:33] op_sel:[1,1,0] op_sel_hi:[1,0,1] neg_lo:[1,0,0]
L_lbc6:
    s_cmp_lt_u32 s99, 5
    s_cbranch_scc1 L_lbc5
    v_accvgpr_read_b32 v32, a120
    v_accvgpr_read_b32 v33, a121
    v_min_u32 v56, v56, v32
    v_pk_fma_f32 v[32:33], v[60:61], v[50:51], v[32:33] op_sel:[0,0,0] op_sel_hi:[0,1,1]
    v_pk_fma_f32 v[50:51], v[60:61], v[50:51], v[32:33] op_sel:[1,1,0] op_sel_hi:[1,0,1] neg_lo:[1,0,0]
L_lbc5:
    s_cmp_lt_u32 s99, 4
    s_cbranch_scc1 L_lbc4
    v_accvgpr_read_b32 v32, a118
    v_accvgpr_read_b32 v33, a119
    v_min_u32 v56, v56, v32
    v_pk_fma_f32 v[32:33], v[60:61], v[50:51], v[32:33] op_sel:[0,0,0] op_sel_hi:[0,1,1]
    v_pk_fma_f32 v[50:51], v[60:61], v[50:51], v[32:33] op_sel:[1,1,0] op_sel_hi:[1,0,1] neg_lo:[1,0,0]
L_lbc4:
    s_cmp_lt_u32 s99, 3
    s_cbranch_scc1 L_lbc3
    v_accvgpr_read_b32 v32, a116
    v_accvgpr_read_b32 v33, a117
    v_min_u32 v56, v56, v32
    v_pk_fma_f32 v[32:33], v[60:61], v[50:51], v[32:33] op_sel:[0,0,0] op_sel_hi:[0,1,1]
    v_pk_fma_f32 v[50:51], v[60:61], v[50:51], v[32:33] op_sel:[1,1,0] op_sel_hi:[1,0,1] neg_lo:[1,0,0]
L_lbc3:
    s_cmp_lt_u32 s99, 2
    s_cbranch_scc1 L_lbc2
    v_accvgpr_read_b32 v32, a114
    v_accvgpr_read_b32 v33, a115
    v_min_u32 v56, v56, v32
    v_pk_fma_f32 v[32:33], v[60:61], v[50:51], v[32:33] op_sel:[0,0,0] op_sel_hi:[0,1,1]
    v_pk_fma_f32 v[50:51], v[60:61], v[50:51], v[32:33] op_sel:[1,1,0] op_sel_hi:[1,0,1] neg_lo:[1,0,0]
L_lbc2:
    s_cmp_lt_u32 s99, 1
    s_cbranch_scc1 L_lbc1
    v_accvgpr_read_b32 v32, a112
    v_accvgpr_read_b32 v33, a113
    v_min_u32 v56, v56, v32
    v_pk_fma_f32 v[32:33], v[60:61], v[50:51], v[32:33] op_sel:[0,0,0] op_sel_hi:[0,1,1]
    v_pk_fma_f32 v[50:51], v[60:61], v[50:51], v[32:33] op_sel:[1,1,0] op_sel_hi:[1,0,1] neg_lo:[1,0,0]
L_lbc1:
    v_cmp_eq_u32 vcc, 0, v56
    s_nop 1
    s_cmp_eq_u64 vcc, 0
    s_cbranch_scc1 L_lb_ok
    s_cmp_lt_u32 s99, 7
    s_cbranch_scc1 L_lbsb7
    s_sub_u32 s54, s96, 5376
    buffer_load_dwordx2 a[124:125], v11, s[72:75], s54 offen sc1
L_lbsb7:
    s_cmp_lt_u32 s99, 6
    s_cbranch_scc1 L_lbsb6
    s_sub_u32 s54, s96, 4608
    buffer_load_dwordx2 a[122:123], v11, s[72:75], s54 offen sc1
L_lbsb6:
    s_cmp_lt_u32 s99, 5
    s_cbranch_scc1 L_lbsb5
    s_sub_u32 s54, s96, 3840
    buffer_load_dwordx2 a[120:121], v11, s[72:75], s54 offen sc1
L_lbsb5:
    s_cmp_lt_u32 s99, 4
    s_cbranch_scc1 L_lbsb4
    s_sub_u32 s54, s96, 3072
    buffer_load_dwordx2 a[118:119], v11, s[72:75], s54 offen sc1
L_lbsb4:
    s_cmp_lt_u32 s99, 3
    s_cbranch_scc1 L_lbsb3
    s_sub_u32 s54, s96, 2304
    buffer_load_dwordx2 a[116:117], v11, s[72:75], s54 offen sc1
L_lbsb3:
    s_cmp_lt_u32 s99, 2
    s_cbranch_scc1 L_lbsb2
    s_sub_u32 s54, s96, 1536
    buffer_load_dwordx2 a[114:115], v11, s[72:75], s54 offen sc1
L_lbsb2:
    s_cmp_lt_u32 s99, 1
    s_cbranch_scc1 L_lbsb1
    s_sub_u32 s54, s96, 768
    buffer_load_dwordx2 a[112:113], v11, s[72:75], s54 offen sc1
L_lbsb1:
    s_waitcnt vmcnt(0)
    s_sub_u32 s101, s101, 1
    s_cmp_lg_u32 s101, 0
    s_cbranch_scc1 L_lb_try
L_lb_ok:
    ds_write_b64 v57, v[50:51] offset:27648
    s_waitcnt lgkmcnt(0)
L_lb_done:
    s_barrier
    ds_read_b64 v[50:51], v11 offset:27648
    ds_read_b64 v[52:53], v59 offset:27648
    ds_read_b64 v[54:55], v3 offset:27648
    s_waitcnt vmcnt(9)
    v_cmp_gt_u32 vcc, 1, v10
    s_cbranch_vccnz L_poll15
L_fok15:
    s_waitcnt lgkmcnt(0)
    v_fma_f32 v32, v20, v50, v44
    v_fma_f32 v38, v20, v51, v45
    v_accvgpr_read_b32 v33, a154
    v_accvgpr_read_b32 v39, a155
    v_fma_f32 v32, -v21, v51, v32
    v_fma_f32 v38, v21, v50, v38
    v_fma_f32 v33, v26, v32, v33
    v_fma_f32 v39, v26, v38, v39
    v_fma_f32 v33, -v27, v38, v33
    v_fma_f32 v39, v27, v32, v39
    v_fma_f32 v34, v22, v52, v46
    v_fma_f32 v40, v22, v53, v47
    v_accvgpr_read_b32 v35, a156
    v_accvgpr_read_b32 v41, a157
    v_fma_f32 v34, -v23, v53, v34
    v_fma_f32 v40, v23, v52, v40
    v_fma_f32 v35, v28, v34, v35
    v_fma_f32 v41, v28, v40, v41
    v_fma_f32 v35, -v29, v40, v35
    v_fma_f32 v41, v29, v34, v41
    v_fma_f32 v36, v24, v54, v48
    v_fma_f32 v42, v24, v55, v49
    v_accvgpr_read_b32 v37, a158
    v_accvgpr_read_b32 v43, a159
    v_fma_f32 v36, -v25, v55, v36
    v_fma_f32 v42, v25, v54, v42
    v_fma_f32 v37, v30, v36, v37
    v_fma_f32 v43, v30, v42, v43
    v_fma_f32 v37, -v31, v42, v37
    v_fma_f32 v43, v31, v36, v43
    s_add_u32 s72, s48, 30228480
    s_addc_u32 s73, s49, 0
    s_mov_b32 s74, 23609344
    s_mov_b32 s75, 0x20000
    v_add_u32 v21, 81920, v5
    v_xor_b32 v22, 32, v5
    v_add_u32 v23, 81920, v22
    v_xor_b32 v24, 64, v5
    v_add_u32 v25, 81920, v24
    v_xor_b32 v26, 96, v5
    v_add_u32 v27, 81920, v26
    v_pk_fma_f32 v[64:65], v[14:15], v[32:33], v[64:65] op_sel:[0,0,0] op_sel_hi:[0,1,1]
    v_pk_fma_f32 v[96:97], v[14:15], v[38:39], v[96:97] op_sel:[0,0,0] op_sel_hi:[0,1,1]
    v_pk_fma_f32 v[64:65], v[14:15], v[38:39], v[64:65] op_sel:[1,0,0] op_sel_hi:[1,1,1] neg_lo:[1,0,0] neg_hi:[1,0,0]
    v_pk_fma_f32 v[96:97], v[14:15], v[32:33], v[96:97] op_sel:[1,0,0] op_sel_hi:[1,1,1]
    v_pk_fma_f32 v[66:67], v[14:15], v[64:65], v[66:67] op_sel:[0,0,0] op_sel_hi:[0,1,1]
    v_pk_fma_f32 v[98:99], v[14:15], v[96:97], v[98:99] op_sel:[0,0,0] op_sel_hi:[0,1,1]
    v_pk_fma_f32 v[66:67], v[14:15], v[96:97], v[66:67] op_sel:[1,0,0] op_sel_hi:[1,1,1] neg_lo:[1,0,0] neg_hi:[1,0,0]
    v_pk_fma_f32 v[98:99], v[14:15], v[64:65], v[98:99] op_sel:[1,0,0] op_sel_hi:[1,1,1]
    s_add_u32 s83, s76, 36864
    buffer_load_dwordx4 a[48:51], v1, s[68:71], s83 offen offset:0 sc1
    v_pk_fma_f32 v[68:69], v[14:15], v[66:67], v[68:69] op_sel:[0,0,0] op_sel_hi:[0,1,1]
    v_pk_fma_f32 v[100:101], v[14:15], v[98:99], v[100:101] op_sel:[0,0,0] op_sel_hi:[0,1,1]
    v_pk_fma_f32 v[68:69], v[14:15], v[98:99], v[68:69] op_sel:[1,0,0] op_sel_hi:[1,1,1] neg_lo:[1,0,0] neg_hi:[1,0,0]
    v_pk_fma_f32 v[100:101], v[14:15], v[66:67], v[100:101] op_sel:[1,0,0] op_sel_hi:[1,1,1]
    v_pk_fma_f32 v[70:71], v[14:15], v[68:69], v[70:71] op_sel:[0,0,0] op_sel_hi:[0,1,1]
    v_pk_fma_f32 v[102:103], v[14:15], v[100:101], v[102:103] op_sel:[0,0,0] op_sel_hi:[0,1,1]
    v_pk_fma_f32 v[70:71], v[14:15], v[100:101], v[70:71] op_sel:[1,0,0] op_sel_hi:[1,1,1] neg_lo:[1,0,0] neg_hi:[1,0,0]
    v_pk_fma_f32 v[102:103], v[14:15], v[68:69], v[102:103] op_sel:[1,0,0] op_sel_hi:[1,1,1]
    buffer_load_dwordx4 a[52:55], v1, s[68:71], s83 offen offset:1024 sc1
    v_pk_fma_f32 v[72:73], v[14:15], v[70:71], v[72:73] op_sel:[0,0,0] op_sel_hi:[0,1,1]
    v_pk_fma_f32 v[104:105], v[14:15], v[102:103], v[104:105] op_sel:[0,0,0] op_sel_hi:[0,1,1]
    v_pk_fma_f32 v[72:73], v[14:15], v[102:103], v[72:73] op_sel:[1,0,0] op_sel_hi:[1,1,1] neg_lo:[1,0,0] neg_hi:[1,0,0]
    v_pk_fma_f32 v[104:105], v[14:15], v[70:71], v[104:105] op_sel:[1,0,0] op_sel_hi:[1,1,1]
    v_pk_fma_f32 v[74:75], v[14:15], v[72:73], v[74:75] op_sel:[0,0,0] op_sel_hi:[0,1,1]
    v_pk_fma_f32 v[106:107], v[14:15], v[104:105], v[106:107] op_sel:[0,0,0] op_sel_hi:[0,1,1]
    v_pk_fma_f32 v[74:75], v[14:15], v[104:105], v[74:75] op_sel:[1,0,0] op_sel_hi:[1,1,1] neg_lo:[1,0,0] neg_hi:[1,0,0]
    v_pk_fma_f32 v[106:107], v[14:15], v[72:73], v[106:107] op_sel:[1,0,0] op_sel_hi:[1,1,1]
    buffer_load_dwordx4 a[56:59], v1, s[68:71], s83 offen offset:2048 sc1
    v_pk_fma_f32 v[76:77], v[14:15], v[74:75], v[76:77] op_sel:[0,0,0] op_sel_hi:[0,1,1]
    v_pk_fma_f32 v[108:109], v[14:15], v[106:107], v[108:109] op_sel:[0,0,0] op_sel_hi:[0,1,1]
    v_pk_fma_f32 v[76:77], v[14:15], v[106:107], v[76:77] op_sel:[1,0,0] op_sel_hi:[1,1,1] neg_lo:[1,0,0] neg_hi:[1,0,0]
    v_pk_fma_f32 v[108:109], v[14:15], v[74:75], v[108:109] op_sel:[1,0,0] op_sel_hi:[1,1,1]
    v_pk_fma_f32 v[78:79], v[14:15], v[76:77], v[78:79] op_sel:[0,0,0] op_sel_hi:[0,1,1]
    v_pk_fma_f32 v[110:111], v[14:15], v[108:109], v[110:111] op_sel:[0,0,0] op_sel_hi:[0,1,1]
    v_pk_fma_f32 v[78:79], v[14:15], v[108:109], v[78:79] op_sel:[1,0,0] op_sel_hi:[1,1,1] neg_lo:[1,0,0] neg_hi:[1,0,0]
    v_pk_fma_f32 v[110:111], v[14:15], v[76:77], v[110:111] op_sel:[1,0,0] op_sel_hi:[1,1,1]
    buffer_load_dwordx4 a[60:63], v1, s[68:71], s83 offen offset:3072 sc1
    v_pk_fma_f32 v[80:81], v[14:15], v[78:79], v[80:81] op_sel:[0,0,0] op_sel_hi:[0,1,1]
    v_pk_fma_f32 v[112:113], v[14:15], v[110:111], v[112:113] op_sel:[0,0,0] op_sel_hi:[0,1,1]
    v_pk_fma_f32 v[80:81], v[14:15], v[110:111], v[80:81] op_sel:[1,0,0] op_sel_hi:[1,1,1] neg_lo:[1,0,0] neg_hi:[1,0,0]
    v_pk_fma_f32 v[112:113], v[14:15], v[78:79], v[112:113] op_sel:[1,0,0] op_sel_hi:[1,1,1]
    v_pk_fma_f32 v[82:83], v[14:15], v[80:81], v[82:83] op_sel:[0,0,0] op_sel_hi:[0,1,1]
    v_pk_fma_f32 v[114:115], v[14:15], v[112:113], v[114:115] op_sel:[0,0,0] op_sel_hi:[0,1,1]
    v_pk_fma_f32 v[82:83], v[14:15], v[112:113], v[82:83] op_sel:[1,0,0] op_sel_hi:[1,1,1] neg_lo:[1,0,0] neg_hi:[1,0,0]
    v_pk_fma_f32 v[114:115], v[14:15], v[80:81], v[114:115] op_sel:[1,0,0] op_sel_hi:[1,1,1]
    s_add_u32 s83, s76, 40960
    buffer_load_dwordx4 a[64:67], v1, s[68:71], s83 offen offset:0 sc1
    v_pk_fma_f32 v[84:85], v[14:15], v[82:83], v[84:85] op_sel:[0,0,0] op_sel_hi:[0,1,1]
    v_pk_fma_f32 v[116:117], v[14:15], v[114:115], v[116:117] op_sel:[0,0,0] op_sel_hi:[0,1,1]
    v_pk_fma_f32 v[84:85], v[14:15], v[114:115], v[84:85] op_sel:[1,0,0] op_sel_hi:[1,1,1] neg_lo:[1,0,0] neg_hi:[1,0,0]
    v_pk_fma_f32 v[116:117], v[14:15], v[82:83], v[116:117] op_sel:[1,0,0] op_sel_hi:[1,1,1]
    v_pk_fma_f32 v[86:87], v[14:15], v[84:85], v[86:87] op_sel:[0,0,0] op_sel_hi:[0,1,1]
    v_pk_fma_f32 v[118:119], v[14:15], v[116:117], v[118:119] op_sel:[0,0,0] op_sel_hi:[0,1,1]
    v_pk_fma_f32 v[86:87], v[14:15], v[116:117], v[86:87] op_sel:[1,0,0] op_sel_hi:[1,1,1] neg_lo:[1,0,0] neg_hi:[1,0,0]
    v_pk_fma_f32 v[118:119], v[14:15], v[84:85], v[118:119] op_sel:[1,0,0] op_sel_hi:[1,1,1]
    buffer_load_dwordx4 a[68:71], v1, s[68:71], s83 offen offset:1024 sc1
    v_pk_fma_f32 v[88:89], v[14:15], v[86:87], v[88:89] op_sel:[0,0,0] op_sel_hi:[0,1,1]
    v_pk_fma_f32 v[120:121], v[14:15], v[118:119], v[120:121] op_sel:[0,0,0] op_sel_hi:[0,1,1]
    v_pk_fma_f32 v[88:89], v[14:15], v[118:119], v[88:89] op_sel:[1,0,0] op_sel_hi:[1,1,1] neg_lo:[1,0,0] neg_hi:[1,0,0]
    v_pk_fma_f32 v[120:121], v[14:15], v[86:87], v[120:121] op_sel:[1,0,0] op_sel_hi:[1,1,1]
    v_pk_fma_f32 v[90:91], v[14:15], v[88:89], v[90:91] op_sel:[0,0,0] op_sel_hi:[0,1,1]
    v_pk_fma_f32 v[122:123], v[14:15], v[120:121], v[122:123] op_sel:[0,0,0] op_sel_hi:[0,1,1]
    v_pk_fma_f32 v[90:91], v[14:15], v[120:121], v[90:91] op_sel:[1,0,0] op_sel_hi:[1,1,1] neg_lo:[1,0,0] neg_hi:[1,0,0]
    v_pk_fma_f32 v[122:123], v[14:15], v[88:89], v[122:123] op_sel:[1,0,0] op_sel_hi:[1,1,1]
    s_add_u32 s83, s76, 43008
    buffer_load_dwordx4 a[72:75], v1, s[68:71], s83 offen offset:0 sc1
    v_pk_fma_f32 v[92:93], v[14:15], v[90:91], v[92:93] op_sel:[0,0,0] op_sel_hi:[0,1,1]
    v_pk_fma_f32 v[124:125], v[14:15], v[122:123], v[124:125] op_sel:[0,0,0] op_sel_hi:[0,1,1]
    v_pk_fma_f32 v[92:93], v[14:15], v[122:123], v[92:93] op_sel:[1,0,0] op_sel_hi:[1,1,1] neg_lo:[1,0,0] neg_hi:[1,0,0]
    v_pk_fma_f32 v[124:125], v[14:15], v[90:91], v[124:125] op_sel:[1,0,0] op_sel_hi:[1,1,1]
    v_pk_fma_f32 v[94:95], v[14:15], v[92:93], v[94:95] op_sel:[0,0,0] op_sel_hi:[0,1,1]
    v_pk_fma_f32 v[126:127], v[14:15], v[124:125], v[126:127] op_sel:[0,0,0] op_sel_hi:[0,1,1]
    v_pk_fma_f32 v[94:95], v[14:15], v[124:125], v[94:95] op_sel:[1,0,0] op_sel_hi:[1,1,1] neg_lo:[1,0,0] neg_hi:[1,0,0]
    v_pk_fma_f32 v[126:127], v[14:15], v[92:93], v[126:127] op_sel:[1,0,0] op_sel_hi:[1,1,1]
    buffer_load_dwordx4 a[76:79], v1, s[68:71], s83 offen offset:1024 sc1
    v_cvt_pk_bf16_f32 v44, v64, v66
    v_cvt_pk_bf16_f32 v45, v68, v70
    v_cvt_pk_bf16_f32 v46, v72, v74
    v_cvt_pk_bf16_f32 v47, v76, v78
    ds_write_b128 v58, v[44:47] offset:30720
    v_pk_fma_f32 v[128:129], v[16:17], v[34:35], v[128:129] op_sel:[0,0,0] op_sel_hi:[0,1,1]
    v_pk_fma_f32 v[160:161], v[16:17], v[40:41], v[160:161] op_sel:[0,0,0] op_sel_hi:[0,1,1]
    v_pk_fma_f32 v[128:129], v[16:17], v[40:41], v[128:129] op_sel:[1,0,0] op_sel_hi:[1,1,1] neg_lo:[1,0,0] neg_hi:[1,0,0]
    v_pk_fma_f32 v[160:161], v[16:17], v[34:35], v[160:161] op_sel:[1,0,0] op_sel_hi:[1,1,1]
    v_pk_fma_f32 v[130:131], v[16:17], v[128:129], v[130:131] op_sel:[0,0,0] op_sel_hi:[0,1,1]
    v_pk_fma_f32 v[162:163], v[16:17], v[160:161], v[162:163] op_sel:[0,0,0] op_sel_hi:[0,1,1]
    v_pk_fma_f32 v[130:131], v[16:17], v[160:161], v[130:131] op_sel:[1,0,0] op_sel_hi:[1,1,1] neg_lo:[1,0,0] neg_hi:[1,0,0]
    v_pk_fma_f32 v[162:163], v[16:17], v[128:129], v[162:163] op_sel:[1,0,0] op_sel_hi:[1,1,1]
    v_cvt_pk_bf16_f32 v48, v80, v82
    v_cvt_pk_bf16_f32 v49, v84, v86
    v_cvt_pk_bf16_f32 v50, v88, v90
    v_cvt_pk_bf16_f32 v51, v92, v94
    ds_write_b128 v58, v[48:51] offset:30736
    v_pk_fma_f32 v[132:133], v[16:17], v[130:131], v[132:133] op_sel:[0,0,0] op_sel_hi:[0,1,1]
    v_pk_fma_f32 v[164:165], v[16:17], v[162:163], v[164:165] op_sel:[0,0,0] op_sel_hi:[0,1,1]
    v_pk_fma_f32 v[132:133], v[16:17], v[162:163], v[132:133] op_sel:[1,0,0] op_sel_hi:[1,1,1] neg_lo:[1,0,0] neg_hi:[1,0,0]
    v_pk_fma_f32 v[164:165], v[16:17], v[130:131], v[164:165] op_sel:[1,0,0] op_sel_hi:[1,1,1]
    v_pk_fma_f32 v[134:135], v[16:17], v[132:133], v[134:135] op_sel:[0,0,0] op_sel_hi:[0,1,1]
    v_pk_fma_f32 v[166:167], v[16:17], v[164:165], v[166:167] op_sel:[0,0,0] op_sel_hi:[0,1,1]
    v_pk_fma_f32 v[134:135], v[16:17], v[164:165], v[134:135] op_sel:[1,0,0] op_sel_hi:[1,1,1] neg_lo:[1,0,0] neg_hi:[1,0,0]
    v_pk_fma_f32 v[166:167], v[16:17], v[132:133], v[166:167] op_sel:[1,0,0] op_sel_hi:[1,1,1]
    v_cvt_pk_bf16_f32 v52, v65, v67
    v_cvt_pk_bf16_f32 v53, v69, v71
    v_cvt_pk_bf16_f32 v54, v73, v75
    v_cvt_pk_bf16_f32 v55, v77, v79
    ds_write_b128 v58, v[52:55] offset:30752
    v_pk_fma_f32 v[136:137], v[16:17], v[134:135], v[136:137] op_sel:[0,0,0] op_sel_hi:[0,1,1]
    v_pk_fma_f32 v[168:169], v[16:17], v[166:167], v[168:169] op_sel:[0,0,0] op_sel_hi:[0,1,1]
    v_pk_fma_f32 v[136:137], v[16:17], v[166:167], v[136:137] op_sel:[1,0,0] op_sel_hi:[1,1,1] neg_lo:[1,0,0] neg_hi:[1,0,0]
    v_pk_fma_f32 v[168:169], v[16:17], v[134:135], v[168:169] op_sel:[1,0,0] op_sel_hi:[1,1,1]
    v_pk_fma_f32 v[138:139], v[16:17], v[136:137], v[138:139] op_sel:[0,0,0] op_sel_hi:[0,1,1]
    v_pk_fma_f32 v[170:171], v[16:17], v[168:169], v[170:171] op_sel:[0,0,0] op_sel_hi:[0,1,1]
    v_pk_fma_f32 v[138:139], v[16:17], v[168:169], v[138:139] op_sel:[1,0,0] op_sel_hi:[1,1,1] neg_lo:[1,0,0] neg_hi:[1,0,0]
    v_pk_fma_f32 v[170:171], v[16:17], v[136:137], v[170:171] op_sel:[1,0,0] op_sel_hi:[1,1,1]
    v_cvt_pk_bf16_f32 v44, v81, v83
    v_cvt_pk_bf16_f32 v45, v85, v87
    v_cvt_pk_bf16_f32 v46, v89, v91
    v_cvt_pk_bf16_f32 v47, v93, v95
    ds_write_b128 v58, v[44:47] offset:30768
    v_pk_fma_f32 v[140:141], v[16:17], v[138:139], v[140:141] op_sel:[0,0,0] op_sel_hi:[0,1,1]
    v_pk_fma_f32 v[172:173], v[16:17], v[170:171], v[172:173] op_sel:[0,0,0] op_sel_hi:[0,1,1]
    v_pk_fma_f32 v[140:141], v[16:17], v[170:171], v[140:141] op_sel:[1,0,0] op_sel_hi:[1,1,1] neg_lo:[1,0,0] neg_hi:[1,0,0]
    v_pk_fma_f32 v[172:173], v[16:17], v[138:139], v[172:173] op_sel:[1,0,0] op_sel_hi:[1,1,1]
    v_pk_fma_f32 v[142:143], v[16:17], v[140:141], v[142:143] op_sel:[0,0,0] op_sel_hi:[0,1,1]
    v_pk_fma_f32 v[174:175], v[16:17], v[172:173], v[174:175] op_sel:[0,0,0] op_sel_hi:[0,1,1]
    v_pk_fma_f32 v[142:143], v[16:17], v[172:173], v[142:143] op_sel:[1,0,0] op_sel_hi:[1,1,1] neg_lo:[1,0,0] neg_hi:[1,0,0]
    v_pk_fma_f32 v[174:175], v[16:17], v[140:141], v[174:175] op_sel:[1,0,0] op_sel_hi:[1,1,1]
    v_cvt_pk_bf16_f32 v48, v96, v98
    v_cvt_pk_bf16_f32 v49, v100, v102
    v_cvt_pk_bf16_f32 v50, v104, v106
    v_cvt_pk_bf16_f32 v51, v108, v110
    ds_write_b128 v58, v[48:51] offset:33024
    v_pk_fma_f32 v[144:145], v[16:17], v[142:143], v[144:145] op_sel:[0,0,0] op_sel_hi:[0,1,1]
    v_pk_fma_f32 v[176:177], v[16:17], v[174:175], v[176:177] op_sel:[0,0,0] op_sel_hi:[0,1,1]
    v_pk_fma_f32 v[144:145], v[16:17], v[174:175], v[144:145] op_sel:[1,0,0] op_sel_hi:[1,1,1] neg_lo:[1,0,0] neg_hi:[1,0,0]
    v_pk_fma_f32 v[176:177], v[16:17], v[142:143], v[176:177] op_sel:[1,0,0] op_sel_hi:[1,1,1]
    v_pk_fma_f32 v[146:147], v[16:17], v[144:145], v[146:147] op_sel:[0,0,0] op_sel_hi:[0,1,1]
    v_pk_fma_f32 v[178:179], v[16:17], v[176:177], v[178:179] op_sel:[0,0,0] op_sel_hi:[0,1,1]
    v_pk_fma_f32 v[146:147], v[16:17], v[176:177], v[146:147] op_sel:[1,0,0] op_sel_hi:[1,1,1] neg_lo:[1,0,0] neg_hi:[1,0,0]
    v_pk_fma_f32 v[178:179], v[16:17], v[144:145], v[178:179] op_sel:[1,0,0] op_sel_hi:[1,1,1]
    v_cvt_pk_bf16_f32 v52, v112, v114
    v_cvt_pk_bf16_f32 v53, v116, v118
    v_cvt_pk_bf16_f32 v54, v120, v122
    v_cvt_pk_bf16_f32 v55, v124, v126
    ds_write_b128 v58, v[52:55] offset:33040
    v_pk_fma_f32 v[148:149], v[16:17], v[146:147], v[148:149] op_sel:[0,0,0] op_sel_hi:[0,1,1]
    v_pk_fma_f32 v[180:181], v[16:17], v[178:179], v[180:181] op_sel:[0,0,0] op_sel_hi:[0,1,1]
    v_pk_fma_f32 v[148:149], v[16:17], v[178:179], v[148:149] op_sel:[1,0,0] op_sel_hi:[1,1,1] neg_lo:[1,0,0] neg_hi:[1,0,0]
    v_pk_fma_f32 v[180:181], v[16:17], v[146:147], v[180:181] op_sel:[1,0,0] op_sel_hi:[1,1,1]
    v_pk_fma_f32 v[150:151], v[16:17], v[148:149], v[150:151] op_sel:[0,0,0] op_sel_hi:[0,1,1]
    v_pk_fma_f32 v[182:183], v[16:17], v[180:181], v[182:183] op_sel:[0,0,0] op_sel_hi:[0,1,1]
    v_pk_fma_f32 v[150:151], v[16:17], v[180:181], v[150:151] op_sel:[1,0,0] op_sel_hi:[1,1,1] neg_lo:[1,0,0] neg_hi:[1,0,0]
    v_pk_fma_f32 v[182:183], v[16:17], v[148:149], v[182:183] op_sel:[1,0,0] op_sel_hi:[1,1,1]
    v_cvt_pk_bf16_f32 v44, v97, v99
    v_cvt_pk_bf16_f32 v45, v101, v103
    v_cvt_pk_bf16_f32 v46, v105, v107
    v_cvt_pk_bf16_f32 v47, v109, v111
    ds_write_b128 v58, v[44:47] offset:33056
    v_pk_fma_f32 v[152:153], v[16:17], v[150:151], v[152:153] op_sel:[0,0,0] op_sel_hi:[0,1,1]
    v_pk_fma_f32 v[184:185], v[16:17], v[182:183], v[184:185] op_sel:[0,0,0] op_sel_hi:[0,1,1]
    v_pk_fma_f32 v[152:153], v[16:17], v[182:183], v[152:153] op_sel:[1,0,0] op_sel_hi:[1,1,1] neg_lo:[1,0,0] neg_hi:[1,0,0]
    v_pk_fma_f32 v[184:185], v[16:17], v[150:151], v[184:185] op_sel:[1,0,0] op_sel_hi:[1,1,1]
    v_pk_fma_f32 v[154:155], v[16:17], v[152:153], v[154:155] op_sel:[0,0,0] op_sel_hi:[0,1,1]
    v_pk_fma_f32 v[186:187], v[16:17], v[184:185], v[186:187] op_sel:[0,0,0] op_sel_hi:[0,1,1]
    v_pk_fma_f32 v[154:155], v[16:17], v[184:185], v[154:155] op_sel:[1,0,0] op_sel_hi:[1,1,1] neg_lo:[1,0,0] neg_hi:[1,0,0]
    v_pk_fma_f32 v[186:187], v[16:17], v[152:153], v[186:187] op_sel:[1,0,0] op_sel_hi:[1,1,1]
    v_cvt_pk_bf16_f32 v48, v113, v115
    v_cvt_pk_bf16_f32 v49, v117, v119
    v_cvt_pk_bf16_f32 v50, v121, v123
    v_cvt_pk_bf16_f32 v51, v125, v127
    ds_write_b128 v58, v[48:51] offset:33072
    v_pk_fma_f32 v[156:157], v[16:17], v[154:155], v[156:157] op_sel:[0,0,0] op_sel_hi:[0,1,1]
    v_pk_fma_f32 v[188:189], v[16:17], v[186:187], v[188:189] op_sel:[0,0,0] op_sel_hi:[0,1,1]
    v_pk_fma_f32 v[156:157], v[16:17], v[186:187], v[156:157] op_sel:[1,0,0] op_sel_hi:[1,1,1] neg_lo:[1,0,0] neg_hi:[1,0,0]
    v_pk_fma_f32 v[188:189], v[16:17], v[154:155], v[188:189] op_sel:[1,0,0] op_sel_hi:[1,1,1]
    v_pk_fma_f32 v[158:159], v[16:17], v[156:157], v[158:159] op_sel:[0,0,0] op_sel_hi:[0,1,1]
    v_pk_fma_f32 v[190:191], v[16:17], v[188:189], v[190:191] op_sel:[0,0,0] op_sel_hi:[0,1,1]
    v_pk_fma_f32 v[158:159], v[16:17], v[188:189], v[158:159] op_sel:[1,0,0] op_sel_hi:[1,1,1] neg_lo:[1,0,0] neg_hi:[1,0,0]
    v_pk_fma_f32 v[190:191], v[16:17], v[156:157], v[190:191] op_sel:[1,0,0] op_sel_hi:[1,1,1]
    ds_read_b64_tr_b16 v[64:65], v62 offset:30720
    ds_read_b64_tr_b16 v[66:67], v62 offset:31296
    ds_read_b64_tr_b16 v[68:69], v62 offset:30752
    ds_read_b64_tr_b16 v[70:71], v62 offset:31328
    ds_read_b64_tr_b16 v[72:73], v62 offset:35328
    ds_read_b64_tr_b16 v[74:75], v62 offset:35904
    ds_read_b64_tr_b16 v[76:77], v62 offset:35360
    ds_read_b64_tr_b16 v[78:79], v62 offset:35936
    ds_read_b64_tr_b16 v[80:81], v62 offset:30784
    ds_read_b64_tr_b16 v[82:83], v62 offset:31360
    ds_read_b64_tr_b16 v[84:85], v62 offset:30816
    ds_read_b64_tr_b16 v[86:87], v62 offset:31392
    ds_read_b64_tr_b16 v[88:89], v62 offset:35392
    ds_read_b64_tr_b16 v[90:91], v62 offset:35968
    ds_read_b64_tr_b16 v[92:93], v62 offset:35424
    ds_read_b64_tr_b16 v[94:95], v62 offset:36000
    v_cvt_pk_bf16_f32 v52, v128, v130
    v_cvt_pk_bf16_f32 v53, v132, v134
    v_cvt_pk_bf16_f32 v54, v136, v138
    v_cvt_pk_bf16_f32 v55, v140, v142
    s_waitcnt lgkmcnt(15)
    s_barrier
    ds_write_b128 v58, v[52:55] offset:18432
    ds_read_b64_tr_b16 a[0:1], v9 offset:30720
    ds_read_b64_tr_b16 a[2:3], v9 offset:31296
    ds_read_b64_tr_b16 a[4:5], v9 offset:30752
    ds_read_b64_tr_b16 a[6:7], v9 offset:31328
    ds_read_b64_tr_b16 a[8:9], v9 offset:35328
    ds_read_b64_tr_b16 a[10:11], v9 offset:35904
    ds_read_b64_tr_b16 a[12:13], v9 offset:35360
    ds_read_b64_tr_b16 a[14:15], v9 offset:35936
    v_pk_fma_f32 v[192:193], v[18:19], v[36:37], v[192:193] op_sel:[0,0,0] op_sel_hi:[0,1,1]
    v_pk_fma_f32 v[224:225], v[18:19], v[42:43], v[224:225] op_sel:[0,0,0] op_sel_hi:[0,1,1]
    v_pk_fma_f32 v[192:193], v[18:19], v[42:43], v[192:193] op_sel:[1,0,0] op_sel_hi:[1,1,1] neg_lo:[1,0,0] neg_hi:[1,0,0]
    v_pk_fma_f32 v[224:225], v[18:19], v[36:37], v[224:225] op_sel:[1,0,0] op_sel_hi:[1,1,1]
    v_pk_fma_f32 v[194:195], v[18:19], v[192:193], v[194:195] op_sel:[0,0,0] op_sel_hi:[0,1,1]
    v_pk_fma_f32 v[226:227], v[18:19], v[224:225], v[226:227] op_sel:[0,0,0] op_sel_hi:[0,1,1]
    v_pk_fma_f32 v[194:195], v[18:19], v[224:225], v[194:195] op_sel:[1,0,0] op_sel_hi:[1,1,1] neg_lo:[1,0,0] neg_hi:[1,0,0]
    v_pk_fma_f32 v[226:227], v[18:19], v[192:193], v[226:227] op_sel:[1,0,0] op_sel_hi:[1,1,1]
    s_add_u32 s54, s94, 0
    s_waitcnt lgkmcnt(15)
    buffer_store_dwordx4 v[64:67], v1, s[68:71], s54 offen offset:0 sc1
    v_cvt_pk_bf16_f32 v44, v144, v146
    v_cvt_pk_bf16_f32 v45, v148, v150
    v_cvt_pk_bf16_f32 v46, v152, v154
    v_cvt_pk_bf16_f32 v47, v156, v158
    ds_write_b128 v58, v[44:47] offset:18448
    v_pk_fma_f32 v[196:197], v[18:19], v[194:195], v[196:197] op_sel:[0,0,0] op_sel_hi:[0,1,1]
    v_pk_fma_f32 v[228:229], v[18:19], v[226:227], v[228:229] op_sel:[0,0,0] op_sel_hi:[0,1,1]
    v_pk_fma_f32 v[196:197], v[18:19], v[226:227], v[196:197] op_sel:[1,0,0] op_sel_hi:[1,1,1] neg_lo:[1,0,0] neg_hi:[1,0,0]
    v_pk_fma_f32 v[228:229], v[18:19], v[194:195], v[228:229] op_sel:[1,0,0] op_sel_hi:[1,1,1]
    v_pk_fma_f32 v[198:199], v[18:19], v[196:197], v[198:199] op_sel:[0,0,0] op_sel_hi:[0,1,1]
    v_pk_fma_f32 v[230:231], v[18:19], v[228:229], v[230:231] op_sel:[0,0,0] op_sel_hi:[0,1,1]
    v_pk_fma_f32 v[198:199], v[18:19], v[228:229], v[198:199] op_sel:[1,0,0] op_sel_hi:[1,1,1] neg_lo:[1,0,0] neg_hi:[1,0,0]
    v_pk_fma_f32 v[230:231], v[18:19], v[196:197], v[230:231] op_sel:[1,0,0] op_sel_hi:[1,1,1]
    buffer_store_dwordx4 v[68:71], v1, s[68:71], s54 offen offset:1024 sc1
    v_cvt_pk_bf16_f32 v48, v129, v131
    v_cvt_pk_bf16_f32 v49, v133, v135
    v_cvt_pk_bf16_f32 v50, v137, v139
    v_cvt_pk_bf16_f32 v51, v141, v143
    ds_write_b128 v58, v[48:51] offset:18464
    v_pk_fma_f32 v[200:201], v[18:19], v[198:199], v[200:201] op_sel:[0,0,0] op_sel_hi:[0,1,1]
    v_pk_fma_f32 v[232:233], v[18:19], v[230:231], v[232:233] op_sel:[0,0,0] op_sel_hi:[0,1,1]
    v_pk_fma_f32 v[200:201], v[18:19], v[230:231], v[200:201] op_sel:[1,0,0] op_sel_hi:[1,1,1] neg_lo:[1,0,0] neg_hi:[1,0,0]
    v_pk_fma_f32 v[232:233], v[18:19], v[198:199], v[232:233] op_sel:[1,0,0] op_sel_hi:[1,1,1]
    v_pk_fma_f32 v[202:203], v[18:19], v[200:201], v[202:203] op_sel:[0,0,0] op_sel_hi:[0,1,1]
    v_pk_fma_f32 v[234:235], v[18:19], v[232:233], v[234:235] op_sel:[0,0,0] op_sel_hi:[0,1,1]
    v_pk_fma_f32 v[202:203], v[18:19], v[232:233], v[202:203] op_sel:[1,0,0] op_sel_hi:[1,1,1] neg_lo:[1,0,0] neg_hi:[1,0,0]
    v_pk_fma_f32 v[234:235], v[18:19], v[200:201], v[234:235] op_sel:[1,0,0] op_sel_hi:[1,1,1]
    buffer_store_dwordx4 v[72:75], v1, s[68:71], s54 offen offset:2048 sc1
    v_cvt_pk_bf16_f32 v52, v145, v147
    v_cvt_pk_bf16_f32 v53, v149, v151
    v_cvt_pk_bf16_f32 v54, v153, v155
    v_cvt_pk_bf16_f32 v55, v157, v159
    ds_write_b128 v58, v[52:55] offset:18480
    v_pk_fma_f32 v[204:205], v[18:19], v[202:203], v[204:205] op_sel:[0,0,0] op_sel_hi:[0,1,1]
    v_pk_fma_f32 v[236:237], v[18:19], v[234:235], v[236:237] op_sel:[0,0,0] op_sel_hi:[0,1,1]
    v_pk_fma_f32 v[204:205], v[18:19], v[234:235], v[204:205] op_sel:[1,0,0] op_sel_hi:[1,1,1] neg_lo:[1,0,0] neg_hi:[1,0,0]
    v_pk_fma_f32 v[236:237], v[18:19], v[202:203], v[236:237] op_sel:[1,0,0] op_sel_hi:[1,1,1]
    v_pk_fma_f32 v[206:207], v[18:19], v[204:205], v[206:207] op_sel:[0,0,0] op_sel_hi:[0,1,1]
    v_pk_fma_f32 v[238:239], v[18:19], v[236:237], v[238:239] op_sel:[0,0,0] op_sel_hi:[0,1,1]
    v_pk_fma_f32 v[206:207], v[18:19], v[236:237], v[206:207] op_sel:[1,0,0] op_sel_hi:[1,1,1] neg_lo:[1,0,0] neg_hi:[1,0,0]
    v_pk_fma_f32 v[238:239], v[18:19], v[204:205], v[238:239] op_sel:[1,0,0] op_sel_hi:[1,1,1]
    buffer_store_dwordx4 v[76:79], v1, s[68:71], s54 offen offset:3072 sc1
    v_cvt_pk_bf16_f32 v44, v160, v162
    v_cvt_pk_bf16_f32 v45, v164, v166
    v_cvt_pk_bf16_f32 v46, v168, v170
    v_cvt_pk_bf16_f32 v47, v172, v174
    ds_write_b128 v58, v[44:47] offset:20736
    v_pk_fma_f32 v[208:209], v[18:19], v[206:207], v[208:209] op_sel:[0,0,0] op_sel_hi:[0,1,1]
    v_pk_fma_f32 v[240:241], v[18:19], v[238:239], v[240:241] op_sel:[0,0,0] op_sel_hi:[0,1,1]
    v_pk_fma_f32 v[208:209], v[18:19], v[238:239], v[208:209] op_sel:[1,0,0] op_sel_hi:[1,1,1] neg_lo:[1,0,0] neg_hi:[1,0,0]
    v_pk_fma_f32 v[240:241], v[18:19], v[206:207], v[240:241] op_sel:[1,0,0] op_sel_hi:[1,1,1]
    v_pk_fma_f32 v[210:211], v[18:19], v[208:209], v[210:211] op_sel:[0,0,0] op_sel_hi:[0,1,1]
    v_pk_fma_f32 v[242:243], v[18:19], v[240:241], v[242:243] op_sel:[0,0,0] op_sel_hi:[0,1,1]
    v_pk_fma_f32 v[210:211], v[18:19], v[240:241], v[210:211] op_sel:[1,0,0] op_sel_hi:[1,1,1] neg_lo:[1,0,0] neg_hi:[1,0,0]
    v_pk_fma_f32 v[242:243], v[18:19], v[208:209], v[242:243] op_sel:[1,0,0] op_sel_hi:[1,1,1]
    s_add_u32 s54, s94, 368640
    buffer_store_dwordx4 v[80:83], v1, s[68:71], s54 offen offset:0 sc1
    v_cvt_pk_bf16_f32 v48, v176, v178
    v_cvt_pk_bf16_f32 v49, v180, v182
    v_cvt_pk_bf16_f32 v50, v184, v186
    v_cvt_pk_bf16_f32 v51, v188, v190
    ds_write_b128 v58, v[48:51] offset:20752
    v_pk_fma_f32 v[212:213], v[18:19], v[210:211], v[212:213] op_sel:[0,0,0] op_sel_hi:[0,1,1]
    v_pk_fma_f32 v[244:245], v[18:19], v[242:243], v[244:245] op_sel:[0,0,0] op_sel_hi:[0,1,1]
    v_pk_fma_f32 v[212:213], v[18:19], v[242:243], v[212:213] op_sel:[1,0,0] op_sel_hi:[1,1,1] neg_lo:[1,0,0] neg_hi:[1,0,0]
    v_pk_fma_f32 v[244:245], v[18:19], v[210:211], v[244:245] op_sel:[1,0,0] op_sel_hi:[1,1,1]
    v_pk_fma_f32 v[214:215], v[18:19], v[212:213], v[214:215] op_sel:[0,0,0] op_sel_hi:[0,1,1]
    v_pk_fma_f32 v[246:247], v[18:19], v[244:245], v[246:247] op_sel:[0,0,0] op_sel_hi:[0,1,1]
    v_pk_fma_f32 v[214:215], v[18:19], v[244:245], v[214:215] op_sel:[1,0,0] op_sel_hi:[1,1,1] neg_lo:[1,0,0] neg_hi:[1,0,0]
    v_pk_fma_f32 v[246:247], v[18:19], v[212:213], v[246:247] op_sel:[1,0,0] op_sel_hi:[1,1,1]
    s_waitcnt lgkmcnt(15)
    buffer_store_dwordx4 v[84:87], v1, s[68:71], s54 offen offset:1024 sc1
    v_cvt_pk_bf16_f32 v52, v161, v163
    v_cvt_pk_bf16_f32 v53, v165, v167
    v_cvt_pk_bf16_f32 v54, v169, v171
    v_cvt_pk_bf16_f32 v55, v173, v175
    ds_write_b128 v58, v[52:55] offset:20768
    v_pk_fma_f32 v[216:217], v[18:19], v[214:215], v[216:217] op_sel:[0,0,0] op_sel_hi:[0,1,1]
    v_pk_fma_f32 v[248:249], v[18:19], v[246:247], v[248:249] op_sel:[0,0,0] op_sel_hi:[0,1,1]
    v_pk_fma_f32 v[216:217], v[18:19], v[246:247], v[216:217] op_sel:[1,0,0] op_sel_hi:[1,1,1] neg_lo:[1,0,0] neg_hi:[1,0,0]
    v_pk_fma_f32 v[248:249], v[18:19], v[214:215], v[248:249] op_sel:[1,0,0] op_sel_hi:[1,1,1]
    v_pk_fma_f32 v[218:219], v[18:19], v[216:217], v[218:219] op_sel:[0,0,0] op_sel_hi:[0,1,1]
    v_pk_fma_f32 v[250:251], v[18:19], v[248:249], v[250:251] op_sel:[0,0,0] op_sel_hi:[0,1,1]
    v_pk_fma_f32 v[218:219], v[18:19], v[248:249], v[218:219] op_sel:[1,0,0] op_sel_hi:[1,1,1] neg_lo:[1,0,0] neg_hi:[1,0,0]
    v_pk_fma_f32 v[250:251], v[18:19], v[216:217], v[250:251] op_sel:[1,0,0] op_sel_hi:[1,1,1]
    buffer_store_dwordx4 v[88:91], v1, s[68:71], s54 offen offset:2048 sc1
    v_cvt_pk_bf16_f32 v44, v177, v179
    v_cvt_pk_bf16_f32 v45, v181, v183
    v_cvt_pk_bf16_f32 v46, v185, v187
    v_cvt_pk_bf16_f32 v47, v189, v191
    ds_write_b128 v58, v[44:47] offset:20784
    v_pk_fma_f32 v[220:221], v[18:19], v[218:219], v[220:221] op_sel:[0,0,0] op_sel_hi:[0,1,1]
    v_pk_fma_f32 v[252:253], v[18:19], v[250:251], v[252:253] op_sel:[0,0,0] op_sel_hi:[0,1,1]
    v_pk_fma_f32 v[220:221], v[18:19], v[250:251], v[220:221] op_sel:[1,0,0] op_sel_hi:[1,1,1] neg_lo:[1,0,0] neg_hi:[1,0,0]
    v_pk_fma_f32 v[252:253], v[18:19], v[218:219], v[252:253] op_sel:[1,0,0] op_sel_hi:[1,1,1]
    v_pk_fma_f32 v[222:223], v[18:19], v[220:221], v[222:223] op_sel:[0,0,0] op_sel_hi:[0,1,1]
    v_pk_fma_f32 v[254:255], v[18:19], v[252:253], v[254:255] op_sel:[0,0,0] op_sel_hi:[0,1,1]
    v_pk_fma_f32 v[222:223], v[18:19], v[252:253], v[222:223] op_sel:[1,0,0] op_sel_hi:[1,1,1] neg_lo:[1,0,0] neg_hi:[1,0,0]
    v_pk_fma_f32 v[254:255], v[18:19], v[220:221], v[254:255] op_sel:[1,0,0] op_sel_hi:[1,1,1]
    s_waitcnt lgkmcnt(15)
    buffer_store_dwordx4 v[92:95], v1, s[68:71], s54 offen offset:3072 sc1
    ds_read_b64_tr_b16 v[128:129], v62 offset:18432
    ds_read_b64_tr_b16 v[130:131], v62 offset:19008
    ds_read_b64_tr_b16 v[132:133], v62 offset:18464
    ds_read_b64_tr_b16 v[134:135], v62 offset:19040
    ds_read_b64_tr_b16 v[136:137], v62 offset:23040
    ds_read_b64_tr_b16 v[138:139], v62 offset:23616
    ds_read_b64_tr_b16 v[140:141], v62 offset:23072
    ds_read_b64_tr_b16 v[142:143], v62 offset:23648
    ds_read_b64_tr_b16 v[144:145], v62 offset:18496
    ds_read_b64_tr_b16 v[146:147], v62 offset:19072
    ds_read_b64_tr_b16 v[148:149], v62 offset:18528
    ds_read_b64_tr_b16 v[150:151], v62 offset:19104
    ds_read_b64_tr_b16 v[152:153], v62 offset:23104
    ds_read_b64_tr_b16 v[154:155], v62 offset:23680
    ds_read_b64_tr_b16 v[156:157], v62 offset:23136
    ds_read_b64_tr_b16 v[158:159], v62 offset:23712
    v_add_u32 v40, 0, v1
    v_add_u32 v41, 40960, v1
    v_add_u32 v42, 81920, v1
    v_add_u32 v43, 122880, v1
    v_cvt_pk_bf16_f32 v48, v192, v194
    v_cvt_pk_bf16_f32 v49, v196, v198
    v_cvt_pk_bf16_f32 v50, v200, v202
    v_cvt_pk_bf16_f32 v51, v204, v206
    s_waitcnt lgkmcnt(15)
    s_barrier
    ds_write_b128 v58, v[48:51] offset:30720
    ds_read_b64_tr_b16 a[16:17], v9 offset:18432
    ds_read_b64_tr_b16 a[18:19], v9 offset:19008
    ds_read_b64_tr_b16 a[20:21], v9 offset:18464
    ds_read_b64_tr_b16 a[22:23], v9 offset:19040
    ds_read_b64_tr_b16 a[24:25], v9 offset:23040
    ds_read_b64_tr_b16 a[26:27], v9 offset:23616
    ds_read_b64_tr_b16 a[28:29], v9 offset:23072
    ds_read_b64_tr_b16 a[30:31], v9 offset:23648
    s_add_u32 s54, s94, 4096
    s_waitcnt lgkmcnt(15)
    buffer_store_dwordx4 v[128:131], v1, s[68:71], s54 offen offset:0 sc1
    v_cvt_pk_bf16_f32 v52, v208, v210
    v_cvt_pk_bf16_f32 v53, v212, v214
    v_cvt_pk_bf16_f32 v54, v216, v218
    v_cvt_pk_bf16_f32 v55, v220, v222
    ds_write_b128 v58, v[52:55] offset:30736
    buffer_store_dwordx4 v[132:135], v1, s[68:71], s54 offen offset:1024 sc1
    v_cvt_pk_bf16_f32 v44, v193, v195
    v_cvt_pk_bf16_f32 v45, v197, v199
    v_cvt_pk_bf16_f32 v46, v201, v203
    v_cvt_pk_bf16_f32 v47, v205, v207
    ds_write_b128 v58, v[44:47] offset:30752
    buffer_store_dwordx4 v[136:139], v1, s[68:71], s54 offen offset:2048 sc1
    v_cvt_pk_bf16_f32 v48, v209, v211
    v_cvt_pk_bf16_f32 v49, v213, v215
    v_cvt_pk_bf16_f32 v50, v217, v219
    v_cvt_pk_bf16_f32 v51, v221, v223
    ds_write_b128 v58, v[48:51] offset:30768
    buffer_store_dwordx4 v[140:143], v1, s[68:71], s54 offen offset:3072 sc1
    v_cvt_pk_bf16_f32 v52, v224, v226
    v_cvt_pk_bf16_f32 v53, v228, v230
    v_cvt_pk_bf16_f32 v54, v232, v234
    v_cvt_pk_bf16_f32 v55, v236, v238
    ds_write_b128 v58, v[52:55] offset:33024
    s_add_u32 s54, s94, 372736
    buffer_store_dwordx4 v[144:147], v1, s[68:71], s54 offen offset:0 sc1
    v_cvt_pk_bf16_f32 v44, v240, v242
    v_cvt_pk_bf16_f32 v45, v244, v246
    v_cvt_pk_bf16_f32 v46, v248, v250
    v_cvt_pk_bf16_f32 v47, v252, v254
    ds_write_b128 v58, v[44:47] offset:33040
    s_waitcnt lgkmcnt(15)
    buffer_store_dwordx4 v[148:151], v1, s[68:71], s54 offen offset:1024 sc1
    v_cvt_pk_bf16_f32 v48, v225, v227
    v_cvt_pk_bf16_f32 v49, v229, v231
    v_cvt_pk_bf16_f32 v50, v233, v235
    v_cvt_pk_bf16_f32 v51, v237, v239
    ds_write_b128 v58, v[48:51] offset:33056
    buffer_store_dwordx4 v[152:155], v1, s[68:71], s54 offen offset:2048 sc1
    v_cvt_pk_bf16_f32 v52, v241, v243
    v_cvt_pk_bf16_f32 v53, v245, v247
    v_cvt_pk_bf16_f32 v54, v249, v251
    v_cvt_pk_bf16_f32 v55, v253, v255
    ds_write_b128 v58, v[52:55] offset:33072
    s_waitcnt lgkmcnt(15)
    buffer_store_dwordx4 v[156:159], v1, s[68:71], s54 offen offset:3072 sc1
    s_waitcnt lgkmcnt(0)
    s_barrier
    ds_read_b128 a[128:131], v40 offset:0
    ds_read_b128 a[132:135], v40 offset:1024
    ds_read_b128 a[136:139], v40 offset:2048
    ds_read_b128 a[140:143], v41 offset:0
    ds_read_b128 a[144:147], v41 offset:1024
    ds_read_b128 a[148:151], v41 offset:2048
    ds_read_b64_tr_b16 a[32:33], v9 offset:30720
    ds_read_b64_tr_b16 a[34:35], v9 offset:31296
    s_branch L_sskip17
L_stub17:
    s_branch L_stub21
L_sskip17:
    ds_read_b64_tr_b16 a[36:37], v9 offset:30752
    ds_read_b64_tr_b16 a[38:39], v9 offset:31328
    ds_read_b64_tr_b16 a[40:41], v9 offset:35328
    ds_read_b64_tr_b16 a[42:43], v9 offset:35904
    ds_read_b64_tr_b16 a[44:45], v9 offset:35360
    ds_read_b64_tr_b16 a[46:47], v9 offset:35936
    v_mfma_f32_16x16x32_bf16 v[96:99], a[160:163], a[208:211], 0
    ds_read_b64_tr_b16 v[192:193], v62 offset:30720
    v_mfma_f32_16x16x32_bf16 v[100:103], a[160:163], a[212:215], 0
    ds_read_b64_tr_b16 v[194:195], v62 offset:31296
    v_mfma_f32_16x16x32_bf16 v[104:107], a[164:167], a[208:211], 0
    ds_read_b64_tr_b16 v[196:197], v62 offset:30752
    v_mfma_f32_16x16x32_bf16 v[108:111], a[164:167], a[212:215], 0
    ds_read_b64_tr_b16 v[198:199], v62 offset:31328
    v_mfma_f32_16x16x32_bf16 v[112:115], a[168:171], a[216:219], 0
    s_add_u32 m0, s52, 18432
    s_add_u32 s82, s84, 3538944
    v_mfma_f32_16x16x32_bf16 v[116:119], a[168:171], a[220:223], 0
    buffer_load_dwordx4 v2, s[64:67], s82 offen offset:0 lds
    v_mfma_f32_16x16x32_bf16 v[120:123], a[172:175], a[216:219], 0
    ds_read_b64_tr_b16 v[200:201], v62 offset:35328
    v_mfma_f32_16x16x32_bf16 v[124:127], a[172:175], a[220:223], 0
    ds_read_b64_tr_b16 v[202:203], v62 offset:35904
    v_mfma_f32_16x16x32_bf16 v[160:163], a[176:179], a[224:227], 0
    ds_read_b64_tr_b16 v[204:205], v62 offset:35360
    v_mfma_f32_16x16x32_bf16 v[164:167], a[176:179], a[228:231], 0
    ds_read_b64_tr_b16 v[206:207], v62 offset:35936
    v_mfma_f32_16x16x32_bf16 v[168:171], a[180:183], a[224:227], 0
    ds_read_b64_tr_b16 v[208:209], v62 offset:30784
    v_mfma_f32_16x16x32_bf16 v[172:175], a[180:183], a[228:231], 0
    ds_read_b64_tr_b16 v[210:211], v62 offset:31360
    v_mfma_f32_16x16x32_bf16 v[176:179], a[184:187], a[232:235], 0
    s_add_u32 s82, s84, 3611648
    ds_read_b64_tr_b16 v[212:213], v62 offset:30816
    v_mfma_f32_16x16x32_bf16 v[180:183], a[184:187], a[236:239], 0
    buffer_load_dwordx4 v2, s[64:67], s82 offen offset:1024 lds
    v_mfma_f32_16x16x32_bf16 v[184:187], a[188:191], a[232:235], 0
    ds_read_b64_tr_b16 v[214:215], v62 offset:31392
    v_mfma_f32_16x16x32_bf16 v[188:191], a[188:191], a[236:239], 0
    ds_read_b64_tr_b16 v[216:217], v62 offset:35392
    v_mfma_f32_16x16x32_bf16 v[224:227], a[192:195], a[240:243], 0
    ds_read_b64_tr_b16 v[218:219], v62 offset:35968
    v_mfma_f32_16x16x32_bf16 v[228:231], a[192:195], a[244:247], 0
    ds_read_b64_tr_b16 v[220:221], v62 offset:35424
    v_mfma_f32_16x16x32_bf16 v[232:235], a[196:199], a[240:243], 0
    ds_read_b64_tr_b16 v[222:223], v62 offset:36000
    v_mfma_f32_16x16x32_bf16 v[236:239], a[196:199], a[244:247], 0
    v_mfma_f32_16x16x32_bf16 v[240:243], a[200:203], a[248:251], 0
    s_add_u32 s82, s84, 3684352
    v_mfma_f32_16x16x32_bf16 v[244:247], a[200:203], a[252:255], 0
    buffer_load_dwordx4 v2, s[64:67], s82 offen offset:2048 lds
    v_mfma_f32_16x16x32_bf16 v[248:251], a[204:207], a[248:251], 0
    v_mfma_f32_16x16x32_bf16 v[252:255], a[204:207], a[252:255], 0
    s_waitcnt lgkmcnt(15)
    v_mfma_f32_16x16x32_bf16 v[96:99], a[128:131], a[0:3], v[96:99]
    s_add_u32 s54, s94, 8192
    s_waitcnt lgkmcnt(14)
    buffer_store_dwordx4 v[192:195], v1, s[68:71], s54 offen offset:0 sc1
    ds_read_b128 a[152:155], v42 offset:0
    v_mfma_f32_16x16x32_bf16 v[100:103], a[128:131], a[4:7], v[100:103]
    ds_read_b128 a[156:159], v42 offset:1024
    v_mfma_f32_16x16x32_bf16 v[104:107], a[132:135], a[0:3], v[104:107]
    v_mfma_f32_16x16x32_bf16 v[108:111], a[132:135], a[4:7], v[108:111]
    v_mfma_f32_16x16x32_bf16 v[96:99], a[136:139], a[8:11], v[96:99]
    s_add_u32 m0, s52, 21504
    s_add_u32 s82, s84, 3539072
    v_mfma_f32_16x16x32_bf16 v[100:103], a[136:139], a[12:15], v[100:103]
    buffer_load_dwordx4 v2, s[64:67], s82 offen offset:0 lds
    v_mfma_f32_16x16x32_bf16 v[104:107], a[140:143], a[8:11], v[104:107]
    ds_read_b128 a[128:131], v42 offset:2048
    v_mfma_f32_16x16x32_bf16 v[108:111], a[140:143], a[12:15], v[108:111]
    ds_read_b128 a[132:135], v43 offset:0
    v_mfma_f32_16x16x32_bf16 v[96:99], a[144:147], a[16:19], v[96:99]
    s_waitcnt lgkmcnt(15)
    buffer_store_dwordx4 v[196:199], v1, s[68:71], s54 offen offset:1024 sc1
    ds_read_b128 a[136:139], v43 offset:1024
    v_mfma_f32_16x16x32_bf16 v[100:103], a[144:147], a[20:23], v[100:103]
    ds_read_b128 a[140:143], v43 offset:2048
    v_mfma_f32_16x16x32_bf16 v[104:107], a[148:151], a[16:19], v[104:107]
    v_mfma_f32_16x16x32_bf16 v[108:111], a[148:151], a[20:23], v[108:111]
    s_waitcnt lgkmcnt(4)
    v_mfma_f32_16x16x32_bf16 v[96:99], a[152:155], a[24:27], v[96:99]
    s_add_u32 s82, s84, 3611776
    ds_read_b128 a[144:147], v40 offset:3072
    v_mfma_f32_16x16x32_bf16 v[100:103], a[152:155], a[28:31], v[100:103]
    buffer_load_dwordx4 v2, s[64:67], s82 offen offset:1024 lds
    v_mfma_f32_16x16x32_bf16 v[104:107], a[156:159], a[24:27], v[104:107]
    ds_read_b128 a[148:151], v40 offset:4096
    v_mfma_f32_16x16x32_bf16 v[108:111], a[156:159], a[28:31], v[108:111]
    s_waitcnt lgkmcnt(4)
    v_mfma_f32_16x16x32_bf16 v[96:99], a[128:131], a[32:35], v[96:99]
    buffer_store_dwordx4 v[200:203], v1, s[68:71], s54 offen offset:2048 sc1
    ds_read_b128 a[152:155], v40 offset:5120
    v_mfma_f32_16x16x32_bf16 v[100:103], a[128:131], a[36:39], v[100:103]
    ds_read_b128 a[156:159], v41 offset:3072
    v_mfma_f32_16x16x32_bf16 v[104:107], a[132:135], a[32:35], v[104:107]
    v_mfma_f32_16x16x32_bf16 v[108:111], a[132:135], a[36:39], v[108:111]
    s_waitcnt lgkmcnt(4)
    v_mfma_f32_16x16x32_bf16 v[96:99], a[136:139], a[40:43], v[96:99]
    s_add_u32 s82, s84, 3684480
    ds_read_b128 a[128:131], v41 offset:4096
    v_mfma_f32_16x16x32_bf16 v[100:103], a[136:139], a[44:47], v[100:103]
    buffer_load_dwordx4 v2, s[64:67], s82 offen offset:2048 lds
    v_mfma_f32_16x16x32_bf16 v[104:107], a[140:143], a[40:43], v[104:107]
    ds_read_b128 a[132:135], v41 offset:5120
    v_mfma_f32_16x16x32_bf16 v[108:111], a[140:143], a[44:47], v[108:111]
    s_waitcnt lgkmcnt(4)
    v_mfma_f32_16x16x32_bf16 v[112:115], a[144:147], a[0:3], v[112:115]
    buffer_store_dwordx4 v[204:207], v1, s[68:71], s54 offen offset:3072 sc1
    ds_read_b128 a[136:139], v42 offset:3072
    v_mfma_f32_16x16x32_bf16 v[116:119], a[144:147], a[4:7], v[116:119]
    ds_read_b128 a[140:143], v42 offset:4096
    v_mfma_f32_16x16x32_bf16 v[120:123], a[148:151], a[0:3], v[120:123]
    v_mfma_f32_16x16x32_bf16 v[124:127], a[148:151], a[4:7], v[124:127]
    s_waitcnt lgkmcnt(4)
    v_mfma_f32_16x16x32_bf16 v[112:115], a[152:155], a[8:11], v[112:115]
    s_add_u32 m0, s52, 24576
    s_add_u32 s82, s84, 3539200
    v_mfma_f32_16x16x32_bf16 v[116:119], a[152:155], a[12:15], v[116:119]
    buffer_load_dwordx4 v2, s[64:67], s82 offen offset:0 lds
    v_mfma_f32_16x16x32_bf16 v[120:123], a[156:159], a[8:11], v[120:123]
    ds_read_b128 a[144:147], v42 offset:5120
    v_mfma_f32_16x16x32_bf16 v[124:127], a[156:159], a[12:15], v[124:127]
    ds_read_b128 a[148:151], v43 offset:3072
    s_waitcnt lgkmcnt(4)
    v_mfma_f32_16x16x32_bf16 v[112:115], a[128:131], a[16:19], v[112:115]
    s_add_u32 s54, s94, 376832
    buffer_store_dwordx4 v[208:211], v1, s[68:71], s54 offen offset:0 sc1
    ds_read_b128 a[152:155], v43 offset:4096
    v_mfma_f32_16x16x32_bf16 v[116:119], a[128:131], a[20:23], v[116:119]
    ds_read_b128 a[156:159], v43 offset:5120
    v_mfma_f32_16x16x32_bf16 v[120:123], a[132:135], a[16:19], v[120:123]
    v_mfma_f32_16x16x32_bf16 v[124:127], a[132:135], a[20:23], v[124:127]
    s_waitcnt lgkmcnt(4)
    v_mfma_f32_16x16x32_bf16 v[112:115], a[136:139], a[24:27], v[112:115]
    s_add_u32 s82, s84, 3611904
    ds_read_b128 a[128:131], v40 offset:6144
    v_mfma_f32_16x16x32_bf16 v[116:119], a[136:139], a[28:31], v[116:119]
    buffer_load_dwordx4 v2, s[64:67], s82 offen offset:1024 lds
    v_mfma_f32_16x16x32_bf16 v[120:123], a[140:143], a[24:27], v[120:123]
    ds_read_b128 a[132:135], v40 offset:7168
    v_mfma_f32_16x16x32_bf16 v[124:127], a[140:143], a[28:31], v[124:127]
    s_waitcnt lgkmcnt(4)
    v_mfma_f32_16x16x32_bf16 v[112:115], a[144:147], a[32:35], v[112:115]
    buffer_store_dwordx4 v[212:215], v1, s[68:71], s54 offen offset:1024 sc1
    ds_read_b128 a[136:139], v40 offset:8192
    v_mfma_f32_16x16x32_bf16 v[116:119], a[144:147], a[36:39], v[116:119]
    ds_read_b128 a[140:143], v41 offset:6144
    v_mfma_f32_16x16x32_bf16 v[120:123], a[148:151], a[32:35], v[120:123]
    v_mfma_f32_16x16x32_bf16 v[124:127], a[148:151], a[36:39], v[124:127]
    s_waitcnt lgkmcnt(4)
    v_mfma_f32_16x16x32_bf16 v[112:115], a[152:155], a[40:43], v[112:115]
    s_add_u32 s82, s84, 3684608
    ds_read_b128 a[144:147], v41 offset:7168
    v_mfma_f32_16x16x32_bf16 v[116:119], a[152:155], a[44:47], v[116:119]
    buffer_load_dwordx4 v2, s[64:67], s82 offen offset:2048 lds
    v_mfma_f32_16x16x32_bf16 v[120:123], a[156:159], a[40:43], v[120:123]
    ds_read_b128 a[148:151], v41 offset:8192
    v_mfma_f32_16x16x32_bf16 v[124:127], a[156:159], a[44:47], v[124:127]
    s_waitcnt lgkmcnt(4)
    v_mfma_f32_16x16x32_bf16 v[160:163], a[128:131], a[0:3], v[160:163]
    buffer_store_dwordx4 v[216:219], v1, s[68:71], s54 offen offset:2048 sc1
    ds_read_b128 a[152:155], v42 offset:6144
    v_mfma_f32_16x16x32_bf16 v[164:167], a[128:131], a[4:7], v[164:167]
    ds_read_b128 a[156:159], v42 offset:7168
    v_mfma_f32_16x16x32_bf16 v[168:171], a[132:135], a[0:3], v[168:171]
    v_mfma_f32_16x16x32_bf16 v[172:175], a[132:135], a[4:7], v[172:175]
    s_waitcnt lgkmcnt(4)
    v_mfma_f32_16x16x32_bf16 v[160:163], a[136:139], a[8:11], v[160:163]
    buffer_load_dwordx4 a[80:83], v1, s[68:71], s83 offen offset:2048 sc1
    v_mfma_f32_16x16x32_bf16 v[164:167], a[136:139], a[12:15], v[164:167]
    ds_read_b128 a[128:131], v42 offset:8192
    v_mfma_f32_16x16x32_bf16 v[168:171], a[140:143], a[8:11], v[168:171]
    ds_read_b128 a[132:135], v43 offset:6144
    v_mfma_f32_16x16x32_bf16 v[172:175], a[140:143], a[12:15], v[172:175]
    s_waitcnt lgkmcnt(4)
    v_mfma_f32_16x16x32_bf16 v[160:163], a[144:147], a[16:19], v[160:163]
    buffer_store_dwordx4 v[220:223], v1, s[68:71], s54 offen offset:3072 sc1
    ds_read_b128 a[136:139], v43 offset:7168
    v_mfma_f32_16x16x32_bf16 v[164:167], a[144:147], a[20:23], v[164:167]
    ds_read_b128 a[140:143], v43 offset:8192
    v_mfma_f32_16x16x32_bf16 v[168:171], a[148:151], a[16:19], v[168:171]
    v_mfma_f32_16x16x32_bf16 v[172:175], a[148:151], a[20:23], v[172:175]
    s_waitcnt lgkmcnt(4)
    v_mfma_f32_16x16x32_bf16 v[160:163], a[152:155], a[24:27], v[160:163]
    s_waitcnt vmcnt(48)
    s_barrier
    v_mfma_f32_16x16x32_bf16 v[164:167], a[152:155], a[28:31], v[164:167]
    buffer_load_dwordx4 a[84:87], v1, s[68:71], s83 offen offset:3072 sc1
    v_mfma_f32_16x16x32_bf16 v[168:171], a[156:159], a[24:27], v[168:171]
    ds_read_b128 a[144:147], v40 offset:9216
    v_mfma_f32_16x16x32_bf16 v[172:175], a[156:159], a[28:31], v[172:175]
    ds_read_b128 a[148:151], v40 offset:10240
    s_waitcnt lgkmcnt(4)
    v_mfma_f32_16x16x32_bf16 v[160:163], a[128:131], a[32:35], v[160:163]
    s_add_u32 s83, s76, 47104
    ds_read_b128 a[152:155], v40 offset:11264
    v_mfma_f32_16x16x32_bf16 v[164:167], a[128:131], a[36:39], v[164:167]
    buffer_load_dwordx4 a[88:91], v1, s[68:71], s83 offen offset:0 sc1
    v_mfma_f32_16x16x32_bf16 v[168:171], a[132:135], a[32:35], v[168:171]
    ds_read_b128 a[156:159], v41 offset:9216
    v_mfma_f32_16x16x32_bf16 v[172:175], a[132:135], a[36:39], v[172:175]
    s_waitcnt lgkmcnt(4)
    v_mfma_f32_16x16x32_bf16 v[160:163], a[136:139], a[40:43], v[160:163]
    buffer_load_dwordx4 a[92:95], v1, s[68:71], s83 offen offset:1024 sc1
    v_mfma_f32_16x16x32_bf16 v[164:167], a[136:139], a[44:47], v[164:167]
    ds_read_b128 a[128:131], v41 offset:10240
    v_mfma_f32_16x16x32_bf16 v[168:171], a[140:143], a[40:43], v[168:171]
    ds_read_b128 a[132:135], v41 offset:11264
    v_mfma_f32_16x16x32_bf16 v[172:175], a[140:143], a[44:47], v[172:175]
    s_waitcnt lgkmcnt(4)
    v_mfma_f32_16x16x32_bf16 v[176:179], a[144:147], a[0:3], v[176:179]
    s_add_u32 m0, s52, 27648
    s_add_u32 s82, s84, 3833856
    v_mfma_f32_16x16x32_bf16 v[180:183], a[144:147], a[4:7], v[180:183]
    buffer_load_dwordx4 v2, s[64:67], s82 offen offset:0 lds
    v_mfma_f32_16x16x32_bf16 v[184:187], a[148:151], a[0:3], v[184:187]
    ds_read_b128 a[136:139], v42 offset:9216
    v_mfma_f32_16x16x32_bf16 v[188:191], a[148:151], a[4:7], v[188:191]
    ds_read_b128 a[140:143], v42 offset:10240
    s_waitcnt lgkmcnt(4)
    v_mfma_f32_16x16x32_bf16 v[176:179], a[152:155], a[8:11], v[176:179]
    s_add_u32 s82, s84, 3906560
    ds_read_b128 a[144:147], v42 offset:11264
    v_mfma_f32_16x16x32_bf16 v[180:183], a[152:155], a[12:15], v[180:183]
    buffer_load_dwordx4 v2, s[64:67], s82 offen offset:1024 lds
    v_mfma_f32_16x16x32_bf16 v[184:187], a[156:159], a[8:11], v[184:187]
    ds_read_b128 a[148:151], v43 offset:9216
    v_mfma_f32_16x16x32_bf16 v[188:191], a[156:159], a[12:15], v[188:191]
    s_waitcnt lgkmcnt(4)
    v_mfma_f32_16x16x32_bf16 v[176:179], a[128:131], a[16:19], v[176:179]
    ds_read_b128 a[152:155], v43 offset:10240
    v_mfma_f32_16x16x32_bf16 v[180:183], a[128:131], a[20:23], v[180:183]
    ds_read_b128 a[156:159], v43 offset:11264
    v_mfma_f32_16x16x32_bf16 v[184:187], a[132:135], a[16:19], v[184:187]
    v_mfma_f32_16x16x32_bf16 v[188:191], a[132:135], a[20:23], v[188:191]
    s_waitcnt lgkmcnt(4)
    v_mfma_f32_16x16x32_bf16 v[176:179], a[136:139], a[24:27], v[176:179]
    s_add_u32 s82, s84, 3979264
    ds_read_b128 a[128:131], v40 offset:12288
    v_mfma_f32_16x16x32_bf16 v[180:183], a[136:139], a[28:31], v[180:183]
    buffer_load_dwordx4 v2, s[64:67], s82 offen offset:2048 lds
    v_mfma_f32_16x16x32_bf16 v[184:187], a[140:143], a[24:27], v[184:187]
    ds_read_b128 a[132:135], v40 offset:13312
    v_mfma_f32_16x16x32_bf16 v[188:191], a[140:143], a[28:31], v[188:191]
    s_waitcnt lgkmcnt(4)
    v_mfma_f32_16x16x32_bf16 v[176:179], a[144:147], a[32:35], v[176:179]
    s_add_u32 m0, s52, 0
    s_add_u32 s82, s84, 3833984
    v_mfma_f32_16x16x32_bf16 v[180:183], a[144:147], a[36:39], v[180:183]
    buffer_load_dwordx4 v2, s[64:67], s82 offen offset:0 lds
    v_mfma_f32_16x16x32_bf16 v[184:187], a[148:151], a[32:35], v[184:187]
    ds_read_b128 a[136:139], v40 offset:14336
    v_mfma_f32_16x16x32_bf16 v[188:191], a[148:151], a[36:39], v[188:191]
    ds_read_b128 a[140:143], v41 offset:12288
    s_waitcnt lgkmcnt(4)
    v_mfma_f32_16x16x32_bf16 v[176:179], a[152:155], a[40:43], v[176:179]
    s_add_u32 s82, s84, 3906688
    ds_read_b128 a[144:147], v41 offset:13312
    v_mfma_f32_16x16x32_bf16 v[180:183], a[152:155], a[44:47], v[180:183]
    buffer_load_dwordx4 v2, s[64:67], s82 offen offset:1024 lds
    v_mfma_f32_16x16x32_bf16 v[184:187], a[156:159], a[40:43], v[184:187]
    ds_read_b128 a[148:151], v41 offset:14336
    v_mfma_f32_16x16x32_bf16 v[188:191], a[156:159], a[44:47], v[188:191]
    s_waitcnt lgkmcnt(4)
    v_mfma_f32_16x16x32_bf16 v[224:227], a[128:131], a[0:3], v[224:227]
    s_add_u32 s82, s84, 3979392
    ds_read_b128 a[152:155], v42 offset:12288
    v_mfma_f32_16x16x32_bf16 v[228:231], a[128:131], a[4:7], v[228:231]
    buffer_load_dwordx4 v2, s[64:67], s82 offen offset:2048 lds
    v_mfma_f32_16x16x32_bf16 v[232:235], a[132:135], a[0:3], v[232:235]
    ds_read_b128 a[156:159], v42 offset:13312
    v_mfma_f32_16x16x32_bf16 v[236:239], a[132:135], a[4:7], v[236:239]
    s_waitcnt lgkmcnt(4)
    v_mfma_f32_16x16x32_bf16 v[224:227], a[136:139], a[8:11], v[224:227]
    s_add_u32 m0, s52, 3072
    s_add_u32 s82, s84, 3834112
    v_mfma_f32_16x16x32_bf16 v[228:231], a[136:139], a[12:15], v[228:231]
    buffer_load_dwordx4 v2, s[64:67], s82 offen offset:0 lds
    v_mfma_f32_16x16x32_bf16 v[232:235], a[140:143], a[8:11], v[232:235]
    ds_read_b128 a[128:131], v42 offset:14336
    v_mfma_f32_16x16x32_bf16 v[236:239], a[140:143], a[12:15], v[236:239]
    ds_read_b128 a[132:135], v43 offset:12288
    s_waitcnt lgkmcnt(4)
    v_mfma_f32_16x16x32_bf16 v[224:227], a[144:147], a[16:19], v[224:227]
    ds_read_b128 a[136:139], v43 offset:13312
    v_mfma_f32_16x16x32_bf16 v[228:231], a[144:147], a[20:23], v[228:231]
    ds_read_b128 a[140:143], v43 offset:14336
    v_mfma_f32_16x16x32_bf16 v[232:235], a[148:151], a[16:19], v[232:235]
    v_mfma_f32_16x16x32_bf16 v[236:239], a[148:151], a[20:23], v[236:239]
    s_waitcnt lgkmcnt(4)
    v_mfma_f32_16x16x32_bf16 v[224:227], a[152:155], a[24:27], v[224:227]
    s_add_u32 s82, s84, 3906816
    ds_read_b128 a[144:147], v40 offset:15360
    v_mfma_f32_16x16x32_bf16 v[228:231], a[152:155], a[28:31], v[228:231]
    buffer_load_dwordx4 v2, s[64:67], s82 offen offset:1024 lds
    v_mfma_f32_16x16x32_bf16 v[232:235], a[156:159], a[24:27], v[232:235]
    ds_read_b128 a[148:151], v40 offset:16384
    v_mfma_f32_16x16x32_bf16 v[236:239], a[156:159], a[28:31], v[236:239]
    s_waitcnt lgkmcnt(4)
    v_mfma_f32_16x16x32_bf16 v[224:227], a[128:131], a[32:35], v[224:227]
    s_add_u32 s82, s84, 3979520
    ds_read_b128 a[152:155], v40 offset:17408
    v_mfma_f32_16x16x32_bf16 v[228:231], a[128:131], a[36:39], v[228:231]
    buffer_load_dwordx4 v2, s[64:67], s82 offen offset:2048 lds
    v_mfma_f32_16x16x32_bf16 v[232:235], a[132:135], a[32:35], v[232:235]
    ds_read_b128 a[156:159], v41 offset:15360
    v_mfma_f32_16x16x32_bf16 v[236:239], a[132:135], a[36:39], v[236:239]
    s_waitcnt lgkmcnt(4)
    v_mfma_f32_16x16x32_bf16 v[224:227], a[136:139], a[40:43], v[224:227]
    ds_read_b128 a[128:131], v41 offset:16384
    v_mfma_f32_16x16x32_bf16 v[228:231], a[136:139], a[44:47], v[228:231]
    ds_read_b128 a[132:135], v41 offset:17408
    v_mfma_f32_16x16x32_bf16 v[232:235], a[140:143], a[40:43], v[232:235]
    v_mfma_f32_16x16x32_bf16 v[236:239], a[140:143], a[44:47], v[236:239]
    s_waitcnt lgkmcnt(4)
    v_mfma_f32_16x16x32_bf16 v[240:243], a[144:147], a[0:3], v[240:243]
    ds_read_b128 a[136:139], v42 offset:15360
    v_mfma_f32_16x16x32_bf16 v[244:247], a[144:147], a[4:7], v[244:247]
    ds_read_b128 a[140:143], v42 offset:16384
    v_mfma_f32_16x16x32_bf16 v[248:251], a[148:151], a[0:3], v[248:251]
    v_mfma_f32_16x16x32_bf16 v[252:255], a[148:151], a[4:7], v[252:255]
    s_waitcnt lgkmcnt(4)
    v_mfma_f32_16x16x32_bf16 v[240:243], a[152:155], a[8:11], v[240:243]
    s_lshl_b32 s54, s99, 2
    s_add_u32 s54, s54, s50
    s_lshl_b32 s54, s54, 10
    s_add_u32 s54, s54, s98
    s_lshl_b32 s54, s54, 2
    s_add_u32 s54, s54, 53840896
    s_waitcnt vmcnt(12)
    v_mov_b32 v12, s54
    v_mov_b32 v13, 1
    s_mov_b64 exec, 1
    global_store_dword v12, v13, s[48:49] sc1
    s_mov_b64 exec, -1
    v_mfma_f32_16x16x32_bf16 v[244:247], a[152:155], a[12:15], v[244:247]
    ds_read_b128 a[144:147], v42 offset:17408
    v_mfma_f32_16x16x32_bf16 v[248:251], a[156:159], a[8:11], v[248:251]
    ds_read_b128 a[148:151], v43 offset:15360
    v_mfma_f32_16x16x32_bf16 v[252:255], a[156:159], a[12:15], v[252:255]
    s_waitcnt lgkmcnt(4)
    v_mfma_f32_16x16x32_bf16 v[240:243], a[128:131], a[16:19], v[240:243]
    ds_read_b128 a[152:155], v43 offset:16384
    v_mfma_f32_16x16x32_bf16 v[244:247], a[128:131], a[20:23], v[244:247]
    ds_read_b128 a[156:159], v43 offset:17408
    v_mfma_f32_16x16x32_bf16 v[248:251], a[132:135], a[16:19], v[248:251]
    v_mfma_f32_16x16x32_bf16 v[252:255], a[132:135], a[20:23], v[252:255]
    s_waitcnt lgkmcnt(4)
    v_mfma_f32_16x16x32_bf16 v[240:243], a[136:139], a[24:27], v[240:243]
    s_lshl2_add_u32 s36, s80, s50
    s_lshl_b32 s36, s36, 7
    s_add_u32 s36, s36, 53970960
    v_mov_b32 v16, s36
    v_mov_b32 v17, 1
    s_mov_b64 exec, 1
    global_store_dword v16, v17, s[48:49] sc1
    s_mov_b64 exec, -1
    s_barrier
    v_mfma_f32_16x16x32_bf16 v[244:247], a[136:139], a[28:31], v[244:247]
    s_add_u32 m0, s52, 6144
    ds_read_b64_tr_b16 a[128:129], v5 offset:18432
    v_mfma_f32_16x16x32_bf16 v[248:251], a[140:143], a[24:27], v[248:251]
    ds_read_b64_tr_b16 a[130:131], v21 offset:18432
    ds_read_b64_tr_b16 a[132:133], v24 offset:18432
    v_mfma_f32_16x16x32_bf16 v[252:255], a[140:143], a[28:31], v[252:255]
    ds_read_b64_tr_b16 a[134:135], v25 offset:18432
    s_waitcnt lgkmcnt(6)
    v_mfma_f32_16x16x32_bf16 v[240:243], a[144:147], a[32:35], v[240:243]
    s_add_u32 s82, s77, s86
    ds_read_b64_tr_b16 a[136:137], v22 offset:18432
    v_mfma_f32_16x16x32_bf16 v[244:247], a[144:147], a[36:39], v[244:247]
    buffer_load_dwordx4 v1, s[60:63], s82 offen offset:0 sc1 lds
    v_mfma_f32_16x16x32_bf16 v[248:251], a[148:151], a[32:35], v[248:251]
    ds_read_b64_tr_b16 a[138:139], v23 offset:18432
    ds_read_b64_tr_b16 a[140:141], v26 offset:18432
    v_mfma_f32_16x16x32_bf16 v[252:255], a[148:151], a[36:39], v[252:255]
    ds_read_b64_tr_b16 a[142:143], v27 offset:18432
    s_waitcnt lgkmcnt(8)
    v_mfma_f32_16x16x32_bf16 v[240:243], a[152:155], a[40:43], v[240:243]
    buffer_load_dwordx4 v1, s[60:63], s82 offen offset:1024 sc1 lds
    v_mfma_f32_16x16x32_bf16 v[244:247], a[152:155], a[44:47], v[244:247]
    ds_read_b64_tr_b16 a[144:145], v5 offset:19456
    ds_read_b64_tr_b16 a[146:147], v21 offset:19456
    v_mfma_f32_16x16x32_bf16 v[248:251], a[156:159], a[40:43], v[248:251]
    ds_read_b64_tr_b16 a[148:149], v24 offset:19456
    v_mfma_f32_16x16x32_bf16 v[252:255], a[156:159], a[44:47], v[252:255]
    ds_read_b64_tr_b16 a[150:151], v25 offset:19456
    s_waitcnt lgkmcnt(8)
    v_mfma_f32_16x16x32_bf16 a[160:163], a[128:131], a[48:51], 0
    buffer_load_dwordx4 v1, s[60:63], s82 offen offset:2048 sc1 lds
    v_mfma_f32_16x16x32_bf16 a[164:167], a[128:131], a[52:55], 0
    ds_read_b64_tr_b16 a[152:153], v22 offset:19456
    ds_read_b64_tr_b16 a[154:155], v23 offset:19456
    v_mfma_f32_16x16x32_bf16 a[176:179], a[132:135], a[48:51], 0
    ds_read_b64_tr_b16 a[156:157], v26 offset:19456
    v_mfma_f32_16x16x32_bf16 a[180:183], a[132:135], a[52:55], 0
    ds_read_b64_tr_b16 a[158:159], v27 offset:19456
    s_waitcnt lgkmcnt(8)
    v_mfma_f32_16x16x32_bf16 a[168:171], a[136:139], a[48:51], 0
    s_add_u32 m0, s52, 9216
    ds_read_b64_tr_b16 a[128:129], v5 offset:20480
    v_mfma_f32_16x16x32_bf16 a[172:175], a[136:139], a[52:55], 0
    s_add_u32 s82, s82, 368640
    ds_read_b64_tr_b16 a[130:131], v21 offset:20480
    v_mfma_f32_16x16x32_bf16 a[184:187], a[140:143], a[48:51], 0
    ds_read_b64_tr_b16 a[132:133], v24 offset:20480
    v_mfma_f32_16x16x32_bf16 a[188:191], a[140:143], a[52:55], 0
    ds_read_b64_tr_b16 a[134:135], v25 offset:20480
    s_waitcnt lgkmcnt(8)
    v_mfma_f32_16x16x32_bf16 a[160:163], a[144:147], a[56:59], a[160:163]
    buffer_load_dwordx4 v1, s[60:63], s82 offen offset:0 sc1 lds
    v_mfma_f32_16x16x32_bf16 a[164:167], a[144:147], a[60:63], a[164:167]
    ds_read_b64_tr_b16 a[136:137], v22 offset:20480
    ds_read_b64_tr_b16 a[138:139], v23 offset:20480
    v_mfma_f32_16x16x32_bf16 a[176:179], a[148:151], a[56:59], a[176:179]
    ds_read_b64_tr_b16 a[140:141], v26 offset:20480
    v_mfma_f32_16x16x32_bf16 a[180:183], a[148:151], a[60:63], a[180:183]
    ds_read_b64_tr_b16 a[142:143], v27 offset:20480
    s_waitcnt lgkmcnt(8)
    v_mfma_f32_16x16x32_bf16 a[168:171], a[152:155], a[56:59], a[168:171]
    buffer_load_dwordx4 v1, s[60:63], s82 offen offset:1024 sc1 lds
    v_mfma_f32_16x16x32_bf16 a[172:175], a[152:155], a[60:63], a[172:175]
    ds_read_b64_tr_b16 a[144:145], v5 offset:21504
    ds_read_b64_tr_b16 a[146:147], v21 offset:21504
    v_mfma_f32_16x16x32_bf16 a[184:187], a[156:159], a[56:59], a[184:187]
    ds_read_b64_tr_b16 a[148:149], v24 offset:21504
    v_mfma_f32_16x16x32_bf16 a[188:191], a[156:159], a[60:63], a[188:191]
    ds_read_b64_tr_b16 a[150:151], v25 offset:21504
    s_waitcnt lgkmcnt(8)
    v_mfma_f32_16x16x32_bf16 a[160:163], a[128:131], a[64:67], a[160:163]
    buffer_load_dwordx4 v1, s[60:63], s82 offen offset:2048 sc1 lds
    v_mfma_f32_16x16x32_bf16 a[164:167], a[128:131], a[68:71], a[164:167]
    ds_read_b64_tr_b16 a[152:153], v22 offset:21504
    ds_read_b64_tr_b16 a[154:155], v23 offset:21504
    v_mfma_f32_16x16x32_bf16 a[176:179], a[132:135], a[64:67], a[176:179]
    ds_read_b64_tr_b16 a[156:157], v26 offset:21504
    v_mfma_f32_16x16x32_bf16 a[180:183], a[132:135], a[68:71], a[180:183]
    ds_read_b64_tr_b16 a[158:159], v27 offset:21504
    s_waitcnt lgkmcnt(8)
    v_mfma_f32_16x16x32_bf16 a[168:171], a[136:139], a[64:67], a[168:171]
    s_add_u32 m0, s52, 12288
    ds_read_b64_tr_b16 a[128:129], v5 offset:22528
    v_mfma_f32_16x16x32_bf16 a[172:175], a[136:139], a[68:71], a[172:175]
    s_add_u32 s82, s82, 368640
    ds_read_b64_tr_b16 a[130:131], v21 offset:22528
    v_mfma_f32_16x16x32_bf16 a[184:187], a[140:143], a[64:67], a[184:187]
    ds_read_b64_tr_b16 a[132:133], v24 offset:22528
    v_mfma_f32_16x16x32_bf16 a[188:191], a[140:143], a[68:71], a[188:191]
    ds_read_b64_tr_b16 a[134:135], v25 offset:22528
    s_waitcnt lgkmcnt(8)
    v_mfma_f32_16x16x32_bf16 a[192:195], a[144:147], a[48:51], 0
    buffer_load_dwordx4 v1, s[60:63], s82 offen offset:0 sc1 lds
    v_mfma_f32_16x16x32_bf16 a[196:199], a[144:147], a[52:55], 0
    ds_read_b64_tr_b16 a[136:137], v22 offset:22528
    ds_read_b64_tr_b16 a[138:139], v23 offset:22528
    v_mfma_f32_16x16x32_bf16 a[208:211], a[148:151], a[48:51], 0
    ds_read_b64_tr_b16 a[140:141], v26 offset:22528
    v_mfma_f32_16x16x32_bf16 a[212:215], a[148:151], a[52:55], 0
    ds_read_b64_tr_b16 a[142:143], v27 offset:22528
    s_waitcnt lgkmcnt(8)
    v_mfma_f32_16x16x32_bf16 a[200:203], a[152:155], a[48:51], 0
    global_load_dword v10, v7, s[48:49] offset:3072 sc1
    ds_read_b64_tr_b16 a[144:145], v5 offset:23552
    v_mfma_f32_16x16x32_bf16 a[204:207], a[152:155], a[52:55], 0
    buffer_load_dwordx4 v1, s[60:63], s82 offen offset:1024 sc1 lds
    v_mfma_f32_16x16x32_bf16 a[216:219], a[156:159], a[48:51], 0
    ds_read_b64_tr_b16 a[146:147], v21 offset:23552
    ds_read_b64_tr_b16 a[148:149], v24 offset:23552
    v_mfma_f32_16x16x32_bf16 a[220:223], a[156:159], a[52:55], 0
    ds_read_b64_tr_b16 a[150:151], v25 offset:23552
    s_waitcnt lgkmcnt(8)
    v_mfma_f32_16x16x32_bf16 a[192:195], a[128:131], a[56:59], a[192:195]
    buffer_load_dwordx4 v1, s[60:63], s82 offen offset:2048 sc1 lds
    v_mfma_f32_16x16x32_bf16 a[196:199], a[128:131], a[60:63], a[196:199]
    ds_read_b64_tr_b16 a[152:153], v22 offset:23552
    ds_read_b64_tr_b16 a[154:155], v23 offset:23552
    v_mfma_f32_16x16x32_bf16 a[208:211], a[132:135], a[56:59], a[208:211]
    ds_read_b64_tr_b16 a[156:157], v26 offset:23552
    v_mfma_f32_16x16x32_bf16 a[212:215], a[132:135], a[60:63], a[212:215]
    ds_read_b64_tr_b16 a[158:159], v27 offset:23552
    s_waitcnt lgkmcnt(8)
    v_mfma_f32_16x16x32_bf16 a[200:203], a[136:139], a[56:59], a[200:203]
    ds_read_b64_tr_b16 a[128:129], v5 offset:24576
    v_mfma_f32_16x16x32_bf16 a[204:207], a[136:139], a[60:63], a[204:207]
    ds_read_b64_tr_b16 a[130:131], v21 offset:24576
    v_mfma_f32_16x16x32_bf16 a[216:219], a[140:143], a[56:59], a[216:219]
    ds_read_b64_tr_b16 a[132:133], v24 offset:24576
    v_mfma_f32_16x16x32_bf16 a[220:223], a[140:143], a[60:63], a[220:223]
    ds_read_b64_tr_b16 a[134:135], v25 offset:24576
    s_waitcnt lgkmcnt(8)
    v_mfma_f32_16x16x32_bf16 a[192:195], a[144:147], a[64:67], a[192:195]
    ds_read_b64_tr_b16 a[136:137], v22 offset:24576
    v_mfma_f32_16x16x32_bf16 a[196:199], a[144:147], a[68:71], a[196:199]
    ds_read_b64_tr_b16 a[138:139], v23 offset:24576
    v_mfma_f32_16x16x32_bf16 a[208:211], a[148:151], a[64:67], a[208:211]
    ds_read_b64_tr_b16 a[140:141], v26 offset:24576
    v_mfma_f32_16x16x32_bf16 a[212:215], a[148:151], a[68:71], a[212:215]
    ds_read_b64_tr_b16 a[142:143], v27 offset:24576
    s_waitcnt lgkmcnt(8)
    v_mfma_f32_16x16x32_bf16 a[200:203], a[152:155], a[64:67], a[200:203]
    ds_read_b64_tr_b16 a[144:145], v5 offset:25600
    v_mfma_f32_16x16x32_bf16 a[204:207], a[152:155], a[68:71], a[204:207]
    ds_read_b64_tr_b16 a[146:147], v21 offset:25600
    v_mfma_f32_16x16x32_bf16 a[216:219], a[156:159], a[64:67], a[216:219]
    ds_read_b64_tr_b16 a[148:149], v24 offset:25600
    v_mfma_f32_16x16x32_bf16 a[220:223], a[156:159], a[68:71], a[220:223]
    ds_read_b64_tr_b16 a[150:151], v25 offset:25600
    s_waitcnt lgkmcnt(8)
    v_mfma_f32_16x16x32_bf16 a[224:227], a[128:131], a[48:51], 0
    ds_read_b64_tr_b16 a[152:153], v22 offset:25600
    v_mfma_f32_16x16x32_bf16 a[228:231], a[128:131], a[52:55], 0
    ds_read_b64_tr_b16 a[154:155], v23 offset:25600
    v_mfma_f32_16x16x32_bf16 a[240:243], a[132:135], a[48:51], 0
    ds_read_b64_tr_b16 a[156:157], v26 offset:25600
    v_mfma_f32_16x16x32_bf16 a[244:247], a[132:135], a[52:55], 0
    ds_read_b64_tr_b16 a[158:159], v27 offset:25600
    s_waitcnt lgkmcnt(8)
    v_mfma_f32_16x16x32_bf16 a[232:235], a[136:139], a[48:51], 0
    ds_read_b64_tr_b16 a[128:129], v5 offset:26624
    v_mfma_f32_16x16x32_bf16 a[236:239], a[136:139], a[52:55], 0
    ds_read_b64_tr_b16 a[130:131], v21 offset:26624
    v_mfma_f32_16x16x32_bf16 a[248:251], a[140:143], a[48:51], 0
    ds_read_b64_tr_b16 a[132:133], v24 offset:26624
    v_mfma_f32_16x16x32_bf16 a[252:255], a[140:143], a[52:55], 0
    ds_read_b64_tr_b16 a[134:135], v25 offset:26624
    s_waitcnt lgkmcnt(8)
    v_mfma_f32_16x16x32_bf16 a[224:227], a[144:147], a[56:59], a[224:227]
    ds_read_b64_tr_b16 a[136:137], v22 offset:26624
    v_mfma_f32_16x16x32_bf16 a[228:231], a[144:147], a[60:63], a[228:231]
    ds_read_b64_tr_b16 a[138:139], v23 offset:26624
    v_mfma_f32_16x16x32_bf16 a[240:243], a[148:151], a[56:59], a[240:243]
    ds_read_b64_tr_b16 a[140:141], v26 offset:26624
    v_mfma_f32_16x16x32_bf16 a[244:247], a[148:151], a[60:63], a[244:247]
    ds_read_b64_tr_b16 a[142:143], v27 offset:26624
    s_waitcnt lgkmcnt(8)
    v_mfma_f32_16x16x32_bf16 a[232:235], a[152:155], a[56:59], a[232:235]
    s_waitcnt vmcnt(12)
    s_barrier
    v_mfma_f32_16x16x32_bf16 a[236:239], a[152:155], a[60:63], a[236:239]
    s_add_u32 m0, s52, 15360
    ds_read_b64_tr_b16 a[144:145], v5 offset:27648
    v_mfma_f32_16x16x32_bf16 a[248:251], a[156:159], a[56:59], a[248:251]
    ds_read_b64_tr_b16 a[146:147], v21 offset:27648
    ds_read_b64_tr_b16 a[148:149], v24 offset:27648
    v_mfma_f32_16x16x32_bf16 a[252:255], a[156:159], a[60:63], a[252:255]
    ds_read_b64_tr_b16 a[150:151], v25 offset:27648
    s_waitcnt lgkmcnt(8)
    v_mfma_f32_16x16x32_bf16 a[224:227], a[128:131], a[64:67], a[224:227]
    s_branch L_sskip18
L_stub18:
    s_setpc_b64 s[100:101]
L_sskip18:
    s_add_u32 s82, s82, 368640
    ds_read_b64_tr_b16 a[152:153], v22 offset:27648
    v_mfma_f32_16x16x32_bf16 a[228:231], a[128:131], a[68:71], a[228:231]
    buffer_load_dwordx4 v1, s[60:63], s82 offen offset:0 sc1 lds
    v_mfma_f32_16x16x32_bf16 a[240:243], a[132:135], a[64:67], a[240:243]
    ds_read_b64_tr_b16 a[154:155], v23 offset:27648
    ds_read_b64_tr_b16 a[156:157], v26 offset:27648
    v_mfma_f32_16x16x32_bf16 a[244:247], a[132:135], a[68:71], a[244:247]
    ds_read_b64_tr_b16 a[158:159], v27 offset:27648
    s_waitcnt lgkmcnt(8)
    v_mfma_f32_16x16x32_bf16 a[232:235], a[136:139], a[64:67], a[232:235]
    buffer_load_dwordx4 v1, s[60:63], s82 offen offset:1024 sc1 lds
    v_mfma_f32_16x16x32_bf16 a[236:239], a[136:139], a[68:71], a[236:239]
    ds_read_b64_tr_b16 a[128:129], v5 offset:28672
    ds_read_b64_tr_b16 a[130:131], v21 offset:28672
    v_mfma_f32_16x16x32_bf16 a[248:251], a[140:143], a[64:67], a[248:251]
    ds_read_b64_tr_b16 a[132:133], v24 offset:28672
    v_mfma_f32_16x16x32_bf16 a[252:255], a[140:143], a[68:71], a[252:255]
    ds_read_b64_tr_b16 a[134:135], v25 offset:28672
    s_waitcnt lgkmcnt(8)
    v_mfma_f32_16x16x32_bf16 a[160:163], a[144:147], a[72:75], a[160:163]
    buffer_load_dwordx4 v1, s[60:63], s82 offen offset:2048 sc1 lds
    v_mfma_f32_16x16x32_bf16 a[164:167], a[144:147], a[76:79], a[164:167]
    ds_read_b64_tr_b16 a[136:137], v22 offset:28672
    ds_read_b64_tr_b16 a[138:139], v23 offset:28672
    v_mfma_f32_16x16x32_bf16 a[176:179], a[148:151], a[72:75], a[176:179]
    ds_read_b64_tr_b16 a[140:141], v26 offset:28672
    v_mfma_f32_16x16x32_bf16 a[180:183], a[148:151], a[76:79], a[180:183]
    ds_read_b64_tr_b16 a[142:143], v27 offset:28672
    s_waitcnt lgkmcnt(8)
    v_mfma_f32_16x16x32_bf16 a[168:171], a[152:155], a[72:75], a[168:171]
    s_waitcnt vmcnt(5)
    v_cmp_gt_u32 vcc, 1, v10
    s_cbranch_vccnz L_poll16
L_fok16:
    s_add_u32 s83, s76, s86
    buffer_load_dwordx4 a[96:99], v1, s[68:71], s83 offen offset:0 sc1
    buffer_load_dwordx4 a[100:103], v1, s[68:71], s83 offen offset:1024 sc1
    buffer_load_dwordx4 a[104:107], v1, s[68:71], s83 offen offset:2048 sc1
    buffer_load_dwordx4 a[108:111], v1, s[68:71], s83 offen offset:3072 sc1
    s_add_u32 s83, s83, 4096
    buffer_load_dwordx4 a[112:115], v1, s[68:71], s83 offen offset:0 sc1
    buffer_load_dwordx4 a[116:119], v1, s[68:71], s83 offen offset:1024 sc1
    buffer_load_dwordx4 a[120:123], v1, s[68:71], s83 offen offset:2048 sc1
    buffer_load_dwordx4 a[124:127], v1, s[68:71], s83 offen offset:3072 sc1
    s_add_u32 s83, s83, 4096
    buffer_load_dwordx4 a[0:3], v1, s[68:71], s83 offen offset:0 sc1
    buffer_load_dwordx4 a[4:7], v1, s[68:71], s83 offen offset:1024 sc1
    buffer_load_dwordx4 a[8:11], v1, s[68:71], s83 offen offset:2048 sc1
    buffer_load_dwordx4 a[12:15], v1, s[68:71], s83 offen offset:3072 sc1
    v_mfma_f32_16x16x32_bf16 a[172:175], a[152:155], a[76:79], a[172:175]
    s_add_u32 m0, s52, 18432
    ds_read_b64_tr_b16 a[144:145], v5 offset:29696
    v_mfma_f32_16x16x32_bf16 a[184:187], a[156:159], a[72:75], a[184:187]
    ds_read_b64_tr_b16 a[146:147], v21 offset:29696
    ds_read_b64_tr_b16 a[148:149], v24 offset:29696
    v_mfma_f32_16x16x32_bf16 a[188:191], a[156:159], a[76:79], a[188:191]
    ds_read_b64_tr_b16 a[150:151], v25 offset:29696
    s_waitcnt lgkmcnt(8)
    v_mfma_f32_16x16x32_bf16 a[160:163], a[128:131], a[80:83], a[160:163]
    s_add_u32 s82, s82, 368640
    ds_read_b64_tr_b16 a[152:153], v22 offset:29696
    v_mfma_f32_16x16x32_bf16 a[164:167], a[128:131], a[84:87], a[164:167]
    buffer_load_dwordx4 v1, s[60:63], s82 offen offset:0 sc1 lds
    v_mfma_f32_16x16x32_bf16 a[176:179], a[132:135], a[80:83], a[176:179]
    ds_read_b64_tr_b16 a[154:155], v23 offset:29696
    ds_read_b64_tr_b16 a[156:157], v26 offset:29696
    v_mfma_f32_16x16x32_bf16 a[180:183], a[132:135], a[84:87], a[180:183]
    ds_read_b64_tr_b16 a[158:159], v27 offset:29696
    s_waitcnt lgkmcnt(8)
    v_mfma_f32_16x16x32_bf16 a[168:171], a[136:139], a[80:83], a[168:171]
    buffer_load_dwordx4 v1, s[60:63], s82 offen offset:1024 sc1 lds
    v_mfma_f32_16x16x32_bf16 a[172:175], a[136:139], a[84:87], a[172:175]
    ds_read_b64_tr_b16 a[128:129], v5 offset:0
    ds_read_b64_tr_b16 a[130:131], v21 offset:0
    v_mfma_f32_16x16x32_bf16 a[184:187], a[140:143], a[80:83], a[184:187]
    ds_read_b64_tr_b16 a[132:133], v24 offset:0
    v_mfma_f32_16x16x32_bf16 a[188:191], a[140:143], a[84:87], a[188:191]
    ds_read_b64_tr_b16 a[134:135], v25 offset:0
    s_waitcnt lgkmcnt(8)
    v_mfma_f32_16x16x32_bf16 a[160:163], a[144:147], a[88:91], a[160:163]
    buffer_load_dwordx4 v1, s[60:63], s82 offen offset:2048 sc1 lds
    v_mfma_f32_16x16x32_bf16 a[164:167], a[144:147], a[92:95], a[164:167]
    ds_read_b64_tr_b16 a[136:137], v22 offset:0
    ds_read_b64_tr_b16 a[138:139], v23 offset:0
    v_mfma_f32_16x16x32_bf16 a[176:179], a[148:151], a[88:91], a[176:179]
    ds_read_b64_tr_b16 a[140:141], v26 offset:0
    v_mfma_f32_16x16x32_bf16 a[180:183], a[148:151], a[92:95], a[180:183]
    ds_read_b64_tr_b16 a[142:143], v27 offset:0
    s_waitcnt lgkmcnt(8)
    v_mfma_f32_16x16x32_bf16 a[168:171], a[152:155], a[88:91], a[168:171]
    s_add_u32 s83, s76, s87
    ds_read_b64_tr_b16 a[144:145], v5 offset:1024
    v_mfma_f32_16x16x32_bf16 a[172:175], a[152:155], a[92:95], a[172:175]
    buffer_load_dwordx4 a[16:19], v1, s[68:71], s83 offen offset:0 sc1
    v_mfma_f32_16x16x32_bf16 a[184:187], a[156:159], a[88:91], a[184:187]
    ds_read_b64_tr_b16 a[146:147], v21 offset:1024
    ds_read_b64_tr_b16 a[148:149], v24 offset:1024
    v_mfma_f32_16x16x32_bf16 a[188:191], a[156:159], a[92:95], a[188:191]
    ds_read_b64_tr_b16 a[150:151], v25 offset:1024
    s_waitcnt lgkmcnt(8)
    v_mfma_f32_16x16x32_bf16 a[192:195], a[128:131], a[72:75], a[192:195]
    buffer_load_dwordx4 a[20:23], v1, s[68:71], s83 offen offset:1024 sc1
    v_mfma_f32_16x16x32_bf16 a[196:199], a[128:131], a[76:79], a[196:199]
    ds_read_b64_tr_b16 a[152:153], v22 offset:1024
    ds_read_b64_tr_b16 a[154:155], v23 offset:1024
    v_mfma_f32_16x16x32_bf16 a[208:211], a[132:135], a[72:75], a[208:211]
    ds_read_b64_tr_b16 a[156:157], v26 offset:1024
    v_mfma_f32_16x16x32_bf16 a[212:215], a[132:135], a[76:79], a[212:215]
    ds_read_b64_tr_b16 a[158:159], v27 offset:1024
    s_waitcnt lgkmcnt(8)
    v_mfma_f32_16x16x32_bf16 a[200:203], a[136:139], a[72:75], a[200:203]
    ds_read_b64_tr_b16 a[128:129], v5 offset:2048
    v_mfma_f32_16x16x32_bf16 a[204:207], a[136:139], a[76:79], a[204:207]
    ds_read_b64_tr_b16 a[130:131], v21 offset:2048
    v_mfma_f32_16x16x32_bf16 a[216:219], a[140:143], a[72:75], a[216:219]
    ds_read_b64_tr_b16 a[132:133], v24 offset:2048
    v_mfma_f32_16x16x32_bf16 a[220:223], a[140:143], a[76:79], a[220:223]
    ds_read_b64_tr_b16 a[134:135], v25 offset:2048
    s_waitcnt lgkmcnt(8)
    v_mfma_f32_16x16x32_bf16 a[192:195], a[144:147], a[80:83], a[192:195]
    s_add_u32 m0, s52, 21504
    ds_read_b64_tr_b16 a[136:137], v22 offset:2048
    v_mfma_f32_16x16x32_bf16 a[196:199], a[144:147], a[84:87], a[196:199]
    s_add_u32 s82, s82, 368640
    ds_read_b64_tr_b16 a[138:139], v23 offset:2048
    v_mfma_f32_16x16x32_bf16 a[208:211], a[148:151], a[80:83], a[208:211]
    ds_read_b64_tr_b16 a[140:141], v26 offset:2048
    v_mfma_f32_16x16x32_bf16 a[212:215], a[148:151], a[84:87], a[212:215]
    ds_read_b64_tr_b16 a[142:143], v27 offset:2048
    s_waitcnt lgkmcnt(8)
    v_mfma_f32_16x16x32_bf16 a[200:203], a[152:155], a[80:83], a[200:203]
    buffer_load_dwordx4 v1, s[60:63], s82 offen offset:0 sc1 lds
    v_mfma_f32_16x16x32_bf16 a[204:207], a[152:155], a[84:87], a[204:207]
    ds_read_b64_tr_b16 a[144:145], v5 offset:3072
    ds_read_b64_tr_b16 a[146:147], v21 offset:3072
    v_mfma_f32_16x16x32_bf16 a[216:219], a[156:159], a[80:83], a[216:219]
    ds_read_b64_tr_b16 a[148:149], v24 offset:3072
    v_mfma_f32_16x16x32_bf16 a[220:223], a[156:159], a[84:87], a[220:223]
    ds_read_b64_tr_b16 a[150:151], v25 offset:3072
    s_waitcnt lgkmcnt(8)
    v_mfma_f32_16x16x32_bf16 a[192:195], a[128:131], a[88:91], a[192:195]
    buffer_load_dwordx4 v1, s[60:63], s82 offen offset:1024 sc1 lds
    v_mfma_f32_16x16x32_bf16 a[196:199], a[128:131], a[92:95], a[196:199]
    ds_read_b64_tr_b16 a[152:153], v22 offset:3072
    ds_read_b64_tr_b16 a[154:155], v23 offset:3072
    v_mfma_f32_16x16x32_bf16 a[208:211], a[132:135], a[88:91], a[208:211]
    ds_read_b64_tr_b16 a[156:157], v26 offset:3072
    v_mfma_f32_16x16x32_bf16 a[212:215], a[132:135], a[92:95], a[212:215]
    ds_read_b64_tr_b16 a[158:159], v27 offset:3072
    s_waitcnt lgkmcnt(8)
    v_mfma_f32_16x16x32_bf16 a[200:203], a[136:139], a[88:91], a[200:203]
    buffer_load_dwordx4 v1, s[60:63], s82 offen offset:2048 sc1 lds
    v_mfma_f32_16x16x32_bf16 a[204:207], a[136:139], a[92:95], a[204:207]
    ds_read_b64_tr_b16 a[128:129], v5 offset:4096
    ds_read_b64_tr_b16 a[130:131], v21 offset:4096
    v_mfma_f32_16x16x32_bf16 a[216:219], a[140:143], a[88:91], a[216:219]
    ds_read_b64_tr_b16 a[132:133], v24 offset:4096
    v_mfma_f32_16x16x32_bf16 a[220:223], a[140:143], a[92:95], a[220:223]
    ds_read_b64_tr_b16 a[134:135], v25 offset:4096
    s_waitcnt lgkmcnt(8)
    v_mfma_f32_16x16x32_bf16 a[224:227], a[144:147], a[72:75], a[224:227]
    buffer_load_dwordx4 a[24:27], v1, s[68:71], s83 offen offset:2048 sc1
    v_mfma_f32_16x16x32_bf16 a[228:231], a[144:147], a[76:79], a[228:231]
    ds_read_b64_tr_b16 a[136:137], v22 offset:4096
    ds_read_b64_tr_b16 a[138:139], v23 offset:4096
    v_mfma_f32_16x16x32_bf16 a[240:243], a[148:151], a[72:75], a[240:243]
    ds_read_b64_tr_b16 a[140:141], v26 offset:4096
    v_mfma_f32_16x16x32_bf16 a[244:247], a[148:151], a[76:79], a[244:247]
    ds_read_b64_tr_b16 a[142:143], v27 offset:4096
    s_waitcnt lgkmcnt(8)
    v_mfma_f32_16x16x32_bf16 a[232:235], a[152:155], a[72:75], a[232:235]
    buffer_load_dwordx4 a[28:31], v1, s[68:71], s83 offen offset:3072 sc1
    v_mfma_f32_16x16x32_bf16 a[236:239], a[152:155], a[76:79], a[236:239]
    ds_read_b64_tr_b16 a[144:145], v5 offset:5120
    ds_read_b64_tr_b16 a[146:147], v21 offset:5120
    v_mfma_f32_16x16x32_bf16 a[248:251], a[156:159], a[72:75], a[248:251]
    ds_read_b64_tr_b16 a[148:149], v24 offset:5120
    v_mfma_f32_16x16x32_bf16 a[252:255], a[156:159], a[76:79], a[252:255]
    ds_read_b64_tr_b16 a[150:151], v25 offset:5120
    s_waitcnt lgkmcnt(8)
    v_mfma_f32_16x16x32_bf16 a[224:227], a[128:131], a[80:83], a[224:227]
    s_add_u32 s83, s83, 4096
    ds_read_b64_tr_b16 a[152:153], v22 offset:5120
    v_mfma_f32_16x16x32_bf16 a[228:231], a[128:131], a[84:87], a[228:231]
    buffer_load_dwordx4 a[32:35], v1, s[68:71], s83 offen offset:0 sc1
    v_mfma_f32_16x16x32_bf16 a[240:243], a[132:135], a[80:83], a[240:243]
    ds_read_b64_tr_b16 a[154:155], v23 offset:5120
    ds_read_b64_tr_b16 a[156:157], v26 offset:5120
    v_mfma_f32_16x16x32_bf16 a[244:247], a[132:135], a[84:87], a[244:247]
    ds_read_b64_tr_b16 a[158:159], v27 offset:5120
    s_waitcnt lgkmcnt(8)
    v_mfma_f32_16x16x32_bf16 a[232:235], a[136:139], a[80:83], a[232:235]
    s_waitcnt vmcnt(26)
    s_barrier
    v_mfma_f32_16x16x32_bf16 a[236:239], a[136:139], a[84:87], a[236:239]
    ds_read_b128 a[128:131], v40 offset:6144
    v_mfma_f32_16x16x32_bf16 a[248:251], a[140:143], a[80:83], a[248:251]
    ds_read_b128 a[132:135], v40 offset:7168
    v_mfma_f32_16x16x32_bf16 a[252:255], a[140:143], a[84:87], a[252:255]
    s_waitcnt lgkmcnt(6)
    v_mfma_f32_16x16x32_bf16 a[224:227], a[144:147], a[88:91], a[224:227]
    buffer_load_dwordx4 a[36:39], v1, s[68:71], s83 offen offset:1024 sc1
    v_mfma_f32_16x16x32_bf16 a[228:231], a[144:147], a[92:95], a[228:231]
    ds_read_b128 a[136:139], v40 offset:8192
    v_mfma_f32_16x16x32_bf16 a[240:243], a[148:151], a[88:91], a[240:243]
    ds_read_b128 a[140:143], v41 offset:6144
    v_mfma_f32_16x16x32_bf16 a[244:247], a[148:151], a[92:95], a[244:247]
    s_waitcnt lgkmcnt(4)
    v_mfma_f32_16x16x32_bf16 a[232:235], a[152:155], a[88:91], a[232:235]
    buffer_load_dwordx4 a[40:43], v1, s[68:71], s83 offen offset:2048 sc1
    v_mfma_f32_16x16x32_bf16 a[236:239], a[152:155], a[92:95], a[236:239]
    ds_read_b128 a[144:147], v41 offset:7168
    v_mfma_f32_16x16x32_bf16 a[248:251], a[156:159], a[88:91], a[248:251]
    ds_read_b128 a[148:151], v41 offset:8192
    v_mfma_f32_16x16x32_bf16 a[252:255], a[156:159], a[92:95], a[252:255]
    s_waitcnt vmcnt(23) lgkmcnt(4)
    v_mfma_f32_16x16x32_bf16 v[96:99], a[128:131], a[96:99], v[96:99]
    buffer_load_dwordx4 a[44:47], v1, s[68:71], s83 offen offset:3072 sc1
    v_mfma_f32_16x16x32_bf16 v[100:103], a[128:131], a[100:103], v[100:103]
    ds_read_b128 a[152:155], v42 offset:6144
    v_mfma_f32_16x16x32_bf16 v[104:107], a[132:135], a[96:99], v[104:107]
    ds_read_b128 a[156:159], v42 offset:7168
    v_mfma_f32_16x16x32_bf16 v[108:111], a[132:135], a[100:103], v[108:111]
    s_waitcnt vmcnt(22) lgkmcnt(4)
    v_mfma_f32_16x16x32_bf16 v[96:99], a[136:139], a[104:107], v[96:99]
    s_add_u32 s83, s83, 4096
    ds_read_b128 a[128:131], v42 offset:8192
    v_mfma_f32_16x16x32_bf16 v[100:103], a[136:139], a[108:111], v[100:103]
    buffer_load_dwordx4 a[48:51], v1, s[68:71], s83 offen offset:0 sc1
    v_mfma_f32_16x16x32_bf16 v[104:107], a[140:143], a[104:107], v[104:107]
    ds_read_b128 a[132:135], v43 offset:6144
    v_mfma_f32_16x16x32_bf16 v[108:111], a[140:143], a[108:111], v[108:111]
    s_waitcnt vmcnt(21) lgkmcnt(4)
    v_mfma_f32_16x16x32_bf16 v[96:99], a[144:147], a[112:115], v[96:99]
    buffer_load_dwordx4 a[52:55], v1, s[68:71], s83 offen offset:1024 sc1
    v_mfma_f32_16x16x32_bf16 v[100:103], a[144:147], a[116:119], v[100:103]
    ds_read_b128 a[136:139], v43 offset:7168
    v_mfma_f32_16x16x32_bf16 v[104:107], a[148:151], a[112:115], v[104:107]
    ds_read_b128 a[140:143], v43 offset:8192
    v_mfma_f32_16x16x32_bf16 v[108:111], a[148:151], a[116:119], v[108:111]
    s_waitcnt vmcnt(20) lgkmcnt(4)
    v_mfma_f32_16x16x32_bf16 v[96:99], a[152:155], a[120:123], v[96:99]
    buffer_load_dwordx4 a[56:59], v1, s[68:71], s83 offen offset:2048 sc1
    v_mfma_f32_16x16x32_bf16 v[100:103], a[152:155], a[124:127], v[100:103]
    ds_read_b128 a[144:147], v40 offset:9216
    v_mfma_f32_16x16x32_bf16 v[104:107], a[156:159], a[120:123], v[104:107]
    ds_read_b128 a[148:151], v40 offset:10240
    v_mfma_f32_16x16x32_bf16 v[108:111], a[156:159], a[124:127], v[108:111]
    s_waitcnt vmcnt(19) lgkmcnt(4)
    v_mfma_f32_16x16x32_bf16 v[96:99], a[128:131], a[0:3], v[96:99]
    ds_read_b128 a[152:155], v40 offset:11264
    v_mfma_f32_16x16x32_bf16 v[100:103], a[128:131], a[4:7], v[100:103]
    ds_read_b128 a[156:159], v41 offset:9216
    v_mfma_f32_16x16x32_bf16 v[104:107], a[132:135], a[0:3], v[104:107]
    v_mfma_f32_16x16x32_bf16 v[108:111], a[132:135], a[4:7], v[108:111]
    s_waitcnt vmcnt(17) lgkmcnt(4)
    v_mfma_f32_16x16x32_bf16 v[96:99], a[136:139], a[8:11], v[96:99]
    buffer_load_dwordx4 a[60:63], v1, s[68:71], s83 offen offset:3072 sc1
    v_mfma_f32_16x16x32_bf16 v[100:103], a[136:139], a[12:15], v[100:103]
    ds_read_b128 a[128:131], v41 offset:10240
    v_mfma_f32_16x16x32_bf16 v[104:107], a[140:143], a[8:11], v[104:107]
    ds_read_b128 a[132:135], v41 offset:11264
    v_mfma_f32_16x16x32_bf16 v[108:111], a[140:143], a[12:15], v[108:111]
    s_waitcnt lgkmcnt(4)
    v_mfma_f32_16x16x32_bf16 v[112:115], a[144:147], a[96:99], v[112:115]
    s_add_u32 m0, s52, 24576
    s_add_u32 s82, s77, s87
    v_mfma_f32_16x16x32_bf16 v[116:119], a[144:147], a[100:103], v[116:119]
    buffer_load_dwordx4 v1, s[60:63], s82 offen offset:0 sc1 lds
    v_mfma_f32_16x16x32_bf16 v[120:123], a[148:151], a[96:99], v[120:123]
    ds_read_b128 a[136:139], v42 offset:9216
    v_mfma_f32_16x16x32_bf16 v[124:127], a[148:151], a[100:103], v[124:127]
    ds_read_b128 a[140:143], v42 offset:10240
    s_waitcnt lgkmcnt(4)
    v_mfma_f32_16x16x32_bf16 v[112:115], a[152:155], a[104:107], v[112:115]
    buffer_load_dwordx4 v1, s[60:63], s82 offen offset:1024 sc1 lds
    v_mfma_f32_16x16x32_bf16 v[116:119], a[152:155], a[108:111], v[116:119]
    ds_read_b128 a[144:147], v42 offset:11264
    v_mfma_f32_16x16x32_bf16 v[120:123], a[156:159], a[104:107], v[120:123]
    ds_read_b128 a[148:151], v43 offset:9216
    v_mfma_f32_16x16x32_bf16 v[124:127], a[156:159], a[108:111], v[124:127]
    s_waitcnt lgkmcnt(4)
    v_mfma_f32_16x16x32_bf16 v[112:115], a[128:131], a[112:115], v[112:115]
    buffer_load_dwordx4 v1, s[60:63], s82 offen offset:2048 sc1 lds
    v_mfma_f32_16x16x32_bf16 v[116:119], a[128:131], a[116:119], v[116:119]
    ds_read_b128 a[152:155], v43 offset:10240
    v_mfma_f32_16x16x32_bf16 v[120:123], a[132:135], a[112:115], v[120:123]
    ds_read_b128 a[156:159], v43 offset:11264
    v_mfma_f32_16x16x32_bf16 v[124:127], a[132:135], a[116:119], v[124:127]
    s_waitcnt lgkmcnt(4)
    v_mfma_f32_16x16x32_bf16 v[112:115], a[136:139], a[120:123], v[112:115]
    s_add_u32 m0, s52, 27648
    s_add_u32 s82, s82, 368640
    v_mfma_f32_16x16x32_bf16 v[116:119], a[136:139], a[124:127], v[116:119]
    buffer_load_dwordx4 v1, s[60:63], s82 offen offset:0 sc1 lds
    v_mfma_f32_16x16x32_bf16 v[120:123], a[140:143], a[120:123], v[120:123]
    ds_read_b128 a[128:131], v40 offset:12288
    v_mfma_f32_16x16x32_bf16 v[124:127], a[140:143], a[124:127], v[124:127]
    ds_read_b128 a[132:135], v40 offset:13312
    s_waitcnt lgkmcnt(4)
    v_mfma_f32_16x16x32_bf16 v[112:115], a[144:147], a[0:3], v[112:115]
    buffer_load_dwordx4 v1, s[60:63], s82 offen offset:1024 sc1 lds
    v_mfma_f32_16x16x32_bf16 v[116:119], a[144:147], a[4:7], v[116:119]
    ds_read_b128 a[136:139], v40 offset:14336
    v_mfma_f32_16x16x32_bf16 v[120:123], a[148:151], a[0:3], v[120:123]
    ds_read_b128 a[140:143], v41 offset:12288
    v_mfma_f32_16x16x32_bf16 v[124:127], a[148:151], a[4:7], v[124:127]
    s_waitcnt lgkmcnt(4)
    v_mfma_f32_16x16x32_bf16 v[112:115], a[152:155], a[8:11], v[112:115]
    ds_read_b128 a[144:147], v41 offset:13312
    v_mfma_f32_16x16x32_bf16 v[116:119], a[152:155], a[12:15], v[116:119]
    ds_read_b128 a[148:151], v41 offset:14336
    v_mfma_f32_16x16x32_bf16 v[120:123], a[156:159], a[8:11], v[120:123]
    v_mfma_f32_16x16x32_bf16 v[124:127], a[156:159], a[12:15], v[124:127]
    s_waitcnt lgkmcnt(4)
    v_mfma_f32_16x16x32_bf16 v[160:163], a[128:131], a[96:99], v[160:163]
    buffer_load_dwordx4 v1, s[60:63], s82 offen offset:2048 sc1 lds
    v_mfma_f32_16x16x32_bf16 v[164:167], a[128:131], a[100:103], v[164:167]
    ds_read_b128 a[152:155], v42 offset:12288
    v_mfma_f32_16x16x32_bf16 v[168:171], a[132:135], a[96:99], v[168:171]
    ds_read_b128 a[156:159], v42 offset:13312
    v_mfma_f32_16x16x32_bf16 v[172:175], a[132:135], a[100:103], v[172:175]
    s_waitcnt lgkmcnt(4)
    v_mfma_f32_16x16x32_bf16 v[160:163], a[136:139], a[104:107], v[160:163]
    s_add_u32 m0, s52, 0
    s_add_u32 s82, s82, 368640
    v_mfma_f32_16x16x32_bf16 v[164:167], a[136:139], a[108:111], v[164:167]
    buffer_load_dwordx4 v1, s[60:63], s82 offen offset:0 sc1 lds
    v_mfma_f32_16x16x32_bf16 v[168:171], a[140:143], a[104:107], v[168:171]
    ds_read_b128 a[128:131], v42 offset:14336
    v_mfma_f32_16x16x32_bf16 v[172:175], a[140:143], a[108:111], v[172:175]
    ds_read_b128 a[132:135], v43 offset:12288
    s_waitcnt lgkmcnt(4)
    v_mfma_f32_16x16x32_bf16 v[160:163], a[144:147], a[112:115], v[160:163]
    buffer_load_dwordx4 v1, s[60:63], s82 offen offset:1024 sc1 lds
    v_mfma_f32_16x16x32_bf16 v[164:167], a[144:147], a[116:119], v[164:167]
    ds_read_b128 a[136:139], v43 offset:13312
    v_mfma_f32_16x16x32_bf16 v[168:171], a[148:151], a[112:115], v[168:171]
    ds_read_b128 a[140:143], v43 offset:14336
    v_mfma_f32_16x16x32_bf16 v[172:175], a[148:151], a[116:119], v[172:175]
    s_waitcnt lgkmcnt(4)
    v_mfma_f32_16x16x32_bf16 v[160:163], a[152:155], a[120:123], v[160:163]
    s_waitcnt vmcnt(18)
    s_barrier
    v_mfma_f32_16x16x32_bf16 v[164:167], a[152:155], a[124:127], v[164:167]
    buffer_load_dwordx4 v1, s[60:63], s82 offen offset:2048 sc1 lds
    v_mfma_f32_16x16x32_bf16 v[168:171], a[156:159], a[120:123], v[168:171]
    ds_read_b128 a[144:147], v40 offset:15360
    v_mfma_f32_16x16x32_bf16 v[172:175], a[156:159], a[124:127], v[172:175]
    ds_read_b128 a[148:151], v40 offset:16384
    s_waitcnt lgkmcnt(4)
    v_mfma_f32_16x16x32_bf16 v[160:163], a[128:131], a[0:3], v[160:163]
    s_add_u32 m0, s52, 3072
    s_add_u32 s82, s82, 368640
    v_mfma_f32_16x16x32_bf16 v[164:167], a[128:131], a[4:7], v[164:167]
    buffer_load_dwordx4 v1, s[60:63], s82 offen offset:0 sc1 lds
    v_mfma_f32_16x16x32_bf16 v[168:171], a[132:135], a[0:3], v[168:171]
    ds_read_b128 a[152:155], v40 offset:17408
    v_mfma_f32_16x16x32_bf16 v[172:175], a[132:135], a[4:7], v[172:175]
    ds_read_b128 a[156:159], v41 offset:15360
    s_waitcnt lgkmcnt(4)
    v_mfma_f32_16x16x32_bf16 v[160:163], a[136:139], a[8:11], v[160:163]
    buffer_load_dwordx4 v1, s[60:63], s82 offen offset:1024 sc1 lds
    v_mfma_f32_16x16x32_bf16 v[164:167], a[136:139], a[12:15], v[164:167]
    ds_read_b128 a[128:131], v41 offset:16384
    v_mfma_f32_16x16x32_bf16 v[168:171], a[140:143], a[8:11], v[168:171]
    ds_read_b128 a[132:135], v41 offset:17408
    v_mfma_f32_16x16x32_bf16 v[172:175], a[140:143], a[12:15], v[172:175]
    s_waitcnt lgkmcnt(4)
    v_mfma_f32_16x16x32_bf16 v[176:179], a[144:147], a[96:99], v[176:179]
    ds_read_b128 a[136:139], v42 offset:15360
    v_mfma_f32_16x16x32_bf16 v[180:183], a[144:147], a[100:103], v[180:183]
    ds_read_b128 a[140:143], v42 offset:16384
    v_mfma_f32_16x16x32_bf16 v[184:187], a[148:151], a[96:99], v[184:187]
    v_mfma_f32_16x16x32_bf16 v[188:191], a[148:151], a[100:103], v[188:191]
    s_waitcnt lgkmcnt(4)
    v_mfma_f32_16x16x32_bf16 v[176:179], a[152:155], a[104:107], v[176:179]
    buffer_load_dwordx4 v1, s[60:63], s82 offen offset:2048 sc1 lds
    v_mfma_f32_16x16x32_bf16 v[180:183], a[152:155], a[108:111], v[180:183]
    ds_read_b128 a[144:147], v42 offset:17408
    v_mfma_f32_16x16x32_bf16 v[184:187], a[156:159], a[104:107], v[184:187]
    ds_read_b128 a[148:151], v43 offset:15360
    v_mfma_f32_16x16x32_bf16 v[188:191], a[156:159], a[108:111], v[188:191]
    s_waitcnt lgkmcnt(4)
    v_mfma_f32_16x16x32_bf16 v[176:179], a[128:131], a[112:115], v[176:179]
    s_add_u32 m0, s52, 6144
    s_add_u32 s82, s82, 368640
    v_mfma_f32_16x16x32_bf16 v[180:183], a[128:131], a[116:119], v[180:183]
    buffer_load_dwordx4 v1, s[60:63], s82 offen offset:0 sc1 lds
    v_mfma_f32_16x16x32_bf16 v[184:187], a[132:135], a[112:115], v[184:187]
    ds_read_b128 a[152:155], v43 offset:16384
    v_mfma_f32_16x16x32_bf16 v[188:191], a[132:135], a[116:119], v[188:191]
    ds_read_b128 a[156:159], v43 offset:17408
    s_waitcnt lgkmcnt(4)
    v_mfma_f32_16x16x32_bf16 v[176:179], a[136:139], a[120:123], v[176:179]
    buffer_load_dwordx4 v1, s[60:63], s82 offen offset:1024 sc1 lds
    v_mfma_f32_16x16x32_bf16 v[180:183], a[136:139], a[124:127], v[180:183]
    ds_read_b128 a[128:131], v40 offset:18432
    v_mfma_f32_16x16x32_bf16 v[184:187], a[140:143], a[120:123], v[184:187]
    ds_read_b128 a[132:135], v40 offset:19456
    v_mfma_f32_16x16x32_bf16 v[188:191], a[140:143], a[124:127], v[188:191]
    s_waitcnt lgkmcnt(4)
    v_mfma_f32_16x16x32_bf16 v[176:179], a[144:147], a[0:3], v[176:179]
    buffer_load_dwordx4 v1, s[60:63], s82 offen offset:2048 sc1 lds
    v_mfma_f32_16x16x32_bf16 v[180:183], a[144:147], a[4:7], v[180:183]
    ds_read_b128 a[136:139], v40 offset:20480
    v_mfma_f32_16x16x32_bf16 v[184:187], a[148:151], a[0:3], v[184:187]
    ds_read_b128 a[140:143], v41 offset:18432
    v_mfma_f32_16x16x32_bf16 v[188:191], a[148:151], a[4:7], v[188:191]
    s_waitcnt lgkmcnt(4)
    v_mfma_f32_16x16x32_bf16 v[176:179], a[152:155], a[8:11], v[176:179]
    s_add_u32 s83, s76, s88
    ds_read_b128 a[144:147], v41 offset:19456
    v_mfma_f32_16x16x32_bf16 v[180:183], a[152:155], a[12:15], v[180:183]
    buffer_load_dwordx4 a[64:67], v1, s[68:71], s83 offen offset:0 sc1
    v_mfma_f32_16x16x32_bf16 v[184:187], a[156:159], a[8:11], v[184:187]
    ds_read_b128 a[148:151], v41 offset:20480
    v_mfma_f32_16x16x32_bf16 v[188:191], a[156:159], a[12:15], v[188:191]
    s_waitcnt lgkmcnt(4)
    v_mfma_f32_16x16x32_bf16 v[224:227], a[128:131], a[96:99], v[224:227]
    buffer_load_dwordx4 a[68:71], v1, s[68:71], s83 offen offset:1024 sc1
    v_mfma_f32_16x16x32_bf16 v[228:231], a[128:131], a[100:103], v[228:231]
    ds_read_b128 a[152:155], v42 offset:18432
    v_mfma_f32_16x16x32_bf16 v[232:235], a[132:135], a[96:99], v[232:235]
    ds_read_b128 a[156:159], v42 offset:19456
    v_mfma_f32_16x16x32_bf16 v[236:239], a[132:135], a[100:103], v[236:239]
    s_waitcnt lgkmcnt(4)
    v_mfma_f32_16x16x32_bf16 v[224:227], a[136:139], a[104:107], v[224:227]
    ds_read_b128 a[128:131], v42 offset:20480
    v_mfma_f32_16x16x32_bf16 v[228:231], a[136:139], a[108:111], v[228:231]
    ds_read_b128 a[132:135], v43 offset:18432
    v_mfma_f32_16x16x32_bf16 v[232:235], a[140:143], a[104:107], v[232:235]
    v_mfma_f32_16x16x32_bf16 v[236:239], a[140:143], a[108:111], v[236:239]
    s_waitcnt lgkmcnt(4)
    v_mfma_f32_16x16x32_bf16 v[224:227], a[144:147], a[112:115], v[224:227]
    s_add_u32 m0, s52, 9216
    s_add_u32 s82, s82, 368640
    v_mfma_f32_16x16x32_bf16 v[228:231], a[144:147], a[116:119], v[228:231]
    buffer_load_dwordx4 v1, s[60:63], s82 offen offset:0 sc1 lds
    v_mfma_f32_16x16x32_bf16 v[232:235], a[148:151], a[112:115], v[232:235]
    ds_read_b128 a[136:139], v43 offset:19456
    v_mfma_f32_16x16x32_bf16 v[236:239], a[148:151], a[116:119], v[236:239]
    ds_read_b128 a[140:143], v43 offset:20480
    s_waitcnt lgkmcnt(4)
    v_mfma_f32_16x16x32_bf16 v[224:227], a[152:155], a[120:123], v[224:227]
    buffer_load_dwordx4 v1, s[60:63], s82 offen offset:1024 sc1 lds
    v_mfma_f32_16x16x32_bf16 v[228:231], a[152:155], a[124:127], v[228:231]
    ds_read_b128 a[144:147], v40 offset:21504
    v_mfma_f32_16x16x32_bf16 v[232:235], a[156:159], a[120:123], v[232:235]
    ds_read_b128 a[148:151], v40 offset:22528
    v_mfma_f32_16x16x32_bf16 v[236:239], a[156:159], a[124:127], v[236:239]
    s_waitcnt lgkmcnt(4)
    v_mfma_f32_16x16x32_bf16 v[224:227], a[128:131], a[0:3], v[224:227]
    buffer_load_dwordx4 v1, s[60:63], s82 offen offset:2048 sc1 lds
    v_mfma_f32_16x16x32_bf16 v[228:231], a[128:131], a[4:7], v[228:231]
    ds_read_b128 a[152:155], v40 offset:23552
    v_mfma_f32_16x16x32_bf16 v[232:235], a[132:135], a[0:3], v[232:235]
    ds_read_b128 a[156:159], v41 offset:21504
    v_mfma_f32_16x16x32_bf16 v[236:239], a[132:135], a[4:7], v[236:239]
    s_waitcnt lgkmcnt(4)
    v_mfma_f32_16x16x32_bf16 v[224:227], a[136:139], a[8:11], v[224:227]
    buffer_load_dwordx4 a[72:75], v1, s[68:71], s83 offen offset:2048 sc1
    v_mfma_f32_16x16x32_bf16 v[228:231], a[136:139], a[12:15], v[228:231]
    ds_read_b128 a[128:131], v41 offset:22528
    v_mfma_f32_16x16x32_bf16 v[232:235], a[140:143], a[8:11], v[232:235]
    ds_read_b128 a[132:135], v41 offset:23552
    v_mfma_f32_16x16x32_bf16 v[236:239], a[140:143], a[12:15], v[236:239]
    s_waitcnt lgkmcnt(4)
    v_mfma_f32_16x16x32_bf16 v[240:243], a[144:147], a[96:99], v[240:243]
    global_load_dword v10, v63, s[48:49] offset:1024 sc1
    ds_read_b128 a[136:139], v42 offset:21504
    v_mfma_f32_16x16x32_bf16 v[244:247], a[144:147], a[100:103], v[244:247]
    buffer_load_dwordx4 a[76:79], v1, s[68:71], s83 offen offset:3072 sc1
    v_mfma_f32_16x16x32_bf16 v[248:251], a[148:151], a[96:99], v[248:251]
    ds_read_b128 a[140:143], v42 offset:22528
    v_mfma_f32_16x16x32_bf16 v[252:255], a[148:151], a[100:103], v[252:255]
    s_waitcnt lgkmcnt(4)
    v_mfma_f32_16x16x32_bf16 v[240:243], a[152:155], a[104:107], v[240:243]
    s_add_u32 s83, s83, 4096
    ds_read_b128 a[144:147], v42 offset:23552
    v_mfma_f32_16x16x32_bf16 v[244:247], a[152:155], a[108:111], v[244:247]
    buffer_load_dwordx4 a[80:83], v1, s[68:71], s83 offen offset:0 sc1
    v_mfma_f32_16x16x32_bf16 v[248:251], a[156:159], a[104:107], v[248:251]
    ds_read_b128 a[148:151], v43 offset:21504
    v_mfma_f32_16x16x32_bf16 v[252:255], a[156:159], a[108:111], v[252:255]
    s_waitcnt lgkmcnt(4)
    v_mfma_f32_16x16x32_bf16 v[240:243], a[128:131], a[112:115], v[240:243]
    ds_read_b128 a[152:155], v43 offset:22528
    v_mfma_f32_16x16x32_bf16 v[244:247], a[128:131], a[116:119], v[244:247]
    ds_read_b128 a[156:159], v43 offset:23552
    v_mfma_f32_16x16x32_bf16 v[248:251], a[132:135], a[112:115], v[248:251]
    v_mfma_f32_16x16x32_bf16 v[252:255], a[132:135], a[116:119], v[252:255]
    s_waitcnt lgkmcnt(4)
    v_mfma_f32_16x16x32_bf16 v[240:243], a[136:139], a[120:123], v[240:243]
    s_waitcnt vmcnt(15)
    s_barrier
    v_mfma_f32_16x16x32_bf16 v[244:247], a[136:139], a[124:127], v[244:247]
    buffer_load_dwordx4 a[84:87], v1, s[68:71], s83 offen offset:1024 sc1
    v_mfma_f32_16x16x32_bf16 v[248:251], a[140:143], a[120:123], v[248:251]
    ds_read_b128 a[128:131], v40 offset:24576
    v_mfma_f32_16x16x32_bf16 v[252:255], a[140:143], a[124:127], v[252:255]
    ds_read_b128 a[132:135], v40 offset:25600
    s_waitcnt lgkmcnt(4)
    v_mfma_f32_16x16x32_bf16 v[240:243], a[144:147], a[0:3], v[240:243]
    buffer_load_dwordx4 a[88:91], v1, s[68:71], s83 offen offset:2048 sc1
    v_mfma_f32_16x16x32_bf16 v[244:247], a[144:147], a[4:7], v[244:247]
    ds_read_b128 a[136:139], v40 offset:26624
    v_mfma_f32_16x16x32_bf16 v[248:251], a[148:151], a[0:3], v[248:251]
    ds_read_b128 a[140:143], v41 offset:24576
    v_mfma_f32_16x16x32_bf16 v[252:255], a[148:151], a[4:7], v[252:255]
    s_waitcnt lgkmcnt(4)
    v_mfma_f32_16x16x32_bf16 v[240:243], a[152:155], a[8:11], v[240:243]
    buffer_load_dwordx4 a[92:95], v1, s[68:71], s83 offen offset:3072 sc1
    v_mfma_f32_16x16x32_bf16 v[244:247], a[152:155], a[12:15], v[244:247]
    ds_read_b128 a[144:147], v41 offset:25600
    v_mfma_f32_16x16x32_bf16 v[248:251], a[156:159], a[8:11], v[248:251]
    ds_read_b128 a[148:151], v41 offset:26624
    v_mfma_f32_16x16x32_bf16 v[252:255], a[156:159], a[12:15], v[252:255]
    s_waitcnt lgkmcnt(4)
    v_mfma_f32_16x16x32_bf16 v[96:99], a[128:131], a[16:19], v[96:99]
    s_add_u32 s83, s83, 4096
    ds_read_b128 a[152:155], v42 offset:24576
    v_mfma_f32_16x16x32_bf16 v[100:103], a[128:131], a[20:23], v[100:103]
    buffer_load_dwordx4 a[96:99], v1, s[68:71], s83 offen offset:0 sc1
    v_mfma_f32_16x16x32_bf16 v[104:107], a[132:135], a[16:19], v[104:107]
    ds_read_b128 a[156:159], v42 offset:25600
    v_mfma_f32_16x16x32_bf16 v[108:111], a[132:135], a[20:23], v[108:111]
    s_waitcnt lgkmcnt(4)
    v_mfma_f32_16x16x32_bf16 v[96:99], a[136:139], a[24:27], v[96:99]
    buffer_load_dwordx4 a[100:103], v1, s[68:71], s83 offen offset:1024 sc1
    v_mfma_f32_16x16x32_bf16 v[100:103], a[136:139], a[28:31], v[100:103]
    ds_read_b128 a[128:131], v42 offset:26624
    v_mfma_f32_16x16x32_bf16 v[104:107], a[140:143], a[24:27], v[104:107]
    ds_read_b128 a[132:135], v43 offset:24576
    v_mfma_f32_16x16x32_bf16 v[108:111], a[140:143], a[28:31], v[108:111]
    s_waitcnt lgkmcnt(4)
    v_mfma_f32_16x16x32_bf16 v[96:99], a[144:147], a[32:35], v[96:99]
    buffer_load_dwordx4 a[104:107], v1, s[68:71], s83 offen offset:2048 sc1
    v_mfma_f32_16x16x32_bf16 v[100:103], a[144:147], a[36:39], v[100:103]
    ds_read_b128 a[136:139], v43 offset:25600
    v_mfma_f32_16x16x32_bf16 v[104:107], a[148:151], a[32:35], v[104:107]
    ds_read_b128 a[140:143], v43 offset:26624
    v_mfma_f32_16x16x32_bf16 v[108:111], a[148:151], a[36:39], v[108:111]
    s_waitcnt lgkmcnt(4)
    v_mfma_f32_16x16x32_bf16 v[96:99], a[152:155], a[40:43], v[96:99]
    ds_read_b128 a[144:147], v40 offset:27648
    v_mfma_f32_16x16x32_bf16 v[100:103], a[152:155], a[44:47], v[100:103]
    ds_read_b128 a[148:151], v40 offset:28672
    s_branch L_sskip19
L_stub19:
    s_setpc_b64 s[100:101]
L_sskip19:
    v_mfma_f32_16x16x32_bf16 v[104:107], a[156:159], a[40:43], v[104:107]
    v_mfma_f32_16x16x32_bf16 v[108:111], a[156:159], a[44:47], v[108:111]
    s_waitcnt lgkmcnt(4)
    v_mfma_f32_16x16x32_bf16 v[96:99], a[128:131], a[48:51], v[96:99]
    buffer_load_dwordx4 a[108:111], v1, s[68:71], s83 offen offset:3072 sc1
    v_mfma_f32_16x16x32_bf16 v[100:103], a[128:131], a[52:55], v[100:103]
    ds_read_b128 a[152:155], v40 offset:29696
    v_mfma_f32_16x16x32_bf16 v[104:107], a[132:135], a[48:51], v[104:107]
    ds_read_b128 a[156:159], v41 offset:27648
    v_mfma_f32_16x16x32_bf16 v[108:111], a[132:135], a[52:55], v[108:111]
    s_waitcnt lgkmcnt(4)
    v_mfma_f32_16x16x32_bf16 v[96:99], a[136:139], a[56:59], v[96:99]
    s_add_u32 m0, s52, 12288
    s_add_u32 s82, s77, s88
    v_mfma_f32_16x16x32_bf16 v[100:103], a[136:139], a[60:63], v[100:103]
    buffer_load_dwordx4 v1, s[60:63], s82 offen offset:0 sc1 lds
    v_mfma_f32_16x16x32_bf16 v[104:107], a[140:143], a[56:59], v[104:107]
    ds_read_b128 a[128:131], v41 offset:28672
    v_mfma_f32_16x16x32_bf16 v[108:111], a[140:143], a[60:63], v[108:111]
    ds_read_b128 a[132:135], v41 offset:29696
    s_waitcnt lgkmcnt(4)
    v_mfma_f32_16x16x32_bf16 v[112:115], a[144:147], a[16:19], v[112:115]
    buffer_load_dwordx4 v1, s[60:63], s82 offen offset:1024 sc1 lds
    v_mfma_f32_16x16x32_bf16 v[116:119], a[144:147], a[20:23], v[116:119]
    ds_read_b128 a[136:139], v42 offset:27648
    v_mfma_f32_16x16x32_bf16 v[120:123], a[148:151], a[16:19], v[120:123]
    ds_read_b128 a[140:143], v42 offset:28672
    v_mfma_f32_16x16x32_bf16 v[124:127], a[148:151], a[20:23], v[124:127]
    s_waitcnt lgkmcnt(4)
    v_mfma_f32_16x16x32_bf16 v[112:115], a[152:155], a[24:27], v[112:115]
    buffer_load_dwordx4 v1, s[60:63], s82 offen offset:2048 sc1 lds
    v_mfma_f32_16x16x32_bf16 v[116:119], a[152:155], a[28:31], v[116:119]
    ds_read_b128 a[144:147], v42 offset:29696
    v_mfma_f32_16x16x32_bf16 v[120:123], a[156:159], a[24:27], v[120:123]
    ds_read_b128 a[148:151], v43 offset:27648
    v_mfma_f32_16x16x32_bf16 v[124:127], a[156:159], a[28:31], v[124:127]
    s_waitcnt lgkmcnt(4)
    v_mfma_f32_16x16x32_bf16 v[112:115], a[128:131], a[32:35], v[112:115]
    s_add_u32 m0, s52, 15360
    s_add_u32 s82, s82, 368640
    v_mfma_f32_16x16x32_bf16 v[116:119], a[128:131], a[36:39], v[116:119]
    buffer_load_dwordx4 v1, s[60:63], s82 offen offset:0 sc1 lds
    v_mfma_f32_16x16x32_bf16 v[120:123], a[132:135], a[32:35], v[120:123]
    ds_read_b128 a[152:155], v43 offset:28672
    v_mfma_f32_16x16x32_bf16 v[124:127], a[132:135], a[36:39], v[124:127]
    ds_read_b128 a[156:159], v43 offset:29696
    s_waitcnt lgkmcnt(4)
    v_mfma_f32_16x16x32_bf16 v[112:115], a[136:139], a[40:43], v[112:115]
    buffer_load_dwordx4 v1, s[60:63], s82 offen offset:1024 sc1 lds
    v_mfma_f32_16x16x32_bf16 v[116:119], a[136:139], a[44:47], v[116:119]
    ds_read_b128 a[128:131], v40 offset:0
    v_mfma_f32_16x16x32_bf16 v[120:123], a[140:143], a[40:43], v[120:123]
    ds_read_b128 a[132:135], v40 offset:1024
    v_mfma_f32_16x16x32_bf16 v[124:127], a[140:143], a[44:47], v[124:127]
    s_waitcnt lgkmcnt(4)
    v_mfma_f32_16x16x32_bf16 v[112:115], a[144:147], a[48:51], v[112:115]
    ds_read_b128 a[136:139], v40 offset:2048
    v_mfma_f32_16x16x32_bf16 v[116:119], a[144:147], a[52:55], v[116:119]
    ds_read_b128 a[140:143], v41 offset:0
    v_mfma_f32_16x16x32_bf16 v[120:123], a[148:151], a[48:51], v[120:123]
    v_mfma_f32_16x16x32_bf16 v[124:127], a[148:151], a[52:55], v[124:127]
    s_waitcnt lgkmcnt(4)
    v_mfma_f32_16x16x32_bf16 v[112:115], a[152:155], a[56:59], v[112:115]
    buffer_load_dwordx4 v1, s[60:63], s82 offen offset:2048 sc1 lds
    v_mfma_f32_16x16x32_bf16 v[116:119], a[152:155], a[60:63], v[116:119]
    ds_read_b128 a[144:147], v41 offset:1024
    v_mfma_f32_16x16x32_bf16 v[120:123], a[156:159], a[56:59], v[120:123]
    ds_read_b128 a[148:151], v41 offset:2048
    v_mfma_f32_16x16x32_bf16 v[124:127], a[156:159], a[60:63], v[124:127]
    s_waitcnt lgkmcnt(4)
    v_mfma_f32_16x16x32_bf16 v[160:163], a[128:131], a[16:19], v[160:163]
    s_add_u32 m0, s52, 18432
    s_add_u32 s82, s82, 368640
    v_mfma_f32_16x16x32_bf16 v[164:167], a[128:131], a[20:23], v[164:167]
    buffer_load_dwordx4 v1, s[60:63], s82 offen offset:0 sc1 lds
    v_mfma_f32_16x16x32_bf16 v[168:171], a[132:135], a[16:19], v[168:171]
    ds_read_b128 a[152:155], v42 offset:0
    v_mfma_f32_16x16x32_bf16 v[172:175], a[132:135], a[20:23], v[172:175]
    ds_read_b128 a[156:159], v42 offset:1024
    s_waitcnt lgkmcnt(4)
    v_mfma_f32_16x16x32_bf16 v[160:163], a[136:139], a[24:27], v[160:163]
    buffer_load_dwordx4 v1, s[60:63], s82 offen offset:1024 sc1 lds
    v_mfma_f32_16x16x32_bf16 v[164:167], a[136:139], a[28:31], v[164:167]
    ds_read_b128 a[128:131], v42 offset:2048
    v_mfma_f32_16x16x32_bf16 v[168:171], a[140:143], a[24:27], v[168:171]
    ds_read_b128 a[132:135], v43 offset:0
    v_mfma_f32_16x16x32_bf16 v[172:175], a[140:143], a[28:31], v[172:175]
    s_waitcnt lgkmcnt(4)
    v_mfma_f32_16x16x32_bf16 v[160:163], a[144:147], a[32:35], v[160:163]
    s_waitcnt vmcnt(17)
    v_cmp_gt_u32 vcc, 3, v10
    s_cbranch_vccnz L_poll17
L_fok17:
    v_mfma_f32_16x16x32_bf16 v[164:167], a[144:147], a[36:39], v[164:167]
    buffer_load_dwordx4 v1, s[60:63], s82 offen offset:2048 sc1 lds
    v_mfma_f32_16x16x32_bf16 v[168:171], a[148:151], a[32:35], v[168:171]
    ds_read_b128 a[136:139], v43 offset:1024
    v_and_b32 v18, 15, v0
    v_mfma_f32_16x16x32_bf16 v[172:175], a[148:151], a[36:39], v[172:175]
    ds_read_b128 a[140:143], v43 offset:2048
    s_waitcnt lgkmcnt(4)
    v_mfma_f32_16x16x32_bf16 v[160:163], a[152:155], a[40:43], v[160:163]
    s_barrier
    s_add_u32 m0, s52, 21504
    v_mfma_f32_16x16x32_bf16 v[164:167], a[152:155], a[44:47], v[164:167]
    s_add_u32 s82, s82, 368640
    v_lshlrev_b32 v18, 2, v18
    v_mfma_f32_16x16x32_bf16 v[168:171], a[156:159], a[40:43], v[168:171]
    s_lshl_b32 s92, s78, 7
    ds_read_b128 a[144:147], v40 offset:3072
    v_mfma_f32_16x16x32_bf16 v[172:175], a[156:159], a[44:47], v[172:175]
    ds_read_b128 a[148:151], v40 offset:4096
    s_waitcnt lgkmcnt(4)
    v_mfma_f32_16x16x32_bf16 v[160:163], a[128:131], a[48:51], v[160:163]
    buffer_load_dwordx4 v1, s[60:63], s82 offen offset:0 sc1 lds
    v_mfma_f32_16x16x32_bf16 v[164:167], a[128:131], a[52:55], v[164:167]
    ds_read_b128 a[152:155], v40 offset:5120
    v_mfma_f32_16x16x32_bf16 v[168:171], a[132:135], a[48:51], v[168:171]
    ds_read_b128 a[156:159], v41 offset:3072
    v_mfma_f32_16x16x32_bf16 v[172:175], a[132:135], a[52:55], v[172:175]
    s_waitcnt lgkmcnt(4)
    v_mfma_f32_16x16x32_bf16 v[160:163], a[136:139], a[56:59], v[160:163]
    buffer_load_dword v32, v18, s[72:75], s92 offen offset:0 sc1
    v_mfma_f32_16x16x32_bf16 v[164:167], a[136:139], a[60:63], v[164:167]
    ds_read_b128 a[128:131], v41 offset:4096
    v_mfma_f32_16x16x32_bf16 v[168:171], a[140:143], a[56:59], v[168:171]
    ds_read_b128 a[132:135], v41 offset:5120
    v_mfma_f32_16x16x32_bf16 v[172:175], a[140:143], a[60:63], v[172:175]
    s_waitcnt lgkmcnt(4)
    v_mfma_f32_16x16x32_bf16 v[176:179], a[144:147], a[16:19], v[176:179]
    buffer_load_dword v33, v18, s[72:75], s92 offen offset:64 sc1
    v_mfma_f32_16x16x32_bf16 v[180:183], a[144:147], a[20:23], v[180:183]
    s_add_u32 s92, s92, 8192
    ds_read_b128 a[136:139], v42 offset:3072
    v_mfma_f32_16x16x32_bf16 v[184:187], a[148:151], a[16:19], v[184:187]
    ds_read_b128 a[140:143], v42 offset:4096
    v_mfma_f32_16x16x32_bf16 v[188:191], a[148:151], a[20:23], v[188:191]
    s_waitcnt lgkmcnt(4)
    v_mfma_f32_16x16x32_bf16 v[176:179], a[152:155], a[24:27], v[176:179]
    buffer_load_dword v34, v18, s[72:75], s92 offen offset:0 sc1
    v_mfma_f32_16x16x32_bf16 v[180:183], a[152:155], a[28:31], v[180:183]
    ds_read_b128 a[144:147], v42 offset:5120
    v_mfma_f32_16x16x32_bf16 v[184:187], a[156:159], a[24:27], v[184:187]
    ds_read_b128 a[148:151], v43 offset:3072
    v_mfma_f32_16x16x32_bf16 v[188:191], a[156:159], a[28:31], v[188:191]
    s_waitcnt lgkmcnt(4)
    v_mfma_f32_16x16x32_bf16 v[176:179], a[128:131], a[32:35], v[176:179]
    buffer_load_dword v35, v18, s[72:75], s92 offen offset:64 sc1
    v_mfma_f32_16x16x32_bf16 v[180:183], a[128:131], a[36:39], v[180:183]
    ds_read_b128 a[152:155], v43 offset:4096
    v_mfma_f32_16x16x32_bf16 v[184:187], a[132:135], a[32:35], v[184:187]
    ds_read_b128 a[156:159], v43 offset:5120
    v_mfma_f32_16x16x32_bf16 v[188:191], a[132:135], a[36:39], v[188:191]
    s_waitcnt lgkmcnt(4)
    v_mfma_f32_16x16x32_bf16 v[176:179], a[136:139], a[40:43], v[176:179]
    buffer_load_dwordx4 v1, s[60:63], s82 offen offset:1024 sc1 lds
    v_mfma_f32_16x16x32_bf16 v[180:183], a[136:139], a[44:47], v[180:183]
    ds_read_b128 a[128:131], v40 offset:6144
    v_mfma_f32_16x16x32_bf16 v[184:187], a[140:143], a[40:43], v[184:187]
    ds_read_b128 a[132:135], v40 offset:7168
    v_mfma_f32_16x16x32_bf16 v[188:191], a[140:143], a[44:47], v[188:191]
    s_waitcnt lgkmcnt(4)
    v_mfma_f32_16x16x32_bf16 v[176:179], a[144:147], a[48:51], v[176:179]
    ds_read_b128 a[136:139], v40 offset:8192
    v_mfma_f32_16x16x32_bf16 v[180:183], a[144:147], a[52:55], v[180:183]
    ds_read_b128 a[140:143], v41 offset:6144
    v_mfma_f32_16x16x32_bf16 v[184:187], a[148:151], a[48:51], v[184:187]
    v_mfma_f32_16x16x32_bf16 v[188:191], a[148:151], a[52:55], v[188:191]
    s_waitcnt lgkmcnt(4)
    v_mfma_f32_16x16x32_bf16 v[176:179], a[152:155], a[56:59], v[176:179]
    buffer_load_dwordx4 v1, s[60:63], s82 offen offset:2048 sc1 lds
    v_mfma_f32_16x16x32_bf16 v[180:183], a[152:155], a[60:63], v[180:183]
    ds_read_b128 a[144:147], v41 offset:7168
    v_mfma_f32_16x16x32_bf16 v[184:187], a[156:159], a[56:59], v[184:187]
    ds_read_b128 a[148:151], v41 offset:8192
    v_mfma_f32_16x16x32_bf16 v[188:191], a[156:159], a[60:63], v[188:191]
    s_waitcnt lgkmcnt(4)
    v_mfma_f32_16x16x32_bf16 v[224:227], a[128:131], a[16:19], v[224:227]
    s_add_u32 m0, s52, 24576
    s_add_u32 s82, s82, 368640
    v_mfma_f32_16x16x32_bf16 v[228:231], a[128:131], a[20:23], v[228:231]
    buffer_load_dwordx4 v1, s[60:63], s82 offen offset:0 sc1 lds
    v_mfma_f32_16x16x32_bf16 v[232:235], a[132:135], a[16:19], v[232:235]
    ds_read_b128 a[152:155], v42 offset:6144
    v_mfma_f32_16x16x32_bf16 v[236:239], a[132:135], a[20:23], v[236:239]
    ds_read_b128 a[156:159], v42 offset:7168
    s_waitcnt lgkmcnt(4)
    v_mfma_f32_16x16x32_bf16 v[224:227], a[136:139], a[24:27], v[224:227]
    buffer_load_dwordx4 v1, s[60:63], s82 offen offset:1024 sc1 lds
    v_mfma_f32_16x16x32_bf16 v[228:231], a[136:139], a[28:31], v[228:231]
    ds_read_b128 a[128:131], v42 offset:8192
    v_mfma_f32_16x16x32_bf16 v[232:235], a[140:143], a[24:27], v[232:235]
    ds_read_b128 a[132:135], v43 offset:6144
    v_mfma_f32_16x16x32_bf16 v[236:239], a[140:143], a[28:31], v[236:239]
    s_waitcnt lgkmcnt(4)
    v_mfma_f32_16x16x32_bf16 v[224:227], a[144:147], a[32:35], v[224:227]
    buffer_load_dwordx4 v1, s[60:63], s82 offen offset:2048 sc1 lds
    v_mfma_f32_16x16x32_bf16 v[228:231], a[144:147], a[36:39], v[228:231]
    ds_read_b128 a[136:139], v43 offset:7168
    v_mfma_f32_16x16x32_bf16 v[232:235], a[148:151], a[32:35], v[232:235]
    ds_read_b128 a[140:143], v43 offset:8192
    v_mfma_f32_16x16x32_bf16 v[236:239], a[148:151], a[36:39], v[236:239]
    s_waitcnt lgkmcnt(4)
    v_mfma_f32_16x16x32_bf16 v[224:227], a[152:155], a[40:43], v[224:227]
    s_add_u32 s83, s76, s89
    ds_read_b128 a[144:147], v40 offset:9216
    v_mfma_f32_16x16x32_bf16 v[228:231], a[152:155], a[44:47], v[228:231]
    buffer_load_dwordx4 a[112:115], v1, s[68:71], s83 offen offset:0 sc1
    v_mfma_f32_16x16x32_bf16 v[232:235], a[156:159], a[40:43], v[232:235]
    ds_read_b128 a[148:151], v40 offset:10240
    v_mfma_f32_16x16x32_bf16 v[236:239], a[156:159], a[44:47], v[236:239]
    s_waitcnt lgkmcnt(4)
    v_mfma_f32_16x16x32_bf16 v[224:227], a[128:131], a[48:51], v[224:227]
    buffer_load_dwordx4 a[116:119], v1, s[68:71], s83 offen offset:1024 sc1
    v_mfma_f32_16x16x32_bf16 v[228:231], a[128:131], a[52:55], v[228:231]
    ds_read_b128 a[152:155], v40 offset:11264
    v_mfma_f32_16x16x32_bf16 v[232:235], a[132:135], a[48:51], v[232:235]
    ds_read_b128 a[156:159], v41 offset:9216
    v_mfma_f32_16x16x32_bf16 v[236:239], a[132:135], a[52:55], v[236:239]
    s_waitcnt lgkmcnt(4)
    v_mfma_f32_16x16x32_bf16 v[224:227], a[136:139], a[56:59], v[224:227]
    ds_read_b128 a[128:131], v41 offset:10240
    v_mfma_f32_16x16x32_bf16 v[228:231], a[136:139], a[60:63], v[228:231]
    ds_read_b128 a[132:135], v41 offset:11264
    v_mfma_f32_16x16x32_bf16 v[232:235], a[140:143], a[56:59], v[232:235]
    v_mfma_f32_16x16x32_bf16 v[236:239], a[140:143], a[60:63], v[236:239]
    s_waitcnt lgkmcnt(4)
    v_mfma_f32_16x16x32_bf16 v[240:243], a[144:147], a[16:19], v[240:243]
    s_add_u32 m0, s52, 27648
    s_add_u32 s82, s82, 368640
    v_mfma_f32_16x16x32_bf16 v[244:247], a[144:147], a[20:23], v[244:247]
    buffer_load_dwordx4 v1, s[60:63], s82 offen offset:0 sc1 lds
    v_mfma_f32_16x16x32_bf16 v[248:251], a[148:151], a[16:19], v[248:251]
    ds_read_b128 a[136:139], v42 offset:9216
    v_mfma_f32_16x16x32_bf16 v[252:255], a[148:151], a[20:23], v[252:255]
    ds_read_b128 a[140:143], v42 offset:10240
    s_waitcnt lgkmcnt(4)
    v_mfma_f32_16x16x32_bf16 v[240:243], a[152:155], a[24:27], v[240:243]
    buffer_load_dwordx4 v1, s[60:63], s82 offen offset:1024 sc1 lds
    v_mfma_f32_16x16x32_bf16 v[244:247], a[152:155], a[28:31], v[244:247]
    ds_read_b128 a[144:147], v42 offset:11264
    v_mfma_f32_16x16x32_bf16 v[248:251], a[156:159], a[24:27], v[248:251]
    ds_read_b128 a[148:151], v43 offset:9216
    v_mfma_f32_16x16x32_bf16 v[252:255], a[156:159], a[28:31], v[252:255]
    s_waitcnt lgkmcnt(4)
    v_mfma_f32_16x16x32_bf16 v[240:243], a[128:131], a[32:35], v[240:243]
    buffer_load_dwordx4 v1, s[60:63], s82 offen offset:2048 sc1 lds
    v_mfma_f32_16x16x32_bf16 v[244:247], a[128:131], a[36:39], v[244:247]
    ds_read_b128 a[152:155], v43 offset:10240
    v_mfma_f32_16x16x32_bf16 v[248:251], a[132:135], a[32:35], v[248:251]
    ds_read_b128 a[156:159], v43 offset:11264
    v_mfma_f32_16x16x32_bf16 v[252:255], a[132:135], a[36:39], v[252:255]
    s_waitcnt lgkmcnt(4)
    v_mfma_f32_16x16x32_bf16 v[240:243], a[136:139], a[40:43], v[240:243]
    s_waitcnt vmcnt(15)
    s_barrier
    v_mfma_f32_16x16x32_bf16 v[244:247], a[136:139], a[44:47], v[244:247]
    buffer_load_dwordx4 a[120:123], v1, s[68:71], s83 offen offset:2048 sc1
    v_mfma_f32_16x16x32_bf16 v[248:251], a[140:143], a[40:43], v[248:251]
    ds_read_b128 a[128:131], v40 offset:12288
    v_mfma_f32_16x16x32_bf16 v[252:255], a[140:143], a[44:47], v[252:255]
    ds_read_b128 a[132:135], v40 offset:13312
    s_waitcnt lgkmcnt(4)
    v_mfma_f32_16x16x32_bf16 v[240:243], a[144:147], a[48:51], v[240:243]
    buffer_load_dwordx4 a[124:127], v1, s[68:71], s83 offen offset:3072 sc1
    v_mfma_f32_16x16x32_bf16 v[244:247], a[144:147], a[52:55], v[244:247]
    ds_read_b128 a[136:139], v40 offset:14336
    v_mfma_f32_16x16x32_bf16 v[248:251], a[148:151], a[48:51], v[248:251]
    ds_read_b128 a[140:143], v41 offset:12288
    v_mfma_f32_16x16x32_bf16 v[252:255], a[148:151], a[52:55], v[252:255]
    s_waitcnt lgkmcnt(4)
    v_mfma_f32_16x16x32_bf16 v[240:243], a[152:155], a[56:59], v[240:243]
    s_add_u32 s83, s83, 4096
    ds_read_b128 a[144:147], v41 offset:13312
    v_mfma_f32_16x16x32_bf16 v[244:247], a[152:155], a[60:63], v[244:247]
    buffer_load_dwordx4 a[0:3], v1, s[68:71], s83 offen offset:0 sc1
    v_mfma_f32_16x16x32_bf16 v[248:251], a[156:159], a[56:59], v[248:251]
    ds_read_b128 a[148:151], v41 offset:14336
    v_mfma_f32_16x16x32_bf16 v[252:255], a[156:159], a[60:63], v[252:255]
    s_waitcnt lgkmcnt(4)
    v_mfma_f32_16x16x32_bf16 v[96:99], a[128:131], a[64:67], v[96:99]
    ds_read_b128 a[152:155], v42 offset:12288
    v_mfma_f32_16x16x32_bf16 v[100:103], a[128:131], a[68:71], v[100:103]
    ds_read_b128 a[156:159], v42 offset:13312
    v_mfma_f32_16x16x32_bf16 v[104:107], a[132:135], a[64:67], v[104:107]
    v_mfma_f32_16x16x32_bf16 v[108:111], a[132:135], a[68:71], v[108:111]
    s_waitcnt lgkmcnt(4)
    v_mfma_f32_16x16x32_bf16 v[96:99], a[136:139], a[72:75], v[96:99]
    buffer_load_dwordx4 a[4:7], v1, s[68:71], s83 offen offset:1024 sc1
    v_mfma_f32_16x16x32_bf16 v[100:103], a[136:139], a[76:79], v[100:103]
    ds_read_b128 a[128:131], v42 offset:14336
    v_mfma_f32_16x16x32_bf16 v[104:107], a[140:143], a[72:75], v[104:107]
    ds_read_b128 a[132:135], v43 offset:12288
    v_mfma_f32_16x16x32_bf16 v[108:111], a[140:143], a[76:79], v[108:111]
    s_waitcnt lgkmcnt(4)
    v_mfma_f32_16x16x32_bf16 v[96:99], a[144:147], a[80:83], v[96:99]
    buffer_load_dwordx4 a[8:11], v1, s[68:71], s83 offen offset:2048 sc1
    v_mfma_f32_16x16x32_bf16 v[100:103], a[144:147], a[84:87], v[100:103]
    ds_read_b128 a[136:139], v43 offset:13312
    v_mfma_f32_16x16x32_bf16 v[104:107], a[148:151], a[80:83], v[104:107]
    ds_read_b128 a[140:143], v43 offset:14336
    v_mfma_f32_16x16x32_bf16 v[108:111], a[148:151], a[84:87], v[108:111]
    s_waitcnt lgkmcnt(4)
    v_mfma_f32_16x16x32_bf16 v[96:99], a[152:155], a[88:91], v[96:99]
    s_waitcnt vmcnt(15)
    buffer_load_dwordx4 a[12:15], v1, s[68:71], s83 offen offset:3072 sc1
    v_mfma_f32_16x16x32_bf16 v[100:103], a[152:155], a[92:95], v[100:103]
    v_accvgpr_read_b32 v64, a160
    v_accvgpr_read_b32 v65, a161
    v_mfma_f32_16x16x32_bf16 v[104:107], a[156:159], a[88:91], v[104:107]
    ds_read_b128 a[144:147], v40 offset:15360
    v_mul_f32 v64, v64, v34
    v_mfma_f32_16x16x32_bf16 v[108:111], a[156:159], a[92:95], v[108:111]
    ds_read_b128 a[148:151], v40 offset:16384
    s_waitcnt lgkmcnt(4)
    v_mfma_f32_16x16x32_bf16 v[96:99], a[128:131], a[96:99], v[96:99]
    s_add_u32 s83, s83, 4096
    v_mul_f32 v65, v65, v34
    v_mfma_f32_16x16x32_bf16 v[100:103], a[128:131], a[100:103], v[100:103]
    buffer_load_dwordx4 a[16:19], v1, s[68:71], s83 offen offset:0 sc1
    v_mfma_f32_16x16x32_bf16 v[104:107], a[132:135], a[96:99], v[104:107]
    ds_read_b128 a[152:155], v40 offset:17408
    v_accvgpr_read_b32 v66, a162
    v_mfma_f32_16x16x32_bf16 v[108:111], a[132:135], a[100:103], v[108:111]
    ds_read_b128 a[156:159], v41 offset:15360
    s_waitcnt lgkmcnt(4)
    v_mfma_f32_16x16x32_bf16 v[96:99], a[136:139], a[104:107], v[96:99]
    buffer_load_dwordx4 a[20:23], v1, s[68:71], s83 offen offset:1024 sc1
    v_mfma_f32_16x16x32_bf16 v[100:103], a[136:139], a[108:111], v[100:103]
    v_accvgpr_read_b32 v67, a163
    v_mul_f32 v66, v66, v34
    v_mfma_f32_16x16x32_bf16 v[104:107], a[140:143], a[104:107], v[104:107]
    ds_read_b128 a[128:131], v41 offset:16384
    v_mul_f32 v67, v67, v34
    v_mfma_f32_16x16x32_bf16 v[108:111], a[140:143], a[108:111], v[108:111]
    ds_read_b128 a[132:135], v41 offset:17408
    s_waitcnt lgkmcnt(4)
    v_mfma_f32_16x16x32_bf16 v[112:115], a[144:147], a[64:67], v[112:115]
    buffer_load_dwordx4 a[24:27], v1, s[68:71], s83 offen offset:2048 sc1
    v_mfma_f32_16x16x32_bf16 v[116:119], a[144:147], a[68:71], v[116:119]
    v_accvgpr_read_b32 v68, a164
    v_accvgpr_read_b32 v69, a165
    v_mfma_f32_16x16x32_bf16 v[120:123], a[148:151], a[64:67], v[120:123]
    ds_read_b128 a[136:139], v42 offset:15360
    v_mul_f32 v68, v68, v35
    v_mfma_f32_16x16x32_bf16 v[124:127], a[148:151], a[68:71], v[124:127]
    ds_read_b128 a[140:143], v42 offset:16384
    s_waitcnt lgkmcnt(4)
    v_mfma_f32_16x16x32_bf16 v[112:115], a[152:155], a[72:75], v[112:115]
    v_mul_f32 v69, v69, v35
    v_accvgpr_read_b32 v70, a166
    v_mfma_f32_16x16x32_bf16 v[116:119], a[152:155], a[76:79], v[116:119]
    v_accvgpr_read_b32 v71, a167
    v_mul_f32 v70, v70, v35
    v_mfma_f32_16x16x32_bf16 v[120:123], a[156:159], a[72:75], v[120:123]
    ds_read_b128 a[144:147], v42 offset:17408
    v_mul_f32 v71, v71, v35
    v_mfma_f32_16x16x32_bf16 v[124:127], a[156:159], a[76:79], v[124:127]
    ds_read_b128 a[148:151], v43 offset:15360
    s_waitcnt lgkmcnt(4)
    v_mfma_f32_16x16x32_bf16 v[112:115], a[128:131], a[80:83], v[112:115]
    buffer_load_dwordx4 a[28:31], v1, s[68:71], s83 offen offset:3072 sc1
    v_mfma_f32_16x16x32_bf16 v[116:119], a[128:131], a[84:87], v[116:119]
    v_accvgpr_read_b32 v72, a168
    v_accvgpr_read_b32 v73, a169
    v_mfma_f32_16x16x32_bf16 v[120:123], a[132:135], a[80:83], v[120:123]
    ds_read_b128 a[152:155], v43 offset:16384
    v_mul_f32 v72, v72, v34
    v_mfma_f32_16x16x32_bf16 v[124:127], a[132:135], a[84:87], v[124:127]
    ds_read_b128 a[156:159], v43 offset:17408
    s_waitcnt lgkmcnt(4)
    v_mfma_f32_16x16x32_bf16 v[112:115], a[136:139], a[88:91], v[112:115]
    s_add_u32 m0, s52, 0
    s_add_u32 s82, s77, s89
    v_mfma_f32_16x16x32_bf16 v[116:119], a[136:139], a[92:95], v[116:119]
    buffer_load_dwordx4 v1, s[60:63], s82 offen offset:0 sc1 lds
    v_mfma_f32_16x16x32_bf16 v[120:123], a[140:143], a[88:91], v[120:123]
    ds_read_b128 a[128:131], v40 offset:18432
    v_mul_f32 v73, v73, v34
    v_mfma_f32_16x16x32_bf16 v[124:127], a[140:143], a[92:95], v[124:127]
    ds_read_b128 a[132:135], v40 offset:19456
    s_waitcnt lgkmcnt(4)
    v_mfma_f32_16x16x32_bf16 v[112:115], a[144:147], a[96:99], v[112:115]
    buffer_load_dwordx4 v1, s[60:63], s82 offen offset:1024 sc1 lds
    v_mfma_f32_16x16x32_bf16 v[116:119], a[144:147], a[100:103], v[116:119]
    v_accvgpr_read_b32 v74, a170
    v_accvgpr_read_b32 v75, a171
    v_mfma_f32_16x16x32_bf16 v[120:123], a[148:151], a[96:99], v[120:123]
    ds_read_b128 a[136:139], v40 offset:20480
    v_mul_f32 v74, v74, v34
    v_mfma_f32_16x16x32_bf16 v[124:127], a[148:151], a[100:103], v[124:127]
    ds_read_b128 a[140:143], v41 offset:18432
    s_waitcnt lgkmcnt(4)
    v_mfma_f32_16x16x32_bf16 v[112:115], a[152:155], a[104:107], v[112:115]
    buffer_load_dwordx4 v1, s[60:63], s82 offen offset:2048 sc1 lds
    v_mfma_f32_16x16x32_bf16 v[116:119], a[152:155], a[108:111], v[116:119]
    v_mul_f32 v75, v75, v34
    v_accvgpr_read_b32 v76, a172
    v_mfma_f32_16x16x32_bf16 v[120:123], a[156:159], a[104:107], v[120:123]
    ds_read_b128 a[144:147], v41 offset:19456
    v_accvgpr_read_b32 v77, a173
    v_mfma_f32_16x16x32_bf16 v[124:127], a[156:159], a[108:111], v[124:127]
    ds_read_b128 a[148:151], v41 offset:20480
    s_waitcnt lgkmcnt(4)
    v_mfma_f32_16x16x32_bf16 v[160:163], a[128:131], a[64:67], v[160:163]
    s_add_u32 m0, s52, 3072
    s_add_u32 s82, s82, 368640
    v_mfma_f32_16x16x32_bf16 v[164:167], a[128:131], a[68:71], v[164:167]
    buffer_load_dwordx4 v1, s[60:63], s82 offen offset:0 sc1 lds
    v_mfma_f32_16x16x32_bf16 v[168:171], a[132:135], a[64:67], v[168:171]
    ds_read_b128 a[152:155], v42 offset:18432
    v_mul_f32 v76, v76, v35
    v_mfma_f32_16x16x32_bf16 v[172:175], a[132:135], a[68:71], v[172:175]
    ds_read_b128 a[156:159], v42 offset:19456
    s_waitcnt lgkmcnt(4)
    v_mfma_f32_16x16x32_bf16 v[160:163], a[136:139], a[72:75], v[160:163]
    buffer_load_dwordx4 v1, s[60:63], s82 offen offset:1024 sc1 lds
    v_mfma_f32_16x16x32_bf16 v[164:167], a[136:139], a[76:79], v[164:167]
    v_mul_f32 v77, v77, v35
    v_accvgpr_read_b32 v78, a174
    v_mfma_f32_16x16x32_bf16 v[168:171], a[140:143], a[72:75], v[168:171]
    ds_read_b128 a[128:131], v42 offset:20480
    v_accvgpr_read_b32 v79, a175
    v_mfma_f32_16x16x32_bf16 v[172:175], a[140:143], a[76:79], v[172:175]
    ds_read_b128 a[132:135], v43 offset:18432
    s_waitcnt lgkmcnt(4)
    v_mfma_f32_16x16x32_bf16 v[160:163], a[144:147], a[80:83], v[160:163]
    v_mul_f32 v78, v78, v35
    v_mul_f32 v79, v79, v35
    v_mfma_f32_16x16x32_bf16 v[164:167], a[144:147], a[84:87], v[164:167]
    v_accvgpr_read_b32 v80, a176
    v_accvgpr_read_b32 v81, a177
    v_mfma_f32_16x16x32_bf16 v[168:171], a[148:151], a[80:83], v[168:171]
    ds_read_b128 a[136:139], v43 offset:19456
    v_mul_f32 v80, v80, v34
    v_mfma_f32_16x16x32_bf16 v[172:175], a[148:151], a[84:87], v[172:175]
    ds_read_b128 a[140:143], v43 offset:20480
    s_waitcnt lgkmcnt(4)
    v_mfma_f32_16x16x32_bf16 v[160:163], a[152:155], a[88:91], v[160:163]
    s_waitcnt vmcnt(15)
    s_barrier
    v_mfma_f32_16x16x32_bf16 v[164:167], a[152:155], a[92:95], v[164:167]
    buffer_load_dwordx4 v1, s[60:63], s82 offen offset:2048 sc1 lds
    v_mfma_f32_16x16x32_bf16 v[168:171], a[156:159], a[88:91], v[168:171]
    ds_read_b128 a[144:147], v40 offset:21504
    v_mul_f32 v81, v81, v34
    v_mfma_f32_16x16x32_bf16 v[172:175], a[156:159], a[92:95], v[172:175]
    ds_read_b128 a[148:151], v40 offset:22528
    s_waitcnt lgkmcnt(4)
    v_mfma_f32_16x16x32_bf16 v[160:163], a[128:131], a[96:99], v[160:163]
    s_add_u32 m0, s52, 6144
    s_add_u32 s82, s82, 368640
    v_mfma_f32_16x16x32_bf16 v[164:167], a[128:131], a[100:103], v[164:167]
    buffer_load_dwordx4 v1, s[60:63], s82 offen offset:0 sc1 lds
    v_mfma_f32_16x16x32_bf16 v[168:171], a[132:135], a[96:99], v[168:171]
    ds_read_b128 a[152:155], v40 offset:23552
    v_accvgpr_read_b32 v82, a178
    v_mfma_f32_16x16x32_bf16 v[172:175], a[132:135], a[100:103], v[172:175]
    ds_read_b128 a[156:159], v41 offset:21504
    s_waitcnt lgkmcnt(4)
    v_mfma_f32_16x16x32_bf16 v[160:163], a[136:139], a[104:107], v[160:163]
    buffer_load_dwordx4 v1, s[60:63], s82 offen offset:1024 sc1 lds
    v_mfma_f32_16x16x32_bf16 v[164:167], a[136:139], a[108:111], v[164:167]
    v_accvgpr_read_b32 v83, a179
    v_mul_f32 v82, v82, v34
    v_mfma_f32_16x16x32_bf16 v[168:171], a[140:143], a[104:107], v[168:171]
    ds_read_b128 a[128:131], v41 offset:22528
    v_mul_f32 v83, v83, v34
    v_mfma_f32_16x16x32_bf16 v[172:175], a[140:143], a[108:111], v[172:175]
    ds_read_b128 a[132:135], v41 offset:23552
    s_waitcnt lgkmcnt(4)
    v_mfma_f32_16x16x32_bf16 v[176:179], a[144:147], a[64:67], v[176:179]
    buffer_load_dwordx4 v1, s[60:63], s82 offen offset:2048 sc1 lds
    v_mfma_f32_16x16x32_bf16 v[180:183], a[144:147], a[68:71], v[180:183]
    v_accvgpr_read_b32 v84, a180
    v_accvgpr_read_b32 v85, a181
    v_mfma_f32_16x16x32_bf16 v[184:187], a[148:151], a[64:67], v[184:187]
    ds_read_b128 a[136:139], v42 offset:21504
    v_mul_f32 v84, v84, v35
    v_mfma_f32_16x16x32_bf16 v[188:191], a[148:151], a[68:71], v[188:191]
    ds_read_b128 a[140:143], v42 offset:22528
    s_waitcnt lgkmcnt(4)
    v_mfma_f32_16x16x32_bf16 v[176:179], a[152:155], a[72:75], v[176:179]
    s_add_u32 m0, s52, 9216
    s_add_u32 s82, s82, 368640
    v_mfma_f32_16x16x32_bf16 v[180:183], a[152:155], a[76:79], v[180:183]
    buffer_load_dwordx4 v1, s[60:63], s82 offen offset:0 sc1 lds
    v_mfma_f32_16x16x32_bf16 v[184:187], a[156:159], a[72:75], v[184:187]
    ds_read_b128 a[144:147], v42 offset:23552
    v_mul_f32 v85, v85, v35
    v_mfma_f32_16x16x32_bf16 v[188:191], a[156:159], a[76:79], v[188:191]
    ds_read_b128 a[148:151], v43 offset:21504
    s_waitcnt lgkmcnt(4)
    v_mfma_f32_16x16x32_bf16 v[176:179], a[128:131], a[80:83], v[176:179]
    buffer_load_dwordx4 v1, s[60:63], s82 offen offset:1024 sc1 lds
    v_mfma_f32_16x16x32_bf16 v[180:183], a[128:131], a[84:87], v[180:183]
    v_accvgpr_read_b32 v86, a182
    v_accvgpr_read_b32 v87, a183
    v_mfma_f32_16x16x32_bf16 v[184:187], a[132:135], a[80:83], v[184:187]
    ds_read_b128 a[152:155], v43 offset:22528
    v_mul_f32 v86, v86, v35
    v_mfma_f32_16x16x32_bf16 v[188:191], a[132:135], a[84:87], v[188:191]
    ds_read_b128 a[156:159], v43 offset:23552
    s_waitcnt lgkmcnt(4)
    v_mfma_f32_16x16x32_bf16 v[176:179], a[136:139], a[88:91], v[176:179]
    v_mul_f32 v87, v87, v35
    v_accvgpr_read_b32 v88, a184
    v_mfma_f32_16x16x32_bf16 v[180:183], a[136:139], a[92:95], v[180:183]
    v_accvgpr_read_b32 v89, a185
    v_mul_f32 v88, v88, v34
    v_mfma_f32_16x16x32_bf16 v[184:187], a[140:143], a[88:91], v[184:187]
    ds_read_b128 a[128:131], v40 offset:24576
    v_mul_f32 v89, v89, v34
    v_mfma_f32_16x16x32_bf16 v[188:191], a[140:143], a[92:95], v[188:191]
    ds_read_b128 a[132:135], v40 offset:25600
    s_waitcnt lgkmcnt(4)
    v_mfma_f32_16x16x32_bf16 v[176:179], a[144:147], a[96:99], v[176:179]
    buffer_load_dwordx4 v1, s[60:63], s82 offen offset:2048 sc1 lds
    v_mfma_f32_16x16x32_bf16 v[180:183], a[144:147], a[100:103], v[180:183]
    v_accvgpr_read_b32 v90, a186
    v_accvgpr_read_b32 v91, a187
    v_mfma_f32_16x16x32_bf16 v[184:187], a[148:151], a[96:99], v[184:187]
    ds_read_b128 a[136:139], v40 offset:26624
    v_mul_f32 v90, v90, v34
    v_mfma_f32_16x16x32_bf16 v[188:191], a[148:151], a[100:103], v[188:191]
    ds_read_b128 a[140:143], v41 offset:24576
    s_waitcnt lgkmcnt(4)
    v_mfma_f32_16x16x32_bf16 v[176:179], a[152:155], a[104:107], v[176:179]
    s_add_u32 m0, s52, 12288
    s_add_u32 s82, s82, 368640
    v_mfma_f32_16x16x32_bf16 v[180:183], a[152:155], a[108:111], v[180:183]
    buffer_load_dwordx4 v1, s[60:63], s82 offen offset:0 sc1 lds
    v_mfma_f32_16x16x32_bf16 v[184:187], a[156:159], a[104:107], v[184:187]
    ds_read_b128 a[144:147], v41 offset:25600
    v_mul_f32 v91, v91, v34
    v_mfma_f32_16x16x32_bf16 v[188:191], a[156:159], a[108:111], v[188:191]
    ds_read_b128 a[148:151], v41 offset:26624
    s_waitcnt lgkmcnt(4)
    v_mfma_f32_16x16x32_bf16 v[224:227], a[128:131], a[64:67], v[224:227]
    buffer_load_dwordx4 v1, s[60:63], s82 offen offset:1024 sc1 lds
    v_mfma_f32_16x16x32_bf16 v[228:231], a[128:131], a[68:71], v[228:231]
    v_accvgpr_read_b32 v92, a188
    v_accvgpr_read_b32 v93, a189
    v_mfma_f32_16x16x32_bf16 v[232:235], a[132:135], a[64:67], v[232:235]
    ds_read_b128 a[152:155], v42 offset:24576
    v_mul_f32 v92, v92, v35
    v_mfma_f32_16x16x32_bf16 v[236:239], a[132:135], a[68:71], v[236:239]
    ds_read_b128 a[156:159], v42 offset:25600
    s_waitcnt lgkmcnt(4)
    v_mfma_f32_16x16x32_bf16 v[224:227], a[136:139], a[72:75], v[224:227]
    buffer_load_dwordx4 v1, s[60:63], s82 offen offset:2048 sc1 lds
    v_mfma_f32_16x16x32_bf16 v[228:231], a[136:139], a[76:79], v[228:231]
    v_mul_f32 v93, v93, v35
    v_accvgpr_read_b32 v94, a190
    v_mfma_f32_16x16x32_bf16 v[232:235], a[140:143], a[72:75], v[232:235]
    ds_read_b128 a[128:131], v42 offset:26624
    v_accvgpr_read_b32 v95, a191
    v_mfma_f32_16x16x32_bf16 v[236:239], a[140:143], a[76:79], v[236:239]
    ds_read_b128 a[132:135], v43 offset:24576
    s_waitcnt lgkmcnt(4)
    v_mfma_f32_16x16x32_bf16 v[224:227], a[144:147], a[80:83], v[224:227]
    s_add_u32 s83, s76, s90
    v_mul_f32 v94, v94, v35
    v_mfma_f32_16x16x32_bf16 v[228:231], a[144:147], a[84:87], v[228:231]
    buffer_load_dwordx4 a[32:35], v1, s[68:71], s83 offen offset:0 sc1
    s_branch L_sskip20
L_stub20:
    s_setpc_b64 s[100:101]
L_sskip20:
    v_mfma_f32_16x16x32_bf16 v[232:235], a[148:151], a[80:83], v[232:235]
    ds_read_b128 a[136:139], v43 offset:25600
    v_mul_f32 v95, v95, v35
    v_mfma_f32_16x16x32_bf16 v[236:239], a[148:151], a[84:87], v[236:239]
    ds_read_b128 a[140:143], v43 offset:26624
    s_waitcnt lgkmcnt(4)
    v_mfma_f32_16x16x32_bf16 v[224:227], a[152:155], a[88:91], v[224:227]
    buffer_load_dwordx4 a[36:39], v1, s[68:71], s83 offen offset:1024 sc1
    v_mfma_f32_16x16x32_bf16 v[228:231], a[152:155], a[92:95], v[228:231]
    v_accvgpr_read_b32 v128, a192
    v_accvgpr_read_b32 v129, a193
    v_mfma_f32_16x16x32_bf16 v[232:235], a[156:159], a[88:91], v[232:235]
    ds_read_b128 a[144:147], v40 offset:27648
    v_mul_f32 v128, v128, v34
    v_mfma_f32_16x16x32_bf16 v[236:239], a[156:159], a[92:95], v[236:239]
    ds_read_b128 a[148:151], v40 offset:28672
    s_waitcnt lgkmcnt(4)
    v_mfma_f32_16x16x32_bf16 v[224:227], a[128:131], a[96:99], v[224:227]
    v_mul_f32 v129, v129, v34
    v_accvgpr_read_b32 v130, a194
    v_mfma_f32_16x16x32_bf16 v[228:231], a[128:131], a[100:103], v[228:231]
    v_accvgpr_read_b32 v131, a195
    v_mul_f32 v130, v130, v34
    v_mfma_f32_16x16x32_bf16 v[232:235], a[132:135], a[96:99], v[232:235]
    ds_read_b128 a[152:155], v40 offset:29696
    v_mul_f32 v131, v131, v34
    v_mfma_f32_16x16x32_bf16 v[236:239], a[132:135], a[100:103], v[236:239]
    ds_read_b128 a[156:159], v41 offset:27648
    s_waitcnt lgkmcnt(4)
    v_mfma_f32_16x16x32_bf16 v[224:227], a[136:139], a[104:107], v[224:227]
    s_add_u32 m0, s52, 15360
    s_add_u32 s82, s82, 368640
    v_mfma_f32_16x16x32_bf16 v[228:231], a[136:139], a[108:111], v[228:231]
    buffer_load_dwordx4 v1, s[60:63], s82 offen offset:0 sc1 lds
    v_mfma_f32_16x16x32_bf16 v[232:235], a[140:143], a[104:107], v[232:235]
    ds_read_b128 a[128:131], v41 offset:28672
    v_accvgpr_read_b32 v132, a196
    v_mfma_f32_16x16x32_bf16 v[236:239], a[140:143], a[108:111], v[236:239]
    ds_read_b128 a[132:135], v41 offset:29696
    s_waitcnt lgkmcnt(4)
    v_mfma_f32_16x16x32_bf16 v[240:243], a[144:147], a[64:67], v[240:243]
    buffer_load_dwordx4 v1, s[60:63], s82 offen offset:1024 sc1 lds
    v_mfma_f32_16x16x32_bf16 v[244:247], a[144:147], a[68:71], v[244:247]
    v_accvgpr_read_b32 v133, a197
    v_mul_f32 v132, v132, v35
    v_mfma_f32_16x16x32_bf16 v[248:251], a[148:151], a[64:67], v[248:251]
    ds_read_b128 a[136:139], v42 offset:27648
    v_mul_f32 v133, v133, v35
    v_mfma_f32_16x16x32_bf16 v[252:255], a[148:151], a[68:71], v[252:255]
    ds_read_b128 a[140:143], v42 offset:28672
    s_waitcnt lgkmcnt(4)
    v_mfma_f32_16x16x32_bf16 v[240:243], a[152:155], a[72:75], v[240:243]
    buffer_load_dwordx4 v1, s[60:63], s82 offen offset:2048 sc1 lds
    v_mfma_f32_16x16x32_bf16 v[244:247], a[152:155], a[76:79], v[244:247]
    v_accvgpr_read_b32 v134, a198
    v_accvgpr_read_b32 v135, a199
    v_mfma_f32_16x16x32_bf16 v[248:251], a[156:159], a[72:75], v[248:251]
    ds_read_b128 a[144:147], v42 offset:29696
    v_mul_f32 v134, v134, v35
    v_mfma_f32_16x16x32_bf16 v[252:255], a[156:159], a[76:79], v[252:255]
    ds_read_b128 a[148:151], v43 offset:27648
    s_waitcnt lgkmcnt(4)
    v_mfma_f32_16x16x32_bf16 v[240:243], a[128:131], a[80:83], v[240:243]
    buffer_load_dwordx4 a[40:43], v1, s[68:71], s83 offen offset:2048 sc1
    v_mfma_f32_16x16x32_bf16 v[244:247], a[128:131], a[84:87], v[244:247]
    v_mul_f32 v135, v135, v35
    v_accvgpr_read_b32 v136, a200
    v_mfma_f32_16x16x32_bf16 v[248:251], a[132:135], a[80:83], v[248:251]
    ds_read_b128 a[152:155], v43 offset:28672
    v_accvgpr_read_b32 v137, a201
    v_mfma_f32_16x16x32_bf16 v[252:255], a[132:135], a[84:87], v[252:255]
    ds_read_b128 a[156:159], v43 offset:29696
    s_waitcnt lgkmcnt(4)
    v_mfma_f32_16x16x32_bf16 v[240:243], a[136:139], a[88:91], v[240:243]
    s_waitcnt vmcnt(12)
    s_barrier
    v_mfma_f32_16x16x32_bf16 v[244:247], a[136:139], a[92:95], v[244:247]
    buffer_load_dwordx4 a[44:47], v1, s[68:71], s83 offen offset:3072 sc1
    v_mfma_f32_16x16x32_bf16 v[248:251], a[140:143], a[88:91], v[248:251]
    ds_read_b128 a[128:131], v40 offset:0
    v_mul_f32 v136, v136, v34
    v_mfma_f32_16x16x32_bf16 v[252:255], a[140:143], a[92:95], v[252:255]
    ds_read_b128 a[132:135], v40 offset:1024
    s_waitcnt lgkmcnt(4)
    v_mfma_f32_16x16x32_bf16 v[240:243], a[144:147], a[96:99], v[240:243]
    s_add_u32 s83, s83, 4096
    v_mul_f32 v137, v137, v34
    v_mfma_f32_16x16x32_bf16 v[244:247], a[144:147], a[100:103], v[244:247]
    buffer_load_dwordx4 a[48:51], v1, s[68:71], s83 offen offset:0 sc1
    v_mfma_f32_16x16x32_bf16 v[248:251], a[148:151], a[96:99], v[248:251]
    ds_read_b128 a[136:139], v40 offset:2048
    v_accvgpr_read_b32 v138, a202
    v_mfma_f32_16x16x32_bf16 v[252:255], a[148:151], a[100:103], v[252:255]
    ds_read_b128 a[140:143], v41 offset:0
    s_waitcnt lgkmcnt(4)
    v_mfma_f32_16x16x32_bf16 v[240:243], a[152:155], a[104:107], v[240:243]
    v_accvgpr_read_b32 v139, a203
    v_mul_f32 v138, v138, v34
    v_mfma_f32_16x16x32_bf16 v[244:247], a[152:155], a[108:111], v[244:247]
    v_mul_f32 v139, v139, v34
    v_accvgpr_read_b32 v140, a204
    v_mfma_f32_16x16x32_bf16 v[248:251], a[156:159], a[104:107], v[248:251]
    ds_read_b128 a[144:147], v41 offset:1024
    v_accvgpr_read_b32 v141, a205
    v_mfma_f32_16x16x32_bf16 v[252:255], a[156:159], a[108:111], v[252:255]
    ds_read_b128 a[148:151], v41 offset:2048
    s_waitcnt lgkmcnt(4)
    v_mfma_f32_16x16x32_bf16 v[96:99], a[128:131], a[112:115], v[96:99]
    buffer_load_dwordx4 a[52:55], v1, s[68:71], s83 offen offset:1024 sc1
    v_mfma_f32_16x16x32_bf16 v[100:103], a[128:131], a[116:119], v[100:103]
    v_mul_f32 v140, v140, v35
    v_mul_f32 v141, v141, v35
    v_mfma_f32_16x16x32_bf16 v[104:107], a[132:135], a[112:115], v[104:107]
    ds_read_b128 a[152:155], v42 offset:0
    v_accvgpr_read_b32 v142, a206
    v_mfma_f32_16x16x32_bf16 v[108:111], a[132:135], a[116:119], v[108:111]
    ds_read_b128 a[156:159], v42 offset:1024
    s_waitcnt lgkmcnt(4)
    v_mfma_f32_16x16x32_bf16 v[96:99], a[136:139], a[120:123], v[96:99]
    buffer_load_dwordx4 a[56:59], v1, s[68:71], s83 offen offset:2048 sc1
    v_mfma_f32_16x16x32_bf16 v[100:103], a[136:139], a[124:127], v[100:103]
    v_accvgpr_read_b32 v143, a207
    v_mul_f32 v142, v142, v35
    v_mfma_f32_16x16x32_bf16 v[104:107], a[140:143], a[120:123], v[104:107]
    ds_read_b128 a[128:131], v42 offset:2048
    v_mul_f32 v143, v143, v35
    v_mfma_f32_16x16x32_bf16 v[108:111], a[140:143], a[124:127], v[108:111]
    ds_read_b128 a[132:135], v43 offset:0
    s_waitcnt lgkmcnt(4)
    v_mfma_f32_16x16x32_bf16 v[96:99], a[144:147], a[0:3], v[96:99]
    buffer_load_dwordx4 a[60:63], v1, s[68:71], s83 offen offset:3072 sc1
    v_mfma_f32_16x16x32_bf16 v[100:103], a[144:147], a[4:7], v[100:103]
    v_accvgpr_read_b32 v144, a208
    v_accvgpr_read_b32 v145, a209
    v_mfma_f32_16x16x32_bf16 v[104:107], a[148:151], a[0:3], v[104:107]
    ds_read_b128 a[136:139], v43 offset:1024
    v_mul_f32 v144, v144, v34
    v_mfma_f32_16x16x32_bf16 v[108:111], a[148:151], a[4:7], v[108:111]
    ds_read_b128 a[140:143], v43 offset:2048
    s_waitcnt lgkmcnt(4)
    v_mfma_f32_16x16x32_bf16 v[96:99], a[152:155], a[8:11], v[96:99]
    s_add_u32 s83, s83, 4096
    v_mul_f32 v145, v145, v34
    v_mfma_f32_16x16x32_bf16 v[100:103], a[152:155], a[12:15], v[100:103]
    buffer_load_dwordx4 a[64:67], v1, s[68:71], s83 offen offset:0 sc1
    v_mfma_f32_16x16x32_bf16 v[104:107], a[156:159], a[8:11], v[104:107]
    ds_read_b128 a[144:147], v40 offset:3072
    v_accvgpr_read_b32 v146, a210
    v_mfma_f32_16x16x32_bf16 v[108:111], a[156:159], a[12:15], v[108:111]
    ds_read_b128 a[148:151], v40 offset:4096
    s_waitcnt lgkmcnt(4)
    v_mfma_f32_16x16x32_bf16 v[96:99], a[128:131], a[16:19], v[96:99]
    buffer_load_dwordx4 a[68:71], v1, s[68:71], s83 offen offset:1024 sc1
    v_mfma_f32_16x16x32_bf16 v[100:103], a[128:131], a[20:23], v[100:103]
    v_accvgpr_read_b32 v147, a211
    v_mul_f32 v146, v146, v34
    v_mfma_f32_16x16x32_bf16 v[104:107], a[132:135], a[16:19], v[104:107]
    ds_read_b128 a[152:155], v40 offset:5120
    v_mul_f32 v147, v147, v34
    v_mfma_f32_16x16x32_bf16 v[108:111], a[132:135], a[20:23], v[108:111]
    ds_read_b128 a[156:159], v41 offset:3072
    s_waitcnt lgkmcnt(4)
    v_mfma_f32_16x16x32_bf16 v[96:99], a[136:139], a[24:27], v[96:99]
    buffer_load_dwordx4 a[72:75], v1, s[68:71], s83 offen offset:2048 sc1
    v_mfma_f32_16x16x32_bf16 v[100:103], a[136:139], a[28:31], v[100:103]
    v_accvgpr_read_b32 v148, a212
    v_accvgpr_read_b32 v149, a213
    v_mfma_f32_16x16x32_bf16 v[104:107], a[140:143], a[24:27], v[104:107]
    ds_read_b128 a[128:131], v41 offset:4096
    v_mul_f32 v148, v148, v35
    v_mfma_f32_16x16x32_bf16 v[108:111], a[140:143], a[28:31], v[108:111]
    ds_read_b128 a[132:135], v41 offset:5120
    s_waitcnt lgkmcnt(4)
    v_mfma_f32_16x16x32_bf16 v[112:115], a[144:147], a[112:115], v[112:115]
    v_mul_f32 v149, v149, v35
    v_accvgpr_read_b32 v150, a214
    v_mfma_f32_16x16x32_bf16 v[116:119], a[144:147], a[116:119], v[116:119]
    v_accvgpr_read_b32 v151, a215
    v_mul_f32 v150, v150, v35
    v_mfma_f32_16x16x32_bf16 v[120:123], a[148:151], a[112:115], v[120:123]
    ds_read_b128 a[136:139], v42 offset:3072
    v_mul_f32 v151, v151, v35
    v_mfma_f32_16x16x32_bf16 v[124:127], a[148:151], a[116:119], v[124:127]
    ds_read_b128 a[140:143], v42 offset:4096
    s_waitcnt lgkmcnt(4)
    v_mfma_f32_16x16x32_bf16 v[112:115], a[152:155], a[120:123], v[112:115]
    buffer_load_dwordx4 a[76:79], v1, s[68:71], s83 offen offset:3072 sc1
    v_mfma_f32_16x16x32_bf16 v[116:119], a[152:155], a[124:127], v[116:119]
    v_accvgpr_read_b32 v152, a216
    v_accvgpr_read_b32 v153, a217
    v_mfma_f32_16x16x32_bf16 v[120:123], a[156:159], a[120:123], v[120:123]
    ds_read_b128 a[144:147], v42 offset:5120
    v_mul_f32 v152, v152, v34
    v_mfma_f32_16x16x32_bf16 v[124:127], a[156:159], a[124:127], v[124:127]
    ds_read_b128 a[148:151], v43 offset:3072
    s_waitcnt lgkmcnt(4)
    v_mfma_f32_16x16x32_bf16 v[112:115], a[128:131], a[0:3], v[112:115]
    s_add_u32 m0, s52, 18432
    s_add_u32 s82, s77, s90
    v_mfma_f32_16x16x32_bf16 v[116:119], a[128:131], a[4:7], v[116:119]
    buffer_load_dwordx4 v1, s[60:63], s82 offen offset:0 sc1 lds
    v_mfma_f32_16x16x32_bf16 v[120:123], a[132:135], a[0:3], v[120:123]
    ds_read_b128 a[152:155], v43 offset:4096
    v_mul_f32 v153, v153, v34
    v_mfma_f32_16x16x32_bf16 v[124:127], a[132:135], a[4:7], v[124:127]
    ds_read_b128 a[156:159], v43 offset:5120
    s_waitcnt lgkmcnt(4)
    v_mfma_f32_16x16x32_bf16 v[112:115], a[136:139], a[8:11], v[112:115]
    buffer_load_dwordx4 v1, s[60:63], s82 offen offset:1024 sc1 lds
    v_mfma_f32_16x16x32_bf16 v[116:119], a[136:139], a[12:15], v[116:119]
    v_accvgpr_read_b32 v154, a218
    v_accvgpr_read_b32 v155, a219
    v_mfma_f32_16x16x32_bf16 v[120:123], a[140:143], a[8:11], v[120:123]
    ds_read_b128 a[128:131], v40 offset:6144
    v_mul_f32 v154, v154, v34
    v_mfma_f32_16x16x32_bf16 v[124:127], a[140:143], a[12:15], v[124:127]
    ds_read_b128 a[132:135], v40 offset:7168
    s_waitcnt lgkmcnt(4)
    v_mfma_f32_16x16x32_bf16 v[112:115], a[144:147], a[16:19], v[112:115]
    buffer_load_dwordx4 v1, s[60:63], s82 offen offset:2048 sc1 lds
    v_mfma_f32_16x16x32_bf16 v[116:119], a[144:147], a[20:23], v[116:119]
    v_mul_f32 v155, v155, v34
    v_accvgpr_read_b32 v156, a220
    v_mfma_f32_16x16x32_bf16 v[120:123], a[148:151], a[16:19], v[120:123]
    ds_read_b128 a[136:139], v40 offset:8192
    v_accvgpr_read_b32 v157, a221
    v_mfma_f32_16x16x32_bf16 v[124:127], a[148:151], a[20:23], v[124:127]
    ds_read_b128 a[140:143], v41 offset:6144
    s_waitcnt lgkmcnt(4)
    v_mfma_f32_16x16x32_bf16 v[112:115], a[152:155], a[24:27], v[112:115]
    s_add_u32 m0, s52, 21504
    s_add_u32 s82, s82, 368640
    v_mfma_f32_16x16x32_bf16 v[116:119], a[152:155], a[28:31], v[116:119]
    buffer_load_dwordx4 v1, s[60:63], s82 offen offset:0 sc1 lds
    v_mfma_f32_16x16x32_bf16 v[120:123], a[156:159], a[24:27], v[120:123]
    ds_read_b128 a[144:147], v41 offset:7168
    v_mul_f32 v156, v156, v35
    v_mfma_f32_16x16x32_bf16 v[124:127], a[156:159], a[28:31], v[124:127]
    ds_read_b128 a[148:151], v41 offset:8192
    s_waitcnt lgkmcnt(4)
    v_mfma_f32_16x16x32_bf16 v[160:163], a[128:131], a[112:115], v[160:163]
    buffer_load_dwordx4 v1, s[60:63], s82 offen offset:1024 sc1 lds
    v_mfma_f32_16x16x32_bf16 v[164:167], a[128:131], a[116:119], v[164:167]
    v_mul_f32 v157, v157, v35
    v_accvgpr_read_b32 v158, a222
    v_mfma_f32_16x16x32_bf16 v[168:171], a[132:135], a[112:115], v[168:171]
    ds_read_b128 a[152:155], v42 offset:6144
    v_accvgpr_read_b32 v159, a223
    v_mfma_f32_16x16x32_bf16 v[172:175], a[132:135], a[116:119], v[172:175]
    ds_read_b128 a[156:159], v42 offset:7168
    s_waitcnt lgkmcnt(4)
    v_mfma_f32_16x16x32_bf16 v[160:163], a[136:139], a[120:123], v[160:163]
    v_mul_f32 v158, v158, v35
    v_mul_f32 v159, v159, v35
    v_mfma_f32_16x16x32_bf16 v[164:167], a[136:139], a[124:127], v[164:167]
    v_accvgpr_read_b32 v192, a224
    v_accvgpr_read_b32 v193, a225
    v_mfma_f32_16x16x32_bf16 v[168:171], a[140:143], a[120:123], v[168:171]
    ds_read_b128 a[128:131], v42 offset:8192
    v_mul_f32 v192, v192, v34
    v_mfma_f32_16x16x32_bf16 v[172:175], a[140:143], a[124:127], v[172:175]
    ds_read_b128 a[132:135], v43 offset:6144
    s_waitcnt lgkmcnt(4)
    v_mfma_f32_16x16x32_bf16 v[160:163], a[144:147], a[0:3], v[160:163]
    buffer_load_dwordx4 v1, s[60:63], s82 offen offset:2048 sc1 lds
    v_mfma_f32_16x16x32_bf16 v[164:167], a[144:147], a[4:7], v[164:167]
    v_mul_f32 v193, v193, v34
    v_accvgpr_read_b32 v194, a226
    v_mfma_f32_16x16x32_bf16 v[168:171], a[148:151], a[0:3], v[168:171]
    ds_read_b128 a[136:139], v43 offset:7168
    v_accvgpr_read_b32 v195, a227
    v_mfma_f32_16x16x32_bf16 v[172:175], a[148:151], a[4:7], v[172:175]
    ds_read_b128 a[140:143], v43 offset:8192
    s_waitcnt lgkmcnt(4)
    v_mfma_f32_16x16x32_bf16 v[160:163], a[152:155], a[8:11], v[160:163]
    s_waitcnt vmcnt(16)
    s_barrier
    v_mfma_f32_16x16x32_bf16 v[164:167], a[152:155], a[12:15], v[164:167]
    s_add_u32 m0, s52, 24576
    s_add_u32 s82, s82, 368640
    v_mfma_f32_16x16x32_bf16 v[168:171], a[156:159], a[8:11], v[168:171]
    ds_read_b128 a[144:147], v40 offset:9216
    v_mul_f32 v194, v194, v34
    v_mfma_f32_16x16x32_bf16 v[172:175], a[156:159], a[12:15], v[172:175]
    ds_read_b128 a[148:151], v40 offset:10240
    s_waitcnt lgkmcnt(4)
    v_mfma_f32_16x16x32_bf16 v[160:163], a[128:131], a[16:19], v[160:163]
    buffer_load_dwordx4 v1, s[60:63], s82 offen offset:0 sc1 lds
    v_mfma_f32_16x16x32_bf16 v[164:167], a[128:131], a[20:23], v[164:167]
    v_mul_f32 v195, v195, v34
    v_accvgpr_read_b32 v196, a228
    v_mfma_f32_16x16x32_bf16 v[168:171], a[132:135], a[16:19], v[168:171]
    ds_read_b128 a[152:155], v40 offset:11264
    v_accvgpr_read_b32 v197, a229
    v_mfma_f32_16x16x32_bf16 v[172:175], a[132:135], a[20:23], v[172:175]
    ds_read_b128 a[156:159], v41 offset:9216
    s_waitcnt lgkmcnt(4)
    v_mfma_f32_16x16x32_bf16 v[160:163], a[136:139], a[24:27], v[160:163]
    buffer_load_dwordx4 v1, s[60:63], s82 offen offset:1024 sc1 lds
    v_mfma_f32_16x16x32_bf16 v[164:167], a[136:139], a[28:31], v[164:167]
    v_mul_f32 v196, v196, v35
    v_mul_f32 v197, v197, v35
    v_mfma_f32_16x16x32_bf16 v[168:171], a[140:143], a[24:27], v[168:171]
    ds_read_b128 a[128:131], v41 offset:10240
    v_accvgpr_read_b32 v198, a230
    v_mfma_f32_16x16x32_bf16 v[172:175], a[140:143], a[28:31], v[172:175]
    ds_read_b128 a[132:135], v41 offset:11264
    s_waitcnt lgkmcnt(4)
    v_mfma_f32_16x16x32_bf16 v[176:179], a[144:147], a[112:115], v[176:179]
    buffer_load_dwordx4 v1, s[60:63], s82 offen offset:2048 sc1 lds
    v_mfma_f32_16x16x32_bf16 v[180:183], a[144:147], a[116:119], v[180:183]
    v_accvgpr_read_b32 v199, a231
    v_mul_f32 v198, v198, v35
    v_mfma_f32_16x16x32_bf16 v[184:187], a[148:151], a[112:115], v[184:187]
    ds_read_b128 a[136:139], v42 offset:9216
    v_mul_f32 v199, v199, v35
    v_mfma_f32_16x16x32_bf16 v[188:191], a[148:151], a[116:119], v[188:191]
    ds_read_b128 a[140:143], v42 offset:10240
    s_waitcnt lgkmcnt(4)
    v_mfma_f32_16x16x32_bf16 v[176:179], a[152:155], a[120:123], v[176:179]
    s_add_u32 m0, s52, 27648
    s_add_u32 s82, s82, 368640
    v_mfma_f32_16x16x32_bf16 v[180:183], a[152:155], a[124:127], v[180:183]
    buffer_load_dwordx4 v1, s[60:63], s82 offen offset:0 sc1 lds
    v_mfma_f32_16x16x32_bf16 v[184:187], a[156:159], a[120:123], v[184:187]
    ds_read_b128 a[144:147], v42 offset:11264
    v_accvgpr_read_b32 v200, a232
    v_mfma_f32_16x16x32_bf16 v[188:191], a[156:159], a[124:127], v[188:191]
    ds_read_b128 a[148:151], v43 offset:9216
    s_waitcnt lgkmcnt(4)
    v_mfma_f32_16x16x32_bf16 v[176:179], a[128:131], a[0:3], v[176:179]
    buffer_load_dwordx4 v1, s[60:63], s82 offen offset:1024 sc1 lds
    v_mfma_f32_16x16x32_bf16 v[180:183], a[128:131], a[4:7], v[180:183]
    v_accvgpr_read_b32 v201, a233
    v_mul_f32 v200, v200, v34
    v_mfma_f32_16x16x32_bf16 v[184:187], a[132:135], a[0:3], v[184:187]
    ds_read_b128 a[152:155], v43 offset:10240
    v_mul_f32 v201, v201, v34
    v_mfma_f32_16x16x32_bf16 v[188:191], a[132:135], a[4:7], v[188:191]
    ds_read_b128 a[156:159], v43 offset:11264
    s_waitcnt lgkmcnt(4)
    v_mfma_f32_16x16x32_bf16 v[176:179], a[136:139], a[8:11], v[176:179]
    buffer_load_dwordx4 v1, s[60:63], s82 offen offset:2048 sc1 lds
    v_mfma_f32_16x16x32_bf16 v[180:183], a[136:139], a[12:15], v[180:183]
    v_accvgpr_read_b32 v202, a234
    v_accvgpr_read_b32 v203, a235
    v_mfma_f32_16x16x32_bf16 v[184:187], a[140:143], a[8:11], v[184:187]
    ds_read_b128 a[128:131], v40 offset:12288
    v_mul_f32 v202, v202, v34
    v_mfma_f32_16x16x32_bf16 v[188:191], a[140:143], a[12:15], v[188:191]
    ds_read_b128 a[132:135], v40 offset:13312
    s_waitcnt lgkmcnt(4)
    v_mfma_f32_16x16x32_bf16 v[176:179], a[144:147], a[16:19], v[176:179]
    v_mul_f32 v203, v203, v34
    v_accvgpr_read_b32 v204, a236
    v_mfma_f32_16x16x32_bf16 v[180:183], a[144:147], a[20:23], v[180:183]
    v_accvgpr_read_b32 v205, a237
    v_mul_f32 v204, v204, v35
    v_mfma_f32_16x16x32_bf16 v[184:187], a[148:151], a[16:19], v[184:187]
    ds_read_b128 a[136:139], v40 offset:14336
    v_mul_f32 v205, v205, v35
    v_mfma_f32_16x16x32_bf16 v[188:191], a[148:151], a[20:23], v[188:191]
    ds_read_b128 a[140:143], v41 offset:12288
    s_waitcnt lgkmcnt(4)
    v_mfma_f32_16x16x32_bf16 v[176:179], a[152:155], a[24:27], v[176:179]
    s_add_u32 m0, s52, 0
    s_add_u32 s82, s82, 368640
    v_mfma_f32_16x16x32_bf16 v[180:183], a[152:155], a[28:31], v[180:183]
    buffer_load_dwordx4 v1, s[60:63], s82 offen offset:0 sc1 lds
    v_mfma_f32_16x16x32_bf16 v[184:187], a[156:159], a[24:27], v[184:187]
    ds_read_b128 a[144:147], v41 offset:13312
    v_accvgpr_read_b32 v206, a238
    v_mfma_f32_16x16x32_bf16 v[188:191], a[156:159], a[28:31], v[188:191]
    ds_read_b128 a[148:151], v41 offset:14336
    s_waitcnt lgkmcnt(4)
    v_mfma_f32_16x16x32_bf16 v[224:227], a[128:131], a[112:115], v[224:227]
    buffer_load_dwordx4 v1, s[60:63], s82 offen offset:1024 sc1 lds
    v_mfma_f32_16x16x32_bf16 v[228:231], a[128:131], a[116:119], v[228:231]
    v_accvgpr_read_b32 v207, a239
    v_mul_f32 v206, v206, v35
    v_mfma_f32_16x16x32_bf16 v[232:235], a[132:135], a[112:115], v[232:235]
    ds_read_b128 a[152:155], v42 offset:12288
    v_mul_f32 v207, v207, v35
    v_mfma_f32_16x16x32_bf16 v[236:239], a[132:135], a[116:119], v[236:239]
    ds_read_b128 a[156:159], v42 offset:13312
    s_waitcnt lgkmcnt(4)
    v_mfma_f32_16x16x32_bf16 v[224:227], a[136:139], a[120:123], v[224:227]
    buffer_load_dwordx4 v1, s[60:63], s82 offen offset:2048 sc1 lds
    v_mfma_f32_16x16x32_bf16 v[228:231], a[136:139], a[124:127], v[228:231]
    v_accvgpr_read_b32 v208, a240
    v_accvgpr_read_b32 v209, a241
    v_mfma_f32_16x16x32_bf16 v[232:235], a[140:143], a[120:123], v[232:235]
    ds_read_b128 a[128:131], v42 offset:14336
    v_mul_f32 v208, v208, v34
    v_mfma_f32_16x16x32_bf16 v[236:239], a[140:143], a[124:127], v[236:239]
    ds_read_b128 a[132:135], v43 offset:12288
    s_waitcnt lgkmcnt(4)
    v_mfma_f32_16x16x32_bf16 v[224:227], a[144:147], a[0:3], v[224:227]
    s_add_u32 m0, s52, 3072
    s_add_u32 s82, s82, 368640
    v_mfma_f32_16x16x32_bf16 v[228:231], a[144:147], a[4:7], v[228:231]
    buffer_load_dwordx4 v1, s[60:63], s82 offen offset:0 sc1 lds
    v_mfma_f32_16x16x32_bf16 v[232:235], a[148:151], a[0:3], v[232:235]
    ds_read_b128 a[136:139], v43 offset:13312
    v_mul_f32 v209, v209, v34
    v_mfma_f32_16x16x32_bf16 v[236:239], a[148:151], a[4:7], v[236:239]
    ds_read_b128 a[140:143], v43 offset:14336
    s_waitcnt lgkmcnt(4)
    v_mfma_f32_16x16x32_bf16 v[224:227], a[152:155], a[8:11], v[224:227]
    buffer_load_dwordx4 v1, s[60:63], s82 offen offset:1024 sc1 lds
    v_mfma_f32_16x16x32_bf16 v[228:231], a[152:155], a[12:15], v[228:231]
    v_accvgpr_read_b32 v210, a242
    v_accvgpr_read_b32 v211, a243
    v_mfma_f32_16x16x32_bf16 v[232:235], a[156:159], a[8:11], v[232:235]
    ds_read_b128 a[144:147], v40 offset:15360
    v_mul_f32 v210, v210, v34
    v_mfma_f32_16x16x32_bf16 v[236:239], a[156:159], a[12:15], v[236:239]
    ds_read_b128 a[148:151], v40 offset:16384
    s_waitcnt lgkmcnt(4)
    v_mfma_f32_16x16x32_bf16 v[224:227], a[128:131], a[16:19], v[224:227]
    buffer_load_dwordx4 v1, s[60:63], s82 offen offset:2048 sc1 lds
    v_mfma_f32_16x16x32_bf16 v[228:231], a[128:131], a[20:23], v[228:231]
    v_mul_f32 v211, v211, v34
    v_accvgpr_read_b32 v212, a244
    v_mfma_f32_16x16x32_bf16 v[232:235], a[132:135], a[16:19], v[232:235]
    ds_read_b128 a[152:155], v40 offset:17408
    v_accvgpr_read_b32 v213, a245
    v_mfma_f32_16x16x32_bf16 v[236:239], a[132:135], a[20:23], v[236:239]
    ds_read_b128 a[156:159], v41 offset:15360
    s_waitcnt lgkmcnt(4)
    v_mfma_f32_16x16x32_bf16 v[224:227], a[136:139], a[24:27], v[224:227]
    v_mul_f32 v212, v212, v35
    v_mul_f32 v213, v213, v35
    v_mfma_f32_16x16x32_bf16 v[228:231], a[136:139], a[28:31], v[228:231]
    v_accvgpr_read_b32 v214, a246
    v_accvgpr_read_b32 v215, a247
    v_mfma_f32_16x16x32_bf16 v[232:235], a[140:143], a[24:27], v[232:235]
    ds_read_b128 a[128:131], v41 offset:16384
    v_mul_f32 v214, v214, v35
    v_mfma_f32_16x16x32_bf16 v[236:239], a[140:143], a[28:31], v[236:239]
    ds_read_b128 a[132:135], v41 offset:17408
    s_waitcnt lgkmcnt(4)
    v_mfma_f32_16x16x32_bf16 v[240:243], a[144:147], a[112:115], v[240:243]
    v_mul_f32 v215, v215, v35
    v_accvgpr_read_b32 v216, a248
    v_mfma_f32_16x16x32_bf16 v[244:247], a[144:147], a[116:119], v[244:247]
    v_accvgpr_read_b32 v217, a249
    v_mul_f32 v216, v216, v34
    v_mfma_f32_16x16x32_bf16 v[248:251], a[148:151], a[112:115], v[248:251]
    ds_read_b128 a[136:139], v42 offset:15360
    v_mul_f32 v217, v217, v34
    v_mfma_f32_16x16x32_bf16 v[252:255], a[148:151], a[116:119], v[252:255]
    ds_read_b128 a[140:143], v42 offset:16384
    s_waitcnt lgkmcnt(4)
    v_mfma_f32_16x16x32_bf16 v[240:243], a[152:155], a[120:123], v[240:243]
    v_accvgpr_read_b32 v218, a250
    v_accvgpr_read_b32 v219, a251
    v_mfma_f32_16x16x32_bf16 v[244:247], a[152:155], a[124:127], v[244:247]
    v_mul_f32 v218, v218, v34
    v_mul_f32 v219, v219, v34
    v_mfma_f32_16x16x32_bf16 v[248:251], a[156:159], a[120:123], v[248:251]
    ds_read_b128 a[144:147], v42 offset:17408
    v_accvgpr_read_b32 v220, a252
    v_mfma_f32_16x16x32_bf16 v[252:255], a[156:159], a[124:127], v[252:255]
    ds_read_b128 a[148:151], v43 offset:15360
    s_waitcnt lgkmcnt(4)
    v_mfma_f32_16x16x32_bf16 v[240:243], a[128:131], a[0:3], v[240:243]
    v_accvgpr_read_b32 v221, a253
    v_mul_f32 v220, v220, v35
    v_mfma_f32_16x16x32_bf16 v[244:247], a[128:131], a[4:7], v[244:247]
    v_mul_f32 v221, v221, v35
    v_accvgpr_read_b32 v222, a254
    v_mfma_f32_16x16x32_bf16 v[248:251], a[132:135], a[0:3], v[248:251]
    ds_read_b128 a[152:155], v43 offset:16384
    v_accvgpr_read_b32 v223, a255
    v_mfma_f32_16x16x32_bf16 v[252:255], a[132:135], a[4:7], v[252:255]
    ds_read_b128 a[156:159], v43 offset:17408
    s_waitcnt lgkmcnt(4)
    v_mfma_f32_16x16x32_bf16 v[240:243], a[136:139], a[8:11], v[240:243]
    s_waitcnt vmcnt(9)
    s_barrier
    v_mfma_f32_16x16x32_bf16 v[244:247], a[136:139], a[12:15], v[244:247]
    v_mul_f32 v222, v222, v35
    v_mul_f32 v223, v223, v35
    v_mfma_f32_16x16x32_bf16 v[248:251], a[140:143], a[8:11], v[248:251]
    ds_read_b128 a[128:131], v40 offset:18432
    v_mfma_f32_16x16x32_bf16 v[252:255], a[140:143], a[12:15], v[252:255]
    ds_read_b128 a[132:135], v40 offset:19456
    s_waitcnt lgkmcnt(4)
    v_mfma_f32_16x16x32_bf16 v[240:243], a[144:147], a[16:19], v[240:243]
    ds_read_b128 a[136:139], v40 offset:20480
    v_mfma_f32_16x16x32_bf16 v[244:247], a[144:147], a[20:23], v[244:247]
    ds_read_b128 a[140:143], v41 offset:18432
    v_mfma_f32_16x16x32_bf16 v[248:251], a[148:151], a[16:19], v[248:251]
    v_mfma_f32_16x16x32_bf16 v[252:255], a[148:151], a[20:23], v[252:255]
    s_waitcnt lgkmcnt(4)
    v_mfma_f32_16x16x32_bf16 v[240:243], a[152:155], a[24:27], v[240:243]
    ds_read_b128 a[144:147], v41 offset:19456
    v_mfma_f32_16x16x32_bf16 v[244:247], a[152:155], a[28:31], v[244:247]
    ds_read_b128 a[148:151], v41 offset:20480
    v_mfma_f32_16x16x32_bf16 v[248:251], a[156:159], a[24:27], v[248:251]
    v_mfma_f32_16x16x32_bf16 v[252:255], a[156:159], a[28:31], v[252:255]
    s_waitcnt lgkmcnt(4)
    v_mfma_f32_16x16x32_bf16 v[96:99], a[128:131], a[32:35], v[96:99]
    ds_read_b128 a[152:155], v42 offset:18432
    v_mfma_f32_16x16x32_bf16 v[100:103], a[128:131], a[36:39], v[100:103]
    ds_read_b128 a[156:159], v42 offset:19456
    v_mfma_f32_16x16x32_bf16 v[104:107], a[132:135], a[32:35], v[104:107]
    v_mfma_f32_16x16x32_bf16 v[108:111], a[132:135], a[36:39], v[108:111]
    s_waitcnt lgkmcnt(4)
    v_mfma_f32_16x16x32_bf16 v[96:99], a[136:139], a[40:43], v[96:99]
    ds_read_b128 a[128:131], v42 offset:20480
    v_mfma_f32_16x16x32_bf16 v[100:103], a[136:139], a[44:47], v[100:103]
    ds_read_b128 a[132:135], v43 offset:18432
    v_mfma_f32_16x16x32_bf16 v[104:107], a[140:143], a[40:43], v[104:107]
    v_mfma_f32_16x16x32_bf16 v[108:111], a[140:143], a[44:47], v[108:111]
    s_waitcnt lgkmcnt(4)
    v_mfma_f32_16x16x32_bf16 v[96:99], a[144:147], a[48:51], v[96:99]
    ds_read_b128 a[136:139], v43 offset:19456
    v_mfma_f32_16x16x32_bf16 v[100:103], a[144:147], a[52:55], v[100:103]
    ds_read_b128 a[140:143], v43 offset:20480
    v_mfma_f32_16x16x32_bf16 v[104:107], a[148:151], a[48:51], v[104:107]
    v_mfma_f32_16x16x32_bf16 v[108:111], a[148:151], a[52:55], v[108:111]
    s_waitcnt lgkmcnt(4)
    v_mfma_f32_16x16x32_bf16 v[96:99], a[152:155], a[56:59], v[96:99]
    ds_read_b128 a[144:147], v40 offset:21504
    v_mfma_f32_16x16x32_bf16 v[100:103], a[152:155], a[60:63], v[100:103]
    ds_read_b128 a[148:151], v40 offset:22528
    v_mfma_f32_16x16x32_bf16 v[104:107], a[156:159], a[56:59], v[104:107]
    v_mfma_f32_16x16x32_bf16 v[108:111], a[156:159], a[60:63], v[108:111]
    s_waitcnt lgkmcnt(4)
    v_mfma_f32_16x16x32_bf16 v[96:99], a[128:131], a[64:67], v[96:99]
    ds_read_b128 a[152:155], v40 offset:23552
    v_mfma_f32_16x16x32_bf16 v[100:103], a[128:131], a[68:71], v[100:103]
    ds_read_b128 a[156:159], v41 offset:21504
    v_mfma_f32_16x16x32_bf16 v[104:107], a[132:135], a[64:67], v[104:107]
    v_mfma_f32_16x16x32_bf16 v[108:111], a[132:135], a[68:71], v[108:111]
    s_waitcnt lgkmcnt(4)
    v_mfma_f32_16x16x32_bf16 v[96:99], a[136:139], a[72:75], v[96:99]
    ds_read_b128 a[128:131], v41 offset:22528
    v_mfma_f32_16x16x32_bf16 v[100:103], a[136:139], a[76:79], v[100:103]
    ds_read_b128 a[132:135], v41 offset:23552
    v_mfma_f32_16x16x32_bf16 v[104:107], a[140:143], a[72:75], v[104:107]
    v_mfma_f32_16x16x32_bf16 v[108:111], a[140:143], a[76:79], v[108:111]
    s_waitcnt lgkmcnt(4)
    v_mfma_f32_16x16x32_bf16 v[112:115], a[144:147], a[32:35], v[112:115]
    ds_read_b128 a[136:139], v42 offset:21504
    v_mfma_f32_16x16x32_bf16 v[116:119], a[144:147], a[36:39], v[116:119]
    ds_read_b128 a[140:143], v42 offset:22528
    v_mfma_f32_16x16x32_bf16 v[120:123], a[148:151], a[32:35], v[120:123]
    v_mfma_f32_16x16x32_bf16 v[124:127], a[148:151], a[36:39], v[124:127]
    s_waitcnt lgkmcnt(4)
    v_mfma_f32_16x16x32_bf16 v[112:115], a[152:155], a[40:43], v[112:115]
    ds_read_b128 a[144:147], v42 offset:23552
    v_mfma_f32_16x16x32_bf16 v[116:119], a[152:155], a[44:47], v[116:119]
    ds_read_b128 a[148:151], v43 offset:21504
    v_mfma_f32_16x16x32_bf16 v[120:123], a[156:159], a[40:43], v[120:123]
    v_mfma_f32_16x16x32_bf16 v[124:127], a[156:159], a[44:47], v[124:127]
    s_waitcnt lgkmcnt(4)
    v_mfma_f32_16x16x32_bf16 v[112:115], a[128:131], a[48:51], v[112:115]
    v_fma_f32 v96, v96, v32, v64
    v_fma_f32 v97, v97, v32, v65
    v_fma_f32 v98, v98, v32, v66
    v_mfma_f32_16x16x32_bf16 v[116:119], a[128:131], a[52:55], v[116:119]
    v_fma_f32 v99, v99, v32, v67
    v_fma_f32 v100, v100, v33, v68
    v_fma_f32 v101, v101, v33, v69
    v_mfma_f32_16x16x32_bf16 v[120:123], a[132:135], a[48:51], v[120:123]
    ds_read_b128 a[152:155], v43 offset:22528
    v_fma_f32 v102, v102, v33, v70
    v_mfma_f32_16x16x32_bf16 v[124:127], a[132:135], a[52:55], v[124:127]
    ds_read_b128 a[156:159], v43 offset:23552
    s_waitcnt lgkmcnt(4)
    v_mfma_f32_16x16x32_bf16 v[112:115], a[136:139], a[56:59], v[112:115]
    v_fma_f32 v103, v103, v33, v71
    s_branch L_sskip21
L_stub21:
    s_setpc_b64 s[100:101]
L_sskip21:
    v_cvt_pk_bf16_f32 v96, v96, v97
    v_cvt_pk_bf16_f32 v97, v98, v99
    v_mfma_f32_16x16x32_bf16 v[116:119], a[136:139], a[60:63], v[116:119]
    v_cvt_pk_bf16_f32 v98, v100, v101
    v_cvt_pk_bf16_f32 v99, v102, v103
    s_add_u32 s55, s44, 1024
    v_mfma_f32_16x16x32_bf16 v[120:123], a[140:143], a[56:59], v[120:123]
    buffer_store_dwordx4 v[96:99], v1, s[68:71], s55 offen sc1
    ds_read_b128 a[128:131], v40 offset:24576
    v_mfma_f32_16x16x32_bf16 v[124:127], a[140:143], a[60:63], v[124:127]
    ds_read_b128 a[132:135], v40 offset:25600
    s_waitcnt lgkmcnt(4)
    v_mfma_f32_16x16x32_bf16 v[112:115], a[144:147], a[64:67], v[112:115]
    v_fma_f32 v104, v104, v32, v72
    v_fma_f32 v105, v105, v32, v73
    v_fma_f32 v106, v106, v32, v74
    v_mfma_f32_16x16x32_bf16 v[116:119], a[144:147], a[68:71], v[116:119]
    v_fma_f32 v107, v107, v32, v75
    v_fma_f32 v108, v108, v33, v76
    v_fma_f32 v109, v109, v33, v77
    v_mfma_f32_16x16x32_bf16 v[120:123], a[148:151], a[64:67], v[120:123]
    ds_read_b128 a[136:139], v40 offset:26624
    v_fma_f32 v110, v110, v33, v78
    v_mfma_f32_16x16x32_bf16 v[124:127], a[148:151], a[68:71], v[124:127]
    ds_read_b128 a[140:143], v41 offset:24576
    s_waitcnt lgkmcnt(4)
    v_mfma_f32_16x16x32_bf16 v[112:115], a[152:155], a[72:75], v[112:115]
    v_fma_f32 v111, v111, v33, v79
    v_cvt_pk_bf16_f32 v104, v104, v105
    v_cvt_pk_bf16_f32 v105, v106, v107
    v_mfma_f32_16x16x32_bf16 v[116:119], a[152:155], a[76:79], v[116:119]
    v_cvt_pk_bf16_f32 v106, v108, v109
    v_cvt_pk_bf16_f32 v107, v110, v111
    s_add_u32 s55, s44, 2048
    v_mfma_f32_16x16x32_bf16 v[120:123], a[156:159], a[72:75], v[120:123]
    buffer_store_dwordx4 v[104:107], v1, s[68:71], s55 offen sc1
    ds_read_b128 a[144:147], v41 offset:25600
    v_mfma_f32_16x16x32_bf16 v[124:127], a[156:159], a[76:79], v[124:127]
    ds_read_b128 a[148:151], v41 offset:26624
    s_waitcnt lgkmcnt(4)
    v_mfma_f32_16x16x32_bf16 v[160:163], a[128:131], a[32:35], v[160:163]
    ds_read_b128 a[152:155], v42 offset:24576
    v_mfma_f32_16x16x32_bf16 v[164:167], a[128:131], a[36:39], v[164:167]
    ds_read_b128 a[156:159], v42 offset:25600
    v_mfma_f32_16x16x32_bf16 v[168:171], a[132:135], a[32:35], v[168:171]
    v_mfma_f32_16x16x32_bf16 v[172:175], a[132:135], a[36:39], v[172:175]
    s_waitcnt lgkmcnt(4)
    v_mfma_f32_16x16x32_bf16 v[160:163], a[136:139], a[40:43], v[160:163]
    ds_read_b128 a[128:131], v42 offset:26624
    v_mfma_f32_16x16x32_bf16 v[164:167], a[136:139], a[44:47], v[164:167]
    ds_read_b128 a[132:135], v43 offset:24576
    v_mfma_f32_16x16x32_bf16 v[168:171], a[140:143], a[40:43], v[168:171]
    v_mfma_f32_16x16x32_bf16 v[172:175], a[140:143], a[44:47], v[172:175]
    s_waitcnt lgkmcnt(4)
    v_mfma_f32_16x16x32_bf16 v[160:163], a[144:147], a[48:51], v[160:163]
    v_fma_f32 v112, v112, v32, v80
    v_fma_f32 v113, v113, v32, v81
    v_fma_f32 v114, v114, v32, v82
    v_mfma_f32_16x16x32_bf16 v[164:167], a[144:147], a[52:55], v[164:167]
    v_fma_f32 v115, v115, v32, v83
    v_fma_f32 v116, v116, v33, v84
    v_fma_f32 v117, v117, v33, v85
    v_mfma_f32_16x16x32_bf16 v[168:171], a[148:151], a[48:51], v[168:171]
    ds_read_b128 a[136:139], v43 offset:25600
    v_fma_f32 v118, v118, v33, v86
    v_mfma_f32_16x16x32_bf16 v[172:175], a[148:151], a[52:55], v[172:175]
    ds_read_b128 a[140:143], v43 offset:26624
    s_waitcnt lgkmcnt(4)
    v_mfma_f32_16x16x32_bf16 v[160:163], a[152:155], a[56:59], v[160:163]
    s_waitcnt vmcnt(2)
    s_barrier
    v_fma_f32 v119, v119, v33, v87
    v_mfma_f32_16x16x32_bf16 v[164:167], a[152:155], a[60:63], v[164:167]
    v_cvt_pk_bf16_f32 v112, v112, v113
    v_cvt_pk_bf16_f32 v113, v114, v115
    v_cvt_pk_bf16_f32 v114, v116, v117
    v_mfma_f32_16x16x32_bf16 v[168:171], a[156:159], a[56:59], v[168:171]
    ds_read_b128 a[144:147], v40 offset:27648
    v_cvt_pk_bf16_f32 v115, v118, v119
    v_mfma_f32_16x16x32_bf16 v[172:175], a[156:159], a[60:63], v[172:175]
    ds_read_b128 a[148:151], v40 offset:28672
    s_waitcnt lgkmcnt(4)
    v_mfma_f32_16x16x32_bf16 v[160:163], a[128:131], a[64:67], v[160:163]
    s_add_u32 s55, s44, 99328
    ds_read_b128 a[152:155], v40 offset:29696
    v_mfma_f32_16x16x32_bf16 v[164:167], a[128:131], a[68:71], v[164:167]
    buffer_store_dwordx4 v[112:115], v1, s[68:71], s55 offen sc1
    v_fma_f32 v120, v120, v32, v88
    v_fma_f32 v121, v121, v32, v89
    v_mfma_f32_16x16x32_bf16 v[168:171], a[132:135], a[64:67], v[168:171]
    v_fma_f32 v122, v122, v32, v90
    v_fma_f32 v123, v123, v32, v91
    v_fma_f32 v124, v124, v33, v92
    v_mfma_f32_16x16x32_bf16 v[172:175], a[132:135], a[68:71], v[172:175]
    ds_read_b128 a[156:159], v41 offset:27648
    s_waitcnt lgkmcnt(4)
    v_mfma_f32_16x16x32_bf16 v[160:163], a[136:139], a[72:75], v[160:163]
    v_fma_f32 v125, v125, v33, v93
    v_fma_f32 v126, v126, v33, v94
    v_fma_f32 v127, v127, v33, v95
    v_mfma_f32_16x16x32_bf16 v[164:167], a[136:139], a[76:79], v[164:167]
    v_cvt_pk_bf16_f32 v120, v120, v121
    v_cvt_pk_bf16_f32 v121, v122, v123
    v_cvt_pk_bf16_f32 v122, v124, v125
    v_mfma_f32_16x16x32_bf16 v[168:171], a[140:143], a[72:75], v[168:171]
    ds_read_b128 a[128:131], v41 offset:28672
    v_cvt_pk_bf16_f32 v123, v126, v127
    v_mfma_f32_16x16x32_bf16 v[172:175], a[140:143], a[76:79], v[172:175]
    ds_read_b128 a[132:135], v41 offset:29696
    s_waitcnt lgkmcnt(4)
    v_mfma_f32_16x16x32_bf16 v[176:179], a[144:147], a[32:35], v[176:179]
    s_add_u32 s55, s44, 100352
    ds_read_b128 a[136:139], v42 offset:27648
    v_mfma_f32_16x16x32_bf16 v[180:183], a[144:147], a[36:39], v[180:183]
    buffer_store_dwordx4 v[120:123], v1, s[68:71], s55 offen sc1
    ds_read_b128 a[140:143], v42 offset:28672
    v_mfma_f32_16x16x32_bf16 v[184:187], a[148:151], a[32:35], v[184:187]
    v_mfma_f32_16x16x32_bf16 v[188:191], a[148:151], a[36:39], v[188:191]
    s_waitcnt lgkmcnt(4)
    v_mfma_f32_16x16x32_bf16 v[176:179], a[152:155], a[40:43], v[176:179]
    ds_read_b128 a[144:147], v42 offset:29696
    v_mfma_f32_16x16x32_bf16 v[180:183], a[152:155], a[44:47], v[180:183]
    ds_read_b128 a[148:151], v43 offset:27648
    v_mfma_f32_16x16x32_bf16 v[184:187], a[156:159], a[40:43], v[184:187]
    v_mfma_f32_16x16x32_bf16 v[188:191], a[156:159], a[44:47], v[188:191]
    s_waitcnt lgkmcnt(4)
    v_mfma_f32_16x16x32_bf16 v[176:179], a[128:131], a[48:51], v[176:179]
    v_fma_f32 v160, v160, v32, v128
    v_fma_f32 v161, v161, v32, v129
    v_fma_f32 v162, v162, v32, v130
    v_mfma_f32_16x16x32_bf16 v[180:183], a[128:131], a[52:55], v[180:183]
    v_fma_f32 v163, v163, v32, v131
    v_fma_f32 v164, v164, v33, v132
    v_fma_f32 v165, v165, v33, v133
    v_mfma_f32_16x16x32_bf16 v[184:187], a[132:135], a[48:51], v[184:187]
    ds_read_b128 a[152:155], v43 offset:28672
    v_fma_f32 v166, v166, v33, v134
    v_mfma_f32_16x16x32_bf16 v[188:191], a[132:135], a[52:55], v[188:191]
    ds_read_b128 a[156:159], v43 offset:29696
    s_waitcnt lgkmcnt(4)
    v_mfma_f32_16x16x32_bf16 v[176:179], a[136:139], a[56:59], v[176:179]
    v_fma_f32 v167, v167, v33, v135
    v_cvt_pk_bf16_f32 v160, v160, v161
    v_cvt_pk_bf16_f32 v161, v162, v163
    v_mfma_f32_16x16x32_bf16 v[180:183], a[136:139], a[60:63], v[180:183]
    v_cvt_pk_bf16_f32 v162, v164, v165
    v_cvt_pk_bf16_f32 v163, v166, v167
    s_add_u32 s55, s44, 0
    v_mfma_f32_16x16x32_bf16 v[184:187], a[140:143], a[56:59], v[184:187]
    buffer_store_dwordx4 v[160:163], v1, s[68:71], s55 offen sc1
    ds_read_b128 a[128:131], v40 offset:0
    v_mfma_f32_16x16x32_bf16 v[188:191], a[140:143], a[60:63], v[188:191]
    ds_read_b128 a[132:135], v40 offset:1024
    s_waitcnt lgkmcnt(4)
    v_mfma_f32_16x16x32_bf16 v[176:179], a[144:147], a[64:67], v[176:179]
    v_fma_f32 v168, v168, v32, v136
    v_fma_f32 v169, v169, v32, v137
    v_fma_f32 v170, v170, v32, v138
    v_mfma_f32_16x16x32_bf16 v[180:183], a[144:147], a[68:71], v[180:183]
    v_fma_f32 v171, v171, v32, v139
    v_fma_f32 v172, v172, v33, v140
    v_fma_f32 v173, v173, v33, v141
    v_mfma_f32_16x16x32_bf16 v[184:187], a[148:151], a[64:67], v[184:187]
    ds_read_b128 a[136:139], v40 offset:2048
    v_fma_f32 v174, v174, v33, v142
    v_mfma_f32_16x16x32_bf16 v[188:191], a[148:151], a[68:71], v[188:191]
    ds_read_b128 a[140:143], v41 offset:0
    s_waitcnt lgkmcnt(4)
    v_mfma_f32_16x16x32_bf16 v[176:179], a[152:155], a[72:75], v[176:179]
    v_fma_f32 v175, v175, v33, v143
    v_cvt_pk_bf16_f32 v168, v168, v169
    v_cvt_pk_bf16_f32 v169, v170, v171
    v_mfma_f32_16x16x32_bf16 v[180:183], a[152:155], a[76:79], v[180:183]
    v_cvt_pk_bf16_f32 v170, v172, v173
    v_cvt_pk_bf16_f32 v171, v174, v175
    s_add_u32 s55, s44, 196608
    v_mfma_f32_16x16x32_bf16 v[184:187], a[156:159], a[72:75], v[184:187]
    buffer_store_dwordx4 v[168:171], v1, s[68:71], s55 offen sc1
    ds_read_b128 a[144:147], v41 offset:1024
    v_mfma_f32_16x16x32_bf16 v[188:191], a[156:159], a[76:79], v[188:191]
    ds_read_b128 a[148:151], v41 offset:2048
    s_waitcnt lgkmcnt(4)
    v_mfma_f32_16x16x32_bf16 v[224:227], a[128:131], a[32:35], v[224:227]
    ds_read_b128 a[152:155], v42 offset:0
    v_mfma_f32_16x16x32_bf16 v[228:231], a[128:131], a[36:39], v[228:231]
    ds_read_b128 a[156:159], v42 offset:1024
    v_mfma_f32_16x16x32_bf16 v[232:235], a[132:135], a[32:35], v[232:235]
    v_mfma_f32_16x16x32_bf16 v[236:239], a[132:135], a[36:39], v[236:239]
    s_waitcnt lgkmcnt(4)
    v_mfma_f32_16x16x32_bf16 v[224:227], a[136:139], a[40:43], v[224:227]
    ds_read_b128 a[128:131], v42 offset:2048
    v_mfma_f32_16x16x32_bf16 v[228:231], a[136:139], a[44:47], v[228:231]
    ds_read_b128 a[132:135], v43 offset:0
    v_mfma_f32_16x16x32_bf16 v[232:235], a[140:143], a[40:43], v[232:235]
    v_mfma_f32_16x16x32_bf16 v[236:239], a[140:143], a[44:47], v[236:239]
    s_waitcnt lgkmcnt(4)
    v_mfma_f32_16x16x32_bf16 v[224:227], a[144:147], a[48:51], v[224:227]
    v_fma_f32 v176, v176, v32, v144
    v_fma_f32 v177, v177, v32, v145
    v_fma_f32 v178, v178, v32, v146
    v_mfma_f32_16x16x32_bf16 v[228:231], a[144:147], a[52:55], v[228:231]
    v_fma_f32 v179, v179, v32, v147
    v_fma_f32 v180, v180, v33, v148
    v_fma_f32 v181, v181, v33, v149
    v_mfma_f32_16x16x32_bf16 v[232:235], a[148:151], a[48:51], v[232:235]
    ds_read_b128 a[136:139], v43 offset:1024
    v_fma_f32 v182, v182, v33, v150
    v_mfma_f32_16x16x32_bf16 v[236:239], a[148:151], a[52:55], v[236:239]
    ds_read_b128 a[140:143], v43 offset:2048
    s_waitcnt lgkmcnt(4)
    v_mfma_f32_16x16x32_bf16 v[224:227], a[152:155], a[56:59], v[224:227]
    v_fma_f32 v183, v183, v33, v151
    v_cvt_pk_bf16_f32 v176, v176, v177
    v_cvt_pk_bf16_f32 v177, v178, v179
    v_mfma_f32_16x16x32_bf16 v[228:231], a[152:155], a[60:63], v[228:231]
    v_cvt_pk_bf16_f32 v178, v180, v181
    v_cvt_pk_bf16_f32 v179, v182, v183
    s_add_u32 s55, s44, 98304
    v_mfma_f32_16x16x32_bf16 v[232:235], a[156:159], a[56:59], v[232:235]
    buffer_store_dwordx4 v[176:179], v1, s[68:71], s55 offen sc1
    ds_read_b128 a[144:147], v40 offset:3072
    v_mfma_f32_16x16x32_bf16 v[236:239], a[156:159], a[60:63], v[236:239]
    ds_read_b128 a[148:151], v40 offset:4096
    s_waitcnt lgkmcnt(4)
    v_mfma_f32_16x16x32_bf16 v[224:227], a[128:131], a[64:67], v[224:227]
    v_fma_f32 v184, v184, v32, v152
    v_fma_f32 v185, v185, v32, v153
    v_fma_f32 v186, v186, v32, v154
    v_mfma_f32_16x16x32_bf16 v[228:231], a[128:131], a[68:71], v[228:231]
    v_fma_f32 v187, v187, v32, v155
    v_fma_f32 v188, v188, v33, v156
    v_fma_f32 v189, v189, v33, v157
    v_mfma_f32_16x16x32_bf16 v[232:235], a[132:135], a[64:67], v[232:235]
    ds_read_b128 a[152:155], v40 offset:5120
    v_fma_f32 v190, v190, v33, v158
    v_mfma_f32_16x16x32_bf16 v[236:239], a[132:135], a[68:71], v[236:239]
    ds_read_b128 a[156:159], v41 offset:3072
    s_waitcnt lgkmcnt(4)
    v_mfma_f32_16x16x32_bf16 v[224:227], a[136:139], a[72:75], v[224:227]
    v_fma_f32 v191, v191, v33, v159
    v_cvt_pk_bf16_f32 v184, v184, v185
    v_cvt_pk_bf16_f32 v185, v186, v187
    v_mfma_f32_16x16x32_bf16 v[228:231], a[136:139], a[76:79], v[228:231]
    v_cvt_pk_bf16_f32 v186, v188, v189
    v_cvt_pk_bf16_f32 v187, v190, v191
    s_add_u32 s55, s44, 294912
    v_mfma_f32_16x16x32_bf16 v[232:235], a[140:143], a[72:75], v[232:235]
    buffer_store_dwordx4 v[184:187], v1, s[68:71], s55 offen sc1
    ds_read_b128 a[128:131], v41 offset:4096
    v_mfma_f32_16x16x32_bf16 v[236:239], a[140:143], a[76:79], v[236:239]
    ds_read_b128 a[132:135], v41 offset:5120
    s_waitcnt lgkmcnt(4)
    v_mfma_f32_16x16x32_bf16 v[240:243], a[144:147], a[32:35], v[240:243]
    ds_read_b128 a[136:139], v42 offset:3072
    v_mfma_f32_16x16x32_bf16 v[244:247], a[144:147], a[36:39], v[244:247]
    ds_read_b128 a[140:143], v42 offset:4096
    v_mfma_f32_16x16x32_bf16 v[248:251], a[148:151], a[32:35], v[248:251]
    v_mfma_f32_16x16x32_bf16 v[252:255], a[148:151], a[36:39], v[252:255]
    s_waitcnt lgkmcnt(4)
    v_mfma_f32_16x16x32_bf16 v[240:243], a[152:155], a[40:43], v[240:243]
    ds_read_b128 a[144:147], v42 offset:5120
    v_mfma_f32_16x16x32_bf16 v[244:247], a[152:155], a[44:47], v[244:247]
    ds_read_b128 a[148:151], v43 offset:3072
    v_mfma_f32_16x16x32_bf16 v[248:251], a[156:159], a[40:43], v[248:251]
    v_mfma_f32_16x16x32_bf16 v[252:255], a[156:159], a[44:47], v[252:255]
    s_waitcnt lgkmcnt(4)
    v_mfma_f32_16x16x32_bf16 v[240:243], a[128:131], a[48:51], v[240:243]
    v_fma_f32 v224, v224, v32, v192
    v_fma_f32 v225, v225, v32, v193
    v_fma_f32 v226, v226, v32, v194
    v_mfma_f32_16x16x32_bf16 v[244:247], a[128:131], a[52:55], v[244:247]
    v_fma_f32 v227, v227, v32, v195
    v_fma_f32 v228, v228, v33, v196
    v_fma_f32 v229, v229, v33, v197
    v_mfma_f32_16x16x32_bf16 v[248:251], a[132:135], a[48:51], v[248:251]
    ds_read_b128 a[152:155], v43 offset:4096
    v_fma_f32 v230, v230, v33, v198
    v_mfma_f32_16x16x32_bf16 v[252:255], a[132:135], a[52:55], v[252:255]
    ds_read_b128 a[156:159], v43 offset:5120
    s_waitcnt lgkmcnt(4)
    v_mfma_f32_16x16x32_bf16 v[240:243], a[136:139], a[56:59], v[240:243]
    v_fma_f32 v231, v231, v33, v199
    v_cvt_pk_bf16_f32 v224, v224, v225
    v_cvt_pk_bf16_f32 v225, v226, v227
    v_mfma_f32_16x16x32_bf16 v[244:247], a[136:139], a[60:63], v[244:247]
    v_cvt_pk_bf16_f32 v226, v228, v229
    v_cvt_pk_bf16_f32 v227, v230, v231
    s_add_u32 s55, s44, 198656
    v_mfma_f32_16x16x32_bf16 v[248:251], a[140:143], a[56:59], v[248:251]
    buffer_store_dwordx4 v[224:227], v1, s[68:71], s55 offen sc1
    v_fma_f32 v232, v232, v32, v200
    v_mfma_f32_16x16x32_bf16 v[252:255], a[140:143], a[60:63], v[252:255]
    v_fma_f32 v233, v233, v32, v201
    s_waitcnt lgkmcnt(2)
    v_mfma_f32_16x16x32_bf16 v[240:243], a[144:147], a[64:67], v[240:243]
    v_fma_f32 v234, v234, v32, v202
    v_fma_f32 v235, v235, v32, v203
    v_fma_f32 v236, v236, v33, v204
    v_mfma_f32_16x16x32_bf16 v[244:247], a[144:147], a[68:71], v[244:247]
    v_fma_f32 v237, v237, v33, v205
    v_fma_f32 v238, v238, v33, v206
    v_fma_f32 v239, v239, v33, v207
    v_mfma_f32_16x16x32_bf16 v[248:251], a[148:151], a[64:67], v[248:251]
    v_cvt_pk_bf16_f32 v232, v232, v233
    v_cvt_pk_bf16_f32 v233, v234, v235
    v_mfma_f32_16x16x32_bf16 v[252:255], a[148:151], a[68:71], v[252:255]
    v_cvt_pk_bf16_f32 v234, v236, v237
    s_waitcnt lgkmcnt(0)
    v_mfma_f32_16x16x32_bf16 v[240:243], a[152:155], a[72:75], v[240:243]
    v_cvt_pk_bf16_f32 v235, v238, v239
    s_add_u32 s55, s44, 197632
    v_mfma_f32_16x16x32_bf16 v[244:247], a[152:155], a[76:79], v[244:247]
    buffer_store_dwordx4 v[232:235], v1, s[68:71], s55 offen sc1
    v_mfma_f32_16x16x32_bf16 v[248:251], a[156:159], a[72:75], v[248:251]
    v_mfma_f32_16x16x32_bf16 v[252:255], a[156:159], a[76:79], v[252:255]
    s_nop 7
    s_nop 3
    v_fma_f32 v240, v240, v32, v208
    v_fma_f32 v241, v241, v32, v209
    v_fma_f32 v242, v242, v32, v210
    v_fma_f32 v243, v243, v32, v211
    v_fma_f32 v244, v244, v33, v212
    v_fma_f32 v245, v245, v33, v213
    v_fma_f32 v246, v246, v33, v214
    v_fma_f32 v247, v247, v33, v215
    v_cvt_pk_bf16_f32 v240, v240, v241
    v_cvt_pk_bf16_f32 v241, v242, v243
    v_cvt_pk_bf16_f32 v242, v244, v245
    v_cvt_pk_bf16_f32 v243, v246, v247
    s_add_u32 s55, s44, 296960
    buffer_store_dwordx4 v[240:243], v1, s[68:71], s55 offen sc1
    v_fma_f32 v248, v248, v32, v216
    v_fma_f32 v249, v249, v32, v217
    v_fma_f32 v250, v250, v32, v218
    v_fma_f32 v251, v251, v32, v219
    v_fma_f32 v252, v252, v33, v220
    v_fma_f32 v253, v253, v33, v221
    v_fma_f32 v254, v254, v33, v222
    v_fma_f32 v255, v255, v33, v223
    v_cvt_pk_bf16_f32 v248, v248, v249
    v_cvt_pk_bf16_f32 v249, v250, v251
    v_cvt_pk_bf16_f32 v250, v252, v253
    v_cvt_pk_bf16_f32 v251, v254, v255
    s_add_u32 s55, s44, 295936
    buffer_store_dwordx4 v[248:251], v1, s[68:71], s55 offen sc1
    s_endpgm
L_poll17:
    s_mov_b32 s101, 0x40000
L_loop17:
    global_load_dword v10, v63, s[48:49] offset:1024 sc1
    s_waitcnt vmcnt(0)
    v_cmp_gt_u32 vcc, 3, v10
    s_cbranch_vccz L_fok17
    s_sleep 4
    s_sub_u32 s101, s101, 1
    s_cmp_lg_u32 s101, 0
    s_cbranch_scc1 L_loop17
    s_branch L_fok17
L_poll16:
    s_mov_b32 s101, 0x40000
L_loop16:
    global_load_dword v10, v7, s[48:49] offset:3072 sc1
    s_waitcnt vmcnt(0)
    v_cmp_gt_u32 vcc, 1, v10
    s_cbranch_vccz L_fok16
    s_sleep 4
    s_sub_u32 s101, s101, 1
    s_cmp_lg_u32 s101, 0
    s_cbranch_scc1 L_loop16
    s_branch L_fok16
L_poll15:
    s_mov_b32 s101, 0x40000
L_loop15:
    global_load_dword v10, v6, s[48:49] sc1
    s_waitcnt vmcnt(0)
    v_cmp_gt_u32 vcc, 1, v10
    s_cbranch_vccz L_fok15
    s_sleep 4
    s_sub_u32 s101, s101, 1
    s_cmp_lg_u32 s101, 0
    s_cbranch_scc1 L_loop15
    s_branch L_fok15
L_poll14:
    s_mov_b32 s101, 0x40000
L_loop14:
    global_load_dword v10, v63, s[48:49] sc1
    s_waitcnt vmcnt(0)
    v_cmp_gt_u32 vcc, 2, v10
    s_cbranch_vccz L_fok14
    s_sleep 4
    s_sub_u32 s101, s101, 1
    s_cmp_lg_u32 s101, 0
    s_cbranch_scc1 L_loop14
    s_branch L_fok14
L_poll13:
    s_mov_b32 s101, 0x40000
L_loop13:
    global_load_dword v12, v13, s[46:47] offset:128 sc1
    s_waitcnt vmcnt(0)
    v_cmp_gt_u32 vcc, 1, v12
    s_cbranch_vccz L_fok13
    s_sleep 4
    s_sub_u32 s101, s101, 1
    s_cmp_lg_u32 s101, 0
    s_cbranch_scc1 L_loop13
    s_branch L_fok13
.p2align 12
L_prep:
    s_sub_u32 s53, s3, 30
    s_lshl_b32 s53, s53, 3
    s_add_u32 s53, s53, s51
    s_lshl_b32 s53, s53, 2
    s_add_u32 s94, s53, s50
    s_mul_i32 s52, s50, 40960
    v_lshlrev_b32 v1, 4, v0
    s_waitcnt lgkmcnt(0)
    s_add_u32 s60, s48, 53837824
    s_addc_u32 s61, s49, 0
    s_mov_b32 s62, 196608
    s_mov_b32 s63, 0x20000
    v_mov_b32 v20, 0
    v_mov_b32 v21, 0
    v_mov_b32 v22, 0
    v_mov_b32 v23, 0
    s_mul_i32 s53, s94, 3072
    buffer_store_dwordx4 v[20:23], v1, s[60:63], s53 offen offset:0 sc1
    buffer_store_dwordx4 v[20:23], v1, s[60:63], s53 offen offset:1024 sc1
    buffer_store_dwordx4 v[20:23], v1, s[60:63], s53 offen offset:2048 sc1
    s_add_u32 s64, s48, 23592960
    s_addc_u32 s65, s49, 0
    s_mov_b32 s66, 6635520
    s_mov_b32 s67, 0x20000
    s_and_b32 s97, s94, 60
    s_lshl_b32 s53, s50, 8
    s_add_u32 s97, s97, s53
    s_add_u32 s97, s97, 53968896
    s_sub_u32 s53, s94, 54
    s_cmp_ge_u32 s94, 54
    s_cselect_b32 s53, s53, s94
    s_mul_i32 s99, s53, 57
    s_lshr_b32 s99, s99, 9
    s_mul_i32 s54, s99, 9
    s_sub_u32 s98, s53, s54
    s_lshl_b32 s53, s98, 7
    v_lshl_add_u32 v3, v0, 1, s53
    global_load_ushort v20, v3, s[18:19]
    global_load_ushort v21, v3, s[20:21]
    global_load_ushort v22, v3, s[30:31]
    s_mov_b32 s68, s26
    s_mov_b32 s69, s27
    s_mov_b32 s70, 663552
    s_mov_b32 s71, 0x20000
    s_mov_b32 s72, s28
    s_mov_b32 s73, s29
    s_mov_b32 s74, 663552
    s_mov_b32 s75, 0x20000
    v_lshrrev_b32 v3, 3, v0
    v_and_b32 v4, 7, v0
    v_xor_b32 v30, v3, v4
    v_lshlrev_b32 v30, 4, v30
    v_mul_u32_u24 v3, 1152, v3
    v_lshl_add_u32 v3, v4, 4, v3
    v_and_b32 v5, 1, v0
    v_lshl_add_u32 v30, v5, 9, v30
    v_bfe_u32 v5, v0, 1, 2
    v_lshl_add_u32 v30, v5, 11, v30
    v_add_u32 v30, s52, v30
    v_lshrrev_b32 v5, 5, v0
    v_xor_b32 v5, v5, v0
    v_lshl_add_u32 v12, v5, 4, s52
    v_xor_b32 v13, 32, v12
    v_xor_b32 v14, 64, v12
    v_xor_b32 v15, 96, v12
    v_and_b32 v16, 15, v0
    v_lshlrev_b32 v16, 4, v16
    v_and_b32 v17, 16, v0
    v_lshl_add_u32 v16, v17, 6, v16
    v_and_b32 v17, 32, v0
    v_lshl_add_u32 v16, v17, 3, v16
    s_mul_i32 s54, s99, 110592
    s_add_u32 s53, s53, s54
    s_add_u32 s54, s53, 0
    buffer_load_dwordx4 v[136:139], v3, s[68:71], s54 offen
    buffer_load_dwordx4 v[140:143], v3, s[72:75], s54 offen
    s_add_u32 s54, s53, 9216
    buffer_load_dwordx4 v[144:147], v3, s[68:71], s54 offen
    buffer_load_dwordx4 v[148:151], v3, s[72:75], s54 offen
    s_add_u32 s54, s53, 18432
    buffer_load_dwordx4 v[152:155], v3, s[68:71], s54 offen
    buffer_load_dwordx4 v[156:159], v3, s[72:75], s54 offen
    s_add_u32 s54, s53, 27648
    buffer_load_dwordx4 v[160:163], v3, s[68:71], s54 offen
    buffer_load_dwordx4 v[164:167], v3, s[72:75], s54 offen
    s_add_u32 s54, s53, 36864
    buffer_load_dwordx4 v[168:171], v3, s[68:71], s54 offen
    buffer_load_dwordx4 v[172:175], v3, s[72:75], s54 offen
    s_add_u32 s54, s53, 46080
    buffer_load_dwordx4 v[176:179], v3, s[68:71], s54 offen
    buffer_load_dwordx4 v[180:183], v3, s[72:75], s54 offen
    s_add_u32 s54, s53, 55296
    buffer_load_dwordx4 v[184:187], v3, s[68:71], s54 offen
    buffer_load_dwordx4 v[188:191], v3, s[72:75], s54 offen
    s_add_u32 s54, s53, 64512
    buffer_load_dwordx4 v[192:195], v3, s[68:71], s54 offen
    buffer_load_dwordx4 v[196:199], v3, s[72:75], s54 offen
    s_add_u32 s54, s53, 73728
    buffer_load_dwordx4 v[200:203], v3, s[68:71], s54 offen
    buffer_load_dwordx4 v[204:207], v3, s[72:75], s54 offen
    s_add_u32 s54, s53, 82944
    buffer_load_dwordx4 v[208:211], v3, s[68:71], s54 offen
    buffer_load_dwordx4 v[212:215], v3, s[72:75], s54 offen
    s_add_u32 s54, s53, 92160
    buffer_load_dwordx4 v[216:219], v3, s[68:71], s54 offen
    buffer_load_dwordx4 v[220:223], v3, s[72:75], s54 offen
    s_add_u32 s54, s53, 101376
    buffer_load_dwordx4 v[224:227], v3, s[68:71], s54 offen
    buffer_load_dwordx4 v[228:231], v3, s[72:75], s54 offen
    s_cmp_lg_u32 s50, 0
    s_cbranch_scc1 L_wskip_prep0
    s_call_b64 s[100:101], L_stub23
L_wskip_prep0:
    s_cmp_lg_u32 s50, 1
    s_cbranch_scc1 L_wskip_prep1
    s_call_b64 s[100:101], L_stub24
L_wskip_prep1:
    s_cmp_lg_u32 s50, 2
    s_cbranch_scc1 L_wskip_prep2
    s_call_b64 s[100:101], L_stub25
L_wskip_prep2:
    s_cmp_lg_u32 s50, 3
    s_cbranch_scc1 L_wskip_prep3
    s_call_b64 s[100:101], L_stub26
L_wskip_prep3:
    s_mov_b32 s53, 0x3fb8aa3b
    s_mov_b32 s54, 0x3e22f983
    s_waitcnt vmcnt(24)
    s_barrier
    s_add_u32 s95, s94, 128
    s_cmp_lg_u32 s50, 0
    s_cbranch_scc1 L_prep_noinit
    v_mov_b32 v6, s95
    v_mov_b32 v7, 1
    s_mov_b64 exec, 1
    global_store_dword v6, v7, s[46:47] sc1
    s_mov_b64 exec, -1
L_prep_noinit:
    v_lshlrev_b32 v22, 16, v22
    v_mul_f32 v22, s53, v22
    v_exp_f32 v22, v22
    s_nop 0
    v_lshlrev_b32 v20, 16, v20
    v_lshlrev_b32 v21, 16, v21
    v_cvt_pk_bf16_f32 v22, v22, v22
    v_lshlrev_b32 v22, 16, v22
    v_mul_f32 v32, v22, v20
    v_mul_f32 v33, v22, v21
    v_mul_f32 v32, s53, v32
    v_mul_f32 v33, s54, v33
    v_exp_f32 v32, v32
    s_nop 0
    v_rndne_f32 v34, v33
    v_sub_f32 v33, v33, v34
    v_cos_f32 v34, v33
    s_nop 0
    v_sin_f32 v35, v33
    s_nop 0
    v_mul_f32 v36, v20, v20
    v_mul_f32 v24, v32, v34
    v_mul_f32 v25, v32, v35
    v_fma_f32 v32, v21, v21, v36
    v_rcp_f32 v32, v32
    s_nop 0
    v_add_f32 v33, -1.0, v24
    v_add_f32 v32, v32, v32
    v_mul_f32 v34, v33, v20
    v_fma_f32 v34, v25, v21, v34
    v_mul_f32 v35, v25, v20
    v_fma_f32 v35, -v33, v21, v35
    v_mul_f32 v22, v34, v32
    v_mul_f32 v23, v35, v32
    v_lshlrev_b32 v5, 3, v0
    v_add_u32 v5, s52, v5
    ds_write_b64 v5, v[22:23] offset:36864
    v_lshlrev_b32 v5, 6, v4
    v_add_u32 v5, s52, v5
    s_waitcnt lgkmcnt(0)
    ds_read_b128 v[40:43], v5 offset:36864
    ds_read_b128 v[44:47], v5 offset:36880
    ds_read_b128 v[48:51], v5 offset:36896
    ds_read_b128 v[52:55], v5 offset:36912
    s_mul_i32 s53, s98, 8192
    s_mul_i32 s54, s99, 1105920
    s_add_u32 s77, s53, s54
    s_add_u32 s77, s77, 294912
    s_mov_b32 s78, 0xffff0000
    s_waitcnt lgkmcnt(0)
    s_mov_b32 s56, s16
    s_mov_b32 s57, s17
    s_mov_b32 s58, 2359296
    s_mov_b32 s59, 0x20000
    s_mul_i32 s55, s94, 36864
    s_waitcnt vmcnt(22)
    buffer_load_dwordx4 a[0:3], v3, s[56:59], s55 offen offset:0
    buffer_load_dwordx4 a[4:7], v3, s[56:59], s55 offen offset:128
    buffer_load_dwordx4 a[8:11], v3, s[56:59], s55 offen offset:256
    v_lshlrev_b32 v232, 16, v136
    v_and_b32 v233, s78, v136
    v_lshlrev_b32 v234, 16, v140
    v_and_b32 v235, s78, v140
    v_mul_f32 v236, v40, v232
    v_mul_f32 v238, v40, v234
    v_mul_f32 v237, v42, v233
    v_mul_f32 v239, v42, v235
    v_fma_f32 v236, -v41, v234, v236
    v_fma_f32 v238, -v41, v232, -v238
    v_fma_f32 v237, -v43, v235, v237
    v_fma_f32 v239, -v43, v233, -v239
    v_cvt_pk_bf16_f32 v136, v236, v237
    v_cvt_pk_bf16_f32 v140, v238, v239
    v_lshlrev_b32 v240, 16, v137
    v_and_b32 v241, s78, v137
    v_lshlrev_b32 v242, 16, v141
    v_and_b32 v243, s78, v141
    v_mul_f32 v244, v44, v240
    v_mul_f32 v246, v44, v242
    v_mul_f32 v245, v46, v241
    v_mul_f32 v247, v46, v243
    v_fma_f32 v244, -v45, v242, v244
    v_fma_f32 v246, -v45, v240, -v246
    v_fma_f32 v245, -v47, v243, v245
    v_fma_f32 v247, -v47, v241, -v247
    v_cvt_pk_bf16_f32 v137, v244, v245
    v_cvt_pk_bf16_f32 v141, v246, v247
    v_lshlrev_b32 v232, 16, v138
    v_and_b32 v233, s78, v138
    v_lshlrev_b32 v234, 16, v142
    v_and_b32 v235, s78, v142
    v_mul_f32 v236, v48, v232
    v_mul_f32 v238, v48, v234
    v_mul_f32 v237, v50, v233
    v_mul_f32 v239, v50, v235
    v_fma_f32 v236, -v49, v234, v236
    v_fma_f32 v238, -v49, v232, -v238
    v_fma_f32 v237, -v51, v235, v237
    v_fma_f32 v239, -v51, v233, -v239
    v_cvt_pk_bf16_f32 v138, v236, v237
    v_cvt_pk_bf16_f32 v142, v238, v239
    v_lshlrev_b32 v240, 16, v139
    v_and_b32 v241, s78, v139
    v_lshlrev_b32 v242, 16, v143
    v_and_b32 v243, s78, v143
    v_mul_f32 v244, v52, v240
    v_mul_f32 v246, v52, v242
    v_mul_f32 v245, v54, v241
    v_mul_f32 v247, v54, v243
    v_fma_f32 v244, -v53, v242, v244
    v_fma_f32 v246, -v53, v240, -v246
    v_fma_f32 v245, -v55, v243, v245
    v_fma_f32 v247, -v55, v241, -v247
    v_cvt_pk_bf16_f32 v139, v244, v245
    v_cvt_pk_bf16_f32 v143, v246, v247
    ds_write_b128 v30, v[136:139] offset:0
    ds_write_b128 v30, v[140:143] offset:1024
    s_waitcnt vmcnt(23)
    buffer_load_dwordx4 a[12:15], v3, s[56:59], s55 offen offset:384
    buffer_load_dwordx4 a[16:19], v3, s[56:59], s55 offen offset:512
    buffer_load_dwordx4 a[20:23], v3, s[56:59], s55 offen offset:640
    v_lshlrev_b32 v232, 16, v144
    v_and_b32 v233, s78, v144
    v_lshlrev_b32 v234, 16, v148
    v_and_b32 v235, s78, v148
    v_mul_f32 v236, v40, v232
    v_mul_f32 v238, v40, v234
    v_mul_f32 v237, v42, v233
    v_mul_f32 v239, v42, v235
    v_fma_f32 v236, -v41, v234, v236
    v_fma_f32 v238, -v41, v232, -v238
    v_fma_f32 v237, -v43, v235, v237
    v_fma_f32 v239, -v43, v233, -v239
    v_cvt_pk_bf16_f32 v144, v236, v237
    v_cvt_pk_bf16_f32 v148, v238, v239
    v_lshlrev_b32 v240, 16, v145
    v_and_b32 v241, s78, v145
    v_lshlrev_b32 v242, 16, v149
    v_and_b32 v243, s78, v149
    v_mul_f32 v244, v44, v240
    v_mul_f32 v246, v44, v242
    v_mul_f32 v245, v46, v241
    v_mul_f32 v247, v46, v243
    v_fma_f32 v244, -v45, v242, v244
    v_fma_f32 v246, -v45, v240, -v246
    v_fma_f32 v245, -v47, v243, v245
    v_fma_f32 v247, -v47, v241, -v247
    v_cvt_pk_bf16_f32 v145, v244, v245
    v_cvt_pk_bf16_f32 v149, v246, v247
    v_lshlrev_b32 v232, 16, v146
    v_and_b32 v233, s78, v146
    v_lshlrev_b32 v234, 16, v150
    v_and_b32 v235, s78, v150
    v_mul_f32 v236, v48, v232
    v_mul_f32 v238, v48, v234
    v_mul_f32 v237, v50, v233
    v_mul_f32 v239, v50, v235
    v_fma_f32 v236, -v49, v234, v236
    v_fma_f32 v238, -v49, v232, -v238
    v_fma_f32 v237, -v51, v235, v237
    v_fma_f32 v239, -v51, v233, -v239
    v_cvt_pk_bf16_f32 v146, v236, v237
    v_cvt_pk_bf16_f32 v150, v238, v239
    v_lshlrev_b32 v240, 16, v147
    v_and_b32 v241, s78, v147
    v_lshlrev_b32 v242, 16, v151
    v_and_b32 v243, s78, v151
    v_mul_f32 v244, v52, v240
    v_mul_f32 v246, v52, v242
    v_mul_f32 v245, v54, v241
    v_mul_f32 v247, v54, v243
    v_fma_f32 v244, -v53, v242, v244
    v_fma_f32 v246, -v53, v240, -v246
    v_fma_f32 v245, -v55, v243, v245
    v_fma_f32 v247, -v55, v241, -v247
    v_cvt_pk_bf16_f32 v147, v244, v245
    v_cvt_pk_bf16_f32 v151, v246, v247
    ds_write_b128 v30, v[144:147] offset:128
    ds_write_b128 v30, v[148:151] offset:1152
    s_waitcnt vmcnt(24)
    buffer_load_dwordx4 a[24:27], v3, s[56:59], s55 offen offset:768
    buffer_load_dwordx4 a[28:31], v3, s[56:59], s55 offen offset:896
    buffer_load_dwordx4 a[32:35], v3, s[56:59], s55 offen offset:1024
    v_lshlrev_b32 v232, 16, v152
    v_and_b32 v233, s78, v152
    v_lshlrev_b32 v234, 16, v156
    v_and_b32 v235, s78, v156
    v_mul_f32 v236, v40, v232
    v_mul_f32 v238, v40, v234
    v_mul_f32 v237, v42, v233
    v_mul_f32 v239, v42, v235
    v_fma_f32 v236, -v41, v234, v236
    v_fma_f32 v238, -v41, v232, -v238
    v_fma_f32 v237, -v43, v235, v237
    v_fma_f32 v239, -v43, v233, -v239
    v_cvt_pk_bf16_f32 v152, v236, v237
    v_cvt_pk_bf16_f32 v156, v238, v239
    v_lshlrev_b32 v240, 16, v153
    v_and_b32 v241, s78, v153
    v_lshlrev_b32 v242, 16, v157
    v_and_b32 v243, s78, v157
    v_mul_f32 v244, v44, v240
    v_mul_f32 v246, v44, v242
    v_mul_f32 v245, v46, v241
    v_mul_f32 v247, v46, v243
    v_fma_f32 v244, -v45, v242, v244
    v_fma_f32 v246, -v45, v240, -v246
    v_fma_f32 v245, -v47, v243, v245
    v_fma_f32 v247, -v47, v241, -v247
    v_cvt_pk_bf16_f32 v153, v244, v245
    v_cvt_pk_bf16_f32 v157, v246, v247
    v_lshlrev_b32 v232, 16, v154
    v_and_b32 v233, s78, v154
    v_lshlrev_b32 v234, 16, v158
    v_and_b32 v235, s78, v158
    v_mul_f32 v236, v48, v232
    v_mul_f32 v238, v48, v234
    v_mul_f32 v237, v50, v233
    v_mul_f32 v239, v50, v235
    v_fma_f32 v236, -v49, v234, v236
    v_fma_f32 v238, -v49, v232, -v238
    v_fma_f32 v237, -v51, v235, v237
    v_fma_f32 v239, -v51, v233, -v239
    v_cvt_pk_bf16_f32 v154, v236, v237
    v_cvt_pk_bf16_f32 v158, v238, v239
    v_lshlrev_b32 v240, 16, v155
    v_and_b32 v241, s78, v155
    v_lshlrev_b32 v242, 16, v159
    v_and_b32 v243, s78, v159
    v_mul_f32 v244, v52, v240
    v_mul_f32 v246, v52, v242
    v_mul_f32 v245, v54, v241
    v_mul_f32 v247, v54, v243
    v_fma_f32 v244, -v53, v242, v244
    v_fma_f32 v246, -v53, v240, -v246
    v_fma_f32 v245, -v55, v243, v245
    v_fma_f32 v247, -v55, v241, -v247
    v_cvt_pk_bf16_f32 v155, v244, v245
    v_cvt_pk_bf16_f32 v159, v246, v247
    ds_write_b128 v30, v[152:155] offset:256
    ds_write_b128 v30, v[156:159] offset:1280
    s_waitcnt vmcnt(25)
    v_lshlrev_b32 v232, 16, v160
    v_and_b32 v233, s78, v160
    v_lshlrev_b32 v234, 16, v164
    v_and_b32 v235, s78, v164
    v_mul_f32 v236, v40, v232
    v_mul_f32 v238, v40, v234
    v_mul_f32 v237, v42, v233
    v_mul_f32 v239, v42, v235
    v_fma_f32 v236, -v41, v234, v236
    v_fma_f32 v238, -v41, v232, -v238
    v_fma_f32 v237, -v43, v235, v237
    v_fma_f32 v239, -v43, v233, -v239
    v_cvt_pk_bf16_f32 v160, v236, v237
    v_cvt_pk_bf16_f32 v164, v238, v239
    v_lshlrev_b32 v240, 16, v161
    v_and_b32 v241, s78, v161
    v_lshlrev_b32 v242, 16, v165
    v_and_b32 v243, s78, v165
    v_mul_f32 v244, v44, v240
    v_mul_f32 v246, v44, v242
    v_mul_f32 v245, v46, v241
    v_mul_f32 v247, v46, v243
    v_fma_f32 v244, -v45, v242, v244
    v_fma_f32 v246, -v45, v240, -v246
    v_fma_f32 v245, -v47, v243, v245
    v_fma_f32 v247, -v47, v241, -v247
    v_cvt_pk_bf16_f32 v161, v244, v245
    v_cvt_pk_bf16_f32 v165, v246, v247
    v_lshlrev_b32 v232, 16, v162
    v_and_b32 v233, s78, v162
    v_lshlrev_b32 v234, 16, v166
    v_and_b32 v235, s78, v166
    v_mul_f32 v236, v48, v232
    v_mul_f32 v238, v48, v234
    v_mul_f32 v237, v50, v233
    v_mul_f32 v239, v50, v235
    v_fma_f32 v236, -v49, v234, v236
    v_fma_f32 v238, -v49, v232, -v238
    v_fma_f32 v237, -v51, v235, v237
    v_fma_f32 v239, -v51, v233, -v239
    v_cvt_pk_bf16_f32 v162, v236, v237
    v_cvt_pk_bf16_f32 v166, v238, v239
    v_lshlrev_b32 v240, 16, v163
    v_and_b32 v241, s78, v163
    v_lshlrev_b32 v242, 16, v167
    v_and_b32 v243, s78, v167
    v_mul_f32 v244, v52, v240
    v_mul_f32 v246, v52, v242
    v_mul_f32 v245, v54, v241
    v_mul_f32 v247, v54, v243
    v_fma_f32 v244, -v53, v242, v244
    v_fma_f32 v246, -v53, v240, -v246
    v_fma_f32 v245, -v55, v243, v245
    v_fma_f32 v247, -v55, v241, -v247
    v_cvt_pk_bf16_f32 v163, v244, v245
    v_cvt_pk_bf16_f32 v167, v246, v247
    ds_write_b128 v30, v[160:163] offset:384
    ds_write_b128 v30, v[164:167] offset:1408
    s_waitcnt lgkmcnt(0)
    ds_read_b128 v[64:67], v12 offset:0
    ds_read_b128 v[68:71], v12 offset:1024
    ds_read_b128 v[72:75], v13 offset:2048
    ds_read_b128 v[76:79], v13 offset:3072
    ds_read_b128 v[80:83], v14 offset:4096
    ds_read_b128 v[84:87], v14 offset:5120
    ds_read_b128 v[88:91], v15 offset:6144
    ds_read_b128 v[92:95], v15 offset:7168
    s_add_u32 s53, s77, 0
    s_waitcnt lgkmcnt(7)
    buffer_store_dwordx4 v[64:67], v16, s[64:67], s53 offen offset:0 sc1
    s_waitcnt lgkmcnt(6)
    buffer_store_dwordx4 v[68:71], v16, s[64:67], s53 offen offset:512 sc1
    s_waitcnt lgkmcnt(5)
    buffer_store_dwordx4 v[72:75], v16, s[64:67], s53 offen offset:2048 sc1
    s_waitcnt lgkmcnt(4)
    buffer_store_dwordx4 v[76:79], v16, s[64:67], s53 offen offset:2560 sc1
    s_add_u32 s53, s77, 4096
    s_waitcnt lgkmcnt(3)
    buffer_store_dwordx4 v[80:83], v16, s[64:67], s53 offen offset:0 sc1
    s_waitcnt lgkmcnt(2)
    buffer_store_dwordx4 v[84:87], v16, s[64:67], s53 offen offset:512 sc1
    s_waitcnt lgkmcnt(1)
    buffer_store_dwordx4 v[88:91], v16, s[64:67], s53 offen offset:2048 sc1
    s_waitcnt lgkmcnt(0)
    buffer_store_dwordx4 v[92:95], v16, s[64:67], s53 offen offset:2560 sc1
    s_waitcnt vmcnt(31)
    v_lshlrev_b32 v232, 16, v168
    v_and_b32 v233, s78, v168
    v_lshlrev_b32 v234, 16, v172
    v_and_b32 v235, s78, v172
    v_mul_f32 v236, v40, v232
    v_mul_f32 v238, v40, v234
    v_mul_f32 v237, v42, v233
    v_mul_f32 v239, v42, v235
    v_fma_f32 v236, -v41, v234, v236
    v_fma_f32 v238, -v41, v232, -v238
    v_fma_f32 v237, -v43, v235, v237
    v_fma_f32 v239, -v43, v233, -v239
    v_cvt_pk_bf16_f32 v168, v236, v237
    v_cvt_pk_bf16_f32 v172, v238, v239
    v_lshlrev_b32 v240, 16, v169
    v_and_b32 v241, s78, v169
    v_lshlrev_b32 v242, 16, v173
    v_and_b32 v243, s78, v173
    v_mul_f32 v244, v44, v240
    v_mul_f32 v246, v44, v242
    v_mul_f32 v245, v46, v241
    v_mul_f32 v247, v46, v243
    v_fma_f32 v244, -v45, v242, v244
    v_fma_f32 v246, -v45, v240, -v246
    v_fma_f32 v245, -v47, v243, v245
    v_fma_f32 v247, -v47, v241, -v247
    v_cvt_pk_bf16_f32 v169, v244, v245
    v_cvt_pk_bf16_f32 v173, v246, v247
    v_lshlrev_b32 v232, 16, v170
    v_and_b32 v233, s78, v170
    v_lshlrev_b32 v234, 16, v174
    v_and_b32 v235, s78, v174
    v_mul_f32 v236, v48, v232
    v_mul_f32 v238, v48, v234
    v_mul_f32 v237, v50, v233
    v_mul_f32 v239, v50, v235
    v_fma_f32 v236, -v49, v234, v236
    v_fma_f32 v238, -v49, v232, -v238
    v_fma_f32 v237, -v51, v235, v237
    v_fma_f32 v239, -v51, v233, -v239
    v_cvt_pk_bf16_f32 v170, v236, v237
    v_cvt_pk_bf16_f32 v174, v238, v239
    v_lshlrev_b32 v240, 16, v171
    v_and_b32 v241, s78, v171
    v_lshlrev_b32 v242, 16, v175
    v_and_b32 v243, s78, v175
    v_mul_f32 v244, v52, v240
    v_mul_f32 v246, v52, v242
    v_mul_f32 v245, v54, v241
    v_mul_f32 v247, v54, v243
    v_fma_f32 v244, -v53, v242, v244
    v_fma_f32 v246, -v53, v240, -v246
    v_fma_f32 v245, -v55, v243, v245
    v_fma_f32 v247, -v55, v241, -v247
    v_cvt_pk_bf16_f32 v171, v244, v245
    v_cvt_pk_bf16_f32 v175, v246, v247
    ds_write_b128 v30, v[168:171] offset:8192
    ds_write_b128 v30, v[172:175] offset:9216
    s_waitcnt vmcnt(29)
    v_lshlrev_b32 v232, 16, v176
    v_and_b32 v233, s78, v176
    v_lshlrev_b32 v234, 16, v180
    v_and_b32 v235, s78, v180
    v_mul_f32 v236, v40, v232
    v_mul_f32 v238, v40, v234
    v_mul_f32 v237, v42, v233
    v_mul_f32 v239, v42, v235
    v_fma_f32 v236, -v41, v234, v236
    v_fma_f32 v238, -v41, v232, -v238
    v_fma_f32 v237, -v43, v235, v237
    v_fma_f32 v239, -v43, v233, -v239
    v_cvt_pk_bf16_f32 v176, v236, v237
    v_cvt_pk_bf16_f32 v180, v238, v239
    v_lshlrev_b32 v240, 16, v177
    v_and_b32 v241, s78, v177
    v_lshlrev_b32 v242, 16, v181
    v_and_b32 v243, s78, v181
    v_mul_f32 v244, v44, v240
    v_mul_f32 v246, v44, v242
    v_mul_f32 v245, v46, v241
    v_mul_f32 v247, v46, v243
    v_fma_f32 v244, -v45, v242, v244
    v_fma_f32 v246, -v45, v240, -v246
    v_fma_f32 v245, -v47, v243, v245
    v_fma_f32 v247, -v47, v241, -v247
    v_cvt_pk_bf16_f32 v177, v244, v245
    v_cvt_pk_bf16_f32 v181, v246, v247
    v_lshlrev_b32 v232, 16, v178
    v_and_b32 v233, s78, v178
    v_lshlrev_b32 v234, 16, v182
    v_and_b32 v235, s78, v182
    v_mul_f32 v236, v48, v232
    v_mul_f32 v238, v48, v234
    v_mul_f32 v237, v50, v233
    v_mul_f32 v239, v50, v235
    v_fma_f32 v236, -v49, v234, v236
    v_fma_f32 v238, -v49, v232, -v238
    v_fma_f32 v237, -v51, v235, v237
    v_fma_f32 v239, -v51, v233, -v239
    v_cvt_pk_bf16_f32 v178, v236, v237
    v_cvt_pk_bf16_f32 v182, v238, v239
    v_lshlrev_b32 v240, 16, v179
    v_and_b32 v241, s78, v179
    v_lshlrev_b32 v242, 16, v183
    v_and_b32 v243, s78, v183
    v_mul_f32 v244, v52, v240
    v_mul_f32 v246, v52, v242
    v_mul_f32 v245, v54, v241
    v_mul_f32 v247, v54, v243
    v_fma_f32 v244, -v53, v242, v244
    v_fma_f32 v246, -v53, v240, -v246
    v_fma_f32 v245, -v55, v243, v245
    v_fma_f32 v247, -v55, v241, -v247
    v_cvt_pk_bf16_f32 v179, v244, v245
    v_cvt_pk_bf16_f32 v183, v246, v247
    ds_write_b128 v30, v[176:179] offset:8320
    ds_write_b128 v30, v[180:183] offset:9344
    s_waitcnt vmcnt(27)
    v_lshlrev_b32 v232, 16, v184
    v_and_b32 v233, s78, v184
    v_lshlrev_b32 v234, 16, v188
    v_and_b32 v235, s78, v188
    v_mul_f32 v236, v40, v232
    v_mul_f32 v238, v40, v234
    v_mul_f32 v237, v42, v233
    v_mul_f32 v239, v42, v235
    v_fma_f32 v236, -v41, v234, v236
    v_fma_f32 v238, -v41, v232, -v238
    v_fma_f32 v237, -v43, v235, v237
    v_fma_f32 v239, -v43, v233, -v239
    v_cvt_pk_bf16_f32 v184, v236, v237
    v_cvt_pk_bf16_f32 v188, v238, v239
    v_lshlrev_b32 v240, 16, v185
    v_and_b32 v241, s78, v185
    v_lshlrev_b32 v242, 16, v189
    v_and_b32 v243, s78, v189
    v_mul_f32 v244, v44, v240
    v_mul_f32 v246, v44, v242
    v_mul_f32 v245, v46, v241
    v_mul_f32 v247, v46, v243
    v_fma_f32 v244, -v45, v242, v244
    v_fma_f32 v246, -v45, v240, -v246
    v_fma_f32 v245, -v47, v243, v245
    v_fma_f32 v247, -v47, v241, -v247
    v_cvt_pk_bf16_f32 v185, v244, v245
    v_cvt_pk_bf16_f32 v189, v246, v247
    v_lshlrev_b32 v232, 16, v186
    v_and_b32 v233, s78, v186
    v_lshlrev_b32 v234, 16, v190
    v_and_b32 v235, s78, v190
    v_mul_f32 v236, v48, v232
    v_mul_f32 v238, v48, v234
    v_mul_f32 v237, v50, v233
    v_mul_f32 v239, v50, v235
    v_fma_f32 v236, -v49, v234, v236
    v_fma_f32 v238, -v49, v232, -v238
    v_fma_f32 v237, -v51, v235, v237
    v_fma_f32 v239, -v51, v233, -v239
    v_cvt_pk_bf16_f32 v186, v236, v237
    v_cvt_pk_bf16_f32 v190, v238, v239
    v_lshlrev_b32 v240, 16, v187
    v_and_b32 v241, s78, v187
    v_lshlrev_b32 v242, 16, v191
    v_and_b32 v243, s78, v191
    v_mul_f32 v244, v52, v240
    v_mul_f32 v246, v52, v242
    v_mul_f32 v245, v54, v241
    v_mul_f32 v247, v54, v243
    v_fma_f32 v244, -v53, v242, v244
    v_fma_f32 v246, -v53, v240, -v246
    v_fma_f32 v245, -v55, v243, v245
    v_fma_f32 v247, -v55, v241, -v247
    v_cvt_pk_bf16_f32 v187, v244, v245
    v_cvt_pk_bf16_f32 v191, v246, v247
    ds_write_b128 v30, v[184:187] offset:8448
    ds_write_b128 v30, v[188:191] offset:9472
    s_waitcnt vmcnt(25)
    v_lshlrev_b32 v232, 16, v192
    v_and_b32 v233, s78, v192
    v_lshlrev_b32 v234, 16, v196
    v_and_b32 v235, s78, v196
    v_mul_f32 v236, v40, v232
    v_mul_f32 v238, v40, v234
    v_mul_f32 v237, v42, v233
    v_mul_f32 v239, v42, v235
    v_fma_f32 v236, -v41, v234, v236
    v_fma_f32 v238, -v41, v232, -v238
    v_fma_f32 v237, -v43, v235, v237
    v_fma_f32 v239, -v43, v233, -v239
    v_cvt_pk_bf16_f32 v192, v236, v237
    v_cvt_pk_bf16_f32 v196, v238, v239
    v_lshlrev_b32 v240, 16, v193
    v_and_b32 v241, s78, v193
    v_lshlrev_b32 v242, 16, v197
    v_and_b32 v243, s78, v197
    v_mul_f32 v244, v44, v240
    v_mul_f32 v246, v44, v242
    v_mul_f32 v245, v46, v241
    v_mul_f32 v247, v46, v243
    v_fma_f32 v244, -v45, v242, v244
    v_fma_f32 v246, -v45, v240, -v246
    v_fma_f32 v245, -v47, v243, v245
    v_fma_f32 v247, -v47, v241, -v247
    v_cvt_pk_bf16_f32 v193, v244, v245
    v_cvt_pk_bf16_f32 v197, v246, v247
    v_lshlrev_b32 v232, 16, v194
    v_and_b32 v233, s78, v194
    v_lshlrev_b32 v234, 16, v198
    v_and_b32 v235, s78, v198
    v_mul_f32 v236, v48, v232
    v_mul_f32 v238, v48, v234
    v_mul_f32 v237, v50, v233
    v_mul_f32 v239, v50, v235
    v_fma_f32 v236, -v49, v234, v236
    v_fma_f32 v238, -v49, v232, -v238
    v_fma_f32 v237, -v51, v235, v237
    v_fma_f32 v239, -v51, v233, -v239
    v_cvt_pk_bf16_f32 v194, v236, v237
    v_cvt_pk_bf16_f32 v198, v238, v239
    v_lshlrev_b32 v240, 16, v195
    v_and_b32 v241, s78, v195
    v_lshlrev_b32 v242, 16, v199
    v_and_b32 v243, s78, v199
    v_mul_f32 v244, v52, v240
    v_mul_f32 v246, v52, v242
    v_mul_f32 v245, v54, v241
    v_mul_f32 v247, v54, v243
    v_fma_f32 v244, -v53, v242, v244
    v_fma_f32 v246, -v53, v240, -v246
    v_fma_f32 v245, -v55, v243, v245
    v_fma_f32 v247, -v55, v241, -v247
    v_cvt_pk_bf16_f32 v195, v244, v245
    v_cvt_pk_bf16_f32 v199, v246, v247
    ds_write_b128 v30, v[192:195] offset:8576
    ds_write_b128 v30, v[196:199] offset:9600
    s_waitcnt lgkmcnt(0)
    ds_read_b128 v[96:99], v12 offset:8192
    ds_read_b128 v[100:103], v12 offset:9216
    ds_read_b128 v[104:107], v13 offset:10240
    ds_read_b128 v[108:111], v13 offset:11264
    ds_read_b128 v[112:115], v14 offset:12288
    s_branch L_sskip23
L_stub23:
    s_setpc_b64 s[100:101]
L_sskip23:
    ds_read_b128 v[116:119], v14 offset:13312
    ds_read_b128 v[120:123], v15 offset:14336
    ds_read_b128 v[124:127], v15 offset:15360
    s_add_u32 s53, s77, 368640
    s_waitcnt lgkmcnt(7)
    buffer_store_dwordx4 v[96:99], v16, s[64:67], s53 offen offset:0 sc1
    s_waitcnt lgkmcnt(6)
    buffer_store_dwordx4 v[100:103], v16, s[64:67], s53 offen offset:512 sc1
    s_waitcnt lgkmcnt(5)
    buffer_store_dwordx4 v[104:107], v16, s[64:67], s53 offen offset:2048 sc1
    s_waitcnt lgkmcnt(4)
    buffer_store_dwordx4 v[108:111], v16, s[64:67], s53 offen offset:2560 sc1
    s_add_u32 s53, s77, 372736
    s_waitcnt lgkmcnt(3)
    buffer_store_dwordx4 v[112:115], v16, s[64:67], s53 offen offset:0 sc1
    s_waitcnt lgkmcnt(2)
    buffer_store_dwordx4 v[116:119], v16, s[64:67], s53 offen offset:512 sc1
    s_waitcnt lgkmcnt(1)
    buffer_store_dwordx4 v[120:123], v16, s[64:67], s53 offen offset:2048 sc1
    s_waitcnt lgkmcnt(0)
    buffer_store_dwordx4 v[124:127], v16, s[64:67], s53 offen offset:2560 sc1
    s_waitcnt vmcnt(31)
    v_lshlrev_b32 v232, 16, v200
    v_and_b32 v233, s78, v200
    v_lshlrev_b32 v234, 16, v204
    v_and_b32 v235, s78, v204
    v_mul_f32 v236, v40, v232
    v_mul_f32 v238, v40, v234
    v_mul_f32 v237, v42, v233
    v_mul_f32 v239, v42, v235
    v_fma_f32 v236, -v41, v234, v236
    v_fma_f32 v238, -v41, v232, -v238
    v_fma_f32 v237, -v43, v235, v237
    v_fma_f32 v239, -v43, v233, -v239
    v_cvt_pk_bf16_f32 v200, v236, v237
    v_cvt_pk_bf16_f32 v204, v238, v239
    v_lshlrev_b32 v240, 16, v201
    v_and_b32 v241, s78, v201
    v_lshlrev_b32 v242, 16, v205
    v_and_b32 v243, s78, v205
    v_mul_f32 v244, v44, v240
    v_mul_f32 v246, v44, v242
    v_mul_f32 v245, v46, v241
    v_mul_f32 v247, v46, v243
    v_fma_f32 v244, -v45, v242, v244
    v_fma_f32 v246, -v45, v240, -v246
    v_fma_f32 v245, -v47, v243, v245
    v_fma_f32 v247, -v47, v241, -v247
    v_cvt_pk_bf16_f32 v201, v244, v245
    v_cvt_pk_bf16_f32 v205, v246, v247
    v_lshlrev_b32 v232, 16, v202
    v_and_b32 v233, s78, v202
    v_lshlrev_b32 v234, 16, v206
    v_and_b32 v235, s78, v206
    v_mul_f32 v236, v48, v232
    v_mul_f32 v238, v48, v234
    v_mul_f32 v237, v50, v233
    v_mul_f32 v239, v50, v235
    v_fma_f32 v236, -v49, v234, v236
    v_fma_f32 v238, -v49, v232, -v238
    v_fma_f32 v237, -v51, v235, v237
    v_fma_f32 v239, -v51, v233, -v239
    v_cvt_pk_bf16_f32 v202, v236, v237
    v_cvt_pk_bf16_f32 v206, v238, v239
    v_lshlrev_b32 v240, 16, v203
    v_and_b32 v241, s78, v203
    v_lshlrev_b32 v242, 16, v207
    v_and_b32 v243, s78, v207
    v_mul_f32 v244, v52, v240
    v_mul_f32 v246, v52, v242
    v_mul_f32 v245, v54, v241
    v_mul_f32 v247, v54, v243
    v_fma_f32 v244, -v53, v242, v244
    v_fma_f32 v246, -v53, v240, -v246
    v_fma_f32 v245, -v55, v243, v245
    v_fma_f32 v247, -v55, v241, -v247
    v_cvt_pk_bf16_f32 v203, v244, v245
    v_cvt_pk_bf16_f32 v207, v246, v247
    ds_write_b128 v30, v[200:203] offset:0
    ds_write_b128 v30, v[204:207] offset:1024
    s_waitcnt vmcnt(29)
    v_lshlrev_b32 v232, 16, v208
    v_and_b32 v233, s78, v208
    v_lshlrev_b32 v234, 16, v212
    v_and_b32 v235, s78, v212
    v_mul_f32 v236, v40, v232
    v_mul_f32 v238, v40, v234
    v_mul_f32 v237, v42, v233
    v_mul_f32 v239, v42, v235
    v_fma_f32 v236, -v41, v234, v236
    v_fma_f32 v238, -v41, v232, -v238
    v_fma_f32 v237, -v43, v235, v237
    v_fma_f32 v239, -v43, v233, -v239
    v_cvt_pk_bf16_f32 v208, v236, v237
    v_cvt_pk_bf16_f32 v212, v238, v239
    v_lshlrev_b32 v240, 16, v209
    v_and_b32 v241, s78, v209
    v_lshlrev_b32 v242, 16, v213
    v_and_b32 v243, s78, v213
    v_mul_f32 v244, v44, v240
    v_mul_f32 v246, v44, v242
    v_mul_f32 v245, v46, v241
    v_mul_f32 v247, v46, v243
    v_fma_f32 v244, -v45, v242, v244
    v_fma_f32 v246, -v45, v240, -v246
    v_fma_f32 v245, -v47, v243, v245
    v_fma_f32 v247, -v47, v241, -v247
    v_cvt_pk_bf16_f32 v209, v244, v245
    v_cvt_pk_bf16_f32 v213, v246, v247
    v_lshlrev_b32 v232, 16, v210
    v_and_b32 v233, s78, v210
    v_lshlrev_b32 v234, 16, v214
    v_and_b32 v235, s78, v214
    v_mul_f32 v236, v48, v232
    v_mul_f32 v238, v48, v234
    v_mul_f32 v237, v50, v233
    v_mul_f32 v239, v50, v235
    v_fma_f32 v236, -v49, v234, v236
    v_fma_f32 v238, -v49, v232, -v238
    v_fma_f32 v237, -v51, v235, v237
    v_fma_f32 v239, -v51, v233, -v239
    v_cvt_pk_bf16_f32 v210, v236, v237
    v_cvt_pk_bf16_f32 v214, v238, v239
    v_lshlrev_b32 v240, 16, v211
    v_and_b32 v241, s78, v211
    v_lshlrev_b32 v242, 16, v215
    v_and_b32 v243, s78, v215
    v_mul_f32 v244, v52, v240
    v_mul_f32 v246, v52, v242
    v_mul_f32 v245, v54, v241
    v_mul_f32 v247, v54, v243
    v_fma_f32 v244, -v53, v242, v244
    v_fma_f32 v246, -v53, v240, -v246
    v_fma_f32 v245, -v55, v243, v245
    v_fma_f32 v247, -v55, v241, -v247
    v_cvt_pk_bf16_f32 v211, v244, v245
    v_cvt_pk_bf16_f32 v215, v246, v247
    ds_write_b128 v30, v[208:211] offset:128
    ds_write_b128 v30, v[212:215] offset:1152
    s_waitcnt vmcnt(27)
    v_lshlrev_b32 v232, 16, v216
    v_and_b32 v233, s78, v216
    v_lshlrev_b32 v234, 16, v220
    v_and_b32 v235, s78, v220
    v_mul_f32 v236, v40, v232
    v_mul_f32 v238, v40, v234
    v_mul_f32 v237, v42, v233
    v_mul_f32 v239, v42, v235
    v_fma_f32 v236, -v41, v234, v236
    v_fma_f32 v238, -v41, v232, -v238
    v_fma_f32 v237, -v43, v235, v237
    v_fma_f32 v239, -v43, v233, -v239
    v_cvt_pk_bf16_f32 v216, v236, v237
    v_cvt_pk_bf16_f32 v220, v238, v239
    v_lshlrev_b32 v240, 16, v217
    v_and_b32 v241, s78, v217
    v_lshlrev_b32 v242, 16, v221
    v_and_b32 v243, s78, v221
    v_mul_f32 v244, v44, v240
    v_mul_f32 v246, v44, v242
    v_mul_f32 v245, v46, v241
    v_mul_f32 v247, v46, v243
    v_fma_f32 v244, -v45, v242, v244
    v_fma_f32 v246, -v45, v240, -v246
    v_fma_f32 v245, -v47, v243, v245
    v_fma_f32 v247, -v47, v241, -v247
    v_cvt_pk_bf16_f32 v217, v244, v245
    v_cvt_pk_bf16_f32 v221, v246, v247
    v_lshlrev_b32 v232, 16, v218
    v_and_b32 v233, s78, v218
    v_lshlrev_b32 v234, 16, v222
    v_and_b32 v235, s78, v222
    v_mul_f32 v236, v48, v232
    v_mul_f32 v238, v48, v234
    v_mul_f32 v237, v50, v233
    v_mul_f32 v239, v50, v235
    v_fma_f32 v236, -v49, v234, v236
    v_fma_f32 v238, -v49, v232, -v238
    v_fma_f32 v237, -v51, v235, v237
    v_fma_f32 v239, -v51, v233, -v239
    v_cvt_pk_bf16_f32 v218, v236, v237
    v_cvt_pk_bf16_f32 v222, v238, v239
    v_lshlrev_b32 v240, 16, v219
    v_and_b32 v241, s78, v219
    v_lshlrev_b32 v242, 16, v223
    v_and_b32 v243, s78, v223
    v_mul_f32 v244, v52, v240
    v_mul_f32 v246, v52, v242
    v_mul_f32 v245, v54, v241
    v_mul_f32 v247, v54, v243
    v_fma_f32 v244, -v53, v242, v244
    v_fma_f32 v246, -v53, v240, -v246
    v_fma_f32 v245, -v55, v243, v245
    v_fma_f32 v247, -v55, v241, -v247
    v_cvt_pk_bf16_f32 v219, v244, v245
    v_cvt_pk_bf16_f32 v223, v246, v247
    ds_write_b128 v30, v[216:219] offset:256
    ds_write_b128 v30, v[220:223] offset:1280
    s_waitcnt vmcnt(25)
    v_and_b32 v9, 60, v0
    v_mov_b32 v8, -1
    s_cmp_eq_u32 s50, 0
    s_cselect_b64 exec, -1, 0
    global_load_dword v8, v9, s[46:47] offset:128 sc1
    s_mov_b64 exec, -1
    v_lshlrev_b32 v232, 16, v224
    v_and_b32 v233, s78, v224
    v_lshlrev_b32 v234, 16, v228
    v_and_b32 v235, s78, v228
    v_mul_f32 v236, v40, v232
    v_mul_f32 v238, v40, v234
    v_mul_f32 v237, v42, v233
    v_mul_f32 v239, v42, v235
    v_fma_f32 v236, -v41, v234, v236
    v_fma_f32 v238, -v41, v232, -v238
    v_fma_f32 v237, -v43, v235, v237
    v_fma_f32 v239, -v43, v233, -v239
    v_cvt_pk_bf16_f32 v224, v236, v237
    v_cvt_pk_bf16_f32 v228, v238, v239
    v_lshlrev_b32 v240, 16, v225
    v_and_b32 v241, s78, v225
    v_lshlrev_b32 v242, 16, v229
    v_and_b32 v243, s78, v229
    v_mul_f32 v244, v44, v240
    v_mul_f32 v246, v44, v242
    v_mul_f32 v245, v46, v241
    v_mul_f32 v247, v46, v243
    v_fma_f32 v244, -v45, v242, v244
    v_fma_f32 v246, -v45, v240, -v246
    v_fma_f32 v245, -v47, v243, v245
    v_fma_f32 v247, -v47, v241, -v247
    v_cvt_pk_bf16_f32 v225, v244, v245
    v_cvt_pk_bf16_f32 v229, v246, v247
    v_lshlrev_b32 v232, 16, v226
    v_and_b32 v233, s78, v226
    v_lshlrev_b32 v234, 16, v230
    v_and_b32 v235, s78, v230
    v_mul_f32 v236, v48, v232
    v_mul_f32 v238, v48, v234
    v_mul_f32 v237, v50, v233
    v_mul_f32 v239, v50, v235
    v_fma_f32 v236, -v49, v234, v236
    v_fma_f32 v238, -v49, v232, -v238
    v_fma_f32 v237, -v51, v235, v237
    v_fma_f32 v239, -v51, v233, -v239
    v_cvt_pk_bf16_f32 v226, v236, v237
    v_cvt_pk_bf16_f32 v230, v238, v239
    v_lshlrev_b32 v240, 16, v227
    v_and_b32 v241, s78, v227
    v_lshlrev_b32 v242, 16, v231
    v_and_b32 v243, s78, v231
    v_mul_f32 v244, v52, v240
    v_mul_f32 v246, v52, v242
    v_mul_f32 v245, v54, v241
    v_mul_f32 v247, v54, v243
    v_fma_f32 v244, -v53, v242, v244
    v_fma_f32 v246, -v53, v240, -v246
    v_fma_f32 v245, -v55, v243, v245
    v_fma_f32 v247, -v55, v241, -v247
    v_cvt_pk_bf16_f32 v227, v244, v245
    v_cvt_pk_bf16_f32 v231, v246, v247
    ds_write_b128 v30, v[224:227] offset:384
    ds_write_b128 v30, v[228:231] offset:1408
    s_waitcnt lgkmcnt(0)
    ds_read_b128 v[64:67], v12 offset:0
    ds_read_b128 v[68:71], v12 offset:1024
    ds_read_b128 v[72:75], v13 offset:2048
    ds_read_b128 v[76:79], v13 offset:3072
    ds_read_b128 v[80:83], v14 offset:4096
    ds_read_b128 v[84:87], v14 offset:5120
    ds_read_b128 v[88:91], v15 offset:6144
    ds_read_b128 v[92:95], v15 offset:7168
    s_add_u32 s53, s77, 737280
    s_waitcnt lgkmcnt(7)
    buffer_store_dwordx4 v[64:67], v16, s[64:67], s53 offen offset:0 sc1
    s_waitcnt lgkmcnt(6)
    buffer_store_dwordx4 v[68:71], v16, s[64:67], s53 offen offset:512 sc1
    s_waitcnt lgkmcnt(5)
    buffer_store_dwordx4 v[72:75], v16, s[64:67], s53 offen offset:2048 sc1
    s_waitcnt lgkmcnt(4)
    buffer_store_dwordx4 v[76:79], v16, s[64:67], s53 offen offset:2560 sc1
    s_add_u32 s53, s77, 741376
    s_waitcnt lgkmcnt(3)
    buffer_store_dwordx4 v[80:83], v16, s[64:67], s53 offen offset:0 sc1
    s_waitcnt lgkmcnt(2)
    buffer_store_dwordx4 v[84:87], v16, s[64:67], s53 offen offset:512 sc1
    s_waitcnt lgkmcnt(1)
    buffer_store_dwordx4 v[88:91], v16, s[64:67], s53 offen offset:2048 sc1
    s_waitcnt lgkmcnt(0)
    buffer_store_dwordx4 v[92:95], v16, s[64:67], s53 offen offset:2560 sc1
    s_add_u32 s68, s48, 30228480
    s_addc_u32 s69, s49, 0
    s_mov_b32 s70, 16384
    s_mov_b32 s71, 0x20000
    v_lshlrev_b32 v5, 4, v4
    v_lshrrev_b32 v4, 3, v0
    v_lshlrev_b32 v4, 2, v4
    global_load_dwordx4 v[20:23], v5, s[42:43] offset:0
    global_load_dwordx4 v[24:27], v5, s[42:43] offset:128
    global_load_dwordx4 v[28:31], v5, s[42:43] offset:256
    global_load_dwordx4 v[32:35], v5, s[42:43] offset:384
    global_load_dwordx4 v[36:39], v5, s[42:43] offset:512
    global_load_dwordx4 v[40:43], v5, s[42:43] offset:640
    global_load_dwordx4 v[44:47], v5, s[42:43] offset:768
    global_load_dwordx4 v[48:51], v5, s[42:43] offset:896
    global_load_dwordx4 v[52:55], v5, s[42:43] offset:1024
    s_lshl_b32 s54, s94, 7
    s_mov_b32 s96, 0xbfb8aa3b
    s_mov_b32 s60, s40
    s_mov_b32 s61, s41
    s_mov_b32 s62, 5308416
    s_mov_b32 s63, 0x20000
    s_mov_b32 s64, s48
    s_mov_b32 s65, s49
    s_mov_b32 s66, 23592960
    s_mov_b32 s67, 0x20000
    s_add_u32 s72, s48, 49119232
    s_addc_u32 s73, s49, 0
    s_mov_b32 s74, 4718592
    s_mov_b32 s75, 0x20000
    s_bitcmp1_b32 s3, 0
    s_mov_b32 s22, 0
    s_cmov_b32 s22, 1474560
    s_mov_b32 s23, 294912
    s_cmov_b32 s23, 2359296
    s_mov_b32 s24, 1179648
    s_cmov_b32 s24, 2654208
    s_mov_b32 s25, 1474560
    s_cmov_b32 s25, 0
    s_mov_b32 s26, 2359296
    s_cmov_b32 s26, 294912
    s_mov_b32 s27, 2654208
    s_cmov_b32 s27, 1179648
    s_cselect_b32 s86, 18432, 0
    v_lshrrev_b32 v220, 3, v0
    s_lshl_b32 s53, s50, 3
    v_add_u32 v220, s53, v220
    v_mul_u32_u24 v220, 1152, v220
    v_bfe_u32 v221, v0, 4, 1
    v_lshlrev_b32 v221, 2, v221
    v_and_b32 v208, 7, v0
    v_xor_b32 v221, v221, v208
    v_lshl_add_u32 v208, v221, 4, v220
    v_and_b32 v221, 32, v0
    v_xor_b32 v208, v208, v221
    v_lshrrev_b32 v220, 5, v0
    v_mul_u32_u24 v220, 40960, v220
    v_bfe_u32 v221, v0, 2, 3
    v_lshl_add_u32 v220, v221, 7, v220
    v_bfe_u32 v221, v0, 4, 1
    v_lshl_add_u32 v220, v221, 5, v220
    v_and_b32 v221, 3, v0
    v_lshl_add_u32 v220, v221, 3, v220
    v_bfe_u32 v221, v0, 3, 1
    v_lshl_add_u32 v210, v221, 6, v220
    v_add_u32 v225, 72704, v208
    v_add_u32 v226, 145408, v208
    v_add_u32 v211, 81920, v210
    v_xor_b32 v212, 32, v210
    v_add_u32 v213, 81920, v212
    v_xor_b32 v214, 64, v210
    v_add_u32 v215, 81920, v214
    v_xor_b32 v216, 96, v210
    v_add_u32 v217, 81920, v216
    s_mul_i32 s79, s94, 368640
    s_add_u32 s85, s79, s86
    s_sub_u32 s86, s79, s86
    s_lshr_b32 s53, s94, 1
    s_lshl_b32 s53, s53, 12
    s_add_u32 s53, s53, 53837824
    v_min_u32 v218, 17, v0
    v_mul_u32_u24 v219, 43, v218
    v_lshrrev_b32 v219, 8, v219
    v_mul_u32_u24 v219, 104, v219
    v_lshl_add_u32 v218, v218, 2, s53
    v_add_u32 v218, v218, v219
    s_lshr_b32 s53, s94, 2
    s_mul_i32 s53, s53, 12
    s_lshl2_add_u32 s82, s53, s50
    s_mul_i32 s82, s82, 6144
    s_add_u32 s53, s53, s50
    s_lshl_b32 s53, s53, 7
    s_add_u32 s53, s53, 53970964
    v_mov_b32 v222, s53
    v_mov_b32 v223, 1
    v_mov_b32 v228, -1
    v_mov_b32 v229, -1
    v_mov_b32 v230, -1
    v_mov_b32 v231, -1
    s_waitcnt vmcnt(17)
    v_cmp_gt_u32 vcc, 1, v8
    s_cbranch_vccnz L_poll18
L_fok18:
    s_waitcnt vmcnt(9)
    s_barrier
    v_lshlrev_b32 v6, 7, v0
    v_add_u32 v6, s97, v6
    v_mov_b32 v7, 2
    s_mov_b64 exec, 3
    global_store_dword v6, v7, s[48:49] offset:0 sc1
    s_mov_b64 exec, -1
    s_add_u32 s55, s55, 9216
    buffer_load_dwordx4 a[36:39], v3, s[56:59], s55 offen offset:0
    buffer_load_dwordx4 a[40:43], v3, s[56:59], s55 offen offset:128
    buffer_load_dwordx4 a[44:47], v3, s[56:59], s55 offen offset:256
    buffer_load_dwordx4 a[48:51], v3, s[56:59], s55 offen offset:384
    buffer_load_dwordx4 a[52:55], v3, s[56:59], s55 offen offset:512
    buffer_load_dwordx4 a[56:59], v3, s[56:59], s55 offen offset:640
    buffer_load_dwordx4 a[60:63], v3, s[56:59], s55 offen offset:768
    buffer_load_dwordx4 a[64:67], v3, s[56:59], s55 offen offset:896
    buffer_load_dwordx4 a[68:71], v3, s[56:59], s55 offen offset:1024
    s_add_u32 s55, s55, 9216
    buffer_load_dwordx4 a[72:75], v3, s[56:59], s55 offen offset:0
    buffer_load_dwordx4 a[76:79], v3, s[56:59], s55 offen offset:128
    buffer_load_dwordx4 a[80:83], v3, s[56:59], s55 offen offset:256
    buffer_load_dwordx4 a[84:87], v3, s[56:59], s55 offen offset:384
    buffer_load_dwordx4 a[88:91], v3, s[56:59], s55 offen offset:512
    buffer_load_dwordx4 a[92:95], v3, s[56:59], s55 offen offset:640
    buffer_load_dwordx4 a[96:99], v3, s[56:59], s55 offen offset:768
    buffer_load_dwordx4 a[100:103], v3, s[56:59], s55 offen offset:896
    buffer_load_dwordx4 a[104:107], v3, s[56:59], s55 offen offset:1024
    s_add_u32 s55, s55, 9216
    buffer_load_dwordx4 a[108:111], v3, s[56:59], s55 offen offset:0
    buffer_load_dwordx4 a[112:115], v3, s[56:59], s55 offen offset:128
    buffer_load_dwordx4 a[116:119], v3, s[56:59], s55 offen offset:256
    buffer_load_dwordx4 a[120:123], v3, s[56:59], s55 offen offset:384
    buffer_load_dwordx4 a[124:127], v3, s[56:59], s55 offen offset:512
    buffer_load_dwordx4 a[128:131], v3, s[56:59], s55 offen offset:640
    buffer_load_dwordx4 a[132:135], v3, s[56:59], s55 offen offset:768
    buffer_load_dwordx4 a[136:139], v3, s[56:59], s55 offen offset:896
    buffer_load_dwordx4 a[140:143], v3, s[56:59], s55 offen offset:1024
    s_waitcnt vmcnt(28)
    v_mov_b32 v6, 0
    v_mov_b32 v7, 0
    v_accvgpr_read_b32 v64, a0
    s_add_u32 m0, s52, 0
    s_add_u32 s81, s22, 0
    buffer_load_dwordx4 v208, s[60:63], s81 offen offset:0 lds
    v_accvgpr_read_b32 v65, a1
    v_accvgpr_read_b32 v66, a2
    v_accvgpr_read_b32 v67, a3
    v_accvgpr_read_b32 v68, a4
    buffer_load_dwordx4 v225, s[60:63], s81 offen offset:1024 lds
    v_accvgpr_read_b32 v69, a5
    v_accvgpr_read_b32 v70, a6
    v_accvgpr_read_b32 v71, a7
    v_accvgpr_read_b32 v72, a8
    buffer_load_dwordx4 v226, s[60:63], s81 offen offset:2048 lds
    v_accvgpr_read_b32 v73, a9
    v_accvgpr_read_b32 v74, a10
    v_accvgpr_read_b32 v75, a11
    v_accvgpr_read_b32 v76, a12
    s_add_u32 m0, s52, 3072
    s_add_u32 s81, s22, 128
    buffer_load_dwordx4 v208, s[60:63], s81 offen offset:0 lds
    v_accvgpr_read_b32 v77, a13
    v_accvgpr_read_b32 v78, a14
    v_accvgpr_read_b32 v79, a15
    v_accvgpr_read_b32 v80, a16
    buffer_load_dwordx4 v225, s[60:63], s81 offen offset:1024 lds
    v_accvgpr_read_b32 v81, a17
    v_accvgpr_read_b32 v82, a18
    v_accvgpr_read_b32 v83, a19
    v_accvgpr_read_b32 v84, a20
    buffer_load_dwordx4 v226, s[60:63], s81 offen offset:2048 lds
    v_accvgpr_read_b32 v85, a21
    v_accvgpr_read_b32 v86, a22
    v_accvgpr_read_b32 v87, a23
    v_accvgpr_read_b32 v88, a24
    s_add_u32 m0, s52, 6144
    s_add_u32 s81, s22, 256
    buffer_load_dwordx4 v208, s[60:63], s81 offen offset:0 lds
    v_accvgpr_read_b32 v89, a25
    v_accvgpr_read_b32 v90, a26
    v_accvgpr_read_b32 v91, a27
    v_accvgpr_read_b32 v92, a28
    buffer_load_dwordx4 v225, s[60:63], s81 offen offset:1024 lds
    v_accvgpr_read_b32 v93, a29
    v_accvgpr_read_b32 v94, a30
    v_accvgpr_read_b32 v95, a31
    v_accvgpr_read_b32 v96, a32
    buffer_load_dwordx4 v226, s[60:63], s81 offen offset:2048 lds
    v_accvgpr_read_b32 v97, a33
    v_accvgpr_read_b32 v98, a34
    v_accvgpr_read_b32 v99, a35
    v_dot2c_f32_bf16 v6, v64, v20
    v_dot2c_f32_bf16 v7, v65, v21
    v_dot2c_f32_bf16 v6, v66, v22
    v_dot2c_f32_bf16 v7, v67, v23
    v_dot2c_f32_bf16 v6, v68, v24
    v_dot2c_f32_bf16 v7, v69, v25
    v_dot2c_f32_bf16 v6, v70, v26
    v_dot2c_f32_bf16 v7, v71, v27
    v_dot2c_f32_bf16 v6, v72, v28
    v_dot2c_f32_bf16 v7, v73, v29
    v_dot2c_f32_bf16 v6, v74, v30
    v_dot2c_f32_bf16 v7, v75, v31
    v_dot2c_f32_bf16 v6, v76, v32
    v_dot2c_f32_bf16 v7, v77, v33
    v_dot2c_f32_bf16 v6, v78, v34
    v_dot2c_f32_bf16 v7, v79, v35
    v_dot2c_f32_bf16 v6, v80, v36
    v_dot2c_f32_bf16 v7, v81, v37
    v_dot2c_f32_bf16 v6, v82, v38
    v_dot2c_f32_bf16 v7, v83, v39
    v_dot2c_f32_bf16 v6, v84, v40
    v_dot2c_f32_bf16 v7, v85, v41
    v_dot2c_f32_bf16 v6, v86, v42
    v_dot2c_f32_bf16 v7, v87, v43
    v_dot2c_f32_bf16 v6, v88, v44
    v_dot2c_f32_bf16 v7, v89, v45
    v_dot2c_f32_bf16 v6, v90, v46
    v_dot2c_f32_bf16 v7, v91, v47
    v_dot2c_f32_bf16 v6, v92, v48
    v_dot2c_f32_bf16 v7, v93, v49
    v_dot2c_f32_bf16 v6, v94, v50
    v_dot2c_f32_bf16 v7, v95, v51
    v_dot2c_f32_bf16 v6, v96, v52
    v_dot2c_f32_bf16 v7, v97, v53
    v_dot2c_f32_bf16 v6, v98, v54
    v_dot2c_f32_bf16 v7, v99, v55
    s_nop 3
    v_add_f32 v6, v6, v7
    s_nop 1
    v_add_f32_dpp v6, v6, v6 quad_perm:[1,0,3,2] row_mask:0xf bank_mask:0xf
    s_nop 1
    v_add_f32_dpp v6, v6, v6 quad_perm:[2,3,0,1] row_mask:0xf bank_mask:0xf
    s_nop 1
    v_add_f32_dpp v6, v6, v6 row_half_mirror row_mask:0xf bank_mask:0xf
    v_and_b32 v7, 3, v0
    v_cmp_eq_u32 vcc, 0, v7
    s_nop 1
    v_cndmask_b32 v8, v8, v6, vcc
    s_waitcnt vmcnt(27)
    v_mov_b32 v6, 0
    v_mov_b32 v7, 0
    v_accvgpr_read_b32 v100, a36
    s_add_u32 m0, s52, 9216
    s_add_u32 s81, s23, 0
    buffer_load_dwordx4 v208, s[60:63], s81 offen offset:0 lds
    v_accvgpr_read_b32 v101, a37
    v_accvgpr_read_b32 v102, a38
    v_accvgpr_read_b32 v103, a39
    v_accvgpr_read_b32 v104, a40
    buffer_load_dwordx4 v225, s[60:63], s81 offen offset:1024 lds
    v_accvgpr_read_b32 v105, a41
    v_accvgpr_read_b32 v106, a42
    v_accvgpr_read_b32 v107, a43
    v_accvgpr_read_b32 v108, a44
    buffer_load_dwordx4 v226, s[60:63], s81 offen offset:2048 lds
    v_accvgpr_read_b32 v109, a45
    v_accvgpr_read_b32 v110, a46
    v_accvgpr_read_b32 v111, a47
    v_accvgpr_read_b32 v112, a48
    s_add_u32 m0, s52, 12288
    s_add_u32 s81, s23, 128
    buffer_load_dwordx4 v208, s[60:63], s81 offen offset:0 lds
    v_accvgpr_read_b32 v113, a49
    v_accvgpr_read_b32 v114, a50
    v_accvgpr_read_b32 v115, a51
    v_accvgpr_read_b32 v116, a52
    buffer_load_dwordx4 v225, s[60:63], s81 offen offset:1024 lds
    v_accvgpr_read_b32 v117, a53
    v_accvgpr_read_b32 v118, a54
    v_accvgpr_read_b32 v119, a55
    v_accvgpr_read_b32 v120, a56
    buffer_load_dwordx4 v226, s[60:63], s81 offen offset:2048 lds
    v_accvgpr_read_b32 v121, a57
    v_accvgpr_read_b32 v122, a58
    v_accvgpr_read_b32 v123, a59
    v_accvgpr_read_b32 v124, a60
    s_add_u32 m0, s52, 15360
    s_add_u32 s81, s23, 256
    buffer_load_dwordx4 v208, s[60:63], s81 offen offset:0 lds
    v_accvgpr_read_b32 v125, a61
    v_accvgpr_read_b32 v126, a62
    v_accvgpr_read_b32 v127, a63
    v_accvgpr_read_b32 v128, a64
    buffer_load_dwordx4 v225, s[60:63], s81 offen offset:1024 lds
    v_accvgpr_read_b32 v129, a65
    v_accvgpr_read_b32 v130, a66
    v_accvgpr_read_b32 v131, a67
    v_accvgpr_read_b32 v132, a68
    buffer_load_dwordx4 v226, s[60:63], s81 offen offset:2048 lds
    v_accvgpr_read_b32 v133, a69
    v_accvgpr_read_b32 v134, a70
    v_accvgpr_read_b32 v135, a71
    v_dot2c_f32_bf16 v6, v100, v20
    v_dot2c_f32_bf16 v7, v101, v21
    v_dot2c_f32_bf16 v6, v102, v22
    v_dot2c_f32_bf16 v7, v103, v23
    v_dot2c_f32_bf16 v6, v104, v24
    v_dot2c_f32_bf16 v7, v105, v25
    v_dot2c_f32_bf16 v6, v106, v26
    v_dot2c_f32_bf16 v7, v107, v27
    v_dot2c_f32_bf16 v6, v108, v28
    v_dot2c_f32_bf16 v7, v109, v29
    v_dot2c_f32_bf16 v6, v110, v30
    v_dot2c_f32_bf16 v7, v111, v31
    v_dot2c_f32_bf16 v6, v112, v32
    v_dot2c_f32_bf16 v7, v113, v33
    v_dot2c_f32_bf16 v6, v114, v34
    v_dot2c_f32_bf16 v7, v115, v35
    v_dot2c_f32_bf16 v6, v116, v36
    v_dot2c_f32_bf16 v7, v117, v37
    v_dot2c_f32_bf16 v6, v118, v38
    v_dot2c_f32_bf16 v7, v119, v39
    v_dot2c_f32_bf16 v6, v120, v40
    v_dot2c_f32_bf16 v7, v121, v41
    v_dot2c_f32_bf16 v6, v122, v42
    v_dot2c_f32_bf16 v7, v123, v43
    v_dot2c_f32_bf16 v6, v124, v44
    v_dot2c_f32_bf16 v7, v125, v45
    v_dot2c_f32_bf16 v6, v126, v46
    v_dot2c_f32_bf16 v7, v127, v47
    v_dot2c_f32_bf16 v6, v128, v48
    v_dot2c_f32_bf16 v7, v129, v49
    v_dot2c_f32_bf16 v6, v130, v50
    v_dot2c_f32_bf16 v7, v131, v51
    v_dot2c_f32_bf16 v6, v132, v52
    v_dot2c_f32_bf16 v7, v133, v53
    v_dot2c_f32_bf16 v6, v134, v54
    v_dot2c_f32_bf16 v7, v135, v55
    s_nop 3
    v_add_f32 v6, v6, v7
    s_nop 1
    v_add_f32_dpp v6, v6, v6 quad_perm:[1,0,3,2] row_mask:0xf bank_mask:0xf
    s_nop 1
    v_add_f32_dpp v6, v6, v6 quad_perm:[2,3,0,1] row_mask:0xf bank_mask:0xf
    s_nop 1
    v_add_f32_dpp v6, v6, v6 row_half_mirror row_mask:0xf bank_mask:0xf
    v_and_b32 v7, 3, v0
    v_cmp_eq_u32 vcc, 1, v7
    s_nop 1
    v_cndmask_b32 v8, v8, v6, vcc
    s_waitcnt vmcnt(27)
    v_mov_b32 v6, 0
    v_mov_b32 v7, 0
    v_accvgpr_read_b32 v136, a72
    s_add_u32 m0, s52, 18432
    s_add_u32 s81, s24, 0
    buffer_load_dwordx4 v208, s[60:63], s81 offen offset:0 lds
    v_accvgpr_read_b32 v137, a73
    v_accvgpr_read_b32 v138, a74
    v_accvgpr_read_b32 v139, a75
    v_accvgpr_read_b32 v140, a76
    buffer_load_dwordx4 v225, s[60:63], s81 offen offset:1024 lds
    v_accvgpr_read_b32 v141, a77
    v_accvgpr_read_b32 v142, a78
    v_accvgpr_read_b32 v143, a79
    v_accvgpr_read_b32 v144, a80
    buffer_load_dwordx4 v226, s[60:63], s81 offen offset:2048 lds
    v_accvgpr_read_b32 v145, a81
    v_accvgpr_read_b32 v146, a82
    v_accvgpr_read_b32 v147, a83
    v_accvgpr_read_b32 v148, a84
    s_add_u32 m0, s52, 21504
    s_add_u32 s81, s24, 128
    buffer_load_dwordx4 v208, s[60:63], s81 offen offset:0 lds
    v_accvgpr_read_b32 v149, a85
    v_accvgpr_read_b32 v150, a86
    v_accvgpr_read_b32 v151, a87
    v_accvgpr_read_b32 v152, a88
    buffer_load_dwordx4 v225, s[60:63], s81 offen offset:1024 lds
    v_accvgpr_read_b32 v153, a89
    v_accvgpr_read_b32 v154, a90
    v_accvgpr_read_b32 v155, a91
    s_branch L_sskip24
L_stub24:
    s_setpc_b64 s[100:101]
L_sskip24:
    v_accvgpr_read_b32 v156, a92
    buffer_load_dwordx4 v226, s[60:63], s81 offen offset:2048 lds
    v_accvgpr_read_b32 v157, a93
    v_accvgpr_read_b32 v158, a94
    v_accvgpr_read_b32 v159, a95
    v_accvgpr_read_b32 v160, a96
    s_add_u32 m0, s52, 24576
    s_add_u32 s81, s24, 256
    buffer_load_dwordx4 v208, s[60:63], s81 offen offset:0 lds
    v_accvgpr_read_b32 v161, a97
    v_accvgpr_read_b32 v162, a98
    v_accvgpr_read_b32 v163, a99
    v_accvgpr_read_b32 v164, a100
    buffer_load_dwordx4 v225, s[60:63], s81 offen offset:1024 lds
    v_accvgpr_read_b32 v165, a101
    v_accvgpr_read_b32 v166, a102
    v_accvgpr_read_b32 v167, a103
    v_accvgpr_read_b32 v168, a104
    buffer_load_dwordx4 v226, s[60:63], s81 offen offset:2048 lds
    v_accvgpr_read_b32 v169, a105
    v_accvgpr_read_b32 v170, a106
    v_accvgpr_read_b32 v171, a107
    v_dot2c_f32_bf16 v6, v136, v20
    v_dot2c_f32_bf16 v7, v137, v21
    v_dot2c_f32_bf16 v6, v138, v22
    v_dot2c_f32_bf16 v7, v139, v23
    v_dot2c_f32_bf16 v6, v140, v24
    v_dot2c_f32_bf16 v7, v141, v25
    v_dot2c_f32_bf16 v6, v142, v26
    v_dot2c_f32_bf16 v7, v143, v27
    v_dot2c_f32_bf16 v6, v144, v28
    v_dot2c_f32_bf16 v7, v145, v29
    v_dot2c_f32_bf16 v6, v146, v30
    v_dot2c_f32_bf16 v7, v147, v31
    v_dot2c_f32_bf16 v6, v148, v32
    v_dot2c_f32_bf16 v7, v149, v33
    v_dot2c_f32_bf16 v6, v150, v34
    v_dot2c_f32_bf16 v7, v151, v35
    v_dot2c_f32_bf16 v6, v152, v36
    v_dot2c_f32_bf16 v7, v153, v37
    v_dot2c_f32_bf16 v6, v154, v38
    v_dot2c_f32_bf16 v7, v155, v39
    v_dot2c_f32_bf16 v6, v156, v40
    v_dot2c_f32_bf16 v7, v157, v41
    v_dot2c_f32_bf16 v6, v158, v42
    v_dot2c_f32_bf16 v7, v159, v43
    v_dot2c_f32_bf16 v6, v160, v44
    v_dot2c_f32_bf16 v7, v161, v45
    v_dot2c_f32_bf16 v6, v162, v46
    v_dot2c_f32_bf16 v7, v163, v47
    v_dot2c_f32_bf16 v6, v164, v48
    v_dot2c_f32_bf16 v7, v165, v49
    v_dot2c_f32_bf16 v6, v166, v50
    v_dot2c_f32_bf16 v7, v167, v51
    v_dot2c_f32_bf16 v6, v168, v52
    v_dot2c_f32_bf16 v7, v169, v53
    v_dot2c_f32_bf16 v6, v170, v54
    v_dot2c_f32_bf16 v7, v171, v55
    s_nop 3
    v_add_f32 v6, v6, v7
    s_nop 1
    v_add_f32_dpp v6, v6, v6 quad_perm:[1,0,3,2] row_mask:0xf bank_mask:0xf
    s_nop 1
    v_add_f32_dpp v6, v6, v6 quad_perm:[2,3,0,1] row_mask:0xf bank_mask:0xf
    s_nop 1
    v_add_f32_dpp v6, v6, v6 row_half_mirror row_mask:0xf bank_mask:0xf
    v_and_b32 v7, 3, v0
    v_cmp_eq_u32 vcc, 2, v7
    s_nop 1
    v_cndmask_b32 v8, v8, v6, vcc
    s_waitcnt vmcnt(27)
    v_mov_b32 v6, 0
    v_mov_b32 v7, 0
    v_accvgpr_read_b32 v172, a108
    s_add_u32 m0, s52, 27648
    s_add_u32 s81, s25, 0
    buffer_load_dwordx4 v208, s[60:63], s81 offen offset:0 lds
    v_accvgpr_read_b32 v173, a109
    v_accvgpr_read_b32 v174, a110
    v_accvgpr_read_b32 v175, a111
    v_accvgpr_read_b32 v176, a112
    buffer_load_dwordx4 v225, s[60:63], s81 offen offset:1024 lds
    v_accvgpr_read_b32 v177, a113
    v_accvgpr_read_b32 v178, a114
    v_accvgpr_read_b32 v179, a115
    v_accvgpr_read_b32 v180, a116
    buffer_load_dwordx4 v226, s[60:63], s81 offen offset:2048 lds
    v_accvgpr_read_b32 v181, a117
    v_accvgpr_read_b32 v182, a118
    v_accvgpr_read_b32 v183, a119
    v_accvgpr_read_b32 v184, a120
    s_add_u32 m0, s52, 30720
    s_add_u32 s81, s25, 128
    buffer_load_dwordx4 v208, s[60:63], s81 offen offset:0 lds
    v_accvgpr_read_b32 v185, a121
    v_accvgpr_read_b32 v186, a122
    v_accvgpr_read_b32 v187, a123
    v_accvgpr_read_b32 v188, a124
    buffer_load_dwordx4 v225, s[60:63], s81 offen offset:1024 lds
    v_accvgpr_read_b32 v189, a125
    v_accvgpr_read_b32 v190, a126
    v_accvgpr_read_b32 v191, a127
    v_accvgpr_read_b32 v192, a128
    buffer_load_dwordx4 v226, s[60:63], s81 offen offset:2048 lds
    v_accvgpr_read_b32 v193, a129
    v_accvgpr_read_b32 v194, a130
    v_accvgpr_read_b32 v195, a131
    v_accvgpr_read_b32 v196, a132
    s_add_u32 m0, s52, 33792
    s_add_u32 s81, s25, 256
    buffer_load_dwordx4 v208, s[60:63], s81 offen offset:0 lds
    v_accvgpr_read_b32 v197, a133
    v_accvgpr_read_b32 v198, a134
    v_accvgpr_read_b32 v199, a135
    v_accvgpr_read_b32 v200, a136
    buffer_load_dwordx4 v225, s[60:63], s81 offen offset:1024 lds
    v_accvgpr_read_b32 v201, a137
    v_accvgpr_read_b32 v202, a138
    v_accvgpr_read_b32 v203, a139
    v_accvgpr_read_b32 v204, a140
    buffer_load_dwordx4 v226, s[60:63], s81 offen offset:2048 lds
    v_accvgpr_read_b32 v205, a141
    v_accvgpr_read_b32 v206, a142
    v_accvgpr_read_b32 v207, a143
    v_dot2c_f32_bf16 v6, v172, v20
    v_dot2c_f32_bf16 v7, v173, v21
    v_dot2c_f32_bf16 v6, v174, v22
    v_dot2c_f32_bf16 v7, v175, v23
    v_dot2c_f32_bf16 v6, v176, v24
    v_dot2c_f32_bf16 v7, v177, v25
    v_dot2c_f32_bf16 v6, v178, v26
    v_dot2c_f32_bf16 v7, v179, v27
    v_dot2c_f32_bf16 v6, v180, v28
    v_dot2c_f32_bf16 v7, v181, v29
    v_dot2c_f32_bf16 v6, v182, v30
    v_dot2c_f32_bf16 v7, v183, v31
    v_dot2c_f32_bf16 v6, v184, v32
    v_dot2c_f32_bf16 v7, v185, v33
    v_dot2c_f32_bf16 v6, v186, v34
    v_dot2c_f32_bf16 v7, v187, v35
    v_dot2c_f32_bf16 v6, v188, v36
    v_dot2c_f32_bf16 v7, v189, v37
    v_dot2c_f32_bf16 v6, v190, v38
    v_dot2c_f32_bf16 v7, v191, v39
    v_dot2c_f32_bf16 v6, v192, v40
    v_dot2c_f32_bf16 v7, v193, v41
    v_dot2c_f32_bf16 v6, v194, v42
    v_dot2c_f32_bf16 v7, v195, v43
    v_dot2c_f32_bf16 v6, v196, v44
    v_dot2c_f32_bf16 v7, v197, v45
    v_dot2c_f32_bf16 v6, v198, v46
    v_dot2c_f32_bf16 v7, v199, v47
    v_dot2c_f32_bf16 v6, v200, v48
    v_dot2c_f32_bf16 v7, v201, v49
    v_dot2c_f32_bf16 v6, v202, v50
    v_dot2c_f32_bf16 v7, v203, v51
    v_dot2c_f32_bf16 v6, v204, v52
    v_dot2c_f32_bf16 v7, v205, v53
    v_dot2c_f32_bf16 v6, v206, v54
    v_dot2c_f32_bf16 v7, v207, v55
    s_nop 3
    v_add_f32 v6, v6, v7
    s_nop 1
    v_add_f32_dpp v6, v6, v6 quad_perm:[1,0,3,2] row_mask:0xf bank_mask:0xf
    s_nop 1
    v_add_f32_dpp v6, v6, v6 quad_perm:[2,3,0,1] row_mask:0xf bank_mask:0xf
    s_nop 1
    v_add_f32_dpp v6, v6, v6 row_half_mirror row_mask:0xf bank_mask:0xf
    v_and_b32 v7, 3, v0
    v_cmp_eq_u32 vcc, 3, v7
    s_nop 1
    v_cndmask_b32 v8, v8, v6, vcc
    v_cvt_pk_bf16_f32 v6, v8, v8
    v_lshlrev_b32 v6, 16, v6
    v_mul_f32 v6, s96, v6
    v_exp_f32 v6, v6
    v_lshlrev_b32 v7, 5, v7
    v_add_f32 v6, 1.0, v6
    v_rcp_f32 v6, v6
    v_add_u32 v4, v4, v7
    v_cvt_pk_bf16_f32 v6, v6, v6
    v_lshlrev_b32 v8, 16, v6
    v_sub_f32 v9, 1.0, v8
    v_cvt_pk_bf16_f32 v9, v9, v9
    v_lshlrev_b32 v9, 16, v9
    v_and_b32 v7, 4, v0
    v_cmp_ne_u32 vcc, 0, v7
    v_lshl_add_u32 v4, v7, 11, v4
    s_nop 0
    v_cndmask_b32 v8, v8, v9, vcc
    buffer_store_dword v8, v4, s[68:71], s54 offen sc1
    global_load_dword v219, v218, s[48:49] sc1
    s_add_u32 m0, s52, 36864
    s_add_u32 s81, s26, 0
    buffer_load_dwordx4 v208, s[60:63], s81 offen offset:0 lds
    buffer_load_dwordx4 v225, s[60:63], s81 offen offset:1024 lds
    buffer_load_dwordx4 v226, s[60:63], s81 offen offset:2048 lds
    s_cmp_lg_u32 s50, 0
    s_cbranch_scc1 L_wskip_prepb0
    s_call_b64 s[100:101], L_stub27
L_wskip_prepb0:
    s_cmp_lg_u32 s50, 1
    s_cbranch_scc1 L_wskip_prepb1
    s_call_b64 s[100:101], L_stub28
L_wskip_prepb1:
    s_cmp_lg_u32 s50, 2
    s_cbranch_scc1 L_wskip_prepb2
    s_call_b64 s[100:101], L_stub29
L_wskip_prepb2:
    s_cmp_lg_u32 s50, 3
    s_cbranch_scc1 L_wskip_prepb3
    s_call_b64 s[100:101], L_stub30
L_wskip_prepb3:
    s_waitcnt vmcnt(3)
    v_cmp_gt_u32 vcc, 1, v219
    s_cbranch_vccnz L_poll19
L_fok19:
    s_add_u32 s80, s85, 0
    buffer_load_dwordx4 a[0:3], v1, s[64:67], s80 offen offset:0 sc1
    buffer_load_dwordx4 a[4:7], v1, s[64:67], s80 offen offset:1024 sc1
    buffer_load_dwordx4 a[8:11], v1, s[64:67], s80 offen offset:2048 sc1
    s_add_u32 s80, s85, 3072
    buffer_load_dwordx4 a[12:15], v1, s[64:67], s80 offen offset:0 sc1
    buffer_load_dwordx4 a[16:19], v1, s[64:67], s80 offen offset:1024 sc1
    buffer_load_dwordx4 a[20:23], v1, s[64:67], s80 offen offset:2048 sc1
    s_add_u32 s80, s85, 6144
    buffer_load_dwordx4 a[24:27], v1, s[64:67], s80 offen offset:0 sc1
    buffer_load_dwordx4 a[28:31], v1, s[64:67], s80 offen offset:1024 sc1
    s_barrier
    ds_read_b64_tr_b16 a[192:193], v210 offset:0
    ds_read_b64_tr_b16 a[194:195], v211 offset:0
    ds_read_b64_tr_b16 a[196:197], v214 offset:0
    ds_read_b64_tr_b16 a[198:199], v215 offset:0
    ds_read_b64_tr_b16 a[200:201], v212 offset:0
    ds_read_b64_tr_b16 a[202:203], v213 offset:0
    ds_read_b64_tr_b16 a[204:205], v216 offset:0
    ds_read_b64_tr_b16 a[206:207], v217 offset:0
    ds_read_b64_tr_b16 a[208:209], v210 offset:1024
    ds_read_b64_tr_b16 a[210:211], v211 offset:1024
    ds_read_b64_tr_b16 a[212:213], v214 offset:1024
    ds_read_b64_tr_b16 a[214:215], v215 offset:1024
    ds_read_b64_tr_b16 a[216:217], v212 offset:1024
    ds_read_b64_tr_b16 a[218:219], v213 offset:1024
    ds_read_b64_tr_b16 a[220:221], v216 offset:1024
    ds_read_b64_tr_b16 a[222:223], v217 offset:1024
    ds_read_b64_tr_b16 a[224:225], v210 offset:2048
    ds_read_b64_tr_b16 a[226:227], v211 offset:2048
    ds_read_b64_tr_b16 a[228:229], v214 offset:2048
    ds_read_b64_tr_b16 a[230:231], v215 offset:2048
    s_waitcnt vmcnt(6) lgkmcnt(12)
    v_mfma_f32_16x16x32_bf16 v[40:43], a[192:195], a[0:3], 0
    buffer_load_dwordx4 a[32:35], v1, s[64:67], s80 offen offset:2048 sc1
    v_mfma_f32_16x16x32_bf16 v[44:47], a[192:195], a[4:7], 0
    ds_read_b64_tr_b16 a[232:233], v212 offset:2048
    ds_read_b64_tr_b16 a[234:235], v213 offset:2048
    v_mfma_f32_16x16x32_bf16 v[56:59], a[196:199], a[0:3], 0
    ds_read_b64_tr_b16 a[236:237], v216 offset:2048
    v_mfma_f32_16x16x32_bf16 v[60:63], a[196:199], a[4:7], 0
    ds_read_b64_tr_b16 a[238:239], v217 offset:2048
    v_mfma_f32_16x16x32_bf16 v[48:51], a[200:203], a[0:3], 0
    ds_read_b64_tr_b16 a[192:193], v210 offset:3072
    v_mfma_f32_16x16x32_bf16 v[52:55], a[200:203], a[4:7], 0
    ds_read_b64_tr_b16 a[194:195], v211 offset:3072
    v_mfma_f32_16x16x32_bf16 v[64:67], a[204:207], a[0:3], 0
    ds_read_b64_tr_b16 a[196:197], v214 offset:3072
    v_mfma_f32_16x16x32_bf16 v[68:71], a[204:207], a[4:7], 0
    ds_read_b64_tr_b16 a[198:199], v215 offset:3072
    s_waitcnt vmcnt(5) lgkmcnt(12)
    v_mfma_f32_16x16x32_bf16 v[40:43], a[208:211], a[8:11], v[40:43]
    s_add_u32 s80, s85, 9216
    ds_read_b64_tr_b16 a[200:201], v212 offset:3072
    v_mfma_f32_16x16x32_bf16 v[44:47], a[208:211], a[12:15], v[44:47]
    buffer_load_dwordx4 a[36:39], v1, s[64:67], s80 offen offset:0 sc1
    v_mfma_f32_16x16x32_bf16 v[56:59], a[212:215], a[8:11], v[56:59]
    ds_read_b64_tr_b16 a[202:203], v213 offset:3072
    ds_read_b64_tr_b16 a[204:205], v216 offset:3072
    v_mfma_f32_16x16x32_bf16 v[60:63], a[212:215], a[12:15], v[60:63]
    ds_read_b64_tr_b16 a[206:207], v217 offset:3072
    v_mfma_f32_16x16x32_bf16 v[48:51], a[216:219], a[8:11], v[48:51]
    buffer_load_dwordx4 a[40:43], v1, s[64:67], s80 offen offset:1024 sc1
    v_mfma_f32_16x16x32_bf16 v[52:55], a[216:219], a[12:15], v[52:55]
    ds_read_b64_tr_b16 a[208:209], v210 offset:4096
    ds_read_b64_tr_b16 a[210:211], v211 offset:4096
    v_mfma_f32_16x16x32_bf16 v[64:67], a[220:223], a[8:11], v[64:67]
    ds_read_b64_tr_b16 a[212:213], v214 offset:4096
    v_mfma_f32_16x16x32_bf16 v[68:71], a[220:223], a[12:15], v[68:71]
    ds_read_b64_tr_b16 a[214:215], v215 offset:4096
    s_waitcnt vmcnt(5) lgkmcnt(12)
    v_mfma_f32_16x16x32_bf16 v[40:43], a[224:227], a[16:19], v[40:43]
    ds_read_b64_tr_b16 a[216:217], v212 offset:4096
    v_mfma_f32_16x16x32_bf16 v[44:47], a[224:227], a[20:23], v[44:47]
    ds_read_b64_tr_b16 a[218:219], v213 offset:4096
    v_mfma_f32_16x16x32_bf16 v[56:59], a[228:231], a[16:19], v[56:59]
    ds_read_b64_tr_b16 a[220:221], v216 offset:4096
    v_mfma_f32_16x16x32_bf16 v[60:63], a[228:231], a[20:23], v[60:63]
    ds_read_b64_tr_b16 a[222:223], v217 offset:4096
    v_mfma_f32_16x16x32_bf16 v[48:51], a[232:235], a[16:19], v[48:51]
    buffer_load_dwordx4 a[44:47], v1, s[64:67], s80 offen offset:2048 sc1
    v_mfma_f32_16x16x32_bf16 v[52:55], a[232:235], a[20:23], v[52:55]
    ds_read_b64_tr_b16 a[224:225], v210 offset:5120
    ds_read_b64_tr_b16 a[226:227], v211 offset:5120
    v_mfma_f32_16x16x32_bf16 v[64:67], a[236:239], a[16:19], v[64:67]
    ds_read_b64_tr_b16 a[228:229], v214 offset:5120
    v_mfma_f32_16x16x32_bf16 v[68:71], a[236:239], a[20:23], v[68:71]
    ds_read_b64_tr_b16 a[230:231], v215 offset:5120
    s_waitcnt lgkmcnt(12)
    v_mfma_f32_16x16x32_bf16 v[72:75], a[192:195], a[0:3], 0
    s_add_u32 s80, s85, 12288
    ds_read_b64_tr_b16 a[232:233], v212 offset:5120
    v_mfma_f32_16x16x32_bf16 v[76:79], a[192:195], a[4:7], 0
    buffer_load_dwordx4 a[48:51], v1, s[64:67], s80 offen offset:0 sc1
    v_mfma_f32_16x16x32_bf16 v[88:91], a[196:199], a[0:3], 0
    ds_read_b64_tr_b16 a[234:235], v213 offset:5120
    ds_read_b64_tr_b16 a[236:237], v216 offset:5120
    v_mfma_f32_16x16x32_bf16 v[92:95], a[196:199], a[4:7], 0
    ds_read_b64_tr_b16 a[238:239], v217 offset:5120
    v_mfma_f32_16x16x32_bf16 v[80:83], a[200:203], a[0:3], 0
    ds_read_b64_tr_b16 a[192:193], v210 offset:6144
    v_mfma_f32_16x16x32_bf16 v[84:87], a[200:203], a[4:7], 0
    ds_read_b64_tr_b16 a[194:195], v211 offset:6144
    v_mfma_f32_16x16x32_bf16 v[96:99], a[204:207], a[0:3], 0
    ds_read_b64_tr_b16 a[196:197], v214 offset:6144
    v_mfma_f32_16x16x32_bf16 v[100:103], a[204:207], a[4:7], 0
    ds_read_b64_tr_b16 a[198:199], v215 offset:6144
    s_waitcnt lgkmcnt(12)
    v_mfma_f32_16x16x32_bf16 v[72:75], a[208:211], a[8:11], v[72:75]
    buffer_load_dwordx4 a[52:55], v1, s[64:67], s80 offen offset:1024 sc1
    v_mfma_f32_16x16x32_bf16 v[76:79], a[208:211], a[12:15], v[76:79]
    ds_read_b64_tr_b16 a[200:201], v212 offset:6144
    ds_read_b64_tr_b16 a[202:203], v213 offset:6144
    v_mfma_f32_16x16x32_bf16 v[88:91], a[212:215], a[8:11], v[88:91]
    ds_read_b64_tr_b16 a[204:205], v216 offset:6144
    v_mfma_f32_16x16x32_bf16 v[92:95], a[212:215], a[12:15], v[92:95]
    ds_read_b64_tr_b16 a[206:207], v217 offset:6144
    v_mfma_f32_16x16x32_bf16 v[80:83], a[216:219], a[8:11], v[80:83]
    buffer_load_dwordx4 a[56:59], v1, s[64:67], s80 offen offset:2048 sc1
    v_mfma_f32_16x16x32_bf16 v[84:87], a[216:219], a[12:15], v[84:87]
    ds_read_b64_tr_b16 a[208:209], v210 offset:7168
    ds_read_b64_tr_b16 a[210:211], v211 offset:7168
    v_mfma_f32_16x16x32_bf16 v[96:99], a[220:223], a[8:11], v[96:99]
    ds_read_b64_tr_b16 a[212:213], v214 offset:7168
    v_mfma_f32_16x16x32_bf16 v[100:103], a[220:223], a[12:15], v[100:103]
    ds_read_b64_tr_b16 a[214:215], v215 offset:7168
    s_waitcnt lgkmcnt(12)
    v_mfma_f32_16x16x32_bf16 v[72:75], a[224:227], a[16:19], v[72:75]
    ds_read_b64_tr_b16 a[216:217], v212 offset:7168
    v_mfma_f32_16x16x32_bf16 v[76:79], a[224:227], a[20:23], v[76:79]
    ds_read_b64_tr_b16 a[218:219], v213 offset:7168
    v_mfma_f32_16x16x32_bf16 v[88:91], a[228:231], a[16:19], v[88:91]
    ds_read_b64_tr_b16 a[220:221], v216 offset:7168
    v_mfma_f32_16x16x32_bf16 v[92:95], a[228:231], a[20:23], v[92:95]
    ds_read_b64_tr_b16 a[222:223], v217 offset:7168
    v_mfma_f32_16x16x32_bf16 v[80:83], a[232:235], a[16:19], v[80:83]
    s_add_u32 s80, s85, 15360
    ds_read_b64_tr_b16 a[224:225], v210 offset:8192
    v_mfma_f32_16x16x32_bf16 v[84:87], a[232:235], a[20:23], v[84:87]
    buffer_load_dwordx4 a[60:63], v1, s[64:67], s80 offen offset:0 sc1
    v_mfma_f32_16x16x32_bf16 v[96:99], a[236:239], a[16:19], v[96:99]
    ds_read_b64_tr_b16 a[226:227], v211 offset:8192
    ds_read_b64_tr_b16 a[228:229], v214 offset:8192
    v_mfma_f32_16x16x32_bf16 v[100:103], a[236:239], a[20:23], v[100:103]
    ds_read_b64_tr_b16 a[230:231], v215 offset:8192
    s_waitcnt lgkmcnt(12)
    v_mfma_f32_16x16x32_bf16 v[104:107], a[192:195], a[0:3], 0
    buffer_load_dwordx4 a[64:67], v1, s[64:67], s80 offen offset:1024 sc1
    v_mfma_f32_16x16x32_bf16 v[108:111], a[192:195], a[4:7], 0
    ds_read_b64_tr_b16 a[232:233], v212 offset:8192
    ds_read_b64_tr_b16 a[234:235], v213 offset:8192
    v_mfma_f32_16x16x32_bf16 v[120:123], a[196:199], a[0:3], 0
    ds_read_b64_tr_b16 a[236:237], v216 offset:8192
    v_mfma_f32_16x16x32_bf16 v[124:127], a[196:199], a[4:7], 0
    ds_read_b64_tr_b16 a[238:239], v217 offset:8192
    v_mfma_f32_16x16x32_bf16 v[112:115], a[200:203], a[0:3], 0
    ds_read_b64_tr_b16 a[192:193], v210 offset:9216
    v_mfma_f32_16x16x32_bf16 v[116:119], a[200:203], a[4:7], 0
    ds_read_b64_tr_b16 a[194:195], v211 offset:9216
    v_mfma_f32_16x16x32_bf16 v[128:131], a[204:207], a[0:3], 0
    ds_read_b64_tr_b16 a[196:197], v214 offset:9216
    v_mfma_f32_16x16x32_bf16 v[132:135], a[204:207], a[4:7], 0
    ds_read_b64_tr_b16 a[198:199], v215 offset:9216
    s_waitcnt lgkmcnt(12)
    v_mfma_f32_16x16x32_bf16 v[104:107], a[208:211], a[8:11], v[104:107]
    buffer_load_dwordx4 a[68:71], v1, s[64:67], s80 offen offset:2048 sc1
    v_mfma_f32_16x16x32_bf16 v[108:111], a[208:211], a[12:15], v[108:111]
    ds_read_b64_tr_b16 a[200:201], v212 offset:9216
    ds_read_b64_tr_b16 a[202:203], v213 offset:9216
    v_mfma_f32_16x16x32_bf16 v[120:123], a[212:215], a[8:11], v[120:123]
    ds_read_b64_tr_b16 a[204:205], v216 offset:9216
    v_mfma_f32_16x16x32_bf16 v[124:127], a[212:215], a[12:15], v[124:127]
    ds_read_b64_tr_b16 a[206:207], v217 offset:9216
    v_mfma_f32_16x16x32_bf16 v[112:115], a[216:219], a[8:11], v[112:115]
    s_add_u32 s80, s86, 18432
    ds_read_b64_tr_b16 a[208:209], v210 offset:10240
    v_mfma_f32_16x16x32_bf16 v[116:119], a[216:219], a[12:15], v[116:119]
    buffer_load_dwordx4 a[72:75], v1, s[64:67], s80 offen offset:0 sc1
    v_mfma_f32_16x16x32_bf16 v[128:131], a[220:223], a[8:11], v[128:131]
    ds_read_b64_tr_b16 a[210:211], v211 offset:10240
    ds_read_b64_tr_b16 a[212:213], v214 offset:10240
    v_mfma_f32_16x16x32_bf16 v[132:135], a[220:223], a[12:15], v[132:135]
    ds_read_b64_tr_b16 a[214:215], v215 offset:10240
    s_waitcnt lgkmcnt(12)
    v_mfma_f32_16x16x32_bf16 v[104:107], a[224:227], a[16:19], v[104:107]
    ds_read_b64_tr_b16 a[216:217], v212 offset:10240
    v_mfma_f32_16x16x32_bf16 v[108:111], a[224:227], a[20:23], v[108:111]
    ds_read_b64_tr_b16 a[218:219], v213 offset:10240
    v_mfma_f32_16x16x32_bf16 v[120:123], a[228:231], a[16:19], v[120:123]
    ds_read_b64_tr_b16 a[220:221], v216 offset:10240
    v_mfma_f32_16x16x32_bf16 v[124:127], a[228:231], a[20:23], v[124:127]
    ds_read_b64_tr_b16 a[222:223], v217 offset:10240
    v_mfma_f32_16x16x32_bf16 v[112:115], a[232:235], a[16:19], v[112:115]
    buffer_load_dwordx4 a[76:79], v1, s[64:67], s80 offen offset:1024 sc1
    v_mfma_f32_16x16x32_bf16 v[116:119], a[232:235], a[20:23], v[116:119]
    ds_read_b64_tr_b16 a[224:225], v210 offset:11264
    ds_read_b64_tr_b16 a[226:227], v211 offset:11264
    v_mfma_f32_16x16x32_bf16 v[128:131], a[236:239], a[16:19], v[128:131]
    ds_read_b64_tr_b16 a[228:229], v214 offset:11264
    v_mfma_f32_16x16x32_bf16 v[132:135], a[236:239], a[20:23], v[132:135]
    ds_read_b64_tr_b16 a[230:231], v215 offset:11264
    s_waitcnt vmcnt(12) lgkmcnt(12)
    v_mfma_f32_16x16x32_bf16 v[40:43], a[192:195], a[24:27], v[40:43]
    buffer_load_dwordx4 a[80:83], v1, s[64:67], s80 offen offset:2048 sc1
    v_mfma_f32_16x16x32_bf16 v[44:47], a[192:195], a[28:31], v[44:47]
    ds_read_b64_tr_b16 a[232:233], v212 offset:11264
    ds_read_b64_tr_b16 a[234:235], v213 offset:11264
    v_mfma_f32_16x16x32_bf16 v[56:59], a[196:199], a[24:27], v[56:59]
    ds_read_b64_tr_b16 a[236:237], v216 offset:11264
    v_mfma_f32_16x16x32_bf16 v[60:63], a[196:199], a[28:31], v[60:63]
    ds_read_b64_tr_b16 a[238:239], v217 offset:11264
    v_mfma_f32_16x16x32_bf16 v[48:51], a[200:203], a[24:27], v[48:51]
    s_barrier
    ds_read_b64_tr_b16 a[192:193], v210 offset:12288
    v_mfma_f32_16x16x32_bf16 v[52:55], a[200:203], a[28:31], v[52:55]
    ds_read_b64_tr_b16 a[194:195], v211 offset:12288
    v_mfma_f32_16x16x32_bf16 v[64:67], a[204:207], a[24:27], v[64:67]
    ds_read_b64_tr_b16 a[196:197], v214 offset:12288
    v_mfma_f32_16x16x32_bf16 v[68:71], a[204:207], a[28:31], v[68:71]
    ds_read_b64_tr_b16 a[198:199], v215 offset:12288
    s_waitcnt vmcnt(11) lgkmcnt(12)
    v_mfma_f32_16x16x32_bf16 v[40:43], a[208:211], a[32:35], v[40:43]
    s_add_u32 s80, s86, 21504
    ds_read_b64_tr_b16 a[200:201], v212 offset:12288
    v_mfma_f32_16x16x32_bf16 v[44:47], a[208:211], a[36:39], v[44:47]
    buffer_load_dwordx4 a[84:87], v1, s[64:67], s80 offen offset:0 sc1
    v_mfma_f32_16x16x32_bf16 v[56:59], a[212:215], a[32:35], v[56:59]
    ds_read_b64_tr_b16 a[202:203], v213 offset:12288
    ds_read_b64_tr_b16 a[204:205], v216 offset:12288
    v_mfma_f32_16x16x32_bf16 v[60:63], a[212:215], a[36:39], v[60:63]
    ds_read_b64_tr_b16 a[206:207], v217 offset:12288
    v_mfma_f32_16x16x32_bf16 v[48:51], a[216:219], a[32:35], v[48:51]
    buffer_load_dwordx4 a[88:91], v1, s[64:67], s80 offen offset:1024 sc1
    v_mfma_f32_16x16x32_bf16 v[52:55], a[216:219], a[36:39], v[52:55]
    ds_read_b64_tr_b16 a[208:209], v210 offset:13312
    ds_read_b64_tr_b16 a[210:211], v211 offset:13312
    v_mfma_f32_16x16x32_bf16 v[64:67], a[220:223], a[32:35], v[64:67]
    ds_read_b64_tr_b16 a[212:213], v214 offset:13312
    v_mfma_f32_16x16x32_bf16 v[68:71], a[220:223], a[36:39], v[68:71]
    ds_read_b64_tr_b16 a[214:215], v215 offset:13312
    s_waitcnt vmcnt(11) lgkmcnt(12)
    v_mfma_f32_16x16x32_bf16 v[40:43], a[224:227], a[40:43], v[40:43]
    ds_read_b64_tr_b16 a[216:217], v212 offset:13312
    v_mfma_f32_16x16x32_bf16 v[44:47], a[224:227], a[44:47], v[44:47]
    ds_read_b64_tr_b16 a[218:219], v213 offset:13312
    v_mfma_f32_16x16x32_bf16 v[56:59], a[228:231], a[40:43], v[56:59]
    ds_read_b64_tr_b16 a[220:221], v216 offset:13312
    v_mfma_f32_16x16x32_bf16 v[60:63], a[228:231], a[44:47], v[60:63]
    ds_read_b64_tr_b16 a[222:223], v217 offset:13312
    v_mfma_f32_16x16x32_bf16 v[48:51], a[232:235], a[40:43], v[48:51]
    buffer_load_dwordx4 a[92:95], v1, s[64:67], s80 offen offset:2048 sc1
    v_mfma_f32_16x16x32_bf16 v[52:55], a[232:235], a[44:47], v[52:55]
    ds_read_b64_tr_b16 a[224:225], v210 offset:14336
    ds_read_b64_tr_b16 a[226:227], v211 offset:14336
    v_mfma_f32_16x16x32_bf16 v[64:67], a[236:239], a[40:43], v[64:67]
    ds_read_b64_tr_b16 a[228:229], v214 offset:14336
    v_mfma_f32_16x16x32_bf16 v[68:71], a[236:239], a[44:47], v[68:71]
    ds_read_b64_tr_b16 a[230:231], v215 offset:14336
    s_waitcnt lgkmcnt(12)
    v_mfma_f32_16x16x32_bf16 v[72:75], a[192:195], a[24:27], v[72:75]
    s_add_u32 s80, s86, 24576
    ds_read_b64_tr_b16 a[232:233], v212 offset:14336
    v_mfma_f32_16x16x32_bf16 v[76:79], a[192:195], a[28:31], v[76:79]
    buffer_load_dwordx4 a[96:99], v1, s[64:67], s80 offen offset:0 sc1
    v_mfma_f32_16x16x32_bf16 v[88:91], a[196:199], a[24:27], v[88:91]
    ds_read_b64_tr_b16 a[234:235], v213 offset:14336
    ds_read_b64_tr_b16 a[236:237], v216 offset:14336
    v_mfma_f32_16x16x32_bf16 v[92:95], a[196:199], a[28:31], v[92:95]
    ds_read_b64_tr_b16 a[238:239], v217 offset:14336
    v_mfma_f32_16x16x32_bf16 v[80:83], a[200:203], a[24:27], v[80:83]
    ds_read_b64_tr_b16 a[192:193], v210 offset:15360
    v_mfma_f32_16x16x32_bf16 v[84:87], a[200:203], a[28:31], v[84:87]
    ds_read_b64_tr_b16 a[194:195], v211 offset:15360
    v_mfma_f32_16x16x32_bf16 v[96:99], a[204:207], a[24:27], v[96:99]
    ds_read_b64_tr_b16 a[196:197], v214 offset:15360
    v_mfma_f32_16x16x32_bf16 v[100:103], a[204:207], a[28:31], v[100:103]
    ds_read_b64_tr_b16 a[198:199], v215 offset:15360
    s_waitcnt lgkmcnt(12)
    v_mfma_f32_16x16x32_bf16 v[72:75], a[208:211], a[32:35], v[72:75]
    buffer_load_dwordx4 a[100:103], v1, s[64:67], s80 offen offset:1024 sc1
    v_mfma_f32_16x16x32_bf16 v[76:79], a[208:211], a[36:39], v[76:79]
    ds_read_b64_tr_b16 a[200:201], v212 offset:15360
    ds_read_b64_tr_b16 a[202:203], v213 offset:15360
    v_mfma_f32_16x16x32_bf16 v[88:91], a[212:215], a[32:35], v[88:91]
    ds_read_b64_tr_b16 a[204:205], v216 offset:15360
    v_mfma_f32_16x16x32_bf16 v[92:95], a[212:215], a[36:39], v[92:95]
    ds_read_b64_tr_b16 a[206:207], v217 offset:15360
    v_mfma_f32_16x16x32_bf16 v[80:83], a[216:219], a[32:35], v[80:83]
    buffer_load_dwordx4 a[104:107], v1, s[64:67], s80 offen offset:2048 sc1
    v_mfma_f32_16x16x32_bf16 v[84:87], a[216:219], a[36:39], v[84:87]
    ds_read_b64_tr_b16 a[208:209], v210 offset:16384
    ds_read_b64_tr_b16 a[210:211], v211 offset:16384
    v_mfma_f32_16x16x32_bf16 v[96:99], a[220:223], a[32:35], v[96:99]
    ds_read_b64_tr_b16 a[212:213], v214 offset:16384
    v_mfma_f32_16x16x32_bf16 v[100:103], a[220:223], a[36:39], v[100:103]
    ds_read_b64_tr_b16 a[214:215], v215 offset:16384
    s_waitcnt lgkmcnt(12)
    v_mfma_f32_16x16x32_bf16 v[72:75], a[224:227], a[40:43], v[72:75]
    ds_read_b64_tr_b16 a[216:217], v212 offset:16384
    v_mfma_f32_16x16x32_bf16 v[76:79], a[224:227], a[44:47], v[76:79]
    ds_read_b64_tr_b16 a[218:219], v213 offset:16384
    v_mfma_f32_16x16x32_bf16 v[88:91], a[228:231], a[40:43], v[88:91]
    ds_read_b64_tr_b16 a[220:221], v216 offset:16384
    v_mfma_f32_16x16x32_bf16 v[92:95], a[228:231], a[44:47], v[92:95]
    ds_read_b64_tr_b16 a[222:223], v217 offset:16384
    v_mfma_f32_16x16x32_bf16 v[80:83], a[232:235], a[40:43], v[80:83]
    s_add_u32 s80, s86, 27648
    ds_read_b64_tr_b16 a[224:225], v210 offset:17408
    v_mfma_f32_16x16x32_bf16 v[84:87], a[232:235], a[44:47], v[84:87]
    buffer_load_dwordx4 a[108:111], v1, s[64:67], s80 offen offset:0 sc1
    v_mfma_f32_16x16x32_bf16 v[96:99], a[236:239], a[40:43], v[96:99]
    ds_read_b64_tr_b16 a[226:227], v211 offset:17408
    ds_read_b64_tr_b16 a[228:229], v214 offset:17408
    v_mfma_f32_16x16x32_bf16 v[100:103], a[236:239], a[44:47], v[100:103]
    ds_read_b64_tr_b16 a[230:231], v215 offset:17408
    s_waitcnt lgkmcnt(12)
    v_mfma_f32_16x16x32_bf16 v[104:107], a[192:195], a[24:27], v[104:107]
    s_barrier
    v_lshlrev_b32 v6, 7, v0
    v_add_u32 v6, s97, v6
    v_mov_b32 v7, 3
    s_mov_b64 exec, 3
    global_store_dword v6, v7, s[48:49] offset:1024 sc1
    s_mov_b64 exec, -1
    v_mfma_f32_16x16x32_bf16 v[108:111], a[192:195], a[28:31], v[108:111]
    buffer_load_dwordx4 a[112:115], v1, s[64:67], s80 offen offset:1024 sc1
    v_mfma_f32_16x16x32_bf16 v[120:123], a[196:199], a[24:27], v[120:123]
    ds_read_b64_tr_b16 a[232:233], v212 offset:17408
    ds_read_b64_tr_b16 a[234:235], v213 offset:17408
    v_mfma_f32_16x16x32_bf16 v[124:127], a[196:199], a[28:31], v[124:127]
    ds_read_b64_tr_b16 a[236:237], v216 offset:17408
    ds_read_b64_tr_b16 a[238:239], v217 offset:17408
    v_mfma_f32_16x16x32_bf16 v[112:115], a[200:203], a[24:27], v[112:115]
    ds_read_b64_tr_b16 a[192:193], v210 offset:18432
    v_mfma_f32_16x16x32_bf16 v[116:119], a[200:203], a[28:31], v[116:119]
    ds_read_b64_tr_b16 a[194:195], v211 offset:18432
    v_mfma_f32_16x16x32_bf16 v[128:131], a[204:207], a[24:27], v[128:131]
    ds_read_b64_tr_b16 a[196:197], v214 offset:18432
    v_mfma_f32_16x16x32_bf16 v[132:135], a[204:207], a[28:31], v[132:135]
    ds_read_b64_tr_b16 a[198:199], v215 offset:18432
    s_waitcnt lgkmcnt(12)
    v_mfma_f32_16x16x32_bf16 v[104:107], a[208:211], a[32:35], v[104:107]
    buffer_load_dwordx4 a[116:119], v1, s[64:67], s80 offen offset:2048 sc1
    v_mfma_f32_16x16x32_bf16 v[108:111], a[208:211], a[36:39], v[108:111]
    ds_read_b64_tr_b16 a[200:201], v212 offset:18432
    ds_read_b64_tr_b16 a[202:203], v213 offset:18432
    v_mfma_f32_16x16x32_bf16 v[120:123], a[212:215], a[32:35], v[120:123]
    ds_read_b64_tr_b16 a[204:205], v216 offset:18432
    v_mfma_f32_16x16x32_bf16 v[124:127], a[212:215], a[36:39], v[124:127]
    ds_read_b64_tr_b16 a[206:207], v217 offset:18432
    v_mfma_f32_16x16x32_bf16 v[112:115], a[216:219], a[32:35], v[112:115]
    s_add_u32 s80, s86, 30720
    ds_read_b64_tr_b16 a[208:209], v210 offset:19456
    v_mfma_f32_16x16x32_bf16 v[116:119], a[216:219], a[36:39], v[116:119]
    buffer_load_dwordx4 a[120:123], v1, s[64:67], s80 offen offset:0 sc1
    v_mfma_f32_16x16x32_bf16 v[128:131], a[220:223], a[32:35], v[128:131]
    ds_read_b64_tr_b16 a[210:211], v211 offset:19456
    ds_read_b64_tr_b16 a[212:213], v214 offset:19456
    v_mfma_f32_16x16x32_bf16 v[132:135], a[220:223], a[36:39], v[132:135]
    ds_read_b64_tr_b16 a[214:215], v215 offset:19456
    s_waitcnt lgkmcnt(12)
    v_mfma_f32_16x16x32_bf16 v[104:107], a[224:227], a[40:43], v[104:107]
    ds_read_b64_tr_b16 a[216:217], v212 offset:19456
    v_mfma_f32_16x16x32_bf16 v[108:111], a[224:227], a[44:47], v[108:111]
    ds_read_b64_tr_b16 a[218:219], v213 offset:19456
    v_mfma_f32_16x16x32_bf16 v[120:123], a[228:231], a[40:43], v[120:123]
    ds_read_b64_tr_b16 a[220:221], v216 offset:19456
    v_mfma_f32_16x16x32_bf16 v[124:127], a[228:231], a[44:47], v[124:127]
    ds_read_b64_tr_b16 a[222:223], v217 offset:19456
    v_mfma_f32_16x16x32_bf16 v[112:115], a[232:235], a[40:43], v[112:115]
    buffer_load_dwordx4 a[124:127], v1, s[64:67], s80 offen offset:1024 sc1
    v_mfma_f32_16x16x32_bf16 v[116:119], a[232:235], a[44:47], v[116:119]
    ds_read_b64_tr_b16 a[224:225], v210 offset:20480
    ds_read_b64_tr_b16 a[226:227], v211 offset:20480
    v_mfma_f32_16x16x32_bf16 v[128:131], a[236:239], a[40:43], v[128:131]
    s_branch L_sskip25
L_stub25:
    s_setpc_b64 s[100:101]
L_sskip25:
    ds_read_b64_tr_b16 a[228:229], v214 offset:20480
    v_mfma_f32_16x16x32_bf16 v[132:135], a[236:239], a[44:47], v[132:135]
    ds_read_b64_tr_b16 a[230:231], v215 offset:20480
    s_waitcnt vmcnt(19) lgkmcnt(12)
    v_mfma_f32_16x16x32_bf16 v[40:43], a[192:195], a[48:51], v[40:43]
    s_add_u32 m0, s52, 0
    ds_read_b64_tr_b16 a[232:233], v212 offset:20480
    v_mfma_f32_16x16x32_bf16 v[44:47], a[192:195], a[52:55], v[44:47]
    s_add_u32 s81, s26, 128
    ds_read_b64_tr_b16 a[234:235], v213 offset:20480
    v_mfma_f32_16x16x32_bf16 v[56:59], a[196:199], a[48:51], v[56:59]
    buffer_load_dwordx4 v208, s[60:63], s81 offen offset:0 lds
    v_mfma_f32_16x16x32_bf16 v[60:63], a[196:199], a[52:55], v[60:63]
    ds_read_b64_tr_b16 a[236:237], v216 offset:20480
    ds_read_b64_tr_b16 a[238:239], v217 offset:20480
    v_mfma_f32_16x16x32_bf16 v[48:51], a[200:203], a[48:51], v[48:51]
    ds_read_b64_tr_b16 a[192:193], v210 offset:21504
    v_mfma_f32_16x16x32_bf16 v[52:55], a[200:203], a[52:55], v[52:55]
    ds_read_b64_tr_b16 a[194:195], v211 offset:21504
    v_mfma_f32_16x16x32_bf16 v[64:67], a[204:207], a[48:51], v[64:67]
    ds_read_b64_tr_b16 a[196:197], v214 offset:21504
    v_mfma_f32_16x16x32_bf16 v[68:71], a[204:207], a[52:55], v[68:71]
    ds_read_b64_tr_b16 a[198:199], v215 offset:21504
    s_waitcnt vmcnt(18) lgkmcnt(12)
    v_mfma_f32_16x16x32_bf16 v[40:43], a[208:211], a[56:59], v[40:43]
    buffer_load_dwordx4 v225, s[60:63], s81 offen offset:1024 lds
    v_mfma_f32_16x16x32_bf16 v[44:47], a[208:211], a[60:63], v[44:47]
    ds_read_b64_tr_b16 a[200:201], v212 offset:21504
    ds_read_b64_tr_b16 a[202:203], v213 offset:21504
    v_mfma_f32_16x16x32_bf16 v[56:59], a[212:215], a[56:59], v[56:59]
    ds_read_b64_tr_b16 a[204:205], v216 offset:21504
    v_mfma_f32_16x16x32_bf16 v[60:63], a[212:215], a[60:63], v[60:63]
    ds_read_b64_tr_b16 a[206:207], v217 offset:21504
    v_mfma_f32_16x16x32_bf16 v[48:51], a[216:219], a[56:59], v[48:51]
    buffer_load_dwordx4 v226, s[60:63], s81 offen offset:2048 lds
    v_mfma_f32_16x16x32_bf16 v[52:55], a[216:219], a[60:63], v[52:55]
    ds_read_b64_tr_b16 a[208:209], v210 offset:22528
    ds_read_b64_tr_b16 a[210:211], v211 offset:22528
    v_mfma_f32_16x16x32_bf16 v[64:67], a[220:223], a[56:59], v[64:67]
    ds_read_b64_tr_b16 a[212:213], v214 offset:22528
    v_mfma_f32_16x16x32_bf16 v[68:71], a[220:223], a[60:63], v[68:71]
    ds_read_b64_tr_b16 a[214:215], v215 offset:22528
    s_waitcnt vmcnt(18) lgkmcnt(12)
    v_mfma_f32_16x16x32_bf16 v[40:43], a[224:227], a[64:67], v[40:43]
    ds_read_b64_tr_b16 a[216:217], v212 offset:22528
    v_mfma_f32_16x16x32_bf16 v[44:47], a[224:227], a[68:71], v[44:47]
    ds_read_b64_tr_b16 a[218:219], v213 offset:22528
    v_mfma_f32_16x16x32_bf16 v[56:59], a[228:231], a[64:67], v[56:59]
    ds_read_b64_tr_b16 a[220:221], v216 offset:22528
    v_mfma_f32_16x16x32_bf16 v[60:63], a[228:231], a[68:71], v[60:63]
    ds_read_b64_tr_b16 a[222:223], v217 offset:22528
    v_mfma_f32_16x16x32_bf16 v[48:51], a[232:235], a[64:67], v[48:51]
    buffer_load_dwordx4 a[128:131], v1, s[64:67], s80 offen offset:2048 sc1
    v_mfma_f32_16x16x32_bf16 v[52:55], a[232:235], a[68:71], v[52:55]
    ds_read_b64_tr_b16 a[224:225], v210 offset:23552
    ds_read_b64_tr_b16 a[226:227], v211 offset:23552
    v_mfma_f32_16x16x32_bf16 v[64:67], a[236:239], a[64:67], v[64:67]
    ds_read_b64_tr_b16 a[228:229], v214 offset:23552
    v_mfma_f32_16x16x32_bf16 v[68:71], a[236:239], a[68:71], v[68:71]
    ds_read_b64_tr_b16 a[230:231], v215 offset:23552
    s_waitcnt lgkmcnt(12)
    v_mfma_f32_16x16x32_bf16 v[72:75], a[192:195], a[48:51], v[72:75]
    s_add_u32 s80, s86, 33792
    ds_read_b64_tr_b16 a[232:233], v212 offset:23552
    v_mfma_f32_16x16x32_bf16 v[76:79], a[192:195], a[52:55], v[76:79]
    buffer_load_dwordx4 a[132:135], v1, s[64:67], s80 offen offset:0 sc1
    v_mfma_f32_16x16x32_bf16 v[88:91], a[196:199], a[48:51], v[88:91]
    ds_read_b64_tr_b16 a[234:235], v213 offset:23552
    ds_read_b64_tr_b16 a[236:237], v216 offset:23552
    v_mfma_f32_16x16x32_bf16 v[92:95], a[196:199], a[52:55], v[92:95]
    ds_read_b64_tr_b16 a[238:239], v217 offset:23552
    v_mfma_f32_16x16x32_bf16 v[80:83], a[200:203], a[48:51], v[80:83]
    s_barrier
    ds_read_b64_tr_b16 a[192:193], v210 offset:24576
    v_mfma_f32_16x16x32_bf16 v[84:87], a[200:203], a[52:55], v[84:87]
    ds_read_b64_tr_b16 a[194:195], v211 offset:24576
    v_mfma_f32_16x16x32_bf16 v[96:99], a[204:207], a[48:51], v[96:99]
    ds_read_b64_tr_b16 a[196:197], v214 offset:24576
    v_mfma_f32_16x16x32_bf16 v[100:103], a[204:207], a[52:55], v[100:103]
    ds_read_b64_tr_b16 a[198:199], v215 offset:24576
    s_waitcnt lgkmcnt(12)
    v_mfma_f32_16x16x32_bf16 v[72:75], a[208:211], a[56:59], v[72:75]
    buffer_load_dwordx4 a[136:139], v1, s[64:67], s80 offen offset:1024 sc1
    v_mfma_f32_16x16x32_bf16 v[76:79], a[208:211], a[60:63], v[76:79]
    ds_read_b64_tr_b16 a[200:201], v212 offset:24576
    ds_read_b64_tr_b16 a[202:203], v213 offset:24576
    v_mfma_f32_16x16x32_bf16 v[88:91], a[212:215], a[56:59], v[88:91]
    ds_read_b64_tr_b16 a[204:205], v216 offset:24576
    v_mfma_f32_16x16x32_bf16 v[92:95], a[212:215], a[60:63], v[92:95]
    ds_read_b64_tr_b16 a[206:207], v217 offset:24576
    v_mfma_f32_16x16x32_bf16 v[80:83], a[216:219], a[56:59], v[80:83]
    buffer_load_dwordx4 a[140:143], v1, s[64:67], s80 offen offset:2048 sc1
    v_mfma_f32_16x16x32_bf16 v[84:87], a[216:219], a[60:63], v[84:87]
    ds_read_b64_tr_b16 a[208:209], v210 offset:25600
    ds_read_b64_tr_b16 a[210:211], v211 offset:25600
    v_mfma_f32_16x16x32_bf16 v[96:99], a[220:223], a[56:59], v[96:99]
    ds_read_b64_tr_b16 a[212:213], v214 offset:25600
    v_mfma_f32_16x16x32_bf16 v[100:103], a[220:223], a[60:63], v[100:103]
    ds_read_b64_tr_b16 a[214:215], v215 offset:25600
    s_waitcnt lgkmcnt(12)
    v_mfma_f32_16x16x32_bf16 v[72:75], a[224:227], a[64:67], v[72:75]
    ds_read_b64_tr_b16 a[216:217], v212 offset:25600
    v_mfma_f32_16x16x32_bf16 v[76:79], a[224:227], a[68:71], v[76:79]
    ds_read_b64_tr_b16 a[218:219], v213 offset:25600
    v_mfma_f32_16x16x32_bf16 v[88:91], a[228:231], a[64:67], v[88:91]
    ds_read_b64_tr_b16 a[220:221], v216 offset:25600
    v_mfma_f32_16x16x32_bf16 v[92:95], a[228:231], a[68:71], v[92:95]
    ds_read_b64_tr_b16 a[222:223], v217 offset:25600
    v_mfma_f32_16x16x32_bf16 v[80:83], a[232:235], a[64:67], v[80:83]
    s_add_u32 m0, s52, 3072
    ds_read_b64_tr_b16 a[224:225], v210 offset:26624
    v_mfma_f32_16x16x32_bf16 v[84:87], a[232:235], a[68:71], v[84:87]
    s_add_u32 s81, s26, 256
    ds_read_b64_tr_b16 a[226:227], v211 offset:26624
    v_mfma_f32_16x16x32_bf16 v[96:99], a[236:239], a[64:67], v[96:99]
    ds_read_b64_tr_b16 a[228:229], v214 offset:26624
    v_mfma_f32_16x16x32_bf16 v[100:103], a[236:239], a[68:71], v[100:103]
    ds_read_b64_tr_b16 a[230:231], v215 offset:26624
    s_waitcnt lgkmcnt(12)
    v_mfma_f32_16x16x32_bf16 v[104:107], a[192:195], a[48:51], v[104:107]
    buffer_load_dwordx4 v208, s[60:63], s81 offen offset:0 lds
    v_mfma_f32_16x16x32_bf16 v[108:111], a[192:195], a[52:55], v[108:111]
    ds_read_b64_tr_b16 a[232:233], v212 offset:26624
    ds_read_b64_tr_b16 a[234:235], v213 offset:26624
    v_mfma_f32_16x16x32_bf16 v[120:123], a[196:199], a[48:51], v[120:123]
    ds_read_b64_tr_b16 a[236:237], v216 offset:26624
    v_mfma_f32_16x16x32_bf16 v[124:127], a[196:199], a[52:55], v[124:127]
    ds_read_b64_tr_b16 a[238:239], v217 offset:26624
    v_mfma_f32_16x16x32_bf16 v[112:115], a[200:203], a[48:51], v[112:115]
    buffer_load_dwordx4 v225, s[60:63], s81 offen offset:1024 lds
    v_mfma_f32_16x16x32_bf16 v[116:119], a[200:203], a[52:55], v[116:119]
    ds_read_b64_tr_b16 a[192:193], v210 offset:27648
    ds_read_b64_tr_b16 a[194:195], v211 offset:27648
    v_mfma_f32_16x16x32_bf16 v[128:131], a[204:207], a[48:51], v[128:131]
    ds_read_b64_tr_b16 a[196:197], v214 offset:27648
    v_mfma_f32_16x16x32_bf16 v[132:135], a[204:207], a[52:55], v[132:135]
    ds_read_b64_tr_b16 a[198:199], v215 offset:27648
    s_waitcnt lgkmcnt(12)
    v_mfma_f32_16x16x32_bf16 v[104:107], a[208:211], a[56:59], v[104:107]
    buffer_load_dwordx4 v226, s[60:63], s81 offen offset:2048 lds
    v_mfma_f32_16x16x32_bf16 v[108:111], a[208:211], a[60:63], v[108:111]
    ds_read_b64_tr_b16 a[200:201], v212 offset:27648
    ds_read_b64_tr_b16 a[202:203], v213 offset:27648
    v_mfma_f32_16x16x32_bf16 v[120:123], a[212:215], a[56:59], v[120:123]
    ds_read_b64_tr_b16 a[204:205], v216 offset:27648
    v_mfma_f32_16x16x32_bf16 v[124:127], a[212:215], a[60:63], v[124:127]
    ds_read_b64_tr_b16 a[206:207], v217 offset:27648
    v_mfma_f32_16x16x32_bf16 v[112:115], a[216:219], a[56:59], v[112:115]
    ds_read_b64_tr_b16 a[208:209], v210 offset:28672
    v_mfma_f32_16x16x32_bf16 v[116:119], a[216:219], a[60:63], v[116:119]
    ds_read_b64_tr_b16 a[210:211], v211 offset:28672
    v_mfma_f32_16x16x32_bf16 v[128:131], a[220:223], a[56:59], v[128:131]
    ds_read_b64_tr_b16 a[212:213], v214 offset:28672
    v_mfma_f32_16x16x32_bf16 v[132:135], a[220:223], a[60:63], v[132:135]
    ds_read_b64_tr_b16 a[214:215], v215 offset:28672
    s_waitcnt lgkmcnt(12)
    v_mfma_f32_16x16x32_bf16 v[104:107], a[224:227], a[64:67], v[104:107]
    s_add_u32 m0, s52, 6144
    ds_read_b64_tr_b16 a[216:217], v212 offset:28672
    v_mfma_f32_16x16x32_bf16 v[108:111], a[224:227], a[68:71], v[108:111]
    s_add_u32 s81, s27, 0
    ds_read_b64_tr_b16 a[218:219], v213 offset:28672
    v_mfma_f32_16x16x32_bf16 v[120:123], a[228:231], a[64:67], v[120:123]
    buffer_load_dwordx4 v208, s[60:63], s81 offen offset:0 lds
    v_mfma_f32_16x16x32_bf16 v[124:127], a[228:231], a[68:71], v[124:127]
    ds_read_b64_tr_b16 a[220:221], v216 offset:28672
    ds_read_b64_tr_b16 a[222:223], v217 offset:28672
    v_mfma_f32_16x16x32_bf16 v[112:115], a[232:235], a[64:67], v[112:115]
    ds_read_b64_tr_b16 a[224:225], v210 offset:29696
    v_mfma_f32_16x16x32_bf16 v[116:119], a[232:235], a[68:71], v[116:119]
    ds_read_b64_tr_b16 a[226:227], v211 offset:29696
    v_mfma_f32_16x16x32_bf16 v[128:131], a[236:239], a[64:67], v[128:131]
    ds_read_b64_tr_b16 a[228:229], v214 offset:29696
    v_mfma_f32_16x16x32_bf16 v[132:135], a[236:239], a[68:71], v[132:135]
    ds_read_b64_tr_b16 a[230:231], v215 offset:29696
    s_waitcnt vmcnt(24) lgkmcnt(12)
    v_mfma_f32_16x16x32_bf16 v[40:43], a[192:195], a[72:75], v[40:43]
    buffer_load_dwordx4 v225, s[60:63], s81 offen offset:1024 lds
    v_mfma_f32_16x16x32_bf16 v[44:47], a[192:195], a[76:79], v[44:47]
    ds_read_b64_tr_b16 a[232:233], v212 offset:29696
    ds_read_b64_tr_b16 a[234:235], v213 offset:29696
    v_mfma_f32_16x16x32_bf16 v[56:59], a[196:199], a[72:75], v[56:59]
    ds_read_b64_tr_b16 a[236:237], v216 offset:29696
    v_mfma_f32_16x16x32_bf16 v[60:63], a[196:199], a[76:79], v[60:63]
    ds_read_b64_tr_b16 a[238:239], v217 offset:29696
    v_mfma_f32_16x16x32_bf16 v[48:51], a[200:203], a[72:75], v[48:51]
    buffer_load_dwordx4 v226, s[60:63], s81 offen offset:2048 lds
    v_mfma_f32_16x16x32_bf16 v[52:55], a[200:203], a[76:79], v[52:55]
    ds_read_b64_tr_b16 a[192:193], v210 offset:30720
    ds_read_b64_tr_b16 a[194:195], v211 offset:30720
    v_mfma_f32_16x16x32_bf16 v[64:67], a[204:207], a[72:75], v[64:67]
    ds_read_b64_tr_b16 a[196:197], v214 offset:30720
    v_mfma_f32_16x16x32_bf16 v[68:71], a[204:207], a[76:79], v[68:71]
    ds_read_b64_tr_b16 a[198:199], v215 offset:30720
    s_waitcnt vmcnt(24) lgkmcnt(12)
    v_mfma_f32_16x16x32_bf16 v[40:43], a[208:211], a[80:83], v[40:43]
    ds_read_b64_tr_b16 a[200:201], v212 offset:30720
    v_mfma_f32_16x16x32_bf16 v[44:47], a[208:211], a[84:87], v[44:47]
    ds_read_b64_tr_b16 a[202:203], v213 offset:30720
    v_mfma_f32_16x16x32_bf16 v[56:59], a[212:215], a[80:83], v[56:59]
    ds_read_b64_tr_b16 a[204:205], v216 offset:30720
    v_mfma_f32_16x16x32_bf16 v[60:63], a[212:215], a[84:87], v[60:63]
    ds_read_b64_tr_b16 a[206:207], v217 offset:30720
    v_mfma_f32_16x16x32_bf16 v[48:51], a[216:219], a[80:83], v[48:51]
    s_add_u32 m0, s52, 9216
    ds_read_b64_tr_b16 a[208:209], v210 offset:31744
    v_mfma_f32_16x16x32_bf16 v[52:55], a[216:219], a[84:87], v[52:55]
    s_add_u32 s81, s27, 128
    ds_read_b64_tr_b16 a[210:211], v211 offset:31744
    v_mfma_f32_16x16x32_bf16 v[64:67], a[220:223], a[80:83], v[64:67]
    ds_read_b64_tr_b16 a[212:213], v214 offset:31744
    v_mfma_f32_16x16x32_bf16 v[68:71], a[220:223], a[84:87], v[68:71]
    ds_read_b64_tr_b16 a[214:215], v215 offset:31744
    s_waitcnt vmcnt(22) lgkmcnt(12)
    v_mfma_f32_16x16x32_bf16 v[40:43], a[224:227], a[88:91], v[40:43]
    buffer_load_dwordx4 v208, s[60:63], s81 offen offset:0 lds
    v_mfma_f32_16x16x32_bf16 v[44:47], a[224:227], a[92:95], v[44:47]
    ds_read_b64_tr_b16 a[216:217], v212 offset:31744
    ds_read_b64_tr_b16 a[218:219], v213 offset:31744
    v_mfma_f32_16x16x32_bf16 v[56:59], a[228:231], a[88:91], v[56:59]
    ds_read_b64_tr_b16 a[220:221], v216 offset:31744
    v_mfma_f32_16x16x32_bf16 v[60:63], a[228:231], a[92:95], v[60:63]
    ds_read_b64_tr_b16 a[222:223], v217 offset:31744
    v_mfma_f32_16x16x32_bf16 v[48:51], a[232:235], a[88:91], v[48:51]
    buffer_load_dwordx4 v225, s[60:63], s81 offen offset:1024 lds
    v_mfma_f32_16x16x32_bf16 v[52:55], a[232:235], a[92:95], v[52:55]
    ds_read_b64_tr_b16 a[224:225], v210 offset:32768
    ds_read_b64_tr_b16 a[226:227], v211 offset:32768
    v_mfma_f32_16x16x32_bf16 v[64:67], a[236:239], a[88:91], v[64:67]
    ds_read_b64_tr_b16 a[228:229], v214 offset:32768
    v_mfma_f32_16x16x32_bf16 v[68:71], a[236:239], a[92:95], v[68:71]
    ds_read_b64_tr_b16 a[230:231], v215 offset:32768
    s_waitcnt lgkmcnt(12)
    v_mfma_f32_16x16x32_bf16 v[72:75], a[192:195], a[72:75], v[72:75]
    buffer_load_dwordx4 v226, s[60:63], s81 offen offset:2048 lds
    v_mfma_f32_16x16x32_bf16 v[76:79], a[192:195], a[76:79], v[76:79]
    ds_read_b64_tr_b16 a[232:233], v212 offset:32768
    ds_read_b64_tr_b16 a[234:235], v213 offset:32768
    v_mfma_f32_16x16x32_bf16 v[88:91], a[196:199], a[72:75], v[88:91]
    ds_read_b64_tr_b16 a[236:237], v216 offset:32768
    v_mfma_f32_16x16x32_bf16 v[92:95], a[196:199], a[76:79], v[92:95]
    ds_read_b64_tr_b16 a[238:239], v217 offset:32768
    v_mfma_f32_16x16x32_bf16 v[80:83], a[200:203], a[72:75], v[80:83]
    ds_read_b64_tr_b16 a[192:193], v210 offset:33792
    v_mfma_f32_16x16x32_bf16 v[84:87], a[200:203], a[76:79], v[84:87]
    ds_read_b64_tr_b16 a[194:195], v211 offset:33792
    v_mfma_f32_16x16x32_bf16 v[96:99], a[204:207], a[72:75], v[96:99]
    ds_read_b64_tr_b16 a[196:197], v214 offset:33792
    v_mfma_f32_16x16x32_bf16 v[100:103], a[204:207], a[76:79], v[100:103]
    ds_read_b64_tr_b16 a[198:199], v215 offset:33792
    s_waitcnt lgkmcnt(12)
    v_mfma_f32_16x16x32_bf16 v[72:75], a[208:211], a[80:83], v[72:75]
    s_add_u32 m0, s52, 12288
    ds_read_b64_tr_b16 a[200:201], v212 offset:33792
    v_mfma_f32_16x16x32_bf16 v[76:79], a[208:211], a[84:87], v[76:79]
    s_add_u32 s81, s27, 256
    ds_read_b64_tr_b16 a[202:203], v213 offset:33792
    v_mfma_f32_16x16x32_bf16 v[88:91], a[212:215], a[80:83], v[88:91]
    buffer_load_dwordx4 v208, s[60:63], s81 offen offset:0 lds
    v_mfma_f32_16x16x32_bf16 v[92:95], a[212:215], a[84:87], v[92:95]
    ds_read_b64_tr_b16 a[204:205], v216 offset:33792
    ds_read_b64_tr_b16 a[206:207], v217 offset:33792
    v_mfma_f32_16x16x32_bf16 v[80:83], a[216:219], a[80:83], v[80:83]
    ds_read_b64_tr_b16 a[208:209], v210 offset:34816
    v_mfma_f32_16x16x32_bf16 v[84:87], a[216:219], a[84:87], v[84:87]
    ds_read_b64_tr_b16 a[210:211], v211 offset:34816
    v_mfma_f32_16x16x32_bf16 v[96:99], a[220:223], a[80:83], v[96:99]
    ds_read_b64_tr_b16 a[212:213], v214 offset:34816
    v_mfma_f32_16x16x32_bf16 v[100:103], a[220:223], a[84:87], v[100:103]
    ds_read_b64_tr_b16 a[214:215], v215 offset:34816
    s_waitcnt lgkmcnt(12)
    v_mfma_f32_16x16x32_bf16 v[72:75], a[224:227], a[88:91], v[72:75]
    buffer_load_dwordx4 v225, s[60:63], s81 offen offset:1024 lds
    v_mfma_f32_16x16x32_bf16 v[76:79], a[224:227], a[92:95], v[76:79]
    ds_read_b64_tr_b16 a[216:217], v212 offset:34816
    ds_read_b64_tr_b16 a[218:219], v213 offset:34816
    v_mfma_f32_16x16x32_bf16 v[88:91], a[228:231], a[88:91], v[88:91]
    ds_read_b64_tr_b16 a[220:221], v216 offset:34816
    v_mfma_f32_16x16x32_bf16 v[92:95], a[228:231], a[92:95], v[92:95]
    ds_read_b64_tr_b16 a[222:223], v217 offset:34816
    v_mfma_f32_16x16x32_bf16 v[80:83], a[232:235], a[88:91], v[80:83]
    buffer_load_dwordx4 v226, s[60:63], s81 offen offset:2048 lds
    v_mfma_f32_16x16x32_bf16 v[84:87], a[232:235], a[92:95], v[84:87]
    ds_read_b64_tr_b16 a[224:225], v210 offset:35840
    ds_read_b64_tr_b16 a[226:227], v211 offset:35840
    v_mfma_f32_16x16x32_bf16 v[96:99], a[236:239], a[88:91], v[96:99]
    ds_read_b64_tr_b16 a[228:229], v214 offset:35840
    v_mfma_f32_16x16x32_bf16 v[100:103], a[236:239], a[92:95], v[100:103]
    ds_read_b64_tr_b16 a[230:231], v215 offset:35840
    s_waitcnt lgkmcnt(12)
    v_mfma_f32_16x16x32_bf16 v[104:107], a[192:195], a[72:75], v[104:107]
    ds_read_b64_tr_b16 a[232:233], v212 offset:35840
    v_mfma_f32_16x16x32_bf16 v[108:111], a[192:195], a[76:79], v[108:111]
    ds_read_b64_tr_b16 a[234:235], v213 offset:35840
    v_mfma_f32_16x16x32_bf16 v[120:123], a[196:199], a[72:75], v[120:123]
    ds_read_b64_tr_b16 a[236:237], v216 offset:35840
    v_mfma_f32_16x16x32_bf16 v[124:127], a[196:199], a[76:79], v[124:127]
    ds_read_b64_tr_b16 a[238:239], v217 offset:35840
    v_mfma_f32_16x16x32_bf16 v[112:115], a[200:203], a[72:75], v[112:115]
    s_waitcnt vmcnt(6)
    s_barrier
    v_mfma_f32_16x16x32_bf16 v[116:119], a[200:203], a[76:79], v[116:119]
    s_add_u32 m0, s52, 15360
    ds_read_b64_tr_b16 a[192:193], v210 offset:36864
    v_mfma_f32_16x16x32_bf16 v[128:131], a[204:207], a[72:75], v[128:131]
    ds_read_b64_tr_b16 a[194:195], v211 offset:36864
    ds_read_b64_tr_b16 a[196:197], v214 offset:36864
    v_mfma_f32_16x16x32_bf16 v[132:135], a[204:207], a[76:79], v[132:135]
    ds_read_b64_tr_b16 a[198:199], v215 offset:36864
    s_waitcnt lgkmcnt(12)
    v_mfma_f32_16x16x32_bf16 v[104:107], a[208:211], a[80:83], v[104:107]
    s_add_u32 s81, s22, 384
    ds_read_b64_tr_b16 a[200:201], v212 offset:36864
    v_mfma_f32_16x16x32_bf16 v[108:111], a[208:211], a[84:87], v[108:111]
    buffer_load_dwordx4 v208, s[60:63], s81 offen offset:0 lds
    v_mfma_f32_16x16x32_bf16 v[120:123], a[212:215], a[80:83], v[120:123]
    ds_read_b64_tr_b16 a[202:203], v213 offset:36864
    ds_read_b64_tr_b16 a[204:205], v216 offset:36864
    v_mfma_f32_16x16x32_bf16 v[124:127], a[212:215], a[84:87], v[124:127]
    ds_read_b64_tr_b16 a[206:207], v217 offset:36864
    v_mfma_f32_16x16x32_bf16 v[112:115], a[216:219], a[80:83], v[112:115]
    buffer_load_dwordx4 v225, s[60:63], s81 offen offset:1024 lds
    v_mfma_f32_16x16x32_bf16 v[116:119], a[216:219], a[84:87], v[116:119]
    ds_read_b64_tr_b16 a[208:209], v210 offset:37888
    ds_read_b64_tr_b16 a[210:211], v211 offset:37888
    v_mfma_f32_16x16x32_bf16 v[128:131], a[220:223], a[80:83], v[128:131]
    ds_read_b64_tr_b16 a[212:213], v214 offset:37888
    v_mfma_f32_16x16x32_bf16 v[132:135], a[220:223], a[84:87], v[132:135]
    ds_read_b64_tr_b16 a[214:215], v215 offset:37888
    s_waitcnt lgkmcnt(12)
    v_mfma_f32_16x16x32_bf16 v[104:107], a[224:227], a[88:91], v[104:107]
    buffer_load_dwordx4 v226, s[60:63], s81 offen offset:2048 lds
    v_mfma_f32_16x16x32_bf16 v[108:111], a[224:227], a[92:95], v[108:111]
    ds_read_b64_tr_b16 a[216:217], v212 offset:37888
    ds_read_b64_tr_b16 a[218:219], v213 offset:37888
    v_mfma_f32_16x16x32_bf16 v[120:123], a[228:231], a[88:91], v[120:123]
    ds_read_b64_tr_b16 a[220:221], v216 offset:37888
    v_mfma_f32_16x16x32_bf16 v[124:127], a[228:231], a[92:95], v[124:127]
    ds_read_b64_tr_b16 a[222:223], v217 offset:37888
    v_mfma_f32_16x16x32_bf16 v[112:115], a[232:235], a[88:91], v[112:115]
    ds_read_b64_tr_b16 a[224:225], v210 offset:38912
    v_mfma_f32_16x16x32_bf16 v[116:119], a[232:235], a[92:95], v[116:119]
    ds_read_b64_tr_b16 a[226:227], v211 offset:38912
    v_mfma_f32_16x16x32_bf16 v[128:131], a[236:239], a[88:91], v[128:131]
    ds_read_b64_tr_b16 a[228:229], v214 offset:38912
    v_mfma_f32_16x16x32_bf16 v[132:135], a[236:239], a[92:95], v[132:135]
    ds_read_b64_tr_b16 a[230:231], v215 offset:38912
    s_waitcnt lgkmcnt(12)
    v_mfma_f32_16x16x32_bf16 v[40:43], a[192:195], a[96:99], v[40:43]
    s_add_u32 m0, s52, 18432
    ds_read_b64_tr_b16 a[232:233], v212 offset:38912
    v_mfma_f32_16x16x32_bf16 v[44:47], a[192:195], a[100:103], v[44:47]
    s_add_u32 s81, s23, 384
    ds_read_b64_tr_b16 a[234:235], v213 offset:38912
    v_mfma_f32_16x16x32_bf16 v[56:59], a[196:199], a[96:99], v[56:59]
    buffer_load_dwordx4 v208, s[60:63], s81 offen offset:0 lds
    v_mfma_f32_16x16x32_bf16 v[60:63], a[196:199], a[100:103], v[60:63]
    ds_read_b64_tr_b16 a[236:237], v216 offset:38912
    ds_read_b64_tr_b16 a[238:239], v217 offset:38912
    v_mfma_f32_16x16x32_bf16 v[48:51], a[200:203], a[96:99], v[48:51]
    ds_read_b64_tr_b16 a[192:193], v210 offset:0
    v_mfma_f32_16x16x32_bf16 v[52:55], a[200:203], a[100:103], v[52:55]
    ds_read_b64_tr_b16 a[194:195], v211 offset:0
    v_mfma_f32_16x16x32_bf16 v[64:67], a[204:207], a[96:99], v[64:67]
    ds_read_b64_tr_b16 a[196:197], v214 offset:0
    v_mfma_f32_16x16x32_bf16 v[68:71], a[204:207], a[100:103], v[68:71]
    ds_read_b64_tr_b16 a[198:199], v215 offset:0
    s_waitcnt lgkmcnt(12)
    v_mfma_f32_16x16x32_bf16 v[40:43], a[208:211], a[104:107], v[40:43]
    buffer_load_dwordx4 v225, s[60:63], s81 offen offset:1024 lds
    v_mfma_f32_16x16x32_bf16 v[44:47], a[208:211], a[108:111], v[44:47]
    ds_read_b64_tr_b16 a[200:201], v212 offset:0
    ds_read_b64_tr_b16 a[202:203], v213 offset:0
    v_mfma_f32_16x16x32_bf16 v[56:59], a[212:215], a[104:107], v[56:59]
    ds_read_b64_tr_b16 a[204:205], v216 offset:0
    v_mfma_f32_16x16x32_bf16 v[60:63], a[212:215], a[108:111], v[60:63]
    ds_read_b64_tr_b16 a[206:207], v217 offset:0
    v_mfma_f32_16x16x32_bf16 v[48:51], a[216:219], a[104:107], v[48:51]
    buffer_load_dwordx4 v226, s[60:63], s81 offen offset:2048 lds
    v_mfma_f32_16x16x32_bf16 v[52:55], a[216:219], a[108:111], v[52:55]
    ds_read_b64_tr_b16 a[208:209], v210 offset:1024
    ds_read_b64_tr_b16 a[210:211], v211 offset:1024
    v_mfma_f32_16x16x32_bf16 v[64:67], a[220:223], a[104:107], v[64:67]
    ds_read_b64_tr_b16 a[212:213], v214 offset:1024
    v_mfma_f32_16x16x32_bf16 v[68:71], a[220:223], a[108:111], v[68:71]
    ds_read_b64_tr_b16 a[214:215], v215 offset:1024
    s_waitcnt lgkmcnt(12)
    v_mfma_f32_16x16x32_bf16 v[40:43], a[224:227], a[112:115], v[40:43]
    ds_read_b64_tr_b16 a[216:217], v212 offset:1024
    v_mfma_f32_16x16x32_bf16 v[44:47], a[224:227], a[116:119], v[44:47]
    ds_read_b64_tr_b16 a[218:219], v213 offset:1024
    v_mfma_f32_16x16x32_bf16 v[56:59], a[228:231], a[112:115], v[56:59]
    ds_read_b64_tr_b16 a[220:221], v216 offset:1024
    v_mfma_f32_16x16x32_bf16 v[60:63], a[228:231], a[116:119], v[60:63]
    ds_read_b64_tr_b16 a[222:223], v217 offset:1024
    v_mfma_f32_16x16x32_bf16 v[48:51], a[232:235], a[112:115], v[48:51]
    s_add_u32 m0, s52, 21504
    ds_read_b64_tr_b16 a[224:225], v210 offset:2048
    v_mfma_f32_16x16x32_bf16 v[52:55], a[232:235], a[116:119], v[52:55]
    s_add_u32 s81, s24, 384
    ds_read_b64_tr_b16 a[226:227], v211 offset:2048
    v_mfma_f32_16x16x32_bf16 v[64:67], a[236:239], a[112:115], v[64:67]
    ds_read_b64_tr_b16 a[228:229], v214 offset:2048
    v_mfma_f32_16x16x32_bf16 v[68:71], a[236:239], a[116:119], v[68:71]
    ds_read_b64_tr_b16 a[230:231], v215 offset:2048
    s_waitcnt lgkmcnt(12)
    v_mfma_f32_16x16x32_bf16 v[72:75], a[192:195], a[96:99], v[72:75]
    buffer_load_dwordx4 v208, s[60:63], s81 offen offset:0 lds
    v_mfma_f32_16x16x32_bf16 v[76:79], a[192:195], a[100:103], v[76:79]
    ds_read_b64_tr_b16 a[232:233], v212 offset:2048
    ds_read_b64_tr_b16 a[234:235], v213 offset:2048
    v_mfma_f32_16x16x32_bf16 v[88:91], a[196:199], a[96:99], v[88:91]
    ds_read_b64_tr_b16 a[236:237], v216 offset:2048
    v_mfma_f32_16x16x32_bf16 v[92:95], a[196:199], a[100:103], v[92:95]
    ds_read_b64_tr_b16 a[238:239], v217 offset:2048
    v_mfma_f32_16x16x32_bf16 v[80:83], a[200:203], a[96:99], v[80:83]
    buffer_load_dwordx4 v225, s[60:63], s81 offen offset:1024 lds
    v_mfma_f32_16x16x32_bf16 v[84:87], a[200:203], a[100:103], v[84:87]
    ds_read_b64_tr_b16 a[192:193], v210 offset:3072
    ds_read_b64_tr_b16 a[194:195], v211 offset:3072
    v_mfma_f32_16x16x32_bf16 v[96:99], a[204:207], a[96:99], v[96:99]
    ds_read_b64_tr_b16 a[196:197], v214 offset:3072
    v_mfma_f32_16x16x32_bf16 v[100:103], a[204:207], a[100:103], v[100:103]
    ds_read_b64_tr_b16 a[198:199], v215 offset:3072
    s_waitcnt lgkmcnt(12)
    v_mfma_f32_16x16x32_bf16 v[72:75], a[208:211], a[104:107], v[72:75]
    buffer_load_dwordx4 v226, s[60:63], s81 offen offset:2048 lds
    v_mfma_f32_16x16x32_bf16 v[76:79], a[208:211], a[108:111], v[76:79]
    ds_read_b64_tr_b16 a[200:201], v212 offset:3072
    ds_read_b64_tr_b16 a[202:203], v213 offset:3072
    v_mfma_f32_16x16x32_bf16 v[88:91], a[212:215], a[104:107], v[88:91]
    ds_read_b64_tr_b16 a[204:205], v216 offset:3072
    v_mfma_f32_16x16x32_bf16 v[92:95], a[212:215], a[108:111], v[92:95]
    ds_read_b64_tr_b16 a[206:207], v217 offset:3072
    v_mfma_f32_16x16x32_bf16 v[80:83], a[216:219], a[104:107], v[80:83]
    ds_read_b64_tr_b16 a[208:209], v210 offset:4096
    v_mfma_f32_16x16x32_bf16 v[84:87], a[216:219], a[108:111], v[84:87]
    ds_read_b64_tr_b16 a[210:211], v211 offset:4096
    v_mfma_f32_16x16x32_bf16 v[96:99], a[220:223], a[104:107], v[96:99]
    ds_read_b64_tr_b16 a[212:213], v214 offset:4096
    v_mfma_f32_16x16x32_bf16 v[100:103], a[220:223], a[108:111], v[100:103]
    ds_read_b64_tr_b16 a[214:215], v215 offset:4096
    s_waitcnt lgkmcnt(12)
    v_mfma_f32_16x16x32_bf16 v[72:75], a[224:227], a[112:115], v[72:75]
    s_add_u32 m0, s52, 24576
    ds_read_b64_tr_b16 a[216:217], v212 offset:4096
    v_mfma_f32_16x16x32_bf16 v[76:79], a[224:227], a[116:119], v[76:79]
    s_add_u32 s81, s25, 384
    ds_read_b64_tr_b16 a[218:219], v213 offset:4096
    v_mfma_f32_16x16x32_bf16 v[88:91], a[228:231], a[112:115], v[88:91]
    buffer_load_dwordx4 v208, s[60:63], s81 offen offset:0 lds
    v_mfma_f32_16x16x32_bf16 v[92:95], a[228:231], a[116:119], v[92:95]
    ds_read_b64_tr_b16 a[220:221], v216 offset:4096
    ds_read_b64_tr_b16 a[222:223], v217 offset:4096
    v_mfma_f32_16x16x32_bf16 v[80:83], a[232:235], a[112:115], v[80:83]
    ds_read_b64_tr_b16 a[224:225], v210 offset:5120
    v_mfma_f32_16x16x32_bf16 v[84:87], a[232:235], a[116:119], v[84:87]
    ds_read_b64_tr_b16 a[226:227], v211 offset:5120
    v_mfma_f32_16x16x32_bf16 v[96:99], a[236:239], a[112:115], v[96:99]
    ds_read_b64_tr_b16 a[228:229], v214 offset:5120
    v_mfma_f32_16x16x32_bf16 v[100:103], a[236:239], a[116:119], v[100:103]
    ds_read_b64_tr_b16 a[230:231], v215 offset:5120
    s_waitcnt lgkmcnt(12)
    v_mfma_f32_16x16x32_bf16 v[104:107], a[192:195], a[96:99], v[104:107]
    buffer_load_dwordx4 v225, s[60:63], s81 offen offset:1024 lds
    v_mfma_f32_16x16x32_bf16 v[108:111], a[192:195], a[100:103], v[108:111]
    ds_read_b64_tr_b16 a[232:233], v212 offset:5120
    ds_read_b64_tr_b16 a[234:235], v213 offset:5120
    v_mfma_f32_16x16x32_bf16 v[120:123], a[196:199], a[96:99], v[120:123]
    ds_read_b64_tr_b16 a[236:237], v216 offset:5120
    v_mfma_f32_16x16x32_bf16 v[124:127], a[196:199], a[100:103], v[124:127]
    ds_read_b64_tr_b16 a[238:239], v217 offset:5120
    v_mfma_f32_16x16x32_bf16 v[112:115], a[200:203], a[96:99], v[112:115]
    buffer_load_dwordx4 v226, s[60:63], s81 offen offset:2048 lds
    v_mfma_f32_16x16x32_bf16 v[116:119], a[200:203], a[100:103], v[116:119]
    ds_read_b64_tr_b16 a[192:193], v210 offset:6144
    ds_read_b64_tr_b16 a[194:195], v211 offset:6144
    v_mfma_f32_16x16x32_bf16 v[128:131], a[204:207], a[96:99], v[128:131]
    ds_read_b64_tr_b16 a[196:197], v214 offset:6144
    v_mfma_f32_16x16x32_bf16 v[132:135], a[204:207], a[100:103], v[132:135]
    ds_read_b64_tr_b16 a[198:199], v215 offset:6144
    s_waitcnt lgkmcnt(12)
    v_mfma_f32_16x16x32_bf16 v[104:107], a[208:211], a[104:107], v[104:107]
    ds_read_b64_tr_b16 a[200:201], v212 offset:6144
    v_mfma_f32_16x16x32_bf16 v[108:111], a[208:211], a[108:111], v[108:111]
    ds_read_b64_tr_b16 a[202:203], v213 offset:6144
    v_mfma_f32_16x16x32_bf16 v[120:123], a[212:215], a[104:107], v[120:123]
    ds_read_b64_tr_b16 a[204:205], v216 offset:6144
    v_mfma_f32_16x16x32_bf16 v[124:127], a[212:215], a[108:111], v[124:127]
    ds_read_b64_tr_b16 a[206:207], v217 offset:6144
    v_mfma_f32_16x16x32_bf16 v[112:115], a[216:219], a[104:107], v[112:115]
    s_add_u32 m0, s52, 27648
    ds_read_b64_tr_b16 a[208:209], v210 offset:7168
    v_mfma_f32_16x16x32_bf16 v[116:119], a[216:219], a[108:111], v[116:119]
    s_add_u32 s81, s26, 384
    ds_read_b64_tr_b16 a[210:211], v211 offset:7168
    v_mfma_f32_16x16x32_bf16 v[128:131], a[220:223], a[104:107], v[128:131]
    ds_read_b64_tr_b16 a[212:213], v214 offset:7168
    v_mfma_f32_16x16x32_bf16 v[132:135], a[220:223], a[108:111], v[132:135]
    ds_read_b64_tr_b16 a[214:215], v215 offset:7168
    s_waitcnt lgkmcnt(12)
    v_mfma_f32_16x16x32_bf16 v[104:107], a[224:227], a[112:115], v[104:107]
    buffer_load_dwordx4 v208, s[60:63], s81 offen offset:0 lds
    v_mfma_f32_16x16x32_bf16 v[108:111], a[224:227], a[116:119], v[108:111]
    ds_read_b64_tr_b16 a[216:217], v212 offset:7168
    ds_read_b64_tr_b16 a[218:219], v213 offset:7168
    v_mfma_f32_16x16x32_bf16 v[120:123], a[228:231], a[112:115], v[120:123]
    ds_read_b64_tr_b16 a[220:221], v216 offset:7168
    v_mfma_f32_16x16x32_bf16 v[124:127], a[228:231], a[116:119], v[124:127]
    ds_read_b64_tr_b16 a[222:223], v217 offset:7168
    v_mfma_f32_16x16x32_bf16 v[112:115], a[232:235], a[112:115], v[112:115]
    buffer_load_dwordx4 v225, s[60:63], s81 offen offset:1024 lds
    v_mfma_f32_16x16x32_bf16 v[116:119], a[232:235], a[116:119], v[116:119]
    ds_read_b64_tr_b16 a[224:225], v210 offset:8192
    ds_read_b64_tr_b16 a[226:227], v211 offset:8192
    v_mfma_f32_16x16x32_bf16 v[128:131], a[236:239], a[112:115], v[128:131]
    ds_read_b64_tr_b16 a[228:229], v214 offset:8192
    v_mfma_f32_16x16x32_bf16 v[132:135], a[236:239], a[116:119], v[132:135]
    ds_read_b64_tr_b16 a[230:231], v215 offset:8192
    s_waitcnt lgkmcnt(12)
    v_mfma_f32_16x16x32_bf16 v[40:43], a[192:195], a[120:123], v[40:43]
    buffer_load_dwordx4 v226, s[60:63], s81 offen offset:2048 lds
    v_mfma_f32_16x16x32_bf16 v[44:47], a[192:195], a[124:127], v[44:47]
    ds_read_b64_tr_b16 a[232:233], v212 offset:8192
    ds_read_b64_tr_b16 a[234:235], v213 offset:8192
    v_mfma_f32_16x16x32_bf16 v[56:59], a[196:199], a[120:123], v[56:59]
    ds_read_b64_tr_b16 a[236:237], v216 offset:8192
    s_branch L_sskip26
L_stub26:
    s_setpc_b64 s[100:101]
L_sskip26:
    v_mfma_f32_16x16x32_bf16 v[60:63], a[196:199], a[124:127], v[60:63]
    ds_read_b64_tr_b16 a[238:239], v217 offset:8192
    v_mfma_f32_16x16x32_bf16 v[48:51], a[200:203], a[120:123], v[48:51]
    s_waitcnt vmcnt(9)
    s_barrier
    v_mfma_f32_16x16x32_bf16 v[52:55], a[200:203], a[124:127], v[52:55]
    ds_read_b64_tr_b16 a[192:193], v210 offset:9216
    ds_read_b64_tr_b16 a[194:195], v211 offset:9216
    v_mfma_f32_16x16x32_bf16 v[64:67], a[204:207], a[120:123], v[64:67]
    ds_read_b64_tr_b16 a[196:197], v214 offset:9216
    v_mfma_f32_16x16x32_bf16 v[68:71], a[204:207], a[124:127], v[68:71]
    ds_read_b64_tr_b16 a[198:199], v215 offset:9216
    s_waitcnt lgkmcnt(12)
    v_mfma_f32_16x16x32_bf16 v[40:43], a[208:211], a[128:131], v[40:43]
    s_add_u32 m0, s52, 30720
    ds_read_b64_tr_b16 a[200:201], v212 offset:9216
    v_mfma_f32_16x16x32_bf16 v[44:47], a[208:211], a[132:135], v[44:47]
    s_add_u32 s81, s27, 384
    ds_read_b64_tr_b16 a[202:203], v213 offset:9216
    v_mfma_f32_16x16x32_bf16 v[56:59], a[212:215], a[128:131], v[56:59]
    buffer_load_dwordx4 v208, s[60:63], s81 offen offset:0 lds
    v_mfma_f32_16x16x32_bf16 v[60:63], a[212:215], a[132:135], v[60:63]
    ds_read_b64_tr_b16 a[204:205], v216 offset:9216
    ds_read_b64_tr_b16 a[206:207], v217 offset:9216
    v_mfma_f32_16x16x32_bf16 v[48:51], a[216:219], a[128:131], v[48:51]
    ds_read_b64_tr_b16 a[208:209], v210 offset:10240
    v_mfma_f32_16x16x32_bf16 v[52:55], a[216:219], a[132:135], v[52:55]
    ds_read_b64_tr_b16 a[210:211], v211 offset:10240
    v_mfma_f32_16x16x32_bf16 v[64:67], a[220:223], a[128:131], v[64:67]
    ds_read_b64_tr_b16 a[212:213], v214 offset:10240
    v_mfma_f32_16x16x32_bf16 v[68:71], a[220:223], a[132:135], v[68:71]
    ds_read_b64_tr_b16 a[214:215], v215 offset:10240
    s_waitcnt lgkmcnt(12)
    v_mfma_f32_16x16x32_bf16 v[40:43], a[224:227], a[136:139], v[40:43]
    buffer_load_dwordx4 v225, s[60:63], s81 offen offset:1024 lds
    v_mfma_f32_16x16x32_bf16 v[44:47], a[224:227], a[140:143], v[44:47]
    ds_read_b64_tr_b16 a[216:217], v212 offset:10240
    ds_read_b64_tr_b16 a[218:219], v213 offset:10240
    v_mfma_f32_16x16x32_bf16 v[56:59], a[228:231], a[136:139], v[56:59]
    ds_read_b64_tr_b16 a[220:221], v216 offset:10240
    v_mfma_f32_16x16x32_bf16 v[60:63], a[228:231], a[140:143], v[60:63]
    ds_read_b64_tr_b16 a[222:223], v217 offset:10240
    v_mfma_f32_16x16x32_bf16 v[48:51], a[232:235], a[136:139], v[48:51]
    buffer_load_dwordx4 v226, s[60:63], s81 offen offset:2048 lds
    v_mfma_f32_16x16x32_bf16 v[52:55], a[232:235], a[140:143], v[52:55]
    ds_read_b64_tr_b16 a[224:225], v210 offset:11264
    ds_read_b64_tr_b16 a[226:227], v211 offset:11264
    v_mfma_f32_16x16x32_bf16 v[64:67], a[236:239], a[136:139], v[64:67]
    ds_read_b64_tr_b16 a[228:229], v214 offset:11264
    v_mfma_f32_16x16x32_bf16 v[68:71], a[236:239], a[140:143], v[68:71]
    ds_read_b64_tr_b16 a[230:231], v215 offset:11264
    s_waitcnt lgkmcnt(12)
    v_mfma_f32_16x16x32_bf16 v[72:75], a[192:195], a[120:123], v[72:75]
    ds_read_b64_tr_b16 a[232:233], v212 offset:11264
    v_mfma_f32_16x16x32_bf16 v[76:79], a[192:195], a[124:127], v[76:79]
    ds_read_b64_tr_b16 a[234:235], v213 offset:11264
    v_mfma_f32_16x16x32_bf16 v[88:91], a[196:199], a[120:123], v[88:91]
    ds_read_b64_tr_b16 a[236:237], v216 offset:11264
    v_mfma_f32_16x16x32_bf16 v[92:95], a[196:199], a[124:127], v[92:95]
    ds_read_b64_tr_b16 a[238:239], v217 offset:11264
    v_mfma_f32_16x16x32_bf16 v[80:83], a[200:203], a[120:123], v[80:83]
    s_add_u32 m0, s52, 33792
    ds_read_b64_tr_b16 a[192:193], v210 offset:12288
    v_mfma_f32_16x16x32_bf16 v[84:87], a[200:203], a[124:127], v[84:87]
    s_add_u32 s81, s22, 512
    ds_read_b64_tr_b16 a[194:195], v211 offset:12288
    v_mfma_f32_16x16x32_bf16 v[96:99], a[204:207], a[120:123], v[96:99]
    ds_read_b64_tr_b16 a[196:197], v214 offset:12288
    v_cvt_pk_bf16_f32 v40, v40, v41
    v_mfma_f32_16x16x32_bf16 v[100:103], a[204:207], a[124:127], v[100:103]
    ds_read_b64_tr_b16 a[198:199], v215 offset:12288
    s_waitcnt lgkmcnt(12)
    v_mfma_f32_16x16x32_bf16 v[72:75], a[208:211], a[128:131], v[72:75]
    buffer_load_dwordx4 v208, s[60:63], s81 offen offset:0 lds
    v_mfma_f32_16x16x32_bf16 v[76:79], a[208:211], a[132:135], v[76:79]
    v_cvt_pk_bf16_f32 v41, v42, v43
    v_cvt_pk_bf16_f32 v42, v44, v45
    v_mfma_f32_16x16x32_bf16 v[88:91], a[212:215], a[128:131], v[88:91]
    ds_read_b64_tr_b16 a[200:201], v212 offset:12288
    ds_read_b64_tr_b16 a[202:203], v213 offset:12288
    v_mfma_f32_16x16x32_bf16 v[92:95], a[212:215], a[132:135], v[92:95]
    ds_read_b64_tr_b16 a[204:205], v216 offset:12288
    ds_read_b64_tr_b16 a[206:207], v217 offset:12288
    v_mfma_f32_16x16x32_bf16 v[80:83], a[216:219], a[128:131], v[80:83]
    buffer_load_dwordx4 v225, s[60:63], s81 offen offset:1024 lds
    v_mfma_f32_16x16x32_bf16 v[84:87], a[216:219], a[132:135], v[84:87]
    ds_read_b64_tr_b16 a[208:209], v210 offset:13312
    v_cvt_pk_bf16_f32 v43, v46, v47
    v_mfma_f32_16x16x32_bf16 v[96:99], a[220:223], a[128:131], v[96:99]
    ds_read_b64_tr_b16 a[210:211], v211 offset:13312
    ds_read_b64_tr_b16 a[212:213], v214 offset:13312
    v_mfma_f32_16x16x32_bf16 v[100:103], a[220:223], a[132:135], v[100:103]
    ds_read_b64_tr_b16 a[214:215], v215 offset:13312
    s_waitcnt lgkmcnt(12)
    v_mfma_f32_16x16x32_bf16 v[72:75], a[224:227], a[136:139], v[72:75]
    buffer_load_dwordx4 v226, s[60:63], s81 offen offset:2048 lds
    v_mfma_f32_16x16x32_bf16 v[76:79], a[224:227], a[140:143], v[76:79]
    s_add_u32 s55, s82, 1024
    ds_read_b64_tr_b16 a[216:217], v212 offset:13312
    v_mfma_f32_16x16x32_bf16 v[88:91], a[228:231], a[136:139], v[88:91]
    buffer_store_dwordx4 v[40:43], v1, s[72:75], s55 offen sc1
    ds_read_b64_tr_b16 a[218:219], v213 offset:13312
    v_mfma_f32_16x16x32_bf16 v[92:95], a[228:231], a[140:143], v[92:95]
    ds_read_b64_tr_b16 a[220:221], v216 offset:13312
    ds_read_b64_tr_b16 a[222:223], v217 offset:13312
    v_mfma_f32_16x16x32_bf16 v[80:83], a[232:235], a[136:139], v[80:83]
    ds_read_b64_tr_b16 a[224:225], v210 offset:14336
    v_cvt_pk_bf16_f32 v48, v48, v49
    v_mfma_f32_16x16x32_bf16 v[84:87], a[232:235], a[140:143], v[84:87]
    ds_read_b64_tr_b16 a[226:227], v211 offset:14336
    v_cvt_pk_bf16_f32 v49, v50, v51
    v_mfma_f32_16x16x32_bf16 v[96:99], a[236:239], a[136:139], v[96:99]
    ds_read_b64_tr_b16 a[228:229], v214 offset:14336
    v_cvt_pk_bf16_f32 v50, v52, v53
    v_mfma_f32_16x16x32_bf16 v[100:103], a[236:239], a[140:143], v[100:103]
    ds_read_b64_tr_b16 a[230:231], v215 offset:14336
    s_waitcnt lgkmcnt(12)
    v_mfma_f32_16x16x32_bf16 v[104:107], a[192:195], a[120:123], v[104:107]
    s_add_u32 m0, s52, 36864
    ds_read_b64_tr_b16 a[232:233], v212 offset:14336
    v_mfma_f32_16x16x32_bf16 v[108:111], a[192:195], a[124:127], v[108:111]
    s_add_u32 s81, s23, 512
    ds_read_b64_tr_b16 a[234:235], v213 offset:14336
    v_mfma_f32_16x16x32_bf16 v[120:123], a[196:199], a[120:123], v[120:123]
    buffer_load_dwordx4 v208, s[60:63], s81 offen offset:0 lds
    v_mfma_f32_16x16x32_bf16 v[124:127], a[196:199], a[124:127], v[124:127]
    ds_read_b64_tr_b16 a[236:237], v216 offset:14336
    ds_read_b64_tr_b16 a[238:239], v217 offset:14336
    v_mfma_f32_16x16x32_bf16 v[112:115], a[200:203], a[120:123], v[112:115]
    ds_read_b64_tr_b16 a[192:193], v210 offset:15360
    v_cvt_pk_bf16_f32 v51, v54, v55
    v_mfma_f32_16x16x32_bf16 v[116:119], a[200:203], a[124:127], v[116:119]
    s_add_u32 s55, s82, 2048
    ds_read_b64_tr_b16 a[194:195], v211 offset:15360
    v_mfma_f32_16x16x32_bf16 v[128:131], a[204:207], a[120:123], v[128:131]
    buffer_store_dwordx4 v[48:51], v1, s[72:75], s55 offen sc1
    ds_read_b64_tr_b16 a[196:197], v214 offset:15360
    v_mfma_f32_16x16x32_bf16 v[132:135], a[204:207], a[124:127], v[132:135]
    ds_read_b64_tr_b16 a[198:199], v215 offset:15360
    s_waitcnt lgkmcnt(12)
    v_mfma_f32_16x16x32_bf16 v[104:107], a[208:211], a[128:131], v[104:107]
    buffer_load_dwordx4 v225, s[60:63], s81 offen offset:1024 lds
    v_mfma_f32_16x16x32_bf16 v[108:111], a[208:211], a[132:135], v[108:111]
    v_cvt_pk_bf16_f32 v56, v56, v57
    v_cvt_pk_bf16_f32 v57, v58, v59
    v_mfma_f32_16x16x32_bf16 v[120:123], a[212:215], a[128:131], v[120:123]
    ds_read_b64_tr_b16 a[200:201], v212 offset:15360
    ds_read_b64_tr_b16 a[202:203], v213 offset:15360
    v_mfma_f32_16x16x32_bf16 v[124:127], a[212:215], a[132:135], v[124:127]
    ds_read_b64_tr_b16 a[204:205], v216 offset:15360
    ds_read_b64_tr_b16 a[206:207], v217 offset:15360
    v_mfma_f32_16x16x32_bf16 v[112:115], a[216:219], a[128:131], v[112:115]
    buffer_load_dwordx4 v226, s[60:63], s81 offen offset:2048 lds
    v_mfma_f32_16x16x32_bf16 v[116:119], a[216:219], a[132:135], v[116:119]
    ds_read_b64_tr_b16 a[208:209], v210 offset:16384
    v_cvt_pk_bf16_f32 v58, v60, v61
    v_mfma_f32_16x16x32_bf16 v[128:131], a[220:223], a[128:131], v[128:131]
    ds_read_b64_tr_b16 a[210:211], v211 offset:16384
    ds_read_b64_tr_b16 a[212:213], v214 offset:16384
    v_mfma_f32_16x16x32_bf16 v[132:135], a[220:223], a[132:135], v[132:135]
    ds_read_b64_tr_b16 a[214:215], v215 offset:16384
    s_waitcnt lgkmcnt(12)
    v_mfma_f32_16x16x32_bf16 v[104:107], a[224:227], a[136:139], v[104:107]
    ds_read_b64_tr_b16 a[216:217], v212 offset:16384
    v_cvt_pk_bf16_f32 v59, v62, v63
    v_mfma_f32_16x16x32_bf16 v[108:111], a[224:227], a[140:143], v[108:111]
    s_add_u32 s55, s82, 25600
    ds_read_b64_tr_b16 a[218:219], v213 offset:16384
    v_mfma_f32_16x16x32_bf16 v[120:123], a[228:231], a[136:139], v[120:123]
    buffer_store_dwordx4 v[56:59], v1, s[72:75], s55 offen sc1
    ds_read_b64_tr_b16 a[220:221], v216 offset:16384
    v_mfma_f32_16x16x32_bf16 v[124:127], a[228:231], a[140:143], v[124:127]
    ds_read_b64_tr_b16 a[222:223], v217 offset:16384
    v_mfma_f32_16x16x32_bf16 v[112:115], a[232:235], a[136:139], v[112:115]
    s_add_u32 m0, s52, 0
    ds_read_b64_tr_b16 a[224:225], v210 offset:17408
    v_mfma_f32_16x16x32_bf16 v[116:119], a[232:235], a[140:143], v[116:119]
    s_add_u32 s81, s24, 512
    ds_read_b64_tr_b16 a[226:227], v211 offset:17408
    v_mfma_f32_16x16x32_bf16 v[128:131], a[236:239], a[136:139], v[128:131]
    ds_read_b64_tr_b16 a[228:229], v214 offset:17408
    v_cvt_pk_bf16_f32 v64, v64, v65
    v_mfma_f32_16x16x32_bf16 v[132:135], a[236:239], a[140:143], v[132:135]
    ds_read_b64_tr_b16 a[230:231], v215 offset:17408
    s_waitcnt lgkmcnt(12)
    v_mfma_f32_16x16x32_bf16 v[136:139], a[192:195], a[0:3], 0
    buffer_load_dwordx4 v208, s[60:63], s81 offen offset:0 lds
    v_mfma_f32_16x16x32_bf16 v[140:143], a[192:195], a[4:7], 0
    v_cvt_pk_bf16_f32 v65, v66, v67
    v_cvt_pk_bf16_f32 v66, v68, v69
    v_mfma_f32_16x16x32_bf16 v[152:155], a[196:199], a[0:3], 0
    ds_read_b64_tr_b16 a[232:233], v212 offset:17408
    ds_read_b64_tr_b16 a[234:235], v213 offset:17408
    v_mfma_f32_16x16x32_bf16 v[156:159], a[196:199], a[4:7], 0
    ds_read_b64_tr_b16 a[236:237], v216 offset:17408
    ds_read_b64_tr_b16 a[238:239], v217 offset:17408
    v_mfma_f32_16x16x32_bf16 v[144:147], a[200:203], a[0:3], 0
    buffer_load_dwordx4 v225, s[60:63], s81 offen offset:1024 lds
    v_mfma_f32_16x16x32_bf16 v[148:151], a[200:203], a[4:7], 0
    ds_read_b64_tr_b16 a[192:193], v210 offset:18432
    v_cvt_pk_bf16_f32 v67, v70, v71
    v_mfma_f32_16x16x32_bf16 v[160:163], a[204:207], a[0:3], 0
    ds_read_b64_tr_b16 a[194:195], v211 offset:18432
    ds_read_b64_tr_b16 a[196:197], v214 offset:18432
    v_mfma_f32_16x16x32_bf16 v[164:167], a[204:207], a[4:7], 0
    ds_read_b64_tr_b16 a[198:199], v215 offset:18432
    s_waitcnt lgkmcnt(12)
    v_mfma_f32_16x16x32_bf16 v[136:139], a[208:211], a[8:11], v[136:139]
    buffer_load_dwordx4 v226, s[60:63], s81 offen offset:2048 lds
    v_mfma_f32_16x16x32_bf16 v[140:143], a[208:211], a[12:15], v[140:143]
    s_add_u32 s55, s82, 26624
    ds_read_b64_tr_b16 a[200:201], v212 offset:18432
    v_mfma_f32_16x16x32_bf16 v[152:155], a[212:215], a[8:11], v[152:155]
    buffer_store_dwordx4 v[64:67], v1, s[72:75], s55 offen sc1
    ds_read_b64_tr_b16 a[202:203], v213 offset:18432
    v_mfma_f32_16x16x32_bf16 v[156:159], a[212:215], a[12:15], v[156:159]
    ds_read_b64_tr_b16 a[204:205], v216 offset:18432
    ds_read_b64_tr_b16 a[206:207], v217 offset:18432
    v_mfma_f32_16x16x32_bf16 v[144:147], a[216:219], a[8:11], v[144:147]
    ds_read_b64_tr_b16 a[208:209], v210 offset:19456
    v_mfma_f32_16x16x32_bf16 v[148:151], a[216:219], a[12:15], v[148:151]
    ds_read_b64_tr_b16 a[210:211], v211 offset:19456
    v_mfma_f32_16x16x32_bf16 v[160:163], a[220:223], a[8:11], v[160:163]
    ds_read_b64_tr_b16 a[212:213], v214 offset:19456
    v_mfma_f32_16x16x32_bf16 v[164:167], a[220:223], a[12:15], v[164:167]
    ds_read_b64_tr_b16 a[214:215], v215 offset:19456
    s_waitcnt lgkmcnt(12)
    v_mfma_f32_16x16x32_bf16 v[136:139], a[224:227], a[16:19], v[136:139]
    s_add_u32 m0, s52, 3072
    ds_read_b64_tr_b16 a[216:217], v212 offset:19456
    v_mfma_f32_16x16x32_bf16 v[140:143], a[224:227], a[20:23], v[140:143]
    s_add_u32 s81, s25, 512
    ds_read_b64_tr_b16 a[218:219], v213 offset:19456
    v_mfma_f32_16x16x32_bf16 v[152:155], a[228:231], a[16:19], v[152:155]
    buffer_load_dwordx4 v208, s[60:63], s81 offen offset:0 lds
    v_mfma_f32_16x16x32_bf16 v[156:159], a[228:231], a[20:23], v[156:159]
    ds_read_b64_tr_b16 a[220:221], v216 offset:19456
    ds_read_b64_tr_b16 a[222:223], v217 offset:19456
    v_mfma_f32_16x16x32_bf16 v[144:147], a[232:235], a[16:19], v[144:147]
    ds_read_b64_tr_b16 a[224:225], v210 offset:20480
    v_cvt_pk_bf16_f32 v72, v72, v73
    v_mfma_f32_16x16x32_bf16 v[148:151], a[232:235], a[20:23], v[148:151]
    ds_read_b64_tr_b16 a[226:227], v211 offset:20480
    v_cvt_pk_bf16_f32 v73, v74, v75
    v_mfma_f32_16x16x32_bf16 v[160:163], a[236:239], a[16:19], v[160:163]
    ds_read_b64_tr_b16 a[228:229], v214 offset:20480
    v_cvt_pk_bf16_f32 v74, v76, v77
    v_mfma_f32_16x16x32_bf16 v[164:167], a[236:239], a[20:23], v[164:167]
    ds_read_b64_tr_b16 a[230:231], v215 offset:20480
    s_waitcnt lgkmcnt(12)
    v_mfma_f32_16x16x32_bf16 v[136:139], a[192:195], a[24:27], v[136:139]
    buffer_load_dwordx4 v225, s[60:63], s81 offen offset:1024 lds
    v_mfma_f32_16x16x32_bf16 v[140:143], a[192:195], a[28:31], v[140:143]
    v_cvt_pk_bf16_f32 v75, v78, v79
    s_add_u32 s55, s82, 0
    v_mfma_f32_16x16x32_bf16 v[152:155], a[196:199], a[24:27], v[152:155]
    ds_read_b64_tr_b16 a[232:233], v212 offset:20480
    ds_read_b64_tr_b16 a[234:235], v213 offset:20480
    v_mfma_f32_16x16x32_bf16 v[156:159], a[196:199], a[28:31], v[156:159]
    ds_read_b64_tr_b16 a[236:237], v216 offset:20480
    ds_read_b64_tr_b16 a[238:239], v217 offset:20480
    v_mfma_f32_16x16x32_bf16 v[144:147], a[200:203], a[24:27], v[144:147]
    s_waitcnt vmcnt(15)
    s_barrier
    v_mfma_f32_16x16x32_bf16 v[148:151], a[200:203], a[28:31], v[148:151]
    buffer_store_dwordx4 v[72:75], v1, s[72:75], s55 offen sc1
    ds_read_b64_tr_b16 a[192:193], v210 offset:21504
    v_mfma_f32_16x16x32_bf16 v[160:163], a[204:207], a[24:27], v[160:163]
    ds_read_b64_tr_b16 a[194:195], v211 offset:21504
    ds_read_b64_tr_b16 a[196:197], v214 offset:21504
    v_mfma_f32_16x16x32_bf16 v[164:167], a[204:207], a[28:31], v[164:167]
    ds_read_b64_tr_b16 a[198:199], v215 offset:21504
    s_waitcnt lgkmcnt(12)
    v_mfma_f32_16x16x32_bf16 v[136:139], a[208:211], a[32:35], v[136:139]
    buffer_load_dwordx4 v226, s[60:63], s81 offen offset:2048 lds
    v_mfma_f32_16x16x32_bf16 v[140:143], a[208:211], a[36:39], v[140:143]
    s_add_u32 m0, s52, 6144
    s_add_u32 s81, s26, 512
    v_mfma_f32_16x16x32_bf16 v[152:155], a[212:215], a[32:35], v[152:155]
    ds_read_b64_tr_b16 a[200:201], v212 offset:21504
    ds_read_b64_tr_b16 a[202:203], v213 offset:21504
    v_mfma_f32_16x16x32_bf16 v[156:159], a[212:215], a[36:39], v[156:159]
    ds_read_b64_tr_b16 a[204:205], v216 offset:21504
    ds_read_b64_tr_b16 a[206:207], v217 offset:21504
    v_mfma_f32_16x16x32_bf16 v[144:147], a[216:219], a[32:35], v[144:147]
    buffer_load_dwordx4 v208, s[60:63], s81 offen offset:0 lds
    v_mfma_f32_16x16x32_bf16 v[148:151], a[216:219], a[36:39], v[148:151]
    ds_read_b64_tr_b16 a[208:209], v210 offset:22528
    v_cvt_pk_bf16_f32 v80, v80, v81
    v_mfma_f32_16x16x32_bf16 v[160:163], a[220:223], a[32:35], v[160:163]
    ds_read_b64_tr_b16 a[210:211], v211 offset:22528
    ds_read_b64_tr_b16 a[212:213], v214 offset:22528
    v_mfma_f32_16x16x32_bf16 v[164:167], a[220:223], a[36:39], v[164:167]
    ds_read_b64_tr_b16 a[214:215], v215 offset:22528
    s_waitcnt lgkmcnt(12)
    v_mfma_f32_16x16x32_bf16 v[136:139], a[224:227], a[40:43], v[136:139]
    buffer_load_dwordx4 v225, s[60:63], s81 offen offset:1024 lds
    v_mfma_f32_16x16x32_bf16 v[140:143], a[224:227], a[44:47], v[140:143]
    v_cvt_pk_bf16_f32 v81, v82, v83
    v_cvt_pk_bf16_f32 v82, v84, v85
    v_mfma_f32_16x16x32_bf16 v[152:155], a[228:231], a[40:43], v[152:155]
    ds_read_b64_tr_b16 a[216:217], v212 offset:22528
    ds_read_b64_tr_b16 a[218:219], v213 offset:22528
    v_mfma_f32_16x16x32_bf16 v[156:159], a[228:231], a[44:47], v[156:159]
    ds_read_b64_tr_b16 a[220:221], v216 offset:22528
    ds_read_b64_tr_b16 a[222:223], v217 offset:22528
    v_mfma_f32_16x16x32_bf16 v[144:147], a[232:235], a[40:43], v[144:147]
    ds_read_b64_tr_b16 a[224:225], v210 offset:23552
    v_cvt_pk_bf16_f32 v83, v86, v87
    v_mfma_f32_16x16x32_bf16 v[148:151], a[232:235], a[44:47], v[148:151]
    s_add_u32 s55, s82, 49152
    ds_read_b64_tr_b16 a[226:227], v211 offset:23552
    v_mfma_f32_16x16x32_bf16 v[160:163], a[236:239], a[40:43], v[160:163]
    buffer_store_dwordx4 v[80:83], v1, s[72:75], s55 offen sc1
    ds_read_b64_tr_b16 a[228:229], v214 offset:23552
    v_mfma_f32_16x16x32_bf16 v[164:167], a[236:239], a[44:47], v[164:167]
    ds_read_b64_tr_b16 a[230:231], v215 offset:23552
    s_waitcnt lgkmcnt(12)
    v_mfma_f32_16x16x32_bf16 v[136:139], a[192:195], a[48:51], v[136:139]
    buffer_load_dwordx4 v226, s[60:63], s81 offen offset:2048 lds
    v_mfma_f32_16x16x32_bf16 v[140:143], a[192:195], a[52:55], v[140:143]
    v_cvt_pk_bf16_f32 v88, v88, v89
    v_cvt_pk_bf16_f32 v89, v90, v91
    v_mfma_f32_16x16x32_bf16 v[152:155], a[196:199], a[48:51], v[152:155]
    ds_read_b64_tr_b16 a[232:233], v212 offset:23552
    ds_read_b64_tr_b16 a[234:235], v213 offset:23552
    v_mfma_f32_16x16x32_bf16 v[156:159], a[196:199], a[52:55], v[156:159]
    ds_read_b64_tr_b16 a[236:237], v216 offset:23552
    ds_read_b64_tr_b16 a[238:239], v217 offset:23552
    v_mfma_f32_16x16x32_bf16 v[144:147], a[200:203], a[48:51], v[144:147]
    ds_read_b64_tr_b16 a[192:193], v210 offset:24576
    v_cvt_pk_bf16_f32 v90, v92, v93
    v_mfma_f32_16x16x32_bf16 v[148:151], a[200:203], a[52:55], v[148:151]
    ds_read_b64_tr_b16 a[194:195], v211 offset:24576
    v_cvt_pk_bf16_f32 v91, v94, v95
    v_mfma_f32_16x16x32_bf16 v[160:163], a[204:207], a[48:51], v[160:163]
    s_add_u32 s55, s82, 24576
    ds_read_b64_tr_b16 a[196:197], v214 offset:24576
    v_mfma_f32_16x16x32_bf16 v[164:167], a[204:207], a[52:55], v[164:167]
    ds_read_b64_tr_b16 a[198:199], v215 offset:24576
    s_waitcnt lgkmcnt(12)
    v_mfma_f32_16x16x32_bf16 v[136:139], a[208:211], a[56:59], v[136:139]
    s_add_u32 m0, s52, 9216
    ds_read_b64_tr_b16 a[200:201], v212 offset:24576
    v_mfma_f32_16x16x32_bf16 v[140:143], a[208:211], a[60:63], v[140:143]
    s_add_u32 s81, s27, 512
    ds_read_b64_tr_b16 a[202:203], v213 offset:24576
    v_mfma_f32_16x16x32_bf16 v[152:155], a[212:215], a[56:59], v[152:155]
    buffer_load_dwordx4 v208, s[60:63], s81 offen offset:0 lds
    v_mfma_f32_16x16x32_bf16 v[156:159], a[212:215], a[60:63], v[156:159]
    ds_read_b64_tr_b16 a[204:205], v216 offset:24576
    ds_read_b64_tr_b16 a[206:207], v217 offset:24576
    v_mfma_f32_16x16x32_bf16 v[144:147], a[216:219], a[56:59], v[144:147]
    buffer_load_dwordx4 v225, s[60:63], s81 offen offset:1024 lds
    v_mfma_f32_16x16x32_bf16 v[148:151], a[216:219], a[60:63], v[148:151]
    buffer_store_dwordx4 v[88:91], v1, s[72:75], s55 offen sc1
    ds_read_b64_tr_b16 a[208:209], v210 offset:25600
    v_mfma_f32_16x16x32_bf16 v[160:163], a[220:223], a[56:59], v[160:163]
    ds_read_b64_tr_b16 a[210:211], v211 offset:25600
    ds_read_b64_tr_b16 a[212:213], v214 offset:25600
    v_mfma_f32_16x16x32_bf16 v[164:167], a[220:223], a[60:63], v[164:167]
    ds_read_b64_tr_b16 a[214:215], v215 offset:25600
    s_waitcnt lgkmcnt(12)
    v_mfma_f32_16x16x32_bf16 v[136:139], a[224:227], a[64:67], v[136:139]
    ds_read_b64_tr_b16 a[216:217], v212 offset:25600
    v_cvt_pk_bf16_f32 v96, v96, v97
    v_mfma_f32_16x16x32_bf16 v[140:143], a[224:227], a[68:71], v[140:143]
    ds_read_b64_tr_b16 a[218:219], v213 offset:25600
    v_cvt_pk_bf16_f32 v97, v98, v99
    v_mfma_f32_16x16x32_bf16 v[152:155], a[228:231], a[64:67], v[152:155]
    ds_read_b64_tr_b16 a[220:221], v216 offset:25600
    v_cvt_pk_bf16_f32 v98, v100, v101
    v_mfma_f32_16x16x32_bf16 v[156:159], a[228:231], a[68:71], v[156:159]
    ds_read_b64_tr_b16 a[222:223], v217 offset:25600
    v_cvt_pk_bf16_f32 v99, v102, v103
    v_mfma_f32_16x16x32_bf16 v[144:147], a[232:235], a[64:67], v[144:147]
    buffer_load_dwordx4 v226, s[60:63], s81 offen offset:2048 lds
    v_mfma_f32_16x16x32_bf16 v[148:151], a[232:235], a[68:71], v[148:151]
    s_add_u32 s55, s82, 73728
    ds_read_b64_tr_b16 a[224:225], v210 offset:26624
    v_mfma_f32_16x16x32_bf16 v[160:163], a[236:239], a[64:67], v[160:163]
    ds_read_b64_tr_b16 a[226:227], v211 offset:26624
    ds_read_b64_tr_b16 a[228:229], v214 offset:26624
    v_mfma_f32_16x16x32_bf16 v[164:167], a[236:239], a[68:71], v[164:167]
    ds_read_b64_tr_b16 a[230:231], v215 offset:26624
    s_waitcnt lgkmcnt(12)
    v_mfma_f32_16x16x32_bf16 v[136:139], a[192:195], a[72:75], v[136:139]
    s_add_u32 m0, s52, 12288
    ds_read_b64_tr_b16 a[232:233], v212 offset:26624
    v_mfma_f32_16x16x32_bf16 v[140:143], a[192:195], a[76:79], v[140:143]
    s_add_u32 s81, s22, 640
    ds_read_b64_tr_b16 a[234:235], v213 offset:26624
    v_mfma_f32_16x16x32_bf16 v[152:155], a[196:199], a[72:75], v[152:155]
    buffer_load_dwordx4 v208, s[60:63], s81 offen offset:0 lds
    v_mfma_f32_16x16x32_bf16 v[156:159], a[196:199], a[76:79], v[156:159]
    ds_read_b64_tr_b16 a[236:237], v216 offset:26624
    ds_read_b64_tr_b16 a[238:239], v217 offset:26624
    v_mfma_f32_16x16x32_bf16 v[144:147], a[200:203], a[72:75], v[144:147]
    buffer_store_dwordx4 v[96:99], v1, s[72:75], s55 offen sc1
    ds_read_b64_tr_b16 a[192:193], v210 offset:27648
    v_mfma_f32_16x16x32_bf16 v[148:151], a[200:203], a[76:79], v[148:151]
    ds_read_b64_tr_b16 a[194:195], v211 offset:27648
    v_mfma_f32_16x16x32_bf16 v[160:163], a[204:207], a[72:75], v[160:163]
    ds_read_b64_tr_b16 a[196:197], v214 offset:27648
    v_mfma_f32_16x16x32_bf16 v[164:167], a[204:207], a[76:79], v[164:167]
    ds_read_b64_tr_b16 a[198:199], v215 offset:27648
    s_waitcnt lgkmcnt(12)
    v_mfma_f32_16x16x32_bf16 v[136:139], a[208:211], a[80:83], v[136:139]
    buffer_load_dwordx4 v225, s[60:63], s81 offen offset:1024 lds
    v_mfma_f32_16x16x32_bf16 v[140:143], a[208:211], a[84:87], v[140:143]
    ds_read_b64_tr_b16 a[200:201], v212 offset:27648
    ds_read_b64_tr_b16 a[202:203], v213 offset:27648
    v_mfma_f32_16x16x32_bf16 v[152:155], a[212:215], a[80:83], v[152:155]
    ds_read_b64_tr_b16 a[204:205], v216 offset:27648
    v_mfma_f32_16x16x32_bf16 v[156:159], a[212:215], a[84:87], v[156:159]
    ds_read_b64_tr_b16 a[206:207], v217 offset:27648
    v_mfma_f32_16x16x32_bf16 v[144:147], a[216:219], a[80:83], v[144:147]
    buffer_load_dwordx4 v226, s[60:63], s81 offen offset:2048 lds
    v_mfma_f32_16x16x32_bf16 v[148:151], a[216:219], a[84:87], v[148:151]
    ds_read_b64_tr_b16 a[208:209], v210 offset:28672
    v_cvt_pk_bf16_f32 v104, v104, v105
    v_mfma_f32_16x16x32_bf16 v[160:163], a[220:223], a[80:83], v[160:163]
    ds_read_b64_tr_b16 a[210:211], v211 offset:28672
    ds_read_b64_tr_b16 a[212:213], v214 offset:28672
    v_mfma_f32_16x16x32_bf16 v[164:167], a[220:223], a[84:87], v[164:167]
    ds_read_b64_tr_b16 a[214:215], v215 offset:28672
    s_waitcnt lgkmcnt(12)
    v_mfma_f32_16x16x32_bf16 v[136:139], a[224:227], a[88:91], v[136:139]
    ds_read_b64_tr_b16 a[216:217], v212 offset:28672
    v_cvt_pk_bf16_f32 v105, v106, v107
    v_mfma_f32_16x16x32_bf16 v[140:143], a[224:227], a[92:95], v[140:143]
    ds_read_b64_tr_b16 a[218:219], v213 offset:28672
    v_cvt_pk_bf16_f32 v106, v108, v109
    v_mfma_f32_16x16x32_bf16 v[152:155], a[228:231], a[88:91], v[152:155]
    ds_read_b64_tr_b16 a[220:221], v216 offset:28672
    v_cvt_pk_bf16_f32 v107, v110, v111
    v_mfma_f32_16x16x32_bf16 v[156:159], a[228:231], a[92:95], v[156:159]
    s_add_u32 s55, s82, 51200
    ds_read_b64_tr_b16 a[222:223], v217 offset:28672
    v_mfma_f32_16x16x32_bf16 v[144:147], a[232:235], a[88:91], v[144:147]
    s_add_u32 m0, s52, 15360
    ds_read_b64_tr_b16 a[224:225], v210 offset:29696
    v_mfma_f32_16x16x32_bf16 v[148:151], a[232:235], a[92:95], v[148:151]
    s_add_u32 s81, s23, 640
    ds_read_b64_tr_b16 a[226:227], v211 offset:29696
    v_mfma_f32_16x16x32_bf16 v[160:163], a[236:239], a[88:91], v[160:163]
    buffer_store_dwordx4 v[104:107], v1, s[72:75], s55 offen sc1
    ds_read_b64_tr_b16 a[228:229], v214 offset:29696
    v_mfma_f32_16x16x32_bf16 v[164:167], a[236:239], a[92:95], v[164:167]
    ds_read_b64_tr_b16 a[230:231], v215 offset:29696
    s_waitcnt lgkmcnt(12)
    v_mfma_f32_16x16x32_bf16 v[136:139], a[192:195], a[96:99], v[136:139]
    buffer_load_dwordx4 v208, s[60:63], s81 offen offset:0 lds
    v_mfma_f32_16x16x32_bf16 v[140:143], a[192:195], a[100:103], v[140:143]
    v_cvt_pk_bf16_f32 v112, v112, v113
    v_cvt_pk_bf16_f32 v113, v114, v115
    v_mfma_f32_16x16x32_bf16 v[152:155], a[196:199], a[96:99], v[152:155]
    ds_read_b64_tr_b16 a[232:233], v212 offset:29696
    ds_read_b64_tr_b16 a[234:235], v213 offset:29696
    v_mfma_f32_16x16x32_bf16 v[156:159], a[196:199], a[100:103], v[156:159]
    ds_read_b64_tr_b16 a[236:237], v216 offset:29696
    ds_read_b64_tr_b16 a[238:239], v217 offset:29696
    v_mfma_f32_16x16x32_bf16 v[144:147], a[200:203], a[96:99], v[144:147]
    buffer_load_dwordx4 v225, s[60:63], s81 offen offset:1024 lds
    v_mfma_f32_16x16x32_bf16 v[148:151], a[200:203], a[100:103], v[148:151]
    ds_read_b64_tr_b16 a[192:193], v210 offset:30720
    v_cvt_pk_bf16_f32 v114, v116, v117
    v_mfma_f32_16x16x32_bf16 v[160:163], a[204:207], a[96:99], v[160:163]
    ds_read_b64_tr_b16 a[194:195], v211 offset:30720
    ds_read_b64_tr_b16 a[196:197], v214 offset:30720
    v_mfma_f32_16x16x32_bf16 v[164:167], a[204:207], a[100:103], v[164:167]
    ds_read_b64_tr_b16 a[198:199], v215 offset:30720
    s_waitcnt lgkmcnt(12)
    v_mfma_f32_16x16x32_bf16 v[136:139], a[208:211], a[104:107], v[136:139]
    buffer_load_dwordx4 v226, s[60:63], s81 offen offset:2048 lds
    v_mfma_f32_16x16x32_bf16 v[140:143], a[208:211], a[108:111], v[140:143]
    v_cvt_pk_bf16_f32 v115, v118, v119
    s_add_u32 s55, s82, 50176
    v_mfma_f32_16x16x32_bf16 v[152:155], a[212:215], a[104:107], v[152:155]
    ds_read_b64_tr_b16 a[200:201], v212 offset:30720
    ds_read_b64_tr_b16 a[202:203], v213 offset:30720
    v_mfma_f32_16x16x32_bf16 v[156:159], a[212:215], a[108:111], v[156:159]
    ds_read_b64_tr_b16 a[204:205], v216 offset:30720
    ds_read_b64_tr_b16 a[206:207], v217 offset:30720
    v_mfma_f32_16x16x32_bf16 v[144:147], a[216:219], a[104:107], v[144:147]
    buffer_store_dwordx4 v[112:115], v1, s[72:75], s55 offen sc1
    ds_read_b64_tr_b16 a[208:209], v210 offset:31744
    v_mfma_f32_16x16x32_bf16 v[148:151], a[216:219], a[108:111], v[148:151]
    ds_read_b64_tr_b16 a[210:211], v211 offset:31744
    v_mfma_f32_16x16x32_bf16 v[160:163], a[220:223], a[104:107], v[160:163]
    ds_read_b64_tr_b16 a[212:213], v214 offset:31744
    v_mfma_f32_16x16x32_bf16 v[164:167], a[220:223], a[108:111], v[164:167]
    ds_read_b64_tr_b16 a[214:215], v215 offset:31744
    s_waitcnt lgkmcnt(12)
    v_mfma_f32_16x16x32_bf16 v[136:139], a[224:227], a[112:115], v[136:139]
    ds_read_b64_tr_b16 a[216:217], v212 offset:31744
    v_cvt_pk_bf16_f32 v120, v120, v121
    v_mfma_f32_16x16x32_bf16 v[140:143], a[224:227], a[116:119], v[140:143]
    ds_read_b64_tr_b16 a[218:219], v213 offset:31744
    v_cvt_pk_bf16_f32 v121, v122, v123
    v_mfma_f32_16x16x32_bf16 v[152:155], a[228:231], a[112:115], v[152:155]
    ds_read_b64_tr_b16 a[220:221], v216 offset:31744
    v_cvt_pk_bf16_f32 v122, v124, v125
    v_mfma_f32_16x16x32_bf16 v[156:159], a[228:231], a[116:119], v[156:159]
    ds_read_b64_tr_b16 a[222:223], v217 offset:31744
    v_cvt_pk_bf16_f32 v123, v126, v127
    v_mfma_f32_16x16x32_bf16 v[144:147], a[232:235], a[112:115], v[144:147]
    s_add_u32 s55, s82, 75776
    ds_read_b64_tr_b16 a[224:225], v210 offset:32768
    v_mfma_f32_16x16x32_bf16 v[148:151], a[232:235], a[116:119], v[148:151]
    buffer_store_dwordx4 v[120:123], v1, s[72:75], s55 offen sc1
    ds_read_b64_tr_b16 a[226:227], v211 offset:32768
    v_mfma_f32_16x16x32_bf16 v[160:163], a[236:239], a[112:115], v[160:163]
    ds_read_b64_tr_b16 a[228:229], v214 offset:32768
    v_mfma_f32_16x16x32_bf16 v[164:167], a[236:239], a[116:119], v[164:167]
    ds_read_b64_tr_b16 a[230:231], v215 offset:32768
    s_waitcnt lgkmcnt(12)
    v_mfma_f32_16x16x32_bf16 v[136:139], a[192:195], a[120:123], v[136:139]
    ds_read_b64_tr_b16 a[232:233], v212 offset:32768
    v_cvt_pk_bf16_f32 v128, v128, v129
    v_mfma_f32_16x16x32_bf16 v[140:143], a[192:195], a[124:127], v[140:143]
    ds_read_b64_tr_b16 a[234:235], v213 offset:32768
    v_cvt_pk_bf16_f32 v129, v130, v131
    v_mfma_f32_16x16x32_bf16 v[152:155], a[196:199], a[120:123], v[152:155]
    ds_read_b64_tr_b16 a[236:237], v216 offset:32768
    v_cvt_pk_bf16_f32 v130, v132, v133
    s_branch L_sskip27
L_stub27:
    s_setpc_b64 s[100:101]
L_sskip27:
    v_mfma_f32_16x16x32_bf16 v[156:159], a[196:199], a[124:127], v[156:159]
    ds_read_b64_tr_b16 a[238:239], v217 offset:32768
    v_cvt_pk_bf16_f32 v131, v134, v135
    v_mfma_f32_16x16x32_bf16 v[144:147], a[200:203], a[120:123], v[144:147]
    s_waitcnt vmcnt(18)
    s_barrier
    v_mfma_f32_16x16x32_bf16 v[148:151], a[200:203], a[124:127], v[148:151]
    s_add_u32 m0, s52, 18432
    ds_read_b64_tr_b16 a[192:193], v210 offset:33792
    v_mfma_f32_16x16x32_bf16 v[160:163], a[204:207], a[120:123], v[160:163]
    ds_read_b64_tr_b16 a[194:195], v211 offset:33792
    ds_read_b64_tr_b16 a[196:197], v214 offset:33792
    v_mfma_f32_16x16x32_bf16 v[164:167], a[204:207], a[124:127], v[164:167]
    ds_read_b64_tr_b16 a[198:199], v215 offset:33792
    s_waitcnt lgkmcnt(12)
    v_mfma_f32_16x16x32_bf16 v[136:139], a[208:211], a[128:131], v[136:139]
    s_add_u32 s81, s24, 640
    ds_read_b64_tr_b16 a[200:201], v212 offset:33792
    v_mfma_f32_16x16x32_bf16 v[140:143], a[208:211], a[132:135], v[140:143]
    buffer_load_dwordx4 v208, s[60:63], s81 offen offset:0 lds
    v_mfma_f32_16x16x32_bf16 v[152:155], a[212:215], a[128:131], v[152:155]
    s_add_u32 s55, s82, 74752
    ds_read_b64_tr_b16 a[202:203], v213 offset:33792
    v_mfma_f32_16x16x32_bf16 v[156:159], a[212:215], a[132:135], v[156:159]
    ds_read_b64_tr_b16 a[204:205], v216 offset:33792
    ds_read_b64_tr_b16 a[206:207], v217 offset:33792
    v_mfma_f32_16x16x32_bf16 v[144:147], a[216:219], a[128:131], v[144:147]
    buffer_load_dwordx4 v225, s[60:63], s81 offen offset:1024 lds
    v_mfma_f32_16x16x32_bf16 v[148:151], a[216:219], a[132:135], v[148:151]
    buffer_store_dwordx4 v[128:131], v1, s[72:75], s55 offen sc1
    ds_read_b64_tr_b16 a[208:209], v210 offset:34816
    v_mfma_f32_16x16x32_bf16 v[160:163], a[220:223], a[128:131], v[160:163]
    ds_read_b64_tr_b16 a[210:211], v211 offset:34816
    ds_read_b64_tr_b16 a[212:213], v214 offset:34816
    v_mfma_f32_16x16x32_bf16 v[164:167], a[220:223], a[132:135], v[164:167]
    ds_read_b64_tr_b16 a[214:215], v215 offset:34816
    s_waitcnt lgkmcnt(12)
    v_mfma_f32_16x16x32_bf16 v[136:139], a[224:227], a[136:139], v[136:139]
    buffer_load_dwordx4 v226, s[60:63], s81 offen offset:2048 lds
    v_mfma_f32_16x16x32_bf16 v[140:143], a[224:227], a[140:143], v[140:143]
    ds_read_b64_tr_b16 a[216:217], v212 offset:34816
    ds_read_b64_tr_b16 a[218:219], v213 offset:34816
    v_mfma_f32_16x16x32_bf16 v[152:155], a[228:231], a[136:139], v[152:155]
    ds_read_b64_tr_b16 a[220:221], v216 offset:34816
    v_mfma_f32_16x16x32_bf16 v[156:159], a[228:231], a[140:143], v[156:159]
    ds_read_b64_tr_b16 a[222:223], v217 offset:34816
    v_mfma_f32_16x16x32_bf16 v[144:147], a[232:235], a[136:139], v[144:147]
    ds_read_b64_tr_b16 a[224:225], v210 offset:35840
    v_mfma_f32_16x16x32_bf16 v[148:151], a[232:235], a[140:143], v[148:151]
    ds_read_b64_tr_b16 a[226:227], v211 offset:35840
    v_mfma_f32_16x16x32_bf16 v[160:163], a[236:239], a[136:139], v[160:163]
    ds_read_b64_tr_b16 a[228:229], v214 offset:35840
    v_mfma_f32_16x16x32_bf16 v[164:167], a[236:239], a[140:143], v[164:167]
    ds_read_b64_tr_b16 a[230:231], v215 offset:35840
    s_waitcnt lgkmcnt(12)
    v_mfma_f32_16x16x32_bf16 v[168:171], a[192:195], a[0:3], 0
    s_add_u32 m0, s52, 21504
    ds_read_b64_tr_b16 a[232:233], v212 offset:35840
    v_mfma_f32_16x16x32_bf16 v[172:175], a[192:195], a[4:7], 0
    s_add_u32 s81, s25, 640
    ds_read_b64_tr_b16 a[234:235], v213 offset:35840
    v_mfma_f32_16x16x32_bf16 v[184:187], a[196:199], a[0:3], 0
    buffer_load_dwordx4 v208, s[60:63], s81 offen offset:0 lds
    v_mfma_f32_16x16x32_bf16 v[188:191], a[196:199], a[4:7], 0
    ds_read_b64_tr_b16 a[236:237], v216 offset:35840
    ds_read_b64_tr_b16 a[238:239], v217 offset:35840
    v_mfma_f32_16x16x32_bf16 v[176:179], a[200:203], a[0:3], 0
    ds_read_b64_tr_b16 a[192:193], v210 offset:36864
    v_cvt_pk_bf16_f32 v136, v136, v137
    v_mfma_f32_16x16x32_bf16 v[180:183], a[200:203], a[4:7], 0
    ds_read_b64_tr_b16 a[194:195], v211 offset:36864
    v_cvt_pk_bf16_f32 v137, v138, v139
    v_mfma_f32_16x16x32_bf16 v[192:195], a[204:207], a[0:3], 0
    ds_read_b64_tr_b16 a[196:197], v214 offset:36864
    v_cvt_pk_bf16_f32 v138, v140, v141
    v_mfma_f32_16x16x32_bf16 v[196:199], a[204:207], a[4:7], 0
    ds_read_b64_tr_b16 a[198:199], v215 offset:36864
    s_waitcnt lgkmcnt(12)
    v_mfma_f32_16x16x32_bf16 v[168:171], a[208:211], a[8:11], v[168:171]
    buffer_load_dwordx4 v225, s[60:63], s81 offen offset:1024 lds
    v_mfma_f32_16x16x32_bf16 v[172:175], a[208:211], a[12:15], v[172:175]
    v_cvt_pk_bf16_f32 v139, v142, v143
    s_add_u32 s55, s82, 99328
    v_mfma_f32_16x16x32_bf16 v[184:187], a[212:215], a[8:11], v[184:187]
    ds_read_b64_tr_b16 a[200:201], v212 offset:36864
    ds_read_b64_tr_b16 a[202:203], v213 offset:36864
    v_mfma_f32_16x16x32_bf16 v[188:191], a[212:215], a[12:15], v[188:191]
    ds_read_b64_tr_b16 a[204:205], v216 offset:36864
    ds_read_b64_tr_b16 a[206:207], v217 offset:36864
    v_mfma_f32_16x16x32_bf16 v[176:179], a[216:219], a[8:11], v[176:179]
    buffer_load_dwordx4 v226, s[60:63], s81 offen offset:2048 lds
    v_mfma_f32_16x16x32_bf16 v[180:183], a[216:219], a[12:15], v[180:183]
    buffer_store_dwordx4 v[136:139], v1, s[72:75], s55 offen sc1
    ds_read_b64_tr_b16 a[208:209], v210 offset:37888
    v_mfma_f32_16x16x32_bf16 v[192:195], a[220:223], a[8:11], v[192:195]
    ds_read_b64_tr_b16 a[210:211], v211 offset:37888
    ds_read_b64_tr_b16 a[212:213], v214 offset:37888
    v_mfma_f32_16x16x32_bf16 v[196:199], a[220:223], a[12:15], v[196:199]
    ds_read_b64_tr_b16 a[214:215], v215 offset:37888
    s_waitcnt lgkmcnt(12)
    v_mfma_f32_16x16x32_bf16 v[168:171], a[224:227], a[16:19], v[168:171]
    ds_read_b64_tr_b16 a[216:217], v212 offset:37888
    v_cvt_pk_bf16_f32 v144, v144, v145
    v_mfma_f32_16x16x32_bf16 v[172:175], a[224:227], a[20:23], v[172:175]
    ds_read_b64_tr_b16 a[218:219], v213 offset:37888
    v_cvt_pk_bf16_f32 v145, v146, v147
    v_mfma_f32_16x16x32_bf16 v[184:187], a[228:231], a[16:19], v[184:187]
    ds_read_b64_tr_b16 a[220:221], v216 offset:37888
    v_cvt_pk_bf16_f32 v146, v148, v149
    v_mfma_f32_16x16x32_bf16 v[188:191], a[228:231], a[20:23], v[188:191]
    ds_read_b64_tr_b16 a[222:223], v217 offset:37888
    v_cvt_pk_bf16_f32 v147, v150, v151
    v_mfma_f32_16x16x32_bf16 v[176:179], a[232:235], a[16:19], v[176:179]
    s_add_u32 m0, s52, 24576
    ds_read_b64_tr_b16 a[224:225], v210 offset:38912
    v_mfma_f32_16x16x32_bf16 v[180:183], a[232:235], a[20:23], v[180:183]
    s_add_u32 s81, s26, 640
    ds_read_b64_tr_b16 a[226:227], v211 offset:38912
    v_mfma_f32_16x16x32_bf16 v[192:195], a[236:239], a[16:19], v[192:195]
    s_add_u32 s55, s82, 100352
    ds_read_b64_tr_b16 a[228:229], v214 offset:38912
    v_mfma_f32_16x16x32_bf16 v[196:199], a[236:239], a[20:23], v[196:199]
    ds_read_b64_tr_b16 a[230:231], v215 offset:38912
    s_waitcnt lgkmcnt(12)
    v_mfma_f32_16x16x32_bf16 v[168:171], a[192:195], a[24:27], v[168:171]
    buffer_load_dwordx4 v208, s[60:63], s81 offen offset:0 lds
    v_mfma_f32_16x16x32_bf16 v[172:175], a[192:195], a[28:31], v[172:175]
    buffer_store_dwordx4 v[144:147], v1, s[72:75], s55 offen sc1
    ds_read_b64_tr_b16 a[232:233], v212 offset:38912
    v_mfma_f32_16x16x32_bf16 v[184:187], a[196:199], a[24:27], v[184:187]
    ds_read_b64_tr_b16 a[234:235], v213 offset:38912
    ds_read_b64_tr_b16 a[236:237], v216 offset:38912
    v_mfma_f32_16x16x32_bf16 v[188:191], a[196:199], a[28:31], v[188:191]
    ds_read_b64_tr_b16 a[238:239], v217 offset:38912
    v_mfma_f32_16x16x32_bf16 v[176:179], a[200:203], a[24:27], v[176:179]
    buffer_load_dwordx4 v225, s[60:63], s81 offen offset:1024 lds
    v_mfma_f32_16x16x32_bf16 v[180:183], a[200:203], a[28:31], v[180:183]
    ds_read_b64_tr_b16 a[192:193], v210 offset:0
    v_cvt_pk_bf16_f32 v152, v152, v153
    v_mfma_f32_16x16x32_bf16 v[192:195], a[204:207], a[24:27], v[192:195]
    ds_read_b64_tr_b16 a[194:195], v211 offset:0
    ds_read_b64_tr_b16 a[196:197], v214 offset:0
    v_mfma_f32_16x16x32_bf16 v[196:199], a[204:207], a[28:31], v[196:199]
    ds_read_b64_tr_b16 a[198:199], v215 offset:0
    s_waitcnt lgkmcnt(12)
    v_mfma_f32_16x16x32_bf16 v[168:171], a[208:211], a[32:35], v[168:171]
    buffer_load_dwordx4 v226, s[60:63], s81 offen offset:2048 lds
    v_mfma_f32_16x16x32_bf16 v[172:175], a[208:211], a[36:39], v[172:175]
    v_cvt_pk_bf16_f32 v153, v154, v155
    v_cvt_pk_bf16_f32 v154, v156, v157
    v_mfma_f32_16x16x32_bf16 v[184:187], a[212:215], a[32:35], v[184:187]
    ds_read_b64_tr_b16 a[200:201], v212 offset:0
    ds_read_b64_tr_b16 a[202:203], v213 offset:0
    v_mfma_f32_16x16x32_bf16 v[188:191], a[212:215], a[36:39], v[188:191]
    ds_read_b64_tr_b16 a[204:205], v216 offset:0
    ds_read_b64_tr_b16 a[206:207], v217 offset:0
    v_mfma_f32_16x16x32_bf16 v[176:179], a[216:219], a[32:35], v[176:179]
    ds_read_b64_tr_b16 a[208:209], v210 offset:1024
    v_cvt_pk_bf16_f32 v155, v158, v159
    v_mfma_f32_16x16x32_bf16 v[180:183], a[216:219], a[36:39], v[180:183]
    s_add_u32 s55, s82, 123904
    ds_read_b64_tr_b16 a[210:211], v211 offset:1024
    v_mfma_f32_16x16x32_bf16 v[192:195], a[220:223], a[32:35], v[192:195]
    buffer_store_dwordx4 v[152:155], v1, s[72:75], s55 offen sc1
    ds_read_b64_tr_b16 a[212:213], v214 offset:1024
    v_mfma_f32_16x16x32_bf16 v[196:199], a[220:223], a[36:39], v[196:199]
    ds_read_b64_tr_b16 a[214:215], v215 offset:1024
    s_waitcnt lgkmcnt(12)
    v_mfma_f32_16x16x32_bf16 v[168:171], a[224:227], a[40:43], v[168:171]
    s_add_u32 m0, s52, 27648
    ds_read_b64_tr_b16 a[216:217], v212 offset:1024
    v_mfma_f32_16x16x32_bf16 v[172:175], a[224:227], a[44:47], v[172:175]
    s_add_u32 s81, s27, 640
    ds_read_b64_tr_b16 a[218:219], v213 offset:1024
    v_mfma_f32_16x16x32_bf16 v[184:187], a[228:231], a[40:43], v[184:187]
    buffer_load_dwordx4 v208, s[60:63], s81 offen offset:0 lds
    v_mfma_f32_16x16x32_bf16 v[188:191], a[228:231], a[44:47], v[188:191]
    ds_read_b64_tr_b16 a[220:221], v216 offset:1024
    ds_read_b64_tr_b16 a[222:223], v217 offset:1024
    v_mfma_f32_16x16x32_bf16 v[176:179], a[232:235], a[40:43], v[176:179]
    ds_read_b64_tr_b16 a[224:225], v210 offset:2048
    v_cvt_pk_bf16_f32 v160, v160, v161
    v_mfma_f32_16x16x32_bf16 v[180:183], a[232:235], a[44:47], v[180:183]
    ds_read_b64_tr_b16 a[226:227], v211 offset:2048
    v_cvt_pk_bf16_f32 v161, v162, v163
    v_mfma_f32_16x16x32_bf16 v[192:195], a[236:239], a[40:43], v[192:195]
    ds_read_b64_tr_b16 a[228:229], v214 offset:2048
    v_cvt_pk_bf16_f32 v162, v164, v165
    v_mfma_f32_16x16x32_bf16 v[196:199], a[236:239], a[44:47], v[196:199]
    ds_read_b64_tr_b16 a[230:231], v215 offset:2048
    s_waitcnt lgkmcnt(12)
    v_mfma_f32_16x16x32_bf16 v[168:171], a[192:195], a[48:51], v[168:171]
    buffer_load_dwordx4 v225, s[60:63], s81 offen offset:1024 lds
    v_mfma_f32_16x16x32_bf16 v[172:175], a[192:195], a[52:55], v[172:175]
    v_cvt_pk_bf16_f32 v163, v166, v167
    s_add_u32 s55, s82, 124928
    v_mfma_f32_16x16x32_bf16 v[184:187], a[196:199], a[48:51], v[184:187]
    ds_read_b64_tr_b16 a[232:233], v212 offset:2048
    ds_read_b64_tr_b16 a[234:235], v213 offset:2048
    v_mfma_f32_16x16x32_bf16 v[188:191], a[196:199], a[52:55], v[188:191]
    ds_read_b64_tr_b16 a[236:237], v216 offset:2048
    ds_read_b64_tr_b16 a[238:239], v217 offset:2048
    v_mfma_f32_16x16x32_bf16 v[176:179], a[200:203], a[48:51], v[176:179]
    buffer_load_dwordx4 v226, s[60:63], s81 offen offset:2048 lds
    v_mfma_f32_16x16x32_bf16 v[180:183], a[200:203], a[52:55], v[180:183]
    buffer_store_dwordx4 v[160:163], v1, s[72:75], s55 offen sc1
    ds_read_b64_tr_b16 a[192:193], v210 offset:3072
    v_mfma_f32_16x16x32_bf16 v[192:195], a[204:207], a[48:51], v[192:195]
    ds_read_b64_tr_b16 a[194:195], v211 offset:3072
    ds_read_b64_tr_b16 a[196:197], v214 offset:3072
    v_mfma_f32_16x16x32_bf16 v[196:199], a[204:207], a[52:55], v[196:199]
    ds_read_b64_tr_b16 a[198:199], v215 offset:3072
    s_waitcnt lgkmcnt(12)
    v_mfma_f32_16x16x32_bf16 v[168:171], a[208:211], a[56:59], v[168:171]
    s_add_u32 s55, s82, 196608
    ds_read_b64_tr_b16 a[200:201], v212 offset:3072
    v_mfma_f32_16x16x32_bf16 v[172:175], a[208:211], a[60:63], v[172:175]
    buffer_store_dwordx4 v[228:231], v1, s[72:75], s55 offen sc1
    ds_read_b64_tr_b16 a[202:203], v213 offset:3072
    v_mfma_f32_16x16x32_bf16 v[184:187], a[212:215], a[56:59], v[184:187]
    ds_read_b64_tr_b16 a[204:205], v216 offset:3072
    v_mfma_f32_16x16x32_bf16 v[188:191], a[212:215], a[60:63], v[188:191]
    ds_read_b64_tr_b16 a[206:207], v217 offset:3072
    v_mfma_f32_16x16x32_bf16 v[176:179], a[216:219], a[56:59], v[176:179]
    ds_read_b64_tr_b16 a[208:209], v210 offset:4096
    v_mfma_f32_16x16x32_bf16 v[180:183], a[216:219], a[60:63], v[180:183]
    ds_read_b64_tr_b16 a[210:211], v211 offset:4096
    v_mfma_f32_16x16x32_bf16 v[192:195], a[220:223], a[56:59], v[192:195]
    ds_read_b64_tr_b16 a[212:213], v214 offset:4096
    v_mfma_f32_16x16x32_bf16 v[196:199], a[220:223], a[60:63], v[196:199]
    ds_read_b64_tr_b16 a[214:215], v215 offset:4096
    s_waitcnt lgkmcnt(12)
    v_mfma_f32_16x16x32_bf16 v[168:171], a[224:227], a[64:67], v[168:171]
    s_add_u32 s55, s82, 197632
    ds_read_b64_tr_b16 a[216:217], v212 offset:4096
    v_mfma_f32_16x16x32_bf16 v[172:175], a[224:227], a[68:71], v[172:175]
    buffer_store_dwordx4 v[228:231], v1, s[72:75], s55 offen sc1
    ds_read_b64_tr_b16 a[218:219], v213 offset:4096
    v_mfma_f32_16x16x32_bf16 v[184:187], a[228:231], a[64:67], v[184:187]
    ds_read_b64_tr_b16 a[220:221], v216 offset:4096
    v_mfma_f32_16x16x32_bf16 v[188:191], a[228:231], a[68:71], v[188:191]
    ds_read_b64_tr_b16 a[222:223], v217 offset:4096
    v_mfma_f32_16x16x32_bf16 v[176:179], a[232:235], a[64:67], v[176:179]
    ds_read_b64_tr_b16 a[224:225], v210 offset:5120
    v_mfma_f32_16x16x32_bf16 v[180:183], a[232:235], a[68:71], v[180:183]
    ds_read_b64_tr_b16 a[226:227], v211 offset:5120
    v_mfma_f32_16x16x32_bf16 v[192:195], a[236:239], a[64:67], v[192:195]
    ds_read_b64_tr_b16 a[228:229], v214 offset:5120
    v_mfma_f32_16x16x32_bf16 v[196:199], a[236:239], a[68:71], v[196:199]
    ds_read_b64_tr_b16 a[230:231], v215 offset:5120
    s_waitcnt lgkmcnt(12)
    v_mfma_f32_16x16x32_bf16 v[168:171], a[192:195], a[72:75], v[168:171]
    s_add_u32 s55, s82, 198656
    ds_read_b64_tr_b16 a[232:233], v212 offset:5120
    v_mfma_f32_16x16x32_bf16 v[172:175], a[192:195], a[76:79], v[172:175]
    buffer_store_dwordx4 v[228:231], v1, s[72:75], s55 offen sc1
    ds_read_b64_tr_b16 a[234:235], v213 offset:5120
    v_mfma_f32_16x16x32_bf16 v[184:187], a[196:199], a[72:75], v[184:187]
    ds_read_b64_tr_b16 a[236:237], v216 offset:5120
    v_mfma_f32_16x16x32_bf16 v[188:191], a[196:199], a[76:79], v[188:191]
    ds_read_b64_tr_b16 a[238:239], v217 offset:5120
    v_mfma_f32_16x16x32_bf16 v[176:179], a[200:203], a[72:75], v[176:179]
    s_waitcnt vmcnt(22)
    s_barrier
    v_mfma_f32_16x16x32_bf16 v[180:183], a[200:203], a[76:79], v[180:183]
    s_add_u32 m0, s52, 30720
    ds_read_b64_tr_b16 a[192:193], v210 offset:6144
    v_mfma_f32_16x16x32_bf16 v[192:195], a[204:207], a[72:75], v[192:195]
    ds_read_b64_tr_b16 a[194:195], v211 offset:6144
    ds_read_b64_tr_b16 a[196:197], v214 offset:6144
    v_mfma_f32_16x16x32_bf16 v[196:199], a[204:207], a[76:79], v[196:199]
    ds_read_b64_tr_b16 a[198:199], v215 offset:6144
    s_waitcnt lgkmcnt(12)
    v_mfma_f32_16x16x32_bf16 v[168:171], a[208:211], a[80:83], v[168:171]
    s_add_u32 s81, s22, 768
    ds_read_b64_tr_b16 a[200:201], v212 offset:6144
    v_mfma_f32_16x16x32_bf16 v[172:175], a[208:211], a[84:87], v[172:175]
    buffer_load_dwordx4 v208, s[60:63], s81 offen offset:0 lds
    v_mfma_f32_16x16x32_bf16 v[184:187], a[212:215], a[80:83], v[184:187]
    s_add_u32 s55, s82, 221184
    ds_read_b64_tr_b16 a[202:203], v213 offset:6144
    v_mfma_f32_16x16x32_bf16 v[188:191], a[212:215], a[84:87], v[188:191]
    ds_read_b64_tr_b16 a[204:205], v216 offset:6144
    ds_read_b64_tr_b16 a[206:207], v217 offset:6144
    v_mfma_f32_16x16x32_bf16 v[176:179], a[216:219], a[80:83], v[176:179]
    s_waitcnt vmcnt(18)
    s_mov_b64 exec, 1
    global_store_dword v222, v223, s[48:49] offset:0 sc1
    s_mov_b64 exec, -1
    v_mfma_f32_16x16x32_bf16 v[180:183], a[216:219], a[84:87], v[180:183]
    buffer_store_dwordx4 v[228:231], v1, s[72:75], s55 offen sc1
    ds_read_b64_tr_b16 a[208:209], v210 offset:7168
    v_mfma_f32_16x16x32_bf16 v[192:195], a[220:223], a[80:83], v[192:195]
    ds_read_b64_tr_b16 a[210:211], v211 offset:7168
    ds_read_b64_tr_b16 a[212:213], v214 offset:7168
    v_mfma_f32_16x16x32_bf16 v[196:199], a[220:223], a[84:87], v[196:199]
    ds_read_b64_tr_b16 a[214:215], v215 offset:7168
    s_waitcnt lgkmcnt(12)
    v_mfma_f32_16x16x32_bf16 v[168:171], a[224:227], a[88:91], v[168:171]
    buffer_load_dwordx4 v225, s[60:63], s81 offen offset:1024 lds
    v_mfma_f32_16x16x32_bf16 v[172:175], a[224:227], a[92:95], v[172:175]
    ds_read_b64_tr_b16 a[216:217], v212 offset:7168
    ds_read_b64_tr_b16 a[218:219], v213 offset:7168
    v_mfma_f32_16x16x32_bf16 v[184:187], a[228:231], a[88:91], v[184:187]
    ds_read_b64_tr_b16 a[220:221], v216 offset:7168
    v_mfma_f32_16x16x32_bf16 v[188:191], a[228:231], a[92:95], v[188:191]
    ds_read_b64_tr_b16 a[222:223], v217 offset:7168
    v_mfma_f32_16x16x32_bf16 v[176:179], a[232:235], a[88:91], v[176:179]
    buffer_load_dwordx4 v226, s[60:63], s81 offen offset:2048 lds
    v_mfma_f32_16x16x32_bf16 v[180:183], a[232:235], a[92:95], v[180:183]
    s_add_u32 m0, s52, 33792
    ds_read_b64_tr_b16 a[224:225], v210 offset:8192
    v_mfma_f32_16x16x32_bf16 v[192:195], a[236:239], a[88:91], v[192:195]
    ds_read_b64_tr_b16 a[226:227], v211 offset:8192
    ds_read_b64_tr_b16 a[228:229], v214 offset:8192
    v_mfma_f32_16x16x32_bf16 v[196:199], a[236:239], a[92:95], v[196:199]
    ds_read_b64_tr_b16 a[230:231], v215 offset:8192
    s_waitcnt lgkmcnt(12)
    v_mfma_f32_16x16x32_bf16 v[168:171], a[192:195], a[96:99], v[168:171]
    s_add_u32 s81, s23, 768
    ds_read_b64_tr_b16 a[232:233], v212 offset:8192
    v_mfma_f32_16x16x32_bf16 v[172:175], a[192:195], a[100:103], v[172:175]
    buffer_load_dwordx4 v208, s[60:63], s81 offen offset:0 lds
    v_mfma_f32_16x16x32_bf16 v[184:187], a[196:199], a[96:99], v[184:187]
    s_add_u32 s55, s82, 222208
    ds_read_b64_tr_b16 a[234:235], v213 offset:8192
    v_mfma_f32_16x16x32_bf16 v[188:191], a[196:199], a[100:103], v[188:191]
    ds_read_b64_tr_b16 a[236:237], v216 offset:8192
    ds_read_b64_tr_b16 a[238:239], v217 offset:8192
    v_mfma_f32_16x16x32_bf16 v[176:179], a[200:203], a[96:99], v[176:179]
    buffer_store_dwordx4 v[228:231], v1, s[72:75], s55 offen sc1
    ds_read_b64_tr_b16 a[192:193], v210 offset:9216
    v_mfma_f32_16x16x32_bf16 v[180:183], a[200:203], a[100:103], v[180:183]
    ds_read_b64_tr_b16 a[194:195], v211 offset:9216
    v_mfma_f32_16x16x32_bf16 v[192:195], a[204:207], a[96:99], v[192:195]
    ds_read_b64_tr_b16 a[196:197], v214 offset:9216
    v_mfma_f32_16x16x32_bf16 v[196:199], a[204:207], a[100:103], v[196:199]
    ds_read_b64_tr_b16 a[198:199], v215 offset:9216
    s_waitcnt lgkmcnt(12)
    v_mfma_f32_16x16x32_bf16 v[168:171], a[208:211], a[104:107], v[168:171]
    buffer_load_dwordx4 v225, s[60:63], s81 offen offset:1024 lds
    v_mfma_f32_16x16x32_bf16 v[172:175], a[208:211], a[108:111], v[172:175]
    ds_read_b64_tr_b16 a[200:201], v212 offset:9216
    ds_read_b64_tr_b16 a[202:203], v213 offset:9216
    v_mfma_f32_16x16x32_bf16 v[184:187], a[212:215], a[104:107], v[184:187]
    ds_read_b64_tr_b16 a[204:205], v216 offset:9216
    v_mfma_f32_16x16x32_bf16 v[188:191], a[212:215], a[108:111], v[188:191]
    ds_read_b64_tr_b16 a[206:207], v217 offset:9216
    v_mfma_f32_16x16x32_bf16 v[176:179], a[216:219], a[104:107], v[176:179]
    s_add_u32 s55, s82, 223232
    ds_read_b64_tr_b16 a[208:209], v210 offset:10240
    v_mfma_f32_16x16x32_bf16 v[180:183], a[216:219], a[108:111], v[180:183]
    buffer_store_dwordx4 v[228:231], v1, s[72:75], s55 offen sc1
    ds_read_b64_tr_b16 a[210:211], v211 offset:10240
    v_mfma_f32_16x16x32_bf16 v[192:195], a[220:223], a[104:107], v[192:195]
    ds_read_b64_tr_b16 a[212:213], v214 offset:10240
    v_mfma_f32_16x16x32_bf16 v[196:199], a[220:223], a[108:111], v[196:199]
    ds_read_b64_tr_b16 a[214:215], v215 offset:10240
    s_waitcnt lgkmcnt(12)
    v_mfma_f32_16x16x32_bf16 v[168:171], a[224:227], a[112:115], v[168:171]
    buffer_load_dwordx4 v226, s[60:63], s81 offen offset:2048 lds
    v_mfma_f32_16x16x32_bf16 v[172:175], a[224:227], a[116:119], v[172:175]
    ds_read_b64_tr_b16 a[216:217], v212 offset:10240
    ds_read_b64_tr_b16 a[218:219], v213 offset:10240
    v_mfma_f32_16x16x32_bf16 v[184:187], a[228:231], a[112:115], v[184:187]
    ds_read_b64_tr_b16 a[220:221], v216 offset:10240
    v_mfma_f32_16x16x32_bf16 v[188:191], a[228:231], a[116:119], v[188:191]
    ds_read_b64_tr_b16 a[222:223], v217 offset:10240
    v_mfma_f32_16x16x32_bf16 v[176:179], a[232:235], a[112:115], v[176:179]
    s_add_u32 m0, s52, 36864
    ds_read_b64_tr_b16 a[224:225], v210 offset:11264
    v_mfma_f32_16x16x32_bf16 v[180:183], a[232:235], a[116:119], v[180:183]
    s_add_u32 s81, s24, 768
    ds_read_b64_tr_b16 a[226:227], v211 offset:11264
    v_mfma_f32_16x16x32_bf16 v[192:195], a[236:239], a[112:115], v[192:195]
    s_add_u32 s55, s82, 245760
    ds_read_b64_tr_b16 a[228:229], v214 offset:11264
    v_mfma_f32_16x16x32_bf16 v[196:199], a[236:239], a[116:119], v[196:199]
    ds_read_b64_tr_b16 a[230:231], v215 offset:11264
    s_waitcnt lgkmcnt(12)
    v_mfma_f32_16x16x32_bf16 v[168:171], a[192:195], a[120:123], v[168:171]
    buffer_load_dwordx4 v208, s[60:63], s81 offen offset:0 lds
    v_mfma_f32_16x16x32_bf16 v[172:175], a[192:195], a[124:127], v[172:175]
    buffer_store_dwordx4 v[228:231], v1, s[72:75], s55 offen sc1
    ds_read_b64_tr_b16 a[232:233], v212 offset:11264
    v_mfma_f32_16x16x32_bf16 v[184:187], a[196:199], a[120:123], v[184:187]
    ds_read_b64_tr_b16 a[234:235], v213 offset:11264
    ds_read_b64_tr_b16 a[236:237], v216 offset:11264
    v_mfma_f32_16x16x32_bf16 v[188:191], a[196:199], a[124:127], v[188:191]
    ds_read_b64_tr_b16 a[238:239], v217 offset:11264
    v_mfma_f32_16x16x32_bf16 v[176:179], a[200:203], a[120:123], v[176:179]
    buffer_load_dwordx4 v225, s[60:63], s81 offen offset:1024 lds
    v_mfma_f32_16x16x32_bf16 v[180:183], a[200:203], a[124:127], v[180:183]
    ds_read_b64_tr_b16 a[192:193], v210 offset:12288
    ds_read_b64_tr_b16 a[194:195], v211 offset:12288
    v_mfma_f32_16x16x32_bf16 v[192:195], a[204:207], a[120:123], v[192:195]
    ds_read_b64_tr_b16 a[196:197], v214 offset:12288
    v_mfma_f32_16x16x32_bf16 v[196:199], a[204:207], a[124:127], v[196:199]
    ds_read_b64_tr_b16 a[198:199], v215 offset:12288
    s_waitcnt lgkmcnt(12)
    v_mfma_f32_16x16x32_bf16 v[168:171], a[208:211], a[128:131], v[168:171]
    buffer_load_dwordx4 v226, s[60:63], s81 offen offset:2048 lds
    v_mfma_f32_16x16x32_bf16 v[172:175], a[208:211], a[132:135], v[172:175]
    s_add_u32 s55, s82, 246784
    ds_read_b64_tr_b16 a[200:201], v212 offset:12288
    v_mfma_f32_16x16x32_bf16 v[184:187], a[212:215], a[128:131], v[184:187]
    buffer_store_dwordx4 v[228:231], v1, s[72:75], s55 offen sc1
    ds_read_b64_tr_b16 a[202:203], v213 offset:12288
    v_mfma_f32_16x16x32_bf16 v[188:191], a[212:215], a[132:135], v[188:191]
    ds_read_b64_tr_b16 a[204:205], v216 offset:12288
    ds_read_b64_tr_b16 a[206:207], v217 offset:12288
    v_mfma_f32_16x16x32_bf16 v[176:179], a[216:219], a[128:131], v[176:179]
    ds_read_b64_tr_b16 a[208:209], v210 offset:13312
    v_mfma_f32_16x16x32_bf16 v[180:183], a[216:219], a[132:135], v[180:183]
    ds_read_b64_tr_b16 a[210:211], v211 offset:13312
    v_mfma_f32_16x16x32_bf16 v[192:195], a[220:223], a[128:131], v[192:195]
    ds_read_b64_tr_b16 a[212:213], v214 offset:13312
    v_mfma_f32_16x16x32_bf16 v[196:199], a[220:223], a[132:135], v[196:199]
    ds_read_b64_tr_b16 a[214:215], v215 offset:13312
    s_waitcnt lgkmcnt(12)
    v_mfma_f32_16x16x32_bf16 v[168:171], a[224:227], a[136:139], v[168:171]
    s_add_u32 m0, s52, 0
    ds_read_b64_tr_b16 a[216:217], v212 offset:13312
    v_mfma_f32_16x16x32_bf16 v[172:175], a[224:227], a[140:143], v[172:175]
    s_add_u32 s81, s25, 768
    ds_read_b64_tr_b16 a[218:219], v213 offset:13312
    v_mfma_f32_16x16x32_bf16 v[184:187], a[228:231], a[136:139], v[184:187]
    buffer_load_dwordx4 v208, s[60:63], s81 offen offset:0 lds
    v_mfma_f32_16x16x32_bf16 v[188:191], a[228:231], a[140:143], v[188:191]
    ds_read_b64_tr_b16 a[220:221], v216 offset:13312
    ds_read_b64_tr_b16 a[222:223], v217 offset:13312
    v_mfma_f32_16x16x32_bf16 v[176:179], a[232:235], a[136:139], v[176:179]
    s_add_u32 s55, s82, 247808
    ds_read_b64_tr_b16 a[224:225], v210 offset:14336
    v_mfma_f32_16x16x32_bf16 v[180:183], a[232:235], a[140:143], v[180:183]
    buffer_store_dwordx4 v[228:231], v1, s[72:75], s55 offen sc1
    ds_read_b64_tr_b16 a[226:227], v211 offset:14336
    v_mfma_f32_16x16x32_bf16 v[192:195], a[236:239], a[136:139], v[192:195]
    ds_read_b64_tr_b16 a[228:229], v214 offset:14336
    v_mfma_f32_16x16x32_bf16 v[196:199], a[236:239], a[140:143], v[196:199]
    ds_read_b64_tr_b16 a[230:231], v215 offset:14336
    s_waitcnt lgkmcnt(12)
    v_mfma_f32_16x16x32_bf16 v[40:43], a[192:195], a[0:3], 0
    buffer_load_dwordx4 v225, s[60:63], s81 offen offset:1024 lds
    v_mfma_f32_16x16x32_bf16 v[44:47], a[192:195], a[4:7], 0
    ds_read_b64_tr_b16 a[232:233], v212 offset:14336
    ds_read_b64_tr_b16 a[234:235], v213 offset:14336
    v_mfma_f32_16x16x32_bf16 v[56:59], a[196:199], a[0:3], 0
    ds_read_b64_tr_b16 a[236:237], v216 offset:14336
    v_mfma_f32_16x16x32_bf16 v[60:63], a[196:199], a[4:7], 0
    ds_read_b64_tr_b16 a[238:239], v217 offset:14336
    v_mfma_f32_16x16x32_bf16 v[48:51], a[200:203], a[0:3], 0
    buffer_load_dwordx4 v226, s[60:63], s81 offen offset:2048 lds
    v_mfma_f32_16x16x32_bf16 v[52:55], a[200:203], a[4:7], 0
    s_add_u32 s55, s82, 270336
    ds_read_b64_tr_b16 a[192:193], v210 offset:15360
    v_mfma_f32_16x16x32_bf16 v[64:67], a[204:207], a[0:3], 0
    ds_read_b64_tr_b16 a[194:195], v211 offset:15360
    ds_read_b64_tr_b16 a[196:197], v214 offset:15360
    v_mfma_f32_16x16x32_bf16 v[68:71], a[204:207], a[4:7], 0
    ds_read_b64_tr_b16 a[198:199], v215 offset:15360
    s_waitcnt lgkmcnt(12)
    v_mfma_f32_16x16x32_bf16 v[40:43], a[208:211], a[8:11], v[40:43]
    buffer_store_dwordx4 v[228:231], v1, s[72:75], s55 offen sc1
    ds_read_b64_tr_b16 a[200:201], v212 offset:15360
    v_mfma_f32_16x16x32_bf16 v[44:47], a[208:211], a[12:15], v[44:47]
    ds_read_b64_tr_b16 a[202:203], v213 offset:15360
    v_mfma_f32_16x16x32_bf16 v[56:59], a[212:215], a[8:11], v[56:59]
    ds_read_b64_tr_b16 a[204:205], v216 offset:15360
    v_mfma_f32_16x16x32_bf16 v[60:63], a[212:215], a[12:15], v[60:63]
    ds_read_b64_tr_b16 a[206:207], v217 offset:15360
    v_mfma_f32_16x16x32_bf16 v[48:51], a[216:219], a[8:11], v[48:51]
    ds_read_b64_tr_b16 a[208:209], v210 offset:16384
    v_mfma_f32_16x16x32_bf16 v[52:55], a[216:219], a[12:15], v[52:55]
    ds_read_b64_tr_b16 a[210:211], v211 offset:16384
    v_mfma_f32_16x16x32_bf16 v[64:67], a[220:223], a[8:11], v[64:67]
    ds_read_b64_tr_b16 a[212:213], v214 offset:16384
    v_mfma_f32_16x16x32_bf16 v[68:71], a[220:223], a[12:15], v[68:71]
    ds_read_b64_tr_b16 a[214:215], v215 offset:16384
    s_waitcnt lgkmcnt(12)
    v_mfma_f32_16x16x32_bf16 v[40:43], a[224:227], a[16:19], v[40:43]
    s_add_u32 s55, s82, 271360
    ds_read_b64_tr_b16 a[216:217], v212 offset:16384
    v_mfma_f32_16x16x32_bf16 v[44:47], a[224:227], a[20:23], v[44:47]
    buffer_store_dwordx4 v[228:231], v1, s[72:75], s55 offen sc1
    ds_read_b64_tr_b16 a[218:219], v213 offset:16384
    v_mfma_f32_16x16x32_bf16 v[56:59], a[228:231], a[16:19], v[56:59]
    ds_read_b64_tr_b16 a[220:221], v216 offset:16384
    v_mfma_f32_16x16x32_bf16 v[60:63], a[228:231], a[20:23], v[60:63]
    ds_read_b64_tr_b16 a[222:223], v217 offset:16384
    v_mfma_f32_16x16x32_bf16 v[48:51], a[232:235], a[16:19], v[48:51]
    ds_read_b64_tr_b16 a[224:225], v210 offset:17408
    v_mfma_f32_16x16x32_bf16 v[52:55], a[232:235], a[20:23], v[52:55]
    ds_read_b64_tr_b16 a[226:227], v211 offset:17408
    v_mfma_f32_16x16x32_bf16 v[64:67], a[236:239], a[16:19], v[64:67]
    ds_read_b64_tr_b16 a[228:229], v214 offset:17408
    v_mfma_f32_16x16x32_bf16 v[68:71], a[236:239], a[20:23], v[68:71]
    ds_read_b64_tr_b16 a[230:231], v215 offset:17408
    s_waitcnt lgkmcnt(12)
    v_mfma_f32_16x16x32_bf16 v[40:43], a[192:195], a[24:27], v[40:43]
    s_add_u32 s55, s82, 272384
    ds_read_b64_tr_b16 a[232:233], v212 offset:17408
    v_mfma_f32_16x16x32_bf16 v[44:47], a[192:195], a[28:31], v[44:47]
    buffer_store_dwordx4 v[228:231], v1, s[72:75], s55 offen sc1
    ds_read_b64_tr_b16 a[234:235], v213 offset:17408
    v_mfma_f32_16x16x32_bf16 v[56:59], a[196:199], a[24:27], v[56:59]
    ds_read_b64_tr_b16 a[236:237], v216 offset:17408
    v_mfma_f32_16x16x32_bf16 v[60:63], a[196:199], a[28:31], v[60:63]
    ds_read_b64_tr_b16 a[238:239], v217 offset:17408
    v_mfma_f32_16x16x32_bf16 v[48:51], a[200:203], a[24:27], v[48:51]
    s_waitcnt vmcnt(26)
    s_barrier
    v_mfma_f32_16x16x32_bf16 v[52:55], a[200:203], a[28:31], v[52:55]
    s_add_u32 m0, s52, 3072
    ds_read_b64_tr_b16 a[192:193], v210 offset:18432
    v_mfma_f32_16x16x32_bf16 v[64:67], a[204:207], a[24:27], v[64:67]
    ds_read_b64_tr_b16 a[194:195], v211 offset:18432
    ds_read_b64_tr_b16 a[196:197], v214 offset:18432
    v_mfma_f32_16x16x32_bf16 v[68:71], a[204:207], a[28:31], v[68:71]
    ds_read_b64_tr_b16 a[198:199], v215 offset:18432
    s_waitcnt lgkmcnt(12)
    v_mfma_f32_16x16x32_bf16 v[40:43], a[208:211], a[32:35], v[40:43]
    s_add_u32 s81, s26, 768
    ds_read_b64_tr_b16 a[200:201], v212 offset:18432
    v_mfma_f32_16x16x32_bf16 v[44:47], a[208:211], a[36:39], v[44:47]
    buffer_load_dwordx4 v208, s[60:63], s81 offen offset:0 lds
    v_mfma_f32_16x16x32_bf16 v[56:59], a[212:215], a[32:35], v[56:59]
    ds_read_b64_tr_b16 a[202:203], v213 offset:18432
    ds_read_b64_tr_b16 a[204:205], v216 offset:18432
    s_branch L_sskip28
L_stub28:
    s_setpc_b64 s[100:101]
L_sskip28:
    v_mfma_f32_16x16x32_bf16 v[60:63], a[212:215], a[36:39], v[60:63]
    ds_read_b64_tr_b16 a[206:207], v217 offset:18432
    v_mfma_f32_16x16x32_bf16 v[48:51], a[216:219], a[32:35], v[48:51]
    buffer_load_dwordx4 v225, s[60:63], s81 offen offset:1024 lds
    v_mfma_f32_16x16x32_bf16 v[52:55], a[216:219], a[36:39], v[52:55]
    ds_read_b64_tr_b16 a[208:209], v210 offset:19456
    v_cvt_pk_bf16_f32 v168, v168, v169
    v_mfma_f32_16x16x32_bf16 v[64:67], a[220:223], a[32:35], v[64:67]
    ds_read_b64_tr_b16 a[210:211], v211 offset:19456
    ds_read_b64_tr_b16 a[212:213], v214 offset:19456
    v_mfma_f32_16x16x32_bf16 v[68:71], a[220:223], a[36:39], v[68:71]
    ds_read_b64_tr_b16 a[214:215], v215 offset:19456
    s_waitcnt lgkmcnt(12)
    v_mfma_f32_16x16x32_bf16 v[40:43], a[224:227], a[40:43], v[40:43]
    buffer_load_dwordx4 v226, s[60:63], s81 offen offset:2048 lds
    v_mfma_f32_16x16x32_bf16 v[44:47], a[224:227], a[44:47], v[44:47]
    v_cvt_pk_bf16_f32 v169, v170, v171
    v_cvt_pk_bf16_f32 v170, v172, v173
    v_mfma_f32_16x16x32_bf16 v[56:59], a[228:231], a[40:43], v[56:59]
    ds_read_b64_tr_b16 a[216:217], v212 offset:19456
    ds_read_b64_tr_b16 a[218:219], v213 offset:19456
    v_mfma_f32_16x16x32_bf16 v[60:63], a[228:231], a[44:47], v[60:63]
    ds_read_b64_tr_b16 a[220:221], v216 offset:19456
    ds_read_b64_tr_b16 a[222:223], v217 offset:19456
    v_mfma_f32_16x16x32_bf16 v[48:51], a[232:235], a[40:43], v[48:51]
    ds_read_b64_tr_b16 a[224:225], v210 offset:20480
    v_cvt_pk_bf16_f32 v171, v174, v175
    v_mfma_f32_16x16x32_bf16 v[52:55], a[232:235], a[44:47], v[52:55]
    s_add_u32 s55, s82, 98304
    ds_read_b64_tr_b16 a[226:227], v211 offset:20480
    v_mfma_f32_16x16x32_bf16 v[64:67], a[236:239], a[40:43], v[64:67]
    buffer_store_dwordx4 v[168:171], v1, s[72:75], s55 offen sc1
    ds_read_b64_tr_b16 a[228:229], v214 offset:20480
    v_mfma_f32_16x16x32_bf16 v[68:71], a[236:239], a[44:47], v[68:71]
    ds_read_b64_tr_b16 a[230:231], v215 offset:20480
    s_waitcnt lgkmcnt(12)
    v_mfma_f32_16x16x32_bf16 v[40:43], a[192:195], a[48:51], v[40:43]
    s_add_u32 m0, s52, 6144
    ds_read_b64_tr_b16 a[232:233], v212 offset:20480
    v_mfma_f32_16x16x32_bf16 v[44:47], a[192:195], a[52:55], v[44:47]
    s_add_u32 s81, s27, 768
    ds_read_b64_tr_b16 a[234:235], v213 offset:20480
    v_mfma_f32_16x16x32_bf16 v[56:59], a[196:199], a[48:51], v[56:59]
    buffer_load_dwordx4 v208, s[60:63], s81 offen offset:0 lds
    v_mfma_f32_16x16x32_bf16 v[60:63], a[196:199], a[52:55], v[60:63]
    ds_read_b64_tr_b16 a[236:237], v216 offset:20480
    ds_read_b64_tr_b16 a[238:239], v217 offset:20480
    v_mfma_f32_16x16x32_bf16 v[48:51], a[200:203], a[48:51], v[48:51]
    ds_read_b64_tr_b16 a[192:193], v210 offset:21504
    v_cvt_pk_bf16_f32 v176, v176, v177
    v_mfma_f32_16x16x32_bf16 v[52:55], a[200:203], a[52:55], v[52:55]
    ds_read_b64_tr_b16 a[194:195], v211 offset:21504
    v_cvt_pk_bf16_f32 v177, v178, v179
    v_mfma_f32_16x16x32_bf16 v[64:67], a[204:207], a[48:51], v[64:67]
    ds_read_b64_tr_b16 a[196:197], v214 offset:21504
    v_cvt_pk_bf16_f32 v178, v180, v181
    v_mfma_f32_16x16x32_bf16 v[68:71], a[204:207], a[52:55], v[68:71]
    ds_read_b64_tr_b16 a[198:199], v215 offset:21504
    s_waitcnt lgkmcnt(12)
    v_mfma_f32_16x16x32_bf16 v[40:43], a[208:211], a[56:59], v[40:43]
    buffer_load_dwordx4 v225, s[60:63], s81 offen offset:1024 lds
    v_mfma_f32_16x16x32_bf16 v[44:47], a[208:211], a[60:63], v[44:47]
    v_cvt_pk_bf16_f32 v179, v182, v183
    s_add_u32 s55, s82, 147456
    v_mfma_f32_16x16x32_bf16 v[56:59], a[212:215], a[56:59], v[56:59]
    ds_read_b64_tr_b16 a[200:201], v212 offset:21504
    ds_read_b64_tr_b16 a[202:203], v213 offset:21504
    v_mfma_f32_16x16x32_bf16 v[60:63], a[212:215], a[60:63], v[60:63]
    ds_read_b64_tr_b16 a[204:205], v216 offset:21504
    ds_read_b64_tr_b16 a[206:207], v217 offset:21504
    v_mfma_f32_16x16x32_bf16 v[48:51], a[216:219], a[56:59], v[48:51]
    buffer_load_dwordx4 v226, s[60:63], s81 offen offset:2048 lds
    v_mfma_f32_16x16x32_bf16 v[52:55], a[216:219], a[60:63], v[52:55]
    buffer_store_dwordx4 v[176:179], v1, s[72:75], s55 offen sc1
    ds_read_b64_tr_b16 a[208:209], v210 offset:22528
    v_mfma_f32_16x16x32_bf16 v[64:67], a[220:223], a[56:59], v[64:67]
    ds_read_b64_tr_b16 a[210:211], v211 offset:22528
    ds_read_b64_tr_b16 a[212:213], v214 offset:22528
    v_mfma_f32_16x16x32_bf16 v[68:71], a[220:223], a[60:63], v[68:71]
    ds_read_b64_tr_b16 a[214:215], v215 offset:22528
    s_waitcnt lgkmcnt(12)
    v_mfma_f32_16x16x32_bf16 v[40:43], a[224:227], a[64:67], v[40:43]
    ds_read_b64_tr_b16 a[216:217], v212 offset:22528
    v_cvt_pk_bf16_f32 v184, v184, v185
    v_mfma_f32_16x16x32_bf16 v[44:47], a[224:227], a[68:71], v[44:47]
    ds_read_b64_tr_b16 a[218:219], v213 offset:22528
    v_cvt_pk_bf16_f32 v185, v186, v187
    v_mfma_f32_16x16x32_bf16 v[56:59], a[228:231], a[64:67], v[56:59]
    ds_read_b64_tr_b16 a[220:221], v216 offset:22528
    v_cvt_pk_bf16_f32 v186, v188, v189
    v_mfma_f32_16x16x32_bf16 v[60:63], a[228:231], a[68:71], v[60:63]
    ds_read_b64_tr_b16 a[222:223], v217 offset:22528
    v_cvt_pk_bf16_f32 v187, v190, v191
    v_mfma_f32_16x16x32_bf16 v[48:51], a[232:235], a[64:67], v[48:51]
    s_add_u32 m0, s52, 9216
    ds_read_b64_tr_b16 a[224:225], v210 offset:23552
    v_mfma_f32_16x16x32_bf16 v[52:55], a[232:235], a[68:71], v[52:55]
    s_add_u32 s81, s22, 896
    ds_read_b64_tr_b16 a[226:227], v211 offset:23552
    v_mfma_f32_16x16x32_bf16 v[64:67], a[236:239], a[64:67], v[64:67]
    s_add_u32 s55, s82, 122880
    ds_read_b64_tr_b16 a[228:229], v214 offset:23552
    v_mfma_f32_16x16x32_bf16 v[68:71], a[236:239], a[68:71], v[68:71]
    ds_read_b64_tr_b16 a[230:231], v215 offset:23552
    s_waitcnt lgkmcnt(12)
    v_mfma_f32_16x16x32_bf16 v[40:43], a[192:195], a[72:75], v[40:43]
    buffer_load_dwordx4 v208, s[60:63], s81 offen offset:0 lds
    v_mfma_f32_16x16x32_bf16 v[44:47], a[192:195], a[76:79], v[44:47]
    buffer_store_dwordx4 v[184:187], v1, s[72:75], s55 offen sc1
    ds_read_b64_tr_b16 a[232:233], v212 offset:23552
    v_mfma_f32_16x16x32_bf16 v[56:59], a[196:199], a[72:75], v[56:59]
    ds_read_b64_tr_b16 a[234:235], v213 offset:23552
    ds_read_b64_tr_b16 a[236:237], v216 offset:23552
    v_mfma_f32_16x16x32_bf16 v[60:63], a[196:199], a[76:79], v[60:63]
    ds_read_b64_tr_b16 a[238:239], v217 offset:23552
    v_mfma_f32_16x16x32_bf16 v[48:51], a[200:203], a[72:75], v[48:51]
    buffer_load_dwordx4 v225, s[60:63], s81 offen offset:1024 lds
    v_mfma_f32_16x16x32_bf16 v[52:55], a[200:203], a[76:79], v[52:55]
    ds_read_b64_tr_b16 a[192:193], v210 offset:24576
    v_cvt_pk_bf16_f32 v192, v192, v193
    v_mfma_f32_16x16x32_bf16 v[64:67], a[204:207], a[72:75], v[64:67]
    ds_read_b64_tr_b16 a[194:195], v211 offset:24576
    ds_read_b64_tr_b16 a[196:197], v214 offset:24576
    v_mfma_f32_16x16x32_bf16 v[68:71], a[204:207], a[76:79], v[68:71]
    ds_read_b64_tr_b16 a[198:199], v215 offset:24576
    s_waitcnt lgkmcnt(12)
    v_mfma_f32_16x16x32_bf16 v[40:43], a[208:211], a[80:83], v[40:43]
    buffer_load_dwordx4 v226, s[60:63], s81 offen offset:2048 lds
    v_mfma_f32_16x16x32_bf16 v[44:47], a[208:211], a[84:87], v[44:47]
    v_cvt_pk_bf16_f32 v193, v194, v195
    v_cvt_pk_bf16_f32 v194, v196, v197
    v_mfma_f32_16x16x32_bf16 v[56:59], a[212:215], a[80:83], v[56:59]
    ds_read_b64_tr_b16 a[200:201], v212 offset:24576
    ds_read_b64_tr_b16 a[202:203], v213 offset:24576
    v_mfma_f32_16x16x32_bf16 v[60:63], a[212:215], a[84:87], v[60:63]
    ds_read_b64_tr_b16 a[204:205], v216 offset:24576
    ds_read_b64_tr_b16 a[206:207], v217 offset:24576
    v_mfma_f32_16x16x32_bf16 v[48:51], a[216:219], a[80:83], v[48:51]
    ds_read_b64_tr_b16 a[208:209], v210 offset:25600
    v_cvt_pk_bf16_f32 v195, v198, v199
    v_mfma_f32_16x16x32_bf16 v[52:55], a[216:219], a[84:87], v[52:55]
    s_add_u32 s55, s82, 172032
    ds_read_b64_tr_b16 a[210:211], v211 offset:25600
    v_mfma_f32_16x16x32_bf16 v[64:67], a[220:223], a[80:83], v[64:67]
    buffer_store_dwordx4 v[192:195], v1, s[72:75], s55 offen sc1
    ds_read_b64_tr_b16 a[212:213], v214 offset:25600
    v_mfma_f32_16x16x32_bf16 v[68:71], a[220:223], a[84:87], v[68:71]
    ds_read_b64_tr_b16 a[214:215], v215 offset:25600
    s_waitcnt lgkmcnt(12)
    v_mfma_f32_16x16x32_bf16 v[40:43], a[224:227], a[88:91], v[40:43]
    s_add_u32 m0, s52, 12288
    ds_read_b64_tr_b16 a[216:217], v212 offset:25600
    v_mfma_f32_16x16x32_bf16 v[44:47], a[224:227], a[92:95], v[44:47]
    s_add_u32 s81, s23, 896
    ds_read_b64_tr_b16 a[218:219], v213 offset:25600
    v_mfma_f32_16x16x32_bf16 v[56:59], a[228:231], a[88:91], v[56:59]
    buffer_load_dwordx4 v208, s[60:63], s81 offen offset:0 lds
    v_mfma_f32_16x16x32_bf16 v[60:63], a[228:231], a[92:95], v[60:63]
    ds_read_b64_tr_b16 a[220:221], v216 offset:25600
    ds_read_b64_tr_b16 a[222:223], v217 offset:25600
    v_mfma_f32_16x16x32_bf16 v[48:51], a[232:235], a[88:91], v[48:51]
    ds_read_b64_tr_b16 a[224:225], v210 offset:26624
    v_mfma_f32_16x16x32_bf16 v[52:55], a[232:235], a[92:95], v[52:55]
    ds_read_b64_tr_b16 a[226:227], v211 offset:26624
    v_mfma_f32_16x16x32_bf16 v[64:67], a[236:239], a[88:91], v[64:67]
    ds_read_b64_tr_b16 a[228:229], v214 offset:26624
    v_mfma_f32_16x16x32_bf16 v[68:71], a[236:239], a[92:95], v[68:71]
    ds_read_b64_tr_b16 a[230:231], v215 offset:26624
    s_waitcnt lgkmcnt(12)
    v_mfma_f32_16x16x32_bf16 v[40:43], a[192:195], a[96:99], v[40:43]
    buffer_load_dwordx4 v225, s[60:63], s81 offen offset:1024 lds
    v_mfma_f32_16x16x32_bf16 v[44:47], a[192:195], a[100:103], v[44:47]
    ds_read_b64_tr_b16 a[232:233], v212 offset:26624
    ds_read_b64_tr_b16 a[234:235], v213 offset:26624
    v_mfma_f32_16x16x32_bf16 v[56:59], a[196:199], a[96:99], v[56:59]
    ds_read_b64_tr_b16 a[236:237], v216 offset:26624
    v_mfma_f32_16x16x32_bf16 v[60:63], a[196:199], a[100:103], v[60:63]
    ds_read_b64_tr_b16 a[238:239], v217 offset:26624
    v_mfma_f32_16x16x32_bf16 v[48:51], a[200:203], a[96:99], v[48:51]
    buffer_load_dwordx4 v226, s[60:63], s81 offen offset:2048 lds
    v_mfma_f32_16x16x32_bf16 v[52:55], a[200:203], a[100:103], v[52:55]
    ds_read_b64_tr_b16 a[192:193], v210 offset:27648
    ds_read_b64_tr_b16 a[194:195], v211 offset:27648
    v_mfma_f32_16x16x32_bf16 v[64:67], a[204:207], a[96:99], v[64:67]
    ds_read_b64_tr_b16 a[196:197], v214 offset:27648
    v_mfma_f32_16x16x32_bf16 v[68:71], a[204:207], a[100:103], v[68:71]
    ds_read_b64_tr_b16 a[198:199], v215 offset:27648
    s_waitcnt lgkmcnt(12)
    v_mfma_f32_16x16x32_bf16 v[40:43], a[208:211], a[104:107], v[40:43]
    s_waitcnt vmcnt(16)
    s_mov_b64 exec, 1
    global_store_dword v222, v223, s[48:49] offset:1024 sc1
    s_mov_b64 exec, -1
    v_mfma_f32_16x16x32_bf16 v[44:47], a[208:211], a[108:111], v[44:47]
    ds_read_b64_tr_b16 a[200:201], v212 offset:27648
    ds_read_b64_tr_b16 a[202:203], v213 offset:27648
    v_mfma_f32_16x16x32_bf16 v[56:59], a[212:215], a[104:107], v[56:59]
    ds_read_b64_tr_b16 a[204:205], v216 offset:27648
    v_mfma_f32_16x16x32_bf16 v[60:63], a[212:215], a[108:111], v[60:63]
    ds_read_b64_tr_b16 a[206:207], v217 offset:27648
    v_mfma_f32_16x16x32_bf16 v[48:51], a[216:219], a[104:107], v[48:51]
    ds_read_b64_tr_b16 a[208:209], v210 offset:28672
    v_mfma_f32_16x16x32_bf16 v[52:55], a[216:219], a[108:111], v[52:55]
    ds_read_b64_tr_b16 a[210:211], v211 offset:28672
    v_mfma_f32_16x16x32_bf16 v[64:67], a[220:223], a[104:107], v[64:67]
    ds_read_b64_tr_b16 a[212:213], v214 offset:28672
    v_mfma_f32_16x16x32_bf16 v[68:71], a[220:223], a[108:111], v[68:71]
    ds_read_b64_tr_b16 a[214:215], v215 offset:28672
    s_waitcnt lgkmcnt(12)
    v_mfma_f32_16x16x32_bf16 v[40:43], a[224:227], a[112:115], v[40:43]
    ds_read_b64_tr_b16 a[216:217], v212 offset:28672
    v_mfma_f32_16x16x32_bf16 v[44:47], a[224:227], a[116:119], v[44:47]
    ds_read_b64_tr_b16 a[218:219], v213 offset:28672
    v_mfma_f32_16x16x32_bf16 v[56:59], a[228:231], a[112:115], v[56:59]
    ds_read_b64_tr_b16 a[220:221], v216 offset:28672
    v_mfma_f32_16x16x32_bf16 v[60:63], a[228:231], a[116:119], v[60:63]
    ds_read_b64_tr_b16 a[222:223], v217 offset:28672
    v_mfma_f32_16x16x32_bf16 v[48:51], a[232:235], a[112:115], v[48:51]
    ds_read_b64_tr_b16 a[224:225], v210 offset:29696
    v_mfma_f32_16x16x32_bf16 v[52:55], a[232:235], a[116:119], v[52:55]
    ds_read_b64_tr_b16 a[226:227], v211 offset:29696
    v_mfma_f32_16x16x32_bf16 v[64:67], a[236:239], a[112:115], v[64:67]
    ds_read_b64_tr_b16 a[228:229], v214 offset:29696
    v_mfma_f32_16x16x32_bf16 v[68:71], a[236:239], a[116:119], v[68:71]
    ds_read_b64_tr_b16 a[230:231], v215 offset:29696
    s_waitcnt lgkmcnt(12)
    v_mfma_f32_16x16x32_bf16 v[40:43], a[192:195], a[120:123], v[40:43]
    ds_read_b64_tr_b16 a[232:233], v212 offset:29696
    v_mfma_f32_16x16x32_bf16 v[44:47], a[192:195], a[124:127], v[44:47]
    ds_read_b64_tr_b16 a[234:235], v213 offset:29696
    v_mfma_f32_16x16x32_bf16 v[56:59], a[196:199], a[120:123], v[56:59]
    ds_read_b64_tr_b16 a[236:237], v216 offset:29696
    v_mfma_f32_16x16x32_bf16 v[60:63], a[196:199], a[124:127], v[60:63]
    ds_read_b64_tr_b16 a[238:239], v217 offset:29696
    v_mfma_f32_16x16x32_bf16 v[48:51], a[200:203], a[120:123], v[48:51]
    s_barrier
    ds_read_b64_tr_b16 a[192:193], v210 offset:30720
    v_mfma_f32_16x16x32_bf16 v[52:55], a[200:203], a[124:127], v[52:55]
    s_add_u32 m0, s52, 15360
    ds_read_b64_tr_b16 a[194:195], v211 offset:30720
    v_mfma_f32_16x16x32_bf16 v[64:67], a[204:207], a[120:123], v[64:67]
    s_add_u32 s81, s24, 896
    ds_read_b64_tr_b16 a[196:197], v214 offset:30720
    v_mfma_f32_16x16x32_bf16 v[68:71], a[204:207], a[124:127], v[68:71]
    ds_read_b64_tr_b16 a[198:199], v215 offset:30720
    s_waitcnt lgkmcnt(12)
    v_mfma_f32_16x16x32_bf16 v[40:43], a[208:211], a[128:131], v[40:43]
    buffer_load_dwordx4 v208, s[60:63], s81 offen offset:0 lds
    v_mfma_f32_16x16x32_bf16 v[44:47], a[208:211], a[132:135], v[44:47]
    ds_read_b64_tr_b16 a[200:201], v212 offset:30720
    ds_read_b64_tr_b16 a[202:203], v213 offset:30720
    v_mfma_f32_16x16x32_bf16 v[56:59], a[212:215], a[128:131], v[56:59]
    ds_read_b64_tr_b16 a[204:205], v216 offset:30720
    v_mfma_f32_16x16x32_bf16 v[60:63], a[212:215], a[132:135], v[60:63]
    ds_read_b64_tr_b16 a[206:207], v217 offset:30720
    v_mfma_f32_16x16x32_bf16 v[48:51], a[216:219], a[128:131], v[48:51]
    buffer_load_dwordx4 v225, s[60:63], s81 offen offset:1024 lds
    v_mfma_f32_16x16x32_bf16 v[52:55], a[216:219], a[132:135], v[52:55]
    ds_read_b64_tr_b16 a[208:209], v210 offset:31744
    ds_read_b64_tr_b16 a[210:211], v211 offset:31744
    v_mfma_f32_16x16x32_bf16 v[64:67], a[220:223], a[128:131], v[64:67]
    ds_read_b64_tr_b16 a[212:213], v214 offset:31744
    v_mfma_f32_16x16x32_bf16 v[68:71], a[220:223], a[132:135], v[68:71]
    ds_read_b64_tr_b16 a[214:215], v215 offset:31744
    s_waitcnt lgkmcnt(12)
    v_mfma_f32_16x16x32_bf16 v[40:43], a[224:227], a[136:139], v[40:43]
    buffer_load_dwordx4 v226, s[60:63], s81 offen offset:2048 lds
    v_mfma_f32_16x16x32_bf16 v[44:47], a[224:227], a[140:143], v[44:47]
    ds_read_b64_tr_b16 a[216:217], v212 offset:31744
    ds_read_b64_tr_b16 a[218:219], v213 offset:31744
    v_mfma_f32_16x16x32_bf16 v[56:59], a[228:231], a[136:139], v[56:59]
    ds_read_b64_tr_b16 a[220:221], v216 offset:31744
    v_mfma_f32_16x16x32_bf16 v[60:63], a[228:231], a[140:143], v[60:63]
    ds_read_b64_tr_b16 a[222:223], v217 offset:31744
    v_mfma_f32_16x16x32_bf16 v[48:51], a[232:235], a[136:139], v[48:51]
    ds_read_b64_tr_b16 a[224:225], v210 offset:32768
    v_mfma_f32_16x16x32_bf16 v[52:55], a[232:235], a[140:143], v[52:55]
    ds_read_b64_tr_b16 a[226:227], v211 offset:32768
    v_mfma_f32_16x16x32_bf16 v[64:67], a[236:239], a[136:139], v[64:67]
    ds_read_b64_tr_b16 a[228:229], v214 offset:32768
    v_mfma_f32_16x16x32_bf16 v[68:71], a[236:239], a[140:143], v[68:71]
    ds_read_b64_tr_b16 a[230:231], v215 offset:32768
    s_waitcnt lgkmcnt(12)
    v_mfma_f32_16x16x32_bf16 v[72:75], a[192:195], a[0:3], 0
    s_add_u32 m0, s52, 18432
    ds_read_b64_tr_b16 a[232:233], v212 offset:32768
    v_mfma_f32_16x16x32_bf16 v[76:79], a[192:195], a[4:7], 0
    s_add_u32 s81, s25, 896
    ds_read_b64_tr_b16 a[234:235], v213 offset:32768
    v_mfma_f32_16x16x32_bf16 v[88:91], a[196:199], a[0:3], 0
    buffer_load_dwordx4 v208, s[60:63], s81 offen offset:0 lds
    v_mfma_f32_16x16x32_bf16 v[92:95], a[196:199], a[4:7], 0
    ds_read_b64_tr_b16 a[236:237], v216 offset:32768
    ds_read_b64_tr_b16 a[238:239], v217 offset:32768
    v_mfma_f32_16x16x32_bf16 v[80:83], a[200:203], a[0:3], 0
    ds_read_b64_tr_b16 a[192:193], v210 offset:33792
    v_cvt_pk_bf16_f32 v40, v40, v41
    v_mfma_f32_16x16x32_bf16 v[84:87], a[200:203], a[4:7], 0
    ds_read_b64_tr_b16 a[194:195], v211 offset:33792
    v_cvt_pk_bf16_f32 v41, v42, v43
    v_mfma_f32_16x16x32_bf16 v[96:99], a[204:207], a[0:3], 0
    ds_read_b64_tr_b16 a[196:197], v214 offset:33792
    v_cvt_pk_bf16_f32 v42, v44, v45
    v_mfma_f32_16x16x32_bf16 v[100:103], a[204:207], a[4:7], 0
    ds_read_b64_tr_b16 a[198:199], v215 offset:33792
    s_waitcnt lgkmcnt(12)
    v_mfma_f32_16x16x32_bf16 v[72:75], a[208:211], a[8:11], v[72:75]
    buffer_load_dwordx4 v225, s[60:63], s81 offen offset:1024 lds
    v_mfma_f32_16x16x32_bf16 v[76:79], a[208:211], a[12:15], v[76:79]
    v_cvt_pk_bf16_f32 v43, v46, v47
    s_add_u32 s55, s82, 149504
    v_mfma_f32_16x16x32_bf16 v[88:91], a[212:215], a[8:11], v[88:91]
    ds_read_b64_tr_b16 a[200:201], v212 offset:33792
    ds_read_b64_tr_b16 a[202:203], v213 offset:33792
    v_mfma_f32_16x16x32_bf16 v[92:95], a[212:215], a[12:15], v[92:95]
    ds_read_b64_tr_b16 a[204:205], v216 offset:33792
    ds_read_b64_tr_b16 a[206:207], v217 offset:33792
    v_mfma_f32_16x16x32_bf16 v[80:83], a[216:219], a[8:11], v[80:83]
    buffer_load_dwordx4 v226, s[60:63], s81 offen offset:2048 lds
    v_mfma_f32_16x16x32_bf16 v[84:87], a[216:219], a[12:15], v[84:87]
    buffer_store_dwordx4 v[40:43], v1, s[72:75], s55 offen sc1
    ds_read_b64_tr_b16 a[208:209], v210 offset:34816
    v_mfma_f32_16x16x32_bf16 v[96:99], a[220:223], a[8:11], v[96:99]
    ds_read_b64_tr_b16 a[210:211], v211 offset:34816
    ds_read_b64_tr_b16 a[212:213], v214 offset:34816
    v_mfma_f32_16x16x32_bf16 v[100:103], a[220:223], a[12:15], v[100:103]
    ds_read_b64_tr_b16 a[214:215], v215 offset:34816
    s_waitcnt lgkmcnt(12)
    v_mfma_f32_16x16x32_bf16 v[72:75], a[224:227], a[16:19], v[72:75]
    ds_read_b64_tr_b16 a[216:217], v212 offset:34816
    v_cvt_pk_bf16_f32 v48, v48, v49
    v_mfma_f32_16x16x32_bf16 v[76:79], a[224:227], a[20:23], v[76:79]
    ds_read_b64_tr_b16 a[218:219], v213 offset:34816
    v_cvt_pk_bf16_f32 v49, v50, v51
    v_mfma_f32_16x16x32_bf16 v[88:91], a[228:231], a[16:19], v[88:91]
    ds_read_b64_tr_b16 a[220:221], v216 offset:34816
    v_cvt_pk_bf16_f32 v50, v52, v53
    v_mfma_f32_16x16x32_bf16 v[92:95], a[228:231], a[20:23], v[92:95]
    ds_read_b64_tr_b16 a[222:223], v217 offset:34816
    v_cvt_pk_bf16_f32 v51, v54, v55
    v_mfma_f32_16x16x32_bf16 v[80:83], a[232:235], a[16:19], v[80:83]
    s_add_u32 m0, s52, 21504
    ds_read_b64_tr_b16 a[224:225], v210 offset:35840
    v_mfma_f32_16x16x32_bf16 v[84:87], a[232:235], a[20:23], v[84:87]
    s_add_u32 s81, s26, 896
    ds_read_b64_tr_b16 a[226:227], v211 offset:35840
    v_mfma_f32_16x16x32_bf16 v[96:99], a[236:239], a[16:19], v[96:99]
    s_add_u32 s55, s82, 148480
    ds_read_b64_tr_b16 a[228:229], v214 offset:35840
    v_mfma_f32_16x16x32_bf16 v[100:103], a[236:239], a[20:23], v[100:103]
    ds_read_b64_tr_b16 a[230:231], v215 offset:35840
    s_waitcnt lgkmcnt(12)
    v_mfma_f32_16x16x32_bf16 v[72:75], a[192:195], a[24:27], v[72:75]
    buffer_load_dwordx4 v208, s[60:63], s81 offen offset:0 lds
    v_mfma_f32_16x16x32_bf16 v[76:79], a[192:195], a[28:31], v[76:79]
    buffer_store_dwordx4 v[48:51], v1, s[72:75], s55 offen sc1
    ds_read_b64_tr_b16 a[232:233], v212 offset:35840
    v_mfma_f32_16x16x32_bf16 v[88:91], a[196:199], a[24:27], v[88:91]
    ds_read_b64_tr_b16 a[234:235], v213 offset:35840
    ds_read_b64_tr_b16 a[236:237], v216 offset:35840
    v_mfma_f32_16x16x32_bf16 v[92:95], a[196:199], a[28:31], v[92:95]
    ds_read_b64_tr_b16 a[238:239], v217 offset:35840
    v_mfma_f32_16x16x32_bf16 v[80:83], a[200:203], a[24:27], v[80:83]
    buffer_load_dwordx4 v225, s[60:63], s81 offen offset:1024 lds
    v_mfma_f32_16x16x32_bf16 v[84:87], a[200:203], a[28:31], v[84:87]
    ds_read_b64_tr_b16 a[192:193], v210 offset:36864
    v_cvt_pk_bf16_f32 v56, v56, v57
    v_mfma_f32_16x16x32_bf16 v[96:99], a[204:207], a[24:27], v[96:99]
    ds_read_b64_tr_b16 a[194:195], v211 offset:36864
    ds_read_b64_tr_b16 a[196:197], v214 offset:36864
    v_mfma_f32_16x16x32_bf16 v[100:103], a[204:207], a[28:31], v[100:103]
    ds_read_b64_tr_b16 a[198:199], v215 offset:36864
    s_waitcnt lgkmcnt(12)
    v_mfma_f32_16x16x32_bf16 v[72:75], a[208:211], a[32:35], v[72:75]
    buffer_load_dwordx4 v226, s[60:63], s81 offen offset:2048 lds
    v_mfma_f32_16x16x32_bf16 v[76:79], a[208:211], a[36:39], v[76:79]
    v_cvt_pk_bf16_f32 v57, v58, v59
    v_cvt_pk_bf16_f32 v58, v60, v61
    v_mfma_f32_16x16x32_bf16 v[88:91], a[212:215], a[32:35], v[88:91]
    ds_read_b64_tr_b16 a[200:201], v212 offset:36864
    ds_read_b64_tr_b16 a[202:203], v213 offset:36864
    v_mfma_f32_16x16x32_bf16 v[92:95], a[212:215], a[36:39], v[92:95]
    ds_read_b64_tr_b16 a[204:205], v216 offset:36864
    ds_read_b64_tr_b16 a[206:207], v217 offset:36864
    v_mfma_f32_16x16x32_bf16 v[80:83], a[216:219], a[32:35], v[80:83]
    ds_read_b64_tr_b16 a[208:209], v210 offset:37888
    v_cvt_pk_bf16_f32 v59, v62, v63
    v_mfma_f32_16x16x32_bf16 v[84:87], a[216:219], a[36:39], v[84:87]
    s_add_u32 s55, s82, 174080
    ds_read_b64_tr_b16 a[210:211], v211 offset:37888
    v_mfma_f32_16x16x32_bf16 v[96:99], a[220:223], a[32:35], v[96:99]
    buffer_store_dwordx4 v[56:59], v1, s[72:75], s55 offen sc1
    ds_read_b64_tr_b16 a[212:213], v214 offset:37888
    v_mfma_f32_16x16x32_bf16 v[100:103], a[220:223], a[36:39], v[100:103]
    ds_read_b64_tr_b16 a[214:215], v215 offset:37888
    s_waitcnt lgkmcnt(12)
    v_mfma_f32_16x16x32_bf16 v[72:75], a[224:227], a[40:43], v[72:75]
    s_add_u32 m0, s52, 24576
    ds_read_b64_tr_b16 a[216:217], v212 offset:37888
    v_mfma_f32_16x16x32_bf16 v[76:79], a[224:227], a[44:47], v[76:79]
    s_add_u32 s81, s27, 896
    ds_read_b64_tr_b16 a[218:219], v213 offset:37888
    v_mfma_f32_16x16x32_bf16 v[88:91], a[228:231], a[40:43], v[88:91]
    buffer_load_dwordx4 v208, s[60:63], s81 offen offset:0 lds
    v_mfma_f32_16x16x32_bf16 v[92:95], a[228:231], a[44:47], v[92:95]
    ds_read_b64_tr_b16 a[220:221], v216 offset:37888
    ds_read_b64_tr_b16 a[222:223], v217 offset:37888
    v_mfma_f32_16x16x32_bf16 v[80:83], a[232:235], a[40:43], v[80:83]
    ds_read_b64_tr_b16 a[224:225], v210 offset:38912
    v_cvt_pk_bf16_f32 v64, v64, v65
    v_mfma_f32_16x16x32_bf16 v[84:87], a[232:235], a[44:47], v[84:87]
    ds_read_b64_tr_b16 a[226:227], v211 offset:38912
    v_cvt_pk_bf16_f32 v65, v66, v67
    v_mfma_f32_16x16x32_bf16 v[96:99], a[236:239], a[40:43], v[96:99]
    ds_read_b64_tr_b16 a[228:229], v214 offset:38912
    v_cvt_pk_bf16_f32 v66, v68, v69
    v_mfma_f32_16x16x32_bf16 v[100:103], a[236:239], a[44:47], v[100:103]
    ds_read_b64_tr_b16 a[230:231], v215 offset:38912
    s_waitcnt lgkmcnt(12)
    v_mfma_f32_16x16x32_bf16 v[72:75], a[192:195], a[48:51], v[72:75]
    buffer_load_dwordx4 v225, s[60:63], s81 offen offset:1024 lds
    v_mfma_f32_16x16x32_bf16 v[76:79], a[192:195], a[52:55], v[76:79]
    v_cvt_pk_bf16_f32 v67, v70, v71
    s_add_u32 s55, s82, 173056
    v_mfma_f32_16x16x32_bf16 v[88:91], a[196:199], a[48:51], v[88:91]
    ds_read_b64_tr_b16 a[232:233], v212 offset:38912
    ds_read_b64_tr_b16 a[234:235], v213 offset:38912
    v_mfma_f32_16x16x32_bf16 v[92:95], a[196:199], a[52:55], v[92:95]
    ds_read_b64_tr_b16 a[236:237], v216 offset:38912
    ds_read_b64_tr_b16 a[238:239], v217 offset:38912
    v_mfma_f32_16x16x32_bf16 v[80:83], a[200:203], a[48:51], v[80:83]
    buffer_load_dwordx4 v226, s[60:63], s81 offen offset:2048 lds
    v_mfma_f32_16x16x32_bf16 v[84:87], a[200:203], a[52:55], v[84:87]
    buffer_store_dwordx4 v[64:67], v1, s[72:75], s55 offen sc1
    ds_read_b64_tr_b16 a[192:193], v210 offset:0
    v_mfma_f32_16x16x32_bf16 v[96:99], a[204:207], a[48:51], v[96:99]
    ds_read_b64_tr_b16 a[194:195], v211 offset:0
    ds_read_b64_tr_b16 a[196:197], v214 offset:0
    v_mfma_f32_16x16x32_bf16 v[100:103], a[204:207], a[52:55], v[100:103]
    ds_read_b64_tr_b16 a[198:199], v215 offset:0
    s_waitcnt lgkmcnt(12)
    v_mfma_f32_16x16x32_bf16 v[72:75], a[208:211], a[56:59], v[72:75]
    ds_read_b64_tr_b16 a[200:201], v212 offset:0
    v_mfma_f32_16x16x32_bf16 v[76:79], a[208:211], a[60:63], v[76:79]
    ds_read_b64_tr_b16 a[202:203], v213 offset:0
    v_mfma_f32_16x16x32_bf16 v[88:91], a[212:215], a[56:59], v[88:91]
    ds_read_b64_tr_b16 a[204:205], v216 offset:0
    v_mfma_f32_16x16x32_bf16 v[92:95], a[212:215], a[60:63], v[92:95]
    ds_read_b64_tr_b16 a[206:207], v217 offset:0
    v_mfma_f32_16x16x32_bf16 v[80:83], a[216:219], a[56:59], v[80:83]
    ds_read_b64_tr_b16 a[208:209], v210 offset:1024
    v_mfma_f32_16x16x32_bf16 v[84:87], a[216:219], a[60:63], v[84:87]
    ds_read_b64_tr_b16 a[210:211], v211 offset:1024
    v_mfma_f32_16x16x32_bf16 v[96:99], a[220:223], a[56:59], v[96:99]
    ds_read_b64_tr_b16 a[212:213], v214 offset:1024
    v_mfma_f32_16x16x32_bf16 v[100:103], a[220:223], a[60:63], v[100:103]
    ds_read_b64_tr_b16 a[214:215], v215 offset:1024
    s_waitcnt lgkmcnt(12)
    v_mfma_f32_16x16x32_bf16 v[72:75], a[224:227], a[64:67], v[72:75]
    ds_read_b64_tr_b16 a[216:217], v212 offset:1024
    v_mfma_f32_16x16x32_bf16 v[76:79], a[224:227], a[68:71], v[76:79]
    ds_read_b64_tr_b16 a[218:219], v213 offset:1024
    v_mfma_f32_16x16x32_bf16 v[88:91], a[228:231], a[64:67], v[88:91]
    ds_read_b64_tr_b16 a[220:221], v216 offset:1024
    v_mfma_f32_16x16x32_bf16 v[92:95], a[228:231], a[68:71], v[92:95]
    ds_read_b64_tr_b16 a[222:223], v217 offset:1024
    v_mfma_f32_16x16x32_bf16 v[80:83], a[232:235], a[64:67], v[80:83]
    ds_read_b64_tr_b16 a[224:225], v210 offset:2048
    v_mfma_f32_16x16x32_bf16 v[84:87], a[232:235], a[68:71], v[84:87]
    ds_read_b64_tr_b16 a[226:227], v211 offset:2048
    v_mfma_f32_16x16x32_bf16 v[96:99], a[236:239], a[64:67], v[96:99]
    ds_read_b64_tr_b16 a[228:229], v214 offset:2048
    v_mfma_f32_16x16x32_bf16 v[100:103], a[236:239], a[68:71], v[100:103]
    ds_read_b64_tr_b16 a[230:231], v215 offset:2048
    s_waitcnt lgkmcnt(12)
    v_mfma_f32_16x16x32_bf16 v[72:75], a[192:195], a[72:75], v[72:75]
    ds_read_b64_tr_b16 a[232:233], v212 offset:2048
    v_mfma_f32_16x16x32_bf16 v[76:79], a[192:195], a[76:79], v[76:79]
    ds_read_b64_tr_b16 a[234:235], v213 offset:2048
    v_mfma_f32_16x16x32_bf16 v[88:91], a[196:199], a[72:75], v[88:91]
    ds_read_b64_tr_b16 a[236:237], v216 offset:2048
    v_mfma_f32_16x16x32_bf16 v[92:95], a[196:199], a[76:79], v[92:95]
    ds_read_b64_tr_b16 a[238:239], v217 offset:2048
    v_mfma_f32_16x16x32_bf16 v[80:83], a[200:203], a[72:75], v[80:83]
    s_waitcnt vmcnt(17)
    s_barrier
    v_mfma_f32_16x16x32_bf16 v[84:87], a[200:203], a[76:79], v[84:87]
    s_add_u32 m0, s52, 27648
    ds_read_b64_tr_b16 a[192:193], v210 offset:3072
    v_mfma_f32_16x16x32_bf16 v[96:99], a[204:207], a[72:75], v[96:99]
    ds_read_b64_tr_b16 a[194:195], v211 offset:3072
    ds_read_b64_tr_b16 a[196:197], v214 offset:3072
    v_mfma_f32_16x16x32_bf16 v[100:103], a[204:207], a[76:79], v[100:103]
    ds_read_b64_tr_b16 a[198:199], v215 offset:3072
    s_waitcnt lgkmcnt(12)
    v_mfma_f32_16x16x32_bf16 v[72:75], a[208:211], a[80:83], v[72:75]
    s_add_u32 s81, s22, 1024
    ds_read_b64_tr_b16 a[200:201], v212 offset:3072
    v_mfma_f32_16x16x32_bf16 v[76:79], a[208:211], a[84:87], v[76:79]
    buffer_load_dwordx4 v208, s[60:63], s81 offen offset:0 lds
    v_mfma_f32_16x16x32_bf16 v[88:91], a[212:215], a[80:83], v[88:91]
    ds_read_b64_tr_b16 a[202:203], v213 offset:3072
    ds_read_b64_tr_b16 a[204:205], v216 offset:3072
    v_mfma_f32_16x16x32_bf16 v[92:95], a[212:215], a[84:87], v[92:95]
    ds_read_b64_tr_b16 a[206:207], v217 offset:3072
    v_mfma_f32_16x16x32_bf16 v[80:83], a[216:219], a[80:83], v[80:83]
    buffer_load_dwordx4 v225, s[60:63], s81 offen offset:1024 lds
    v_mfma_f32_16x16x32_bf16 v[84:87], a[216:219], a[84:87], v[84:87]
    ds_read_b64_tr_b16 a[208:209], v210 offset:4096
    ds_read_b64_tr_b16 a[210:211], v211 offset:4096
    v_mfma_f32_16x16x32_bf16 v[96:99], a[220:223], a[80:83], v[96:99]
    ds_read_b64_tr_b16 a[212:213], v214 offset:4096
    v_mfma_f32_16x16x32_bf16 v[100:103], a[220:223], a[84:87], v[100:103]
    ds_read_b64_tr_b16 a[214:215], v215 offset:4096
    s_waitcnt lgkmcnt(12)
    v_mfma_f32_16x16x32_bf16 v[72:75], a[224:227], a[88:91], v[72:75]
    buffer_load_dwordx4 v226, s[60:63], s81 offen offset:2048 lds
    v_mfma_f32_16x16x32_bf16 v[76:79], a[224:227], a[92:95], v[76:79]
    ds_read_b64_tr_b16 a[216:217], v212 offset:4096
    ds_read_b64_tr_b16 a[218:219], v213 offset:4096
    v_mfma_f32_16x16x32_bf16 v[88:91], a[228:231], a[88:91], v[88:91]
    ds_read_b64_tr_b16 a[220:221], v216 offset:4096
    v_mfma_f32_16x16x32_bf16 v[92:95], a[228:231], a[92:95], v[92:95]
    ds_read_b64_tr_b16 a[222:223], v217 offset:4096
    v_mfma_f32_16x16x32_bf16 v[80:83], a[232:235], a[88:91], v[80:83]
    ds_read_b64_tr_b16 a[224:225], v210 offset:5120
    s_branch L_sskip29
L_stub29:
    s_setpc_b64 s[100:101]
L_sskip29:
    v_mfma_f32_16x16x32_bf16 v[84:87], a[232:235], a[92:95], v[84:87]
    ds_read_b64_tr_b16 a[226:227], v211 offset:5120
    v_mfma_f32_16x16x32_bf16 v[96:99], a[236:239], a[88:91], v[96:99]
    ds_read_b64_tr_b16 a[228:229], v214 offset:5120
    v_mfma_f32_16x16x32_bf16 v[100:103], a[236:239], a[92:95], v[100:103]
    ds_read_b64_tr_b16 a[230:231], v215 offset:5120
    s_waitcnt lgkmcnt(12)
    v_mfma_f32_16x16x32_bf16 v[72:75], a[192:195], a[96:99], v[72:75]
    s_add_u32 m0, s52, 30720
    ds_read_b64_tr_b16 a[232:233], v212 offset:5120
    v_mfma_f32_16x16x32_bf16 v[76:79], a[192:195], a[100:103], v[76:79]
    s_add_u32 s81, s23, 1024
    ds_read_b64_tr_b16 a[234:235], v213 offset:5120
    v_mfma_f32_16x16x32_bf16 v[88:91], a[196:199], a[96:99], v[88:91]
    buffer_load_dwordx4 v208, s[60:63], s81 offen offset:0 lds
    v_mfma_f32_16x16x32_bf16 v[92:95], a[196:199], a[100:103], v[92:95]
    ds_read_b64_tr_b16 a[236:237], v216 offset:5120
    ds_read_b64_tr_b16 a[238:239], v217 offset:5120
    v_mfma_f32_16x16x32_bf16 v[80:83], a[200:203], a[96:99], v[80:83]
    ds_read_b64_tr_b16 a[192:193], v210 offset:6144
    v_mfma_f32_16x16x32_bf16 v[84:87], a[200:203], a[100:103], v[84:87]
    ds_read_b64_tr_b16 a[194:195], v211 offset:6144
    v_mfma_f32_16x16x32_bf16 v[96:99], a[204:207], a[96:99], v[96:99]
    ds_read_b64_tr_b16 a[196:197], v214 offset:6144
    v_mfma_f32_16x16x32_bf16 v[100:103], a[204:207], a[100:103], v[100:103]
    ds_read_b64_tr_b16 a[198:199], v215 offset:6144
    s_waitcnt lgkmcnt(12)
    v_mfma_f32_16x16x32_bf16 v[72:75], a[208:211], a[104:107], v[72:75]
    buffer_load_dwordx4 v225, s[60:63], s81 offen offset:1024 lds
    v_mfma_f32_16x16x32_bf16 v[76:79], a[208:211], a[108:111], v[76:79]
    ds_read_b64_tr_b16 a[200:201], v212 offset:6144
    ds_read_b64_tr_b16 a[202:203], v213 offset:6144
    v_mfma_f32_16x16x32_bf16 v[88:91], a[212:215], a[104:107], v[88:91]
    ds_read_b64_tr_b16 a[204:205], v216 offset:6144
    v_mfma_f32_16x16x32_bf16 v[92:95], a[212:215], a[108:111], v[92:95]
    ds_read_b64_tr_b16 a[206:207], v217 offset:6144
    v_mfma_f32_16x16x32_bf16 v[80:83], a[216:219], a[104:107], v[80:83]
    buffer_load_dwordx4 v226, s[60:63], s81 offen offset:2048 lds
    v_mfma_f32_16x16x32_bf16 v[84:87], a[216:219], a[108:111], v[84:87]
    ds_read_b64_tr_b16 a[208:209], v210 offset:7168
    ds_read_b64_tr_b16 a[210:211], v211 offset:7168
    v_mfma_f32_16x16x32_bf16 v[96:99], a[220:223], a[104:107], v[96:99]
    ds_read_b64_tr_b16 a[212:213], v214 offset:7168
    v_mfma_f32_16x16x32_bf16 v[100:103], a[220:223], a[108:111], v[100:103]
    ds_read_b64_tr_b16 a[214:215], v215 offset:7168
    s_waitcnt lgkmcnt(12)
    v_mfma_f32_16x16x32_bf16 v[72:75], a[224:227], a[112:115], v[72:75]
    ds_read_b64_tr_b16 a[216:217], v212 offset:7168
    v_mfma_f32_16x16x32_bf16 v[76:79], a[224:227], a[116:119], v[76:79]
    ds_read_b64_tr_b16 a[218:219], v213 offset:7168
    v_mfma_f32_16x16x32_bf16 v[88:91], a[228:231], a[112:115], v[88:91]
    ds_read_b64_tr_b16 a[220:221], v216 offset:7168
    v_mfma_f32_16x16x32_bf16 v[92:95], a[228:231], a[116:119], v[92:95]
    ds_read_b64_tr_b16 a[222:223], v217 offset:7168
    v_mfma_f32_16x16x32_bf16 v[80:83], a[232:235], a[112:115], v[80:83]
    s_add_u32 m0, s52, 33792
    ds_read_b64_tr_b16 a[224:225], v210 offset:8192
    v_mfma_f32_16x16x32_bf16 v[84:87], a[232:235], a[116:119], v[84:87]
    s_add_u32 s81, s24, 1024
    ds_read_b64_tr_b16 a[226:227], v211 offset:8192
    v_mfma_f32_16x16x32_bf16 v[96:99], a[236:239], a[112:115], v[96:99]
    ds_read_b64_tr_b16 a[228:229], v214 offset:8192
    v_mfma_f32_16x16x32_bf16 v[100:103], a[236:239], a[116:119], v[100:103]
    ds_read_b64_tr_b16 a[230:231], v215 offset:8192
    s_waitcnt lgkmcnt(12)
    v_mfma_f32_16x16x32_bf16 v[72:75], a[192:195], a[120:123], v[72:75]
    buffer_load_dwordx4 v208, s[60:63], s81 offen offset:0 lds
    v_mfma_f32_16x16x32_bf16 v[76:79], a[192:195], a[124:127], v[76:79]
    ds_read_b64_tr_b16 a[232:233], v212 offset:8192
    ds_read_b64_tr_b16 a[234:235], v213 offset:8192
    v_mfma_f32_16x16x32_bf16 v[88:91], a[196:199], a[120:123], v[88:91]
    ds_read_b64_tr_b16 a[236:237], v216 offset:8192
    v_mfma_f32_16x16x32_bf16 v[92:95], a[196:199], a[124:127], v[92:95]
    ds_read_b64_tr_b16 a[238:239], v217 offset:8192
    v_mfma_f32_16x16x32_bf16 v[80:83], a[200:203], a[120:123], v[80:83]
    buffer_load_dwordx4 v225, s[60:63], s81 offen offset:1024 lds
    v_mfma_f32_16x16x32_bf16 v[84:87], a[200:203], a[124:127], v[84:87]
    ds_read_b64_tr_b16 a[192:193], v210 offset:9216
    ds_read_b64_tr_b16 a[194:195], v211 offset:9216
    v_mfma_f32_16x16x32_bf16 v[96:99], a[204:207], a[120:123], v[96:99]
    ds_read_b64_tr_b16 a[196:197], v214 offset:9216
    v_mfma_f32_16x16x32_bf16 v[100:103], a[204:207], a[124:127], v[100:103]
    ds_read_b64_tr_b16 a[198:199], v215 offset:9216
    s_waitcnt lgkmcnt(12)
    v_mfma_f32_16x16x32_bf16 v[72:75], a[208:211], a[128:131], v[72:75]
    buffer_load_dwordx4 v226, s[60:63], s81 offen offset:2048 lds
    v_mfma_f32_16x16x32_bf16 v[76:79], a[208:211], a[132:135], v[76:79]
    ds_read_b64_tr_b16 a[200:201], v212 offset:9216
    ds_read_b64_tr_b16 a[202:203], v213 offset:9216
    v_mfma_f32_16x16x32_bf16 v[88:91], a[212:215], a[128:131], v[88:91]
    ds_read_b64_tr_b16 a[204:205], v216 offset:9216
    v_mfma_f32_16x16x32_bf16 v[92:95], a[212:215], a[132:135], v[92:95]
    ds_read_b64_tr_b16 a[206:207], v217 offset:9216
    v_mfma_f32_16x16x32_bf16 v[80:83], a[216:219], a[128:131], v[80:83]
    ds_read_b64_tr_b16 a[208:209], v210 offset:10240
    v_mfma_f32_16x16x32_bf16 v[84:87], a[216:219], a[132:135], v[84:87]
    ds_read_b64_tr_b16 a[210:211], v211 offset:10240
    v_mfma_f32_16x16x32_bf16 v[96:99], a[220:223], a[128:131], v[96:99]
    ds_read_b64_tr_b16 a[212:213], v214 offset:10240
    v_mfma_f32_16x16x32_bf16 v[100:103], a[220:223], a[132:135], v[100:103]
    ds_read_b64_tr_b16 a[214:215], v215 offset:10240
    s_waitcnt lgkmcnt(12)
    v_mfma_f32_16x16x32_bf16 v[72:75], a[224:227], a[136:139], v[72:75]
    s_add_u32 m0, s52, 36864
    ds_read_b64_tr_b16 a[216:217], v212 offset:10240
    v_mfma_f32_16x16x32_bf16 v[76:79], a[224:227], a[140:143], v[76:79]
    s_add_u32 s81, s25, 1024
    ds_read_b64_tr_b16 a[218:219], v213 offset:10240
    v_mfma_f32_16x16x32_bf16 v[88:91], a[228:231], a[136:139], v[88:91]
    buffer_load_dwordx4 v208, s[60:63], s81 offen offset:0 lds
    v_mfma_f32_16x16x32_bf16 v[92:95], a[228:231], a[140:143], v[92:95]
    ds_read_b64_tr_b16 a[220:221], v216 offset:10240
    ds_read_b64_tr_b16 a[222:223], v217 offset:10240
    v_mfma_f32_16x16x32_bf16 v[80:83], a[232:235], a[136:139], v[80:83]
    ds_read_b64_tr_b16 a[224:225], v210 offset:11264
    v_mfma_f32_16x16x32_bf16 v[84:87], a[232:235], a[140:143], v[84:87]
    ds_read_b64_tr_b16 a[226:227], v211 offset:11264
    v_mfma_f32_16x16x32_bf16 v[96:99], a[236:239], a[136:139], v[96:99]
    ds_read_b64_tr_b16 a[228:229], v214 offset:11264
    v_mfma_f32_16x16x32_bf16 v[100:103], a[236:239], a[140:143], v[100:103]
    ds_read_b64_tr_b16 a[230:231], v215 offset:11264
    s_waitcnt lgkmcnt(12)
    v_mfma_f32_16x16x32_bf16 v[104:107], a[192:195], a[0:3], 0
    buffer_load_dwordx4 v225, s[60:63], s81 offen offset:1024 lds
    v_mfma_f32_16x16x32_bf16 v[108:111], a[192:195], a[4:7], 0
    ds_read_b64_tr_b16 a[232:233], v212 offset:11264
    ds_read_b64_tr_b16 a[234:235], v213 offset:11264
    v_mfma_f32_16x16x32_bf16 v[120:123], a[196:199], a[0:3], 0
    ds_read_b64_tr_b16 a[236:237], v216 offset:11264
    v_mfma_f32_16x16x32_bf16 v[124:127], a[196:199], a[4:7], 0
    ds_read_b64_tr_b16 a[238:239], v217 offset:11264
    v_mfma_f32_16x16x32_bf16 v[112:115], a[200:203], a[0:3], 0
    s_waitcnt vmcnt(11)
    s_mov_b64 exec, 1
    global_store_dword v222, v223, s[48:49] offset:512 sc1
    s_mov_b64 exec, -1
    v_mfma_f32_16x16x32_bf16 v[116:119], a[200:203], a[4:7], 0
    ds_read_b64_tr_b16 a[192:193], v210 offset:12288
    v_cvt_pk_bf16_f32 v72, v72, v73
    v_mfma_f32_16x16x32_bf16 v[128:131], a[204:207], a[0:3], 0
    ds_read_b64_tr_b16 a[194:195], v211 offset:12288
    ds_read_b64_tr_b16 a[196:197], v214 offset:12288
    v_mfma_f32_16x16x32_bf16 v[132:135], a[204:207], a[4:7], 0
    ds_read_b64_tr_b16 a[198:199], v215 offset:12288
    s_waitcnt lgkmcnt(12)
    v_mfma_f32_16x16x32_bf16 v[104:107], a[208:211], a[8:11], v[104:107]
    buffer_load_dwordx4 v226, s[60:63], s81 offen offset:2048 lds
    v_mfma_f32_16x16x32_bf16 v[108:111], a[208:211], a[12:15], v[108:111]
    v_cvt_pk_bf16_f32 v73, v74, v75
    v_cvt_pk_bf16_f32 v74, v76, v77
    v_mfma_f32_16x16x32_bf16 v[120:123], a[212:215], a[8:11], v[120:123]
    ds_read_b64_tr_b16 a[200:201], v212 offset:12288
    ds_read_b64_tr_b16 a[202:203], v213 offset:12288
    v_mfma_f32_16x16x32_bf16 v[124:127], a[212:215], a[12:15], v[124:127]
    ds_read_b64_tr_b16 a[204:205], v216 offset:12288
    ds_read_b64_tr_b16 a[206:207], v217 offset:12288
    v_mfma_f32_16x16x32_bf16 v[112:115], a[216:219], a[8:11], v[112:115]
    ds_read_b64_tr_b16 a[208:209], v210 offset:13312
    v_cvt_pk_bf16_f32 v75, v78, v79
    v_mfma_f32_16x16x32_bf16 v[116:119], a[216:219], a[12:15], v[116:119]
    s_add_u32 s55, s82, 197632
    ds_read_b64_tr_b16 a[210:211], v211 offset:13312
    v_mfma_f32_16x16x32_bf16 v[128:131], a[220:223], a[8:11], v[128:131]
    buffer_store_dwordx4 v[72:75], v1, s[72:75], s55 offen sc1
    ds_read_b64_tr_b16 a[212:213], v214 offset:13312
    v_mfma_f32_16x16x32_bf16 v[132:135], a[220:223], a[12:15], v[132:135]
    ds_read_b64_tr_b16 a[214:215], v215 offset:13312
    s_waitcnt lgkmcnt(12)
    v_mfma_f32_16x16x32_bf16 v[104:107], a[224:227], a[16:19], v[104:107]
    ds_read_b64_tr_b16 a[216:217], v212 offset:13312
    v_cvt_pk_bf16_f32 v80, v80, v81
    v_mfma_f32_16x16x32_bf16 v[108:111], a[224:227], a[20:23], v[108:111]
    ds_read_b64_tr_b16 a[218:219], v213 offset:13312
    v_cvt_pk_bf16_f32 v81, v82, v83
    v_mfma_f32_16x16x32_bf16 v[120:123], a[228:231], a[16:19], v[120:123]
    ds_read_b64_tr_b16 a[220:221], v216 offset:13312
    v_cvt_pk_bf16_f32 v82, v84, v85
    v_mfma_f32_16x16x32_bf16 v[124:127], a[228:231], a[20:23], v[124:127]
    ds_read_b64_tr_b16 a[222:223], v217 offset:13312
    v_cvt_pk_bf16_f32 v83, v86, v87
    v_mfma_f32_16x16x32_bf16 v[112:115], a[232:235], a[16:19], v[112:115]
    s_add_u32 s55, s82, 198656
    ds_read_b64_tr_b16 a[224:225], v210 offset:14336
    v_mfma_f32_16x16x32_bf16 v[116:119], a[232:235], a[20:23], v[116:119]
    buffer_store_dwordx4 v[80:83], v1, s[72:75], s55 offen sc1
    ds_read_b64_tr_b16 a[226:227], v211 offset:14336
    v_mfma_f32_16x16x32_bf16 v[128:131], a[236:239], a[16:19], v[128:131]
    ds_read_b64_tr_b16 a[228:229], v214 offset:14336
    v_mfma_f32_16x16x32_bf16 v[132:135], a[236:239], a[20:23], v[132:135]
    ds_read_b64_tr_b16 a[230:231], v215 offset:14336
    s_waitcnt lgkmcnt(12)
    v_mfma_f32_16x16x32_bf16 v[104:107], a[192:195], a[24:27], v[104:107]
    ds_read_b64_tr_b16 a[232:233], v212 offset:14336
    v_cvt_pk_bf16_f32 v88, v88, v89
    v_mfma_f32_16x16x32_bf16 v[108:111], a[192:195], a[28:31], v[108:111]
    ds_read_b64_tr_b16 a[234:235], v213 offset:14336
    v_cvt_pk_bf16_f32 v89, v90, v91
    v_mfma_f32_16x16x32_bf16 v[120:123], a[196:199], a[24:27], v[120:123]
    ds_read_b64_tr_b16 a[236:237], v216 offset:14336
    v_cvt_pk_bf16_f32 v90, v92, v93
    v_mfma_f32_16x16x32_bf16 v[124:127], a[196:199], a[28:31], v[124:127]
    ds_read_b64_tr_b16 a[238:239], v217 offset:14336
    v_cvt_pk_bf16_f32 v91, v94, v95
    v_mfma_f32_16x16x32_bf16 v[112:115], a[200:203], a[24:27], v[112:115]
    s_barrier
    ds_read_b64_tr_b16 a[192:193], v210 offset:15360
    v_mfma_f32_16x16x32_bf16 v[116:119], a[200:203], a[28:31], v[116:119]
    s_add_u32 m0, s52, 0
    ds_read_b64_tr_b16 a[194:195], v211 offset:15360
    v_mfma_f32_16x16x32_bf16 v[128:131], a[204:207], a[24:27], v[128:131]
    s_add_u32 s81, s26, 1024
    ds_read_b64_tr_b16 a[196:197], v214 offset:15360
    v_mfma_f32_16x16x32_bf16 v[132:135], a[204:207], a[28:31], v[132:135]
    ds_read_b64_tr_b16 a[198:199], v215 offset:15360
    s_waitcnt lgkmcnt(12)
    v_mfma_f32_16x16x32_bf16 v[104:107], a[208:211], a[32:35], v[104:107]
    buffer_load_dwordx4 v208, s[60:63], s81 offen offset:0 lds
    v_mfma_f32_16x16x32_bf16 v[108:111], a[208:211], a[36:39], v[108:111]
    s_add_u32 s55, s82, 222208
    ds_read_b64_tr_b16 a[200:201], v212 offset:15360
    v_mfma_f32_16x16x32_bf16 v[120:123], a[212:215], a[32:35], v[120:123]
    buffer_store_dwordx4 v[88:91], v1, s[72:75], s55 offen sc1
    ds_read_b64_tr_b16 a[202:203], v213 offset:15360
    v_mfma_f32_16x16x32_bf16 v[124:127], a[212:215], a[36:39], v[124:127]
    ds_read_b64_tr_b16 a[204:205], v216 offset:15360
    ds_read_b64_tr_b16 a[206:207], v217 offset:15360
    v_mfma_f32_16x16x32_bf16 v[112:115], a[216:219], a[32:35], v[112:115]
    buffer_load_dwordx4 v225, s[60:63], s81 offen offset:1024 lds
    v_mfma_f32_16x16x32_bf16 v[116:119], a[216:219], a[36:39], v[116:119]
    ds_read_b64_tr_b16 a[208:209], v210 offset:16384
    v_cvt_pk_bf16_f32 v96, v96, v97
    v_mfma_f32_16x16x32_bf16 v[128:131], a[220:223], a[32:35], v[128:131]
    ds_read_b64_tr_b16 a[210:211], v211 offset:16384
    ds_read_b64_tr_b16 a[212:213], v214 offset:16384
    v_mfma_f32_16x16x32_bf16 v[132:135], a[220:223], a[36:39], v[132:135]
    ds_read_b64_tr_b16 a[214:215], v215 offset:16384
    s_waitcnt lgkmcnt(12)
    v_mfma_f32_16x16x32_bf16 v[104:107], a[224:227], a[40:43], v[104:107]
    buffer_load_dwordx4 v226, s[60:63], s81 offen offset:2048 lds
    v_mfma_f32_16x16x32_bf16 v[108:111], a[224:227], a[44:47], v[108:111]
    v_cvt_pk_bf16_f32 v97, v98, v99
    v_cvt_pk_bf16_f32 v98, v100, v101
    v_mfma_f32_16x16x32_bf16 v[120:123], a[228:231], a[40:43], v[120:123]
    ds_read_b64_tr_b16 a[216:217], v212 offset:16384
    ds_read_b64_tr_b16 a[218:219], v213 offset:16384
    v_mfma_f32_16x16x32_bf16 v[124:127], a[228:231], a[44:47], v[124:127]
    ds_read_b64_tr_b16 a[220:221], v216 offset:16384
    ds_read_b64_tr_b16 a[222:223], v217 offset:16384
    v_mfma_f32_16x16x32_bf16 v[112:115], a[232:235], a[40:43], v[112:115]
    ds_read_b64_tr_b16 a[224:225], v210 offset:17408
    v_cvt_pk_bf16_f32 v99, v102, v103
    v_mfma_f32_16x16x32_bf16 v[116:119], a[232:235], a[44:47], v[116:119]
    s_add_u32 s55, s82, 223232
    ds_read_b64_tr_b16 a[226:227], v211 offset:17408
    v_mfma_f32_16x16x32_bf16 v[128:131], a[236:239], a[40:43], v[128:131]
    buffer_store_dwordx4 v[96:99], v1, s[72:75], s55 offen sc1
    ds_read_b64_tr_b16 a[228:229], v214 offset:17408
    v_mfma_f32_16x16x32_bf16 v[132:135], a[236:239], a[44:47], v[132:135]
    ds_read_b64_tr_b16 a[230:231], v215 offset:17408
    s_waitcnt lgkmcnt(12)
    v_mfma_f32_16x16x32_bf16 v[104:107], a[192:195], a[48:51], v[104:107]
    s_add_u32 m0, s52, 3072
    ds_read_b64_tr_b16 a[232:233], v212 offset:17408
    v_mfma_f32_16x16x32_bf16 v[108:111], a[192:195], a[52:55], v[108:111]
    s_add_u32 s81, s27, 1024
    ds_read_b64_tr_b16 a[234:235], v213 offset:17408
    v_mfma_f32_16x16x32_bf16 v[120:123], a[196:199], a[48:51], v[120:123]
    buffer_load_dwordx4 v208, s[60:63], s81 offen offset:0 lds
    v_mfma_f32_16x16x32_bf16 v[124:127], a[196:199], a[52:55], v[124:127]
    ds_read_b64_tr_b16 a[236:237], v216 offset:17408
    ds_read_b64_tr_b16 a[238:239], v217 offset:17408
    v_mfma_f32_16x16x32_bf16 v[112:115], a[200:203], a[48:51], v[112:115]
    ds_read_b64_tr_b16 a[192:193], v210 offset:18432
    v_mfma_f32_16x16x32_bf16 v[116:119], a[200:203], a[52:55], v[116:119]
    ds_read_b64_tr_b16 a[194:195], v211 offset:18432
    v_mfma_f32_16x16x32_bf16 v[128:131], a[204:207], a[48:51], v[128:131]
    ds_read_b64_tr_b16 a[196:197], v214 offset:18432
    v_mfma_f32_16x16x32_bf16 v[132:135], a[204:207], a[52:55], v[132:135]
    ds_read_b64_tr_b16 a[198:199], v215 offset:18432
    s_waitcnt lgkmcnt(12)
    v_mfma_f32_16x16x32_bf16 v[104:107], a[208:211], a[56:59], v[104:107]
    buffer_load_dwordx4 v225, s[60:63], s81 offen offset:1024 lds
    v_mfma_f32_16x16x32_bf16 v[108:111], a[208:211], a[60:63], v[108:111]
    ds_read_b64_tr_b16 a[200:201], v212 offset:18432
    ds_read_b64_tr_b16 a[202:203], v213 offset:18432
    v_mfma_f32_16x16x32_bf16 v[120:123], a[212:215], a[56:59], v[120:123]
    ds_read_b64_tr_b16 a[204:205], v216 offset:18432
    v_mfma_f32_16x16x32_bf16 v[124:127], a[212:215], a[60:63], v[124:127]
    ds_read_b64_tr_b16 a[206:207], v217 offset:18432
    v_mfma_f32_16x16x32_bf16 v[112:115], a[216:219], a[56:59], v[112:115]
    buffer_load_dwordx4 v226, s[60:63], s81 offen offset:2048 lds
    v_mfma_f32_16x16x32_bf16 v[116:119], a[216:219], a[60:63], v[116:119]
    ds_read_b64_tr_b16 a[208:209], v210 offset:19456
    ds_read_b64_tr_b16 a[210:211], v211 offset:19456
    v_mfma_f32_16x16x32_bf16 v[128:131], a[220:223], a[56:59], v[128:131]
    ds_read_b64_tr_b16 a[212:213], v214 offset:19456
    v_mfma_f32_16x16x32_bf16 v[132:135], a[220:223], a[60:63], v[132:135]
    ds_read_b64_tr_b16 a[214:215], v215 offset:19456
    s_waitcnt lgkmcnt(12)
    v_mfma_f32_16x16x32_bf16 v[104:107], a[224:227], a[64:67], v[104:107]
    ds_read_b64_tr_b16 a[216:217], v212 offset:19456
    v_mfma_f32_16x16x32_bf16 v[108:111], a[224:227], a[68:71], v[108:111]
    ds_read_b64_tr_b16 a[218:219], v213 offset:19456
    v_mfma_f32_16x16x32_bf16 v[120:123], a[228:231], a[64:67], v[120:123]
    ds_read_b64_tr_b16 a[220:221], v216 offset:19456
    v_mfma_f32_16x16x32_bf16 v[124:127], a[228:231], a[68:71], v[124:127]
    ds_read_b64_tr_b16 a[222:223], v217 offset:19456
    v_mfma_f32_16x16x32_bf16 v[112:115], a[232:235], a[64:67], v[112:115]
    ds_read_b64_tr_b16 a[224:225], v210 offset:20480
    v_mfma_f32_16x16x32_bf16 v[116:119], a[232:235], a[68:71], v[116:119]
    ds_read_b64_tr_b16 a[226:227], v211 offset:20480
    v_mfma_f32_16x16x32_bf16 v[128:131], a[236:239], a[64:67], v[128:131]
    ds_read_b64_tr_b16 a[228:229], v214 offset:20480
    v_mfma_f32_16x16x32_bf16 v[132:135], a[236:239], a[68:71], v[132:135]
    ds_read_b64_tr_b16 a[230:231], v215 offset:20480
    s_waitcnt lgkmcnt(12)
    v_mfma_f32_16x16x32_bf16 v[104:107], a[192:195], a[72:75], v[104:107]
    ds_read_b64_tr_b16 a[232:233], v212 offset:20480
    v_mfma_f32_16x16x32_bf16 v[108:111], a[192:195], a[76:79], v[108:111]
    ds_read_b64_tr_b16 a[234:235], v213 offset:20480
    v_mfma_f32_16x16x32_bf16 v[120:123], a[196:199], a[72:75], v[120:123]
    ds_read_b64_tr_b16 a[236:237], v216 offset:20480
    v_mfma_f32_16x16x32_bf16 v[124:127], a[196:199], a[76:79], v[124:127]
    ds_read_b64_tr_b16 a[238:239], v217 offset:20480
    v_mfma_f32_16x16x32_bf16 v[112:115], a[200:203], a[72:75], v[112:115]
    ds_read_b64_tr_b16 a[192:193], v210 offset:21504
    v_mfma_f32_16x16x32_bf16 v[116:119], a[200:203], a[76:79], v[116:119]
    ds_read_b64_tr_b16 a[194:195], v211 offset:21504
    v_mfma_f32_16x16x32_bf16 v[128:131], a[204:207], a[72:75], v[128:131]
    ds_read_b64_tr_b16 a[196:197], v214 offset:21504
    v_mfma_f32_16x16x32_bf16 v[132:135], a[204:207], a[76:79], v[132:135]
    ds_read_b64_tr_b16 a[198:199], v215 offset:21504
    s_waitcnt lgkmcnt(12)
    v_mfma_f32_16x16x32_bf16 v[104:107], a[208:211], a[80:83], v[104:107]
    ds_read_b64_tr_b16 a[200:201], v212 offset:21504
    v_mfma_f32_16x16x32_bf16 v[108:111], a[208:211], a[84:87], v[108:111]
    ds_read_b64_tr_b16 a[202:203], v213 offset:21504
    v_mfma_f32_16x16x32_bf16 v[120:123], a[212:215], a[80:83], v[120:123]
    ds_read_b64_tr_b16 a[204:205], v216 offset:21504
    v_mfma_f32_16x16x32_bf16 v[124:127], a[212:215], a[84:87], v[124:127]
    ds_read_b64_tr_b16 a[206:207], v217 offset:21504
    v_mfma_f32_16x16x32_bf16 v[112:115], a[216:219], a[80:83], v[112:115]
    ds_read_b64_tr_b16 a[208:209], v210 offset:22528
    v_mfma_f32_16x16x32_bf16 v[116:119], a[216:219], a[84:87], v[116:119]
    ds_read_b64_tr_b16 a[210:211], v211 offset:22528
    v_mfma_f32_16x16x32_bf16 v[128:131], a[220:223], a[80:83], v[128:131]
    ds_read_b64_tr_b16 a[212:213], v214 offset:22528
    v_mfma_f32_16x16x32_bf16 v[132:135], a[220:223], a[84:87], v[132:135]
    ds_read_b64_tr_b16 a[214:215], v215 offset:22528
    s_waitcnt lgkmcnt(12)
    v_mfma_f32_16x16x32_bf16 v[104:107], a[224:227], a[88:91], v[104:107]
    ds_read_b64_tr_b16 a[216:217], v212 offset:22528
    v_mfma_f32_16x16x32_bf16 v[108:111], a[224:227], a[92:95], v[108:111]
    ds_read_b64_tr_b16 a[218:219], v213 offset:22528
    v_mfma_f32_16x16x32_bf16 v[120:123], a[228:231], a[88:91], v[120:123]
    ds_read_b64_tr_b16 a[220:221], v216 offset:22528
    v_mfma_f32_16x16x32_bf16 v[124:127], a[228:231], a[92:95], v[124:127]
    ds_read_b64_tr_b16 a[222:223], v217 offset:22528
    v_mfma_f32_16x16x32_bf16 v[112:115], a[232:235], a[88:91], v[112:115]
    ds_read_b64_tr_b16 a[224:225], v210 offset:23552
    v_mfma_f32_16x16x32_bf16 v[116:119], a[232:235], a[92:95], v[116:119]
    ds_read_b64_tr_b16 a[226:227], v211 offset:23552
    v_mfma_f32_16x16x32_bf16 v[128:131], a[236:239], a[88:91], v[128:131]
    ds_read_b64_tr_b16 a[228:229], v214 offset:23552
    v_mfma_f32_16x16x32_bf16 v[132:135], a[236:239], a[92:95], v[132:135]
    ds_read_b64_tr_b16 a[230:231], v215 offset:23552
    s_waitcnt lgkmcnt(12)
    v_mfma_f32_16x16x32_bf16 v[104:107], a[192:195], a[96:99], v[104:107]
    ds_read_b64_tr_b16 a[232:233], v212 offset:23552
    v_mfma_f32_16x16x32_bf16 v[108:111], a[192:195], a[100:103], v[108:111]
    ds_read_b64_tr_b16 a[234:235], v213 offset:23552
    v_mfma_f32_16x16x32_bf16 v[120:123], a[196:199], a[96:99], v[120:123]
    ds_read_b64_tr_b16 a[236:237], v216 offset:23552
    v_mfma_f32_16x16x32_bf16 v[124:127], a[196:199], a[100:103], v[124:127]
    ds_read_b64_tr_b16 a[238:239], v217 offset:23552
    v_mfma_f32_16x16x32_bf16 v[112:115], a[200:203], a[96:99], v[112:115]
    ds_read_b64_tr_b16 a[192:193], v210 offset:24576
    v_mfma_f32_16x16x32_bf16 v[116:119], a[200:203], a[100:103], v[116:119]
    ds_read_b64_tr_b16 a[194:195], v211 offset:24576
    v_mfma_f32_16x16x32_bf16 v[128:131], a[204:207], a[96:99], v[128:131]
    ds_read_b64_tr_b16 a[196:197], v214 offset:24576
    v_mfma_f32_16x16x32_bf16 v[132:135], a[204:207], a[100:103], v[132:135]
    ds_read_b64_tr_b16 a[198:199], v215 offset:24576
    s_waitcnt lgkmcnt(12)
    v_mfma_f32_16x16x32_bf16 v[104:107], a[208:211], a[104:107], v[104:107]
    ds_read_b64_tr_b16 a[200:201], v212 offset:24576
    v_mfma_f32_16x16x32_bf16 v[108:111], a[208:211], a[108:111], v[108:111]
    ds_read_b64_tr_b16 a[202:203], v213 offset:24576
    v_mfma_f32_16x16x32_bf16 v[120:123], a[212:215], a[104:107], v[120:123]
    ds_read_b64_tr_b16 a[204:205], v216 offset:24576
    v_mfma_f32_16x16x32_bf16 v[124:127], a[212:215], a[108:111], v[124:127]
    ds_read_b64_tr_b16 a[206:207], v217 offset:24576
    v_mfma_f32_16x16x32_bf16 v[112:115], a[216:219], a[104:107], v[112:115]
    ds_read_b64_tr_b16 a[208:209], v210 offset:25600
    v_mfma_f32_16x16x32_bf16 v[116:119], a[216:219], a[108:111], v[116:119]
    ds_read_b64_tr_b16 a[210:211], v211 offset:25600
    v_mfma_f32_16x16x32_bf16 v[128:131], a[220:223], a[104:107], v[128:131]
    ds_read_b64_tr_b16 a[212:213], v214 offset:25600
    v_mfma_f32_16x16x32_bf16 v[132:135], a[220:223], a[108:111], v[132:135]
    ds_read_b64_tr_b16 a[214:215], v215 offset:25600
    s_waitcnt lgkmcnt(12)
    v_mfma_f32_16x16x32_bf16 v[104:107], a[224:227], a[112:115], v[104:107]
    ds_read_b64_tr_b16 a[216:217], v212 offset:25600
    v_mfma_f32_16x16x32_bf16 v[108:111], a[224:227], a[116:119], v[108:111]
    ds_read_b64_tr_b16 a[218:219], v213 offset:25600
    v_mfma_f32_16x16x32_bf16 v[120:123], a[228:231], a[112:115], v[120:123]
    ds_read_b64_tr_b16 a[220:221], v216 offset:25600
    v_mfma_f32_16x16x32_bf16 v[124:127], a[228:231], a[116:119], v[124:127]
    ds_read_b64_tr_b16 a[222:223], v217 offset:25600
    v_mfma_f32_16x16x32_bf16 v[112:115], a[232:235], a[112:115], v[112:115]
    ds_read_b64_tr_b16 a[224:225], v210 offset:26624
    v_mfma_f32_16x16x32_bf16 v[116:119], a[232:235], a[116:119], v[116:119]
    ds_read_b64_tr_b16 a[226:227], v211 offset:26624
    v_mfma_f32_16x16x32_bf16 v[128:131], a[236:239], a[112:115], v[128:131]
    ds_read_b64_tr_b16 a[228:229], v214 offset:26624
    v_mfma_f32_16x16x32_bf16 v[132:135], a[236:239], a[116:119], v[132:135]
    ds_read_b64_tr_b16 a[230:231], v215 offset:26624
    s_waitcnt lgkmcnt(12)
    v_mfma_f32_16x16x32_bf16 v[104:107], a[192:195], a[120:123], v[104:107]
    ds_read_b64_tr_b16 a[232:233], v212 offset:26624
    v_mfma_f32_16x16x32_bf16 v[108:111], a[192:195], a[124:127], v[108:111]
    ds_read_b64_tr_b16 a[234:235], v213 offset:26624
    v_mfma_f32_16x16x32_bf16 v[120:123], a[196:199], a[120:123], v[120:123]
    ds_read_b64_tr_b16 a[236:237], v216 offset:26624
    v_mfma_f32_16x16x32_bf16 v[124:127], a[196:199], a[124:127], v[124:127]
    ds_read_b64_tr_b16 a[238:239], v217 offset:26624
    v_mfma_f32_16x16x32_bf16 v[112:115], a[200:203], a[120:123], v[112:115]
    s_waitcnt vmcnt(10)
    s_barrier
    v_mfma_f32_16x16x32_bf16 v[116:119], a[200:203], a[124:127], v[116:119]
    ds_read_b64_tr_b16 a[192:193], v210 offset:27648
    ds_read_b64_tr_b16 a[194:195], v211 offset:27648
    v_mfma_f32_16x16x32_bf16 v[128:131], a[204:207], a[120:123], v[128:131]
    ds_read_b64_tr_b16 a[196:197], v214 offset:27648
    v_mfma_f32_16x16x32_bf16 v[132:135], a[204:207], a[124:127], v[132:135]
    ds_read_b64_tr_b16 a[198:199], v215 offset:27648
    s_waitcnt lgkmcnt(12)
    v_mfma_f32_16x16x32_bf16 v[104:107], a[208:211], a[128:131], v[104:107]
    ds_read_b64_tr_b16 a[200:201], v212 offset:27648
    v_mfma_f32_16x16x32_bf16 v[108:111], a[208:211], a[132:135], v[108:111]
    ds_read_b64_tr_b16 a[202:203], v213 offset:27648
    v_mfma_f32_16x16x32_bf16 v[120:123], a[212:215], a[128:131], v[120:123]
    ds_read_b64_tr_b16 a[204:205], v216 offset:27648
    v_mfma_f32_16x16x32_bf16 v[124:127], a[212:215], a[132:135], v[124:127]
    ds_read_b64_tr_b16 a[206:207], v217 offset:27648
    v_mfma_f32_16x16x32_bf16 v[112:115], a[216:219], a[128:131], v[112:115]
    ds_read_b64_tr_b16 a[208:209], v210 offset:28672
    v_mfma_f32_16x16x32_bf16 v[116:119], a[216:219], a[132:135], v[116:119]
    ds_read_b64_tr_b16 a[210:211], v211 offset:28672
    v_mfma_f32_16x16x32_bf16 v[128:131], a[220:223], a[128:131], v[128:131]
    ds_read_b64_tr_b16 a[212:213], v214 offset:28672
    v_mfma_f32_16x16x32_bf16 v[132:135], a[220:223], a[132:135], v[132:135]
    ds_read_b64_tr_b16 a[214:215], v215 offset:28672
    s_waitcnt lgkmcnt(12)
    v_mfma_f32_16x16x32_bf16 v[104:107], a[224:227], a[136:139], v[104:107]
    ds_read_b64_tr_b16 a[216:217], v212 offset:28672
    v_mfma_f32_16x16x32_bf16 v[108:111], a[224:227], a[140:143], v[108:111]
    ds_read_b64_tr_b16 a[218:219], v213 offset:28672
    v_mfma_f32_16x16x32_bf16 v[120:123], a[228:231], a[136:139], v[120:123]
    ds_read_b64_tr_b16 a[220:221], v216 offset:28672
    v_mfma_f32_16x16x32_bf16 v[124:127], a[228:231], a[140:143], v[124:127]
    ds_read_b64_tr_b16 a[222:223], v217 offset:28672
    v_mfma_f32_16x16x32_bf16 v[112:115], a[232:235], a[136:139], v[112:115]
    ds_read_b64_tr_b16 a[224:225], v210 offset:29696
    v_mfma_f32_16x16x32_bf16 v[116:119], a[232:235], a[140:143], v[116:119]
    ds_read_b64_tr_b16 a[226:227], v211 offset:29696
    v_mfma_f32_16x16x32_bf16 v[128:131], a[236:239], a[136:139], v[128:131]
    ds_read_b64_tr_b16 a[228:229], v214 offset:29696
    v_mfma_f32_16x16x32_bf16 v[132:135], a[236:239], a[140:143], v[132:135]
    ds_read_b64_tr_b16 a[230:231], v215 offset:29696
    s_waitcnt lgkmcnt(12)
    v_mfma_f32_16x16x32_bf16 v[136:139], a[192:195], a[0:3], 0
    ds_read_b64_tr_b16 a[232:233], v212 offset:29696
    v_mfma_f32_16x16x32_bf16 v[140:143], a[192:195], a[4:7], 0
    ds_read_b64_tr_b16 a[234:235], v213 offset:29696
    v_mfma_f32_16x16x32_bf16 v[152:155], a[196:199], a[0:3], 0
    ds_read_b64_tr_b16 a[236:237], v216 offset:29696
    v_mfma_f32_16x16x32_bf16 v[156:159], a[196:199], a[4:7], 0
    ds_read_b64_tr_b16 a[238:239], v217 offset:29696
    v_mfma_f32_16x16x32_bf16 v[144:147], a[200:203], a[0:3], 0
    ds_read_b64_tr_b16 a[192:193], v210 offset:30720
    v_cvt_pk_bf16_f32 v104, v104, v105
    v_mfma_f32_16x16x32_bf16 v[148:151], a[200:203], a[4:7], 0
    ds_read_b64_tr_b16 a[194:195], v211 offset:30720
    v_cvt_pk_bf16_f32 v105, v106, v107
    v_mfma_f32_16x16x32_bf16 v[160:163], a[204:207], a[0:3], 0
    ds_read_b64_tr_b16 a[196:197], v214 offset:30720
    v_cvt_pk_bf16_f32 v106, v108, v109
    v_mfma_f32_16x16x32_bf16 v[164:167], a[204:207], a[4:7], 0
    ds_read_b64_tr_b16 a[198:199], v215 offset:30720
    s_waitcnt lgkmcnt(12)
    v_mfma_f32_16x16x32_bf16 v[136:139], a[208:211], a[8:11], v[136:139]
    ds_read_b64_tr_b16 a[200:201], v212 offset:30720
    v_cvt_pk_bf16_f32 v107, v110, v111
    v_mfma_f32_16x16x32_bf16 v[140:143], a[208:211], a[12:15], v[140:143]
    s_add_u32 s55, s82, 196608
    ds_read_b64_tr_b16 a[202:203], v213 offset:30720
    v_mfma_f32_16x16x32_bf16 v[152:155], a[212:215], a[8:11], v[152:155]
    buffer_store_dwordx4 v[104:107], v1, s[72:75], s55 offen sc1
    ds_read_b64_tr_b16 a[204:205], v216 offset:30720
    v_mfma_f32_16x16x32_bf16 v[156:159], a[212:215], a[12:15], v[156:159]
    ds_read_b64_tr_b16 a[206:207], v217 offset:30720
    v_mfma_f32_16x16x32_bf16 v[144:147], a[216:219], a[8:11], v[144:147]
    ds_read_b64_tr_b16 a[208:209], v210 offset:31744
    v_cvt_pk_bf16_f32 v112, v112, v113
    v_mfma_f32_16x16x32_bf16 v[148:151], a[216:219], a[12:15], v[148:151]
    ds_read_b64_tr_b16 a[210:211], v211 offset:31744
    v_cvt_pk_bf16_f32 v113, v114, v115
    v_mfma_f32_16x16x32_bf16 v[160:163], a[220:223], a[8:11], v[160:163]
    ds_read_b64_tr_b16 a[212:213], v214 offset:31744
    v_cvt_pk_bf16_f32 v114, v116, v117
    v_mfma_f32_16x16x32_bf16 v[164:167], a[220:223], a[12:15], v[164:167]
    ds_read_b64_tr_b16 a[214:215], v215 offset:31744
    s_waitcnt lgkmcnt(12)
    v_mfma_f32_16x16x32_bf16 v[136:139], a[224:227], a[16:19], v[136:139]
    ds_read_b64_tr_b16 a[216:217], v212 offset:31744
    v_cvt_pk_bf16_f32 v115, v118, v119
    v_mfma_f32_16x16x32_bf16 v[140:143], a[224:227], a[20:23], v[140:143]
    s_add_u32 s55, s82, 245760
    ds_read_b64_tr_b16 a[218:219], v213 offset:31744
    v_mfma_f32_16x16x32_bf16 v[152:155], a[228:231], a[16:19], v[152:155]
    buffer_store_dwordx4 v[112:115], v1, s[72:75], s55 offen sc1
    ds_read_b64_tr_b16 a[220:221], v216 offset:31744
    v_mfma_f32_16x16x32_bf16 v[156:159], a[228:231], a[20:23], v[156:159]
    ds_read_b64_tr_b16 a[222:223], v217 offset:31744
    v_mfma_f32_16x16x32_bf16 v[144:147], a[232:235], a[16:19], v[144:147]
    ds_read_b64_tr_b16 a[224:225], v210 offset:32768
    v_cvt_pk_bf16_f32 v120, v120, v121
    s_branch L_sskip30
L_stub30:
    s_setpc_b64 s[100:101]
L_sskip30:
    v_mfma_f32_16x16x32_bf16 v[148:151], a[232:235], a[20:23], v[148:151]
    ds_read_b64_tr_b16 a[226:227], v211 offset:32768
    v_cvt_pk_bf16_f32 v121, v122, v123
    v_mfma_f32_16x16x32_bf16 v[160:163], a[236:239], a[16:19], v[160:163]
    ds_read_b64_tr_b16 a[228:229], v214 offset:32768
    v_cvt_pk_bf16_f32 v122, v124, v125
    v_mfma_f32_16x16x32_bf16 v[164:167], a[236:239], a[20:23], v[164:167]
    ds_read_b64_tr_b16 a[230:231], v215 offset:32768
    s_waitcnt lgkmcnt(12)
    v_mfma_f32_16x16x32_bf16 v[136:139], a[192:195], a[24:27], v[136:139]
    ds_read_b64_tr_b16 a[232:233], v212 offset:32768
    v_cvt_pk_bf16_f32 v123, v126, v127
    v_mfma_f32_16x16x32_bf16 v[140:143], a[192:195], a[28:31], v[140:143]
    s_add_u32 s55, s82, 221184
    ds_read_b64_tr_b16 a[234:235], v213 offset:32768
    v_mfma_f32_16x16x32_bf16 v[152:155], a[196:199], a[24:27], v[152:155]
    buffer_store_dwordx4 v[120:123], v1, s[72:75], s55 offen sc1
    ds_read_b64_tr_b16 a[236:237], v216 offset:32768
    v_mfma_f32_16x16x32_bf16 v[156:159], a[196:199], a[28:31], v[156:159]
    ds_read_b64_tr_b16 a[238:239], v217 offset:32768
    v_mfma_f32_16x16x32_bf16 v[144:147], a[200:203], a[24:27], v[144:147]
    ds_read_b64_tr_b16 a[192:193], v210 offset:33792
    v_cvt_pk_bf16_f32 v128, v128, v129
    v_mfma_f32_16x16x32_bf16 v[148:151], a[200:203], a[28:31], v[148:151]
    ds_read_b64_tr_b16 a[194:195], v211 offset:33792
    v_cvt_pk_bf16_f32 v129, v130, v131
    v_mfma_f32_16x16x32_bf16 v[160:163], a[204:207], a[24:27], v[160:163]
    ds_read_b64_tr_b16 a[196:197], v214 offset:33792
    v_cvt_pk_bf16_f32 v130, v132, v133
    v_mfma_f32_16x16x32_bf16 v[164:167], a[204:207], a[28:31], v[164:167]
    ds_read_b64_tr_b16 a[198:199], v215 offset:33792
    s_waitcnt lgkmcnt(12)
    v_mfma_f32_16x16x32_bf16 v[136:139], a[208:211], a[32:35], v[136:139]
    ds_read_b64_tr_b16 a[200:201], v212 offset:33792
    v_cvt_pk_bf16_f32 v131, v134, v135
    v_mfma_f32_16x16x32_bf16 v[140:143], a[208:211], a[36:39], v[140:143]
    s_add_u32 s55, s82, 270336
    ds_read_b64_tr_b16 a[202:203], v213 offset:33792
    v_mfma_f32_16x16x32_bf16 v[152:155], a[212:215], a[32:35], v[152:155]
    buffer_store_dwordx4 v[128:131], v1, s[72:75], s55 offen sc1
    ds_read_b64_tr_b16 a[204:205], v216 offset:33792
    v_mfma_f32_16x16x32_bf16 v[156:159], a[212:215], a[36:39], v[156:159]
    ds_read_b64_tr_b16 a[206:207], v217 offset:33792
    v_mfma_f32_16x16x32_bf16 v[144:147], a[216:219], a[32:35], v[144:147]
    ds_read_b64_tr_b16 a[208:209], v210 offset:34816
    v_mfma_f32_16x16x32_bf16 v[148:151], a[216:219], a[36:39], v[148:151]
    ds_read_b64_tr_b16 a[210:211], v211 offset:34816
    v_mfma_f32_16x16x32_bf16 v[160:163], a[220:223], a[32:35], v[160:163]
    ds_read_b64_tr_b16 a[212:213], v214 offset:34816
    v_mfma_f32_16x16x32_bf16 v[164:167], a[220:223], a[36:39], v[164:167]
    ds_read_b64_tr_b16 a[214:215], v215 offset:34816
    s_waitcnt lgkmcnt(12)
    v_mfma_f32_16x16x32_bf16 v[136:139], a[224:227], a[40:43], v[136:139]
    ds_read_b64_tr_b16 a[216:217], v212 offset:34816
    v_mfma_f32_16x16x32_bf16 v[140:143], a[224:227], a[44:47], v[140:143]
    ds_read_b64_tr_b16 a[218:219], v213 offset:34816
    v_mfma_f32_16x16x32_bf16 v[152:155], a[228:231], a[40:43], v[152:155]
    ds_read_b64_tr_b16 a[220:221], v216 offset:34816
    v_mfma_f32_16x16x32_bf16 v[156:159], a[228:231], a[44:47], v[156:159]
    ds_read_b64_tr_b16 a[222:223], v217 offset:34816
    v_mfma_f32_16x16x32_bf16 v[144:147], a[232:235], a[40:43], v[144:147]
    ds_read_b64_tr_b16 a[224:225], v210 offset:35840
    v_mfma_f32_16x16x32_bf16 v[148:151], a[232:235], a[44:47], v[148:151]
    ds_read_b64_tr_b16 a[226:227], v211 offset:35840
    v_mfma_f32_16x16x32_bf16 v[160:163], a[236:239], a[40:43], v[160:163]
    ds_read_b64_tr_b16 a[228:229], v214 offset:35840
    v_mfma_f32_16x16x32_bf16 v[164:167], a[236:239], a[44:47], v[164:167]
    ds_read_b64_tr_b16 a[230:231], v215 offset:35840
    s_waitcnt lgkmcnt(12)
    v_mfma_f32_16x16x32_bf16 v[136:139], a[192:195], a[48:51], v[136:139]
    ds_read_b64_tr_b16 a[232:233], v212 offset:35840
    v_mfma_f32_16x16x32_bf16 v[140:143], a[192:195], a[52:55], v[140:143]
    ds_read_b64_tr_b16 a[234:235], v213 offset:35840
    v_mfma_f32_16x16x32_bf16 v[152:155], a[196:199], a[48:51], v[152:155]
    ds_read_b64_tr_b16 a[236:237], v216 offset:35840
    v_mfma_f32_16x16x32_bf16 v[156:159], a[196:199], a[52:55], v[156:159]
    ds_read_b64_tr_b16 a[238:239], v217 offset:35840
    v_mfma_f32_16x16x32_bf16 v[144:147], a[200:203], a[48:51], v[144:147]
    ds_read_b64_tr_b16 a[192:193], v210 offset:36864
    v_mfma_f32_16x16x32_bf16 v[148:151], a[200:203], a[52:55], v[148:151]
    ds_read_b64_tr_b16 a[194:195], v211 offset:36864
    v_mfma_f32_16x16x32_bf16 v[160:163], a[204:207], a[48:51], v[160:163]
    ds_read_b64_tr_b16 a[196:197], v214 offset:36864
    v_mfma_f32_16x16x32_bf16 v[164:167], a[204:207], a[52:55], v[164:167]
    ds_read_b64_tr_b16 a[198:199], v215 offset:36864
    s_waitcnt lgkmcnt(12)
    v_mfma_f32_16x16x32_bf16 v[136:139], a[208:211], a[56:59], v[136:139]
    ds_read_b64_tr_b16 a[200:201], v212 offset:36864
    v_mfma_f32_16x16x32_bf16 v[140:143], a[208:211], a[60:63], v[140:143]
    ds_read_b64_tr_b16 a[202:203], v213 offset:36864
    v_mfma_f32_16x16x32_bf16 v[152:155], a[212:215], a[56:59], v[152:155]
    ds_read_b64_tr_b16 a[204:205], v216 offset:36864
    v_mfma_f32_16x16x32_bf16 v[156:159], a[212:215], a[60:63], v[156:159]
    ds_read_b64_tr_b16 a[206:207], v217 offset:36864
    v_mfma_f32_16x16x32_bf16 v[144:147], a[216:219], a[56:59], v[144:147]
    ds_read_b64_tr_b16 a[208:209], v210 offset:37888
    v_mfma_f32_16x16x32_bf16 v[148:151], a[216:219], a[60:63], v[148:151]
    ds_read_b64_tr_b16 a[210:211], v211 offset:37888
    v_mfma_f32_16x16x32_bf16 v[160:163], a[220:223], a[56:59], v[160:163]
    ds_read_b64_tr_b16 a[212:213], v214 offset:37888
    v_mfma_f32_16x16x32_bf16 v[164:167], a[220:223], a[60:63], v[164:167]
    ds_read_b64_tr_b16 a[214:215], v215 offset:37888
    s_waitcnt lgkmcnt(12)
    v_mfma_f32_16x16x32_bf16 v[136:139], a[224:227], a[64:67], v[136:139]
    ds_read_b64_tr_b16 a[216:217], v212 offset:37888
    v_mfma_f32_16x16x32_bf16 v[140:143], a[224:227], a[68:71], v[140:143]
    ds_read_b64_tr_b16 a[218:219], v213 offset:37888
    v_mfma_f32_16x16x32_bf16 v[152:155], a[228:231], a[64:67], v[152:155]
    ds_read_b64_tr_b16 a[220:221], v216 offset:37888
    v_mfma_f32_16x16x32_bf16 v[156:159], a[228:231], a[68:71], v[156:159]
    ds_read_b64_tr_b16 a[222:223], v217 offset:37888
    v_mfma_f32_16x16x32_bf16 v[144:147], a[232:235], a[64:67], v[144:147]
    ds_read_b64_tr_b16 a[224:225], v210 offset:38912
    v_mfma_f32_16x16x32_bf16 v[148:151], a[232:235], a[68:71], v[148:151]
    ds_read_b64_tr_b16 a[226:227], v211 offset:38912
    v_mfma_f32_16x16x32_bf16 v[160:163], a[236:239], a[64:67], v[160:163]
    ds_read_b64_tr_b16 a[228:229], v214 offset:38912
    v_mfma_f32_16x16x32_bf16 v[164:167], a[236:239], a[68:71], v[164:167]
    ds_read_b64_tr_b16 a[230:231], v215 offset:38912
    s_waitcnt lgkmcnt(12)
    v_mfma_f32_16x16x32_bf16 v[136:139], a[192:195], a[72:75], v[136:139]
    ds_read_b64_tr_b16 a[232:233], v212 offset:38912
    v_mfma_f32_16x16x32_bf16 v[140:143], a[192:195], a[76:79], v[140:143]
    ds_read_b64_tr_b16 a[234:235], v213 offset:38912
    v_mfma_f32_16x16x32_bf16 v[152:155], a[196:199], a[72:75], v[152:155]
    ds_read_b64_tr_b16 a[236:237], v216 offset:38912
    v_mfma_f32_16x16x32_bf16 v[156:159], a[196:199], a[76:79], v[156:159]
    ds_read_b64_tr_b16 a[238:239], v217 offset:38912
    v_mfma_f32_16x16x32_bf16 v[144:147], a[200:203], a[72:75], v[144:147]
    s_waitcnt vmcnt(4)
    s_barrier
    v_mfma_f32_16x16x32_bf16 v[148:151], a[200:203], a[76:79], v[148:151]
    ds_read_b64_tr_b16 a[192:193], v210 offset:0
    ds_read_b64_tr_b16 a[194:195], v211 offset:0
    v_mfma_f32_16x16x32_bf16 v[160:163], a[204:207], a[72:75], v[160:163]
    ds_read_b64_tr_b16 a[196:197], v214 offset:0
    v_mfma_f32_16x16x32_bf16 v[164:167], a[204:207], a[76:79], v[164:167]
    ds_read_b64_tr_b16 a[198:199], v215 offset:0
    s_waitcnt lgkmcnt(12)
    v_mfma_f32_16x16x32_bf16 v[136:139], a[208:211], a[80:83], v[136:139]
    ds_read_b64_tr_b16 a[200:201], v212 offset:0
    v_mfma_f32_16x16x32_bf16 v[140:143], a[208:211], a[84:87], v[140:143]
    ds_read_b64_tr_b16 a[202:203], v213 offset:0
    v_mfma_f32_16x16x32_bf16 v[152:155], a[212:215], a[80:83], v[152:155]
    ds_read_b64_tr_b16 a[204:205], v216 offset:0
    v_mfma_f32_16x16x32_bf16 v[156:159], a[212:215], a[84:87], v[156:159]
    ds_read_b64_tr_b16 a[206:207], v217 offset:0
    v_mfma_f32_16x16x32_bf16 v[144:147], a[216:219], a[80:83], v[144:147]
    ds_read_b64_tr_b16 a[208:209], v210 offset:1024
    v_mfma_f32_16x16x32_bf16 v[148:151], a[216:219], a[84:87], v[148:151]
    ds_read_b64_tr_b16 a[210:211], v211 offset:1024
    v_mfma_f32_16x16x32_bf16 v[160:163], a[220:223], a[80:83], v[160:163]
    ds_read_b64_tr_b16 a[212:213], v214 offset:1024
    v_mfma_f32_16x16x32_bf16 v[164:167], a[220:223], a[84:87], v[164:167]
    ds_read_b64_tr_b16 a[214:215], v215 offset:1024
    s_waitcnt lgkmcnt(12)
    v_mfma_f32_16x16x32_bf16 v[136:139], a[224:227], a[88:91], v[136:139]
    ds_read_b64_tr_b16 a[216:217], v212 offset:1024
    v_mfma_f32_16x16x32_bf16 v[140:143], a[224:227], a[92:95], v[140:143]
    ds_read_b64_tr_b16 a[218:219], v213 offset:1024
    v_mfma_f32_16x16x32_bf16 v[152:155], a[228:231], a[88:91], v[152:155]
    ds_read_b64_tr_b16 a[220:221], v216 offset:1024
    v_mfma_f32_16x16x32_bf16 v[156:159], a[228:231], a[92:95], v[156:159]
    ds_read_b64_tr_b16 a[222:223], v217 offset:1024
    v_mfma_f32_16x16x32_bf16 v[144:147], a[232:235], a[88:91], v[144:147]
    ds_read_b64_tr_b16 a[224:225], v210 offset:2048
    v_mfma_f32_16x16x32_bf16 v[148:151], a[232:235], a[92:95], v[148:151]
    ds_read_b64_tr_b16 a[226:227], v211 offset:2048
    v_mfma_f32_16x16x32_bf16 v[160:163], a[236:239], a[88:91], v[160:163]
    ds_read_b64_tr_b16 a[228:229], v214 offset:2048
    v_mfma_f32_16x16x32_bf16 v[164:167], a[236:239], a[92:95], v[164:167]
    ds_read_b64_tr_b16 a[230:231], v215 offset:2048
    s_waitcnt lgkmcnt(12)
    v_mfma_f32_16x16x32_bf16 v[136:139], a[192:195], a[96:99], v[136:139]
    ds_read_b64_tr_b16 a[232:233], v212 offset:2048
    v_mfma_f32_16x16x32_bf16 v[140:143], a[192:195], a[100:103], v[140:143]
    ds_read_b64_tr_b16 a[234:235], v213 offset:2048
    v_mfma_f32_16x16x32_bf16 v[152:155], a[196:199], a[96:99], v[152:155]
    ds_read_b64_tr_b16 a[236:237], v216 offset:2048
    v_mfma_f32_16x16x32_bf16 v[156:159], a[196:199], a[100:103], v[156:159]
    ds_read_b64_tr_b16 a[238:239], v217 offset:2048
    v_mfma_f32_16x16x32_bf16 v[144:147], a[200:203], a[96:99], v[144:147]
    ds_read_b64_tr_b16 a[192:193], v210 offset:3072
    v_mfma_f32_16x16x32_bf16 v[148:151], a[200:203], a[100:103], v[148:151]
    ds_read_b64_tr_b16 a[194:195], v211 offset:3072
    v_mfma_f32_16x16x32_bf16 v[160:163], a[204:207], a[96:99], v[160:163]
    ds_read_b64_tr_b16 a[196:197], v214 offset:3072
    v_mfma_f32_16x16x32_bf16 v[164:167], a[204:207], a[100:103], v[164:167]
    ds_read_b64_tr_b16 a[198:199], v215 offset:3072
    s_waitcnt lgkmcnt(12)
    v_mfma_f32_16x16x32_bf16 v[136:139], a[208:211], a[104:107], v[136:139]
    ds_read_b64_tr_b16 a[200:201], v212 offset:3072
    v_mfma_f32_16x16x32_bf16 v[140:143], a[208:211], a[108:111], v[140:143]
    ds_read_b64_tr_b16 a[202:203], v213 offset:3072
    v_mfma_f32_16x16x32_bf16 v[152:155], a[212:215], a[104:107], v[152:155]
    ds_read_b64_tr_b16 a[204:205], v216 offset:3072
    v_mfma_f32_16x16x32_bf16 v[156:159], a[212:215], a[108:111], v[156:159]
    ds_read_b64_tr_b16 a[206:207], v217 offset:3072
    v_mfma_f32_16x16x32_bf16 v[144:147], a[216:219], a[104:107], v[144:147]
    ds_read_b64_tr_b16 a[208:209], v210 offset:4096
    v_mfma_f32_16x16x32_bf16 v[148:151], a[216:219], a[108:111], v[148:151]
    ds_read_b64_tr_b16 a[210:211], v211 offset:4096
    v_mfma_f32_16x16x32_bf16 v[160:163], a[220:223], a[104:107], v[160:163]
    ds_read_b64_tr_b16 a[212:213], v214 offset:4096
    v_mfma_f32_16x16x32_bf16 v[164:167], a[220:223], a[108:111], v[164:167]
    ds_read_b64_tr_b16 a[214:215], v215 offset:4096
    s_waitcnt lgkmcnt(12)
    v_mfma_f32_16x16x32_bf16 v[136:139], a[224:227], a[112:115], v[136:139]
    ds_read_b64_tr_b16 a[216:217], v212 offset:4096
    v_mfma_f32_16x16x32_bf16 v[140:143], a[224:227], a[116:119], v[140:143]
    ds_read_b64_tr_b16 a[218:219], v213 offset:4096
    v_mfma_f32_16x16x32_bf16 v[152:155], a[228:231], a[112:115], v[152:155]
    ds_read_b64_tr_b16 a[220:221], v216 offset:4096
    v_mfma_f32_16x16x32_bf16 v[156:159], a[228:231], a[116:119], v[156:159]
    ds_read_b64_tr_b16 a[222:223], v217 offset:4096
    v_mfma_f32_16x16x32_bf16 v[144:147], a[232:235], a[112:115], v[144:147]
    ds_read_b64_tr_b16 a[224:225], v210 offset:5120
    v_mfma_f32_16x16x32_bf16 v[148:151], a[232:235], a[116:119], v[148:151]
    ds_read_b64_tr_b16 a[226:227], v211 offset:5120
    v_mfma_f32_16x16x32_bf16 v[160:163], a[236:239], a[112:115], v[160:163]
    ds_read_b64_tr_b16 a[228:229], v214 offset:5120
    v_mfma_f32_16x16x32_bf16 v[164:167], a[236:239], a[116:119], v[164:167]
    ds_read_b64_tr_b16 a[230:231], v215 offset:5120
    s_waitcnt lgkmcnt(12)
    v_mfma_f32_16x16x32_bf16 v[136:139], a[192:195], a[120:123], v[136:139]
    ds_read_b64_tr_b16 a[232:233], v212 offset:5120
    v_mfma_f32_16x16x32_bf16 v[140:143], a[192:195], a[124:127], v[140:143]
    ds_read_b64_tr_b16 a[234:235], v213 offset:5120
    v_mfma_f32_16x16x32_bf16 v[152:155], a[196:199], a[120:123], v[152:155]
    ds_read_b64_tr_b16 a[236:237], v216 offset:5120
    v_mfma_f32_16x16x32_bf16 v[156:159], a[196:199], a[124:127], v[156:159]
    ds_read_b64_tr_b16 a[238:239], v217 offset:5120
    v_mfma_f32_16x16x32_bf16 v[144:147], a[200:203], a[120:123], v[144:147]
    v_mfma_f32_16x16x32_bf16 v[148:151], a[200:203], a[124:127], v[148:151]
    v_mfma_f32_16x16x32_bf16 v[160:163], a[204:207], a[120:123], v[160:163]
    v_mfma_f32_16x16x32_bf16 v[164:167], a[204:207], a[124:127], v[164:167]
    s_waitcnt lgkmcnt(8)
    v_mfma_f32_16x16x32_bf16 v[136:139], a[208:211], a[128:131], v[136:139]
    v_mfma_f32_16x16x32_bf16 v[140:143], a[208:211], a[132:135], v[140:143]
    v_mfma_f32_16x16x32_bf16 v[152:155], a[212:215], a[128:131], v[152:155]
    v_mfma_f32_16x16x32_bf16 v[156:159], a[212:215], a[132:135], v[156:159]
    v_mfma_f32_16x16x32_bf16 v[144:147], a[216:219], a[128:131], v[144:147]
    v_mfma_f32_16x16x32_bf16 v[148:151], a[216:219], a[132:135], v[148:151]
    v_mfma_f32_16x16x32_bf16 v[160:163], a[220:223], a[128:131], v[160:163]
    v_mfma_f32_16x16x32_bf16 v[164:167], a[220:223], a[132:135], v[164:167]
    s_waitcnt lgkmcnt(0)
    v_mfma_f32_16x16x32_bf16 v[136:139], a[224:227], a[136:139], v[136:139]
    v_mfma_f32_16x16x32_bf16 v[140:143], a[224:227], a[140:143], v[140:143]
    v_mfma_f32_16x16x32_bf16 v[152:155], a[228:231], a[136:139], v[152:155]
    v_mfma_f32_16x16x32_bf16 v[156:159], a[228:231], a[140:143], v[156:159]
    v_mfma_f32_16x16x32_bf16 v[144:147], a[232:235], a[136:139], v[144:147]
    v_mfma_f32_16x16x32_bf16 v[148:151], a[232:235], a[140:143], v[148:151]
    v_mfma_f32_16x16x32_bf16 v[160:163], a[236:239], a[136:139], v[160:163]
    v_mfma_f32_16x16x32_bf16 v[164:167], a[236:239], a[140:143], v[164:167]
    s_nop 7
    s_nop 3
    v_cvt_pk_bf16_f32 v136, v136, v137
    v_cvt_pk_bf16_f32 v137, v138, v139
    v_cvt_pk_bf16_f32 v138, v140, v141
    v_cvt_pk_bf16_f32 v139, v142, v143
    s_add_u32 s55, s82, 247808
    buffer_store_dwordx4 v[136:139], v1, s[72:75], s55 offen sc1
    v_cvt_pk_bf16_f32 v144, v144, v145
    v_cvt_pk_bf16_f32 v145, v146, v147
    v_cvt_pk_bf16_f32 v146, v148, v149
    v_cvt_pk_bf16_f32 v147, v150, v151
    s_add_u32 s55, s82, 246784
    buffer_store_dwordx4 v[144:147], v1, s[72:75], s55 offen sc1
    v_cvt_pk_bf16_f32 v152, v152, v153
    v_cvt_pk_bf16_f32 v153, v154, v155
    v_cvt_pk_bf16_f32 v154, v156, v157
    v_cvt_pk_bf16_f32 v155, v158, v159
    s_add_u32 s55, s82, 272384
    buffer_store_dwordx4 v[152:155], v1, s[72:75], s55 offen sc1
    v_cvt_pk_bf16_f32 v160, v160, v161
    v_cvt_pk_bf16_f32 v161, v162, v163
    v_cvt_pk_bf16_f32 v162, v164, v165
    v_cvt_pk_bf16_f32 v163, v166, v167
    s_add_u32 s55, s82, 271360
    buffer_store_dwordx4 v[160:163], v1, s[72:75], s55 offen sc1
    s_endpgm
L_poll19:
    s_mov_b32 s101, 0x40000
L_loop19:
    global_load_dword v219, v218, s[48:49] sc1
    s_waitcnt vmcnt(0)
    v_cmp_gt_u32 vcc, 1, v219
    s_cbranch_vccz L_fok19
    s_sleep 4
    s_sub_u32 s101, s101, 1
    s_cmp_lg_u32 s101, 0
    s_cbranch_scc1 L_loop19
    s_branch L_fok19
L_poll18:
    s_mov_b32 s101, 0x40000
L_loop18:
    global_load_dword v8, v9, s[46:47] offset:128 sc1
    s_waitcnt vmcnt(0)
    v_cmp_gt_u32 vcc, 1, v8
    s_cbranch_vccz L_fok18
    s_sleep 4
    s_sub_u32 s101, s101, 1
    s_cmp_lg_u32 s101, 0
    s_cbranch_scc1 L_loop18
    s_branch L_fok18
L_codeend:
L_wret:
    s_setpc_b64 s[100:101]
.section .rodata,"a"
.p2align 6
.amdhsa_kernel gated_mix__ssm_conv_s5__swiglu_ffn__prompt_kernel
  .amdhsa_next_free_vgpr 512
  .amdhsa_next_free_sgpr 102
  .amdhsa_accum_offset 256
  .amdhsa_group_segment_fixed_size 0
  .amdhsa_kernarg_size 136
  .amdhsa_user_sgpr_count 2
  .amdhsa_user_sgpr_kernarg_segment_ptr 1
  .amdhsa_system_sgpr_workgroup_id_x 1
  .amdhsa_float_denorm_mode_32 3
.end_amdhsa_kernel
```
